```python
import torch

def _softmax(x, axis=-1):
    return torch.softmax(x, dim=axis)

def _gelu(x):
    return torch.nn.functional.gelu(x, approximate='tanh')

def _silu(x):
    return torch.nn.functional.silu(x)

def _sigmoid(x):
    return torch.sigmoid(x)

def _layernorm(x, axis=-1, eps=1e-05):
    m = x.mean(dim=axis, keepdim=True)
    v = x.var(dim=axis, keepdim=True, unbiased=False)
    return (x - m) / torch.sqrt(v + eps)

def _scatter_add(tgt, idx, src, axis=0):
    return tgt.clone().index_add_(axis, idx, src)

def _segment_sum(src, seg, n):
    out = torch.zeros((n,) + src.shape[1:], dtype=src.dtype)
    return out.index_add_(0, seg, src)

def _pad(x, pw):
    flat = tuple((v for pair in reversed(pw) for v in pair))
    return torch.nn.functional.pad(x, flat)
kernel_name = 'adaLN_cond__ssm_conv_h3__mixer_gmlp__prompt'

def setup_inputs():

    _w = lambda a: (lambda t: t.to(torch.bfloat16) if t.is_floating_point() else t)(torch.as_tensor(a))

    def _A_setup():
        B, S, D = (1, 2048, 640)
        ks = 4
        return {'q': _w((lambda *s: torch.randn(*s, dtype=torch.bfloat16) * 0.05)(B, S, D)), 'k': _w((lambda *s: torch.randn(*s, dtype=torch.bfloat16) * 1.6)(B, S, D)), 'v': _w((lambda *s: torch.randn(*s, dtype=torch.bfloat16) * 1.6)(B, S, D)), 'shift_k': _w((lambda *s: torch.randn(*s, dtype=torch.bfloat16) * 1.6)(D, ks) * 0.5), 'ssm_k': _w((lambda *s: torch.randn(*s, dtype=torch.bfloat16) * 1.6)(D, S) * (1.0 / S ** 0.5)), 'ssm_D': _w((lambda *s: torch.randn(*s, dtype=torch.bfloat16) * 1.6)(D))}
    _A_in = _A_setup()

    def _B_setup():
        B, S, D, F = (1, 2048, 640, 1728)
        Fh = F // 2
        return {'x': _w((lambda *s: torch.randn(*s, dtype=torch.bfloat16) * 0.05)(B, S, D)), 'w_in': _w((lambda *s: torch.randn(*s, dtype=torch.bfloat16) * 0.8)(D, 2 * Fh)), 'w_sp': _w(0.01 * (lambda *s: torch.randn(*s, dtype=torch.bfloat16) * 0.8)(S, S)), 'b_sp': _w(1.0 + 0.01 * (lambda *s: torch.randn(*s, dtype=torch.bfloat16) * 0.1)(S)), 'w_out': _w((lambda *s: torch.randn(*s, dtype=torch.bfloat16) * 0.1)(Fh, D))}
    _B_in = _B_setup()
    return {'A_q': _A_in['q'], 'A_k': _A_in['k'], 'A_v': _A_in['v'], 'A_shift_k': _A_in['shift_k'], 'A_ssm_k': _A_in['ssm_k'], 'A_ssm_D': _A_in['ssm_D'], 'B_x': _B_in['x'], 'B_w_in': _B_in['w_in'], 'B_w_sp': _B_in['w_sp'], 'B_b_sp': _B_in['b_sp'], 'B_w_out': _B_in['w_out'], 'c': _w((lambda *s: torch.randn(*s, dtype=torch.bfloat16) * 0.1)(1, 640) * 8.0), 'w_mod': _w((lambda *s: torch.randn(*s, dtype=torch.bfloat16) * 0.1)(640, 6 * 640) * 640 ** (-0.5) * 8.0)}

def reference(A_q, A_k, A_v, A_shift_k, A_ssm_k, A_ssm_D, B_x, B_w_in, B_w_sp, B_b_sp, B_w_out, c, w_mod):

    def _A_ref(q, k, v, shift_k, ssm_k, ssm_D):
        B, S, D = q.shape
        ks = shift_k.shape[-1]
        k_pad = _pad(k, ((0, 0), (ks - 1, 0), (0, 0)))
        k_shift = torch.zeros_like(k)
        for t in range(ks):
            k_shift = k_shift + k_pad[:, t:t + S, :] * shift_k[:, ks - 1 - t][None, None, :]
        kv = k_shift * v
        L = 2 * S
        kv_pad = _pad(kv, ((0, 0), (0, S), (0, 0)))
        kf_pad = _pad(ssm_k, ((0, 0), (0, S)))
        kv_f = (lambda x, axes=(-2, -1): torch.fft.rfft2(x.float(), dim=axes))(kv_pad[:, None, :, :], axes=(1, 2))
        kf_f = (lambda x, axes=(-2, -1): torch.fft.rfft2(x.float(), dim=axes))(kf_pad[:, None, :], axes=(1, 2))
        kf_f = (lambda x, *d: x.permute(*d))(kf_f, 1, 2, 0)
        y_f = kv_f * kf_f[None, :, :, :]
        y = (lambda x, s, axes=(-2, -1): torch.fft.irfft2(x, s=s, dim=axes).to(torch.bfloat16))(y_f, (1, L), axes=(1, 2))[:, 0, :S, :]
        y = y + kv * ssm_D[None, None, :]
        return q * y

    def _B_ref(x, w_in, w_sp, b_sp, w_out):
        B, S, D = x.shape
        F = w_in.shape[-1]
        Fh = F // 2
        z = _gelu(torch.einsum('bsd,df->bsf', x, w_in))
        z1 = z[..., :Fh].clone()
        z2 = _layernorm(z[..., Fh:], axis=-1)
        g = torch.einsum('ts,bsf->btf', w_sp, z2) + b_sp[None, :, None]
        return torch.einsum('bsf,fd->bsd', z1 * g, w_out)
    x = A_q
    mod = (_silu(c) @ w_mod).reshape(c.shape[0], 6, 1, -1)
    sa, ca, ga, sb, cb, gb = (mod[:, 0].clone(), mod[:, 1].clone(), mod[:, 2].clone(), mod[:, 3].clone(), mod[:, 4].clone(), mod[:, 5].clone())
    h = _layernorm(x, axis=-1) * (1 + ca) + sa
    x = x + ga * _A_ref(h, A_k, A_v, A_shift_k, A_ssm_k, A_ssm_D)
    h = _layernorm(x, axis=-1) * (1 + cb) + sb
    x = x + gb * _B_ref(h, B_w_in, B_w_sp, B_b_sp, B_w_out)
    return x
```

```asm
; @launch kernel=side_kernel grid=(245,1,1) block=(256,1,1) lds=43008
; @launch kernel=conv_kernel grid=(256,1,1) block=(256,1,1) lds=99584
; @launch kernel=g1_kernel grid=(256,1,1) block=(256,1,1) lds=87296
; @launch kernel=g2_kernel grid=(256,1,1) block=(256,1,1) lds=86016
; @launch kernel=g3_kernel grid=(256,1,1) block=(256,1,1) lds=139264
.amdgcn_target "amdgcn-amd-amdhsa--gfx950"
.text
.p2align 8
.globl side_kernel
.type side_kernel,@function
side_kernel:
    s_cmp_ge_u32 s2, 245
    s_cbranch_scc1 Lend_side_kernel
    s_load_dwordx16 s[8:23], s[0:1], 0
    s_load_dwordx16 s[24:39], s[0:1], 64
    v_lshrrev_b32 v2, 6, v0
    v_and_b32 v1, 63, v0
    v_readfirstlane_b32 s3, v2
    s_waitcnt lgkmcnt(0)
    s_mov_b32 s40, s2
    s_cmp_ge_u32 s40, 120
    s_cbranch_scc1 Lrole_side_kernel_0
    s_cmp_ge_u32 s40, 60
    s_cselect_b32 s4, 1, 0
    s_mul_i32 s5, s4, 60
    s_sub_u32 s5, s40, s5
    s_mul_i32 s6, s4, 320
    s_mul_i32 s7, s3, 80
    s_add_u32 s6, s6, s7
    v_lshrrev_b32 v2, 3, v1
    v_add_u32 v2, s6, v2
    v_lshlrev_b32 v4, 1, v2
    v_mul_u32_u24 v3, 7680, v2
    v_and_b32 v2, 7, v1
    v_lshl_add_u32 v3, v2, 4, v3
    s_lshl_b32 s7, s5, 7
    v_add_u32 v3, s7, v3
    global_load_ushort v6, v4, s[30:31] offset:0
    global_load_ushort v7, v4, s[30:31] offset:16
    global_load_ushort v8, v4, s[30:31] offset:32
    global_load_ushort v9, v4, s[30:31] offset:48
    global_load_ushort v10, v4, s[30:31] offset:64
    global_load_ushort v11, v4, s[30:31] offset:80
    global_load_ushort v12, v4, s[30:31] offset:96
    global_load_ushort v13, v4, s[30:31] offset:112
    global_load_ushort v14, v4, s[30:31] offset:128
    global_load_ushort v15, v4, s[30:31] offset:144
    global_load_dwordx4 v[16:19], v3, s[32:33] nt
    v_add_u32 v3, 61440, v3
    global_load_dwordx4 v[20:23], v3, s[32:33] nt
    v_add_u32 v3, 61440, v3
    global_load_dwordx4 v[24:27], v3, s[32:33] nt
    v_add_u32 v3, 61440, v3
    global_load_dwordx4 v[28:31], v3, s[32:33] nt
    v_add_u32 v3, 61440, v3
    global_load_dwordx4 v[32:35], v3, s[32:33] nt
    v_add_u32 v3, 61440, v3
    global_load_dwordx4 v[36:39], v3, s[32:33] nt
    v_add_u32 v3, 61440, v3
    global_load_dwordx4 v[40:43], v3, s[32:33] nt
    v_add_u32 v3, 61440, v3
    global_load_dwordx4 v[44:47], v3, s[32:33] nt
    v_add_u32 v3, 61440, v3
    global_load_dwordx4 v[48:51], v3, s[32:33] nt
    v_add_u32 v3, 61440, v3
    global_load_dwordx4 v[52:55], v3, s[32:33] nt
    s_waitcnt vmcnt(19)
    v_lshlrev_b32 v6, 16, v6
    v_mul_f32 v56, 0xbfb8aa3b, v6
    s_waitcnt vmcnt(18)
    v_lshlrev_b32 v7, 16, v7
    v_mul_f32 v57, 0xbfb8aa3b, v7
    s_waitcnt vmcnt(17)
    v_lshlrev_b32 v8, 16, v8
    v_mul_f32 v58, 0xbfb8aa3b, v8
    s_waitcnt vmcnt(16)
    v_lshlrev_b32 v9, 16, v9
    v_mul_f32 v59, 0xbfb8aa3b, v9
    s_waitcnt vmcnt(15)
    v_lshlrev_b32 v10, 16, v10
    v_mul_f32 v60, 0xbfb8aa3b, v10
    s_waitcnt vmcnt(14)
    v_lshlrev_b32 v11, 16, v11
    v_mul_f32 v61, 0xbfb8aa3b, v11
    s_waitcnt vmcnt(13)
    v_lshlrev_b32 v12, 16, v12
    v_mul_f32 v62, 0xbfb8aa3b, v12
    s_waitcnt vmcnt(12)
    v_lshlrev_b32 v13, 16, v13
    v_mul_f32 v63, 0xbfb8aa3b, v13
    s_waitcnt vmcnt(11)
    v_lshlrev_b32 v14, 16, v14
    v_mul_f32 v64, 0xbfb8aa3b, v14
    s_waitcnt vmcnt(10)
    v_lshlrev_b32 v15, 16, v15
    v_mul_f32 v65, 0xbfb8aa3b, v15
    v_exp_f32 v56, v56
    v_exp_f32 v57, v57
    v_exp_f32 v58, v58
    v_exp_f32 v59, v59
    v_exp_f32 v60, v60
    v_exp_f32 v61, v61
    v_exp_f32 v62, v62
    v_exp_f32 v63, v63
    v_exp_f32 v64, v64
    v_exp_f32 v65, v65
    v_add_f32 v56, 1.0, v56
    v_add_f32 v57, 1.0, v57
    v_add_f32 v58, 1.0, v58
    v_add_f32 v59, 1.0, v59
    v_add_f32 v60, 1.0, v60
    v_add_f32 v61, 1.0, v61
    v_add_f32 v62, 1.0, v62
    v_add_f32 v63, 1.0, v63
    v_add_f32 v64, 1.0, v64
    v_add_f32 v65, 1.0, v65
    v_rcp_f32 v56, v56
    v_rcp_f32 v57, v57
    v_rcp_f32 v58, v58
    v_rcp_f32 v59, v59
    v_rcp_f32 v60, v60
    v_rcp_f32 v61, v61
    v_rcp_f32 v62, v62
    v_rcp_f32 v63, v63
    v_rcp_f32 v64, v64
    v_rcp_f32 v65, v65
    v_mul_f32 v6, v6, v56
    v_mul_f32 v7, v7, v57
    v_mul_f32 v8, v8, v58
    v_mul_f32 v9, v9, v59
    v_mul_f32 v10, v10, v60
    v_mul_f32 v11, v11, v61
    v_mul_f32 v12, v12, v62
    v_mul_f32 v13, v13, v63
    v_mul_f32 v14, v14, v64
    v_mul_f32 v15, v15, v65
    v_cvt_pk_bf16_f32 v6, v6, v6
    v_lshlrev_b32 v6, 16, v6
    v_cvt_pk_bf16_f32 v7, v7, v7
    v_lshlrev_b32 v7, 16, v7
    v_cvt_pk_bf16_f32 v8, v8, v8
    v_lshlrev_b32 v8, 16, v8
    v_cvt_pk_bf16_f32 v9, v9, v9
    v_lshlrev_b32 v9, 16, v9
    v_cvt_pk_bf16_f32 v10, v10, v10
    v_lshlrev_b32 v10, 16, v10
    v_cvt_pk_bf16_f32 v11, v11, v11
    v_lshlrev_b32 v11, 16, v11
    v_cvt_pk_bf16_f32 v12, v12, v12
    v_lshlrev_b32 v12, 16, v12
    v_cvt_pk_bf16_f32 v13, v13, v13
    v_lshlrev_b32 v13, 16, v13
    v_cvt_pk_bf16_f32 v14, v14, v14
    v_lshlrev_b32 v14, 16, v14
    v_cvt_pk_bf16_f32 v15, v15, v15
    v_lshlrev_b32 v15, 16, v15
    s_waitcnt vmcnt(9)
    v_lshlrev_b32 v74, 16, v16
    v_and_b32 v75, 0xffff0000, v16
    v_lshlrev_b32 v76, 16, v17
    v_and_b32 v77, 0xffff0000, v17
    v_lshlrev_b32 v78, 16, v18
    v_and_b32 v79, 0xffff0000, v18
    v_lshlrev_b32 v80, 16, v19
    v_and_b32 v81, 0xffff0000, v19
    v_pk_mul_f32 v[66:67], v[6:7], v[74:75] op_sel:[0,0] op_sel_hi:[0,1]
    v_pk_mul_f32 v[68:69], v[6:7], v[76:77] op_sel:[0,0] op_sel_hi:[0,1]
    v_pk_mul_f32 v[70:71], v[6:7], v[78:79] op_sel:[0,0] op_sel_hi:[0,1]
    v_pk_mul_f32 v[72:73], v[6:7], v[80:81] op_sel:[0,0] op_sel_hi:[0,1]
    s_waitcnt vmcnt(8)
    v_lshlrev_b32 v74, 16, v20
    v_and_b32 v75, 0xffff0000, v20
    v_lshlrev_b32 v76, 16, v21
    v_and_b32 v77, 0xffff0000, v21
    v_lshlrev_b32 v78, 16, v22
    v_and_b32 v79, 0xffff0000, v22
    v_lshlrev_b32 v80, 16, v23
    v_and_b32 v81, 0xffff0000, v23
    v_pk_fma_f32 v[66:67], v[6:7], v[74:75], v[66:67] op_sel:[1,0,0] op_sel_hi:[1,1,1]
    v_pk_fma_f32 v[68:69], v[6:7], v[76:77], v[68:69] op_sel:[1,0,0] op_sel_hi:[1,1,1]
    v_pk_fma_f32 v[70:71], v[6:7], v[78:79], v[70:71] op_sel:[1,0,0] op_sel_hi:[1,1,1]
    v_pk_fma_f32 v[72:73], v[6:7], v[80:81], v[72:73] op_sel:[1,0,0] op_sel_hi:[1,1,1]
    s_waitcnt vmcnt(7)
    v_lshlrev_b32 v74, 16, v24
    v_and_b32 v75, 0xffff0000, v24
    v_lshlrev_b32 v76, 16, v25
    v_and_b32 v77, 0xffff0000, v25
    v_lshlrev_b32 v78, 16, v26
    v_and_b32 v79, 0xffff0000, v26
    v_lshlrev_b32 v80, 16, v27
    v_and_b32 v81, 0xffff0000, v27
    v_pk_fma_f32 v[66:67], v[8:9], v[74:75], v[66:67] op_sel:[0,0,0] op_sel_hi:[0,1,1]
    v_pk_fma_f32 v[68:69], v[8:9], v[76:77], v[68:69] op_sel:[0,0,0] op_sel_hi:[0,1,1]
    v_pk_fma_f32 v[70:71], v[8:9], v[78:79], v[70:71] op_sel:[0,0,0] op_sel_hi:[0,1,1]
    v_pk_fma_f32 v[72:73], v[8:9], v[80:81], v[72:73] op_sel:[0,0,0] op_sel_hi:[0,1,1]
    s_waitcnt vmcnt(6)
    v_lshlrev_b32 v74, 16, v28
    v_and_b32 v75, 0xffff0000, v28
    v_lshlrev_b32 v76, 16, v29
    v_and_b32 v77, 0xffff0000, v29
    v_lshlrev_b32 v78, 16, v30
    v_and_b32 v79, 0xffff0000, v30
    v_lshlrev_b32 v80, 16, v31
    v_and_b32 v81, 0xffff0000, v31
    v_pk_fma_f32 v[66:67], v[8:9], v[74:75], v[66:67] op_sel:[1,0,0] op_sel_hi:[1,1,1]
    v_pk_fma_f32 v[68:69], v[8:9], v[76:77], v[68:69] op_sel:[1,0,0] op_sel_hi:[1,1,1]
    v_pk_fma_f32 v[70:71], v[8:9], v[78:79], v[70:71] op_sel:[1,0,0] op_sel_hi:[1,1,1]
    v_pk_fma_f32 v[72:73], v[8:9], v[80:81], v[72:73] op_sel:[1,0,0] op_sel_hi:[1,1,1]
    s_waitcnt vmcnt(5)
    v_lshlrev_b32 v74, 16, v32
    v_and_b32 v75, 0xffff0000, v32
    v_lshlrev_b32 v76, 16, v33
    v_and_b32 v77, 0xffff0000, v33
    v_lshlrev_b32 v78, 16, v34
    v_and_b32 v79, 0xffff0000, v34
    v_lshlrev_b32 v80, 16, v35
    v_and_b32 v81, 0xffff0000, v35
    v_pk_fma_f32 v[66:67], v[10:11], v[74:75], v[66:67] op_sel:[0,0,0] op_sel_hi:[0,1,1]
    v_pk_fma_f32 v[68:69], v[10:11], v[76:77], v[68:69] op_sel:[0,0,0] op_sel_hi:[0,1,1]
    v_pk_fma_f32 v[70:71], v[10:11], v[78:79], v[70:71] op_sel:[0,0,0] op_sel_hi:[0,1,1]
    v_pk_fma_f32 v[72:73], v[10:11], v[80:81], v[72:73] op_sel:[0,0,0] op_sel_hi:[0,1,1]
    s_waitcnt vmcnt(4)
    v_lshlrev_b32 v74, 16, v36
    v_and_b32 v75, 0xffff0000, v36
    v_lshlrev_b32 v76, 16, v37
    v_and_b32 v77, 0xffff0000, v37
    v_lshlrev_b32 v78, 16, v38
    v_and_b32 v79, 0xffff0000, v38
    v_lshlrev_b32 v80, 16, v39
    v_and_b32 v81, 0xffff0000, v39
    v_pk_fma_f32 v[66:67], v[10:11], v[74:75], v[66:67] op_sel:[1,0,0] op_sel_hi:[1,1,1]
    v_pk_fma_f32 v[68:69], v[10:11], v[76:77], v[68:69] op_sel:[1,0,0] op_sel_hi:[1,1,1]
    v_pk_fma_f32 v[70:71], v[10:11], v[78:79], v[70:71] op_sel:[1,0,0] op_sel_hi:[1,1,1]
    v_pk_fma_f32 v[72:73], v[10:11], v[80:81], v[72:73] op_sel:[1,0,0] op_sel_hi:[1,1,1]
    s_waitcnt vmcnt(3)
    v_lshlrev_b32 v74, 16, v40
    v_and_b32 v75, 0xffff0000, v40
    v_lshlrev_b32 v76, 16, v41
    v_and_b32 v77, 0xffff0000, v41
    v_lshlrev_b32 v78, 16, v42
    v_and_b32 v79, 0xffff0000, v42
    v_lshlrev_b32 v80, 16, v43
    v_and_b32 v81, 0xffff0000, v43
    v_pk_fma_f32 v[66:67], v[12:13], v[74:75], v[66:67] op_sel:[0,0,0] op_sel_hi:[0,1,1]
    v_pk_fma_f32 v[68:69], v[12:13], v[76:77], v[68:69] op_sel:[0,0,0] op_sel_hi:[0,1,1]
    v_pk_fma_f32 v[70:71], v[12:13], v[78:79], v[70:71] op_sel:[0,0,0] op_sel_hi:[0,1,1]
    v_pk_fma_f32 v[72:73], v[12:13], v[80:81], v[72:73] op_sel:[0,0,0] op_sel_hi:[0,1,1]
    s_waitcnt vmcnt(2)
    v_lshlrev_b32 v74, 16, v44
    v_and_b32 v75, 0xffff0000, v44
    v_lshlrev_b32 v76, 16, v45
    v_and_b32 v77, 0xffff0000, v45
    v_lshlrev_b32 v78, 16, v46
    v_and_b32 v79, 0xffff0000, v46
    v_lshlrev_b32 v80, 16, v47
    v_and_b32 v81, 0xffff0000, v47
    v_pk_fma_f32 v[66:67], v[12:13], v[74:75], v[66:67] op_sel:[1,0,0] op_sel_hi:[1,1,1]
    v_pk_fma_f32 v[68:69], v[12:13], v[76:77], v[68:69] op_sel:[1,0,0] op_sel_hi:[1,1,1]
    v_pk_fma_f32 v[70:71], v[12:13], v[78:79], v[70:71] op_sel:[1,0,0] op_sel_hi:[1,1,1]
    v_pk_fma_f32 v[72:73], v[12:13], v[80:81], v[72:73] op_sel:[1,0,0] op_sel_hi:[1,1,1]
    s_waitcnt vmcnt(1)
    v_lshlrev_b32 v74, 16, v48
    v_and_b32 v75, 0xffff0000, v48
    v_lshlrev_b32 v76, 16, v49
    v_and_b32 v77, 0xffff0000, v49
    v_lshlrev_b32 v78, 16, v50
    v_and_b32 v79, 0xffff0000, v50
    v_lshlrev_b32 v80, 16, v51
    v_and_b32 v81, 0xffff0000, v51
    v_pk_fma_f32 v[66:67], v[14:15], v[74:75], v[66:67] op_sel:[0,0,0] op_sel_hi:[0,1,1]
    v_pk_fma_f32 v[68:69], v[14:15], v[76:77], v[68:69] op_sel:[0,0,0] op_sel_hi:[0,1,1]
    v_pk_fma_f32 v[70:71], v[14:15], v[78:79], v[70:71] op_sel:[0,0,0] op_sel_hi:[0,1,1]
    v_pk_fma_f32 v[72:73], v[14:15], v[80:81], v[72:73] op_sel:[0,0,0] op_sel_hi:[0,1,1]
    s_waitcnt vmcnt(0)
    v_lshlrev_b32 v74, 16, v52
    v_and_b32 v75, 0xffff0000, v52
    v_lshlrev_b32 v76, 16, v53
    v_and_b32 v77, 0xffff0000, v53
    v_lshlrev_b32 v78, 16, v54
    v_and_b32 v79, 0xffff0000, v54
    v_lshlrev_b32 v80, 16, v55
    v_and_b32 v81, 0xffff0000, v55
    v_pk_fma_f32 v[66:67], v[14:15], v[74:75], v[66:67] op_sel:[1,0,0] op_sel_hi:[1,1,1]
    v_pk_fma_f32 v[68:69], v[14:15], v[76:77], v[68:69] op_sel:[1,0,0] op_sel_hi:[1,1,1]
    v_pk_fma_f32 v[70:71], v[14:15], v[78:79], v[70:71] op_sel:[1,0,0] op_sel_hi:[1,1,1]
    v_pk_fma_f32 v[72:73], v[14:15], v[80:81], v[72:73] op_sel:[1,0,0] op_sel_hi:[1,1,1]
    s_nop 0
    v_permlane32_swap_b32 v66, v70
    v_permlane32_swap_b32 v67, v71
    v_permlane32_swap_b32 v68, v72
    v_permlane32_swap_b32 v69, v73
    v_add_f32 v66, v66, v70
    v_add_f32 v67, v67, v71
    v_add_f32 v68, v68, v72
    v_add_f32 v69, v69, v73
    s_nop 0
    v_permlane16_swap_b32 v66, v68
    v_permlane16_swap_b32 v67, v69
    v_add_f32 v66, v66, v68
    v_add_f32 v67, v67, v69
    s_nop 0
    v_add_f32_dpp v74, v66, v66 row_ror:8 row_mask:0xf bank_mask:0x3
    s_nop 1
    v_add_f32_dpp v74, v67, v67 row_ror:8 row_mask:0xf bank_mask:0xc
    v_and_b32 v75, 7, v1
    v_lshrrev_b32 v76, 3, v1
    v_lshl_add_u32 v75, v75, 3, v76
    s_lshl_b32 s7, s3, 6
    v_add_lshl_u32 v75, v75, s7, 2
    ds_write_b32 v75, v74
    s_waitcnt lgkmcnt(0)
    s_barrier
    v_lshlrev_b32 v75, 2, v1
    ds_read_b32 v66, v75 offset:0
    ds_read_b32 v67, v75 offset:256
    ds_read_b32 v68, v75 offset:512
    ds_read_b32 v69, v75 offset:768
    s_mul_i32 s6, s4, 15360
    s_lshl_b32 s7, s5, 8
    s_add_u32 s6, s6, s7
    s_add_u32 s6, s6, 0
    v_add_u32 v75, s6, v75
    s_waitcnt lgkmcnt(2)
    v_add_f32 v66, v66, v67
    s_waitcnt lgkmcnt(0)
    v_add_f32 v68, v68, v69
    v_add_f32 v66, v66, v68
    s_cmp_lg_u32 s3, 0
    s_cbranch_scc1 Lmod_skip_15664_282
    global_store_dword v75, v66, s[38:39] sc1
Lmod_skip_15664_282:
    s_branch Ldone_side_kernel
Lrole_side_kernel_0:
    s_sub_u32 s40, s40, 120
    s_cmp_ge_u32 s40, 64
    s_cbranch_scc1 Lrole_side_kernel_1
    s_lshl_b32 s4, s40, 2
    s_add_u32 s4, s4, s3
    s_mul_i32 s4, s4, 10240
    s_add_u32 s4, s4, 4096
    v_lshl_add_u32 v2, v1, 4, s4
    global_load_dwordx4 v[8:11], v2, s[8:9] offset:-4096 nt
    global_load_dwordx4 v[12:15], v2, s[8:9] offset:-3072 nt
    global_load_dwordx4 v[16:19], v2, s[8:9] offset:-2048 nt
    global_load_dwordx4 v[20:23], v2, s[8:9] offset:-1024 nt
    global_load_dwordx4 v[24:27], v2, s[8:9] offset:0 nt
    global_load_dwordx4 v[28:31], v2, s[8:9] offset:1024 nt
    global_load_dwordx4 v[32:35], v2, s[8:9] offset:2048 nt
    global_load_dwordx4 v[36:39], v2, s[8:9] offset:3072 nt
    v_add_u32 v2, 8192, v2
    global_load_dwordx4 v[40:43], v2, s[8:9] offset:-4096 nt
    global_load_dwordx4 v[44:47], v2, s[8:9] offset:-3072 nt
    s_mul_i32 s5, s3, 10304
    v_lshl_add_u32 v3, v1, 4, s5
    v_lshrrev_b32 v4, 5, v1
    v_lshl_add_u32 v4, v4, 4, v3
    s_waitcnt vmcnt(9)
    ds_write_b128 v3, v[8:11] offset:0
    s_waitcnt vmcnt(8)
    ds_write_b128 v3, v[12:15] offset:1024
    s_waitcnt vmcnt(7)
    ds_write_b128 v4, v[16:19] offset:2048
    s_waitcnt vmcnt(6)
    ds_write_b128 v3, v[20:23] offset:3088
    s_waitcnt vmcnt(5)
    ds_write_b128 v3, v[24:27] offset:4112
    s_waitcnt vmcnt(4)
    ds_write_b128 v3, v[28:31] offset:5152
    s_waitcnt vmcnt(3)
    ds_write_b128 v3, v[32:35] offset:6176
    s_waitcnt vmcnt(2)
    ds_write_b128 v4, v[36:39] offset:7200
    s_waitcnt vmcnt(1)
    ds_write_b128 v3, v[40:43] offset:8240
    s_waitcnt vmcnt(0)
    ds_write_b128 v3, v[44:47] offset:9264
    s_waitcnt lgkmcnt(0)
    s_barrier
    v_and_b32 v48, 15, v1
    v_lshrrev_b32 v49, 4, v1
    v_mul_u32_u24 v3, 2576, v48
    v_lshl_add_u32 v3, v49, 3, v3
    s_mul_i32 s5, s3, 320
    v_add_u32 v3, s5, v3
    ds_read2_b64 v[8:11], v3 offset0:0 offset1:160
    ds_read2_b64 v[12:15], v3 offset0:4 offset1:164
    ds_read2_b64 v[16:19], v3 offset0:8 offset1:168
    ds_read2_b64 v[20:23], v3 offset0:12 offset1:172
    ds_read2_b64 v[24:27], v3 offset0:16 offset1:176
    ds_read2_b64 v[28:31], v3 offset0:20 offset1:180
    ds_read2_b64 v[32:35], v3 offset0:24 offset1:184
    ds_read2_b64 v[36:39], v3 offset0:28 offset1:188
    ds_read2_b64 v[40:43], v3 offset0:32 offset1:192
    ds_read2_b64 v[44:47], v3 offset0:36 offset1:196
    s_mul_i32 s5, s3, 655360
    s_lshl_b32 s6, s40, 8
    s_add_u32 s5, s5, s6
    s_add_u32 s5, s5, 1048576
    v_lshlrev_b32 v2, 14, v49
    v_lshl_add_u32 v2, v48, 4, v2
    v_add_u32 v2, s5, v2
    s_mov_b32 s7, 0x3f803f80
    v_mov_b32 v50, 0
    v_mov_b32 v51, 0
    v_mov_b32 v52, 0
    v_mov_b32 v53, 0
    s_waitcnt lgkmcnt(9)
    global_store_dwordx4 v2, v[8:11], s[38:39] sc1
    v_add_u32 v2, 65536, v2
    v_dot2_f32_bf16 v50, v8, s7, v50
    v_dot2_f32_bf16 v51, v8, v8, v51
    v_dot2_f32_bf16 v52, v10, s7, v52
    v_dot2_f32_bf16 v53, v10, v10, v53
    v_dot2_f32_bf16 v50, v9, s7, v50
    v_dot2_f32_bf16 v51, v9, v9, v51
    v_dot2_f32_bf16 v52, v11, s7, v52
    v_dot2_f32_bf16 v53, v11, v11, v53
    s_waitcnt lgkmcnt(8)
    global_store_dwordx4 v2, v[12:15], s[38:39] sc1
    v_add_u32 v2, 65536, v2
    v_dot2_f32_bf16 v50, v12, s7, v50
    v_dot2_f32_bf16 v51, v12, v12, v51
    v_dot2_f32_bf16 v52, v14, s7, v52
    v_dot2_f32_bf16 v53, v14, v14, v53
    v_dot2_f32_bf16 v50, v13, s7, v50
    v_dot2_f32_bf16 v51, v13, v13, v51
    v_dot2_f32_bf16 v52, v15, s7, v52
    v_dot2_f32_bf16 v53, v15, v15, v53
    s_waitcnt lgkmcnt(7)
    global_store_dwordx4 v2, v[16:19], s[38:39] sc1
    v_add_u32 v2, 65536, v2
    v_dot2_f32_bf16 v50, v16, s7, v50
    v_dot2_f32_bf16 v51, v16, v16, v51
    v_dot2_f32_bf16 v52, v18, s7, v52
    v_dot2_f32_bf16 v53, v18, v18, v53
    v_dot2_f32_bf16 v50, v17, s7, v50
    v_dot2_f32_bf16 v51, v17, v17, v51
    v_dot2_f32_bf16 v52, v19, s7, v52
    v_dot2_f32_bf16 v53, v19, v19, v53
    s_waitcnt lgkmcnt(6)
    global_store_dwordx4 v2, v[20:23], s[38:39] sc1
    v_add_u32 v2, 65536, v2
    v_dot2_f32_bf16 v50, v20, s7, v50
    v_dot2_f32_bf16 v51, v20, v20, v51
    v_dot2_f32_bf16 v52, v22, s7, v52
    v_dot2_f32_bf16 v53, v22, v22, v53
    v_dot2_f32_bf16 v50, v21, s7, v50
    v_dot2_f32_bf16 v51, v21, v21, v51
    v_dot2_f32_bf16 v52, v23, s7, v52
    v_dot2_f32_bf16 v53, v23, v23, v53
    s_waitcnt lgkmcnt(5)
    global_store_dwordx4 v2, v[24:27], s[38:39] sc1
    v_add_u32 v2, 65536, v2
    v_dot2_f32_bf16 v50, v24, s7, v50
    v_dot2_f32_bf16 v51, v24, v24, v51
    v_dot2_f32_bf16 v52, v26, s7, v52
    v_dot2_f32_bf16 v53, v26, v26, v53
    v_dot2_f32_bf16 v50, v25, s7, v50
    v_dot2_f32_bf16 v51, v25, v25, v51
    v_dot2_f32_bf16 v52, v27, s7, v52
    v_dot2_f32_bf16 v53, v27, v27, v53
    s_waitcnt lgkmcnt(4)
    global_store_dwordx4 v2, v[28:31], s[38:39] sc1
    v_add_u32 v2, 65536, v2
    v_dot2_f32_bf16 v50, v28, s7, v50
    v_dot2_f32_bf16 v51, v28, v28, v51
    v_dot2_f32_bf16 v52, v30, s7, v52
    v_dot2_f32_bf16 v53, v30, v30, v53
    v_dot2_f32_bf16 v50, v29, s7, v50
    v_dot2_f32_bf16 v51, v29, v29, v51
    v_dot2_f32_bf16 v52, v31, s7, v52
    v_dot2_f32_bf16 v53, v31, v31, v53
    s_waitcnt lgkmcnt(3)
    global_store_dwordx4 v2, v[32:35], s[38:39] sc1
    v_add_u32 v2, 65536, v2
    v_dot2_f32_bf16 v50, v32, s7, v50
    v_dot2_f32_bf16 v51, v32, v32, v51
    v_dot2_f32_bf16 v52, v34, s7, v52
    v_dot2_f32_bf16 v53, v34, v34, v53
    v_dot2_f32_bf16 v50, v33, s7, v50
    v_dot2_f32_bf16 v51, v33, v33, v51
    v_dot2_f32_bf16 v52, v35, s7, v52
    v_dot2_f32_bf16 v53, v35, v35, v53
    s_waitcnt lgkmcnt(2)
    global_store_dwordx4 v2, v[36:39], s[38:39] sc1
    v_add_u32 v2, 65536, v2
    v_dot2_f32_bf16 v50, v36, s7, v50
    v_dot2_f32_bf16 v51, v36, v36, v51
    v_dot2_f32_bf16 v52, v38, s7, v52
    v_dot2_f32_bf16 v53, v38, v38, v53
    v_dot2_f32_bf16 v50, v37, s7, v50
    v_dot2_f32_bf16 v51, v37, v37, v51
    v_dot2_f32_bf16 v52, v39, s7, v52
    v_dot2_f32_bf16 v53, v39, v39, v53
    s_waitcnt lgkmcnt(1)
    global_store_dwordx4 v2, v[40:43], s[38:39] sc1
    v_add_u32 v2, 65536, v2
    v_dot2_f32_bf16 v50, v40, s7, v50
    v_dot2_f32_bf16 v51, v40, v40, v51
    v_dot2_f32_bf16 v52, v42, s7, v52
    v_dot2_f32_bf16 v53, v42, v42, v53
    v_dot2_f32_bf16 v50, v41, s7, v50
    v_dot2_f32_bf16 v51, v41, v41, v51
    v_dot2_f32_bf16 v52, v43, s7, v52
    v_dot2_f32_bf16 v53, v43, v43, v53
    s_waitcnt lgkmcnt(0)
    global_store_dwordx4 v2, v[44:47], s[38:39] sc1
    v_dot2_f32_bf16 v50, v44, s7, v50
    v_dot2_f32_bf16 v51, v44, v44, v51
    v_dot2_f32_bf16 v52, v46, s7, v52
    v_dot2_f32_bf16 v53, v46, v46, v53
    v_dot2_f32_bf16 v50, v45, s7, v50
    v_dot2_f32_bf16 v51, v45, v45, v51
    v_dot2_f32_bf16 v52, v47, s7, v52
    v_dot2_f32_bf16 v53, v47, v47, v53
    s_nop 1
    v_permlane32_swap_b32 v50, v52
    v_permlane32_swap_b32 v51, v53
    v_add_f32 v50, v50, v52
    v_add_f32 v51, v51, v53
    s_nop 1
    v_permlane16_swap_b32 v50, v51
    v_add_f32 v50, v50, v51
    v_lshlrev_b32 v3, 4, v48
    v_lshl_add_u32 v3, v49, 2, v3
    s_lshl_b32 s5, s3, 8
    v_add_u32 v3, s5, v3
    ds_write_b32 v3, v50 offset:41472
    s_waitcnt lgkmcnt(0)
    s_barrier
    v_and_b32 v3, 31, v1
    v_lshlrev_b32 v3, 3, v3
    ds_read_b64 v[54:55], v3 offset:41472
    ds_read_b64 v[56:57], v3 offset:41728
    ds_read_b64 v[58:59], v3 offset:41984
    ds_read_b64 v[60:61], v3 offset:42240
    s_waitcnt lgkmcnt(2)
    v_pk_add_f32 v[54:55], v[54:55], v[56:57] op_sel:[0,0] op_sel_hi:[1,1]
    s_waitcnt lgkmcnt(0)
    v_pk_add_f32 v[58:59], v[58:59], v[60:61] op_sel:[0,0] op_sel_hi:[1,1]
    v_pk_add_f32 v[54:55], v[54:55], v[58:59] op_sel:[0,0] op_sel_hi:[1,1]
    v_mul_f32 v54, 0x3acccccd, v54
    v_mul_f32 v55, 0x3acccccd, v55
    v_fma_f32 v55, -v54, v54, v55
    v_max_f32 v55, 0, v55
    v_add_f32 v55, 0x3727c5ac, v55
    v_rsq_f32 v56, v55
    s_nop 0
    v_mul_f32_e64 v55, -v54, v56
    v_mov_b32 v54, v56
    s_lshl_b32 s5, s40, 8
    s_add_u32 s5, s5, 32768
    v_add_u32 v3, s5, v3
    s_cmp_lg_u32 s3, 0
    s_cbranch_scc1 Lx_skip_15568_194
    global_store_dwordx2 v3, v[54:55], s[38:39] sc1
Lx_skip_15568_194:
    s_branch Ldone_side_kernel
Lrole_side_kernel_1:
    s_sub_u32 s40, s40, 64
    s_cmp_ge_u32 s40, 27
    s_cbranch_scc1 Lrole_side_kernel_2
    s_mul_i32 s4, s40, 40960
    s_mul_i32 s5, s3, 10240
    s_add_u32 s4, s4, s5
    v_lshl_add_u32 v2, v1, 4, s4
    s_add_u32 m0, s5, 0
    s_nop 0
    global_load_lds_dwordx4 v2, s[28:29] offset:0 nt
    global_load_lds_dwordx4 v2, s[28:29] offset:1024 nt
    global_load_lds_dwordx4 v2, s[28:29] offset:2048 nt
    global_load_lds_dwordx4 v2, s[28:29] offset:3072 nt
    s_add_u32 m0, s5, 4096
    v_add_u32 v2, 4096, v2
    global_load_lds_dwordx4 v2, s[28:29] offset:0 nt
    global_load_lds_dwordx4 v2, s[28:29] offset:1024 nt
    global_load_lds_dwordx4 v2, s[28:29] offset:2048 nt
    global_load_lds_dwordx4 v2, s[28:29] offset:3072 nt
    s_add_u32 m0, s5, 8192
    v_add_u32 v2, 4096, v2
    global_load_lds_dwordx4 v2, s[28:29] offset:0 nt
    global_load_lds_dwordx4 v2, s[28:29] offset:1024 nt
    v_and_b32 v5, 15, v1
    v_lshrrev_b32 v6, 4, v1
    v_mul_u32_u24 v6, 10240, v6
    s_mul_i32 s5, s3, 320
    v_add_u32 v6, s5, v6
    v_lshl_add_u32 v3, v5, 2, v6
    v_lshl_add_u32 v4, v5, 1, v6
    s_mul_i32 s5, s3, 276480
    s_mul_i32 s6, s40, 5120
    s_add_u32 s5, s5, s6
    s_add_u32 s5, s5, 10487808
    v_lshl_add_u32 v2, v1, 4, s5
    s_mov_b32 s6, 0x5040100
    s_mov_b32 s7, 0x7060302
    s_waitcnt vmcnt(0)
    s_barrier
    ds_read_b32 v8, v3 offset:0
    ds_read_b32 v9, v3 offset:2560
    ds_read_b32 v10, v3 offset:5120
    ds_read_b32 v11, v3 offset:7680
    ds_read_b32 v12, v3 offset:1280
    ds_read_b32 v13, v3 offset:3840
    ds_read_b32 v14, v3 offset:6400
    ds_read_b32 v15, v3 offset:8960
    ds_read_b32 v16, v3 offset:64
    ds_read_b32 v17, v3 offset:2624
    ds_read_b32 v18, v3 offset:5184
    ds_read_b32 v19, v3 offset:7744
    ds_read_b32 v20, v3 offset:1344
    ds_read_b32 v21, v3 offset:3904
    ds_read_b32 v22, v3 offset:6464
    ds_read_b32 v23, v3 offset:9024
    ds_read_u16 v24, v4 offset:128
    ds_read_u16 v25, v4 offset:2688
    ds_read_u16 v26, v4 offset:5248
    ds_read_u16 v27, v4 offset:7808
    ds_read_u16 v28, v4 offset:1408
    ds_read_u16 v29, v4 offset:3968
    ds_read_u16 v30, v4 offset:6528
    ds_read_u16 v31, v4 offset:9088
    s_waitcnt lgkmcnt(15)
    v_perm_b32 v32, v9, v8, s6
    v_perm_b32 v33, v11, v10, s6
    v_perm_b32 v34, v13, v12, s6
    v_perm_b32 v35, v15, v14, s6
    v_perm_b32 v36, v9, v8, s7
    v_perm_b32 v37, v11, v10, s7
    v_perm_b32 v38, v13, v12, s7
    v_perm_b32 v39, v15, v14, s7
    s_waitcnt lgkmcnt(14)
    v_perm_b32 v40, v17, v16, s6
    s_waitcnt lgkmcnt(12)
    v_perm_b32 v41, v19, v18, s6
    s_waitcnt lgkmcnt(10)
    v_perm_b32 v42, v21, v20, s6
    s_waitcnt lgkmcnt(8)
    v_perm_b32 v43, v23, v22, s6
    v_perm_b32 v44, v17, v16, s7
    v_perm_b32 v45, v19, v18, s7
    v_perm_b32 v46, v21, v20, s7
    v_perm_b32 v47, v23, v22, s7
    s_waitcnt lgkmcnt(6)
    v_perm_b32 v48, v25, v24, s6
    s_waitcnt lgkmcnt(4)
    v_perm_b32 v49, v27, v26, s6
    s_waitcnt lgkmcnt(2)
    v_perm_b32 v50, v29, v28, s6
    s_waitcnt lgkmcnt(0)
    v_perm_b32 v51, v31, v30, s6
    global_store_dwordx4 v2, v[32:35], s[38:39] offset:-2048 sc1
    global_store_dwordx4 v2, v[36:39], s[38:39] offset:-1024 sc1
    global_store_dwordx4 v2, v[40:43], s[38:39] offset:0 sc1
    global_store_dwordx4 v2, v[44:47], s[38:39] offset:1024 sc1
    global_store_dwordx4 v2, v[48:51], s[38:39] offset:2048 sc1
    v_add_u32 v2, 138240, v2
    ds_read_b32 v52, v3 offset:160
    ds_read_b32 v53, v3 offset:2720
    ds_read_b32 v54, v3 offset:5280
    ds_read_b32 v55, v3 offset:7840
    ds_read_b32 v56, v3 offset:1440
    ds_read_b32 v57, v3 offset:4000
    ds_read_b32 v58, v3 offset:6560
    ds_read_b32 v59, v3 offset:9120
    ds_read_b32 v60, v3 offset:224
    ds_read_b32 v61, v3 offset:2784
    ds_read_b32 v62, v3 offset:5344
    ds_read_b32 v63, v3 offset:7904
    ds_read_b32 v64, v3 offset:1504
    ds_read_b32 v65, v3 offset:4064
    ds_read_b32 v66, v3 offset:6624
    ds_read_b32 v67, v3 offset:9184
    ds_read_u16 v68, v4 offset:288
    ds_read_u16 v69, v4 offset:2848
    ds_read_u16 v70, v4 offset:5408
    ds_read_u16 v71, v4 offset:7968
    ds_read_u16 v72, v4 offset:1568
    ds_read_u16 v73, v4 offset:4128
    ds_read_u16 v74, v4 offset:6688
    ds_read_u16 v75, v4 offset:9248
    s_waitcnt lgkmcnt(15)
    v_perm_b32 v76, v53, v52, s6
    v_perm_b32 v77, v55, v54, s6
    v_perm_b32 v78, v57, v56, s6
    v_perm_b32 v79, v59, v58, s6
    v_perm_b32 v80, v53, v52, s7
    v_perm_b32 v81, v55, v54, s7
    v_perm_b32 v82, v57, v56, s7
    v_perm_b32 v83, v59, v58, s7
    s_waitcnt lgkmcnt(14)
    v_perm_b32 v84, v61, v60, s6
    s_waitcnt lgkmcnt(12)
    v_perm_b32 v85, v63, v62, s6
    s_waitcnt lgkmcnt(10)
    v_perm_b32 v86, v65, v64, s6
    s_waitcnt lgkmcnt(8)
    v_perm_b32 v87, v67, v66, s6
    v_perm_b32 v88, v61, v60, s7
    v_perm_b32 v89, v63, v62, s7
    v_perm_b32 v90, v65, v64, s7
    v_perm_b32 v91, v67, v66, s7
    s_waitcnt lgkmcnt(6)
    v_perm_b32 v92, v69, v68, s6
    s_waitcnt lgkmcnt(4)
    v_perm_b32 v93, v71, v70, s6
    s_waitcnt lgkmcnt(2)
    v_perm_b32 v94, v73, v72, s6
    s_waitcnt lgkmcnt(0)
    v_perm_b32 v95, v75, v74, s6
    global_store_dwordx4 v2, v[76:79], s[38:39] offset:-2048 sc1
    global_store_dwordx4 v2, v[80:83], s[38:39] offset:-1024 sc1
    global_store_dwordx4 v2, v[84:87], s[38:39] offset:0 sc1
    global_store_dwordx4 v2, v[88:91], s[38:39] offset:1024 sc1
    global_store_dwordx4 v2, v[92:95], s[38:39] offset:2048 sc1
    s_branch Ldone_side_kernel
Lrole_side_kernel_2:
    s_sub_u32 s40, s40, 27
    s_cmp_ge_u32 s40, 2
    s_cbranch_scc1 Lrole_side_kernel_3
    v_mov_b32 v4, 0
    v_mov_b32 v5, 0
    v_mov_b32 v6, 0
    v_mov_b32 v7, 0
    s_mul_i32 s4, s40, 1146880
    s_add_u32 s4, s4, 8445952
    v_lshl_add_u32 v2, v0, 4, s4
    global_store_dwordx4 v2, v[4:7], s[38:39] sc1
    v_add_u32 v2, 4096, v2
    global_store_dwordx4 v2, v[4:7], s[38:39] sc1
    v_add_u32 v2, 4096, v2
    global_store_dwordx4 v2, v[4:7], s[38:39] sc1
    v_add_u32 v2, 4096, v2
    global_store_dwordx4 v2, v[4:7], s[38:39] sc1
    v_add_u32 v2, 4096, v2
    global_store_dwordx4 v2, v[4:7], s[38:39] sc1
    v_add_u32 v2, 4096, v2
    global_store_dwordx4 v2, v[4:7], s[38:39] sc1
    v_add_u32 v2, 4096, v2
    global_store_dwordx4 v2, v[4:7], s[38:39] sc1
    v_add_u32 v2, 4096, v2
    global_store_dwordx4 v2, v[4:7], s[38:39] sc1
    v_add_u32 v2, 4096, v2
    global_store_dwordx4 v2, v[4:7], s[38:39] sc1
    v_add_u32 v2, 4096, v2
    global_store_dwordx4 v2, v[4:7], s[38:39] sc1
    v_add_u32 v2, 4096, v2
    s_mul_i32 s4, s40, 7168
    s_add_u32 s4, s4, 56064
    v_lshl_add_u32 v2, v1, 2, s4
    global_store_dword v2, v4, s[38:39] sc1
    s_branch Ldone_side_kernel
Lrole_side_kernel_3:
    s_sub_u32 s40, s40, 2
    s_cmp_ge_u32 s40, 32
    s_cbranch_scc1 Lrole_side_kernel_4
    v_mov_b32 v4, -1
    v_mov_b32 v5, -1
    v_mov_b32 v6, -1
    v_mov_b32 v7, -1
    s_mul_i32 s4, s40, 4096
    s_add_u32 s4, s4, 65536
    v_lshl_add_u32 v2, v0, 4, s4
    global_store_dwordx4 v2, v[4:7], s[38:39] sc1
    v_add_u32 v2, 4096, v2
    s_branch Ldone_side_kernel
Lrole_side_kernel_4:
    s_sub_u32 s40, s40, 32
Ldone_side_kernel:
Lend_side_kernel:
    s_endpgm
.p2align 8
.globl conv_kernel
.type conv_kernel,@function
conv_kernel:
    s_cmp_ge_u32 s2, 256
    s_cbranch_scc1 Lend_conv_kernel
    s_load_dwordx16 s[8:23], s[0:1], 0
    s_load_dwordx16 s[24:39], s[0:1], 64
    v_lshrrev_b32 v2, 6, v0
    v_and_b32 v1, 63, v0
    v_readfirstlane_b32 s3, v2
    s_waitcnt lgkmcnt(0)
    s_and_b32 s4, s2, 7
    s_lshr_b32 s5, s2, 3
    s_cmp_ge_u32 s5, 20
    s_cbranch_scc1 Lconv_spare
    s_mul_i32 s4, s4, 20
    s_add_u32 s50, s4, s5
    v_and_b32 v2, 15, v1
    v_lshrrev_b32 v3, 4, v1
    s_lshl_b32 s4, s50, 2
    s_add_u32 s4, s4, s3
    s_lshl_b32 s4, s4, 12
    v_lshl_add_u32 v4, v1, 4, s4
    s_mul_i32 s5, s3, 4224
    s_add_u32 m0, s5, 128
    s_nop 0
    global_load_lds_dwordx4 v4, s[16:17] offset:0 nt
    global_load_lds_dwordx4 v4, s[16:17] offset:1024 nt
    global_load_lds_dwordx4 v4, s[16:17] offset:2048 nt
    global_load_lds_dwordx4 v4, s[16:17] offset:3072 nt
    s_mul_i32 s6, s3, 163840
    s_lshl_b32 s7, s50, 3
    s_add_u32 s6, s6, s7
    v_mul_u32_u24 v5, 2560, v1
    v_add_u32 v5, s6, v5
    global_load_dwordx2 v[8:9], v5, s[10:11] offset:0
    global_load_dwordx2 v[24:25], v5, s[12:13] offset:0
    global_load_dwordx2 v[10:11], v5, s[10:11] offset:1280
    global_load_dwordx2 v[26:27], v5, s[12:13] offset:1280
    v_add_u32 v5, 655360, v5
    global_load_dwordx2 v[12:13], v5, s[10:11] offset:0
    global_load_dwordx2 v[28:29], v5, s[12:13] offset:0
    global_load_dwordx2 v[14:15], v5, s[10:11] offset:1280
    global_load_dwordx2 v[30:31], v5, s[12:13] offset:1280
    v_add_u32 v5, 655360, v5
    global_load_dwordx2 v[16:17], v5, s[10:11] offset:0
    global_load_dwordx2 v[32:33], v5, s[12:13] offset:0
    global_load_dwordx2 v[18:19], v5, s[10:11] offset:1280
    global_load_dwordx2 v[34:35], v5, s[12:13] offset:1280
    v_add_u32 v5, 655360, v5
    global_load_dwordx2 v[20:21], v5, s[10:11] offset:0
    global_load_dwordx2 v[36:37], v5, s[12:13] offset:0
    global_load_dwordx2 v[22:23], v5, s[10:11] offset:1280
    global_load_dwordx2 v[38:39], v5, s[12:13] offset:1280
    s_lshl_b32 s4, s50, 5
    s_load_dwordx8 s[40:47], s[14:15], s4
    s_load_dwordx2 s[48:49], s[18:19], s7
    s_add_i32 s4, s6, -3840
    s_max_i32 s4, s4, 0
    s_load_dwordx2 s[52:53], s[10:11], s4
    s_add_i32 s4, s6, -2560
    s_max_i32 s4, s4, 0
    s_load_dwordx2 s[54:55], s[10:11], s4
    s_add_i32 s4, s6, -1280
    s_max_i32 s4, s4, 0
    s_load_dwordx2 s[56:57], s[10:11], s4
    s_add_i32 s4, s6, 651520
    s_load_dwordx2 s[58:59], s[10:11], s4
    s_add_i32 s4, s6, 652800
    s_load_dwordx2 s[60:61], s[10:11], s4
    s_add_i32 s4, s6, 654080
    s_load_dwordx2 s[62:63], s[10:11], s4
    s_add_i32 s4, s6, 1306880
    s_load_dwordx2 s[64:65], s[10:11], s4
    s_add_i32 s4, s6, 1308160
    s_load_dwordx2 s[66:67], s[10:11], s4
    s_add_i32 s4, s6, 1309440
    s_load_dwordx2 s[68:69], s[10:11], s4
    s_add_i32 s4, s6, 1962240
    s_load_dwordx2 s[70:71], s[10:11], s4
    s_add_i32 s4, s6, 1963520
    s_load_dwordx2 s[72:73], s[10:11], s4
    s_add_i32 s4, s6, 1964800
    s_load_dwordx2 s[74:75], s[10:11], s4
    v_mov_b32 v40, 0
    v_mov_b32 v41, 0
    v_mov_b32 v42, 0
    v_mov_b32 v43, 0
    v_and_b32 v4, 7, v1
    v_lshl_add_u32 v4, v4, 4, s5
    ds_write_b128 v4, v[40:43] offset:0
    v_min_u32 v4, 25, v1
    s_mul_i32 s4, s3, 18560
    v_lshl_add_u32 v4, v4, 4, s4
    ds_write_b128 v4, v[40:43] offset:29424
    ds_write_b128 v4, v[40:43] offset:34064
    ds_write_b128 v4, v[40:43] offset:38704
    ds_write_b128 v4, v[40:43] offset:43344
    s_lshl_b32 s4, s50, 4
    v_mov_b32 v44, s4
    v_add_u32 v72, 0, v44
    global_load_dwordx4 v[52:55], v72, s[38:39]
    v_add_u32 v72, 15360, v44
    global_load_dwordx4 v[68:71], v72, s[38:39]
    v_add_u32 v64, 2560, v44
    global_load_dwordx4 v[48:51], v64, s[38:39]
    v_add_u32 v64, 17920, v44
    global_load_dwordx4 v[60:63], v64, s[38:39]
    v_add_u32 v80, 5120, v44
    global_load_dwordx4 v[56:59], v80, s[38:39]
    v_add_u32 v80, 20480, v44
    global_load_dwordx4 v[76:79], v80, s[38:39]
    s_lshl_b32 s4, s50, 14
    v_lshl_add_u32 v81, v0, 4, s4
    v_lshlrev_b32 v82, 4, v0
    v_add_u32 v4, 1048576, v81
    global_load_dwordx4 v[84:87], v4, s[38:39]
    v_add_u32 v4, 32768, v82
    global_load_dwordx4 v[100:103], v4, s[38:39]
    v_add_u32 v4, 1052672, v81
    global_load_dwordx4 v[88:91], v4, s[38:39]
    v_add_u32 v4, 36864, v82
    global_load_dwordx4 v[104:107], v4, s[38:39]
    v_add_u32 v4, 1056768, v81
    global_load_dwordx4 v[92:95], v4, s[38:39]
    v_add_u32 v4, 40960, v82
    global_load_dwordx4 v[108:111], v4, s[38:39]
    v_add_u32 v4, 1060864, v81
    global_load_dwordx4 v[96:99], v4, s[38:39]
    v_add_u32 v4, 45056, v82
    global_load_dwordx4 v[112:115], v4, s[38:39]
    v_add_u32 v81, 4194304, v81
    v_lshlrev_b32 v116, 3, v2
    v_lshl_add_u32 v116, v3, 4, v116
    v_add_u32 v116, s5, v116
    s_waitcnt vmcnt(30)
    ds_read_b64 a[0:1], v116 offset:8
    ds_read_b64 a[2:3], v116 offset:16
    ds_read_b64 a[4:5], v116 offset:72
    ds_read_b64 a[6:7], v116 offset:80
    ds_read_b64 a[8:9], v116 offset:136
    ds_read_b64 a[10:11], v116 offset:144
    ds_read_b64 a[12:13], v116 offset:200
    ds_read_b64 a[14:15], v116 offset:208
    ds_read_b64 a[16:17], v116 offset:264
    ds_read_b64 a[18:19], v116 offset:272
    ds_read_b64 a[20:21], v116 offset:328
    ds_read_b64 a[22:23], v116 offset:336
    ds_read_b64 a[24:25], v116 offset:392
    ds_read_b64 a[26:27], v116 offset:400
    ds_read_b64 a[28:29], v116 offset:456
    ds_read_b64 a[30:31], v116 offset:464
    ds_read_b64 a[32:33], v116 offset:520
    ds_read_b64 a[34:35], v116 offset:528
    ds_read_b64 a[36:37], v116 offset:584
    ds_read_b64 a[38:39], v116 offset:592
    ds_read_b64 a[40:41], v116 offset:648
    ds_read_b64 a[42:43], v116 offset:656
    ds_read_b64 a[44:45], v116 offset:712
    ds_read_b64 a[46:47], v116 offset:720
    ds_read_b64 a[48:49], v116 offset:776
    ds_read_b64 a[50:51], v116 offset:784
    ds_read_b64 a[52:53], v116 offset:840
    ds_read_b64 a[54:55], v116 offset:848
    ds_read_b64 a[56:57], v116 offset:904
    ds_read_b64 a[58:59], v116 offset:912
    ds_read_b64 a[60:61], v116 offset:968
    ds_read_b64 a[62:63], v116 offset:976
    ds_read_b64 a[64:65], v116 offset:1032
    ds_read_b64 a[66:67], v116 offset:1040
    ds_read_b64 a[68:69], v116 offset:1096
    ds_read_b64 a[70:71], v116 offset:1104
    ds_read_b64 a[72:73], v116 offset:1160
    ds_read_b64 a[74:75], v116 offset:1168
    ds_read_b64 a[76:77], v116 offset:1224
    ds_read_b64 a[78:79], v116 offset:1232
    ds_read_b64 a[80:81], v116 offset:1288
    ds_read_b64 a[82:83], v116 offset:1296
    ds_read_b64 a[84:85], v116 offset:1352
    ds_read_b64 a[86:87], v116 offset:1360
    ds_read_b64 a[88:89], v116 offset:1416
    ds_read_b64 a[90:91], v116 offset:1424
    ds_read_b64 a[92:93], v116 offset:1480
    ds_read_b64 a[94:95], v116 offset:1488
    ds_read_b64 a[96:97], v116 offset:1544
    ds_read_b64 a[98:99], v116 offset:1552
    ds_read_b64 a[100:101], v116 offset:1608
    ds_read_b64 a[102:103], v116 offset:1616
    ds_read_b64 a[104:105], v116 offset:1672
    ds_read_b64 a[106:107], v116 offset:1680
    ds_read_b64 a[108:109], v116 offset:1736
    ds_read_b64 a[110:111], v116 offset:1744
    ds_read_b64 a[112:113], v116 offset:1800
    ds_read_b64 a[114:115], v116 offset:1808
    ds_read_b64 a[116:117], v116 offset:1864
    ds_read_b64 a[118:119], v116 offset:1872
    ds_read_b64 a[120:121], v116 offset:1928
    ds_read_b64 a[122:123], v116 offset:1936
    ds_read_b64 a[124:125], v116 offset:1992
    ds_read_b64 a[126:127], v116 offset:2000
    ds_read_b64 a[128:129], v116 offset:2056
    ds_read_b64 a[130:131], v116 offset:2064
    ds_read_b64 a[132:133], v116 offset:2120
    ds_read_b64 a[134:135], v116 offset:2128
    ds_read_b64 a[136:137], v116 offset:2184
    ds_read_b64 a[138:139], v116 offset:2192
    ds_read_b64 a[140:141], v116 offset:2248
    ds_read_b64 a[142:143], v116 offset:2256
    ds_read_b64 a[144:145], v116 offset:2312
    ds_read_b64 a[146:147], v116 offset:2320
    ds_read_b64 a[148:149], v116 offset:2376
    ds_read_b64 a[150:151], v116 offset:2384
    ds_read_b64 a[152:153], v116 offset:2440
    ds_read_b64 a[154:155], v116 offset:2448
    ds_read_b64 a[156:157], v116 offset:2504
    ds_read_b64 a[158:159], v116 offset:2512
    ds_read_b64 a[160:161], v116 offset:2568
    ds_read_b64 a[162:163], v116 offset:2576
    ds_read_b64 a[164:165], v116 offset:2632
    ds_read_b64 a[166:167], v116 offset:2640
    ds_read_b64 a[168:169], v116 offset:2696
    ds_read_b64 a[170:171], v116 offset:2704
    ds_read_b64 a[172:173], v116 offset:2760
    ds_read_b64 a[174:175], v116 offset:2768
    ds_read_b64 a[176:177], v116 offset:2824
    ds_read_b64 a[178:179], v116 offset:2832
    ds_read_b64 a[180:181], v116 offset:2888
    ds_read_b64 a[182:183], v116 offset:2896
    ds_read_b64 a[184:185], v116 offset:2952
    ds_read_b64 a[186:187], v116 offset:2960
    ds_read_b64 a[188:189], v116 offset:3016
    ds_read_b64 a[190:191], v116 offset:3024
    ds_read_b64 a[192:193], v116 offset:3080
    ds_read_b64 a[194:195], v116 offset:3088
    ds_read_b64 a[196:197], v116 offset:3144
    ds_read_b64 a[198:199], v116 offset:3152
    ds_read_b64 a[200:201], v116 offset:3208
    ds_read_b64 a[202:203], v116 offset:3216
    ds_read_b64 a[204:205], v116 offset:3272
    ds_read_b64 a[206:207], v116 offset:3280
    ds_read_b64 a[208:209], v116 offset:3336
    ds_read_b64 a[210:211], v116 offset:3344
    ds_read_b64 a[212:213], v116 offset:3400
    ds_read_b64 a[214:215], v116 offset:3408
    ds_read_b64 a[216:217], v116 offset:3464
    ds_read_b64 a[218:219], v116 offset:3472
    ds_read_b64 a[220:221], v116 offset:3528
    ds_read_b64 a[222:223], v116 offset:3536
    ds_read_b64 a[224:225], v116 offset:3592
    ds_read_b64 a[226:227], v116 offset:3600
    ds_read_b64 a[228:229], v116 offset:3656
    ds_read_b64 a[230:231], v116 offset:3664
    ds_read_b64 a[232:233], v116 offset:3720
    ds_read_b64 a[234:235], v116 offset:3728
    ds_read_b64 a[236:237], v116 offset:3784
    ds_read_b64 a[238:239], v116 offset:3792
    ds_read_b64 a[240:241], v116 offset:3848
    ds_read_b64 a[242:243], v116 offset:3856
    ds_read_b64 a[244:245], v116 offset:3912
    ds_read_b64 a[246:247], v116 offset:3920
    ds_read_b64 a[248:249], v116 offset:3976
    ds_read_b64 a[250:251], v116 offset:3984
    ds_read_b64 a[252:253], v116 offset:4040
    ds_read_b64 a[254:255], v116 offset:4048
    s_waitcnt lgkmcnt(0)
    s_lshl_b32 s76, s40, 16
    s_lshl_b32 s77, s42, 16
    s_lshl_b32 s78, s44, 16
    s_lshl_b32 s79, s46, 16
    s_and_b32 s80, s40, 0xffff0000
    s_and_b32 s81, s42, 0xffff0000
    s_and_b32 s82, s44, 0xffff0000
    s_and_b32 s83, s46, 0xffff0000
    s_lshl_b32 s84, s41, 16
    s_lshl_b32 s85, s43, 16
    s_lshl_b32 s86, s45, 16
    s_lshl_b32 s87, s47, 16
    s_and_b32 s88, s41, 0xffff0000
    s_and_b32 s89, s43, 0xffff0000
    s_and_b32 s90, s45, 0xffff0000
    s_and_b32 s91, s47, 0xffff0000
    s_lshl_b32 s92, s48, 16
    s_and_b32 s93, s48, 0xffff0000
    s_lshl_b32 s94, s49, 16
    s_and_b32 s95, s49, 0xffff0000
    s_cmp_eq_u32 s3, 0
    s_cselect_b32 s52, 0, s52
    s_cselect_b32 s53, 0, s53
    s_cselect_b32 s54, 0, s54
    s_cselect_b32 s55, 0, s55
    s_cselect_b32 s56, 0, s56
    s_cselect_b32 s57, 0, s57
    v_and_b32 v4, 3, v2
    v_mul_u32_u24 v117, 4640, v4
    v_lshrrev_b32 v4, 2, v2
    v_lshlrev_b32 v4, 7, v4
    v_sub_u32 v117, v117, v4
    v_lshl_add_u32 v117, v3, 4, v117
    s_mul_i32 s4, s3, 18560
    s_add_u32 s4, s4, 25744
    v_add_u32 v117, s4, v117
    v_lshlrev_b32 v4, 2, v0
    v_sub_u32 v118, 26374, v4
    v_add_u32 v119, 37120, v118
    s_mul_i32 s4, s3, 1056
    v_lshl_add_u32 v120, v1, 3, s4
    v_mov_b32 v121, v4
    s_waitcnt lgkmcnt(0)
    s_barrier
    v_mov_b32 v228, s52
    v_mov_b32 v230, s54
    v_mov_b32 v232, s56
    v_mov_b32 v229, s53
    v_mov_b32 v231, s55
    v_mov_b32 v233, s57
    s_waitcnt vmcnt(29)
    v_mov_b32_dpp v230, v8 wave_shr:1 row_mask:0xf bank_mask:0xf
    v_mov_b32_dpp v231, v9 wave_shr:1 row_mask:0xf bank_mask:0xf
    s_waitcnt vmcnt(27)
    v_mov_b32_dpp v232, v10 wave_shr:1 row_mask:0xf bank_mask:0xf
    v_mov_b32_dpp v233, v11 wave_shr:1 row_mask:0xf bank_mask:0xf
    s_nop 0
    v_mov_b32_dpp v228, v232 wave_shr:1 row_mask:0xf bank_mask:0xf
    v_mov_b32_dpp v229, v233 wave_shr:1 row_mask:0xf bank_mask:0xf
    v_lshlrev_b32 v234, 16, v228
    v_and_b32 v235, 0xffff0000, v228
    v_lshlrev_b32 v236, 16, v229
    v_and_b32 v237, 0xffff0000, v229
    v_lshlrev_b32 v238, 16, v230
    v_and_b32 v239, 0xffff0000, v230
    v_lshlrev_b32 v240, 16, v231
    v_and_b32 v241, 0xffff0000, v231
    v_lshlrev_b32 v242, 16, v232
    v_and_b32 v243, 0xffff0000, v232
    v_lshlrev_b32 v244, 16, v233
    v_and_b32 v245, 0xffff0000, v233
    v_lshlrev_b32 v246, 16, v8
    v_and_b32 v247, 0xffff0000, v8
    v_lshlrev_b32 v248, 16, v9
    v_and_b32 v249, 0xffff0000, v9
    v_lshlrev_b32 v250, 16, v10
    v_and_b32 v251, 0xffff0000, v10
    v_lshlrev_b32 v252, 16, v11
    v_and_b32 v253, 0xffff0000, v11
    v_pk_mul_f32 v[220:221], v[246:247], s[76:77] op_sel:[0,0] op_sel_hi:[1,1]
    v_pk_mul_f32 v[222:223], v[248:249], s[78:79] op_sel:[0,0] op_sel_hi:[1,1]
    v_pk_mul_f32 v[224:225], v[250:251], s[76:77] op_sel:[0,0] op_sel_hi:[1,1]
    v_pk_mul_f32 v[226:227], v[252:253], s[78:79] op_sel:[0,0] op_sel_hi:[1,1]
    v_pk_fma_f32 v[220:221], v[242:243], s[80:81], v[220:221] op_sel:[0,0,0] op_sel_hi:[1,1,1]
    v_pk_fma_f32 v[222:223], v[244:245], s[82:83], v[222:223] op_sel:[0,0,0] op_sel_hi:[1,1,1]
    v_pk_fma_f32 v[224:225], v[246:247], s[80:81], v[224:225] op_sel:[0,0,0] op_sel_hi:[1,1,1]
    v_pk_fma_f32 v[226:227], v[248:249], s[82:83], v[226:227] op_sel:[0,0,0] op_sel_hi:[1,1,1]
    v_pk_fma_f32 v[220:221], v[238:239], s[84:85], v[220:221] op_sel:[0,0,0] op_sel_hi:[1,1,1]
    v_pk_fma_f32 v[222:223], v[240:241], s[86:87], v[222:223] op_sel:[0,0,0] op_sel_hi:[1,1,1]
    v_pk_fma_f32 v[224:225], v[242:243], s[84:85], v[224:225] op_sel:[0,0,0] op_sel_hi:[1,1,1]
    v_pk_fma_f32 v[226:227], v[244:245], s[86:87], v[226:227] op_sel:[0,0,0] op_sel_hi:[1,1,1]
    v_pk_fma_f32 v[220:221], v[234:235], s[88:89], v[220:221] op_sel:[0,0,0] op_sel_hi:[1,1,1]
    v_pk_fma_f32 v[222:223], v[236:237], s[90:91], v[222:223] op_sel:[0,0,0] op_sel_hi:[1,1,1]
    v_pk_fma_f32 v[224:225], v[238:239], s[88:89], v[224:225] op_sel:[0,0,0] op_sel_hi:[1,1,1]
    v_pk_fma_f32 v[226:227], v[240:241], s[90:91], v[226:227] op_sel:[0,0,0] op_sel_hi:[1,1,1]
    v_lshlrev_b32 v234, 16, v24
    v_and_b32 v235, 0xffff0000, v24
    v_lshlrev_b32 v236, 16, v25
    v_and_b32 v237, 0xffff0000, v25
    s_waitcnt vmcnt(26)
    v_lshlrev_b32 v238, 16, v26
    v_and_b32 v239, 0xffff0000, v26
    v_lshlrev_b32 v240, 16, v27
    v_and_b32 v241, 0xffff0000, v27
    v_pk_mul_f32 v[220:221], v[220:221], v[234:235] op_sel:[0,0] op_sel_hi:[1,1]
    v_pk_mul_f32 v[222:223], v[222:223], v[236:237] op_sel:[0,0] op_sel_hi:[1,1]
    v_pk_mul_f32 v[224:225], v[224:225], v[238:239] op_sel:[0,0] op_sel_hi:[1,1]
    v_pk_mul_f32 v[226:227], v[226:227], v[240:241] op_sel:[0,0] op_sel_hi:[1,1]
    v_cvt_pk_bf16_f32 v40, v224, v220
    v_cvt_pk_bf16_f32 v41, v225, v221
    v_cvt_pk_bf16_f32 v42, v226, v222
    v_cvt_pk_bf16_f32 v43, v227, v223
    ds_write_b16 v118, v40 offset:3072
    ds_write_b16_d16_hi v118, v40 offset:3074
    ds_write_b32 v118, v40 offset:7714
    ds_write_b16 v118, v40 offset:12356
    ds_write_b16_d16_hi v118, v40 offset:12358
    ds_write_b32 v118, v40 offset:16998
    ds_write_b16 v118, v41 offset:21632
    ds_write_b16_d16_hi v118, v41 offset:21634
    ds_write_b32 v118, v41 offset:26274
    ds_write_b16 v118, v41 offset:30916
    ds_write_b16_d16_hi v118, v41 offset:30918
    ds_write_b32 v118, v41 offset:35558
    ds_write_b16 v119, v42 offset:3072
    ds_write_b16_d16_hi v119, v42 offset:3074
    ds_write_b32 v119, v42 offset:7714
    ds_write_b16 v119, v42 offset:12356
    ds_write_b16_d16_hi v119, v42 offset:12358
    ds_write_b32 v119, v42 offset:16998
    ds_write_b16 v119, v43 offset:21632
    ds_write_b16_d16_hi v119, v43 offset:21634
    ds_write_b32 v119, v43 offset:26274
    ds_write_b16 v119, v43 offset:30916
    ds_write_b16_d16_hi v119, v43 offset:30918
    ds_write_b32 v119, v43 offset:35558
    s_waitcnt lgkmcnt(0)
    s_barrier
    ds_read_b128 v[156:159], v117 offset:3584
    ds_read_b128 v[160:163], v117 offset:3648
    ds_read_b128 v[164:167], v117 offset:3712
    ds_read_b128 v[168:171], v117 offset:3776
    ds_read_b128 v[172:175], v117 offset:3840
    ds_read_b128 v[176:179], v117 offset:3904
    ds_read_b128 v[180:183], v117 offset:3968
    ds_read_b128 v[184:187], v117 offset:4032
    ds_read_b128 v[188:191], v117 offset:3072
    ds_read_b128 v[192:195], v117 offset:3136
    ds_read_b128 v[196:199], v117 offset:3200
    ds_read_b128 v[200:203], v117 offset:3264
    ds_read_b128 v[204:207], v117 offset:3328
    ds_read_b128 v[208:211], v117 offset:3392
    ds_read_b128 v[212:215], v117 offset:3456
    ds_read_b128 v[216:219], v117 offset:3520
    s_waitcnt lgkmcnt(15)
    v_mfma_f32_16x16x32_bf16 v[124:127], v[156:159], a[0:3], 0
    v_mfma_f32_16x16x32_bf16 v[128:131], v[156:159], a[32:35], 0
    s_waitcnt lgkmcnt(14)
    v_mfma_f32_16x16x32_bf16 v[124:127], v[160:163], a[4:7], v[124:127]
    v_mfma_f32_16x16x32_bf16 v[128:131], v[160:163], a[36:39], v[128:131]
    s_waitcnt lgkmcnt(13)
    v_mfma_f32_16x16x32_bf16 v[124:127], v[164:167], a[8:11], v[124:127]
    v_mfma_f32_16x16x32_bf16 v[128:131], v[164:167], a[40:43], v[128:131]
    s_waitcnt lgkmcnt(12)
    v_mfma_f32_16x16x32_bf16 v[124:127], v[168:171], a[12:15], v[124:127]
    v_mfma_f32_16x16x32_bf16 v[128:131], v[168:171], a[44:47], v[128:131]
    s_waitcnt lgkmcnt(11)
    v_mfma_f32_16x16x32_bf16 v[124:127], v[172:175], a[16:19], v[124:127]
    v_mfma_f32_16x16x32_bf16 v[128:131], v[172:175], a[48:51], v[128:131]
    s_waitcnt lgkmcnt(10)
    v_mfma_f32_16x16x32_bf16 v[124:127], v[176:179], a[20:23], v[124:127]
    v_mfma_f32_16x16x32_bf16 v[128:131], v[176:179], a[52:55], v[128:131]
    s_waitcnt lgkmcnt(9)
    v_mfma_f32_16x16x32_bf16 v[124:127], v[180:183], a[24:27], v[124:127]
    v_mfma_f32_16x16x32_bf16 v[128:131], v[180:183], a[56:59], v[128:131]
    s_waitcnt lgkmcnt(8)
    v_mfma_f32_16x16x32_bf16 v[124:127], v[184:187], a[28:31], v[124:127]
    v_mfma_f32_16x16x32_bf16 v[128:131], v[184:187], a[60:63], v[128:131]
    s_waitcnt lgkmcnt(7)
    v_mfma_f32_16x16x32_bf16 v[128:131], v[188:191], a[0:3], v[128:131]
    s_waitcnt lgkmcnt(6)
    v_mfma_f32_16x16x32_bf16 v[128:131], v[192:195], a[4:7], v[128:131]
    s_waitcnt lgkmcnt(5)
    v_mfma_f32_16x16x32_bf16 v[128:131], v[196:199], a[8:11], v[128:131]
    s_waitcnt lgkmcnt(4)
    v_mfma_f32_16x16x32_bf16 v[128:131], v[200:203], a[12:15], v[128:131]
    s_waitcnt lgkmcnt(3)
    v_mfma_f32_16x16x32_bf16 v[128:131], v[204:207], a[16:19], v[128:131]
    s_waitcnt lgkmcnt(2)
    v_mfma_f32_16x16x32_bf16 v[128:131], v[208:211], a[20:23], v[128:131]
    s_waitcnt lgkmcnt(1)
    v_mfma_f32_16x16x32_bf16 v[128:131], v[212:215], a[24:27], v[128:131]
    s_waitcnt lgkmcnt(0)
    v_mfma_f32_16x16x32_bf16 v[128:131], v[216:219], a[28:31], v[128:131]
    v_mfma_f32_16x16x32_bf16 v[132:135], v[156:159], a[64:67], 0
    v_mfma_f32_16x16x32_bf16 v[136:139], v[156:159], a[96:99], 0
    v_mfma_f32_16x16x32_bf16 v[140:143], v[156:159], a[128:131], 0
    v_mfma_f32_16x16x32_bf16 v[144:147], v[156:159], a[160:163], 0
    v_mfma_f32_16x16x32_bf16 v[148:151], v[156:159], a[192:195], 0
    v_cvt_pk_bf16_f32 v40, v124, v125
    v_cvt_pk_bf16_f32 v41, v126, v127
    v_mfma_f32_16x16x32_bf16 v[152:155], v[156:159], a[224:227], 0
    ds_write_b64 v120, v[40:41] offset:16896
    v_cvt_pk_bf16_f32 v42, v128, v129
    v_mfma_f32_16x16x32_bf16 v[132:135], v[188:191], a[32:35], v[132:135]
    v_cvt_pk_bf16_f32 v43, v130, v131
    v_mfma_f32_16x16x32_bf16 v[136:139], v[188:191], a[64:67], v[136:139]
    ds_write_b64 v120, v[42:43] offset:17408
    s_waitcnt lgkmcnt(0)
    v_mfma_f32_16x16x32_bf16 v[140:143], v[188:191], a[96:99], v[140:143]
    s_barrier
    v_mfma_f32_16x16x32_bf16 v[144:147], v[188:191], a[128:131], v[144:147]
    ds_read_b32 v40, v121 offset:16896
    ds_read_b32 v41, v121 offset:17952
    v_mfma_f32_16x16x32_bf16 v[148:151], v[188:191], a[160:163], v[148:151]
    ds_read_b32 v42, v121 offset:19008
    ds_read_b32 v43, v121 offset:20064
    v_mfma_f32_16x16x32_bf16 v[152:155], v[188:191], a[192:195], v[152:155]
    s_waitcnt vmcnt(12)
    v_add_f32 v52, v52, v68
    v_mfma_f32_16x16x32_bf16 v[132:135], v[160:163], a[68:71], v[132:135]
    v_add_f32 v53, v53, v69
    v_add_f32 v54, v54, v70
    v_mfma_f32_16x16x32_bf16 v[136:139], v[160:163], a[100:103], v[136:139]
    v_add_f32 v55, v55, v71
    v_mfma_f32_16x16x32_bf16 v[140:143], v[160:163], a[132:135], v[140:143]
    v_cvt_pk_bf16_f32 v52, v52, v52
    v_lshlrev_b32 v52, 16, v52
    v_mfma_f32_16x16x32_bf16 v[144:147], v[160:163], a[164:167], v[144:147]
    v_cvt_pk_bf16_f32 v53, v53, v53
    v_mfma_f32_16x16x32_bf16 v[148:151], v[160:163], a[196:199], v[148:151]
    v_lshlrev_b32 v53, 16, v53
    v_cvt_pk_bf16_f32 v54, v54, v54
    v_mfma_f32_16x16x32_bf16 v[152:155], v[160:163], a[228:231], v[152:155]
    v_lshlrev_b32 v54, 16, v54
    v_cvt_pk_bf16_f32 v55, v55, v55
    v_mfma_f32_16x16x32_bf16 v[132:135], v[192:195], a[36:39], v[132:135]
    v_lshlrev_b32 v55, 16, v55
    v_mfma_f32_16x16x32_bf16 v[136:139], v[192:195], a[68:71], v[136:139]
    s_waitcnt vmcnt(10)
    v_add_f32 v48, v48, v60
    v_add_f32 v49, v49, v61
    v_mfma_f32_16x16x32_bf16 v[140:143], v[192:195], a[100:103], v[140:143]
    v_add_f32 v50, v50, v62
    v_mfma_f32_16x16x32_bf16 v[144:147], v[192:195], a[132:135], v[144:147]
    v_add_f32 v51, v51, v63
    v_cvt_pk_bf16_f32 v48, v48, v48
    v_mfma_f32_16x16x32_bf16 v[148:151], v[192:195], a[164:167], v[148:151]
    v_lshlrev_b32 v48, 16, v48
    v_cvt_pk_bf16_f32 v49, v49, v49
    v_mfma_f32_16x16x32_bf16 v[152:155], v[192:195], a[196:199], v[152:155]
    v_lshlrev_b32 v49, 16, v49
    v_mfma_f32_16x16x32_bf16 v[132:135], v[164:167], a[72:75], v[132:135]
    v_cvt_pk_bf16_f32 v50, v50, v50
    v_lshlrev_b32 v50, 16, v50
    v_mfma_f32_16x16x32_bf16 v[136:139], v[164:167], a[104:107], v[136:139]
    v_cvt_pk_bf16_f32 v51, v51, v51
    v_mfma_f32_16x16x32_bf16 v[140:143], v[164:167], a[136:139], v[140:143]
    v_lshlrev_b32 v51, 16, v51
    v_add_f32 v48, 1.0, v48
    v_mfma_f32_16x16x32_bf16 v[144:147], v[164:167], a[168:171], v[144:147]
    v_add_f32 v49, 1.0, v49
    v_mfma_f32_16x16x32_bf16 v[148:151], v[164:167], a[200:203], v[148:151]
    v_add_f32 v50, 1.0, v50
    v_add_f32 v51, 1.0, v51
    v_mfma_f32_16x16x32_bf16 v[152:155], v[164:167], a[232:235], v[152:155]
    v_cvt_pk_bf16_f32 v48, v48, v48
    v_lshlrev_b32 v48, 16, v48
    v_mfma_f32_16x16x32_bf16 v[132:135], v[196:199], a[40:43], v[132:135]
    v_cvt_pk_bf16_f32 v49, v49, v49
    v_mfma_f32_16x16x32_bf16 v[136:139], v[196:199], a[72:75], v[136:139]
    v_lshlrev_b32 v49, 16, v49
    v_cvt_pk_bf16_f32 v50, v50, v50
    v_mfma_f32_16x16x32_bf16 v[140:143], v[196:199], a[104:107], v[140:143]
    v_lshlrev_b32 v50, 16, v50
    v_mfma_f32_16x16x32_bf16 v[144:147], v[196:199], a[136:139], v[144:147]
    v_cvt_pk_bf16_f32 v51, v51, v51
    v_lshlrev_b32 v51, 16, v51
    v_mfma_f32_16x16x32_bf16 v[148:151], v[196:199], a[168:171], v[148:151]
    s_waitcnt vmcnt(8)
    v_add_f32 v56, v56, v76
    v_add_f32 v57, v57, v77
    v_mfma_f32_16x16x32_bf16 v[152:155], v[196:199], a[200:203], v[152:155]
    v_add_f32 v58, v58, v78
    v_mfma_f32_16x16x32_bf16 v[132:135], v[168:171], a[76:79], v[132:135]
    v_add_f32 v59, v59, v79
    v_cvt_pk_bf16_f32 v56, v56, v56
    v_mfma_f32_16x16x32_bf16 v[136:139], v[168:171], a[108:111], v[136:139]
    v_lshlrev_b32 v56, 16, v56
    v_mfma_f32_16x16x32_bf16 v[140:143], v[168:171], a[140:143], v[140:143]
    v_cvt_pk_bf16_f32 v57, v57, v57
    v_lshlrev_b32 v57, 16, v57
    v_mfma_f32_16x16x32_bf16 v[144:147], v[168:171], a[172:175], v[144:147]
    v_cvt_pk_bf16_f32 v58, v58, v58
    v_mfma_f32_16x16x32_bf16 v[148:151], v[168:171], a[204:207], v[148:151]
    v_lshlrev_b32 v58, 16, v58
    v_cvt_pk_bf16_f32 v59, v59, v59
    v_mfma_f32_16x16x32_bf16 v[152:155], v[168:171], a[236:239], v[152:155]
    v_lshlrev_b32 v59, 16, v59
    v_pk_mul_f32 v[48:49], v[48:49], v[56:57] op_sel:[0,0] op_sel_hi:[1,1]
    v_mfma_f32_16x16x32_bf16 v[132:135], v[200:203], a[44:47], v[132:135]
    v_pk_mul_f32 v[52:53], v[52:53], v[56:57] op_sel:[0,0] op_sel_hi:[1,1]
    v_mfma_f32_16x16x32_bf16 v[136:139], v[200:203], a[76:79], v[136:139]
    v_pk_mul_f32 v[50:51], v[50:51], v[58:59] op_sel:[0,0] op_sel_hi:[1,1]
    v_pk_mul_f32 v[54:55], v[54:55], v[58:59] op_sel:[0,0] op_sel_hi:[1,1]
    v_mfma_f32_16x16x32_bf16 v[140:143], v[200:203], a[108:111], v[140:143]
    s_waitcnt vmcnt(7)
    v_lshlrev_b32 v234, 16, v84
    v_mfma_f32_16x16x32_bf16 v[144:147], v[200:203], a[140:143], v[144:147]
    v_and_b32 v235, 0xffff0000, v84
    v_lshlrev_b32 v236, 16, v85
    v_mfma_f32_16x16x32_bf16 v[148:151], v[200:203], a[172:175], v[148:151]
    v_and_b32 v237, 0xffff0000, v85
    v_lshlrev_b32 v238, 16, v86
    v_mfma_f32_16x16x32_bf16 v[152:155], v[200:203], a[204:207], v[152:155]
    v_and_b32 v239, 0xffff0000, v86
    v_mfma_f32_16x16x32_bf16 v[132:135], v[172:175], a[80:83], v[132:135]
    v_lshlrev_b32 v240, 16, v87
    v_and_b32 v241, 0xffff0000, v87
    v_mfma_f32_16x16x32_bf16 v[136:139], v[172:175], a[112:115], v[136:139]
    s_waitcnt vmcnt(6)
    v_pk_fma_f32 v[242:243], v[100:101], v[234:235], v[100:101] op_sel:[0,0,1] op_sel_hi:[0,1,1]
    v_mfma_f32_16x16x32_bf16 v[140:143], v[172:175], a[144:147], v[140:143]
    v_pk_fma_f32 v[244:245], v[100:101], v[236:237], v[100:101] op_sel:[0,0,1] op_sel_hi:[0,1,1]
    v_pk_fma_f32 v[246:247], v[102:103], v[238:239], v[102:103] op_sel:[0,0,1] op_sel_hi:[0,1,1]
    v_mfma_f32_16x16x32_bf16 v[144:147], v[172:175], a[176:179], v[144:147]
    v_pk_fma_f32 v[248:249], v[102:103], v[240:241], v[102:103] op_sel:[0,0,1] op_sel_hi:[0,1,1]
    v_mfma_f32_16x16x32_bf16 v[148:151], v[172:175], a[208:211], v[148:151]
    v_pk_fma_f32 v[242:243], v[242:243], v[48:49], v[52:53] op_sel:[0,0,0] op_sel_hi:[1,1,1]
    v_pk_fma_f32 v[244:245], v[244:245], v[50:51], v[54:55] op_sel:[0,0,0] op_sel_hi:[1,1,1]
    v_mfma_f32_16x16x32_bf16 v[152:155], v[172:175], a[240:243], v[152:155]
    v_pk_fma_f32 v[246:247], v[246:247], v[48:49], v[52:53] op_sel:[0,0,0] op_sel_hi:[1,1,1]
    v_pk_fma_f32 v[248:249], v[248:249], v[50:51], v[54:55] op_sel:[0,0,0] op_sel_hi:[1,1,1]
    v_mfma_f32_16x16x32_bf16 v[132:135], v[204:207], a[48:51], v[132:135]
    s_waitcnt lgkmcnt(3)
    v_lshlrev_b32 v8, 16, v40
    v_mfma_f32_16x16x32_bf16 v[136:139], v[204:207], a[80:83], v[136:139]
    v_and_b32 v24, 0xffff0000, v40
    s_waitcnt lgkmcnt(2)
    v_lshlrev_b32 v9, 16, v41
    v_mfma_f32_16x16x32_bf16 v[140:143], v[204:207], a[112:115], v[140:143]
    v_and_b32 v25, 0xffff0000, v41
    v_mfma_f32_16x16x32_bf16 v[144:147], v[204:207], a[144:147], v[144:147]
    s_waitcnt lgkmcnt(1)
    v_lshlrev_b32 v10, 16, v42
    v_and_b32 v26, 0xffff0000, v42
    v_mfma_f32_16x16x32_bf16 v[148:151], v[204:207], a[176:179], v[148:151]
    s_waitcnt lgkmcnt(0)
    v_lshlrev_b32 v11, 16, v43
    v_and_b32 v27, 0xffff0000, v43
    v_mfma_f32_16x16x32_bf16 v[152:155], v[204:207], a[208:211], v[152:155]
    v_pk_fma_f32 v[8:9], v[220:221], s[92:93], v[8:9] op_sel:[0,0,0] op_sel_hi:[1,1,1]
    v_mfma_f32_16x16x32_bf16 v[132:135], v[176:179], a[84:87], v[132:135]
    v_pk_fma_f32 v[10:11], v[222:223], s[94:95], v[10:11] op_sel:[0,0,0] op_sel_hi:[1,1,1]
    v_pk_fma_f32 v[24:25], v[224:225], s[92:93], v[24:25] op_sel:[0,0,0] op_sel_hi:[1,1,1]
    v_mfma_f32_16x16x32_bf16 v[136:139], v[176:179], a[116:119], v[136:139]
    v_pk_fma_f32 v[26:27], v[226:227], s[94:95], v[26:27] op_sel:[0,0,0] op_sel_hi:[1,1,1]
    v_mfma_f32_16x16x32_bf16 v[140:143], v[176:179], a[148:151], v[140:143]
    v_pk_fma_f32 v[234:235], v[242:243], v[8:9], v[234:235] op_sel:[0,0,0] op_sel_hi:[1,1,1]
    v_pk_fma_f32 v[236:237], v[244:245], v[10:11], v[236:237] op_sel:[0,0,0] op_sel_hi:[1,1,1]
    v_mfma_f32_16x16x32_bf16 v[144:147], v[176:179], a[180:183], v[144:147]
    v_pk_fma_f32 v[238:239], v[246:247], v[24:25], v[238:239] op_sel:[0,0,0] op_sel_hi:[1,1,1]
    v_mfma_f32_16x16x32_bf16 v[148:151], v[176:179], a[212:215], v[148:151]
    v_pk_fma_f32 v[240:241], v[248:249], v[26:27], v[240:241] op_sel:[0,0,0] op_sel_hi:[1,1,1]
    v_cvt_pk_bf16_f32 v84, v234, v235
    v_mfma_f32_16x16x32_bf16 v[152:155], v[176:179], a[244:247], v[152:155]
    v_cvt_pk_bf16_f32 v85, v236, v237
    v_cvt_pk_bf16_f32 v86, v238, v239
    v_mfma_f32_16x16x32_bf16 v[132:135], v[208:211], a[52:55], v[132:135]
    v_cvt_pk_bf16_f32 v87, v240, v241
    v_mfma_f32_16x16x32_bf16 v[136:139], v[208:211], a[84:87], v[136:139]
    v_min_u32 v84, -2, v84
    v_min_u32 v85, -2, v85
    v_mfma_f32_16x16x32_bf16 v[140:143], v[208:211], a[116:119], v[140:143]
    v_min_u32 v86, -2, v86
    v_mfma_f32_16x16x32_bf16 v[144:147], v[208:211], a[148:151], v[144:147]
    v_min_u32 v87, -2, v87
    global_store_dwordx4 v81, v[84:87], s[38:39] sc1
    v_mfma_f32_16x16x32_bf16 v[148:151], v[208:211], a[180:183], v[148:151]
    v_add_u32 v81, 4096, v81
    v_mfma_f32_16x16x32_bf16 v[152:155], v[208:211], a[212:215], v[152:155]
    v_mfma_f32_16x16x32_bf16 v[132:135], v[180:183], a[88:91], v[132:135]
    v_mfma_f32_16x16x32_bf16 v[136:139], v[180:183], a[120:123], v[136:139]
    v_mfma_f32_16x16x32_bf16 v[140:143], v[180:183], a[152:155], v[140:143]
    v_mfma_f32_16x16x32_bf16 v[144:147], v[180:183], a[184:187], v[144:147]
    v_mfma_f32_16x16x32_bf16 v[148:151], v[180:183], a[216:219], v[148:151]
    v_mfma_f32_16x16x32_bf16 v[152:155], v[180:183], a[248:251], v[152:155]
    v_mfma_f32_16x16x32_bf16 v[132:135], v[212:215], a[56:59], v[132:135]
    v_mfma_f32_16x16x32_bf16 v[136:139], v[212:215], a[88:91], v[136:139]
    v_mfma_f32_16x16x32_bf16 v[140:143], v[212:215], a[120:123], v[140:143]
    v_mfma_f32_16x16x32_bf16 v[144:147], v[212:215], a[152:155], v[144:147]
    v_mfma_f32_16x16x32_bf16 v[148:151], v[212:215], a[184:187], v[148:151]
    v_mfma_f32_16x16x32_bf16 v[152:155], v[212:215], a[216:219], v[152:155]
    v_mfma_f32_16x16x32_bf16 v[132:135], v[184:187], a[92:95], v[132:135]
    v_mfma_f32_16x16x32_bf16 v[136:139], v[184:187], a[124:127], v[136:139]
    v_mfma_f32_16x16x32_bf16 v[140:143], v[184:187], a[156:159], v[140:143]
    v_mfma_f32_16x16x32_bf16 v[144:147], v[184:187], a[188:191], v[144:147]
    v_mfma_f32_16x16x32_bf16 v[148:151], v[184:187], a[220:223], v[148:151]
    v_mfma_f32_16x16x32_bf16 v[152:155], v[184:187], a[252:255], v[152:155]
    v_mfma_f32_16x16x32_bf16 v[132:135], v[216:219], a[60:63], v[132:135]
    v_mfma_f32_16x16x32_bf16 v[136:139], v[216:219], a[92:95], v[136:139]
    v_mfma_f32_16x16x32_bf16 v[140:143], v[216:219], a[124:127], v[140:143]
    v_mfma_f32_16x16x32_bf16 v[144:147], v[216:219], a[156:159], v[144:147]
    v_mfma_f32_16x16x32_bf16 v[148:151], v[216:219], a[188:191], v[148:151]
    v_mfma_f32_16x16x32_bf16 v[152:155], v[216:219], a[220:223], v[152:155]
    v_mov_b32 v228, s58
    v_mov_b32 v230, s60
    v_mov_b32 v232, s62
    v_mov_b32 v229, s59
    v_mov_b32 v231, s61
    v_mov_b32 v233, s63
    v_mov_b32_dpp v230, v12 wave_shr:1 row_mask:0xf bank_mask:0xf
    v_mov_b32_dpp v231, v13 wave_shr:1 row_mask:0xf bank_mask:0xf
    v_mov_b32_dpp v232, v14 wave_shr:1 row_mask:0xf bank_mask:0xf
    v_mov_b32_dpp v233, v15 wave_shr:1 row_mask:0xf bank_mask:0xf
    s_nop 0
    v_mov_b32_dpp v228, v232 wave_shr:1 row_mask:0xf bank_mask:0xf
    v_mov_b32_dpp v229, v233 wave_shr:1 row_mask:0xf bank_mask:0xf
    v_lshlrev_b32 v234, 16, v228
    v_and_b32 v235, 0xffff0000, v228
    v_lshlrev_b32 v236, 16, v229
    v_and_b32 v237, 0xffff0000, v229
    v_lshlrev_b32 v238, 16, v230
    v_and_b32 v239, 0xffff0000, v230
    v_lshlrev_b32 v240, 16, v231
    v_and_b32 v241, 0xffff0000, v231
    v_lshlrev_b32 v242, 16, v232
    v_and_b32 v243, 0xffff0000, v232
    v_lshlrev_b32 v244, 16, v233
    v_and_b32 v245, 0xffff0000, v233
    v_lshlrev_b32 v246, 16, v12
    v_and_b32 v247, 0xffff0000, v12
    v_lshlrev_b32 v248, 16, v13
    v_and_b32 v249, 0xffff0000, v13
    v_lshlrev_b32 v250, 16, v14
    v_and_b32 v251, 0xffff0000, v14
    v_lshlrev_b32 v252, 16, v15
    v_and_b32 v253, 0xffff0000, v15
    v_pk_mul_f32 v[220:221], v[246:247], s[76:77] op_sel:[0,0] op_sel_hi:[1,1]
    v_pk_mul_f32 v[222:223], v[248:249], s[78:79] op_sel:[0,0] op_sel_hi:[1,1]
    v_pk_mul_f32 v[224:225], v[250:251], s[76:77] op_sel:[0,0] op_sel_hi:[1,1]
    v_pk_mul_f32 v[226:227], v[252:253], s[78:79] op_sel:[0,0] op_sel_hi:[1,1]
    v_pk_fma_f32 v[220:221], v[242:243], s[80:81], v[220:221] op_sel:[0,0,0] op_sel_hi:[1,1,1]
    v_pk_fma_f32 v[222:223], v[244:245], s[82:83], v[222:223] op_sel:[0,0,0] op_sel_hi:[1,1,1]
    v_pk_fma_f32 v[224:225], v[246:247], s[80:81], v[224:225] op_sel:[0,0,0] op_sel_hi:[1,1,1]
    v_pk_fma_f32 v[226:227], v[248:249], s[82:83], v[226:227] op_sel:[0,0,0] op_sel_hi:[1,1,1]
    v_pk_fma_f32 v[220:221], v[238:239], s[84:85], v[220:221] op_sel:[0,0,0] op_sel_hi:[1,1,1]
    v_pk_fma_f32 v[222:223], v[240:241], s[86:87], v[222:223] op_sel:[0,0,0] op_sel_hi:[1,1,1]
    v_pk_fma_f32 v[224:225], v[242:243], s[84:85], v[224:225] op_sel:[0,0,0] op_sel_hi:[1,1,1]
    v_pk_fma_f32 v[226:227], v[244:245], s[86:87], v[226:227] op_sel:[0,0,0] op_sel_hi:[1,1,1]
    v_pk_fma_f32 v[220:221], v[234:235], s[88:89], v[220:221] op_sel:[0,0,0] op_sel_hi:[1,1,1]
    v_pk_fma_f32 v[222:223], v[236:237], s[90:91], v[222:223] op_sel:[0,0,0] op_sel_hi:[1,1,1]
    v_pk_fma_f32 v[224:225], v[238:239], s[88:89], v[224:225] op_sel:[0,0,0] op_sel_hi:[1,1,1]
    v_pk_fma_f32 v[226:227], v[240:241], s[90:91], v[226:227] op_sel:[0,0,0] op_sel_hi:[1,1,1]
    v_lshlrev_b32 v234, 16, v28
    v_and_b32 v235, 0xffff0000, v28
    v_lshlrev_b32 v236, 16, v29
    v_and_b32 v237, 0xffff0000, v29
    v_lshlrev_b32 v238, 16, v30
    v_and_b32 v239, 0xffff0000, v30
    v_lshlrev_b32 v240, 16, v31
    v_and_b32 v241, 0xffff0000, v31
    v_pk_mul_f32 v[220:221], v[220:221], v[234:235] op_sel:[0,0] op_sel_hi:[1,1]
    v_pk_mul_f32 v[222:223], v[222:223], v[236:237] op_sel:[0,0] op_sel_hi:[1,1]
    v_pk_mul_f32 v[224:225], v[224:225], v[238:239] op_sel:[0,0] op_sel_hi:[1,1]
    v_pk_mul_f32 v[226:227], v[226:227], v[240:241] op_sel:[0,0] op_sel_hi:[1,1]
    v_cvt_pk_bf16_f32 v40, v224, v220
    v_cvt_pk_bf16_f32 v41, v225, v221
    v_cvt_pk_bf16_f32 v42, v226, v222
    v_cvt_pk_bf16_f32 v43, v227, v223
    ds_write_b16 v118, v40 offset:2048
    ds_write_b16_d16_hi v118, v40 offset:2050
    ds_write_b32 v118, v40 offset:6690
    ds_write_b16 v118, v40 offset:11332
    ds_write_b16_d16_hi v118, v40 offset:11334
    ds_write_b32 v118, v40 offset:15974
    ds_write_b16 v118, v41 offset:20608
    ds_write_b16_d16_hi v118, v41 offset:20610
    ds_write_b32 v118, v41 offset:25250
    ds_write_b16 v118, v41 offset:29892
    ds_write_b16_d16_hi v118, v41 offset:29894
    ds_write_b32 v118, v41 offset:34534
    ds_write_b16 v119, v42 offset:2048
    ds_write_b16_d16_hi v119, v42 offset:2050
    ds_write_b32 v119, v42 offset:6690
    ds_write_b16 v119, v42 offset:11332
    ds_write_b16_d16_hi v119, v42 offset:11334
    ds_write_b32 v119, v42 offset:15974
    ds_write_b16 v119, v43 offset:20608
    ds_write_b16_d16_hi v119, v43 offset:20610
    ds_write_b32 v119, v43 offset:25250
    ds_write_b16 v119, v43 offset:29892
    ds_write_b16_d16_hi v119, v43 offset:29894
    ds_write_b32 v119, v43 offset:34534
    s_waitcnt lgkmcnt(0)
    s_barrier
    ds_read_b128 v[156:159], v117 offset:2560
    ds_read_b128 v[160:163], v117 offset:2624
    ds_read_b128 v[164:167], v117 offset:2688
    ds_read_b128 v[168:171], v117 offset:2752
    ds_read_b128 v[172:175], v117 offset:2816
    ds_read_b128 v[176:179], v117 offset:2880
    ds_read_b128 v[180:183], v117 offset:2944
    ds_read_b128 v[184:187], v117 offset:3008
    ds_read_b128 v[188:191], v117 offset:2048
    ds_read_b128 v[192:195], v117 offset:2112
    ds_read_b128 v[196:199], v117 offset:2176
    ds_read_b128 v[200:203], v117 offset:2240
    ds_read_b128 v[204:207], v117 offset:2304
    ds_read_b128 v[208:211], v117 offset:2368
    ds_read_b128 v[212:215], v117 offset:2432
    ds_read_b128 v[216:219], v117 offset:2496
    s_waitcnt lgkmcnt(15)
    v_mfma_f32_16x16x32_bf16 v[132:135], v[156:159], a[0:3], v[132:135]
    v_mfma_f32_16x16x32_bf16 v[136:139], v[156:159], a[32:35], v[136:139]
    s_waitcnt lgkmcnt(14)
    v_mfma_f32_16x16x32_bf16 v[132:135], v[160:163], a[4:7], v[132:135]
    v_mfma_f32_16x16x32_bf16 v[136:139], v[160:163], a[36:39], v[136:139]
    s_waitcnt lgkmcnt(13)
    v_mfma_f32_16x16x32_bf16 v[132:135], v[164:167], a[8:11], v[132:135]
    v_mfma_f32_16x16x32_bf16 v[136:139], v[164:167], a[40:43], v[136:139]
    s_waitcnt lgkmcnt(12)
    v_mfma_f32_16x16x32_bf16 v[132:135], v[168:171], a[12:15], v[132:135]
    v_mfma_f32_16x16x32_bf16 v[136:139], v[168:171], a[44:47], v[136:139]
    s_waitcnt lgkmcnt(11)
    v_mfma_f32_16x16x32_bf16 v[132:135], v[172:175], a[16:19], v[132:135]
    v_mfma_f32_16x16x32_bf16 v[136:139], v[172:175], a[48:51], v[136:139]
    s_waitcnt lgkmcnt(10)
    v_mfma_f32_16x16x32_bf16 v[132:135], v[176:179], a[20:23], v[132:135]
    v_mfma_f32_16x16x32_bf16 v[136:139], v[176:179], a[52:55], v[136:139]
    s_waitcnt lgkmcnt(9)
    v_mfma_f32_16x16x32_bf16 v[132:135], v[180:183], a[24:27], v[132:135]
    v_mfma_f32_16x16x32_bf16 v[136:139], v[180:183], a[56:59], v[136:139]
    s_waitcnt lgkmcnt(8)
    v_mfma_f32_16x16x32_bf16 v[132:135], v[184:187], a[28:31], v[132:135]
    v_mfma_f32_16x16x32_bf16 v[136:139], v[184:187], a[60:63], v[136:139]
    s_waitcnt lgkmcnt(7)
    v_mfma_f32_16x16x32_bf16 v[136:139], v[188:191], a[0:3], v[136:139]
    s_waitcnt lgkmcnt(6)
    v_mfma_f32_16x16x32_bf16 v[136:139], v[192:195], a[4:7], v[136:139]
    s_waitcnt lgkmcnt(5)
    v_mfma_f32_16x16x32_bf16 v[136:139], v[196:199], a[8:11], v[136:139]
    s_waitcnt lgkmcnt(4)
    v_mfma_f32_16x16x32_bf16 v[136:139], v[200:203], a[12:15], v[136:139]
    s_waitcnt lgkmcnt(3)
    v_mfma_f32_16x16x32_bf16 v[136:139], v[204:207], a[16:19], v[136:139]
    s_waitcnt lgkmcnt(2)
    v_mfma_f32_16x16x32_bf16 v[136:139], v[208:211], a[20:23], v[136:139]
    s_waitcnt lgkmcnt(1)
    v_mfma_f32_16x16x32_bf16 v[136:139], v[212:215], a[24:27], v[136:139]
    s_waitcnt lgkmcnt(0)
    v_mfma_f32_16x16x32_bf16 v[136:139], v[216:219], a[28:31], v[136:139]
    v_mfma_f32_16x16x32_bf16 v[140:143], v[156:159], a[64:67], v[140:143]
    v_mfma_f32_16x16x32_bf16 v[144:147], v[156:159], a[96:99], v[144:147]
    v_mfma_f32_16x16x32_bf16 v[148:151], v[156:159], a[128:131], v[148:151]
    v_mfma_f32_16x16x32_bf16 v[152:155], v[156:159], a[160:163], v[152:155]
    v_cvt_pk_bf16_f32 v40, v132, v133
    v_cvt_pk_bf16_f32 v41, v134, v135
    v_mfma_f32_16x16x32_bf16 v[140:143], v[188:191], a[32:35], v[140:143]
    ds_write_b64 v120, v[40:41] offset:21120
    v_cvt_pk_bf16_f32 v42, v136, v137
    v_mfma_f32_16x16x32_bf16 v[144:147], v[188:191], a[64:67], v[144:147]
    v_cvt_pk_bf16_f32 v43, v138, v139
    v_mfma_f32_16x16x32_bf16 v[148:151], v[188:191], a[96:99], v[148:151]
    ds_write_b64 v120, v[42:43] offset:21632
    s_waitcnt lgkmcnt(0)
    v_mfma_f32_16x16x32_bf16 v[152:155], v[188:191], a[128:131], v[152:155]
    s_barrier
    ds_read_b32 v40, v121 offset:21120
    v_mfma_f32_16x16x32_bf16 v[140:143], v[160:163], a[68:71], v[140:143]
    ds_read_b32 v41, v121 offset:22176
    v_mfma_f32_16x16x32_bf16 v[144:147], v[160:163], a[100:103], v[144:147]
    ds_read_b32 v42, v121 offset:23232
    ds_read_b32 v43, v121 offset:24288
    v_mfma_f32_16x16x32_bf16 v[148:151], v[160:163], a[132:135], v[148:151]
    s_waitcnt vmcnt(6)
    v_lshlrev_b32 v234, 16, v88
    v_and_b32 v235, 0xffff0000, v88
    v_mfma_f32_16x16x32_bf16 v[152:155], v[160:163], a[164:167], v[152:155]
    v_lshlrev_b32 v236, 16, v89
    v_mfma_f32_16x16x32_bf16 v[140:143], v[192:195], a[36:39], v[140:143]
    v_and_b32 v237, 0xffff0000, v89
    v_lshlrev_b32 v238, 16, v90
    v_mfma_f32_16x16x32_bf16 v[144:147], v[192:195], a[68:71], v[144:147]
    v_and_b32 v239, 0xffff0000, v90
    v_mfma_f32_16x16x32_bf16 v[148:151], v[192:195], a[100:103], v[148:151]
    v_lshlrev_b32 v240, 16, v91
    v_and_b32 v241, 0xffff0000, v91
    v_mfma_f32_16x16x32_bf16 v[152:155], v[192:195], a[132:135], v[152:155]
    s_waitcnt vmcnt(5)
    v_pk_fma_f32 v[242:243], v[104:105], v[234:235], v[104:105] op_sel:[0,0,1] op_sel_hi:[0,1,1]
    v_pk_fma_f32 v[244:245], v[104:105], v[236:237], v[104:105] op_sel:[0,0,1] op_sel_hi:[0,1,1]
    v_mfma_f32_16x16x32_bf16 v[140:143], v[164:167], a[72:75], v[140:143]
    v_pk_fma_f32 v[246:247], v[106:107], v[238:239], v[106:107] op_sel:[0,0,1] op_sel_hi:[0,1,1]
    v_mfma_f32_16x16x32_bf16 v[144:147], v[164:167], a[104:107], v[144:147]
    v_pk_fma_f32 v[248:249], v[106:107], v[240:241], v[106:107] op_sel:[0,0,1] op_sel_hi:[0,1,1]
    v_pk_fma_f32 v[242:243], v[242:243], v[48:49], v[52:53] op_sel:[0,0,0] op_sel_hi:[1,1,1]
    v_mfma_f32_16x16x32_bf16 v[148:151], v[164:167], a[136:139], v[148:151]
    v_pk_fma_f32 v[244:245], v[244:245], v[50:51], v[54:55] op_sel:[0,0,0] op_sel_hi:[1,1,1]
    v_pk_fma_f32 v[246:247], v[246:247], v[48:49], v[52:53] op_sel:[0,0,0] op_sel_hi:[1,1,1]
    v_mfma_f32_16x16x32_bf16 v[152:155], v[164:167], a[168:171], v[152:155]
    v_pk_fma_f32 v[248:249], v[248:249], v[50:51], v[54:55] op_sel:[0,0,0] op_sel_hi:[1,1,1]
    v_mfma_f32_16x16x32_bf16 v[140:143], v[196:199], a[40:43], v[140:143]
    s_waitcnt lgkmcnt(3)
    v_lshlrev_b32 v12, 16, v40
    v_and_b32 v28, 0xffff0000, v40
    v_mfma_f32_16x16x32_bf16 v[144:147], v[196:199], a[72:75], v[144:147]
    s_waitcnt lgkmcnt(2)
    v_lshlrev_b32 v13, 16, v41
    v_and_b32 v29, 0xffff0000, v41
    v_mfma_f32_16x16x32_bf16 v[148:151], v[196:199], a[104:107], v[148:151]
    s_waitcnt lgkmcnt(1)
    v_lshlrev_b32 v14, 16, v42
    v_mfma_f32_16x16x32_bf16 v[152:155], v[196:199], a[136:139], v[152:155]
    v_and_b32 v30, 0xffff0000, v42
    s_waitcnt lgkmcnt(0)
    v_lshlrev_b32 v15, 16, v43
    v_mfma_f32_16x16x32_bf16 v[140:143], v[168:171], a[76:79], v[140:143]
    v_and_b32 v31, 0xffff0000, v43
    v_mfma_f32_16x16x32_bf16 v[144:147], v[168:171], a[108:111], v[144:147]
    v_pk_fma_f32 v[12:13], v[220:221], s[92:93], v[12:13] op_sel:[0,0,0] op_sel_hi:[1,1,1]
    v_pk_fma_f32 v[14:15], v[222:223], s[94:95], v[14:15] op_sel:[0,0,0] op_sel_hi:[1,1,1]
    v_mfma_f32_16x16x32_bf16 v[148:151], v[168:171], a[140:143], v[148:151]
    v_pk_fma_f32 v[28:29], v[224:225], s[92:93], v[28:29] op_sel:[0,0,0] op_sel_hi:[1,1,1]
    v_pk_fma_f32 v[30:31], v[226:227], s[94:95], v[30:31] op_sel:[0,0,0] op_sel_hi:[1,1,1]
    v_mfma_f32_16x16x32_bf16 v[152:155], v[168:171], a[172:175], v[152:155]
    v_pk_fma_f32 v[234:235], v[242:243], v[12:13], v[234:235] op_sel:[0,0,0] op_sel_hi:[1,1,1]
    v_mfma_f32_16x16x32_bf16 v[140:143], v[200:203], a[44:47], v[140:143]
    v_pk_fma_f32 v[236:237], v[244:245], v[14:15], v[236:237] op_sel:[0,0,0] op_sel_hi:[1,1,1]
    v_pk_fma_f32 v[238:239], v[246:247], v[28:29], v[238:239] op_sel:[0,0,0] op_sel_hi:[1,1,1]
    v_mfma_f32_16x16x32_bf16 v[144:147], v[200:203], a[76:79], v[144:147]
    v_pk_fma_f32 v[240:241], v[248:249], v[30:31], v[240:241] op_sel:[0,0,0] op_sel_hi:[1,1,1]
    v_cvt_pk_bf16_f32 v88, v234, v235
    v_mfma_f32_16x16x32_bf16 v[148:151], v[200:203], a[108:111], v[148:151]
    v_cvt_pk_bf16_f32 v89, v236, v237
    v_mfma_f32_16x16x32_bf16 v[152:155], v[200:203], a[140:143], v[152:155]
    v_cvt_pk_bf16_f32 v90, v238, v239
    v_cvt_pk_bf16_f32 v91, v240, v241
    v_mfma_f32_16x16x32_bf16 v[140:143], v[172:175], a[80:83], v[140:143]
    v_min_u32 v88, -2, v88
    v_min_u32 v89, -2, v89
    v_mfma_f32_16x16x32_bf16 v[144:147], v[172:175], a[112:115], v[144:147]
    v_min_u32 v90, -2, v90
    v_mfma_f32_16x16x32_bf16 v[148:151], v[172:175], a[144:147], v[148:151]
    v_min_u32 v91, -2, v91
    global_store_dwordx4 v81, v[88:91], s[38:39] sc1
    v_mfma_f32_16x16x32_bf16 v[152:155], v[172:175], a[176:179], v[152:155]
    v_add_u32 v81, 4096, v81
    v_mfma_f32_16x16x32_bf16 v[140:143], v[204:207], a[48:51], v[140:143]
    v_mfma_f32_16x16x32_bf16 v[144:147], v[204:207], a[80:83], v[144:147]
    v_mfma_f32_16x16x32_bf16 v[148:151], v[204:207], a[112:115], v[148:151]
    v_mfma_f32_16x16x32_bf16 v[152:155], v[204:207], a[144:147], v[152:155]
    v_mfma_f32_16x16x32_bf16 v[140:143], v[176:179], a[84:87], v[140:143]
    v_mfma_f32_16x16x32_bf16 v[144:147], v[176:179], a[116:119], v[144:147]
    v_mfma_f32_16x16x32_bf16 v[148:151], v[176:179], a[148:151], v[148:151]
    v_mfma_f32_16x16x32_bf16 v[152:155], v[176:179], a[180:183], v[152:155]
    v_mfma_f32_16x16x32_bf16 v[140:143], v[208:211], a[52:55], v[140:143]
    v_mfma_f32_16x16x32_bf16 v[144:147], v[208:211], a[84:87], v[144:147]
    v_mfma_f32_16x16x32_bf16 v[148:151], v[208:211], a[116:119], v[148:151]
    v_mfma_f32_16x16x32_bf16 v[152:155], v[208:211], a[148:151], v[152:155]
    v_mfma_f32_16x16x32_bf16 v[140:143], v[180:183], a[88:91], v[140:143]
    v_mfma_f32_16x16x32_bf16 v[144:147], v[180:183], a[120:123], v[144:147]
    v_mfma_f32_16x16x32_bf16 v[148:151], v[180:183], a[152:155], v[148:151]
    v_mfma_f32_16x16x32_bf16 v[152:155], v[180:183], a[184:187], v[152:155]
    v_mfma_f32_16x16x32_bf16 v[140:143], v[212:215], a[56:59], v[140:143]
    v_mfma_f32_16x16x32_bf16 v[144:147], v[212:215], a[88:91], v[144:147]
    v_mfma_f32_16x16x32_bf16 v[148:151], v[212:215], a[120:123], v[148:151]
    v_mfma_f32_16x16x32_bf16 v[152:155], v[212:215], a[152:155], v[152:155]
    v_mfma_f32_16x16x32_bf16 v[140:143], v[184:187], a[92:95], v[140:143]
    v_mfma_f32_16x16x32_bf16 v[144:147], v[184:187], a[124:127], v[144:147]
    v_mfma_f32_16x16x32_bf16 v[148:151], v[184:187], a[156:159], v[148:151]
    v_mfma_f32_16x16x32_bf16 v[152:155], v[184:187], a[188:191], v[152:155]
    v_mfma_f32_16x16x32_bf16 v[140:143], v[216:219], a[60:63], v[140:143]
    v_mfma_f32_16x16x32_bf16 v[144:147], v[216:219], a[92:95], v[144:147]
    v_mfma_f32_16x16x32_bf16 v[148:151], v[216:219], a[124:127], v[148:151]
    v_mfma_f32_16x16x32_bf16 v[152:155], v[216:219], a[156:159], v[152:155]
    v_mov_b32 v228, s64
    v_mov_b32 v230, s66
    v_mov_b32 v232, s68
    v_mov_b32 v229, s65
    v_mov_b32 v231, s67
    v_mov_b32 v233, s69
    v_mov_b32_dpp v230, v16 wave_shr:1 row_mask:0xf bank_mask:0xf
    v_mov_b32_dpp v231, v17 wave_shr:1 row_mask:0xf bank_mask:0xf
    v_mov_b32_dpp v232, v18 wave_shr:1 row_mask:0xf bank_mask:0xf
    v_mov_b32_dpp v233, v19 wave_shr:1 row_mask:0xf bank_mask:0xf
    s_nop 0
    v_mov_b32_dpp v228, v232 wave_shr:1 row_mask:0xf bank_mask:0xf
    v_mov_b32_dpp v229, v233 wave_shr:1 row_mask:0xf bank_mask:0xf
    v_lshlrev_b32 v234, 16, v228
    v_and_b32 v235, 0xffff0000, v228
    v_lshlrev_b32 v236, 16, v229
    v_and_b32 v237, 0xffff0000, v229
    v_lshlrev_b32 v238, 16, v230
    v_and_b32 v239, 0xffff0000, v230
    v_lshlrev_b32 v240, 16, v231
    v_and_b32 v241, 0xffff0000, v231
    v_lshlrev_b32 v242, 16, v232
    v_and_b32 v243, 0xffff0000, v232
    v_lshlrev_b32 v244, 16, v233
    v_and_b32 v245, 0xffff0000, v233
    v_lshlrev_b32 v246, 16, v16
    v_and_b32 v247, 0xffff0000, v16
    v_lshlrev_b32 v248, 16, v17
    v_and_b32 v249, 0xffff0000, v17
    v_lshlrev_b32 v250, 16, v18
    v_and_b32 v251, 0xffff0000, v18
    v_lshlrev_b32 v252, 16, v19
    v_and_b32 v253, 0xffff0000, v19
    v_pk_mul_f32 v[220:221], v[246:247], s[76:77] op_sel:[0,0] op_sel_hi:[1,1]
    v_pk_mul_f32 v[222:223], v[248:249], s[78:79] op_sel:[0,0] op_sel_hi:[1,1]
    v_pk_mul_f32 v[224:225], v[250:251], s[76:77] op_sel:[0,0] op_sel_hi:[1,1]
    v_pk_mul_f32 v[226:227], v[252:253], s[78:79] op_sel:[0,0] op_sel_hi:[1,1]
    v_pk_fma_f32 v[220:221], v[242:243], s[80:81], v[220:221] op_sel:[0,0,0] op_sel_hi:[1,1,1]
    v_pk_fma_f32 v[222:223], v[244:245], s[82:83], v[222:223] op_sel:[0,0,0] op_sel_hi:[1,1,1]
    v_pk_fma_f32 v[224:225], v[246:247], s[80:81], v[224:225] op_sel:[0,0,0] op_sel_hi:[1,1,1]
    v_pk_fma_f32 v[226:227], v[248:249], s[82:83], v[226:227] op_sel:[0,0,0] op_sel_hi:[1,1,1]
    v_pk_fma_f32 v[220:221], v[238:239], s[84:85], v[220:221] op_sel:[0,0,0] op_sel_hi:[1,1,1]
    v_pk_fma_f32 v[222:223], v[240:241], s[86:87], v[222:223] op_sel:[0,0,0] op_sel_hi:[1,1,1]
    v_pk_fma_f32 v[224:225], v[242:243], s[84:85], v[224:225] op_sel:[0,0,0] op_sel_hi:[1,1,1]
    v_pk_fma_f32 v[226:227], v[244:245], s[86:87], v[226:227] op_sel:[0,0,0] op_sel_hi:[1,1,1]
    v_pk_fma_f32 v[220:221], v[234:235], s[88:89], v[220:221] op_sel:[0,0,0] op_sel_hi:[1,1,1]
    v_pk_fma_f32 v[222:223], v[236:237], s[90:91], v[222:223] op_sel:[0,0,0] op_sel_hi:[1,1,1]
    v_pk_fma_f32 v[224:225], v[238:239], s[88:89], v[224:225] op_sel:[0,0,0] op_sel_hi:[1,1,1]
    v_pk_fma_f32 v[226:227], v[240:241], s[90:91], v[226:227] op_sel:[0,0,0] op_sel_hi:[1,1,1]
    v_lshlrev_b32 v234, 16, v32
    v_and_b32 v235, 0xffff0000, v32
    v_lshlrev_b32 v236, 16, v33
    v_and_b32 v237, 0xffff0000, v33
    v_lshlrev_b32 v238, 16, v34
    v_and_b32 v239, 0xffff0000, v34
    v_lshlrev_b32 v240, 16, v35
    v_and_b32 v241, 0xffff0000, v35
    v_pk_mul_f32 v[220:221], v[220:221], v[234:235] op_sel:[0,0] op_sel_hi:[1,1]
    v_pk_mul_f32 v[222:223], v[222:223], v[236:237] op_sel:[0,0] op_sel_hi:[1,1]
    v_pk_mul_f32 v[224:225], v[224:225], v[238:239] op_sel:[0,0] op_sel_hi:[1,1]
    v_pk_mul_f32 v[226:227], v[226:227], v[240:241] op_sel:[0,0] op_sel_hi:[1,1]
    v_cvt_pk_bf16_f32 v40, v224, v220
    v_cvt_pk_bf16_f32 v41, v225, v221
    v_cvt_pk_bf16_f32 v42, v226, v222
    v_cvt_pk_bf16_f32 v43, v227, v223
    ds_write_b16 v118, v40 offset:1024
    ds_write_b16_d16_hi v118, v40 offset:1026
    ds_write_b32 v118, v40 offset:5666
    ds_write_b16 v118, v40 offset:10308
    ds_write_b16_d16_hi v118, v40 offset:10310
    ds_write_b32 v118, v40 offset:14950
    ds_write_b16 v118, v41 offset:19584
    ds_write_b16_d16_hi v118, v41 offset:19586
    ds_write_b32 v118, v41 offset:24226
    ds_write_b16 v118, v41 offset:28868
    ds_write_b16_d16_hi v118, v41 offset:28870
    ds_write_b32 v118, v41 offset:33510
    ds_write_b16 v119, v42 offset:1024
    ds_write_b16_d16_hi v119, v42 offset:1026
    ds_write_b32 v119, v42 offset:5666
    ds_write_b16 v119, v42 offset:10308
    ds_write_b16_d16_hi v119, v42 offset:10310
    ds_write_b32 v119, v42 offset:14950
    ds_write_b16 v119, v43 offset:19584
    ds_write_b16_d16_hi v119, v43 offset:19586
    ds_write_b32 v119, v43 offset:24226
    ds_write_b16 v119, v43 offset:28868
    ds_write_b16_d16_hi v119, v43 offset:28870
    ds_write_b32 v119, v43 offset:33510
    s_waitcnt lgkmcnt(0)
    s_barrier
    ds_read_b128 v[156:159], v117 offset:1536
    ds_read_b128 v[160:163], v117 offset:1600
    ds_read_b128 v[164:167], v117 offset:1664
    ds_read_b128 v[168:171], v117 offset:1728
    ds_read_b128 v[172:175], v117 offset:1792
    ds_read_b128 v[176:179], v117 offset:1856
    ds_read_b128 v[180:183], v117 offset:1920
    ds_read_b128 v[184:187], v117 offset:1984
    ds_read_b128 v[188:191], v117 offset:1024
    ds_read_b128 v[192:195], v117 offset:1088
    ds_read_b128 v[196:199], v117 offset:1152
    ds_read_b128 v[200:203], v117 offset:1216
    ds_read_b128 v[204:207], v117 offset:1280
    ds_read_b128 v[208:211], v117 offset:1344
    ds_read_b128 v[212:215], v117 offset:1408
    ds_read_b128 v[216:219], v117 offset:1472
    s_waitcnt lgkmcnt(15)
    v_mfma_f32_16x16x32_bf16 v[140:143], v[156:159], a[0:3], v[140:143]
    v_mfma_f32_16x16x32_bf16 v[144:147], v[156:159], a[32:35], v[144:147]
    s_waitcnt lgkmcnt(14)
    v_mfma_f32_16x16x32_bf16 v[140:143], v[160:163], a[4:7], v[140:143]
    v_mfma_f32_16x16x32_bf16 v[144:147], v[160:163], a[36:39], v[144:147]
    s_waitcnt lgkmcnt(13)
    v_mfma_f32_16x16x32_bf16 v[140:143], v[164:167], a[8:11], v[140:143]
    v_mfma_f32_16x16x32_bf16 v[144:147], v[164:167], a[40:43], v[144:147]
    s_waitcnt lgkmcnt(12)
    v_mfma_f32_16x16x32_bf16 v[140:143], v[168:171], a[12:15], v[140:143]
    v_mfma_f32_16x16x32_bf16 v[144:147], v[168:171], a[44:47], v[144:147]
    s_waitcnt lgkmcnt(11)
    v_mfma_f32_16x16x32_bf16 v[140:143], v[172:175], a[16:19], v[140:143]
    v_mfma_f32_16x16x32_bf16 v[144:147], v[172:175], a[48:51], v[144:147]
    s_waitcnt lgkmcnt(10)
    v_mfma_f32_16x16x32_bf16 v[140:143], v[176:179], a[20:23], v[140:143]
    v_mfma_f32_16x16x32_bf16 v[144:147], v[176:179], a[52:55], v[144:147]
    s_waitcnt lgkmcnt(9)
    v_mfma_f32_16x16x32_bf16 v[140:143], v[180:183], a[24:27], v[140:143]
    v_mfma_f32_16x16x32_bf16 v[144:147], v[180:183], a[56:59], v[144:147]
    s_waitcnt lgkmcnt(8)
    v_mfma_f32_16x16x32_bf16 v[140:143], v[184:187], a[28:31], v[140:143]
    v_mfma_f32_16x16x32_bf16 v[144:147], v[184:187], a[60:63], v[144:147]
    s_waitcnt lgkmcnt(7)
    v_mfma_f32_16x16x32_bf16 v[144:147], v[188:191], a[0:3], v[144:147]
    s_waitcnt lgkmcnt(6)
    v_mfma_f32_16x16x32_bf16 v[144:147], v[192:195], a[4:7], v[144:147]
    s_waitcnt lgkmcnt(5)
    v_mfma_f32_16x16x32_bf16 v[144:147], v[196:199], a[8:11], v[144:147]
    s_waitcnt lgkmcnt(4)
    v_mfma_f32_16x16x32_bf16 v[144:147], v[200:203], a[12:15], v[144:147]
    s_waitcnt lgkmcnt(3)
    v_mfma_f32_16x16x32_bf16 v[144:147], v[204:207], a[16:19], v[144:147]
    s_waitcnt lgkmcnt(2)
    v_mfma_f32_16x16x32_bf16 v[144:147], v[208:211], a[20:23], v[144:147]
    s_waitcnt lgkmcnt(1)
    v_mfma_f32_16x16x32_bf16 v[144:147], v[212:215], a[24:27], v[144:147]
    s_waitcnt lgkmcnt(0)
    v_mfma_f32_16x16x32_bf16 v[144:147], v[216:219], a[28:31], v[144:147]
    v_mfma_f32_16x16x32_bf16 v[148:151], v[156:159], a[64:67], v[148:151]
    v_mfma_f32_16x16x32_bf16 v[152:155], v[156:159], a[96:99], v[152:155]
    v_cvt_pk_bf16_f32 v40, v140, v141
    v_cvt_pk_bf16_f32 v41, v142, v143
    v_mfma_f32_16x16x32_bf16 v[148:151], v[188:191], a[32:35], v[148:151]
    ds_write_b64 v120, v[40:41] offset:16896
    s_nop 1
    v_cvt_pk_bf16_f32 v42, v144, v145
    v_mfma_f32_16x16x32_bf16 v[152:155], v[188:191], a[64:67], v[152:155]
    v_cvt_pk_bf16_f32 v43, v146, v147
    ds_write_b64 v120, v[42:43] offset:17408
    v_mfma_f32_16x16x32_bf16 v[148:151], v[160:163], a[68:71], v[148:151]
    s_waitcnt lgkmcnt(0)
    v_mfma_f32_16x16x32_bf16 v[152:155], v[160:163], a[100:103], v[152:155]
    s_barrier
    ds_read_b32 v40, v121 offset:16896
    v_mfma_f32_16x16x32_bf16 v[148:151], v[192:195], a[36:39], v[148:151]
    ds_read_b32 v41, v121 offset:17952
    ds_read_b32 v42, v121 offset:19008
    v_mfma_f32_16x16x32_bf16 v[152:155], v[192:195], a[68:71], v[152:155]
    ds_read_b32 v43, v121 offset:20064
    s_waitcnt vmcnt(5)
    v_lshlrev_b32 v234, 16, v92
    v_mfma_f32_16x16x32_bf16 v[148:151], v[164:167], a[72:75], v[148:151]
    v_and_b32 v235, 0xffff0000, v92
    v_mfma_f32_16x16x32_bf16 v[152:155], v[164:167], a[104:107], v[152:155]
    v_lshlrev_b32 v236, 16, v93
    v_and_b32 v237, 0xffff0000, v93
    v_mfma_f32_16x16x32_bf16 v[148:151], v[196:199], a[40:43], v[148:151]
    v_lshlrev_b32 v238, 16, v94
    v_and_b32 v239, 0xffff0000, v94
    v_mfma_f32_16x16x32_bf16 v[152:155], v[196:199], a[72:75], v[152:155]
    v_lshlrev_b32 v240, 16, v95
    v_and_b32 v241, 0xffff0000, v95
    v_mfma_f32_16x16x32_bf16 v[148:151], v[168:171], a[76:79], v[148:151]
    s_waitcnt vmcnt(4)
    v_pk_fma_f32 v[242:243], v[108:109], v[234:235], v[108:109] op_sel:[0,0,1] op_sel_hi:[0,1,1]
    v_mfma_f32_16x16x32_bf16 v[152:155], v[168:171], a[108:111], v[152:155]
    v_pk_fma_f32 v[244:245], v[108:109], v[236:237], v[108:109] op_sel:[0,0,1] op_sel_hi:[0,1,1]
    v_pk_fma_f32 v[246:247], v[110:111], v[238:239], v[110:111] op_sel:[0,0,1] op_sel_hi:[0,1,1]
    v_mfma_f32_16x16x32_bf16 v[148:151], v[200:203], a[44:47], v[148:151]
    v_pk_fma_f32 v[248:249], v[110:111], v[240:241], v[110:111] op_sel:[0,0,1] op_sel_hi:[0,1,1]
    v_pk_fma_f32 v[242:243], v[242:243], v[48:49], v[52:53] op_sel:[0,0,0] op_sel_hi:[1,1,1]
    v_mfma_f32_16x16x32_bf16 v[152:155], v[200:203], a[76:79], v[152:155]
    v_pk_fma_f32 v[244:245], v[244:245], v[50:51], v[54:55] op_sel:[0,0,0] op_sel_hi:[1,1,1]
    v_pk_fma_f32 v[246:247], v[246:247], v[48:49], v[52:53] op_sel:[0,0,0] op_sel_hi:[1,1,1]
    v_mfma_f32_16x16x32_bf16 v[148:151], v[172:175], a[80:83], v[148:151]
    v_pk_fma_f32 v[248:249], v[248:249], v[50:51], v[54:55] op_sel:[0,0,0] op_sel_hi:[1,1,1]
    v_mfma_f32_16x16x32_bf16 v[152:155], v[172:175], a[112:115], v[152:155]
    s_waitcnt lgkmcnt(3)
    v_lshlrev_b32 v16, 16, v40
    v_and_b32 v32, 0xffff0000, v40
    v_mfma_f32_16x16x32_bf16 v[148:151], v[204:207], a[48:51], v[148:151]
    s_waitcnt lgkmcnt(2)
    v_lshlrev_b32 v17, 16, v41
    v_and_b32 v33, 0xffff0000, v41
    v_mfma_f32_16x16x32_bf16 v[152:155], v[204:207], a[80:83], v[152:155]
    s_waitcnt lgkmcnt(1)
    v_lshlrev_b32 v18, 16, v42
    v_and_b32 v34, 0xffff0000, v42
    v_mfma_f32_16x16x32_bf16 v[148:151], v[176:179], a[84:87], v[148:151]
    s_waitcnt lgkmcnt(0)
    v_lshlrev_b32 v19, 16, v43
    v_mfma_f32_16x16x32_bf16 v[152:155], v[176:179], a[116:119], v[152:155]
    v_and_b32 v35, 0xffff0000, v43
    v_pk_fma_f32 v[16:17], v[220:221], s[92:93], v[16:17] op_sel:[0,0,0] op_sel_hi:[1,1,1]
    v_mfma_f32_16x16x32_bf16 v[148:151], v[208:211], a[52:55], v[148:151]
    v_pk_fma_f32 v[18:19], v[222:223], s[94:95], v[18:19] op_sel:[0,0,0] op_sel_hi:[1,1,1]
    v_pk_fma_f32 v[32:33], v[224:225], s[92:93], v[32:33] op_sel:[0,0,0] op_sel_hi:[1,1,1]
    v_mfma_f32_16x16x32_bf16 v[152:155], v[208:211], a[84:87], v[152:155]
    v_pk_fma_f32 v[34:35], v[226:227], s[94:95], v[34:35] op_sel:[0,0,0] op_sel_hi:[1,1,1]
    v_pk_fma_f32 v[234:235], v[242:243], v[16:17], v[234:235] op_sel:[0,0,0] op_sel_hi:[1,1,1]
    v_mfma_f32_16x16x32_bf16 v[148:151], v[180:183], a[88:91], v[148:151]
    v_pk_fma_f32 v[236:237], v[244:245], v[18:19], v[236:237] op_sel:[0,0,0] op_sel_hi:[1,1,1]
    v_mfma_f32_16x16x32_bf16 v[152:155], v[180:183], a[120:123], v[152:155]
    v_pk_fma_f32 v[238:239], v[246:247], v[32:33], v[238:239] op_sel:[0,0,0] op_sel_hi:[1,1,1]
    v_pk_fma_f32 v[240:241], v[248:249], v[34:35], v[240:241] op_sel:[0,0,0] op_sel_hi:[1,1,1]
    v_mfma_f32_16x16x32_bf16 v[148:151], v[212:215], a[56:59], v[148:151]
    v_cvt_pk_bf16_f32 v92, v234, v235
    v_cvt_pk_bf16_f32 v93, v236, v237
    v_mfma_f32_16x16x32_bf16 v[152:155], v[212:215], a[88:91], v[152:155]
    v_cvt_pk_bf16_f32 v94, v238, v239
    v_cvt_pk_bf16_f32 v95, v240, v241
    v_mfma_f32_16x16x32_bf16 v[148:151], v[184:187], a[92:95], v[148:151]
    v_min_u32 v92, -2, v92
    v_mfma_f32_16x16x32_bf16 v[152:155], v[184:187], a[124:127], v[152:155]
    v_min_u32 v93, -2, v93
    v_min_u32 v94, -2, v94
    v_mfma_f32_16x16x32_bf16 v[148:151], v[216:219], a[60:63], v[148:151]
    v_min_u32 v95, -2, v95
    global_store_dwordx4 v81, v[92:95], s[38:39] sc1
    v_mfma_f32_16x16x32_bf16 v[152:155], v[216:219], a[92:95], v[152:155]
    v_add_u32 v81, 4096, v81
    v_mov_b32 v228, s70
    v_mov_b32 v230, s72
    v_mov_b32 v232, s74
    v_mov_b32 v229, s71
    v_mov_b32 v231, s73
    v_mov_b32 v233, s75
    v_mov_b32_dpp v230, v20 wave_shr:1 row_mask:0xf bank_mask:0xf
    v_mov_b32_dpp v231, v21 wave_shr:1 row_mask:0xf bank_mask:0xf
    v_mov_b32_dpp v232, v22 wave_shr:1 row_mask:0xf bank_mask:0xf
    v_mov_b32_dpp v233, v23 wave_shr:1 row_mask:0xf bank_mask:0xf
    s_nop 0
    v_mov_b32_dpp v228, v232 wave_shr:1 row_mask:0xf bank_mask:0xf
    v_mov_b32_dpp v229, v233 wave_shr:1 row_mask:0xf bank_mask:0xf
    v_lshlrev_b32 v234, 16, v228
    v_and_b32 v235, 0xffff0000, v228
    v_lshlrev_b32 v236, 16, v229
    v_and_b32 v237, 0xffff0000, v229
    v_lshlrev_b32 v238, 16, v230
    v_and_b32 v239, 0xffff0000, v230
    v_lshlrev_b32 v240, 16, v231
    v_and_b32 v241, 0xffff0000, v231
    v_lshlrev_b32 v242, 16, v232
    v_and_b32 v243, 0xffff0000, v232
    v_lshlrev_b32 v244, 16, v233
    v_and_b32 v245, 0xffff0000, v233
    v_lshlrev_b32 v246, 16, v20
    v_and_b32 v247, 0xffff0000, v20
    v_lshlrev_b32 v248, 16, v21
    v_and_b32 v249, 0xffff0000, v21
    v_lshlrev_b32 v250, 16, v22
    v_and_b32 v251, 0xffff0000, v22
    v_lshlrev_b32 v252, 16, v23
    v_and_b32 v253, 0xffff0000, v23
    v_pk_mul_f32 v[220:221], v[246:247], s[76:77] op_sel:[0,0] op_sel_hi:[1,1]
    v_pk_mul_f32 v[222:223], v[248:249], s[78:79] op_sel:[0,0] op_sel_hi:[1,1]
    v_pk_mul_f32 v[224:225], v[250:251], s[76:77] op_sel:[0,0] op_sel_hi:[1,1]
    v_pk_mul_f32 v[226:227], v[252:253], s[78:79] op_sel:[0,0] op_sel_hi:[1,1]
    v_pk_fma_f32 v[220:221], v[242:243], s[80:81], v[220:221] op_sel:[0,0,0] op_sel_hi:[1,1,1]
    v_pk_fma_f32 v[222:223], v[244:245], s[82:83], v[222:223] op_sel:[0,0,0] op_sel_hi:[1,1,1]
    v_pk_fma_f32 v[224:225], v[246:247], s[80:81], v[224:225] op_sel:[0,0,0] op_sel_hi:[1,1,1]
    v_pk_fma_f32 v[226:227], v[248:249], s[82:83], v[226:227] op_sel:[0,0,0] op_sel_hi:[1,1,1]
    v_pk_fma_f32 v[220:221], v[238:239], s[84:85], v[220:221] op_sel:[0,0,0] op_sel_hi:[1,1,1]
    v_pk_fma_f32 v[222:223], v[240:241], s[86:87], v[222:223] op_sel:[0,0,0] op_sel_hi:[1,1,1]
    v_pk_fma_f32 v[224:225], v[242:243], s[84:85], v[224:225] op_sel:[0,0,0] op_sel_hi:[1,1,1]
    v_pk_fma_f32 v[226:227], v[244:245], s[86:87], v[226:227] op_sel:[0,0,0] op_sel_hi:[1,1,1]
    v_pk_fma_f32 v[220:221], v[234:235], s[88:89], v[220:221] op_sel:[0,0,0] op_sel_hi:[1,1,1]
    v_pk_fma_f32 v[222:223], v[236:237], s[90:91], v[222:223] op_sel:[0,0,0] op_sel_hi:[1,1,1]
    v_pk_fma_f32 v[224:225], v[238:239], s[88:89], v[224:225] op_sel:[0,0,0] op_sel_hi:[1,1,1]
    v_pk_fma_f32 v[226:227], v[240:241], s[90:91], v[226:227] op_sel:[0,0,0] op_sel_hi:[1,1,1]
    v_lshlrev_b32 v234, 16, v36
    v_and_b32 v235, 0xffff0000, v36
    v_lshlrev_b32 v236, 16, v37
    v_and_b32 v237, 0xffff0000, v37
    v_lshlrev_b32 v238, 16, v38
    v_and_b32 v239, 0xffff0000, v38
    v_lshlrev_b32 v240, 16, v39
    v_and_b32 v241, 0xffff0000, v39
    v_pk_mul_f32 v[220:221], v[220:221], v[234:235] op_sel:[0,0] op_sel_hi:[1,1]
    v_pk_mul_f32 v[222:223], v[222:223], v[236:237] op_sel:[0,0] op_sel_hi:[1,1]
    v_pk_mul_f32 v[224:225], v[224:225], v[238:239] op_sel:[0,0] op_sel_hi:[1,1]
    v_pk_mul_f32 v[226:227], v[226:227], v[240:241] op_sel:[0,0] op_sel_hi:[1,1]
    v_cvt_pk_bf16_f32 v40, v224, v220
    v_cvt_pk_bf16_f32 v41, v225, v221
    v_cvt_pk_bf16_f32 v42, v226, v222
    v_cvt_pk_bf16_f32 v43, v227, v223
    ds_write_b16 v118, v40 offset:0
    ds_write_b16_d16_hi v118, v40 offset:2
    ds_write_b32 v118, v40 offset:4642
    ds_write_b16 v118, v40 offset:9284
    ds_write_b16_d16_hi v118, v40 offset:9286
    ds_write_b32 v118, v40 offset:13926
    ds_write_b16 v118, v41 offset:18560
    ds_write_b16_d16_hi v118, v41 offset:18562
    ds_write_b32 v118, v41 offset:23202
    ds_write_b16 v118, v41 offset:27844
    ds_write_b16_d16_hi v118, v41 offset:27846
    ds_write_b32 v118, v41 offset:32486
    ds_write_b16 v119, v42 offset:0
    ds_write_b16_d16_hi v119, v42 offset:2
    ds_write_b32 v119, v42 offset:4642
    ds_write_b16 v119, v42 offset:9284
    ds_write_b16_d16_hi v119, v42 offset:9286
    ds_write_b32 v119, v42 offset:13926
    ds_write_b16 v119, v43 offset:18560
    ds_write_b16_d16_hi v119, v43 offset:18562
    ds_write_b32 v119, v43 offset:23202
    ds_write_b16 v119, v43 offset:27844
    ds_write_b16_d16_hi v119, v43 offset:27846
    ds_write_b32 v119, v43 offset:32486
    s_waitcnt lgkmcnt(0)
    s_barrier
    ds_read_b128 v[156:159], v117 offset:512
    ds_read_b128 v[160:163], v117 offset:576
    ds_read_b128 v[164:167], v117 offset:640
    ds_read_b128 v[168:171], v117 offset:704
    ds_read_b128 v[172:175], v117 offset:768
    ds_read_b128 v[176:179], v117 offset:832
    ds_read_b128 v[180:183], v117 offset:896
    ds_read_b128 v[184:187], v117 offset:960
    ds_read_b128 v[188:191], v117 offset:0
    ds_read_b128 v[192:195], v117 offset:64
    ds_read_b128 v[196:199], v117 offset:128
    ds_read_b128 v[200:203], v117 offset:192
    ds_read_b128 v[204:207], v117 offset:256
    ds_read_b128 v[208:211], v117 offset:320
    ds_read_b128 v[212:215], v117 offset:384
    ds_read_b128 v[216:219], v117 offset:448
    s_waitcnt lgkmcnt(15)
    v_mfma_f32_16x16x32_bf16 v[148:151], v[156:159], a[0:3], v[148:151]
    v_mfma_f32_16x16x32_bf16 v[152:155], v[156:159], a[32:35], v[152:155]
    s_waitcnt lgkmcnt(14)
    v_mfma_f32_16x16x32_bf16 v[148:151], v[160:163], a[4:7], v[148:151]
    v_mfma_f32_16x16x32_bf16 v[152:155], v[160:163], a[36:39], v[152:155]
    s_waitcnt lgkmcnt(13)
    v_mfma_f32_16x16x32_bf16 v[148:151], v[164:167], a[8:11], v[148:151]
    v_mfma_f32_16x16x32_bf16 v[152:155], v[164:167], a[40:43], v[152:155]
    s_waitcnt lgkmcnt(12)
    v_mfma_f32_16x16x32_bf16 v[148:151], v[168:171], a[12:15], v[148:151]
    v_mfma_f32_16x16x32_bf16 v[152:155], v[168:171], a[44:47], v[152:155]
    s_waitcnt lgkmcnt(11)
    v_mfma_f32_16x16x32_bf16 v[148:151], v[172:175], a[16:19], v[148:151]
    v_mfma_f32_16x16x32_bf16 v[152:155], v[172:175], a[48:51], v[152:155]
    s_waitcnt lgkmcnt(10)
    v_mfma_f32_16x16x32_bf16 v[148:151], v[176:179], a[20:23], v[148:151]
    v_mfma_f32_16x16x32_bf16 v[152:155], v[176:179], a[52:55], v[152:155]
    s_waitcnt lgkmcnt(9)
    v_mfma_f32_16x16x32_bf16 v[148:151], v[180:183], a[24:27], v[148:151]
    v_mfma_f32_16x16x32_bf16 v[152:155], v[180:183], a[56:59], v[152:155]
    s_waitcnt lgkmcnt(8)
    v_mfma_f32_16x16x32_bf16 v[148:151], v[184:187], a[28:31], v[148:151]
    v_mfma_f32_16x16x32_bf16 v[152:155], v[184:187], a[60:63], v[152:155]
    s_waitcnt lgkmcnt(7)
    v_mfma_f32_16x16x32_bf16 v[152:155], v[188:191], a[0:3], v[152:155]
    s_waitcnt lgkmcnt(6)
    v_mfma_f32_16x16x32_bf16 v[152:155], v[192:195], a[4:7], v[152:155]
    s_waitcnt lgkmcnt(5)
    v_mfma_f32_16x16x32_bf16 v[152:155], v[196:199], a[8:11], v[152:155]
    s_waitcnt lgkmcnt(4)
    v_mfma_f32_16x16x32_bf16 v[152:155], v[200:203], a[12:15], v[152:155]
    s_waitcnt lgkmcnt(3)
    v_mfma_f32_16x16x32_bf16 v[152:155], v[204:207], a[16:19], v[152:155]
    s_waitcnt lgkmcnt(2)
    v_mfma_f32_16x16x32_bf16 v[152:155], v[208:211], a[20:23], v[152:155]
    s_waitcnt lgkmcnt(1)
    v_mfma_f32_16x16x32_bf16 v[152:155], v[212:215], a[24:27], v[152:155]
    s_waitcnt lgkmcnt(0)
    v_mfma_f32_16x16x32_bf16 v[152:155], v[216:219], a[28:31], v[152:155]
    v_cvt_pk_bf16_f32 v40, v148, v149
    v_cvt_pk_bf16_f32 v41, v150, v151
    ds_write_b64 v120, v[40:41] offset:21120
    s_nop 4
    v_cvt_pk_bf16_f32 v42, v152, v153
    v_cvt_pk_bf16_f32 v43, v154, v155
    ds_write_b64 v120, v[42:43] offset:21632
    s_waitcnt lgkmcnt(0)
    s_barrier
    ds_read_b32 v40, v121 offset:21120
    ds_read_b32 v41, v121 offset:22176
    ds_read_b32 v42, v121 offset:23232
    ds_read_b32 v43, v121 offset:24288
    s_waitcnt vmcnt(4)
    v_lshlrev_b32 v234, 16, v96
    v_and_b32 v235, 0xffff0000, v96
    v_lshlrev_b32 v236, 16, v97
    v_and_b32 v237, 0xffff0000, v97
    v_lshlrev_b32 v238, 16, v98
    v_and_b32 v239, 0xffff0000, v98
    v_lshlrev_b32 v240, 16, v99
    v_and_b32 v241, 0xffff0000, v99
    s_waitcnt vmcnt(3)
    v_pk_fma_f32 v[242:243], v[112:113], v[234:235], v[112:113] op_sel:[0,0,1] op_sel_hi:[0,1,1]
    v_pk_fma_f32 v[244:245], v[112:113], v[236:237], v[112:113] op_sel:[0,0,1] op_sel_hi:[0,1,1]
    v_pk_fma_f32 v[246:247], v[114:115], v[238:239], v[114:115] op_sel:[0,0,1] op_sel_hi:[0,1,1]
    v_pk_fma_f32 v[248:249], v[114:115], v[240:241], v[114:115] op_sel:[0,0,1] op_sel_hi:[0,1,1]
    v_pk_fma_f32 v[242:243], v[242:243], v[48:49], v[52:53] op_sel:[0,0,0] op_sel_hi:[1,1,1]
    v_pk_fma_f32 v[244:245], v[244:245], v[50:51], v[54:55] op_sel:[0,0,0] op_sel_hi:[1,1,1]
    v_pk_fma_f32 v[246:247], v[246:247], v[48:49], v[52:53] op_sel:[0,0,0] op_sel_hi:[1,1,1]
    v_pk_fma_f32 v[248:249], v[248:249], v[50:51], v[54:55] op_sel:[0,0,0] op_sel_hi:[1,1,1]
    s_waitcnt lgkmcnt(3)
    v_lshlrev_b32 v20, 16, v40
    v_and_b32 v36, 0xffff0000, v40
    s_waitcnt lgkmcnt(2)
    v_lshlrev_b32 v21, 16, v41
    v_and_b32 v37, 0xffff0000, v41
    s_waitcnt lgkmcnt(1)
    v_lshlrev_b32 v22, 16, v42
    v_and_b32 v38, 0xffff0000, v42
    s_waitcnt lgkmcnt(0)
    v_lshlrev_b32 v23, 16, v43
    v_and_b32 v39, 0xffff0000, v43
    v_pk_fma_f32 v[20:21], v[220:221], s[92:93], v[20:21] op_sel:[0,0,0] op_sel_hi:[1,1,1]
    v_pk_fma_f32 v[22:23], v[222:223], s[94:95], v[22:23] op_sel:[0,0,0] op_sel_hi:[1,1,1]
    v_pk_fma_f32 v[36:37], v[224:225], s[92:93], v[36:37] op_sel:[0,0,0] op_sel_hi:[1,1,1]
    v_pk_fma_f32 v[38:39], v[226:227], s[94:95], v[38:39] op_sel:[0,0,0] op_sel_hi:[1,1,1]
    v_pk_fma_f32 v[234:235], v[242:243], v[20:21], v[234:235] op_sel:[0,0,0] op_sel_hi:[1,1,1]
    v_pk_fma_f32 v[236:237], v[244:245], v[22:23], v[236:237] op_sel:[0,0,0] op_sel_hi:[1,1,1]
    v_pk_fma_f32 v[238:239], v[246:247], v[36:37], v[238:239] op_sel:[0,0,0] op_sel_hi:[1,1,1]
    v_pk_fma_f32 v[240:241], v[248:249], v[38:39], v[240:241] op_sel:[0,0,0] op_sel_hi:[1,1,1]
    v_cvt_pk_bf16_f32 v96, v234, v235
    v_cvt_pk_bf16_f32 v97, v236, v237
    v_cvt_pk_bf16_f32 v98, v238, v239
    v_cvt_pk_bf16_f32 v99, v240, v241
    v_min_u32 v96, -2, v96
    v_min_u32 v97, -2, v97
    v_min_u32 v98, -2, v98
    v_min_u32 v99, -2, v99
    global_store_dwordx4 v81, v[96:99], s[38:39] sc1
    s_branch Ldone_conv_kernel
Lconv_spare:
    s_sub_u32 s40, s2, 160
    s_cmp_ge_u32 s40, 54
    s_cbranch_scc1 Lrole_conv_kernel_0
    v_and_b32 v2, 15, v1
    v_lshrrev_b32 v3, 4, v1
    s_mul_i32 s4, s3, 552960
    s_lshl_b32 s5, s40, 6
    s_add_u32 s4, s4, s5
    s_add_u32 s4, s4, 3456
    v_mul_u32_u24 v4, 27648, v3
    v_lshl_add_u32 v4, v2, 2, v4
    v_add_u32 v4, s4, v4
    global_load_dword v8, v4, s[22:23] offset:-3456 nt
    global_load_dword v9, v4, s[22:23] offset:0 nt
    global_load_dword v10, v4, s[22:23] offset:3456 nt
    v_add_u32 v4, 10368, v4
    global_load_dword v11, v4, s[22:23] offset:-3456 nt
    global_load_dword v12, v4, s[22:23] offset:0 nt
    global_load_dword v13, v4, s[22:23] offset:3456 nt
    v_add_u32 v4, 10368, v4
    global_load_dword v14, v4, s[22:23] offset:-3456 nt
    global_load_dword v15, v4, s[22:23] offset:0 nt
    v_add_u32 v4, 89856, v4
    global_load_dword v16, v4, s[22:23] offset:-3456 nt
    global_load_dword v17, v4, s[22:23] offset:0 nt
    global_load_dword v18, v4, s[22:23] offset:3456 nt
    v_add_u32 v4, 10368, v4
    global_load_dword v19, v4, s[22:23] offset:-3456 nt
    global_load_dword v20, v4, s[22:23] offset:0 nt
    global_load_dword v21, v4, s[22:23] offset:3456 nt
    v_add_u32 v4, 10368, v4
    global_load_dword v22, v4, s[22:23] offset:-3456 nt
    global_load_dword v23, v4, s[22:23] offset:0 nt
    v_add_u32 v4, 89856, v4
    global_load_dword v24, v4, s[22:23] offset:-3456 nt
    global_load_dword v25, v4, s[22:23] offset:0 nt
    global_load_dword v26, v4, s[22:23] offset:3456 nt
    v_add_u32 v4, 10368, v4
    global_load_dword v27, v4, s[22:23] offset:-3456 nt
    global_load_dword v28, v4, s[22:23] offset:0 nt
    global_load_dword v29, v4, s[22:23] offset:3456 nt
    v_add_u32 v4, 10368, v4
    global_load_dword v30, v4, s[22:23] offset:-3456 nt
    global_load_dword v31, v4, s[22:23] offset:0 nt
    v_add_u32 v4, 89856, v4
    global_load_dword v32, v4, s[22:23] offset:-3456 nt
    global_load_dword v33, v4, s[22:23] offset:0 nt
    global_load_dword v34, v4, s[22:23] offset:3456 nt
    v_add_u32 v4, 10368, v4
    global_load_dword v35, v4, s[22:23] offset:-3456 nt
    global_load_dword v36, v4, s[22:23] offset:0 nt
    global_load_dword v37, v4, s[22:23] offset:3456 nt
    v_add_u32 v4, 10368, v4
    global_load_dword v38, v4, s[22:23] offset:-3456 nt
    global_load_dword v39, v4, s[22:23] offset:0 nt
    v_add_u32 v4, 89856, v4
    global_load_dword v40, v4, s[22:23] offset:-3456 nt
    global_load_dword v41, v4, s[22:23] offset:0 nt
    global_load_dword v42, v4, s[22:23] offset:3456 nt
    v_add_u32 v4, 10368, v4
    global_load_dword v43, v4, s[22:23] offset:-3456 nt
    global_load_dword v44, v4, s[22:23] offset:0 nt
    global_load_dword v45, v4, s[22:23] offset:3456 nt
    v_add_u32 v4, 10368, v4
    global_load_dword v46, v4, s[22:23] offset:-3456 nt
    global_load_dword v47, v4, s[22:23] offset:0 nt
    v_min_u32 v48, 39, v1
    s_mul_i32 s5, s3, 640
    v_lshl_add_u32 v48, v48, 4, s5
    v_add_u32 v60, 10240, v48
    global_load_dwordx4 v[52:55], v60, s[38:39]
    v_add_u32 v60, 25600, v48
    global_load_dwordx4 v[56:59], v60, s[38:39]
    v_add_u32 v72, 7680, v48
    global_load_dwordx4 v[64:67], v72, s[38:39]
    v_add_u32 v72, 23040, v48
    global_load_dwordx4 v[68:71], v72, s[38:39]
    s_waitcnt vmcnt(2)
    v_add_f32 v52, v52, v56
    v_add_f32 v53, v53, v57
    v_add_f32 v54, v54, v58
    v_add_f32 v55, v55, v59
    v_cvt_pk_bf16_f32 v52, v52, v52
    v_lshlrev_b32 v52, 16, v52
    v_cvt_pk_bf16_f32 v53, v53, v53
    v_lshlrev_b32 v53, 16, v53
    v_cvt_pk_bf16_f32 v54, v54, v54
    v_lshlrev_b32 v54, 16, v54
    v_cvt_pk_bf16_f32 v55, v55, v55
    v_lshlrev_b32 v55, 16, v55
    v_add_f32 v52, 1.0, v52
    v_add_f32 v53, 1.0, v53
    v_add_f32 v54, 1.0, v54
    v_add_f32 v55, 1.0, v55
    v_cvt_pk_bf16_f32 v52, v52, v52
    v_lshlrev_b32 v52, 16, v52
    v_cvt_pk_bf16_f32 v53, v53, v53
    v_lshlrev_b32 v53, 16, v53
    v_cvt_pk_bf16_f32 v54, v54, v54
    v_lshlrev_b32 v54, 16, v54
    v_cvt_pk_bf16_f32 v55, v55, v55
    v_lshlrev_b32 v55, 16, v55
    s_waitcnt vmcnt(0)
    v_add_f32 v64, v64, v68
    v_add_f32 v65, v65, v69
    v_add_f32 v66, v66, v70
    v_add_f32 v67, v67, v71
    v_cvt_pk_bf16_f32 v64, v64, v64
    v_lshlrev_b32 v64, 16, v64
    v_cvt_pk_bf16_f32 v65, v65, v65
    v_lshlrev_b32 v65, 16, v65
    v_cvt_pk_bf16_f32 v66, v66, v66
    v_lshlrev_b32 v66, 16, v66
    v_cvt_pk_bf16_f32 v67, v67, v67
    v_lshlrev_b32 v67, 16, v67
    ds_write_b128 v48, v[52:55]
    ds_write_b128 v48, v[64:67] offset:2560
    v_lshl_add_u32 v73, v3, 5, s5
    s_cmp_ge_u32 s40, 27
    s_cselect_b32 s6, -54, 56
    s_lshl_b32 s7, s40, 1
    s_add_u32 s6, s6, s7
    s_mul_i32 s4, s6, 20480
    s_mul_i32 s5, s3, 5120
    s_add_u32 s4, s4, s5
    s_add_u32 s4, s4, 7342080
    v_lshl_add_u32 v74, v1, 4, s4
    v_add_u32 v75, 20480, v74
    s_mov_b32 s7, 0x3f803f80
    v_mov_b32 v76, 0
    v_mov_b32 v77, 0
    v_mov_b32 v78, 0
    v_mov_b32 v79, 0
    ds_read_b128 v[80:83], v73 offset:0
    ds_read_b128 v[88:91], v73 offset:2560
    ds_read_b128 v[84:87], v73 offset:16
    ds_read_b128 v[92:95], v73 offset:2576
    v_lshlrev_b32 v112, 16, v8
    v_and_b32 v113, 0xffff0000, v8
    v_lshlrev_b32 v114, 16, v9
    v_and_b32 v115, 0xffff0000, v9
    v_lshlrev_b32 v116, 16, v10
    v_and_b32 v117, 0xffff0000, v10
    v_lshlrev_b32 v118, 16, v11
    v_and_b32 v119, 0xffff0000, v11
    v_lshlrev_b32 v120, 16, v12
    v_and_b32 v121, 0xffff0000, v12
    v_lshlrev_b32 v122, 16, v13
    v_and_b32 v123, 0xffff0000, v13
    v_lshlrev_b32 v124, 16, v14
    v_and_b32 v125, 0xffff0000, v14
    v_lshlrev_b32 v126, 16, v15
    v_and_b32 v127, 0xffff0000, v15
    s_waitcnt lgkmcnt(3)
    v_pk_mul_f32 v[128:129], v[80:81], v[112:113] op_sel:[0,0] op_sel_hi:[0,1]
    v_pk_mul_f32 v[130:131], v[80:81], v[114:115] op_sel:[1,0] op_sel_hi:[1,1]
    v_pk_mul_f32 v[132:133], v[82:83], v[116:117] op_sel:[0,0] op_sel_hi:[0,1]
    v_pk_mul_f32 v[134:135], v[82:83], v[118:119] op_sel:[1,0] op_sel_hi:[1,1]
    s_waitcnt lgkmcnt(1)
    v_pk_mul_f32 v[136:137], v[84:85], v[120:121] op_sel:[0,0] op_sel_hi:[0,1]
    v_pk_mul_f32 v[138:139], v[84:85], v[122:123] op_sel:[1,0] op_sel_hi:[1,1]
    v_pk_mul_f32 v[140:141], v[86:87], v[124:125] op_sel:[0,0] op_sel_hi:[0,1]
    v_pk_mul_f32 v[142:143], v[86:87], v[126:127] op_sel:[1,0] op_sel_hi:[1,1]
    v_cvt_pk_bf16_f32 v144, v128, v130
    v_cvt_pk_bf16_f32 v145, v132, v134
    v_cvt_pk_bf16_f32 v146, v136, v138
    v_cvt_pk_bf16_f32 v147, v140, v142
    v_cvt_pk_bf16_f32 v148, v129, v131
    v_cvt_pk_bf16_f32 v149, v133, v135
    v_cvt_pk_bf16_f32 v150, v137, v139
    v_cvt_pk_bf16_f32 v151, v141, v143
    global_store_dwordx4 v74, v[144:147], s[38:39] offset:-2048 sc1
    global_store_dwordx4 v75, v[148:151], s[38:39] offset:-2048 sc1
    v_pk_fma_f32 v[78:79], v[88:89], v[112:113], v[78:79] op_sel:[0,0,0] op_sel_hi:[0,1,1]
    v_pk_fma_f32 v[78:79], v[88:89], v[114:115], v[78:79] op_sel:[1,0,0] op_sel_hi:[1,1,1]
    v_pk_fma_f32 v[78:79], v[90:91], v[116:117], v[78:79] op_sel:[0,0,0] op_sel_hi:[0,1,1]
    v_pk_fma_f32 v[78:79], v[90:91], v[118:119], v[78:79] op_sel:[1,0,0] op_sel_hi:[1,1,1]
    s_waitcnt lgkmcnt(0)
    v_pk_fma_f32 v[78:79], v[92:93], v[120:121], v[78:79] op_sel:[0,0,0] op_sel_hi:[0,1,1]
    v_pk_fma_f32 v[78:79], v[92:93], v[122:123], v[78:79] op_sel:[1,0,0] op_sel_hi:[1,1,1]
    v_pk_fma_f32 v[78:79], v[94:95], v[124:125], v[78:79] op_sel:[0,0,0] op_sel_hi:[0,1,1]
    v_pk_fma_f32 v[78:79], v[94:95], v[126:127], v[78:79] op_sel:[1,0,0] op_sel_hi:[1,1,1]
    v_dot2_f32_bf16 v76, v144, s7, v76
    v_dot2_f32_bf16 v77, v148, s7, v77
    v_dot2_f32_bf16 v76, v145, s7, v76
    v_dot2_f32_bf16 v77, v149, s7, v77
    v_dot2_f32_bf16 v76, v146, s7, v76
    v_dot2_f32_bf16 v77, v150, s7, v77
    v_dot2_f32_bf16 v76, v147, s7, v76
    v_dot2_f32_bf16 v77, v151, s7, v77
    ds_read_b128 v[96:99], v73 offset:128
    ds_read_b128 v[104:107], v73 offset:2688
    ds_read_b128 v[100:103], v73 offset:144
    ds_read_b128 v[108:111], v73 offset:2704
    v_lshlrev_b32 v112, 16, v16
    v_and_b32 v113, 0xffff0000, v16
    v_lshlrev_b32 v114, 16, v17
    v_and_b32 v115, 0xffff0000, v17
    v_lshlrev_b32 v116, 16, v18
    v_and_b32 v117, 0xffff0000, v18
    v_lshlrev_b32 v118, 16, v19
    v_and_b32 v119, 0xffff0000, v19
    v_lshlrev_b32 v120, 16, v20
    v_and_b32 v121, 0xffff0000, v20
    v_lshlrev_b32 v122, 16, v21
    v_and_b32 v123, 0xffff0000, v21
    v_lshlrev_b32 v124, 16, v22
    v_and_b32 v125, 0xffff0000, v22
    v_lshlrev_b32 v126, 16, v23
    v_and_b32 v127, 0xffff0000, v23
    s_waitcnt lgkmcnt(3)
    v_pk_mul_f32 v[128:129], v[96:97], v[112:113] op_sel:[0,0] op_sel_hi:[0,1]
    v_pk_mul_f32 v[130:131], v[96:97], v[114:115] op_sel:[1,0] op_sel_hi:[1,1]
    v_pk_mul_f32 v[132:133], v[98:99], v[116:117] op_sel:[0,0] op_sel_hi:[0,1]
    v_pk_mul_f32 v[134:135], v[98:99], v[118:119] op_sel:[1,0] op_sel_hi:[1,1]
    s_waitcnt lgkmcnt(1)
    v_pk_mul_f32 v[136:137], v[100:101], v[120:121] op_sel:[0,0] op_sel_hi:[0,1]
    v_pk_mul_f32 v[138:139], v[100:101], v[122:123] op_sel:[1,0] op_sel_hi:[1,1]
    v_pk_mul_f32 v[140:141], v[102:103], v[124:125] op_sel:[0,0] op_sel_hi:[0,1]
    v_pk_mul_f32 v[142:143], v[102:103], v[126:127] op_sel:[1,0] op_sel_hi:[1,1]
    v_cvt_pk_bf16_f32 v152, v128, v130
    v_cvt_pk_bf16_f32 v153, v132, v134
    v_cvt_pk_bf16_f32 v154, v136, v138
    v_cvt_pk_bf16_f32 v155, v140, v142
    v_cvt_pk_bf16_f32 v156, v129, v131
    v_cvt_pk_bf16_f32 v157, v133, v135
    v_cvt_pk_bf16_f32 v158, v137, v139
    v_cvt_pk_bf16_f32 v159, v141, v143
    global_store_dwordx4 v74, v[152:155], s[38:39] offset:-1024 sc1
    global_store_dwordx4 v75, v[156:159], s[38:39] offset:-1024 sc1
    v_pk_fma_f32 v[78:79], v[104:105], v[112:113], v[78:79] op_sel:[0,0,0] op_sel_hi:[0,1,1]
    v_pk_fma_f32 v[78:79], v[104:105], v[114:115], v[78:79] op_sel:[1,0,0] op_sel_hi:[1,1,1]
    v_pk_fma_f32 v[78:79], v[106:107], v[116:117], v[78:79] op_sel:[0,0,0] op_sel_hi:[0,1,1]
    v_pk_fma_f32 v[78:79], v[106:107], v[118:119], v[78:79] op_sel:[1,0,0] op_sel_hi:[1,1,1]
    s_waitcnt lgkmcnt(0)
    v_pk_fma_f32 v[78:79], v[108:109], v[120:121], v[78:79] op_sel:[0,0,0] op_sel_hi:[0,1,1]
    v_pk_fma_f32 v[78:79], v[108:109], v[122:123], v[78:79] op_sel:[1,0,0] op_sel_hi:[1,1,1]
    v_pk_fma_f32 v[78:79], v[110:111], v[124:125], v[78:79] op_sel:[0,0,0] op_sel_hi:[0,1,1]
    v_pk_fma_f32 v[78:79], v[110:111], v[126:127], v[78:79] op_sel:[1,0,0] op_sel_hi:[1,1,1]
    v_dot2_f32_bf16 v76, v152, s7, v76
    v_dot2_f32_bf16 v77, v156, s7, v77
    v_dot2_f32_bf16 v76, v153, s7, v76
    v_dot2_f32_bf16 v77, v157, s7, v77
    v_dot2_f32_bf16 v76, v154, s7, v76
    v_dot2_f32_bf16 v77, v158, s7, v77
    v_dot2_f32_bf16 v76, v155, s7, v76
    v_dot2_f32_bf16 v77, v159, s7, v77
    ds_read_b128 v[80:83], v73 offset:256
    ds_read_b128 v[88:91], v73 offset:2816
    ds_read_b128 v[84:87], v73 offset:272
    ds_read_b128 v[92:95], v73 offset:2832
    v_lshlrev_b32 v112, 16, v24
    v_and_b32 v113, 0xffff0000, v24
    v_lshlrev_b32 v114, 16, v25
    v_and_b32 v115, 0xffff0000, v25
    v_lshlrev_b32 v116, 16, v26
    v_and_b32 v117, 0xffff0000, v26
    v_lshlrev_b32 v118, 16, v27
    v_and_b32 v119, 0xffff0000, v27
    v_lshlrev_b32 v120, 16, v28
    v_and_b32 v121, 0xffff0000, v28
    v_lshlrev_b32 v122, 16, v29
    v_and_b32 v123, 0xffff0000, v29
    v_lshlrev_b32 v124, 16, v30
    v_and_b32 v125, 0xffff0000, v30
    v_lshlrev_b32 v126, 16, v31
    v_and_b32 v127, 0xffff0000, v31
    s_waitcnt lgkmcnt(3)
    v_pk_mul_f32 v[128:129], v[80:81], v[112:113] op_sel:[0,0] op_sel_hi:[0,1]
    v_pk_mul_f32 v[130:131], v[80:81], v[114:115] op_sel:[1,0] op_sel_hi:[1,1]
    v_pk_mul_f32 v[132:133], v[82:83], v[116:117] op_sel:[0,0] op_sel_hi:[0,1]
    v_pk_mul_f32 v[134:135], v[82:83], v[118:119] op_sel:[1,0] op_sel_hi:[1,1]
    s_waitcnt lgkmcnt(1)
    v_pk_mul_f32 v[136:137], v[84:85], v[120:121] op_sel:[0,0] op_sel_hi:[0,1]
    v_pk_mul_f32 v[138:139], v[84:85], v[122:123] op_sel:[1,0] op_sel_hi:[1,1]
    v_pk_mul_f32 v[140:141], v[86:87], v[124:125] op_sel:[0,0] op_sel_hi:[0,1]
    v_pk_mul_f32 v[142:143], v[86:87], v[126:127] op_sel:[1,0] op_sel_hi:[1,1]
    v_cvt_pk_bf16_f32 v144, v128, v130
    v_cvt_pk_bf16_f32 v145, v132, v134
    v_cvt_pk_bf16_f32 v146, v136, v138
    v_cvt_pk_bf16_f32 v147, v140, v142
    v_cvt_pk_bf16_f32 v148, v129, v131
    v_cvt_pk_bf16_f32 v149, v133, v135
    v_cvt_pk_bf16_f32 v150, v137, v139
    v_cvt_pk_bf16_f32 v151, v141, v143
    global_store_dwordx4 v74, v[144:147], s[38:39] offset:0 sc1
    global_store_dwordx4 v75, v[148:151], s[38:39] offset:0 sc1
    v_pk_fma_f32 v[78:79], v[88:89], v[112:113], v[78:79] op_sel:[0,0,0] op_sel_hi:[0,1,1]
    v_pk_fma_f32 v[78:79], v[88:89], v[114:115], v[78:79] op_sel:[1,0,0] op_sel_hi:[1,1,1]
    v_pk_fma_f32 v[78:79], v[90:91], v[116:117], v[78:79] op_sel:[0,0,0] op_sel_hi:[0,1,1]
    v_pk_fma_f32 v[78:79], v[90:91], v[118:119], v[78:79] op_sel:[1,0,0] op_sel_hi:[1,1,1]
    s_waitcnt lgkmcnt(0)
    v_pk_fma_f32 v[78:79], v[92:93], v[120:121], v[78:79] op_sel:[0,0,0] op_sel_hi:[0,1,1]
    v_pk_fma_f32 v[78:79], v[92:93], v[122:123], v[78:79] op_sel:[1,0,0] op_sel_hi:[1,1,1]
    v_pk_fma_f32 v[78:79], v[94:95], v[124:125], v[78:79] op_sel:[0,0,0] op_sel_hi:[0,1,1]
    v_pk_fma_f32 v[78:79], v[94:95], v[126:127], v[78:79] op_sel:[1,0,0] op_sel_hi:[1,1,1]
    v_dot2_f32_bf16 v76, v144, s7, v76
    v_dot2_f32_bf16 v77, v148, s7, v77
    v_dot2_f32_bf16 v76, v145, s7, v76
    v_dot2_f32_bf16 v77, v149, s7, v77
    v_dot2_f32_bf16 v76, v146, s7, v76
    v_dot2_f32_bf16 v77, v150, s7, v77
    v_dot2_f32_bf16 v76, v147, s7, v76
    v_dot2_f32_bf16 v77, v151, s7, v77
    ds_read_b128 v[96:99], v73 offset:384
    ds_read_b128 v[104:107], v73 offset:2944
    ds_read_b128 v[100:103], v73 offset:400
    ds_read_b128 v[108:111], v73 offset:2960
    v_lshlrev_b32 v112, 16, v32
    v_and_b32 v113, 0xffff0000, v32
    v_lshlrev_b32 v114, 16, v33
    v_and_b32 v115, 0xffff0000, v33
    v_lshlrev_b32 v116, 16, v34
    v_and_b32 v117, 0xffff0000, v34
    v_lshlrev_b32 v118, 16, v35
    v_and_b32 v119, 0xffff0000, v35
    v_lshlrev_b32 v120, 16, v36
    v_and_b32 v121, 0xffff0000, v36
    v_lshlrev_b32 v122, 16, v37
    v_and_b32 v123, 0xffff0000, v37
    v_lshlrev_b32 v124, 16, v38
    v_and_b32 v125, 0xffff0000, v38
    v_lshlrev_b32 v126, 16, v39
    v_and_b32 v127, 0xffff0000, v39
    s_waitcnt lgkmcnt(3)
    v_pk_mul_f32 v[128:129], v[96:97], v[112:113] op_sel:[0,0] op_sel_hi:[0,1]
    v_pk_mul_f32 v[130:131], v[96:97], v[114:115] op_sel:[1,0] op_sel_hi:[1,1]
    v_pk_mul_f32 v[132:133], v[98:99], v[116:117] op_sel:[0,0] op_sel_hi:[0,1]
    v_pk_mul_f32 v[134:135], v[98:99], v[118:119] op_sel:[1,0] op_sel_hi:[1,1]
    s_waitcnt lgkmcnt(1)
    v_pk_mul_f32 v[136:137], v[100:101], v[120:121] op_sel:[0,0] op_sel_hi:[0,1]
    v_pk_mul_f32 v[138:139], v[100:101], v[122:123] op_sel:[1,0] op_sel_hi:[1,1]
    v_pk_mul_f32 v[140:141], v[102:103], v[124:125] op_sel:[0,0] op_sel_hi:[0,1]
    v_pk_mul_f32 v[142:143], v[102:103], v[126:127] op_sel:[1,0] op_sel_hi:[1,1]
    v_cvt_pk_bf16_f32 v152, v128, v130
    v_cvt_pk_bf16_f32 v153, v132, v134
    v_cvt_pk_bf16_f32 v154, v136, v138
    v_cvt_pk_bf16_f32 v155, v140, v142
    v_cvt_pk_bf16_f32 v156, v129, v131
    v_cvt_pk_bf16_f32 v157, v133, v135
    v_cvt_pk_bf16_f32 v158, v137, v139
    v_cvt_pk_bf16_f32 v159, v141, v143
    global_store_dwordx4 v74, v[152:155], s[38:39] offset:1024 sc1
    global_store_dwordx4 v75, v[156:159], s[38:39] offset:1024 sc1
    v_pk_fma_f32 v[78:79], v[104:105], v[112:113], v[78:79] op_sel:[0,0,0] op_sel_hi:[0,1,1]
    v_pk_fma_f32 v[78:79], v[104:105], v[114:115], v[78:79] op_sel:[1,0,0] op_sel_hi:[1,1,1]
    v_pk_fma_f32 v[78:79], v[106:107], v[116:117], v[78:79] op_sel:[0,0,0] op_sel_hi:[0,1,1]
    v_pk_fma_f32 v[78:79], v[106:107], v[118:119], v[78:79] op_sel:[1,0,0] op_sel_hi:[1,1,1]
    s_waitcnt lgkmcnt(0)
    v_pk_fma_f32 v[78:79], v[108:109], v[120:121], v[78:79] op_sel:[0,0,0] op_sel_hi:[0,1,1]
    v_pk_fma_f32 v[78:79], v[108:109], v[122:123], v[78:79] op_sel:[1,0,0] op_sel_hi:[1,1,1]
    v_pk_fma_f32 v[78:79], v[110:111], v[124:125], v[78:79] op_sel:[0,0,0] op_sel_hi:[0,1,1]
    v_pk_fma_f32 v[78:79], v[110:111], v[126:127], v[78:79] op_sel:[1,0,0] op_sel_hi:[1,1,1]
    v_dot2_f32_bf16 v76, v152, s7, v76
    v_dot2_f32_bf16 v77, v156, s7, v77
    v_dot2_f32_bf16 v76, v153, s7, v76
    v_dot2_f32_bf16 v77, v157, s7, v77
    v_dot2_f32_bf16 v76, v154, s7, v76
    v_dot2_f32_bf16 v77, v158, s7, v77
    v_dot2_f32_bf16 v76, v155, s7, v76
    v_dot2_f32_bf16 v77, v159, s7, v77
    ds_read_b128 v[80:83], v73 offset:512
    ds_read_b128 v[88:91], v73 offset:3072
    ds_read_b128 v[84:87], v73 offset:528
    ds_read_b128 v[92:95], v73 offset:3088
    v_lshlrev_b32 v112, 16, v40
    v_and_b32 v113, 0xffff0000, v40
    v_lshlrev_b32 v114, 16, v41
    v_and_b32 v115, 0xffff0000, v41
    v_lshlrev_b32 v116, 16, v42
    v_and_b32 v117, 0xffff0000, v42
    v_lshlrev_b32 v118, 16, v43
    v_and_b32 v119, 0xffff0000, v43
    v_lshlrev_b32 v120, 16, v44
    v_and_b32 v121, 0xffff0000, v44
    v_lshlrev_b32 v122, 16, v45
    v_and_b32 v123, 0xffff0000, v45
    v_lshlrev_b32 v124, 16, v46
    v_and_b32 v125, 0xffff0000, v46
    v_lshlrev_b32 v126, 16, v47
    v_and_b32 v127, 0xffff0000, v47
    s_waitcnt lgkmcnt(3)
    v_pk_mul_f32 v[128:129], v[80:81], v[112:113] op_sel:[0,0] op_sel_hi:[0,1]
    v_pk_mul_f32 v[130:131], v[80:81], v[114:115] op_sel:[1,0] op_sel_hi:[1,1]
    v_pk_mul_f32 v[132:133], v[82:83], v[116:117] op_sel:[0,0] op_sel_hi:[0,1]
    v_pk_mul_f32 v[134:135], v[82:83], v[118:119] op_sel:[1,0] op_sel_hi:[1,1]
    s_waitcnt lgkmcnt(1)
    v_pk_mul_f32 v[136:137], v[84:85], v[120:121] op_sel:[0,0] op_sel_hi:[0,1]
    v_pk_mul_f32 v[138:139], v[84:85], v[122:123] op_sel:[1,0] op_sel_hi:[1,1]
    v_pk_mul_f32 v[140:141], v[86:87], v[124:125] op_sel:[0,0] op_sel_hi:[0,1]
    v_pk_mul_f32 v[142:143], v[86:87], v[126:127] op_sel:[1,0] op_sel_hi:[1,1]
    v_cvt_pk_bf16_f32 v144, v128, v130
    v_cvt_pk_bf16_f32 v145, v132, v134
    v_cvt_pk_bf16_f32 v146, v136, v138
    v_cvt_pk_bf16_f32 v147, v140, v142
    v_cvt_pk_bf16_f32 v148, v129, v131
    v_cvt_pk_bf16_f32 v149, v133, v135
    v_cvt_pk_bf16_f32 v150, v137, v139
    v_cvt_pk_bf16_f32 v151, v141, v143
    global_store_dwordx4 v74, v[144:147], s[38:39] offset:2048 sc1
    global_store_dwordx4 v75, v[148:151], s[38:39] offset:2048 sc1
    v_pk_fma_f32 v[78:79], v[88:89], v[112:113], v[78:79] op_sel:[0,0,0] op_sel_hi:[0,1,1]
    v_pk_fma_f32 v[78:79], v[88:89], v[114:115], v[78:79] op_sel:[1,0,0] op_sel_hi:[1,1,1]
    v_pk_fma_f32 v[78:79], v[90:91], v[116:117], v[78:79] op_sel:[0,0,0] op_sel_hi:[0,1,1]
    v_pk_fma_f32 v[78:79], v[90:91], v[118:119], v[78:79] op_sel:[1,0,0] op_sel_hi:[1,1,1]
    s_waitcnt lgkmcnt(0)
    v_pk_fma_f32 v[78:79], v[92:93], v[120:121], v[78:79] op_sel:[0,0,0] op_sel_hi:[0,1,1]
    v_pk_fma_f32 v[78:79], v[92:93], v[122:123], v[78:79] op_sel:[1,0,0] op_sel_hi:[1,1,1]
    v_pk_fma_f32 v[78:79], v[94:95], v[124:125], v[78:79] op_sel:[0,0,0] op_sel_hi:[0,1,1]
    v_pk_fma_f32 v[78:79], v[94:95], v[126:127], v[78:79] op_sel:[1,0,0] op_sel_hi:[1,1,1]
    v_dot2_f32_bf16 v76, v144, s7, v76
    v_dot2_f32_bf16 v77, v148, s7, v77
    v_dot2_f32_bf16 v76, v145, s7, v76
    v_dot2_f32_bf16 v77, v149, s7, v77
    v_dot2_f32_bf16 v76, v146, s7, v76
    v_dot2_f32_bf16 v77, v150, s7, v77
    v_dot2_f32_bf16 v76, v147, s7, v76
    v_dot2_f32_bf16 v77, v151, s7, v77
    s_nop 2
    v_permlane32_swap_b32 v76, v77
    v_permlane32_swap_b32 v78, v79
    v_add_f32 v76, v76, v77
    v_add_f32 v78, v78, v79
    s_nop 1
    v_permlane16_swap_b32 v76, v78
    v_add_f32 v76, v76, v78
    v_lshlrev_b32 v73, 2, v0
    ds_write_b32 v73, v76 offset:5120
    s_waitcnt lgkmcnt(0)
    s_barrier
    v_lshlrev_b32 v73, 2, v1
    ds_read_b32 v112, v73 offset:5120
    ds_read_b32 v113, v73 offset:5376
    ds_read_b32 v114, v73 offset:5632
    ds_read_b32 v115, v73 offset:5888
    s_lshl_b32 s6, s6, 7
    s_add_u32 s6, s6, 49152
    v_add_u32 v73, s6, v73
    s_waitcnt lgkmcnt(2)
    v_add_f32 v112, v112, v113
    s_waitcnt lgkmcnt(0)
    v_add_f32 v114, v114, v115
    v_add_f32 v112, v112, v114
    s_cmp_lg_u32 s3, 0
    s_cbranch_scc1 Lwp_skip_15520_421
    global_store_dword v73, v112, s[38:39] sc1
Lwp_skip_15520_421:
    s_branch Ldone_conv_kernel
Lrole_conv_kernel_0:
    s_sub_u32 s40, s40, 54
Ldone_conv_kernel:
Lend_conv_kernel:
    s_endpgm
.p2align 8
.globl g1_kernel
.type g1_kernel,@function
g1_kernel:
    s_cmp_ge_u32 s2, 256
    s_cbranch_scc1 Lend_g1_kernel
    s_load_dwordx16 s[8:23], s[0:1], 0
    s_load_dwordx16 s[24:39], s[0:1], 64
    v_lshrrev_b32 v2, 6, v0
    v_and_b32 v1, 63, v0
    v_readfirstlane_b32 s3, v2
    s_waitcnt lgkmcnt(0)
    s_and_b32 s4, s2, 7
    s_lshr_b32 s5, s2, 3
    s_lshr_b32 s60, s4, 1
    s_lshl_b32 s60, s60, 3
    s_lshr_b32 s6, s5, 2
    s_add_u32 s60, s60, s6
    s_and_b32 s61, s4, 1
    s_lshl_b32 s61, s61, 2
    s_and_b32 s6, s5, 3
    s_add_u32 s61, s61, s6
    v_and_b32 v2, 15, v1
    v_lshrrev_b32 v3, 4, v1
    v_and_b32 v4, 7, v1
    v_lshl_add_u32 v4, v3, 3, v4
    v_bfe_u32 v5, v1, 3, 1
    v_lshlrev_b32 v6, 14, v5
    v_lshl_add_u32 v6, v4, 4, v6
    s_lshl_b32 s4, s3, 15
    s_lshl_b32 s5, s60, 9
    s_add_u32 s4, s4, s5
    s_add_u32 s4, s4, 4194304
    v_add_u32 v6, s4, v6
    v_lshl_add_u32 v7, v4, 1, v5
    s_mul_i32 s40, s61, 7
    s_lshl_b32 s5, s3, 1
    s_add_u32 s40, s40, s5
    s_add_u32 s41, s40, 1
    s_cmp_eq_u32 s3, 3
    s_cselect_b32 s41, 55, s41
    s_mul_i32 s4, s40, 20480
    s_add_u32 s4, s4, 7344128
    v_lshl_add_u32 v8, v1, 4, s4
    s_mul_i32 s4, s41, 20480
    s_add_u32 s4, s4, 7344128
    v_lshl_add_u32 v9, v1, 4, s4
    global_load_dwordx4 v[12:15], v6, s[38:39] sc1
    v_add_u32 v6, 131072, v6
    global_load_dwordx4 v[16:19], v6, s[38:39] sc1
    v_add_u32 v6, 131072, v6
    global_load_dwordx4 v[20:23], v6, s[38:39] sc1
    v_add_u32 v6, 131072, v6
    global_load_dwordx4 v[24:27], v6, s[38:39] sc1
    v_add_u32 v6, 131072, v6
    global_load_dwordx4 v[28:31], v6, s[38:39] sc1
    v_add_u32 v6, 131072, v6
    global_load_dwordx4 v[32:35], v6, s[38:39] sc1
    v_add_u32 v6, 131072, v6
    global_load_dwordx4 v[36:39], v6, s[38:39] sc1
    v_add_u32 v6, 131072, v6
    global_load_dwordx4 v[40:43], v6, s[38:39] sc1
    v_add_u32 v6, 131072, v6
    global_load_dwordx4 v[44:47], v6, s[38:39] sc1
    v_add_u32 v6, 131072, v6
    global_load_dwordx4 v[48:51], v6, s[38:39] sc1
    v_add_u32 v6, 131072, v6
    global_load_dwordx4 v[52:55], v6, s[38:39] sc1
    v_add_u32 v6, 131072, v6
    global_load_dwordx4 v[56:59], v6, s[38:39] sc1
    v_add_u32 v6, 131072, v6
    global_load_dwordx4 v[60:63], v6, s[38:39] sc1
    v_add_u32 v6, 131072, v6
    global_load_dwordx4 v[64:67], v6, s[38:39] sc1
    v_add_u32 v6, 131072, v6
    global_load_dwordx4 v[68:71], v6, s[38:39] sc1
    v_add_u32 v6, 131072, v6
    global_load_dwordx4 v[72:75], v6, s[38:39] sc1
    v_add_u32 v6, 131072, v6
    global_load_dwordx4 v[76:79], v6, s[38:39] sc1
    v_add_u32 v6, 131072, v6
    global_load_dwordx4 v[80:83], v6, s[38:39] sc1
    v_add_u32 v6, 131072, v6
    global_load_dwordx4 v[84:87], v6, s[38:39] sc1
    v_add_u32 v6, 131072, v6
    global_load_dwordx4 v[88:91], v6, s[38:39] sc1
    v_add_u32 v6, 131072, v6
    global_load_dwordx4 a[0:3], v8, s[38:39] offset:-4096 sc1
    global_load_dwordx4 a[4:7], v9, s[38:39] offset:-4096 sc1
    global_load_dwordx4 a[8:11], v8, s[38:39] offset:-3072 sc1
    global_load_dwordx4 a[12:15], v9, s[38:39] offset:-3072 sc1
    global_load_dwordx4 a[16:19], v8, s[38:39] offset:-2048 sc1
    global_load_dwordx4 a[20:23], v9, s[38:39] offset:-2048 sc1
    global_load_dwordx4 a[24:27], v8, s[38:39] offset:-1024 sc1
    global_load_dwordx4 a[28:31], v9, s[38:39] offset:-1024 sc1
    global_load_dwordx4 a[32:35], v8, s[38:39] offset:0 sc1
    global_load_dwordx4 a[36:39], v9, s[38:39] offset:0 sc1
    global_load_dwordx4 a[40:43], v8, s[38:39] offset:1024 sc1
    global_load_dwordx4 a[44:47], v9, s[38:39] offset:1024 sc1
    global_load_dwordx4 a[48:51], v8, s[38:39] offset:2048 sc1
    global_load_dwordx4 a[52:55], v9, s[38:39] offset:2048 sc1
    global_load_dwordx4 a[56:59], v8, s[38:39] offset:3072 sc1
    global_load_dwordx4 a[60:63], v9, s[38:39] offset:3072 sc1
    v_add_u32 v8, 8192, v8
    v_add_u32 v9, 8192, v9
    global_load_dwordx4 a[64:67], v8, s[38:39] offset:-4096 sc1
    global_load_dwordx4 a[68:71], v9, s[38:39] offset:-4096 sc1
    global_load_dwordx4 a[72:75], v8, s[38:39] offset:-3072 sc1
    global_load_dwordx4 a[76:79], v9, s[38:39] offset:-3072 sc1
    global_load_dwordx4 a[80:83], v8, s[38:39] offset:-2048 sc1
    global_load_dwordx4 a[84:87], v9, s[38:39] offset:-2048 sc1
    global_load_dwordx4 a[88:91], v8, s[38:39] offset:-1024 sc1
    global_load_dwordx4 a[92:95], v9, s[38:39] offset:-1024 sc1
    global_load_dwordx4 a[96:99], v8, s[38:39] offset:0 sc1
    global_load_dwordx4 a[100:103], v9, s[38:39] offset:0 sc1
    global_load_dwordx4 a[104:107], v8, s[38:39] offset:1024 sc1
    global_load_dwordx4 a[108:111], v9, s[38:39] offset:1024 sc1
    global_load_dwordx4 a[112:115], v8, s[38:39] offset:2048 sc1
    global_load_dwordx4 a[116:119], v9, s[38:39] offset:2048 sc1
    global_load_dwordx4 a[120:123], v8, s[38:39] offset:3072 sc1
    global_load_dwordx4 a[124:127], v9, s[38:39] offset:3072 sc1
    v_add_u32 v8, 8192, v8
    v_add_u32 v9, 8192, v9
    global_load_dwordx4 a[128:131], v8, s[38:39] offset:-4096 sc1
    global_load_dwordx4 a[132:135], v9, s[38:39] offset:-4096 sc1
    global_load_dwordx4 a[136:139], v8, s[38:39] offset:-3072 sc1
    global_load_dwordx4 a[140:143], v9, s[38:39] offset:-3072 sc1
    global_load_dwordx4 a[144:147], v8, s[38:39] offset:-2048 sc1
    global_load_dwordx4 a[148:151], v9, s[38:39] offset:-2048 sc1
    global_load_dwordx4 a[152:155], v8, s[38:39] offset:-1024 sc1
    global_load_dwordx4 a[156:159], v9, s[38:39] offset:-1024 sc1
    v_add_u32 v8, 1130496, v8
    v_add_u32 v9, 1130496, v9
    s_lshl_b32 s4, s40, 7
    s_add_u32 s4, s4, 49152
    v_lshl_add_u32 v4, v2, 2, s4
    global_load_dword v92, v4, s[38:39] sc1
    global_load_dword v93, v4, s[38:39] offset:64 sc1
    s_add_u32 s4, s4, 7168
    v_lshl_add_u32 v4, v3, 4, s4
    global_load_dwordx4 v[96:99], v4, s[38:39] sc1
    global_load_dwordx4 v[100:103], v4, s[38:39] offset:64 sc1
    s_lshl_b32 s4, s41, 7
    s_add_u32 s4, s4, 49152
    v_lshl_add_u32 v4, v2, 2, s4
    global_load_dword v94, v4, s[38:39] sc1
    global_load_dword v95, v4, s[38:39] offset:64 sc1
    s_add_u32 s4, s4, 7168
    v_lshl_add_u32 v4, v3, 4, s4
    global_load_dwordx4 v[104:107], v4, s[38:39] sc1
    global_load_dwordx4 v[108:111], v4, s[38:39] offset:64 sc1
    v_lshrrev_b32 v4, 5, v1
    v_bfe_u32 v112, v1, 1, 1
    v_lshl_add_u32 v4, v4, 1, v112
    v_mul_u32_u24 v112, 1040, v4
    v_lshl_add_u32 v112, v5, 3, v112
    v_bfe_u32 v4, v1, 2, 1
    v_lshl_add_u32 v112, v4, 6, v112
    v_bfe_u32 v4, v1, 4, 1
    v_lshl_add_u32 v112, v4, 7, v112
    v_and_b32 v4, 1, v1
    v_lshl_add_u32 v112, v4, 5, v112
    s_lshl_b32 s4, s3, 8
    s_add_u32 s4, s4, 0
    v_add_u32 v112, s4, v112
    s_mov_b32 s7, 0x3f803f80
    v_mov_b32 v114, 0
    v_mov_b32 v115, 0
    v_mov_b32 v116, 0
    v_mov_b32 v117, 0
    s_waitcnt vmcnt(63)
    ds_write2_b64 v112, v[12:13], v[14:15] offset0:0 offset1:2
    v_add_u32 v112, 4160, v112
    v_dot2_f32_bf16 v114, v12, s7, v114
    v_dot2_f32_bf16 v115, v12, v12, v115
    v_dot2_f32_bf16 v116, v14, s7, v116
    v_dot2_f32_bf16 v117, v14, v14, v117
    v_dot2_f32_bf16 v114, v13, s7, v114
    v_dot2_f32_bf16 v115, v13, v13, v115
    v_dot2_f32_bf16 v116, v15, s7, v116
    v_dot2_f32_bf16 v117, v15, v15, v117
    ds_write2_b64 v112, v[16:17], v[18:19] offset0:0 offset1:2
    v_add_u32 v112, 4160, v112
    v_dot2_f32_bf16 v114, v16, s7, v114
    v_dot2_f32_bf16 v115, v16, v16, v115
    v_dot2_f32_bf16 v116, v18, s7, v116
    v_dot2_f32_bf16 v117, v18, v18, v117
    v_dot2_f32_bf16 v114, v17, s7, v114
    v_dot2_f32_bf16 v115, v17, v17, v115
    v_dot2_f32_bf16 v116, v19, s7, v116
    v_dot2_f32_bf16 v117, v19, v19, v117
    ds_write2_b64 v112, v[20:21], v[22:23] offset0:0 offset1:2
    v_add_u32 v112, 4160, v112
    v_dot2_f32_bf16 v114, v20, s7, v114
    v_dot2_f32_bf16 v115, v20, v20, v115
    v_dot2_f32_bf16 v116, v22, s7, v116
    v_dot2_f32_bf16 v117, v22, v22, v117
    v_dot2_f32_bf16 v114, v21, s7, v114
    v_dot2_f32_bf16 v115, v21, v21, v115
    v_dot2_f32_bf16 v116, v23, s7, v116
    v_dot2_f32_bf16 v117, v23, v23, v117
    ds_write2_b64 v112, v[24:25], v[26:27] offset0:0 offset1:2
    v_add_u32 v112, 4160, v112
    v_dot2_f32_bf16 v114, v24, s7, v114
    v_dot2_f32_bf16 v115, v24, v24, v115
    v_dot2_f32_bf16 v116, v26, s7, v116
    v_dot2_f32_bf16 v117, v26, v26, v117
    v_dot2_f32_bf16 v114, v25, s7, v114
    v_dot2_f32_bf16 v115, v25, v25, v115
    v_dot2_f32_bf16 v116, v27, s7, v116
    v_dot2_f32_bf16 v117, v27, v27, v117
    ds_write2_b64 v112, v[28:29], v[30:31] offset0:0 offset1:2
    v_add_u32 v112, 4160, v112
    v_dot2_f32_bf16 v114, v28, s7, v114
    v_dot2_f32_bf16 v115, v28, v28, v115
    v_dot2_f32_bf16 v116, v30, s7, v116
    v_dot2_f32_bf16 v117, v30, v30, v117
    v_dot2_f32_bf16 v114, v29, s7, v114
    v_dot2_f32_bf16 v115, v29, v29, v115
    v_dot2_f32_bf16 v116, v31, s7, v116
    v_dot2_f32_bf16 v117, v31, v31, v117
    s_waitcnt vmcnt(62)
    ds_write2_b64 v112, v[32:33], v[34:35] offset0:0 offset1:2
    v_add_u32 v112, 4160, v112
    v_dot2_f32_bf16 v114, v32, s7, v114
    v_dot2_f32_bf16 v115, v32, v32, v115
    v_dot2_f32_bf16 v116, v34, s7, v116
    v_dot2_f32_bf16 v117, v34, v34, v117
    v_dot2_f32_bf16 v114, v33, s7, v114
    v_dot2_f32_bf16 v115, v33, v33, v115
    v_dot2_f32_bf16 v116, v35, s7, v116
    v_dot2_f32_bf16 v117, v35, v35, v117
    s_waitcnt vmcnt(61)
    ds_write2_b64 v112, v[36:37], v[38:39] offset0:0 offset1:2
    v_add_u32 v112, 4160, v112
    v_dot2_f32_bf16 v114, v36, s7, v114
    v_dot2_f32_bf16 v115, v36, v36, v115
    v_dot2_f32_bf16 v116, v38, s7, v116
    v_dot2_f32_bf16 v117, v38, v38, v117
    v_dot2_f32_bf16 v114, v37, s7, v114
    v_dot2_f32_bf16 v115, v37, v37, v115
    v_dot2_f32_bf16 v116, v39, s7, v116
    v_dot2_f32_bf16 v117, v39, v39, v117
    s_waitcnt vmcnt(60)
    ds_write2_b64 v112, v[40:41], v[42:43] offset0:0 offset1:2
    v_add_u32 v112, 4160, v112
    v_dot2_f32_bf16 v114, v40, s7, v114
    v_dot2_f32_bf16 v115, v40, v40, v115
    v_dot2_f32_bf16 v116, v42, s7, v116
    v_dot2_f32_bf16 v117, v42, v42, v117
    v_dot2_f32_bf16 v114, v41, s7, v114
    v_dot2_f32_bf16 v115, v41, v41, v115
    v_dot2_f32_bf16 v116, v43, s7, v116
    v_dot2_f32_bf16 v117, v43, v43, v117
    s_waitcnt vmcnt(59)
    ds_write2_b64 v112, v[44:45], v[46:47] offset0:0 offset1:2
    v_add_u32 v112, 4160, v112
    v_dot2_f32_bf16 v114, v44, s7, v114
    v_dot2_f32_bf16 v115, v44, v44, v115
    v_dot2_f32_bf16 v116, v46, s7, v116
    v_dot2_f32_bf16 v117, v46, v46, v117
    v_dot2_f32_bf16 v114, v45, s7, v114
    v_dot2_f32_bf16 v115, v45, v45, v115
    v_dot2_f32_bf16 v116, v47, s7, v116
    v_dot2_f32_bf16 v117, v47, v47, v117
    s_waitcnt vmcnt(58)
    ds_write2_b64 v112, v[48:49], v[50:51] offset0:0 offset1:2
    v_add_u32 v112, 4160, v112
    v_dot2_f32_bf16 v114, v48, s7, v114
    v_dot2_f32_bf16 v115, v48, v48, v115
    v_dot2_f32_bf16 v116, v50, s7, v116
    v_dot2_f32_bf16 v117, v50, v50, v117
    v_dot2_f32_bf16 v114, v49, s7, v114
    v_dot2_f32_bf16 v115, v49, v49, v115
    v_dot2_f32_bf16 v116, v51, s7, v116
    v_dot2_f32_bf16 v117, v51, v51, v117
    s_waitcnt vmcnt(57)
    ds_write2_b64 v112, v[52:53], v[54:55] offset0:0 offset1:2
    v_add_u32 v112, 4160, v112
    v_dot2_f32_bf16 v114, v52, s7, v114
    v_dot2_f32_bf16 v115, v52, v52, v115
    v_dot2_f32_bf16 v116, v54, s7, v116
    v_dot2_f32_bf16 v117, v54, v54, v117
    v_dot2_f32_bf16 v114, v53, s7, v114
    v_dot2_f32_bf16 v115, v53, v53, v115
    v_dot2_f32_bf16 v116, v55, s7, v116
    v_dot2_f32_bf16 v117, v55, v55, v117
    s_waitcnt vmcnt(56)
    ds_write2_b64 v112, v[56:57], v[58:59] offset0:0 offset1:2
    v_add_u32 v112, 4160, v112
    v_dot2_f32_bf16 v114, v56, s7, v114
    v_dot2_f32_bf16 v115, v56, v56, v115
    v_dot2_f32_bf16 v116, v58, s7, v116
    v_dot2_f32_bf16 v117, v58, v58, v117
    v_dot2_f32_bf16 v114, v57, s7, v114
    v_dot2_f32_bf16 v115, v57, v57, v115
    v_dot2_f32_bf16 v116, v59, s7, v116
    v_dot2_f32_bf16 v117, v59, v59, v117
    s_waitcnt vmcnt(55)
    ds_write2_b64 v112, v[60:61], v[62:63] offset0:0 offset1:2
    v_add_u32 v112, 4160, v112
    v_dot2_f32_bf16 v114, v60, s7, v114
    v_dot2_f32_bf16 v115, v60, v60, v115
    v_dot2_f32_bf16 v116, v62, s7, v116
    v_dot2_f32_bf16 v117, v62, v62, v117
    v_dot2_f32_bf16 v114, v61, s7, v114
    v_dot2_f32_bf16 v115, v61, v61, v115
    v_dot2_f32_bf16 v116, v63, s7, v116
    v_dot2_f32_bf16 v117, v63, v63, v117
    s_waitcnt vmcnt(54)
    ds_write2_b64 v112, v[64:65], v[66:67] offset0:0 offset1:2
    v_add_u32 v112, 4160, v112
    v_dot2_f32_bf16 v114, v64, s7, v114
    v_dot2_f32_bf16 v115, v64, v64, v115
    v_dot2_f32_bf16 v116, v66, s7, v116
    v_dot2_f32_bf16 v117, v66, v66, v117
    v_dot2_f32_bf16 v114, v65, s7, v114
    v_dot2_f32_bf16 v115, v65, v65, v115
    v_dot2_f32_bf16 v116, v67, s7, v116
    v_dot2_f32_bf16 v117, v67, v67, v117
    s_waitcnt vmcnt(53)
    ds_write2_b64 v112, v[68:69], v[70:71] offset0:0 offset1:2
    v_add_u32 v112, 4160, v112
    v_dot2_f32_bf16 v114, v68, s7, v114
    v_dot2_f32_bf16 v115, v68, v68, v115
    v_dot2_f32_bf16 v116, v70, s7, v116
    v_dot2_f32_bf16 v117, v70, v70, v117
    v_dot2_f32_bf16 v114, v69, s7, v114
    v_dot2_f32_bf16 v115, v69, v69, v115
    v_dot2_f32_bf16 v116, v71, s7, v116
    v_dot2_f32_bf16 v117, v71, v71, v117
    s_waitcnt vmcnt(52)
    ds_write2_b64 v112, v[72:73], v[74:75] offset0:0 offset1:2
    v_add_u32 v112, 4160, v112
    v_dot2_f32_bf16 v114, v72, s7, v114
    v_dot2_f32_bf16 v115, v72, v72, v115
    v_dot2_f32_bf16 v116, v74, s7, v116
    v_dot2_f32_bf16 v117, v74, v74, v117
    v_dot2_f32_bf16 v114, v73, s7, v114
    v_dot2_f32_bf16 v115, v73, v73, v115
    v_dot2_f32_bf16 v116, v75, s7, v116
    v_dot2_f32_bf16 v117, v75, v75, v117
    s_waitcnt vmcnt(51)
    ds_write2_b64 v112, v[76:77], v[78:79] offset0:0 offset1:2
    v_add_u32 v112, 4160, v112
    v_dot2_f32_bf16 v114, v76, s7, v114
    v_dot2_f32_bf16 v115, v76, v76, v115
    v_dot2_f32_bf16 v116, v78, s7, v116
    v_dot2_f32_bf16 v117, v78, v78, v117
    v_dot2_f32_bf16 v114, v77, s7, v114
    v_dot2_f32_bf16 v115, v77, v77, v115
    v_dot2_f32_bf16 v116, v79, s7, v116
    v_dot2_f32_bf16 v117, v79, v79, v117
    s_waitcnt vmcnt(50)
    ds_write2_b64 v112, v[80:81], v[82:83] offset0:0 offset1:2
    v_add_u32 v112, 4160, v112
    v_dot2_f32_bf16 v114, v80, s7, v114
    v_dot2_f32_bf16 v115, v80, v80, v115
    v_dot2_f32_bf16 v116, v82, s7, v116
    v_dot2_f32_bf16 v117, v82, v82, v117
    v_dot2_f32_bf16 v114, v81, s7, v114
    v_dot2_f32_bf16 v115, v81, v81, v115
    v_dot2_f32_bf16 v116, v83, s7, v116
    v_dot2_f32_bf16 v117, v83, v83, v117
    s_waitcnt vmcnt(49)
    ds_write2_b64 v112, v[84:85], v[86:87] offset0:0 offset1:2
    v_add_u32 v112, 4160, v112
    v_dot2_f32_bf16 v114, v84, s7, v114
    v_dot2_f32_bf16 v115, v84, v84, v115
    v_dot2_f32_bf16 v116, v86, s7, v116
    v_dot2_f32_bf16 v117, v86, v86, v117
    v_dot2_f32_bf16 v114, v85, s7, v114
    v_dot2_f32_bf16 v115, v85, v85, v115
    v_dot2_f32_bf16 v116, v87, s7, v116
    v_dot2_f32_bf16 v117, v87, v87, v117
    s_waitcnt vmcnt(48)
    ds_write2_b64 v112, v[88:89], v[90:91] offset0:0 offset1:2
    v_add_u32 v112, 4160, v112
    v_dot2_f32_bf16 v114, v88, s7, v114
    v_dot2_f32_bf16 v115, v88, v88, v115
    v_dot2_f32_bf16 v116, v90, s7, v116
    v_dot2_f32_bf16 v117, v90, v90, v117
    v_dot2_f32_bf16 v114, v89, s7, v114
    v_dot2_f32_bf16 v115, v89, v89, v115
    v_dot2_f32_bf16 v116, v91, s7, v116
    v_dot2_f32_bf16 v117, v91, v91, v117
    v_add_f32_dpp v118, v114, v114 row_ror:8 row_mask:0xf bank_mask:0x3
    s_nop 1
    v_add_f32_dpp v118, v116, v116 row_ror:8 row_mask:0xf bank_mask:0xc
    v_add_f32_dpp v119, v115, v115 row_ror:8 row_mask:0xf bank_mask:0x3
    s_nop 1
    v_add_f32_dpp v119, v117, v117 row_ror:8 row_mask:0xf bank_mask:0xc
    s_lshl_b32 s42, s3, 9
    v_lshl_add_u32 v4, v7, 3, s42
    v_add_u32 v4, 83200, v4
    ds_write_b64 v4, v[118:119]
    s_waitcnt lgkmcnt(0)
    s_barrier
    v_lshlrev_b32 v126, 3, v1
    v_add_u32 v4, 83200, v126
    ds_read_b64 v[118:119], v4 offset:0
    ds_read_b64 v[120:121], v4 offset:512
    ds_read_b64 v[122:123], v4 offset:1024
    ds_read_b64 v[124:125], v4 offset:1536
    s_waitcnt lgkmcnt(2)
    v_pk_add_f32 v[118:119], v[118:119], v[120:121] op_sel:[0,0] op_sel_hi:[1,1]
    s_waitcnt lgkmcnt(0)
    v_pk_add_f32 v[122:123], v[122:123], v[124:125] op_sel:[0,0] op_sel_hi:[1,1]
    v_pk_add_f32 v[118:119], v[118:119], v[122:123] op_sel:[0,0] op_sel_hi:[1,1]
    v_mul_f32 v118, 0x3acccccd, v118
    v_mul_f32 v119, 0x3acccccd, v119
    v_fma_f32 v119, -v118, v118, v119
    v_max_f32 v119, 0, v119
    v_add_f32 v119, 0x3727c5ac, v119
    v_rsq_f32 v120, v119
    s_nop 0
    v_mul_f32_e64 v119, -v118, v120
    v_mov_b32 v118, v120
    s_add_u32 s43, s42, 85248
    v_lshl_add_u32 v127, v1, 2, s43
    v_lshl_add_u32 v128, v3, 5, s43
    v_lshrrev_b32 v4, 2, v2
    v_and_b32 v129, 3, v2
    v_lshl_add_u32 v129, v4, 3, v129
    v_lshl_add_u32 v129, v129, 2, s43
    ds_write2st64_b32 v127, v118, v119 offset0:0 offset1:1
    v_lshlrev_b32 v228, 4, v1
    v_add_u32 v229, 41600, v228
    ds_read_b128 v[12:15], v128 offset:0
    ds_read_b128 v[16:19], v128 offset:16
    ds_read_b128 v[20:23], v128 offset:128
    ds_read_b128 v[24:27], v128 offset:144
    ds_read_b128 v[28:31], v128 offset:256
    ds_read_b128 v[32:35], v128 offset:272
    ds_read_b128 v[36:39], v128 offset:384
    ds_read_b128 v[40:43], v128 offset:400
    ds_read2st64_b32 v[76:77], v129 offset0:0 offset1:1
    ds_read_b32 v78, v129 offset:16
    ds_read_b32 v79, v129 offset:272
    ds_read_b32 v80, v129 offset:128
    ds_read_b32 v81, v129 offset:384
    ds_read_b32 v82, v129 offset:144
    ds_read_b32 v83, v129 offset:400
    s_mov_b32 s44, 0xc0135761
    s_mov_b32 s45, 0xbdd2d3e8
    ds_read_b128 v[196:199], v228 offset:0
    ds_read_b128 v[200:203], v228 offset:1040
    ds_read_b128 v[204:207], v228 offset:2080
    ds_read_b128 v[208:211], v228 offset:3120
    ds_read_b128 v[212:215], v228 offset:4160
    ds_read_b128 v[216:219], v228 offset:5200
    ds_read_b128 v[220:223], v228 offset:6240
    ds_read_b128 v[224:227], v228 offset:7280
    s_waitcnt vmcnt(47) lgkmcnt(7)
    v_mfma_f32_16x16x32_bf16 v[132:135], v[196:199], a[0:3], 0
    s_waitcnt vmcnt(46)
    v_mfma_f32_16x16x32_bf16 v[148:151], v[196:199], a[4:7], 0
    s_waitcnt lgkmcnt(6)
    v_mfma_f32_16x16x32_bf16 v[136:139], v[200:203], a[0:3], 0
    v_mfma_f32_16x16x32_bf16 v[152:155], v[200:203], a[4:7], 0
    s_waitcnt lgkmcnt(5)
    v_mfma_f32_16x16x32_bf16 v[140:143], v[204:207], a[0:3], 0
    v_mfma_f32_16x16x32_bf16 v[156:159], v[204:207], a[4:7], 0
    s_waitcnt lgkmcnt(4)
    v_mfma_f32_16x16x32_bf16 v[144:147], v[208:211], a[0:3], 0
    v_mfma_f32_16x16x32_bf16 v[160:163], v[208:211], a[4:7], 0
    global_load_dwordx4 a[0:3], v8, s[38:39] offset:-4096 sc1
    global_load_dwordx4 a[4:7], v9, s[38:39] offset:-4096 sc1
    ds_read_b128 v[196:199], v228 offset:8320
    ds_read_b128 v[200:203], v228 offset:9360
    ds_read_b128 v[204:207], v228 offset:10400
    ds_read_b128 v[208:211], v228 offset:11440
    s_waitcnt vmcnt(47) lgkmcnt(7)
    v_mfma_f32_16x16x32_bf16 v[132:135], v[212:215], a[8:11], v[132:135]
    s_waitcnt vmcnt(46)
    v_mfma_f32_16x16x32_bf16 v[148:151], v[212:215], a[12:15], v[148:151]
    s_waitcnt lgkmcnt(6)
    v_mfma_f32_16x16x32_bf16 v[136:139], v[216:219], a[8:11], v[136:139]
    v_mfma_f32_16x16x32_bf16 v[152:155], v[216:219], a[12:15], v[152:155]
    s_waitcnt lgkmcnt(5)
    v_mfma_f32_16x16x32_bf16 v[140:143], v[220:223], a[8:11], v[140:143]
    v_mfma_f32_16x16x32_bf16 v[156:159], v[220:223], a[12:15], v[156:159]
    s_waitcnt lgkmcnt(4)
    v_mfma_f32_16x16x32_bf16 v[144:147], v[224:227], a[8:11], v[144:147]
    v_mfma_f32_16x16x32_bf16 v[160:163], v[224:227], a[12:15], v[160:163]
    global_load_dwordx4 a[8:11], v8, s[38:39] offset:-3072 sc1
    global_load_dwordx4 a[12:15], v9, s[38:39] offset:-3072 sc1
    ds_read_b128 v[212:215], v228 offset:12480
    ds_read_b128 v[216:219], v228 offset:13520
    ds_read_b128 v[220:223], v228 offset:14560
    ds_read_b128 v[224:227], v228 offset:15600
    s_waitcnt vmcnt(47) lgkmcnt(7)
    v_mfma_f32_16x16x32_bf16 v[132:135], v[196:199], a[16:19], v[132:135]
    s_waitcnt vmcnt(46)
    v_mfma_f32_16x16x32_bf16 v[148:151], v[196:199], a[20:23], v[148:151]
    s_waitcnt lgkmcnt(6)
    v_mfma_f32_16x16x32_bf16 v[136:139], v[200:203], a[16:19], v[136:139]
    v_mfma_f32_16x16x32_bf16 v[152:155], v[200:203], a[20:23], v[152:155]
    s_waitcnt lgkmcnt(5)
    v_mfma_f32_16x16x32_bf16 v[140:143], v[204:207], a[16:19], v[140:143]
    v_mfma_f32_16x16x32_bf16 v[156:159], v[204:207], a[20:23], v[156:159]
    s_waitcnt lgkmcnt(4)
    v_mfma_f32_16x16x32_bf16 v[144:147], v[208:211], a[16:19], v[144:147]
    v_mfma_f32_16x16x32_bf16 v[160:163], v[208:211], a[20:23], v[160:163]
    global_load_dwordx4 a[16:19], v8, s[38:39] offset:-2048 sc1
    global_load_dwordx4 a[20:23], v9, s[38:39] offset:-2048 sc1
    ds_read_b128 v[196:199], v228 offset:16640
    ds_read_b128 v[200:203], v228 offset:17680
    ds_read_b128 v[204:207], v228 offset:18720
    ds_read_b128 v[208:211], v228 offset:19760
    s_waitcnt vmcnt(47) lgkmcnt(7)
    v_mfma_f32_16x16x32_bf16 v[132:135], v[212:215], a[24:27], v[132:135]
    s_waitcnt vmcnt(46)
    v_mfma_f32_16x16x32_bf16 v[148:151], v[212:215], a[28:31], v[148:151]
    s_waitcnt lgkmcnt(6)
    v_mfma_f32_16x16x32_bf16 v[136:139], v[216:219], a[24:27], v[136:139]
    v_mfma_f32_16x16x32_bf16 v[152:155], v[216:219], a[28:31], v[152:155]
    s_waitcnt lgkmcnt(5)
    v_mfma_f32_16x16x32_bf16 v[140:143], v[220:223], a[24:27], v[140:143]
    v_mfma_f32_16x16x32_bf16 v[156:159], v[220:223], a[28:31], v[156:159]
    s_waitcnt lgkmcnt(4)
    v_mfma_f32_16x16x32_bf16 v[144:147], v[224:227], a[24:27], v[144:147]
    v_mfma_f32_16x16x32_bf16 v[160:163], v[224:227], a[28:31], v[160:163]
    global_load_dwordx4 a[24:27], v8, s[38:39] offset:-1024 sc1
    global_load_dwordx4 a[28:31], v9, s[38:39] offset:-1024 sc1
    ds_read_b128 v[212:215], v228 offset:20800
    ds_read_b128 v[216:219], v228 offset:21840
    ds_read_b128 v[220:223], v228 offset:22880
    ds_read_b128 v[224:227], v228 offset:23920
    s_waitcnt vmcnt(47) lgkmcnt(7)
    v_mfma_f32_16x16x32_bf16 v[132:135], v[196:199], a[32:35], v[132:135]
    s_waitcnt vmcnt(46)
    v_mfma_f32_16x16x32_bf16 v[148:151], v[196:199], a[36:39], v[148:151]
    s_waitcnt lgkmcnt(6)
    v_mfma_f32_16x16x32_bf16 v[136:139], v[200:203], a[32:35], v[136:139]
    v_mfma_f32_16x16x32_bf16 v[152:155], v[200:203], a[36:39], v[152:155]
    s_waitcnt lgkmcnt(5)
    v_mfma_f32_16x16x32_bf16 v[140:143], v[204:207], a[32:35], v[140:143]
    v_mfma_f32_16x16x32_bf16 v[156:159], v[204:207], a[36:39], v[156:159]
    s_waitcnt lgkmcnt(4)
    v_mfma_f32_16x16x32_bf16 v[144:147], v[208:211], a[32:35], v[144:147]
    v_mfma_f32_16x16x32_bf16 v[160:163], v[208:211], a[36:39], v[160:163]
    global_load_dwordx4 a[32:35], v8, s[38:39] offset:0 sc1
    global_load_dwordx4 a[36:39], v9, s[38:39] offset:0 sc1
    ds_read_b128 v[196:199], v228 offset:24960
    ds_read_b128 v[200:203], v228 offset:26000
    ds_read_b128 v[204:207], v228 offset:27040
    ds_read_b128 v[208:211], v228 offset:28080
    s_waitcnt vmcnt(47) lgkmcnt(7)
    v_mfma_f32_16x16x32_bf16 v[132:135], v[212:215], a[40:43], v[132:135]
    s_waitcnt vmcnt(46)
    v_mfma_f32_16x16x32_bf16 v[148:151], v[212:215], a[44:47], v[148:151]
    s_waitcnt lgkmcnt(6)
    v_mfma_f32_16x16x32_bf16 v[136:139], v[216:219], a[40:43], v[136:139]
    v_mfma_f32_16x16x32_bf16 v[152:155], v[216:219], a[44:47], v[152:155]
    s_waitcnt lgkmcnt(5)
    v_mfma_f32_16x16x32_bf16 v[140:143], v[220:223], a[40:43], v[140:143]
    v_mfma_f32_16x16x32_bf16 v[156:159], v[220:223], a[44:47], v[156:159]
    s_waitcnt lgkmcnt(4)
    v_mfma_f32_16x16x32_bf16 v[144:147], v[224:227], a[40:43], v[144:147]
    v_mfma_f32_16x16x32_bf16 v[160:163], v[224:227], a[44:47], v[160:163]
    global_load_dwordx4 a[40:43], v8, s[38:39] offset:1024 sc1
    global_load_dwordx4 a[44:47], v9, s[38:39] offset:1024 sc1
    ds_read_b128 v[212:215], v228 offset:29120
    ds_read_b128 v[216:219], v228 offset:30160
    ds_read_b128 v[220:223], v228 offset:31200
    ds_read_b128 v[224:227], v228 offset:32240
    s_waitcnt vmcnt(47) lgkmcnt(7)
    v_mfma_f32_16x16x32_bf16 v[132:135], v[196:199], a[48:51], v[132:135]
    s_waitcnt vmcnt(46)
    v_mfma_f32_16x16x32_bf16 v[148:151], v[196:199], a[52:55], v[148:151]
    s_waitcnt lgkmcnt(6)
    v_mfma_f32_16x16x32_bf16 v[136:139], v[200:203], a[48:51], v[136:139]
    v_mfma_f32_16x16x32_bf16 v[152:155], v[200:203], a[52:55], v[152:155]
    s_waitcnt lgkmcnt(5)
    v_mfma_f32_16x16x32_bf16 v[140:143], v[204:207], a[48:51], v[140:143]
    v_mfma_f32_16x16x32_bf16 v[156:159], v[204:207], a[52:55], v[156:159]
    s_waitcnt lgkmcnt(4)
    v_mfma_f32_16x16x32_bf16 v[144:147], v[208:211], a[48:51], v[144:147]
    v_mfma_f32_16x16x32_bf16 v[160:163], v[208:211], a[52:55], v[160:163]
    global_load_dwordx4 a[48:51], v8, s[38:39] offset:2048 sc1
    global_load_dwordx4 a[52:55], v9, s[38:39] offset:2048 sc1
    ds_read_b128 v[196:199], v228 offset:33280
    ds_read_b128 v[200:203], v228 offset:34320
    ds_read_b128 v[204:207], v228 offset:35360
    ds_read_b128 v[208:211], v228 offset:36400
    s_waitcnt vmcnt(47) lgkmcnt(7)
    v_mfma_f32_16x16x32_bf16 v[132:135], v[212:215], a[56:59], v[132:135]
    s_waitcnt vmcnt(46)
    v_mfma_f32_16x16x32_bf16 v[148:151], v[212:215], a[60:63], v[148:151]
    s_waitcnt lgkmcnt(6)
    v_mfma_f32_16x16x32_bf16 v[136:139], v[216:219], a[56:59], v[136:139]
    v_mfma_f32_16x16x32_bf16 v[152:155], v[216:219], a[60:63], v[152:155]
    s_waitcnt lgkmcnt(5)
    v_mfma_f32_16x16x32_bf16 v[140:143], v[220:223], a[56:59], v[140:143]
    v_mfma_f32_16x16x32_bf16 v[156:159], v[220:223], a[60:63], v[156:159]
    s_waitcnt lgkmcnt(4)
    v_mfma_f32_16x16x32_bf16 v[144:147], v[224:227], a[56:59], v[144:147]
    v_mfma_f32_16x16x32_bf16 v[160:163], v[224:227], a[60:63], v[160:163]
    global_load_dwordx4 a[56:59], v8, s[38:39] offset:3072 sc1
    global_load_dwordx4 a[60:63], v9, s[38:39] offset:3072 sc1
    v_add_u32 v8, 8192, v8
    v_add_u32 v9, 8192, v9
    ds_read_b128 v[212:215], v228 offset:37440
    ds_read_b128 v[216:219], v228 offset:38480
    ds_read_b128 v[220:223], v228 offset:39520
    ds_read_b128 v[224:227], v228 offset:40560
    s_waitcnt vmcnt(47) lgkmcnt(7)
    v_mfma_f32_16x16x32_bf16 v[132:135], v[196:199], a[64:67], v[132:135]
    s_waitcnt vmcnt(46)
    v_mfma_f32_16x16x32_bf16 v[148:151], v[196:199], a[68:71], v[148:151]
    s_waitcnt lgkmcnt(6)
    v_mfma_f32_16x16x32_bf16 v[136:139], v[200:203], a[64:67], v[136:139]
    v_mfma_f32_16x16x32_bf16 v[152:155], v[200:203], a[68:71], v[152:155]
    s_waitcnt lgkmcnt(5)
    v_mfma_f32_16x16x32_bf16 v[140:143], v[204:207], a[64:67], v[140:143]
    v_mfma_f32_16x16x32_bf16 v[156:159], v[204:207], a[68:71], v[156:159]
    s_waitcnt lgkmcnt(4)
    v_mfma_f32_16x16x32_bf16 v[144:147], v[208:211], a[64:67], v[144:147]
    v_mfma_f32_16x16x32_bf16 v[160:163], v[208:211], a[68:71], v[160:163]
    global_load_dwordx4 a[64:67], v8, s[38:39] offset:-4096 sc1
    global_load_dwordx4 a[68:71], v9, s[38:39] offset:-4096 sc1
    ds_read_b128 v[196:199], v229 offset:0
    ds_read_b128 v[200:203], v229 offset:1040
    ds_read_b128 v[204:207], v229 offset:2080
    ds_read_b128 v[208:211], v229 offset:3120
    s_waitcnt vmcnt(47) lgkmcnt(7)
    v_mfma_f32_16x16x32_bf16 v[132:135], v[212:215], a[72:75], v[132:135]
    s_waitcnt vmcnt(46)
    v_mfma_f32_16x16x32_bf16 v[148:151], v[212:215], a[76:79], v[148:151]
    s_waitcnt lgkmcnt(6)
    v_mfma_f32_16x16x32_bf16 v[136:139], v[216:219], a[72:75], v[136:139]
    v_mfma_f32_16x16x32_bf16 v[152:155], v[216:219], a[76:79], v[152:155]
    s_waitcnt lgkmcnt(5)
    v_mfma_f32_16x16x32_bf16 v[140:143], v[220:223], a[72:75], v[140:143]
    v_mfma_f32_16x16x32_bf16 v[156:159], v[220:223], a[76:79], v[156:159]
    s_waitcnt lgkmcnt(4)
    v_mfma_f32_16x16x32_bf16 v[144:147], v[224:227], a[72:75], v[144:147]
    v_mfma_f32_16x16x32_bf16 v[160:163], v[224:227], a[76:79], v[160:163]
    global_load_dwordx4 a[72:75], v8, s[38:39] offset:-3072 sc1
    global_load_dwordx4 a[76:79], v9, s[38:39] offset:-3072 sc1
    ds_read_b128 v[212:215], v229 offset:4160
    ds_read_b128 v[216:219], v229 offset:5200
    ds_read_b128 v[220:223], v229 offset:6240
    ds_read_b128 v[224:227], v229 offset:7280
    s_waitcnt vmcnt(47) lgkmcnt(7)
    v_mfma_f32_16x16x32_bf16 v[132:135], v[196:199], a[80:83], v[132:135]
    s_waitcnt vmcnt(46)
    v_mfma_f32_16x16x32_bf16 v[148:151], v[196:199], a[84:87], v[148:151]
    s_waitcnt lgkmcnt(6)
    v_mfma_f32_16x16x32_bf16 v[136:139], v[200:203], a[80:83], v[136:139]
    v_mfma_f32_16x16x32_bf16 v[152:155], v[200:203], a[84:87], v[152:155]
    s_waitcnt lgkmcnt(5)
    v_mfma_f32_16x16x32_bf16 v[140:143], v[204:207], a[80:83], v[140:143]
    v_mfma_f32_16x16x32_bf16 v[156:159], v[204:207], a[84:87], v[156:159]
    s_waitcnt lgkmcnt(4)
    v_mfma_f32_16x16x32_bf16 v[144:147], v[208:211], a[80:83], v[144:147]
    v_mfma_f32_16x16x32_bf16 v[160:163], v[208:211], a[84:87], v[160:163]
    global_load_dwordx4 a[80:83], v8, s[38:39] offset:-2048 sc1
    global_load_dwordx4 a[84:87], v9, s[38:39] offset:-2048 sc1
    ds_read_b128 v[196:199], v229 offset:8320
    ds_read_b128 v[200:203], v229 offset:9360
    ds_read_b128 v[204:207], v229 offset:10400
    ds_read_b128 v[208:211], v229 offset:11440
    s_waitcnt vmcnt(47) lgkmcnt(7)
    v_mfma_f32_16x16x32_bf16 v[132:135], v[212:215], a[88:91], v[132:135]
    s_waitcnt vmcnt(46)
    v_mfma_f32_16x16x32_bf16 v[148:151], v[212:215], a[92:95], v[148:151]
    s_waitcnt lgkmcnt(6)
    v_mfma_f32_16x16x32_bf16 v[136:139], v[216:219], a[88:91], v[136:139]
    v_mfma_f32_16x16x32_bf16 v[152:155], v[216:219], a[92:95], v[152:155]
    s_waitcnt lgkmcnt(5)
    v_mfma_f32_16x16x32_bf16 v[140:143], v[220:223], a[88:91], v[140:143]
    v_mfma_f32_16x16x32_bf16 v[156:159], v[220:223], a[92:95], v[156:159]
    s_waitcnt lgkmcnt(4)
    v_mfma_f32_16x16x32_bf16 v[144:147], v[224:227], a[88:91], v[144:147]
    v_mfma_f32_16x16x32_bf16 v[160:163], v[224:227], a[92:95], v[160:163]
    global_load_dwordx4 a[88:91], v8, s[38:39] offset:-1024 sc1
    global_load_dwordx4 a[92:95], v9, s[38:39] offset:-1024 sc1
    ds_read_b128 v[212:215], v229 offset:12480
    ds_read_b128 v[216:219], v229 offset:13520
    ds_read_b128 v[220:223], v229 offset:14560
    ds_read_b128 v[224:227], v229 offset:15600
    s_waitcnt vmcnt(47) lgkmcnt(7)
    v_mfma_f32_16x16x32_bf16 v[132:135], v[196:199], a[96:99], v[132:135]
    s_waitcnt vmcnt(46)
    v_mfma_f32_16x16x32_bf16 v[148:151], v[196:199], a[100:103], v[148:151]
    s_waitcnt lgkmcnt(6)
    v_mfma_f32_16x16x32_bf16 v[136:139], v[200:203], a[96:99], v[136:139]
    v_mfma_f32_16x16x32_bf16 v[152:155], v[200:203], a[100:103], v[152:155]
    s_waitcnt lgkmcnt(5)
    v_mfma_f32_16x16x32_bf16 v[140:143], v[204:207], a[96:99], v[140:143]
    v_mfma_f32_16x16x32_bf16 v[156:159], v[204:207], a[100:103], v[156:159]
    s_waitcnt lgkmcnt(4)
    v_mfma_f32_16x16x32_bf16 v[144:147], v[208:211], a[96:99], v[144:147]
    v_mfma_f32_16x16x32_bf16 v[160:163], v[208:211], a[100:103], v[160:163]
    global_load_dwordx4 a[96:99], v8, s[38:39] offset:0 sc1
    global_load_dwordx4 a[100:103], v9, s[38:39] offset:0 sc1
    ds_read_b128 v[196:199], v229 offset:16640
    ds_read_b128 v[200:203], v229 offset:17680
    ds_read_b128 v[204:207], v229 offset:18720
    ds_read_b128 v[208:211], v229 offset:19760
    s_waitcnt vmcnt(47) lgkmcnt(7)
    v_mfma_f32_16x16x32_bf16 v[132:135], v[212:215], a[104:107], v[132:135]
    s_waitcnt vmcnt(46)
    v_mfma_f32_16x16x32_bf16 v[148:151], v[212:215], a[108:111], v[148:151]
    s_waitcnt lgkmcnt(6)
    v_mfma_f32_16x16x32_bf16 v[136:139], v[216:219], a[104:107], v[136:139]
    v_mfma_f32_16x16x32_bf16 v[152:155], v[216:219], a[108:111], v[152:155]
    s_waitcnt lgkmcnt(5)
    v_mfma_f32_16x16x32_bf16 v[140:143], v[220:223], a[104:107], v[140:143]
    v_mfma_f32_16x16x32_bf16 v[156:159], v[220:223], a[108:111], v[156:159]
    s_waitcnt lgkmcnt(4)
    v_mfma_f32_16x16x32_bf16 v[144:147], v[224:227], a[104:107], v[144:147]
    v_mfma_f32_16x16x32_bf16 v[160:163], v[224:227], a[108:111], v[160:163]
    global_load_dwordx4 a[104:107], v8, s[38:39] offset:1024 sc1
    global_load_dwordx4 a[108:111], v9, s[38:39] offset:1024 sc1
    ds_read_b128 v[212:215], v229 offset:20800
    ds_read_b128 v[216:219], v229 offset:21840
    ds_read_b128 v[220:223], v229 offset:22880
    ds_read_b128 v[224:227], v229 offset:23920
    s_waitcnt vmcnt(47) lgkmcnt(7)
    v_mfma_f32_16x16x32_bf16 v[132:135], v[196:199], a[112:115], v[132:135]
    s_waitcnt vmcnt(46)
    v_mfma_f32_16x16x32_bf16 v[148:151], v[196:199], a[116:119], v[148:151]
    s_waitcnt lgkmcnt(6)
    v_mfma_f32_16x16x32_bf16 v[136:139], v[200:203], a[112:115], v[136:139]
    v_mfma_f32_16x16x32_bf16 v[152:155], v[200:203], a[116:119], v[152:155]
    s_waitcnt lgkmcnt(5)
    v_mfma_f32_16x16x32_bf16 v[140:143], v[204:207], a[112:115], v[140:143]
    v_mfma_f32_16x16x32_bf16 v[156:159], v[204:207], a[116:119], v[156:159]
    s_waitcnt lgkmcnt(4)
    v_mfma_f32_16x16x32_bf16 v[144:147], v[208:211], a[112:115], v[144:147]
    v_mfma_f32_16x16x32_bf16 v[160:163], v[208:211], a[116:119], v[160:163]
    global_load_dwordx4 a[112:115], v8, s[38:39] offset:2048 sc1
    global_load_dwordx4 a[116:119], v9, s[38:39] offset:2048 sc1
    ds_read_b128 v[196:199], v229 offset:24960
    ds_read_b128 v[200:203], v229 offset:26000
    ds_read_b128 v[204:207], v229 offset:27040
    ds_read_b128 v[208:211], v229 offset:28080
    s_waitcnt vmcnt(47) lgkmcnt(7)
    v_mfma_f32_16x16x32_bf16 v[132:135], v[212:215], a[120:123], v[132:135]
    s_waitcnt vmcnt(46)
    v_mfma_f32_16x16x32_bf16 v[148:151], v[212:215], a[124:127], v[148:151]
    s_waitcnt lgkmcnt(6)
    v_mfma_f32_16x16x32_bf16 v[136:139], v[216:219], a[120:123], v[136:139]
    v_mfma_f32_16x16x32_bf16 v[152:155], v[216:219], a[124:127], v[152:155]
    s_waitcnt lgkmcnt(5)
    v_mfma_f32_16x16x32_bf16 v[140:143], v[220:223], a[120:123], v[140:143]
    v_mfma_f32_16x16x32_bf16 v[156:159], v[220:223], a[124:127], v[156:159]
    s_waitcnt lgkmcnt(4)
    v_mfma_f32_16x16x32_bf16 v[144:147], v[224:227], a[120:123], v[144:147]
    v_mfma_f32_16x16x32_bf16 v[160:163], v[224:227], a[124:127], v[160:163]
    global_load_dwordx4 a[120:123], v8, s[38:39] offset:3072 sc1
    global_load_dwordx4 a[124:127], v9, s[38:39] offset:3072 sc1
    v_add_u32 v8, 8192, v8
    v_add_u32 v9, 8192, v9
    ds_read_b128 v[212:215], v229 offset:29120
    ds_read_b128 v[216:219], v229 offset:30160
    ds_read_b128 v[220:223], v229 offset:31200
    ds_read_b128 v[224:227], v229 offset:32240
    s_waitcnt vmcnt(47) lgkmcnt(7)
    v_mfma_f32_16x16x32_bf16 v[132:135], v[196:199], a[128:131], v[132:135]
    s_waitcnt vmcnt(46)
    v_mfma_f32_16x16x32_bf16 v[148:151], v[196:199], a[132:135], v[148:151]
    s_waitcnt lgkmcnt(6)
    v_mfma_f32_16x16x32_bf16 v[136:139], v[200:203], a[128:131], v[136:139]
    v_mfma_f32_16x16x32_bf16 v[152:155], v[200:203], a[132:135], v[152:155]
    s_waitcnt lgkmcnt(5)
    v_mfma_f32_16x16x32_bf16 v[140:143], v[204:207], a[128:131], v[140:143]
    v_mfma_f32_16x16x32_bf16 v[156:159], v[204:207], a[132:135], v[156:159]
    s_waitcnt lgkmcnt(4)
    v_mfma_f32_16x16x32_bf16 v[144:147], v[208:211], a[128:131], v[144:147]
    v_mfma_f32_16x16x32_bf16 v[160:163], v[208:211], a[132:135], v[160:163]
    global_load_dwordx4 a[128:131], v8, s[38:39] offset:-4096 sc1
    global_load_dwordx4 a[132:135], v9, s[38:39] offset:-4096 sc1
    ds_read_b128 v[196:199], v229 offset:33280
    ds_read_b128 v[200:203], v229 offset:34320
    ds_read_b128 v[204:207], v229 offset:35360
    ds_read_b128 v[208:211], v229 offset:36400
    s_waitcnt vmcnt(47) lgkmcnt(7)
    v_mfma_f32_16x16x32_bf16 v[132:135], v[212:215], a[136:139], v[132:135]
    s_waitcnt vmcnt(46)
    v_mfma_f32_16x16x32_bf16 v[148:151], v[212:215], a[140:143], v[148:151]
    s_waitcnt lgkmcnt(6)
    v_mfma_f32_16x16x32_bf16 v[136:139], v[216:219], a[136:139], v[136:139]
    v_mfma_f32_16x16x32_bf16 v[152:155], v[216:219], a[140:143], v[152:155]
    s_waitcnt lgkmcnt(5)
    v_mfma_f32_16x16x32_bf16 v[140:143], v[220:223], a[136:139], v[140:143]
    v_mfma_f32_16x16x32_bf16 v[156:159], v[220:223], a[140:143], v[156:159]
    s_waitcnt lgkmcnt(4)
    v_mfma_f32_16x16x32_bf16 v[144:147], v[224:227], a[136:139], v[144:147]
    v_mfma_f32_16x16x32_bf16 v[160:163], v[224:227], a[140:143], v[160:163]
    global_load_dwordx4 a[136:139], v8, s[38:39] offset:-3072 sc1
    global_load_dwordx4 a[140:143], v9, s[38:39] offset:-3072 sc1
    ds_read_b128 v[212:215], v229 offset:37440
    ds_read_b128 v[216:219], v229 offset:38480
    ds_read_b128 v[220:223], v229 offset:39520
    ds_read_b128 v[224:227], v229 offset:40560
    s_waitcnt vmcnt(47) lgkmcnt(7)
    v_mfma_f32_16x16x32_bf16 v[132:135], v[196:199], a[144:147], v[132:135]
    s_waitcnt vmcnt(46)
    v_mfma_f32_16x16x32_bf16 v[148:151], v[196:199], a[148:151], v[148:151]
    s_waitcnt lgkmcnt(6)
    v_mfma_f32_16x16x32_bf16 v[136:139], v[200:203], a[144:147], v[136:139]
    v_mfma_f32_16x16x32_bf16 v[152:155], v[200:203], a[148:151], v[152:155]
    s_waitcnt lgkmcnt(5)
    v_mfma_f32_16x16x32_bf16 v[140:143], v[204:207], a[144:147], v[140:143]
    v_mfma_f32_16x16x32_bf16 v[156:159], v[204:207], a[148:151], v[156:159]
    s_waitcnt lgkmcnt(4)
    v_mfma_f32_16x16x32_bf16 v[144:147], v[208:211], a[144:147], v[144:147]
    v_mfma_f32_16x16x32_bf16 v[160:163], v[208:211], a[148:151], v[160:163]
    global_load_dwordx4 a[144:147], v8, s[38:39] offset:-2048 sc1
    global_load_dwordx4 a[148:151], v9, s[38:39] offset:-2048 sc1
    s_waitcnt vmcnt(47) lgkmcnt(3)
    v_mfma_f32_16x16x32_bf16 v[132:135], v[212:215], a[152:155], v[132:135]
    s_waitcnt vmcnt(46)
    v_mfma_f32_16x16x32_bf16 v[148:151], v[212:215], a[156:159], v[148:151]
    s_waitcnt lgkmcnt(2)
    v_mfma_f32_16x16x32_bf16 v[136:139], v[216:219], a[152:155], v[136:139]
    v_mfma_f32_16x16x32_bf16 v[152:155], v[216:219], a[156:159], v[152:155]
    s_waitcnt lgkmcnt(1)
    v_mfma_f32_16x16x32_bf16 v[140:143], v[220:223], a[152:155], v[140:143]
    v_mfma_f32_16x16x32_bf16 v[156:159], v[220:223], a[156:159], v[156:159]
    s_waitcnt lgkmcnt(0)
    v_mfma_f32_16x16x32_bf16 v[144:147], v[224:227], a[152:155], v[144:147]
    v_mfma_f32_16x16x32_bf16 v[160:163], v[224:227], a[156:159], v[160:163]
    global_load_dwordx4 a[152:155], v8, s[38:39] offset:-1024 sc1
    global_load_dwordx4 a[156:159], v9, s[38:39] offset:-1024 sc1
    v_add_u32 v8, 1130496, v8
    v_add_u32 v9, 1130496, v9
    s_waitcnt vmcnt(46)
    v_pk_fma_f32 v[44:45], v[92:93], v[28:29], v[92:93] op_sel:[0,0,1] op_sel_hi:[0,1,1]
    v_pk_fma_f32 v[46:47], v[92:93], v[30:31], v[92:93] op_sel:[0,0,1] op_sel_hi:[0,1,1]
    v_pk_fma_f32 v[48:49], v[92:93], v[32:33], v[92:93] op_sel:[0,0,1] op_sel_hi:[0,1,1]
    v_pk_fma_f32 v[50:51], v[92:93], v[34:35], v[92:93] op_sel:[0,0,1] op_sel_hi:[0,1,1]
    v_pk_fma_f32 v[52:53], v[92:93], v[36:37], v[92:93] op_sel:[0,0,1] op_sel_hi:[0,1,1]
    v_pk_fma_f32 v[54:55], v[92:93], v[38:39], v[92:93] op_sel:[0,0,1] op_sel_hi:[0,1,1]
    v_pk_fma_f32 v[56:57], v[92:93], v[40:41], v[92:93] op_sel:[0,0,1] op_sel_hi:[0,1,1]
    v_pk_fma_f32 v[58:59], v[92:93], v[42:43], v[92:93] op_sel:[0,0,1] op_sel_hi:[0,1,1]
    v_pk_fma_f32 v[132:133], v[132:133], v[12:13], v[44:45] op_sel:[0,0,0] op_sel_hi:[1,1,1]
    v_pk_fma_f32 v[134:135], v[134:135], v[14:15], v[46:47] op_sel:[0,0,0] op_sel_hi:[1,1,1]
    v_pk_fma_f32 v[136:137], v[136:137], v[16:17], v[48:49] op_sel:[0,0,0] op_sel_hi:[1,1,1]
    v_pk_fma_f32 v[138:139], v[138:139], v[18:19], v[50:51] op_sel:[0,0,0] op_sel_hi:[1,1,1]
    v_pk_fma_f32 v[140:141], v[140:141], v[20:21], v[52:53] op_sel:[0,0,0] op_sel_hi:[1,1,1]
    v_pk_fma_f32 v[142:143], v[142:143], v[22:23], v[54:55] op_sel:[0,0,0] op_sel_hi:[1,1,1]
    v_pk_fma_f32 v[144:145], v[144:145], v[24:25], v[56:57] op_sel:[0,0,0] op_sel_hi:[1,1,1]
    v_pk_fma_f32 v[146:147], v[146:147], v[26:27], v[58:59] op_sel:[0,0,0] op_sel_hi:[1,1,1]
    s_waitcnt vmcnt(42)
    v_pk_fma_f32 v[44:45], v[94:95], v[28:29], v[94:95] op_sel:[0,0,1] op_sel_hi:[0,1,1]
    v_pk_fma_f32 v[46:47], v[94:95], v[30:31], v[94:95] op_sel:[0,0,1] op_sel_hi:[0,1,1]
    v_pk_fma_f32 v[48:49], v[94:95], v[32:33], v[94:95] op_sel:[0,0,1] op_sel_hi:[0,1,1]
    v_pk_fma_f32 v[50:51], v[94:95], v[34:35], v[94:95] op_sel:[0,0,1] op_sel_hi:[0,1,1]
    v_pk_fma_f32 v[52:53], v[94:95], v[36:37], v[94:95] op_sel:[0,0,1] op_sel_hi:[0,1,1]
    v_pk_fma_f32 v[54:55], v[94:95], v[38:39], v[94:95] op_sel:[0,0,1] op_sel_hi:[0,1,1]
    v_pk_fma_f32 v[56:57], v[94:95], v[40:41], v[94:95] op_sel:[0,0,1] op_sel_hi:[0,1,1]
    v_pk_fma_f32 v[58:59], v[94:95], v[42:43], v[94:95] op_sel:[0,0,1] op_sel_hi:[0,1,1]
    v_pk_fma_f32 v[148:149], v[148:149], v[12:13], v[44:45] op_sel:[0,0,0] op_sel_hi:[1,1,1]
    v_pk_fma_f32 v[150:151], v[150:151], v[14:15], v[46:47] op_sel:[0,0,0] op_sel_hi:[1,1,1]
    v_pk_fma_f32 v[152:153], v[152:153], v[16:17], v[48:49] op_sel:[0,0,0] op_sel_hi:[1,1,1]
    v_pk_fma_f32 v[154:155], v[154:155], v[18:19], v[50:51] op_sel:[0,0,0] op_sel_hi:[1,1,1]
    v_pk_fma_f32 v[156:157], v[156:157], v[20:21], v[52:53] op_sel:[0,0,0] op_sel_hi:[1,1,1]
    v_pk_fma_f32 v[158:159], v[158:159], v[22:23], v[54:55] op_sel:[0,0,0] op_sel_hi:[1,1,1]
    v_pk_fma_f32 v[160:161], v[160:161], v[24:25], v[56:57] op_sel:[0,0,0] op_sel_hi:[1,1,1]
    v_pk_fma_f32 v[162:163], v[162:163], v[26:27], v[58:59] op_sel:[0,0,0] op_sel_hi:[1,1,1]
    v_pk_mul_f32 v[44:45], v[132:133], v[132:133] op_sel:[0,0] op_sel_hi:[1,1]
    v_pk_mul_f32 v[46:47], v[134:135], v[134:135] op_sel:[0,0] op_sel_hi:[1,1]
    v_pk_mul_f32 v[48:49], v[136:137], v[136:137] op_sel:[0,0] op_sel_hi:[1,1]
    v_pk_mul_f32 v[50:51], v[138:139], v[138:139] op_sel:[0,0] op_sel_hi:[1,1]
    v_pk_mul_f32 v[52:53], v[140:141], v[140:141] op_sel:[0,0] op_sel_hi:[1,1]
    v_pk_mul_f32 v[54:55], v[142:143], v[142:143] op_sel:[0,0] op_sel_hi:[1,1]
    v_pk_mul_f32 v[56:57], v[144:145], v[144:145] op_sel:[0,0] op_sel_hi:[1,1]
    v_pk_mul_f32 v[58:59], v[146:147], v[146:147] op_sel:[0,0] op_sel_hi:[1,1]
    v_pk_mul_f32 v[60:61], v[148:149], v[148:149] op_sel:[0,0] op_sel_hi:[1,1]
    v_pk_mul_f32 v[62:63], v[150:151], v[150:151] op_sel:[0,0] op_sel_hi:[1,1]
    v_pk_mul_f32 v[64:65], v[152:153], v[152:153] op_sel:[0,0] op_sel_hi:[1,1]
    v_pk_mul_f32 v[66:67], v[154:155], v[154:155] op_sel:[0,0] op_sel_hi:[1,1]
    v_pk_mul_f32 v[68:69], v[156:157], v[156:157] op_sel:[0,0] op_sel_hi:[1,1]
    v_pk_mul_f32 v[70:71], v[158:159], v[158:159] op_sel:[0,0] op_sel_hi:[1,1]
    v_pk_mul_f32 v[72:73], v[160:161], v[160:161] op_sel:[0,0] op_sel_hi:[1,1]
    v_pk_mul_f32 v[74:75], v[162:163], v[162:163] op_sel:[0,0] op_sel_hi:[1,1]
    v_pk_fma_f32 v[44:45], v[44:45], s[44:45], s[44:45] op_sel:[0,1,0] op_sel_hi:[1,1,0]
    v_pk_fma_f32 v[46:47], v[46:47], s[44:45], s[44:45] op_sel:[0,1,0] op_sel_hi:[1,1,0]
    v_pk_fma_f32 v[48:49], v[48:49], s[44:45], s[44:45] op_sel:[0,1,0] op_sel_hi:[1,1,0]
    v_pk_fma_f32 v[50:51], v[50:51], s[44:45], s[44:45] op_sel:[0,1,0] op_sel_hi:[1,1,0]
    v_pk_fma_f32 v[52:53], v[52:53], s[44:45], s[44:45] op_sel:[0,1,0] op_sel_hi:[1,1,0]
    v_pk_fma_f32 v[54:55], v[54:55], s[44:45], s[44:45] op_sel:[0,1,0] op_sel_hi:[1,1,0]
    v_pk_fma_f32 v[56:57], v[56:57], s[44:45], s[44:45] op_sel:[0,1,0] op_sel_hi:[1,1,0]
    v_pk_fma_f32 v[58:59], v[58:59], s[44:45], s[44:45] op_sel:[0,1,0] op_sel_hi:[1,1,0]
    v_pk_fma_f32 v[60:61], v[60:61], s[44:45], s[44:45] op_sel:[0,1,0] op_sel_hi:[1,1,0]
    v_pk_fma_f32 v[62:63], v[62:63], s[44:45], s[44:45] op_sel:[0,1,0] op_sel_hi:[1,1,0]
    v_pk_fma_f32 v[64:65], v[64:65], s[44:45], s[44:45] op_sel:[0,1,0] op_sel_hi:[1,1,0]
    v_pk_fma_f32 v[66:67], v[66:67], s[44:45], s[44:45] op_sel:[0,1,0] op_sel_hi:[1,1,0]
    v_pk_fma_f32 v[68:69], v[68:69], s[44:45], s[44:45] op_sel:[0,1,0] op_sel_hi:[1,1,0]
    v_pk_fma_f32 v[70:71], v[70:71], s[44:45], s[44:45] op_sel:[0,1,0] op_sel_hi:[1,1,0]
    v_pk_fma_f32 v[72:73], v[72:73], s[44:45], s[44:45] op_sel:[0,1,0] op_sel_hi:[1,1,0]
    v_pk_fma_f32 v[74:75], v[74:75], s[44:45], s[44:45] op_sel:[0,1,0] op_sel_hi:[1,1,0]
    v_pk_mul_f32 v[44:45], v[44:45], v[132:133] op_sel:[0,0] op_sel_hi:[1,1]
    v_pk_mul_f32 v[46:47], v[46:47], v[134:135] op_sel:[0,0] op_sel_hi:[1,1]
    v_pk_mul_f32 v[48:49], v[48:49], v[136:137] op_sel:[0,0] op_sel_hi:[1,1]
    v_pk_mul_f32 v[50:51], v[50:51], v[138:139] op_sel:[0,0] op_sel_hi:[1,1]
    v_pk_mul_f32 v[52:53], v[52:53], v[140:141] op_sel:[0,0] op_sel_hi:[1,1]
    v_pk_mul_f32 v[54:55], v[54:55], v[142:143] op_sel:[0,0] op_sel_hi:[1,1]
    v_pk_mul_f32 v[56:57], v[56:57], v[144:145] op_sel:[0,0] op_sel_hi:[1,1]
    v_pk_mul_f32 v[58:59], v[58:59], v[146:147] op_sel:[0,0] op_sel_hi:[1,1]
    v_pk_mul_f32 v[60:61], v[60:61], v[148:149] op_sel:[0,0] op_sel_hi:[1,1]
    v_pk_mul_f32 v[62:63], v[62:63], v[150:151] op_sel:[0,0] op_sel_hi:[1,1]
    v_pk_mul_f32 v[64:65], v[64:65], v[152:153] op_sel:[0,0] op_sel_hi:[1,1]
    v_pk_mul_f32 v[66:67], v[66:67], v[154:155] op_sel:[0,0] op_sel_hi:[1,1]
    v_pk_mul_f32 v[68:69], v[68:69], v[156:157] op_sel:[0,0] op_sel_hi:[1,1]
    v_pk_mul_f32 v[70:71], v[70:71], v[158:159] op_sel:[0,0] op_sel_hi:[1,1]
    v_pk_mul_f32 v[72:73], v[72:73], v[160:161] op_sel:[0,0] op_sel_hi:[1,1]
    v_pk_mul_f32 v[74:75], v[74:75], v[162:163] op_sel:[0,0] op_sel_hi:[1,1]
    v_exp_f32 v44, v44
    v_exp_f32 v45, v45
    v_exp_f32 v46, v46
    v_exp_f32 v47, v47
    v_exp_f32 v48, v48
    v_exp_f32 v49, v49
    v_exp_f32 v50, v50
    v_exp_f32 v51, v51
    v_exp_f32 v52, v52
    v_exp_f32 v53, v53
    v_exp_f32 v54, v54
    v_exp_f32 v55, v55
    v_exp_f32 v56, v56
    v_exp_f32 v57, v57
    v_exp_f32 v58, v58
    v_exp_f32 v59, v59
    v_exp_f32 v60, v60
    v_exp_f32 v61, v61
    v_exp_f32 v62, v62
    v_exp_f32 v63, v63
    v_exp_f32 v64, v64
    v_exp_f32 v65, v65
    v_exp_f32 v66, v66
    v_exp_f32 v67, v67
    v_exp_f32 v68, v68
    v_exp_f32 v69, v69
    v_exp_f32 v70, v70
    v_exp_f32 v71, v71
    v_exp_f32 v72, v72
    v_exp_f32 v73, v73
    v_exp_f32 v74, v74
    v_exp_f32 v75, v75
    v_pk_add_f32 v[44:45], v[44:45], 1.0 op_sel:[0,0] op_sel_hi:[1,0]
    v_pk_add_f32 v[46:47], v[46:47], 1.0 op_sel:[0,0] op_sel_hi:[1,0]
    v_pk_add_f32 v[48:49], v[48:49], 1.0 op_sel:[0,0] op_sel_hi:[1,0]
    v_pk_add_f32 v[50:51], v[50:51], 1.0 op_sel:[0,0] op_sel_hi:[1,0]
    v_pk_add_f32 v[52:53], v[52:53], 1.0 op_sel:[0,0] op_sel_hi:[1,0]
    v_pk_add_f32 v[54:55], v[54:55], 1.0 op_sel:[0,0] op_sel_hi:[1,0]
    v_pk_add_f32 v[56:57], v[56:57], 1.0 op_sel:[0,0] op_sel_hi:[1,0]
    v_pk_add_f32 v[58:59], v[58:59], 1.0 op_sel:[0,0] op_sel_hi:[1,0]
    v_pk_add_f32 v[60:61], v[60:61], 1.0 op_sel:[0,0] op_sel_hi:[1,0]
    v_pk_add_f32 v[62:63], v[62:63], 1.0 op_sel:[0,0] op_sel_hi:[1,0]
    v_pk_add_f32 v[64:65], v[64:65], 1.0 op_sel:[0,0] op_sel_hi:[1,0]
    v_pk_add_f32 v[66:67], v[66:67], 1.0 op_sel:[0,0] op_sel_hi:[1,0]
    v_pk_add_f32 v[68:69], v[68:69], 1.0 op_sel:[0,0] op_sel_hi:[1,0]
    v_pk_add_f32 v[70:71], v[70:71], 1.0 op_sel:[0,0] op_sel_hi:[1,0]
    v_pk_add_f32 v[72:73], v[72:73], 1.0 op_sel:[0,0] op_sel_hi:[1,0]
    v_pk_add_f32 v[74:75], v[74:75], 1.0 op_sel:[0,0] op_sel_hi:[1,0]
    v_rcp_f32 v44, v44
    v_rcp_f32 v45, v45
    v_rcp_f32 v46, v46
    v_rcp_f32 v47, v47
    v_rcp_f32 v48, v48
    v_rcp_f32 v49, v49
    v_rcp_f32 v50, v50
    v_rcp_f32 v51, v51
    v_rcp_f32 v52, v52
    v_rcp_f32 v53, v53
    v_rcp_f32 v54, v54
    v_rcp_f32 v55, v55
    v_rcp_f32 v56, v56
    v_rcp_f32 v57, v57
    v_rcp_f32 v58, v58
    v_rcp_f32 v59, v59
    v_rcp_f32 v60, v60
    v_rcp_f32 v61, v61
    v_rcp_f32 v62, v62
    v_rcp_f32 v63, v63
    v_rcp_f32 v64, v64
    v_rcp_f32 v65, v65
    v_rcp_f32 v66, v66
    v_rcp_f32 v67, v67
    v_rcp_f32 v68, v68
    v_rcp_f32 v69, v69
    v_rcp_f32 v70, v70
    v_rcp_f32 v71, v71
    v_rcp_f32 v72, v72
    v_rcp_f32 v73, v73
    v_rcp_f32 v74, v74
    v_rcp_f32 v75, v75
    v_pk_mul_f32 v[132:133], v[132:133], v[44:45] op_sel:[0,0] op_sel_hi:[1,1]
    v_pk_mul_f32 v[134:135], v[134:135], v[46:47] op_sel:[0,0] op_sel_hi:[1,1]
    v_pk_mul_f32 v[136:137], v[136:137], v[48:49] op_sel:[0,0] op_sel_hi:[1,1]
    v_pk_mul_f32 v[138:139], v[138:139], v[50:51] op_sel:[0,0] op_sel_hi:[1,1]
    v_pk_mul_f32 v[140:141], v[140:141], v[52:53] op_sel:[0,0] op_sel_hi:[1,1]
    v_pk_mul_f32 v[142:143], v[142:143], v[54:55] op_sel:[0,0] op_sel_hi:[1,1]
    v_pk_mul_f32 v[144:145], v[144:145], v[56:57] op_sel:[0,0] op_sel_hi:[1,1]
    v_pk_mul_f32 v[146:147], v[146:147], v[58:59] op_sel:[0,0] op_sel_hi:[1,1]
    v_pk_mul_f32 v[148:149], v[148:149], v[60:61] op_sel:[0,0] op_sel_hi:[1,1]
    v_pk_mul_f32 v[150:151], v[150:151], v[62:63] op_sel:[0,0] op_sel_hi:[1,1]
    v_pk_mul_f32 v[152:153], v[152:153], v[64:65] op_sel:[0,0] op_sel_hi:[1,1]
    v_pk_mul_f32 v[154:155], v[154:155], v[66:67] op_sel:[0,0] op_sel_hi:[1,1]
    v_pk_mul_f32 v[156:157], v[156:157], v[68:69] op_sel:[0,0] op_sel_hi:[1,1]
    v_pk_mul_f32 v[158:159], v[158:159], v[70:71] op_sel:[0,0] op_sel_hi:[1,1]
    v_pk_mul_f32 v[160:161], v[160:161], v[72:73] op_sel:[0,0] op_sel_hi:[1,1]
    v_pk_mul_f32 v[162:163], v[162:163], v[74:75] op_sel:[0,0] op_sel_hi:[1,1]
    v_pk_add_f32 v[44:45], v[132:133], v[148:149] op_sel:[0,0] op_sel_hi:[1,1]
    v_pk_mul_f32 v[60:61], v[132:133], v[132:133] op_sel:[0,0] op_sel_hi:[1,1]
    v_pk_add_f32 v[46:47], v[134:135], v[150:151] op_sel:[0,0] op_sel_hi:[1,1]
    v_pk_mul_f32 v[62:63], v[134:135], v[134:135] op_sel:[0,0] op_sel_hi:[1,1]
    v_pk_add_f32 v[48:49], v[136:137], v[152:153] op_sel:[0,0] op_sel_hi:[1,1]
    v_pk_mul_f32 v[64:65], v[136:137], v[136:137] op_sel:[0,0] op_sel_hi:[1,1]
    v_pk_add_f32 v[50:51], v[138:139], v[154:155] op_sel:[0,0] op_sel_hi:[1,1]
    v_pk_mul_f32 v[66:67], v[138:139], v[138:139] op_sel:[0,0] op_sel_hi:[1,1]
    v_pk_add_f32 v[52:53], v[140:141], v[156:157] op_sel:[0,0] op_sel_hi:[1,1]
    v_pk_mul_f32 v[68:69], v[140:141], v[140:141] op_sel:[0,0] op_sel_hi:[1,1]
    v_pk_add_f32 v[54:55], v[142:143], v[158:159] op_sel:[0,0] op_sel_hi:[1,1]
    v_pk_mul_f32 v[70:71], v[142:143], v[142:143] op_sel:[0,0] op_sel_hi:[1,1]
    v_pk_add_f32 v[56:57], v[144:145], v[160:161] op_sel:[0,0] op_sel_hi:[1,1]
    v_pk_mul_f32 v[72:73], v[144:145], v[144:145] op_sel:[0,0] op_sel_hi:[1,1]
    v_pk_add_f32 v[58:59], v[146:147], v[162:163] op_sel:[0,0] op_sel_hi:[1,1]
    v_pk_mul_f32 v[74:75], v[146:147], v[146:147] op_sel:[0,0] op_sel_hi:[1,1]
    v_pk_fma_f32 v[60:61], v[148:149], v[148:149], v[60:61] op_sel:[0,0,0] op_sel_hi:[1,1,1]
    v_pk_fma_f32 v[62:63], v[150:151], v[150:151], v[62:63] op_sel:[0,0,0] op_sel_hi:[1,1,1]
    v_pk_fma_f32 v[64:65], v[152:153], v[152:153], v[64:65] op_sel:[0,0,0] op_sel_hi:[1,1,1]
    v_pk_fma_f32 v[66:67], v[154:155], v[154:155], v[66:67] op_sel:[0,0,0] op_sel_hi:[1,1,1]
    v_pk_fma_f32 v[68:69], v[156:157], v[156:157], v[68:69] op_sel:[0,0,0] op_sel_hi:[1,1,1]
    v_pk_fma_f32 v[70:71], v[158:159], v[158:159], v[70:71] op_sel:[0,0,0] op_sel_hi:[1,1,1]
    v_pk_fma_f32 v[72:73], v[160:161], v[160:161], v[72:73] op_sel:[0,0,0] op_sel_hi:[1,1,1]
    v_pk_fma_f32 v[74:75], v[162:163], v[162:163], v[74:75] op_sel:[0,0,0] op_sel_hi:[1,1,1]
    v_add_f32_dpp v12, v44, v44 row_ror:8 row_mask:0xf bank_mask:0x3
    v_add_f32_dpp v13, v45, v45 row_ror:8 row_mask:0xf bank_mask:0x3
    v_add_f32_dpp v14, v46, v46 row_ror:8 row_mask:0xf bank_mask:0x3
    v_add_f32_dpp v15, v47, v47 row_ror:8 row_mask:0xf bank_mask:0x3
    v_add_f32_dpp v16, v48, v48 row_ror:8 row_mask:0xf bank_mask:0x3
    v_add_f32_dpp v17, v49, v49 row_ror:8 row_mask:0xf bank_mask:0x3
    v_add_f32_dpp v18, v50, v50 row_ror:8 row_mask:0xf bank_mask:0x3
    v_add_f32_dpp v19, v51, v51 row_ror:8 row_mask:0xf bank_mask:0x3
    v_add_f32_dpp v20, v52, v52 row_ror:8 row_mask:0xf bank_mask:0x3
    v_add_f32_dpp v21, v53, v53 row_ror:8 row_mask:0xf bank_mask:0x3
    v_add_f32_dpp v22, v54, v54 row_ror:8 row_mask:0xf bank_mask:0x3
    v_add_f32_dpp v23, v55, v55 row_ror:8 row_mask:0xf bank_mask:0x3
    v_add_f32_dpp v24, v56, v56 row_ror:8 row_mask:0xf bank_mask:0x3
    v_add_f32_dpp v25, v57, v57 row_ror:8 row_mask:0xf bank_mask:0x3
    v_add_f32_dpp v26, v58, v58 row_ror:8 row_mask:0xf bank_mask:0x3
    v_add_f32_dpp v27, v59, v59 row_ror:8 row_mask:0xf bank_mask:0x3
    v_add_f32_dpp v12, v60, v60 row_ror:8 row_mask:0xf bank_mask:0xc
    v_add_f32_dpp v13, v61, v61 row_ror:8 row_mask:0xf bank_mask:0xc
    v_add_f32_dpp v14, v62, v62 row_ror:8 row_mask:0xf bank_mask:0xc
    v_add_f32_dpp v15, v63, v63 row_ror:8 row_mask:0xf bank_mask:0xc
    v_add_f32_dpp v16, v64, v64 row_ror:8 row_mask:0xf bank_mask:0xc
    v_add_f32_dpp v17, v65, v65 row_ror:8 row_mask:0xf bank_mask:0xc
    v_add_f32_dpp v18, v66, v66 row_ror:8 row_mask:0xf bank_mask:0xc
    v_add_f32_dpp v19, v67, v67 row_ror:8 row_mask:0xf bank_mask:0xc
    v_add_f32_dpp v20, v68, v68 row_ror:8 row_mask:0xf bank_mask:0xc
    v_add_f32_dpp v21, v69, v69 row_ror:8 row_mask:0xf bank_mask:0xc
    v_add_f32_dpp v22, v70, v70 row_ror:8 row_mask:0xf bank_mask:0xc
    v_add_f32_dpp v23, v71, v71 row_ror:8 row_mask:0xf bank_mask:0xc
    v_add_f32_dpp v24, v72, v72 row_ror:8 row_mask:0xf bank_mask:0xc
    v_add_f32_dpp v25, v73, v73 row_ror:8 row_mask:0xf bank_mask:0xc
    v_add_f32_dpp v26, v74, v74 row_ror:8 row_mask:0xf bank_mask:0xc
    v_add_f32_dpp v27, v75, v75 row_ror:8 row_mask:0xf bank_mask:0xc
    v_add_f32_dpp v44, v12, v12 row_half_mirror row_mask:0xf bank_mask:0x5
    v_add_f32_dpp v45, v13, v13 row_half_mirror row_mask:0xf bank_mask:0x5
    v_add_f32_dpp v46, v14, v14 row_half_mirror row_mask:0xf bank_mask:0x5
    v_add_f32_dpp v47, v15, v15 row_half_mirror row_mask:0xf bank_mask:0x5
    v_add_f32_dpp v48, v16, v16 row_half_mirror row_mask:0xf bank_mask:0x5
    v_add_f32_dpp v49, v17, v17 row_half_mirror row_mask:0xf bank_mask:0x5
    v_add_f32_dpp v50, v18, v18 row_half_mirror row_mask:0xf bank_mask:0x5
    v_add_f32_dpp v51, v19, v19 row_half_mirror row_mask:0xf bank_mask:0x5
    v_add_f32_dpp v44, v20, v20 row_half_mirror row_mask:0xf bank_mask:0xa
    v_add_f32_dpp v45, v21, v21 row_half_mirror row_mask:0xf bank_mask:0xa
    v_add_f32_dpp v46, v22, v22 row_half_mirror row_mask:0xf bank_mask:0xa
    v_add_f32_dpp v47, v23, v23 row_half_mirror row_mask:0xf bank_mask:0xa
    v_add_f32_dpp v48, v24, v24 row_half_mirror row_mask:0xf bank_mask:0xa
    v_add_f32_dpp v49, v25, v25 row_half_mirror row_mask:0xf bank_mask:0xa
    v_add_f32_dpp v50, v26, v26 row_half_mirror row_mask:0xf bank_mask:0xa
    v_add_f32_dpp v51, v27, v27 row_half_mirror row_mask:0xf bank_mask:0xa
    v_add_f32_dpp v44, v44, v44 quad_perm:[1,0,3,2] row_mask:0xf bank_mask:0xf
    v_add_f32_dpp v45, v45, v45 quad_perm:[1,0,3,2] row_mask:0xf bank_mask:0xf
    v_add_f32_dpp v46, v46, v46 quad_perm:[1,0,3,2] row_mask:0xf bank_mask:0xf
    v_add_f32_dpp v47, v47, v47 quad_perm:[1,0,3,2] row_mask:0xf bank_mask:0xf
    v_add_f32_dpp v48, v48, v48 quad_perm:[1,0,3,2] row_mask:0xf bank_mask:0xf
    v_add_f32_dpp v49, v49, v49 quad_perm:[1,0,3,2] row_mask:0xf bank_mask:0xf
    v_add_f32_dpp v50, v50, v50 quad_perm:[1,0,3,2] row_mask:0xf bank_mask:0xf
    v_add_f32_dpp v51, v51, v51 quad_perm:[1,0,3,2] row_mask:0xf bank_mask:0xf
    v_add_f32_dpp v44, v44, v44 quad_perm:[2,3,0,1] row_mask:0xf bank_mask:0xf
    v_add_f32_dpp v45, v45, v45 quad_perm:[2,3,0,1] row_mask:0xf bank_mask:0xf
    v_add_f32_dpp v46, v46, v46 quad_perm:[2,3,0,1] row_mask:0xf bank_mask:0xf
    v_add_f32_dpp v47, v47, v47 quad_perm:[2,3,0,1] row_mask:0xf bank_mask:0xf
    v_add_f32_dpp v48, v48, v48 quad_perm:[2,3,0,1] row_mask:0xf bank_mask:0xf
    v_add_f32_dpp v49, v49, v49 quad_perm:[2,3,0,1] row_mask:0xf bank_mask:0xf
    v_add_f32_dpp v50, v50, v50 quad_perm:[2,3,0,1] row_mask:0xf bank_mask:0xf
    v_add_f32_dpp v51, v51, v51 quad_perm:[2,3,0,1] row_mask:0xf bank_mask:0xf
    v_lshrrev_b32 v4, 2, v2
    v_lshlrev_b32 v4, 7, v4
    v_lshl_add_u32 v4, v3, 5, v4
    s_add_u32 s4, s42, 83200
    v_add_u32 v4, s4, v4
    s_barrier
    ds_write_b128 v4, v[44:47]
    ds_write_b128 v4, v[48:51] offset:16
    s_waitcnt lgkmcnt(0)
    s_barrier
    v_lshlrev_b32 v4, 2, v1
    v_add_u32 v4, 83200, v4
    ds_read2st64_b32 v[118:119], v4 offset0:0 offset1:1
    ds_read2st64_b32 v[120:121], v4 offset0:2 offset1:3
    ds_read2st64_b32 v[122:123], v4 offset0:4 offset1:5
    ds_read2st64_b32 v[124:125], v4 offset0:6 offset1:7
    s_lshl_b32 s4, s60, 12
    s_add_u32 s4, s4, 65536
    v_add_u32 v230, s4, v126
    s_lshl_b32 s4, s61, 9
    v_add_u32 v4, s4, v230
    s_waitcnt lgkmcnt(2)
    v_pk_add_f32 v[118:119], v[118:119], v[120:121] op_sel:[0,0] op_sel_hi:[1,1]
    s_waitcnt lgkmcnt(0)
    v_pk_add_f32 v[122:123], v[122:123], v[124:125] op_sel:[0,0] op_sel_hi:[1,1]
    v_pk_add_f32 v[118:119], v[118:119], v[122:123] op_sel:[0,0] op_sel_hi:[1,1]
    v_min_u32 v118, -2, v118
    v_min_u32 v119, -2, v119
    s_cmp_eq_u32 s3, 0
    s_cselect_b64 exec, -1, 1
    global_store_dwordx2 v4, v[118:119], s[38:39] sc1
    s_mov_b64 exec, -1
    ds_read_b128 v[196:199], v228 offset:0
    ds_read_b128 v[200:203], v228 offset:1040
    ds_read_b128 v[204:207], v228 offset:2080
    ds_read_b128 v[208:211], v228 offset:3120
    ds_read_b128 v[212:215], v228 offset:4160
    ds_read_b128 v[216:219], v228 offset:5200
    ds_read_b128 v[220:223], v228 offset:6240
    ds_read_b128 v[224:227], v228 offset:7280
    s_waitcnt vmcnt(40) lgkmcnt(7)
    v_mfma_f32_16x16x32_bf16 v[164:167], a[0:3], v[196:199], 0
    s_waitcnt vmcnt(39)
    v_mfma_f32_16x16x32_bf16 v[180:183], a[4:7], v[196:199], 0
    s_waitcnt lgkmcnt(6)
    v_mfma_f32_16x16x32_bf16 v[168:171], a[0:3], v[200:203], 0
    v_mfma_f32_16x16x32_bf16 v[184:187], a[4:7], v[200:203], 0
    s_waitcnt lgkmcnt(5)
    v_mfma_f32_16x16x32_bf16 v[172:175], a[0:3], v[204:207], 0
    v_mfma_f32_16x16x32_bf16 v[188:191], a[4:7], v[204:207], 0
    s_waitcnt lgkmcnt(4)
    v_mfma_f32_16x16x32_bf16 v[176:179], a[0:3], v[208:211], 0
    v_mfma_f32_16x16x32_bf16 v[192:195], a[4:7], v[208:211], 0
    ds_read_b128 v[196:199], v228 offset:8320
    ds_read_b128 v[200:203], v228 offset:9360
    ds_read_b128 v[204:207], v228 offset:10400
    ds_read_b128 v[208:211], v228 offset:11440
    s_waitcnt vmcnt(38) lgkmcnt(7)
    v_mfma_f32_16x16x32_bf16 v[164:167], a[8:11], v[212:215], v[164:167]
    s_waitcnt vmcnt(37)
    v_mfma_f32_16x16x32_bf16 v[180:183], a[12:15], v[212:215], v[180:183]
    s_waitcnt lgkmcnt(6)
    v_mfma_f32_16x16x32_bf16 v[168:171], a[8:11], v[216:219], v[168:171]
    v_mfma_f32_16x16x32_bf16 v[184:187], a[12:15], v[216:219], v[184:187]
    s_waitcnt lgkmcnt(5)
    v_mfma_f32_16x16x32_bf16 v[172:175], a[8:11], v[220:223], v[172:175]
    v_mfma_f32_16x16x32_bf16 v[188:191], a[12:15], v[220:223], v[188:191]
    s_waitcnt lgkmcnt(4)
    v_mfma_f32_16x16x32_bf16 v[176:179], a[8:11], v[224:227], v[176:179]
    v_mfma_f32_16x16x32_bf16 v[192:195], a[12:15], v[224:227], v[192:195]
    ds_read_b128 v[212:215], v228 offset:12480
    ds_read_b128 v[216:219], v228 offset:13520
    ds_read_b128 v[220:223], v228 offset:14560
    ds_read_b128 v[224:227], v228 offset:15600
    s_waitcnt vmcnt(36) lgkmcnt(7)
    v_mfma_f32_16x16x32_bf16 v[164:167], a[16:19], v[196:199], v[164:167]
    s_waitcnt vmcnt(35)
    v_mfma_f32_16x16x32_bf16 v[180:183], a[20:23], v[196:199], v[180:183]
    s_waitcnt lgkmcnt(6)
    v_mfma_f32_16x16x32_bf16 v[168:171], a[16:19], v[200:203], v[168:171]
    v_mfma_f32_16x16x32_bf16 v[184:187], a[20:23], v[200:203], v[184:187]
    s_waitcnt lgkmcnt(5)
    v_mfma_f32_16x16x32_bf16 v[172:175], a[16:19], v[204:207], v[172:175]
    v_mfma_f32_16x16x32_bf16 v[188:191], a[20:23], v[204:207], v[188:191]
    s_waitcnt lgkmcnt(4)
    v_mfma_f32_16x16x32_bf16 v[176:179], a[16:19], v[208:211], v[176:179]
    v_mfma_f32_16x16x32_bf16 v[192:195], a[20:23], v[208:211], v[192:195]
    ds_read_b128 v[196:199], v228 offset:16640
    ds_read_b128 v[200:203], v228 offset:17680
    ds_read_b128 v[204:207], v228 offset:18720
    ds_read_b128 v[208:211], v228 offset:19760
    s_waitcnt vmcnt(34) lgkmcnt(7)
    v_mfma_f32_16x16x32_bf16 v[164:167], a[24:27], v[212:215], v[164:167]
    s_waitcnt vmcnt(33)
    v_mfma_f32_16x16x32_bf16 v[180:183], a[28:31], v[212:215], v[180:183]
    s_waitcnt lgkmcnt(6)
    v_mfma_f32_16x16x32_bf16 v[168:171], a[24:27], v[216:219], v[168:171]
    v_mfma_f32_16x16x32_bf16 v[184:187], a[28:31], v[216:219], v[184:187]
    s_waitcnt lgkmcnt(5)
    v_mfma_f32_16x16x32_bf16 v[172:175], a[24:27], v[220:223], v[172:175]
    v_mfma_f32_16x16x32_bf16 v[188:191], a[28:31], v[220:223], v[188:191]
    s_waitcnt lgkmcnt(4)
    v_mfma_f32_16x16x32_bf16 v[176:179], a[24:27], v[224:227], v[176:179]
    v_mfma_f32_16x16x32_bf16 v[192:195], a[28:31], v[224:227], v[192:195]
    ds_read_b128 v[212:215], v228 offset:20800
    ds_read_b128 v[216:219], v228 offset:21840
    ds_read_b128 v[220:223], v228 offset:22880
    ds_read_b128 v[224:227], v228 offset:23920
    s_waitcnt vmcnt(32) lgkmcnt(7)
    v_mfma_f32_16x16x32_bf16 v[164:167], a[32:35], v[196:199], v[164:167]
    s_waitcnt vmcnt(31)
    v_mfma_f32_16x16x32_bf16 v[180:183], a[36:39], v[196:199], v[180:183]
    s_waitcnt lgkmcnt(6)
    v_mfma_f32_16x16x32_bf16 v[168:171], a[32:35], v[200:203], v[168:171]
    v_mfma_f32_16x16x32_bf16 v[184:187], a[36:39], v[200:203], v[184:187]
    s_waitcnt lgkmcnt(5)
    v_mfma_f32_16x16x32_bf16 v[172:175], a[32:35], v[204:207], v[172:175]
    v_mfma_f32_16x16x32_bf16 v[188:191], a[36:39], v[204:207], v[188:191]
    s_waitcnt lgkmcnt(4)
    v_mfma_f32_16x16x32_bf16 v[176:179], a[32:35], v[208:211], v[176:179]
    v_mfma_f32_16x16x32_bf16 v[192:195], a[36:39], v[208:211], v[192:195]
    ds_read_b128 v[196:199], v228 offset:24960
    ds_read_b128 v[200:203], v228 offset:26000
    ds_read_b128 v[204:207], v228 offset:27040
    ds_read_b128 v[208:211], v228 offset:28080
    s_waitcnt vmcnt(30) lgkmcnt(7)
    v_mfma_f32_16x16x32_bf16 v[164:167], a[40:43], v[212:215], v[164:167]
    s_waitcnt vmcnt(29)
    v_mfma_f32_16x16x32_bf16 v[180:183], a[44:47], v[212:215], v[180:183]
    s_waitcnt lgkmcnt(6)
    v_mfma_f32_16x16x32_bf16 v[168:171], a[40:43], v[216:219], v[168:171]
    v_mfma_f32_16x16x32_bf16 v[184:187], a[44:47], v[216:219], v[184:187]
    s_waitcnt lgkmcnt(5)
    v_mfma_f32_16x16x32_bf16 v[172:175], a[40:43], v[220:223], v[172:175]
    v_mfma_f32_16x16x32_bf16 v[188:191], a[44:47], v[220:223], v[188:191]
    s_waitcnt lgkmcnt(4)
    v_mfma_f32_16x16x32_bf16 v[176:179], a[40:43], v[224:227], v[176:179]
    v_mfma_f32_16x16x32_bf16 v[192:195], a[44:47], v[224:227], v[192:195]
    ds_read_b128 v[212:215], v228 offset:29120
    ds_read_b128 v[216:219], v228 offset:30160
    ds_read_b128 v[220:223], v228 offset:31200
    ds_read_b128 v[224:227], v228 offset:32240
    s_waitcnt vmcnt(28) lgkmcnt(7)
    v_mfma_f32_16x16x32_bf16 v[164:167], a[48:51], v[196:199], v[164:167]
    s_waitcnt vmcnt(27)
    v_mfma_f32_16x16x32_bf16 v[180:183], a[52:55], v[196:199], v[180:183]
    s_waitcnt lgkmcnt(6)
    v_mfma_f32_16x16x32_bf16 v[168:171], a[48:51], v[200:203], v[168:171]
    v_mfma_f32_16x16x32_bf16 v[184:187], a[52:55], v[200:203], v[184:187]
    s_waitcnt lgkmcnt(5)
    v_mfma_f32_16x16x32_bf16 v[172:175], a[48:51], v[204:207], v[172:175]
    v_mfma_f32_16x16x32_bf16 v[188:191], a[52:55], v[204:207], v[188:191]
    s_waitcnt lgkmcnt(4)
    v_mfma_f32_16x16x32_bf16 v[176:179], a[48:51], v[208:211], v[176:179]
    v_mfma_f32_16x16x32_bf16 v[192:195], a[52:55], v[208:211], v[192:195]
    ds_read_b128 v[196:199], v228 offset:33280
    ds_read_b128 v[200:203], v228 offset:34320
    ds_read_b128 v[204:207], v228 offset:35360
    ds_read_b128 v[208:211], v228 offset:36400
    s_waitcnt vmcnt(26) lgkmcnt(7)
    v_mfma_f32_16x16x32_bf16 v[164:167], a[56:59], v[212:215], v[164:167]
    s_waitcnt vmcnt(25)
    v_mfma_f32_16x16x32_bf16 v[180:183], a[60:63], v[212:215], v[180:183]
    s_waitcnt lgkmcnt(6)
    v_mfma_f32_16x16x32_bf16 v[168:171], a[56:59], v[216:219], v[168:171]
    v_mfma_f32_16x16x32_bf16 v[184:187], a[60:63], v[216:219], v[184:187]
    s_waitcnt lgkmcnt(5)
    v_mfma_f32_16x16x32_bf16 v[172:175], a[56:59], v[220:223], v[172:175]
    v_mfma_f32_16x16x32_bf16 v[188:191], a[60:63], v[220:223], v[188:191]
    s_waitcnt lgkmcnt(4)
    v_mfma_f32_16x16x32_bf16 v[176:179], a[56:59], v[224:227], v[176:179]
    v_mfma_f32_16x16x32_bf16 v[192:195], a[60:63], v[224:227], v[192:195]
    ds_read_b128 v[212:215], v228 offset:37440
    ds_read_b128 v[216:219], v228 offset:38480
    ds_read_b128 v[220:223], v228 offset:39520
    ds_read_b128 v[224:227], v228 offset:40560
    s_waitcnt vmcnt(24) lgkmcnt(7)
    v_mfma_f32_16x16x32_bf16 v[164:167], a[64:67], v[196:199], v[164:167]
    s_waitcnt vmcnt(23)
    v_mfma_f32_16x16x32_bf16 v[180:183], a[68:71], v[196:199], v[180:183]
    s_waitcnt lgkmcnt(6)
    v_mfma_f32_16x16x32_bf16 v[168:171], a[64:67], v[200:203], v[168:171]
    v_mfma_f32_16x16x32_bf16 v[184:187], a[68:71], v[200:203], v[184:187]
    s_waitcnt lgkmcnt(5)
    v_mfma_f32_16x16x32_bf16 v[172:175], a[64:67], v[204:207], v[172:175]
    v_mfma_f32_16x16x32_bf16 v[188:191], a[68:71], v[204:207], v[188:191]
    s_waitcnt lgkmcnt(4)
    v_mfma_f32_16x16x32_bf16 v[176:179], a[64:67], v[208:211], v[176:179]
    v_mfma_f32_16x16x32_bf16 v[192:195], a[68:71], v[208:211], v[192:195]
    ds_read_b128 v[196:199], v229 offset:0
    ds_read_b128 v[200:203], v229 offset:1040
    ds_read_b128 v[204:207], v229 offset:2080
    ds_read_b128 v[208:211], v229 offset:3120
    s_waitcnt vmcnt(22) lgkmcnt(7)
    v_mfma_f32_16x16x32_bf16 v[164:167], a[72:75], v[212:215], v[164:167]
    s_waitcnt vmcnt(21)
    v_mfma_f32_16x16x32_bf16 v[180:183], a[76:79], v[212:215], v[180:183]
    s_waitcnt lgkmcnt(6)
    v_mfma_f32_16x16x32_bf16 v[168:171], a[72:75], v[216:219], v[168:171]
    v_mfma_f32_16x16x32_bf16 v[184:187], a[76:79], v[216:219], v[184:187]
    s_waitcnt lgkmcnt(5)
    v_mfma_f32_16x16x32_bf16 v[172:175], a[72:75], v[220:223], v[172:175]
    v_mfma_f32_16x16x32_bf16 v[188:191], a[76:79], v[220:223], v[188:191]
    s_waitcnt lgkmcnt(4)
    v_mfma_f32_16x16x32_bf16 v[176:179], a[72:75], v[224:227], v[176:179]
    v_mfma_f32_16x16x32_bf16 v[192:195], a[76:79], v[224:227], v[192:195]
    ds_read_b128 v[212:215], v229 offset:4160
    ds_read_b128 v[216:219], v229 offset:5200
    ds_read_b128 v[220:223], v229 offset:6240
    ds_read_b128 v[224:227], v229 offset:7280
    s_waitcnt vmcnt(20) lgkmcnt(7)
    v_mfma_f32_16x16x32_bf16 v[164:167], a[80:83], v[196:199], v[164:167]
    s_waitcnt vmcnt(19)
    v_mfma_f32_16x16x32_bf16 v[180:183], a[84:87], v[196:199], v[180:183]
    s_waitcnt lgkmcnt(6)
    v_mfma_f32_16x16x32_bf16 v[168:171], a[80:83], v[200:203], v[168:171]
    v_mfma_f32_16x16x32_bf16 v[184:187], a[84:87], v[200:203], v[184:187]
    s_waitcnt lgkmcnt(5)
    v_mfma_f32_16x16x32_bf16 v[172:175], a[80:83], v[204:207], v[172:175]
    v_mfma_f32_16x16x32_bf16 v[188:191], a[84:87], v[204:207], v[188:191]
    s_waitcnt lgkmcnt(4)
    v_mfma_f32_16x16x32_bf16 v[176:179], a[80:83], v[208:211], v[176:179]
    v_mfma_f32_16x16x32_bf16 v[192:195], a[84:87], v[208:211], v[192:195]
    ds_read_b128 v[196:199], v229 offset:8320
    ds_read_b128 v[200:203], v229 offset:9360
    ds_read_b128 v[204:207], v229 offset:10400
    ds_read_b128 v[208:211], v229 offset:11440
    s_waitcnt vmcnt(18) lgkmcnt(7)
    v_mfma_f32_16x16x32_bf16 v[164:167], a[88:91], v[212:215], v[164:167]
    s_waitcnt vmcnt(17)
    v_mfma_f32_16x16x32_bf16 v[180:183], a[92:95], v[212:215], v[180:183]
    s_waitcnt lgkmcnt(6)
    v_mfma_f32_16x16x32_bf16 v[168:171], a[88:91], v[216:219], v[168:171]
    v_mfma_f32_16x16x32_bf16 v[184:187], a[92:95], v[216:219], v[184:187]
    s_waitcnt lgkmcnt(5)
    v_mfma_f32_16x16x32_bf16 v[172:175], a[88:91], v[220:223], v[172:175]
    v_mfma_f32_16x16x32_bf16 v[188:191], a[92:95], v[220:223], v[188:191]
    s_waitcnt lgkmcnt(4)
    v_mfma_f32_16x16x32_bf16 v[176:179], a[88:91], v[224:227], v[176:179]
    v_mfma_f32_16x16x32_bf16 v[192:195], a[92:95], v[224:227], v[192:195]
    ds_read_b128 v[212:215], v229 offset:12480
    ds_read_b128 v[216:219], v229 offset:13520
    ds_read_b128 v[220:223], v229 offset:14560
    ds_read_b128 v[224:227], v229 offset:15600
    s_waitcnt vmcnt(16) lgkmcnt(7)
    v_mfma_f32_16x16x32_bf16 v[164:167], a[96:99], v[196:199], v[164:167]
    s_waitcnt vmcnt(15)
    v_mfma_f32_16x16x32_bf16 v[180:183], a[100:103], v[196:199], v[180:183]
    s_waitcnt lgkmcnt(6)
    v_mfma_f32_16x16x32_bf16 v[168:171], a[96:99], v[200:203], v[168:171]
    v_mfma_f32_16x16x32_bf16 v[184:187], a[100:103], v[200:203], v[184:187]
    s_waitcnt lgkmcnt(5)
    v_mfma_f32_16x16x32_bf16 v[172:175], a[96:99], v[204:207], v[172:175]
    v_mfma_f32_16x16x32_bf16 v[188:191], a[100:103], v[204:207], v[188:191]
    s_waitcnt lgkmcnt(4)
    v_mfma_f32_16x16x32_bf16 v[176:179], a[96:99], v[208:211], v[176:179]
    v_mfma_f32_16x16x32_bf16 v[192:195], a[100:103], v[208:211], v[192:195]
    ds_read_b128 v[196:199], v229 offset:16640
    ds_read_b128 v[200:203], v229 offset:17680
    ds_read_b128 v[204:207], v229 offset:18720
    ds_read_b128 v[208:211], v229 offset:19760
    s_waitcnt vmcnt(14) lgkmcnt(7)
    v_mfma_f32_16x16x32_bf16 v[164:167], a[104:107], v[212:215], v[164:167]
    s_waitcnt vmcnt(13)
    v_mfma_f32_16x16x32_bf16 v[180:183], a[108:111], v[212:215], v[180:183]
    s_waitcnt lgkmcnt(6)
    v_mfma_f32_16x16x32_bf16 v[168:171], a[104:107], v[216:219], v[168:171]
    v_mfma_f32_16x16x32_bf16 v[184:187], a[108:111], v[216:219], v[184:187]
    s_waitcnt lgkmcnt(5)
    v_mfma_f32_16x16x32_bf16 v[172:175], a[104:107], v[220:223], v[172:175]
    v_mfma_f32_16x16x32_bf16 v[188:191], a[108:111], v[220:223], v[188:191]
    s_waitcnt lgkmcnt(4)
    v_mfma_f32_16x16x32_bf16 v[176:179], a[104:107], v[224:227], v[176:179]
    v_mfma_f32_16x16x32_bf16 v[192:195], a[108:111], v[224:227], v[192:195]
    ds_read_b128 v[212:215], v229 offset:20800
    ds_read_b128 v[216:219], v229 offset:21840
    ds_read_b128 v[220:223], v229 offset:22880
    ds_read_b128 v[224:227], v229 offset:23920
    s_waitcnt vmcnt(12) lgkmcnt(7)
    v_mfma_f32_16x16x32_bf16 v[164:167], a[112:115], v[196:199], v[164:167]
    s_waitcnt vmcnt(11)
    v_mfma_f32_16x16x32_bf16 v[180:183], a[116:119], v[196:199], v[180:183]
    s_waitcnt lgkmcnt(6)
    v_mfma_f32_16x16x32_bf16 v[168:171], a[112:115], v[200:203], v[168:171]
    v_mfma_f32_16x16x32_bf16 v[184:187], a[116:119], v[200:203], v[184:187]
    s_waitcnt lgkmcnt(5)
    v_mfma_f32_16x16x32_bf16 v[172:175], a[112:115], v[204:207], v[172:175]
    v_mfma_f32_16x16x32_bf16 v[188:191], a[116:119], v[204:207], v[188:191]
    s_waitcnt lgkmcnt(4)
    v_mfma_f32_16x16x32_bf16 v[176:179], a[112:115], v[208:211], v[176:179]
    v_mfma_f32_16x16x32_bf16 v[192:195], a[116:119], v[208:211], v[192:195]
    ds_read_b128 v[196:199], v229 offset:24960
    ds_read_b128 v[200:203], v229 offset:26000
    ds_read_b128 v[204:207], v229 offset:27040
    ds_read_b128 v[208:211], v229 offset:28080
    s_waitcnt vmcnt(10) lgkmcnt(7)
    v_mfma_f32_16x16x32_bf16 v[164:167], a[120:123], v[212:215], v[164:167]
    s_waitcnt vmcnt(9)
    v_mfma_f32_16x16x32_bf16 v[180:183], a[124:127], v[212:215], v[180:183]
    s_waitcnt lgkmcnt(6)
    v_mfma_f32_16x16x32_bf16 v[168:171], a[120:123], v[216:219], v[168:171]
    v_mfma_f32_16x16x32_bf16 v[184:187], a[124:127], v[216:219], v[184:187]
    s_waitcnt lgkmcnt(5)
    v_mfma_f32_16x16x32_bf16 v[172:175], a[120:123], v[220:223], v[172:175]
    v_mfma_f32_16x16x32_bf16 v[188:191], a[124:127], v[220:223], v[188:191]
    s_waitcnt lgkmcnt(4)
    v_mfma_f32_16x16x32_bf16 v[176:179], a[120:123], v[224:227], v[176:179]
    v_mfma_f32_16x16x32_bf16 v[192:195], a[124:127], v[224:227], v[192:195]
    ds_read_b128 v[212:215], v229 offset:29120
    ds_read_b128 v[216:219], v229 offset:30160
    ds_read_b128 v[220:223], v229 offset:31200
    ds_read_b128 v[224:227], v229 offset:32240
    s_waitcnt vmcnt(8) lgkmcnt(7)
    v_mfma_f32_16x16x32_bf16 v[164:167], a[128:131], v[196:199], v[164:167]
    s_waitcnt vmcnt(7)
    v_mfma_f32_16x16x32_bf16 v[180:183], a[132:135], v[196:199], v[180:183]
    s_waitcnt lgkmcnt(6)
    v_mfma_f32_16x16x32_bf16 v[168:171], a[128:131], v[200:203], v[168:171]
    v_mfma_f32_16x16x32_bf16 v[184:187], a[132:135], v[200:203], v[184:187]
    s_waitcnt lgkmcnt(5)
    v_mfma_f32_16x16x32_bf16 v[172:175], a[128:131], v[204:207], v[172:175]
    v_mfma_f32_16x16x32_bf16 v[188:191], a[132:135], v[204:207], v[188:191]
    s_waitcnt lgkmcnt(4)
    v_mfma_f32_16x16x32_bf16 v[176:179], a[128:131], v[208:211], v[176:179]
    v_mfma_f32_16x16x32_bf16 v[192:195], a[132:135], v[208:211], v[192:195]
    ds_read_b128 v[196:199], v229 offset:33280
    ds_read_b128 v[200:203], v229 offset:34320
    ds_read_b128 v[204:207], v229 offset:35360
    ds_read_b128 v[208:211], v229 offset:36400
    s_waitcnt vmcnt(6) lgkmcnt(7)
    v_mfma_f32_16x16x32_bf16 v[164:167], a[136:139], v[212:215], v[164:167]
    s_waitcnt vmcnt(5)
    v_mfma_f32_16x16x32_bf16 v[180:183], a[140:143], v[212:215], v[180:183]
    s_waitcnt lgkmcnt(6)
    v_mfma_f32_16x16x32_bf16 v[168:171], a[136:139], v[216:219], v[168:171]
    v_mfma_f32_16x16x32_bf16 v[184:187], a[140:143], v[216:219], v[184:187]
    s_waitcnt lgkmcnt(5)
    v_mfma_f32_16x16x32_bf16 v[172:175], a[136:139], v[220:223], v[172:175]
    v_mfma_f32_16x16x32_bf16 v[188:191], a[140:143], v[220:223], v[188:191]
    s_waitcnt lgkmcnt(4)
    v_mfma_f32_16x16x32_bf16 v[176:179], a[136:139], v[224:227], v[176:179]
    v_mfma_f32_16x16x32_bf16 v[192:195], a[140:143], v[224:227], v[192:195]
    ds_read_b128 v[212:215], v229 offset:37440
    ds_read_b128 v[216:219], v229 offset:38480
    ds_read_b128 v[220:223], v229 offset:39520
    ds_read_b128 v[224:227], v229 offset:40560
    s_waitcnt vmcnt(4) lgkmcnt(7)
    v_mfma_f32_16x16x32_bf16 v[164:167], a[144:147], v[196:199], v[164:167]
    s_waitcnt vmcnt(3)
    v_mfma_f32_16x16x32_bf16 v[180:183], a[148:151], v[196:199], v[180:183]
    s_waitcnt lgkmcnt(6)
    v_mfma_f32_16x16x32_bf16 v[168:171], a[144:147], v[200:203], v[168:171]
    v_mfma_f32_16x16x32_bf16 v[184:187], a[148:151], v[200:203], v[184:187]
    s_waitcnt lgkmcnt(5)
    v_mfma_f32_16x16x32_bf16 v[172:175], a[144:147], v[204:207], v[172:175]
    v_mfma_f32_16x16x32_bf16 v[188:191], a[148:151], v[204:207], v[188:191]
    s_waitcnt lgkmcnt(4)
    v_mfma_f32_16x16x32_bf16 v[176:179], a[144:147], v[208:211], v[176:179]
    v_mfma_f32_16x16x32_bf16 v[192:195], a[148:151], v[208:211], v[192:195]
    s_waitcnt vmcnt(2) lgkmcnt(3)
    v_mfma_f32_16x16x32_bf16 v[164:167], a[152:155], v[212:215], v[164:167]
    s_waitcnt vmcnt(1)
    v_mfma_f32_16x16x32_bf16 v[180:183], a[156:159], v[212:215], v[180:183]
    s_waitcnt lgkmcnt(2)
    v_mfma_f32_16x16x32_bf16 v[168:171], a[152:155], v[216:219], v[168:171]
    v_mfma_f32_16x16x32_bf16 v[184:187], a[156:159], v[216:219], v[184:187]
    s_waitcnt lgkmcnt(1)
    v_mfma_f32_16x16x32_bf16 v[172:175], a[152:155], v[220:223], v[172:175]
    v_mfma_f32_16x16x32_bf16 v[188:191], a[156:159], v[220:223], v[188:191]
    s_waitcnt lgkmcnt(0)
    v_mfma_f32_16x16x32_bf16 v[176:179], a[152:155], v[224:227], v[176:179]
    v_mfma_f32_16x16x32_bf16 v[192:195], a[156:159], v[224:227], v[192:195]
    v_pk_fma_f32 v[44:45], v[76:77], v[96:97], v[100:101] op_sel:[1,0,0] op_sel_hi:[1,1,1]
    v_pk_fma_f32 v[46:47], v[76:77], v[98:99], v[102:103] op_sel:[1,0,0] op_sel_hi:[1,1,1]
    v_pk_fma_f32 v[48:49], v[78:79], v[96:97], v[100:101] op_sel:[1,0,0] op_sel_hi:[1,1,1]
    v_pk_fma_f32 v[50:51], v[78:79], v[98:99], v[102:103] op_sel:[1,0,0] op_sel_hi:[1,1,1]
    v_pk_fma_f32 v[52:53], v[80:81], v[96:97], v[100:101] op_sel:[1,0,0] op_sel_hi:[1,1,1]
    v_pk_fma_f32 v[54:55], v[80:81], v[98:99], v[102:103] op_sel:[1,0,0] op_sel_hi:[1,1,1]
    v_pk_fma_f32 v[56:57], v[82:83], v[96:97], v[100:101] op_sel:[1,0,0] op_sel_hi:[1,1,1]
    v_pk_fma_f32 v[58:59], v[82:83], v[98:99], v[102:103] op_sel:[1,0,0] op_sel_hi:[1,1,1]
    v_pk_fma_f32 v[164:165], v[76:77], v[164:165], v[44:45] op_sel:[0,0,0] op_sel_hi:[0,1,1]
    v_pk_fma_f32 v[166:167], v[76:77], v[166:167], v[46:47] op_sel:[0,0,0] op_sel_hi:[0,1,1]
    v_pk_fma_f32 v[168:169], v[78:79], v[168:169], v[48:49] op_sel:[0,0,0] op_sel_hi:[0,1,1]
    v_pk_fma_f32 v[170:171], v[78:79], v[170:171], v[50:51] op_sel:[0,0,0] op_sel_hi:[0,1,1]
    v_pk_fma_f32 v[172:173], v[80:81], v[172:173], v[52:53] op_sel:[0,0,0] op_sel_hi:[0,1,1]
    v_pk_fma_f32 v[174:175], v[80:81], v[174:175], v[54:55] op_sel:[0,0,0] op_sel_hi:[0,1,1]
    v_pk_fma_f32 v[176:177], v[82:83], v[176:177], v[56:57] op_sel:[0,0,0] op_sel_hi:[0,1,1]
    v_pk_fma_f32 v[178:179], v[82:83], v[178:179], v[58:59] op_sel:[0,0,0] op_sel_hi:[0,1,1]
    v_pk_fma_f32 v[44:45], v[76:77], v[104:105], v[108:109] op_sel:[1,0,0] op_sel_hi:[1,1,1]
    v_pk_fma_f32 v[46:47], v[76:77], v[106:107], v[110:111] op_sel:[1,0,0] op_sel_hi:[1,1,1]
    v_pk_fma_f32 v[48:49], v[78:79], v[104:105], v[108:109] op_sel:[1,0,0] op_sel_hi:[1,1,1]
    v_pk_fma_f32 v[50:51], v[78:79], v[106:107], v[110:111] op_sel:[1,0,0] op_sel_hi:[1,1,1]
    v_pk_fma_f32 v[52:53], v[80:81], v[104:105], v[108:109] op_sel:[1,0,0] op_sel_hi:[1,1,1]
    v_pk_fma_f32 v[54:55], v[80:81], v[106:107], v[110:111] op_sel:[1,0,0] op_sel_hi:[1,1,1]
    v_pk_fma_f32 v[56:57], v[82:83], v[104:105], v[108:109] op_sel:[1,0,0] op_sel_hi:[1,1,1]
    v_pk_fma_f32 v[58:59], v[82:83], v[106:107], v[110:111] op_sel:[1,0,0] op_sel_hi:[1,1,1]
    v_pk_fma_f32 v[180:181], v[76:77], v[180:181], v[44:45] op_sel:[0,0,0] op_sel_hi:[0,1,1]
    v_pk_fma_f32 v[182:183], v[76:77], v[182:183], v[46:47] op_sel:[0,0,0] op_sel_hi:[0,1,1]
    v_pk_fma_f32 v[184:185], v[78:79], v[184:185], v[48:49] op_sel:[0,0,0] op_sel_hi:[0,1,1]
    v_pk_fma_f32 v[186:187], v[78:79], v[186:187], v[50:51] op_sel:[0,0,0] op_sel_hi:[0,1,1]
    v_pk_fma_f32 v[188:189], v[80:81], v[188:189], v[52:53] op_sel:[0,0,0] op_sel_hi:[0,1,1]
    v_pk_fma_f32 v[190:191], v[80:81], v[190:191], v[54:55] op_sel:[0,0,0] op_sel_hi:[0,1,1]
    v_pk_fma_f32 v[192:193], v[82:83], v[192:193], v[56:57] op_sel:[0,0,0] op_sel_hi:[0,1,1]
    v_pk_fma_f32 v[194:195], v[82:83], v[194:195], v[58:59] op_sel:[0,0,0] op_sel_hi:[0,1,1]
    v_pk_mul_f32 v[44:45], v[164:165], v[164:165] op_sel:[0,0] op_sel_hi:[1,1]
    v_pk_mul_f32 v[46:47], v[166:167], v[166:167] op_sel:[0,0] op_sel_hi:[1,1]
    v_pk_mul_f32 v[48:49], v[168:169], v[168:169] op_sel:[0,0] op_sel_hi:[1,1]
    v_pk_mul_f32 v[50:51], v[170:171], v[170:171] op_sel:[0,0] op_sel_hi:[1,1]
    v_pk_mul_f32 v[52:53], v[172:173], v[172:173] op_sel:[0,0] op_sel_hi:[1,1]
    v_pk_mul_f32 v[54:55], v[174:175], v[174:175] op_sel:[0,0] op_sel_hi:[1,1]
    v_pk_mul_f32 v[56:57], v[176:177], v[176:177] op_sel:[0,0] op_sel_hi:[1,1]
    v_pk_mul_f32 v[58:59], v[178:179], v[178:179] op_sel:[0,0] op_sel_hi:[1,1]
    v_pk_mul_f32 v[60:61], v[180:181], v[180:181] op_sel:[0,0] op_sel_hi:[1,1]
    v_pk_mul_f32 v[62:63], v[182:183], v[182:183] op_sel:[0,0] op_sel_hi:[1,1]
    v_pk_mul_f32 v[64:65], v[184:185], v[184:185] op_sel:[0,0] op_sel_hi:[1,1]
    v_pk_mul_f32 v[66:67], v[186:187], v[186:187] op_sel:[0,0] op_sel_hi:[1,1]
    v_pk_mul_f32 v[68:69], v[188:189], v[188:189] op_sel:[0,0] op_sel_hi:[1,1]
    v_pk_mul_f32 v[70:71], v[190:191], v[190:191] op_sel:[0,0] op_sel_hi:[1,1]
    v_pk_mul_f32 v[72:73], v[192:193], v[192:193] op_sel:[0,0] op_sel_hi:[1,1]
    v_pk_mul_f32 v[74:75], v[194:195], v[194:195] op_sel:[0,0] op_sel_hi:[1,1]
    v_pk_fma_f32 v[44:45], v[44:45], s[44:45], s[44:45] op_sel:[0,1,0] op_sel_hi:[1,1,0]
    v_pk_fma_f32 v[46:47], v[46:47], s[44:45], s[44:45] op_sel:[0,1,0] op_sel_hi:[1,1,0]
    v_pk_fma_f32 v[48:49], v[48:49], s[44:45], s[44:45] op_sel:[0,1,0] op_sel_hi:[1,1,0]
    v_pk_fma_f32 v[50:51], v[50:51], s[44:45], s[44:45] op_sel:[0,1,0] op_sel_hi:[1,1,0]
    v_pk_fma_f32 v[52:53], v[52:53], s[44:45], s[44:45] op_sel:[0,1,0] op_sel_hi:[1,1,0]
    v_pk_fma_f32 v[54:55], v[54:55], s[44:45], s[44:45] op_sel:[0,1,0] op_sel_hi:[1,1,0]
    v_pk_fma_f32 v[56:57], v[56:57], s[44:45], s[44:45] op_sel:[0,1,0] op_sel_hi:[1,1,0]
    v_pk_fma_f32 v[58:59], v[58:59], s[44:45], s[44:45] op_sel:[0,1,0] op_sel_hi:[1,1,0]
    v_pk_fma_f32 v[60:61], v[60:61], s[44:45], s[44:45] op_sel:[0,1,0] op_sel_hi:[1,1,0]
    v_pk_fma_f32 v[62:63], v[62:63], s[44:45], s[44:45] op_sel:[0,1,0] op_sel_hi:[1,1,0]
    v_pk_fma_f32 v[64:65], v[64:65], s[44:45], s[44:45] op_sel:[0,1,0] op_sel_hi:[1,1,0]
    v_pk_fma_f32 v[66:67], v[66:67], s[44:45], s[44:45] op_sel:[0,1,0] op_sel_hi:[1,1,0]
    v_pk_fma_f32 v[68:69], v[68:69], s[44:45], s[44:45] op_sel:[0,1,0] op_sel_hi:[1,1,0]
    v_pk_fma_f32 v[70:71], v[70:71], s[44:45], s[44:45] op_sel:[0,1,0] op_sel_hi:[1,1,0]
    v_pk_fma_f32 v[72:73], v[72:73], s[44:45], s[44:45] op_sel:[0,1,0] op_sel_hi:[1,1,0]
    v_pk_fma_f32 v[74:75], v[74:75], s[44:45], s[44:45] op_sel:[0,1,0] op_sel_hi:[1,1,0]
    v_pk_mul_f32 v[44:45], v[44:45], v[164:165] op_sel:[0,0] op_sel_hi:[1,1]
    v_pk_mul_f32 v[46:47], v[46:47], v[166:167] op_sel:[0,0] op_sel_hi:[1,1]
    v_pk_mul_f32 v[48:49], v[48:49], v[168:169] op_sel:[0,0] op_sel_hi:[1,1]
    v_pk_mul_f32 v[50:51], v[50:51], v[170:171] op_sel:[0,0] op_sel_hi:[1,1]
    v_pk_mul_f32 v[52:53], v[52:53], v[172:173] op_sel:[0,0] op_sel_hi:[1,1]
    v_pk_mul_f32 v[54:55], v[54:55], v[174:175] op_sel:[0,0] op_sel_hi:[1,1]
    v_pk_mul_f32 v[56:57], v[56:57], v[176:177] op_sel:[0,0] op_sel_hi:[1,1]
    v_pk_mul_f32 v[58:59], v[58:59], v[178:179] op_sel:[0,0] op_sel_hi:[1,1]
    v_pk_mul_f32 v[60:61], v[60:61], v[180:181] op_sel:[0,0] op_sel_hi:[1,1]
    v_pk_mul_f32 v[62:63], v[62:63], v[182:183] op_sel:[0,0] op_sel_hi:[1,1]
    v_pk_mul_f32 v[64:65], v[64:65], v[184:185] op_sel:[0,0] op_sel_hi:[1,1]
    v_pk_mul_f32 v[66:67], v[66:67], v[186:187] op_sel:[0,0] op_sel_hi:[1,1]
    v_pk_mul_f32 v[68:69], v[68:69], v[188:189] op_sel:[0,0] op_sel_hi:[1,1]
    v_pk_mul_f32 v[70:71], v[70:71], v[190:191] op_sel:[0,0] op_sel_hi:[1,1]
    v_pk_mul_f32 v[72:73], v[72:73], v[192:193] op_sel:[0,0] op_sel_hi:[1,1]
    v_pk_mul_f32 v[74:75], v[74:75], v[194:195] op_sel:[0,0] op_sel_hi:[1,1]
    v_exp_f32 v44, v44
    v_exp_f32 v45, v45
    v_exp_f32 v46, v46
    v_exp_f32 v47, v47
    v_exp_f32 v48, v48
    v_exp_f32 v49, v49
    v_exp_f32 v50, v50
    v_exp_f32 v51, v51
    v_exp_f32 v52, v52
    v_exp_f32 v53, v53
    v_exp_f32 v54, v54
    v_exp_f32 v55, v55
    v_exp_f32 v56, v56
    v_exp_f32 v57, v57
    v_exp_f32 v58, v58
    v_exp_f32 v59, v59
    v_exp_f32 v60, v60
    v_exp_f32 v61, v61
    v_exp_f32 v62, v62
    v_exp_f32 v63, v63
    v_exp_f32 v64, v64
    v_exp_f32 v65, v65
    v_exp_f32 v66, v66
    v_exp_f32 v67, v67
    v_exp_f32 v68, v68
    v_exp_f32 v69, v69
    v_exp_f32 v70, v70
    v_exp_f32 v71, v71
    v_exp_f32 v72, v72
    v_exp_f32 v73, v73
    v_exp_f32 v74, v74
    v_exp_f32 v75, v75
    v_pk_add_f32 v[44:45], v[44:45], 1.0 op_sel:[0,0] op_sel_hi:[1,0]
    v_pk_add_f32 v[46:47], v[46:47], 1.0 op_sel:[0,0] op_sel_hi:[1,0]
    v_pk_add_f32 v[48:49], v[48:49], 1.0 op_sel:[0,0] op_sel_hi:[1,0]
    v_pk_add_f32 v[50:51], v[50:51], 1.0 op_sel:[0,0] op_sel_hi:[1,0]
    v_pk_add_f32 v[52:53], v[52:53], 1.0 op_sel:[0,0] op_sel_hi:[1,0]
    v_pk_add_f32 v[54:55], v[54:55], 1.0 op_sel:[0,0] op_sel_hi:[1,0]
    v_pk_add_f32 v[56:57], v[56:57], 1.0 op_sel:[0,0] op_sel_hi:[1,0]
    v_pk_add_f32 v[58:59], v[58:59], 1.0 op_sel:[0,0] op_sel_hi:[1,0]
    v_pk_add_f32 v[60:61], v[60:61], 1.0 op_sel:[0,0] op_sel_hi:[1,0]
    v_pk_add_f32 v[62:63], v[62:63], 1.0 op_sel:[0,0] op_sel_hi:[1,0]
    v_pk_add_f32 v[64:65], v[64:65], 1.0 op_sel:[0,0] op_sel_hi:[1,0]
    v_pk_add_f32 v[66:67], v[66:67], 1.0 op_sel:[0,0] op_sel_hi:[1,0]
    v_pk_add_f32 v[68:69], v[68:69], 1.0 op_sel:[0,0] op_sel_hi:[1,0]
    v_pk_add_f32 v[70:71], v[70:71], 1.0 op_sel:[0,0] op_sel_hi:[1,0]
    v_pk_add_f32 v[72:73], v[72:73], 1.0 op_sel:[0,0] op_sel_hi:[1,0]
    v_pk_add_f32 v[74:75], v[74:75], 1.0 op_sel:[0,0] op_sel_hi:[1,0]
    v_rcp_f32 v44, v44
    v_rcp_f32 v45, v45
    v_rcp_f32 v46, v46
    v_rcp_f32 v47, v47
    v_rcp_f32 v48, v48
    v_rcp_f32 v49, v49
    v_rcp_f32 v50, v50
    v_rcp_f32 v51, v51
    v_rcp_f32 v52, v52
    v_rcp_f32 v53, v53
    v_rcp_f32 v54, v54
    v_rcp_f32 v55, v55
    v_rcp_f32 v56, v56
    v_rcp_f32 v57, v57
    v_rcp_f32 v58, v58
    v_rcp_f32 v59, v59
    v_rcp_f32 v60, v60
    v_rcp_f32 v61, v61
    v_rcp_f32 v62, v62
    v_rcp_f32 v63, v63
    v_rcp_f32 v64, v64
    v_rcp_f32 v65, v65
    v_rcp_f32 v66, v66
    v_rcp_f32 v67, v67
    v_rcp_f32 v68, v68
    v_rcp_f32 v69, v69
    v_rcp_f32 v70, v70
    v_rcp_f32 v71, v71
    v_rcp_f32 v72, v72
    v_rcp_f32 v73, v73
    v_rcp_f32 v74, v74
    v_rcp_f32 v75, v75
    v_pk_mul_f32 v[164:165], v[164:165], v[44:45] op_sel:[0,0] op_sel_hi:[1,1]
    v_pk_mul_f32 v[166:167], v[166:167], v[46:47] op_sel:[0,0] op_sel_hi:[1,1]
    v_pk_mul_f32 v[168:169], v[168:169], v[48:49] op_sel:[0,0] op_sel_hi:[1,1]
    v_pk_mul_f32 v[170:171], v[170:171], v[50:51] op_sel:[0,0] op_sel_hi:[1,1]
    v_pk_mul_f32 v[172:173], v[172:173], v[52:53] op_sel:[0,0] op_sel_hi:[1,1]
    v_pk_mul_f32 v[174:175], v[174:175], v[54:55] op_sel:[0,0] op_sel_hi:[1,1]
    v_pk_mul_f32 v[176:177], v[176:177], v[56:57] op_sel:[0,0] op_sel_hi:[1,1]
    v_pk_mul_f32 v[178:179], v[178:179], v[58:59] op_sel:[0,0] op_sel_hi:[1,1]
    v_pk_mul_f32 v[180:181], v[180:181], v[60:61] op_sel:[0,0] op_sel_hi:[1,1]
    v_pk_mul_f32 v[182:183], v[182:183], v[62:63] op_sel:[0,0] op_sel_hi:[1,1]
    v_pk_mul_f32 v[184:185], v[184:185], v[64:65] op_sel:[0,0] op_sel_hi:[1,1]
    v_pk_mul_f32 v[186:187], v[186:187], v[66:67] op_sel:[0,0] op_sel_hi:[1,1]
    v_pk_mul_f32 v[188:189], v[188:189], v[68:69] op_sel:[0,0] op_sel_hi:[1,1]
    v_pk_mul_f32 v[190:191], v[190:191], v[70:71] op_sel:[0,0] op_sel_hi:[1,1]
    v_pk_mul_f32 v[192:193], v[192:193], v[72:73] op_sel:[0,0] op_sel_hi:[1,1]
    v_pk_mul_f32 v[194:195], v[194:195], v[74:75] op_sel:[0,0] op_sel_hi:[1,1]
    v_cvt_pk_bf16_f32 v44, v164, v165
    v_cvt_pk_bf16_f32 v45, v166, v167
    v_cvt_pk_bf16_f32 v46, v168, v169
    v_cvt_pk_bf16_f32 v47, v170, v171
    v_cvt_pk_bf16_f32 v48, v172, v173
    v_cvt_pk_bf16_f32 v49, v174, v175
    v_cvt_pk_bf16_f32 v50, v176, v177
    v_cvt_pk_bf16_f32 v51, v178, v179
    v_cvt_pk_bf16_f32 v52, v180, v181
    v_cvt_pk_bf16_f32 v53, v182, v183
    v_cvt_pk_bf16_f32 v54, v184, v185
    v_cvt_pk_bf16_f32 v55, v186, v187
    v_cvt_pk_bf16_f32 v56, v188, v189
    v_cvt_pk_bf16_f32 v57, v190, v191
    v_cvt_pk_bf16_f32 v58, v192, v193
    v_cvt_pk_bf16_f32 v59, v194, v195
    s_lshl_b32 s4, s60, 3
    s_add_u32 s4, s4, s61
    s_mul_i32 s4, s4, 14336
    s_lshl_b32 s5, s3, 10
    s_add_u32 s4, s4, s5
    s_add_u32 s4, s4, 20971520
    v_add_u32 v4, s4, v126
    s_cmp_eq_u32 s3, 3
    s_cselect_b64 s[46:47], 0, -1
    global_store_dwordx2 v4, v[44:45], s[38:39] sc1
    s_mov_b64 exec, s[46:47]
    global_store_dwordx2 v4, v[52:53], s[38:39] offset:512 sc1
    s_mov_b64 exec, -1
    v_add_u32 v4, 3584, v4
    global_store_dwordx2 v4, v[46:47], s[38:39] sc1
    s_mov_b64 exec, s[46:47]
    global_store_dwordx2 v4, v[54:55], s[38:39] offset:512 sc1
    s_mov_b64 exec, -1
    v_add_u32 v4, 3584, v4
    global_store_dwordx2 v4, v[48:49], s[38:39] sc1
    s_mov_b64 exec, s[46:47]
    global_store_dwordx2 v4, v[56:57], s[38:39] offset:512 sc1
    s_mov_b64 exec, -1
    v_add_u32 v4, 3584, v4
    global_store_dwordx2 v4, v[50:51], s[38:39] sc1
    s_mov_b64 exec, s[46:47]
    global_store_dwordx2 v4, v[58:59], s[38:39] offset:512 sc1
    s_mov_b64 exec, -1
    v_add_u32 v4, 3584, v4
    s_waitcnt vmcnt(0) lgkmcnt(0)
    s_mov_b32 s5, 0
Lg1_poll_a:
    global_load_dwordx2 v[164:165], v230, s[38:39] offset:0 sc1
    global_load_dwordx2 v[166:167], v230, s[38:39] offset:512 sc1
    global_load_dwordx2 v[168:169], v230, s[38:39] offset:1024 sc1
    global_load_dwordx2 v[170:171], v230, s[38:39] offset:1536 sc1
    global_load_dwordx2 v[172:173], v230, s[38:39] offset:2048 sc1
    global_load_dwordx2 v[174:175], v230, s[38:39] offset:2560 sc1
    global_load_dwordx2 v[176:177], v230, s[38:39] offset:3072 sc1
    global_load_dwordx2 v[178:179], v230, s[38:39] offset:3584 sc1
    s_waitcnt vmcnt(7)
    v_max_u32 v4, v164, v165
    s_waitcnt vmcnt(6)
    v_max3_u32 v4, v166, v167, v4
    s_waitcnt vmcnt(5)
    v_max3_u32 v4, v168, v169, v4
    s_waitcnt vmcnt(4)
    v_max3_u32 v4, v170, v171, v4
    s_waitcnt vmcnt(3)
    v_max3_u32 v4, v172, v173, v4
    s_waitcnt vmcnt(2)
    v_max3_u32 v4, v174, v175, v4
    s_waitcnt vmcnt(1)
    v_max3_u32 v4, v176, v177, v4
    s_waitcnt vmcnt(0)
    v_max3_u32 v4, v178, v179, v4
    v_cmp_eq_u32 vcc, -1, v4
    s_add_u32 s5, s5, 1
    s_cmp_ge_u32 s5, 0x40000
    s_cbranch_scc1 Lg1_go_a
    s_cbranch_vccnz Lg1_poll_a
Lg1_go_a:
    v_pk_add_f32 v[164:165], v[164:165], v[166:167] op_sel:[0,0] op_sel_hi:[1,1]
    v_pk_add_f32 v[168:169], v[168:169], v[170:171] op_sel:[0,0] op_sel_hi:[1,1]
    v_pk_add_f32 v[172:173], v[172:173], v[174:175] op_sel:[0,0] op_sel_hi:[1,1]
    v_pk_add_f32 v[176:177], v[176:177], v[178:179] op_sel:[0,0] op_sel_hi:[1,1]
    v_pk_add_f32 v[164:165], v[164:165], v[168:169] op_sel:[0,0] op_sel_hi:[1,1]
    v_pk_add_f32 v[172:173], v[172:173], v[176:177] op_sel:[0,0] op_sel_hi:[1,1]
    v_pk_add_f32 v[164:165], v[164:165], v[172:173] op_sel:[0,0] op_sel_hi:[1,1]
    v_mul_f32 v164, 0x3a97b426, v164
    v_mul_f32 v165, 0x3a97b426, v165
    v_fma_f32 v165, -v164, v164, v165
    v_max_f32 v165, 0, v165
    v_add_f32 v165, 0x3727c5ac, v165
    v_rsq_f32 v166, v165
    s_nop 0
    v_mul_f32_e64 v165, -v164, v166
    v_mov_b32 v164, v166
    ds_write2st64_b32 v127, v164, v165 offset0:0 offset1:1
    ds_read_b128 v[12:15], v128 offset:0
    ds_read_b128 v[16:19], v128 offset:16
    ds_read_b128 v[20:23], v128 offset:128
    ds_read_b128 v[24:27], v128 offset:144
    ds_read_b128 v[28:31], v128 offset:256
    ds_read_b128 v[32:35], v128 offset:272
    ds_read_b128 v[36:39], v128 offset:384
    ds_read_b128 v[40:43], v128 offset:400
    s_lshl_b32 s4, s61, 6
    s_lshl_b32 s5, s60, 1
    s_add_u32 s4, s4, s5
    s_mul_i32 s4, s4, 7168
    s_lshl_b32 s5, s3, 11
    s_add_u32 s4, s4, s5
    s_add_u32 s4, s4, 12582912
    v_lshl_add_u32 v4, v1, 4, s4
    v_add_u32 v5, 7168, v4
    s_waitcnt lgkmcnt(3)
    v_pk_fma_f32 v[132:133], v[132:133], v[12:13], v[28:29] op_sel:[0,0,0] op_sel_hi:[1,1,1]
    v_pk_fma_f32 v[134:135], v[134:135], v[14:15], v[30:31] op_sel:[0,0,0] op_sel_hi:[1,1,1]
    s_waitcnt lgkmcnt(2)
    v_pk_fma_f32 v[136:137], v[136:137], v[16:17], v[32:33] op_sel:[0,0,0] op_sel_hi:[1,1,1]
    v_pk_fma_f32 v[138:139], v[138:139], v[18:19], v[34:35] op_sel:[0,0,0] op_sel_hi:[1,1,1]
    s_waitcnt lgkmcnt(1)
    v_pk_fma_f32 v[140:141], v[140:141], v[20:21], v[36:37] op_sel:[0,0,0] op_sel_hi:[1,1,1]
    v_pk_fma_f32 v[142:143], v[142:143], v[22:23], v[38:39] op_sel:[0,0,0] op_sel_hi:[1,1,1]
    s_waitcnt lgkmcnt(0)
    v_pk_fma_f32 v[144:145], v[144:145], v[24:25], v[40:41] op_sel:[0,0,0] op_sel_hi:[1,1,1]
    v_pk_fma_f32 v[146:147], v[146:147], v[26:27], v[42:43] op_sel:[0,0,0] op_sel_hi:[1,1,1]
    v_pk_fma_f32 v[148:149], v[148:149], v[12:13], v[28:29] op_sel:[0,0,0] op_sel_hi:[1,1,1]
    v_pk_fma_f32 v[150:151], v[150:151], v[14:15], v[30:31] op_sel:[0,0,0] op_sel_hi:[1,1,1]
    v_pk_fma_f32 v[152:153], v[152:153], v[16:17], v[32:33] op_sel:[0,0,0] op_sel_hi:[1,1,1]
    v_pk_fma_f32 v[154:155], v[154:155], v[18:19], v[34:35] op_sel:[0,0,0] op_sel_hi:[1,1,1]
    v_pk_fma_f32 v[156:157], v[156:157], v[20:21], v[36:37] op_sel:[0,0,0] op_sel_hi:[1,1,1]
    v_pk_fma_f32 v[158:159], v[158:159], v[22:23], v[38:39] op_sel:[0,0,0] op_sel_hi:[1,1,1]
    v_pk_fma_f32 v[160:161], v[160:161], v[24:25], v[40:41] op_sel:[0,0,0] op_sel_hi:[1,1,1]
    v_pk_fma_f32 v[162:163], v[162:163], v[26:27], v[42:43] op_sel:[0,0,0] op_sel_hi:[1,1,1]
    v_cvt_pk_bf16_f32 v44, v132, v133
    v_cvt_pk_bf16_f32 v45, v134, v135
    v_cvt_pk_bf16_f32 v46, v136, v137
    v_cvt_pk_bf16_f32 v47, v138, v139
    v_cvt_pk_bf16_f32 v48, v140, v141
    v_cvt_pk_bf16_f32 v49, v142, v143
    v_cvt_pk_bf16_f32 v50, v144, v145
    v_cvt_pk_bf16_f32 v51, v146, v147
    v_cvt_pk_bf16_f32 v52, v148, v149
    v_cvt_pk_bf16_f32 v53, v150, v151
    v_cvt_pk_bf16_f32 v54, v152, v153
    v_cvt_pk_bf16_f32 v55, v154, v155
    v_cvt_pk_bf16_f32 v56, v156, v157
    v_cvt_pk_bf16_f32 v57, v158, v159
    v_cvt_pk_bf16_f32 v58, v160, v161
    v_cvt_pk_bf16_f32 v59, v162, v163
    v_min_u32 v44, -2, v44
    v_min_u32 v45, -2, v45
    v_min_u32 v46, -2, v46
    v_min_u32 v47, -2, v47
    v_min_u32 v48, -2, v48
    v_min_u32 v49, -2, v49
    v_min_u32 v50, -2, v50
    v_min_u32 v51, -2, v51
    v_min_u32 v52, -2, v52
    v_min_u32 v53, -2, v53
    v_min_u32 v54, -2, v54
    v_min_u32 v55, -2, v55
    v_min_u32 v56, -2, v56
    v_min_u32 v57, -2, v57
    v_min_u32 v58, -2, v58
    v_min_u32 v59, -2, v59
    global_store_dwordx4 v4, v[44:47], s[38:39] sc1
    global_store_dwordx4 v5, v[48:51], s[38:39] sc1
    s_mov_b64 exec, s[46:47]
    global_store_dwordx4 v4, v[52:55], s[38:39] offset:1024 sc1
    global_store_dwordx4 v5, v[56:59], s[38:39] offset:1024 sc1
    s_mov_b64 exec, -1
Ldone_g1_kernel:
Lend_g1_kernel:
    s_endpgm
.p2align 8
.globl g2_kernel
.type g2_kernel,@function
g2_kernel:
    s_cmp_ge_u32 s2, 256
    s_cbranch_scc1 Lend_g2_kernel
    s_load_dwordx16 s[8:23], s[0:1], 0
    s_load_dwordx16 s[24:39], s[0:1], 64
    v_lshrrev_b32 v2, 6, v0
    v_and_b32 v1, 63, v0
    v_readfirstlane_b32 s3, v2
    s_waitcnt lgkmcnt(0)
    s_and_b32 s4, s2, 7
    s_lshr_b32 s5, s2, 3
    s_lshr_b32 s60, s4, 1
    s_lshl_b32 s60, s60, 3
    s_lshr_b32 s6, s5, 2
    s_add_u32 s60, s60, s6
    s_and_b32 s61, s4, 1
    s_lshl_b32 s61, s61, 2
    s_and_b32 s6, s5, 3
    s_add_u32 s61, s61, s6
    v_and_b32 v2, 15, v1
    v_lshrrev_b32 v3, 4, v1
    s_add_u32 s4, s60, 0
    s_lshl_b32 s4, s4, 2
    s_add_u32 s4, s4, s3
    s_and_b32 s48, s4, 31
    s_add_u32 s4, s60, 1
    s_lshl_b32 s4, s4, 2
    s_add_u32 s4, s4, s3
    s_and_b32 s49, s4, 31
    s_add_u32 s4, s60, 2
    s_lshl_b32 s4, s4, 2
    s_add_u32 s4, s4, s3
    s_and_b32 s50, s4, 31
    s_add_u32 s4, s60, 3
    s_lshl_b32 s4, s4, 2
    s_add_u32 s4, s4, s3
    s_and_b32 s51, s4, 31
    s_add_u32 s4, s60, 4
    s_lshl_b32 s4, s4, 2
    s_add_u32 s4, s4, s3
    s_and_b32 s52, s4, 31
    s_add_u32 s4, s60, 5
    s_lshl_b32 s4, s4, 2
    s_add_u32 s4, s4, s3
    s_and_b32 s53, s4, 31
    s_add_u32 s4, s60, 6
    s_lshl_b32 s4, s4, 2
    s_add_u32 s4, s4, s3
    s_and_b32 s54, s4, 31
    s_add_u32 s4, s60, 7
    s_lshl_b32 s4, s4, 2
    s_add_u32 s4, s4, s3
    s_and_b32 s55, s4, 31
    v_lshrrev_b32 v4, 3, v1
    v_bfe_u32 v5, v1, 4, 1
    v_xor_b32 v5, v5, v1
    v_and_b32 v5, 7, v5
    s_lshl_b32 s4, s60, 18
    v_lshl_add_u32 v4, v4, 12, s4
    v_xor_b32 v6, 0, v5
    v_lshl_add_u32 v6, v6, 4, v4
    v_add_u32 v6, 0, v6
    v_xor_b32 v7, 2, v5
    v_lshl_add_u32 v7, v7, 4, v4
    v_add_u32 v7, 32768, v7
    v_xor_b32 v8, 4, v5
    v_lshl_add_u32 v8, v8, 4, v4
    v_add_u32 v8, 65536, v8
    v_xor_b32 v9, 6, v5
    v_lshl_add_u32 v9, v9, 4, v4
    v_add_u32 v9, 98304, v9
    v_lshrrev_b32 v4, 2, v2
    v_and_b32 v18, 3, v2
    v_lshl_add_u32 v18, v4, 3, v18
    v_lshrrev_b32 v5, 1, v2
    v_xor_b32 v5, v5, v3
    s_lshl_b32 s6, s3, 14
    s_xor_b32 s4, s3, 0
    s_lshr_b32 s5, s4, 1
    s_lshl_b32 s5, s5, 5
    s_and_b32 s4, s4, 1
    s_lshl_b32 s4, s4, 2
    s_add_u32 s4, s4, s5
    s_lshl_b32 s4, s4, 7
    s_add_u32 s4, s4, s6
    v_lshl_add_u32 v4, v18, 7, s4
    v_lshl_add_u32 v10, v5, 4, v4
    v_xor_b32 v11, 64, v10
    s_xor_b32 s4, s3, 1
    s_lshr_b32 s5, s4, 1
    s_lshl_b32 s5, s5, 5
    s_and_b32 s4, s4, 1
    s_lshl_b32 s4, s4, 2
    s_add_u32 s4, s4, s5
    s_lshl_b32 s4, s4, 7
    s_add_u32 s4, s4, s6
    v_lshl_add_u32 v4, v18, 7, s4
    v_lshl_add_u32 v12, v5, 4, v4
    v_xor_b32 v13, 64, v12
    s_xor_b32 s4, s3, 2
    s_lshr_b32 s5, s4, 1
    s_lshl_b32 s5, s5, 5
    s_and_b32 s4, s4, 1
    s_lshl_b32 s4, s4, 2
    s_add_u32 s4, s4, s5
    s_lshl_b32 s4, s4, 7
    s_add_u32 s4, s4, s6
    v_lshl_add_u32 v4, v18, 7, s4
    v_lshl_add_u32 v14, v5, 4, v4
    v_xor_b32 v15, 64, v14
    s_xor_b32 s4, s3, 3
    s_lshr_b32 s5, s4, 1
    s_lshl_b32 s5, s5, 5
    s_and_b32 s4, s4, 1
    s_lshl_b32 s4, s4, 2
    s_add_u32 s4, s4, s5
    s_lshl_b32 s4, s4, 7
    s_add_u32 s4, s4, s6
    v_lshl_add_u32 v4, v18, 7, s4
    v_lshl_add_u32 v16, v5, 4, v4
    v_xor_b32 v17, 64, v16
    s_mul_i32 s4, s61, 458752
    s_add_u32 s4, s4, 12585984
    v_lshl_add_u32 v217, v1, 4, s4
    s_lshl_b32 s4, s48, 7
    s_add_u32 m0, s6, 0
    v_add_u32 v19, s4, v6
    global_load_lds_dwordx4 v19, s[24:25] nt
    s_add_u32 m0, s6, 1024
    v_add_u32 v19, s4, v7
    global_load_lds_dwordx4 v19, s[24:25] nt
    s_add_u32 m0, s6, 2048
    v_add_u32 v19, s4, v8
    global_load_lds_dwordx4 v19, s[24:25] nt
    s_add_u32 m0, s6, 3072
    v_add_u32 v19, s4, v9
    global_load_lds_dwordx4 v19, s[24:25] nt
    s_add_u32 m0, s6, 4096
    s_add_u32 s4, s4, 131072
    v_add_u32 v19, s4, v6
    global_load_lds_dwordx4 v19, s[24:25] nt
    s_add_u32 m0, s6, 5120
    v_add_u32 v19, s4, v7
    global_load_lds_dwordx4 v19, s[24:25] nt
    s_add_u32 m0, s6, 6144
    v_add_u32 v19, s4, v8
    global_load_lds_dwordx4 v19, s[24:25] nt
    s_add_u32 m0, s6, 7168
    v_add_u32 v19, s4, v9
    global_load_lds_dwordx4 v19, s[24:25] nt
    s_mul_i32 s5, s48, 14336
    v_add_u32 v216, s5, v217
    global_load_dwordx4 v[132:135], v216, s[38:39] offset:-3072 sc1
    global_load_dwordx4 v[136:139], v216, s[38:39] offset:-2048 sc1
    global_load_dwordx4 v[140:143], v216, s[38:39] offset:-1024 sc1
    global_load_dwordx4 v[144:147], v216, s[38:39] offset:0 sc1
    global_load_dwordx4 v[148:151], v216, s[38:39] offset:1024 sc1
    global_load_dwordx4 v[152:155], v216, s[38:39] offset:2048 sc1
    global_load_dwordx4 v[156:159], v216, s[38:39] offset:3072 sc1
    s_lshl_b32 s4, s49, 7
    s_add_u32 m0, s6, 8192
    v_add_u32 v19, s4, v6
    global_load_lds_dwordx4 v19, s[24:25] nt
    s_add_u32 m0, s6, 9216
    v_add_u32 v19, s4, v7
    global_load_lds_dwordx4 v19, s[24:25] nt
    s_add_u32 m0, s6, 10240
    v_add_u32 v19, s4, v8
    global_load_lds_dwordx4 v19, s[24:25] nt
    s_add_u32 m0, s6, 11264
    v_add_u32 v19, s4, v9
    global_load_lds_dwordx4 v19, s[24:25] nt
    s_add_u32 m0, s6, 12288
    s_add_u32 s4, s4, 131072
    v_add_u32 v19, s4, v6
    global_load_lds_dwordx4 v19, s[24:25] nt
    s_add_u32 m0, s6, 13312
    v_add_u32 v19, s4, v7
    global_load_lds_dwordx4 v19, s[24:25] nt
    s_add_u32 m0, s6, 14336
    v_add_u32 v19, s4, v8
    global_load_lds_dwordx4 v19, s[24:25] nt
    s_add_u32 m0, s6, 15360
    v_add_u32 v19, s4, v9
    global_load_lds_dwordx4 v19, s[24:25] nt
    s_mul_i32 s5, s48, 14336
    s_add_u32 s5, s5, 7168
    v_add_u32 v216, s5, v217
    global_load_dwordx4 v[160:163], v216, s[38:39] offset:-3072 sc1
    global_load_dwordx4 v[164:167], v216, s[38:39] offset:-2048 sc1
    global_load_dwordx4 v[168:171], v216, s[38:39] offset:-1024 sc1
    global_load_dwordx4 v[172:175], v216, s[38:39] offset:0 sc1
    global_load_dwordx4 v[176:179], v216, s[38:39] offset:1024 sc1
    global_load_dwordx4 v[180:183], v216, s[38:39] offset:2048 sc1
    global_load_dwordx4 v[184:187], v216, s[38:39] offset:3072 sc1
    s_waitcnt vmcnt(22)
    ds_read_b128 a[0:3], v10 offset:0
    ds_read_b128 a[4:7], v12 offset:0
    ds_read_b128 a[8:11], v14 offset:0
    ds_read_b128 a[12:15], v16 offset:0
    ds_read_b128 a[16:19], v11 offset:0
    ds_read_b128 a[20:23], v13 offset:0
    ds_read_b128 a[24:27], v15 offset:0
    ds_read_b128 a[28:31], v17 offset:0
    s_mul_i32 s5, s49, 14336
    v_add_u32 v216, s5, v217
    global_load_dwordx4 v[188:191], v216, s[38:39] offset:-3072 sc1
    global_load_dwordx4 v[192:195], v216, s[38:39] offset:-2048 sc1
    global_load_dwordx4 v[196:199], v216, s[38:39] offset:-1024 sc1
    global_load_dwordx4 v[200:203], v216, s[38:39] offset:0 sc1
    global_load_dwordx4 v[204:207], v216, s[38:39] offset:1024 sc1
    global_load_dwordx4 v[208:211], v216, s[38:39] offset:2048 sc1
    global_load_dwordx4 v[212:215], v216, s[38:39] offset:3072 sc1
    s_waitcnt vmcnt(28) lgkmcnt(7)
    v_mfma_f32_16x16x32_bf16 v[20:23], v[132:135], a[0:3], 0
    s_waitcnt lgkmcnt(6)
    v_mfma_f32_16x16x32_bf16 v[24:27], v[132:135], a[4:7], 0
    s_waitcnt lgkmcnt(5)
    v_mfma_f32_16x16x32_bf16 v[28:31], v[132:135], a[8:11], 0
    s_waitcnt lgkmcnt(4)
    v_mfma_f32_16x16x32_bf16 v[32:35], v[132:135], a[12:15], 0
    s_waitcnt vmcnt(27)
    v_mfma_f32_16x16x32_bf16 v[36:39], v[136:139], a[0:3], 0
    v_mfma_f32_16x16x32_bf16 v[40:43], v[136:139], a[4:7], 0
    v_mfma_f32_16x16x32_bf16 v[44:47], v[136:139], a[8:11], 0
    v_mfma_f32_16x16x32_bf16 v[48:51], v[136:139], a[12:15], 0
    s_waitcnt vmcnt(26)
    v_mfma_f32_16x16x32_bf16 v[52:55], v[140:143], a[0:3], 0
    v_mfma_f32_16x16x32_bf16 v[56:59], v[140:143], a[4:7], 0
    v_mfma_f32_16x16x32_bf16 v[60:63], v[140:143], a[8:11], 0
    v_mfma_f32_16x16x32_bf16 v[64:67], v[140:143], a[12:15], 0
    s_waitcnt vmcnt(25)
    v_mfma_f32_16x16x32_bf16 v[68:71], v[144:147], a[0:3], 0
    v_mfma_f32_16x16x32_bf16 v[72:75], v[144:147], a[4:7], 0
    v_mfma_f32_16x16x32_bf16 v[76:79], v[144:147], a[8:11], 0
    v_mfma_f32_16x16x32_bf16 v[80:83], v[144:147], a[12:15], 0
    s_waitcnt vmcnt(24)
    v_mfma_f32_16x16x32_bf16 v[84:87], v[148:151], a[0:3], 0
    v_mfma_f32_16x16x32_bf16 v[88:91], v[148:151], a[4:7], 0
    v_mfma_f32_16x16x32_bf16 v[92:95], v[148:151], a[8:11], 0
    v_mfma_f32_16x16x32_bf16 v[96:99], v[148:151], a[12:15], 0
    s_waitcnt vmcnt(23)
    v_mfma_f32_16x16x32_bf16 v[100:103], v[152:155], a[0:3], 0
    v_mfma_f32_16x16x32_bf16 v[104:107], v[152:155], a[4:7], 0
    v_mfma_f32_16x16x32_bf16 v[108:111], v[152:155], a[8:11], 0
    v_mfma_f32_16x16x32_bf16 v[112:115], v[152:155], a[12:15], 0
    s_waitcnt vmcnt(22)
    v_mfma_f32_16x16x32_bf16 v[116:119], v[156:159], a[0:3], 0
    v_mfma_f32_16x16x32_bf16 v[120:123], v[156:159], a[4:7], 0
    v_mfma_f32_16x16x32_bf16 v[124:127], v[156:159], a[8:11], 0
    v_mfma_f32_16x16x32_bf16 v[128:131], v[156:159], a[12:15], 0
    s_mul_i32 s5, s49, 14336
    s_add_u32 s5, s5, 7168
    v_add_u32 v216, s5, v217
    global_load_dwordx4 v[132:135], v216, s[38:39] offset:-3072 sc1
    global_load_dwordx4 v[136:139], v216, s[38:39] offset:-2048 sc1
    global_load_dwordx4 v[140:143], v216, s[38:39] offset:-1024 sc1
    global_load_dwordx4 v[144:147], v216, s[38:39] offset:0 sc1
    global_load_dwordx4 v[148:151], v216, s[38:39] offset:1024 sc1
    global_load_dwordx4 v[152:155], v216, s[38:39] offset:2048 sc1
    global_load_dwordx4 v[156:159], v216, s[38:39] offset:3072 sc1
    s_waitcnt lgkmcnt(0)
    s_lshl_b32 s4, s50, 7
    s_add_u32 m0, s6, 0
    v_add_u32 v19, s4, v6
    global_load_lds_dwordx4 v19, s[24:25] nt
    s_add_u32 m0, s6, 1024
    v_add_u32 v19, s4, v7
    global_load_lds_dwordx4 v19, s[24:25] nt
    s_add_u32 m0, s6, 2048
    v_add_u32 v19, s4, v8
    global_load_lds_dwordx4 v19, s[24:25] nt
    s_add_u32 m0, s6, 3072
    v_add_u32 v19, s4, v9
    global_load_lds_dwordx4 v19, s[24:25] nt
    s_add_u32 m0, s6, 4096
    s_add_u32 s4, s4, 131072
    v_add_u32 v19, s4, v6
    global_load_lds_dwordx4 v19, s[24:25] nt
    s_add_u32 m0, s6, 5120
    v_add_u32 v19, s4, v7
    global_load_lds_dwordx4 v19, s[24:25] nt
    s_add_u32 m0, s6, 6144
    v_add_u32 v19, s4, v8
    global_load_lds_dwordx4 v19, s[24:25] nt
    s_add_u32 m0, s6, 7168
    v_add_u32 v19, s4, v9
    global_load_lds_dwordx4 v19, s[24:25] nt
    s_waitcnt vmcnt(28)
    v_mfma_f32_16x16x32_bf16 v[20:23], v[160:163], a[16:19], v[20:23]
    v_mfma_f32_16x16x32_bf16 v[24:27], v[160:163], a[20:23], v[24:27]
    v_mfma_f32_16x16x32_bf16 v[28:31], v[160:163], a[24:27], v[28:31]
    v_mfma_f32_16x16x32_bf16 v[32:35], v[160:163], a[28:31], v[32:35]
    s_waitcnt vmcnt(27)
    v_mfma_f32_16x16x32_bf16 v[36:39], v[164:167], a[16:19], v[36:39]
    v_mfma_f32_16x16x32_bf16 v[40:43], v[164:167], a[20:23], v[40:43]
    v_mfma_f32_16x16x32_bf16 v[44:47], v[164:167], a[24:27], v[44:47]
    v_mfma_f32_16x16x32_bf16 v[48:51], v[164:167], a[28:31], v[48:51]
    s_waitcnt vmcnt(26)
    v_mfma_f32_16x16x32_bf16 v[52:55], v[168:171], a[16:19], v[52:55]
    v_mfma_f32_16x16x32_bf16 v[56:59], v[168:171], a[20:23], v[56:59]
    v_mfma_f32_16x16x32_bf16 v[60:63], v[168:171], a[24:27], v[60:63]
    v_mfma_f32_16x16x32_bf16 v[64:67], v[168:171], a[28:31], v[64:67]
    s_waitcnt vmcnt(25)
    v_mfma_f32_16x16x32_bf16 v[68:71], v[172:175], a[16:19], v[68:71]
    v_mfma_f32_16x16x32_bf16 v[72:75], v[172:175], a[20:23], v[72:75]
    v_mfma_f32_16x16x32_bf16 v[76:79], v[172:175], a[24:27], v[76:79]
    v_mfma_f32_16x16x32_bf16 v[80:83], v[172:175], a[28:31], v[80:83]
    s_waitcnt vmcnt(24)
    v_mfma_f32_16x16x32_bf16 v[84:87], v[176:179], a[16:19], v[84:87]
    v_mfma_f32_16x16x32_bf16 v[88:91], v[176:179], a[20:23], v[88:91]
    v_mfma_f32_16x16x32_bf16 v[92:95], v[176:179], a[24:27], v[92:95]
    v_mfma_f32_16x16x32_bf16 v[96:99], v[176:179], a[28:31], v[96:99]
    s_waitcnt vmcnt(23)
    v_mfma_f32_16x16x32_bf16 v[100:103], v[180:183], a[16:19], v[100:103]
    v_mfma_f32_16x16x32_bf16 v[104:107], v[180:183], a[20:23], v[104:107]
    v_mfma_f32_16x16x32_bf16 v[108:111], v[180:183], a[24:27], v[108:111]
    v_mfma_f32_16x16x32_bf16 v[112:115], v[180:183], a[28:31], v[112:115]
    s_waitcnt vmcnt(22)
    v_mfma_f32_16x16x32_bf16 v[116:119], v[184:187], a[16:19], v[116:119]
    v_mfma_f32_16x16x32_bf16 v[120:123], v[184:187], a[20:23], v[120:123]
    v_mfma_f32_16x16x32_bf16 v[124:127], v[184:187], a[24:27], v[124:127]
    v_mfma_f32_16x16x32_bf16 v[128:131], v[184:187], a[28:31], v[128:131]
    ds_read_b128 a[32:35], v10 offset:8192
    ds_read_b128 a[36:39], v12 offset:8192
    ds_read_b128 a[40:43], v14 offset:8192
    ds_read_b128 a[44:47], v16 offset:8192
    ds_read_b128 a[48:51], v11 offset:8192
    ds_read_b128 a[52:55], v13 offset:8192
    ds_read_b128 a[56:59], v15 offset:8192
    ds_read_b128 a[60:63], v17 offset:8192
    s_mul_i32 s5, s50, 14336
    v_add_u32 v216, s5, v217
    global_load_dwordx4 v[160:163], v216, s[38:39] offset:-3072 sc1
    global_load_dwordx4 v[164:167], v216, s[38:39] offset:-2048 sc1
    global_load_dwordx4 v[168:171], v216, s[38:39] offset:-1024 sc1
    global_load_dwordx4 v[172:175], v216, s[38:39] offset:0 sc1
    global_load_dwordx4 v[176:179], v216, s[38:39] offset:1024 sc1
    global_load_dwordx4 v[180:183], v216, s[38:39] offset:2048 sc1
    global_load_dwordx4 v[184:187], v216, s[38:39] offset:3072 sc1
    s_waitcnt vmcnt(28) lgkmcnt(7)
    v_mfma_f32_16x16x32_bf16 v[20:23], v[188:191], a[32:35], v[20:23]
    s_waitcnt lgkmcnt(6)
    v_mfma_f32_16x16x32_bf16 v[24:27], v[188:191], a[36:39], v[24:27]
    s_waitcnt lgkmcnt(5)
    v_mfma_f32_16x16x32_bf16 v[28:31], v[188:191], a[40:43], v[28:31]
    s_waitcnt lgkmcnt(4)
    v_mfma_f32_16x16x32_bf16 v[32:35], v[188:191], a[44:47], v[32:35]
    s_waitcnt vmcnt(27)
    v_mfma_f32_16x16x32_bf16 v[36:39], v[192:195], a[32:35], v[36:39]
    v_mfma_f32_16x16x32_bf16 v[40:43], v[192:195], a[36:39], v[40:43]
    v_mfma_f32_16x16x32_bf16 v[44:47], v[192:195], a[40:43], v[44:47]
    v_mfma_f32_16x16x32_bf16 v[48:51], v[192:195], a[44:47], v[48:51]
    s_waitcnt vmcnt(26)
    v_mfma_f32_16x16x32_bf16 v[52:55], v[196:199], a[32:35], v[52:55]
    v_mfma_f32_16x16x32_bf16 v[56:59], v[196:199], a[36:39], v[56:59]
    v_mfma_f32_16x16x32_bf16 v[60:63], v[196:199], a[40:43], v[60:63]
    v_mfma_f32_16x16x32_bf16 v[64:67], v[196:199], a[44:47], v[64:67]
    s_waitcnt vmcnt(25)
    v_mfma_f32_16x16x32_bf16 v[68:71], v[200:203], a[32:35], v[68:71]
    v_mfma_f32_16x16x32_bf16 v[72:75], v[200:203], a[36:39], v[72:75]
    v_mfma_f32_16x16x32_bf16 v[76:79], v[200:203], a[40:43], v[76:79]
    v_mfma_f32_16x16x32_bf16 v[80:83], v[200:203], a[44:47], v[80:83]
    s_waitcnt vmcnt(24)
    v_mfma_f32_16x16x32_bf16 v[84:87], v[204:207], a[32:35], v[84:87]
    v_mfma_f32_16x16x32_bf16 v[88:91], v[204:207], a[36:39], v[88:91]
    v_mfma_f32_16x16x32_bf16 v[92:95], v[204:207], a[40:43], v[92:95]
    v_mfma_f32_16x16x32_bf16 v[96:99], v[204:207], a[44:47], v[96:99]
    s_waitcnt vmcnt(23)
    v_mfma_f32_16x16x32_bf16 v[100:103], v[208:211], a[32:35], v[100:103]
    v_mfma_f32_16x16x32_bf16 v[104:107], v[208:211], a[36:39], v[104:107]
    v_mfma_f32_16x16x32_bf16 v[108:111], v[208:211], a[40:43], v[108:111]
    v_mfma_f32_16x16x32_bf16 v[112:115], v[208:211], a[44:47], v[112:115]
    s_waitcnt vmcnt(22)
    v_mfma_f32_16x16x32_bf16 v[116:119], v[212:215], a[32:35], v[116:119]
    v_mfma_f32_16x16x32_bf16 v[120:123], v[212:215], a[36:39], v[120:123]
    v_mfma_f32_16x16x32_bf16 v[124:127], v[212:215], a[40:43], v[124:127]
    v_mfma_f32_16x16x32_bf16 v[128:131], v[212:215], a[44:47], v[128:131]
    s_mul_i32 s5, s50, 14336
    s_add_u32 s5, s5, 7168
    v_add_u32 v216, s5, v217
    global_load_dwordx4 v[188:191], v216, s[38:39] offset:-3072 sc1
    global_load_dwordx4 v[192:195], v216, s[38:39] offset:-2048 sc1
    global_load_dwordx4 v[196:199], v216, s[38:39] offset:-1024 sc1
    global_load_dwordx4 v[200:203], v216, s[38:39] offset:0 sc1
    global_load_dwordx4 v[204:207], v216, s[38:39] offset:1024 sc1
    global_load_dwordx4 v[208:211], v216, s[38:39] offset:2048 sc1
    global_load_dwordx4 v[212:215], v216, s[38:39] offset:3072 sc1
    s_waitcnt lgkmcnt(0)
    s_lshl_b32 s4, s51, 7
    s_add_u32 m0, s6, 8192
    v_add_u32 v19, s4, v6
    global_load_lds_dwordx4 v19, s[24:25] nt
    s_add_u32 m0, s6, 9216
    v_add_u32 v19, s4, v7
    global_load_lds_dwordx4 v19, s[24:25] nt
    s_add_u32 m0, s6, 10240
    v_add_u32 v19, s4, v8
    global_load_lds_dwordx4 v19, s[24:25] nt
    s_add_u32 m0, s6, 11264
    v_add_u32 v19, s4, v9
    global_load_lds_dwordx4 v19, s[24:25] nt
    s_add_u32 m0, s6, 12288
    s_add_u32 s4, s4, 131072
    v_add_u32 v19, s4, v6
    global_load_lds_dwordx4 v19, s[24:25] nt
    s_add_u32 m0, s6, 13312
    v_add_u32 v19, s4, v7
    global_load_lds_dwordx4 v19, s[24:25] nt
    s_add_u32 m0, s6, 14336
    v_add_u32 v19, s4, v8
    global_load_lds_dwordx4 v19, s[24:25] nt
    s_add_u32 m0, s6, 15360
    v_add_u32 v19, s4, v9
    global_load_lds_dwordx4 v19, s[24:25] nt
    s_waitcnt vmcnt(36)
    v_mfma_f32_16x16x32_bf16 v[20:23], v[132:135], a[48:51], v[20:23]
    v_mfma_f32_16x16x32_bf16 v[24:27], v[132:135], a[52:55], v[24:27]
    v_mfma_f32_16x16x32_bf16 v[28:31], v[132:135], a[56:59], v[28:31]
    v_mfma_f32_16x16x32_bf16 v[32:35], v[132:135], a[60:63], v[32:35]
    s_waitcnt vmcnt(35)
    v_mfma_f32_16x16x32_bf16 v[36:39], v[136:139], a[48:51], v[36:39]
    v_mfma_f32_16x16x32_bf16 v[40:43], v[136:139], a[52:55], v[40:43]
    v_mfma_f32_16x16x32_bf16 v[44:47], v[136:139], a[56:59], v[44:47]
    v_mfma_f32_16x16x32_bf16 v[48:51], v[136:139], a[60:63], v[48:51]
    s_waitcnt vmcnt(34)
    v_mfma_f32_16x16x32_bf16 v[52:55], v[140:143], a[48:51], v[52:55]
    v_mfma_f32_16x16x32_bf16 v[56:59], v[140:143], a[52:55], v[56:59]
    v_mfma_f32_16x16x32_bf16 v[60:63], v[140:143], a[56:59], v[60:63]
    v_mfma_f32_16x16x32_bf16 v[64:67], v[140:143], a[60:63], v[64:67]
    s_waitcnt vmcnt(33)
    v_mfma_f32_16x16x32_bf16 v[68:71], v[144:147], a[48:51], v[68:71]
    v_mfma_f32_16x16x32_bf16 v[72:75], v[144:147], a[52:55], v[72:75]
    v_mfma_f32_16x16x32_bf16 v[76:79], v[144:147], a[56:59], v[76:79]
    v_mfma_f32_16x16x32_bf16 v[80:83], v[144:147], a[60:63], v[80:83]
    s_waitcnt vmcnt(32)
    v_mfma_f32_16x16x32_bf16 v[84:87], v[148:151], a[48:51], v[84:87]
    v_mfma_f32_16x16x32_bf16 v[88:91], v[148:151], a[52:55], v[88:91]
    v_mfma_f32_16x16x32_bf16 v[92:95], v[148:151], a[56:59], v[92:95]
    v_mfma_f32_16x16x32_bf16 v[96:99], v[148:151], a[60:63], v[96:99]
    s_waitcnt vmcnt(31)
    v_mfma_f32_16x16x32_bf16 v[100:103], v[152:155], a[48:51], v[100:103]
    v_mfma_f32_16x16x32_bf16 v[104:107], v[152:155], a[52:55], v[104:107]
    v_mfma_f32_16x16x32_bf16 v[108:111], v[152:155], a[56:59], v[108:111]
    v_mfma_f32_16x16x32_bf16 v[112:115], v[152:155], a[60:63], v[112:115]
    s_waitcnt vmcnt(30)
    v_mfma_f32_16x16x32_bf16 v[116:119], v[156:159], a[48:51], v[116:119]
    v_mfma_f32_16x16x32_bf16 v[120:123], v[156:159], a[52:55], v[120:123]
    v_mfma_f32_16x16x32_bf16 v[124:127], v[156:159], a[56:59], v[124:127]
    v_mfma_f32_16x16x32_bf16 v[128:131], v[156:159], a[60:63], v[128:131]
    s_waitcnt vmcnt(22)
    ds_read_b128 a[64:67], v10 offset:0
    ds_read_b128 a[68:71], v12 offset:0
    ds_read_b128 a[72:75], v14 offset:0
    ds_read_b128 a[76:79], v16 offset:0
    ds_read_b128 a[80:83], v11 offset:0
    ds_read_b128 a[84:87], v13 offset:0
    ds_read_b128 a[88:91], v15 offset:0
    ds_read_b128 a[92:95], v17 offset:0
    s_mul_i32 s5, s51, 14336
    v_add_u32 v216, s5, v217
    global_load_dwordx4 v[132:135], v216, s[38:39] offset:-3072 sc1
    global_load_dwordx4 v[136:139], v216, s[38:39] offset:-2048 sc1
    global_load_dwordx4 v[140:143], v216, s[38:39] offset:-1024 sc1
    global_load_dwordx4 v[144:147], v216, s[38:39] offset:0 sc1
    global_load_dwordx4 v[148:151], v216, s[38:39] offset:1024 sc1
    global_load_dwordx4 v[152:155], v216, s[38:39] offset:2048 sc1
    global_load_dwordx4 v[156:159], v216, s[38:39] offset:3072 sc1
    s_waitcnt vmcnt(28) lgkmcnt(7)
    v_mfma_f32_16x16x32_bf16 v[20:23], v[160:163], a[64:67], v[20:23]
    s_waitcnt lgkmcnt(6)
    v_mfma_f32_16x16x32_bf16 v[24:27], v[160:163], a[68:71], v[24:27]
    s_waitcnt lgkmcnt(5)
    v_mfma_f32_16x16x32_bf16 v[28:31], v[160:163], a[72:75], v[28:31]
    s_waitcnt lgkmcnt(4)
    v_mfma_f32_16x16x32_bf16 v[32:35], v[160:163], a[76:79], v[32:35]
    s_waitcnt vmcnt(27)
    v_mfma_f32_16x16x32_bf16 v[36:39], v[164:167], a[64:67], v[36:39]
    v_mfma_f32_16x16x32_bf16 v[40:43], v[164:167], a[68:71], v[40:43]
    v_mfma_f32_16x16x32_bf16 v[44:47], v[164:167], a[72:75], v[44:47]
    v_mfma_f32_16x16x32_bf16 v[48:51], v[164:167], a[76:79], v[48:51]
    s_waitcnt vmcnt(26)
    v_mfma_f32_16x16x32_bf16 v[52:55], v[168:171], a[64:67], v[52:55]
    v_mfma_f32_16x16x32_bf16 v[56:59], v[168:171], a[68:71], v[56:59]
    v_mfma_f32_16x16x32_bf16 v[60:63], v[168:171], a[72:75], v[60:63]
    v_mfma_f32_16x16x32_bf16 v[64:67], v[168:171], a[76:79], v[64:67]
    s_waitcnt vmcnt(25)
    v_mfma_f32_16x16x32_bf16 v[68:71], v[172:175], a[64:67], v[68:71]
    v_mfma_f32_16x16x32_bf16 v[72:75], v[172:175], a[68:71], v[72:75]
    v_mfma_f32_16x16x32_bf16 v[76:79], v[172:175], a[72:75], v[76:79]
    v_mfma_f32_16x16x32_bf16 v[80:83], v[172:175], a[76:79], v[80:83]
    s_waitcnt vmcnt(24)
    v_mfma_f32_16x16x32_bf16 v[84:87], v[176:179], a[64:67], v[84:87]
    v_mfma_f32_16x16x32_bf16 v[88:91], v[176:179], a[68:71], v[88:91]
    v_mfma_f32_16x16x32_bf16 v[92:95], v[176:179], a[72:75], v[92:95]
    v_mfma_f32_16x16x32_bf16 v[96:99], v[176:179], a[76:79], v[96:99]
    s_waitcnt vmcnt(23)
    v_mfma_f32_16x16x32_bf16 v[100:103], v[180:183], a[64:67], v[100:103]
    v_mfma_f32_16x16x32_bf16 v[104:107], v[180:183], a[68:71], v[104:107]
    v_mfma_f32_16x16x32_bf16 v[108:111], v[180:183], a[72:75], v[108:111]
    v_mfma_f32_16x16x32_bf16 v[112:115], v[180:183], a[76:79], v[112:115]
    s_waitcnt vmcnt(22)
    v_mfma_f32_16x16x32_bf16 v[116:119], v[184:187], a[64:67], v[116:119]
    v_mfma_f32_16x16x32_bf16 v[120:123], v[184:187], a[68:71], v[120:123]
    v_mfma_f32_16x16x32_bf16 v[124:127], v[184:187], a[72:75], v[124:127]
    v_mfma_f32_16x16x32_bf16 v[128:131], v[184:187], a[76:79], v[128:131]
    s_mul_i32 s5, s51, 14336
    s_add_u32 s5, s5, 7168
    v_add_u32 v216, s5, v217
    global_load_dwordx4 v[160:163], v216, s[38:39] offset:-3072 sc1
    global_load_dwordx4 v[164:167], v216, s[38:39] offset:-2048 sc1
    global_load_dwordx4 v[168:171], v216, s[38:39] offset:-1024 sc1
    global_load_dwordx4 v[172:175], v216, s[38:39] offset:0 sc1
    global_load_dwordx4 v[176:179], v216, s[38:39] offset:1024 sc1
    global_load_dwordx4 v[180:183], v216, s[38:39] offset:2048 sc1
    global_load_dwordx4 v[184:187], v216, s[38:39] offset:3072 sc1
    s_waitcnt lgkmcnt(0)
    s_lshl_b32 s4, s52, 7
    s_add_u32 m0, s6, 0
    v_add_u32 v19, s4, v6
    global_load_lds_dwordx4 v19, s[24:25] nt
    s_add_u32 m0, s6, 1024
    v_add_u32 v19, s4, v7
    global_load_lds_dwordx4 v19, s[24:25] nt
    s_add_u32 m0, s6, 2048
    v_add_u32 v19, s4, v8
    global_load_lds_dwordx4 v19, s[24:25] nt
    s_add_u32 m0, s6, 3072
    v_add_u32 v19, s4, v9
    global_load_lds_dwordx4 v19, s[24:25] nt
    s_add_u32 m0, s6, 4096
    s_add_u32 s4, s4, 131072
    v_add_u32 v19, s4, v6
    global_load_lds_dwordx4 v19, s[24:25] nt
    s_add_u32 m0, s6, 5120
    v_add_u32 v19, s4, v7
    global_load_lds_dwordx4 v19, s[24:25] nt
    s_add_u32 m0, s6, 6144
    v_add_u32 v19, s4, v8
    global_load_lds_dwordx4 v19, s[24:25] nt
    s_add_u32 m0, s6, 7168
    v_add_u32 v19, s4, v9
    global_load_lds_dwordx4 v19, s[24:25] nt
    s_waitcnt vmcnt(36)
    v_mfma_f32_16x16x32_bf16 v[20:23], v[188:191], a[80:83], v[20:23]
    v_mfma_f32_16x16x32_bf16 v[24:27], v[188:191], a[84:87], v[24:27]
    v_mfma_f32_16x16x32_bf16 v[28:31], v[188:191], a[88:91], v[28:31]
    v_mfma_f32_16x16x32_bf16 v[32:35], v[188:191], a[92:95], v[32:35]
    s_waitcnt vmcnt(35)
    v_mfma_f32_16x16x32_bf16 v[36:39], v[192:195], a[80:83], v[36:39]
    v_mfma_f32_16x16x32_bf16 v[40:43], v[192:195], a[84:87], v[40:43]
    v_mfma_f32_16x16x32_bf16 v[44:47], v[192:195], a[88:91], v[44:47]
    v_mfma_f32_16x16x32_bf16 v[48:51], v[192:195], a[92:95], v[48:51]
    s_waitcnt vmcnt(34)
    v_mfma_f32_16x16x32_bf16 v[52:55], v[196:199], a[80:83], v[52:55]
    v_mfma_f32_16x16x32_bf16 v[56:59], v[196:199], a[84:87], v[56:59]
    v_mfma_f32_16x16x32_bf16 v[60:63], v[196:199], a[88:91], v[60:63]
    v_mfma_f32_16x16x32_bf16 v[64:67], v[196:199], a[92:95], v[64:67]
    s_waitcnt vmcnt(33)
    v_mfma_f32_16x16x32_bf16 v[68:71], v[200:203], a[80:83], v[68:71]
    v_mfma_f32_16x16x32_bf16 v[72:75], v[200:203], a[84:87], v[72:75]
    v_mfma_f32_16x16x32_bf16 v[76:79], v[200:203], a[88:91], v[76:79]
    v_mfma_f32_16x16x32_bf16 v[80:83], v[200:203], a[92:95], v[80:83]
    s_waitcnt vmcnt(32)
    v_mfma_f32_16x16x32_bf16 v[84:87], v[204:207], a[80:83], v[84:87]
    v_mfma_f32_16x16x32_bf16 v[88:91], v[204:207], a[84:87], v[88:91]
    v_mfma_f32_16x16x32_bf16 v[92:95], v[204:207], a[88:91], v[92:95]
    v_mfma_f32_16x16x32_bf16 v[96:99], v[204:207], a[92:95], v[96:99]
    s_waitcnt vmcnt(31)
    v_mfma_f32_16x16x32_bf16 v[100:103], v[208:211], a[80:83], v[100:103]
    v_mfma_f32_16x16x32_bf16 v[104:107], v[208:211], a[84:87], v[104:107]
    v_mfma_f32_16x16x32_bf16 v[108:111], v[208:211], a[88:91], v[108:111]
    v_mfma_f32_16x16x32_bf16 v[112:115], v[208:211], a[92:95], v[112:115]
    s_waitcnt vmcnt(30)
    v_mfma_f32_16x16x32_bf16 v[116:119], v[212:215], a[80:83], v[116:119]
    v_mfma_f32_16x16x32_bf16 v[120:123], v[212:215], a[84:87], v[120:123]
    v_mfma_f32_16x16x32_bf16 v[124:127], v[212:215], a[88:91], v[124:127]
    v_mfma_f32_16x16x32_bf16 v[128:131], v[212:215], a[92:95], v[128:131]
    s_waitcnt vmcnt(22)
    ds_read_b128 a[96:99], v10 offset:8192
    ds_read_b128 a[100:103], v12 offset:8192
    ds_read_b128 a[104:107], v14 offset:8192
    ds_read_b128 a[108:111], v16 offset:8192
    ds_read_b128 a[112:115], v11 offset:8192
    ds_read_b128 a[116:119], v13 offset:8192
    ds_read_b128 a[120:123], v15 offset:8192
    ds_read_b128 a[124:127], v17 offset:8192
    s_mul_i32 s5, s52, 14336
    v_add_u32 v216, s5, v217
    global_load_dwordx4 v[188:191], v216, s[38:39] offset:-3072 sc1
    global_load_dwordx4 v[192:195], v216, s[38:39] offset:-2048 sc1
    global_load_dwordx4 v[196:199], v216, s[38:39] offset:-1024 sc1
    global_load_dwordx4 v[200:203], v216, s[38:39] offset:0 sc1
    global_load_dwordx4 v[204:207], v216, s[38:39] offset:1024 sc1
    global_load_dwordx4 v[208:211], v216, s[38:39] offset:2048 sc1
    global_load_dwordx4 v[212:215], v216, s[38:39] offset:3072 sc1
    s_waitcnt vmcnt(28) lgkmcnt(7)
    v_mfma_f32_16x16x32_bf16 v[20:23], v[132:135], a[96:99], v[20:23]
    s_waitcnt lgkmcnt(6)
    v_mfma_f32_16x16x32_bf16 v[24:27], v[132:135], a[100:103], v[24:27]
    s_waitcnt lgkmcnt(5)
    v_mfma_f32_16x16x32_bf16 v[28:31], v[132:135], a[104:107], v[28:31]
    s_waitcnt lgkmcnt(4)
    v_mfma_f32_16x16x32_bf16 v[32:35], v[132:135], a[108:111], v[32:35]
    s_waitcnt vmcnt(27)
    v_mfma_f32_16x16x32_bf16 v[36:39], v[136:139], a[96:99], v[36:39]
    v_mfma_f32_16x16x32_bf16 v[40:43], v[136:139], a[100:103], v[40:43]
    v_mfma_f32_16x16x32_bf16 v[44:47], v[136:139], a[104:107], v[44:47]
    v_mfma_f32_16x16x32_bf16 v[48:51], v[136:139], a[108:111], v[48:51]
    s_waitcnt vmcnt(26)
    v_mfma_f32_16x16x32_bf16 v[52:55], v[140:143], a[96:99], v[52:55]
    v_mfma_f32_16x16x32_bf16 v[56:59], v[140:143], a[100:103], v[56:59]
    v_mfma_f32_16x16x32_bf16 v[60:63], v[140:143], a[104:107], v[60:63]
    v_mfma_f32_16x16x32_bf16 v[64:67], v[140:143], a[108:111], v[64:67]
    s_waitcnt vmcnt(25)
    v_mfma_f32_16x16x32_bf16 v[68:71], v[144:147], a[96:99], v[68:71]
    v_mfma_f32_16x16x32_bf16 v[72:75], v[144:147], a[100:103], v[72:75]
    v_mfma_f32_16x16x32_bf16 v[76:79], v[144:147], a[104:107], v[76:79]
    v_mfma_f32_16x16x32_bf16 v[80:83], v[144:147], a[108:111], v[80:83]
    s_waitcnt vmcnt(24)
    v_mfma_f32_16x16x32_bf16 v[84:87], v[148:151], a[96:99], v[84:87]
    v_mfma_f32_16x16x32_bf16 v[88:91], v[148:151], a[100:103], v[88:91]
    v_mfma_f32_16x16x32_bf16 v[92:95], v[148:151], a[104:107], v[92:95]
    v_mfma_f32_16x16x32_bf16 v[96:99], v[148:151], a[108:111], v[96:99]
    s_waitcnt vmcnt(23)
    v_mfma_f32_16x16x32_bf16 v[100:103], v[152:155], a[96:99], v[100:103]
    v_mfma_f32_16x16x32_bf16 v[104:107], v[152:155], a[100:103], v[104:107]
    v_mfma_f32_16x16x32_bf16 v[108:111], v[152:155], a[104:107], v[108:111]
    v_mfma_f32_16x16x32_bf16 v[112:115], v[152:155], a[108:111], v[112:115]
    s_waitcnt vmcnt(22)
    v_mfma_f32_16x16x32_bf16 v[116:119], v[156:159], a[96:99], v[116:119]
    v_mfma_f32_16x16x32_bf16 v[120:123], v[156:159], a[100:103], v[120:123]
    v_mfma_f32_16x16x32_bf16 v[124:127], v[156:159], a[104:107], v[124:127]
    v_mfma_f32_16x16x32_bf16 v[128:131], v[156:159], a[108:111], v[128:131]
    s_mul_i32 s5, s52, 14336
    s_add_u32 s5, s5, 7168
    v_add_u32 v216, s5, v217
    global_load_dwordx4 v[132:135], v216, s[38:39] offset:-3072 sc1
    global_load_dwordx4 v[136:139], v216, s[38:39] offset:-2048 sc1
    global_load_dwordx4 v[140:143], v216, s[38:39] offset:-1024 sc1
    global_load_dwordx4 v[144:147], v216, s[38:39] offset:0 sc1
    global_load_dwordx4 v[148:151], v216, s[38:39] offset:1024 sc1
    global_load_dwordx4 v[152:155], v216, s[38:39] offset:2048 sc1
    global_load_dwordx4 v[156:159], v216, s[38:39] offset:3072 sc1
    s_waitcnt lgkmcnt(0)
    s_lshl_b32 s4, s53, 7
    s_add_u32 m0, s6, 8192
    v_add_u32 v19, s4, v6
    global_load_lds_dwordx4 v19, s[24:25] nt
    s_add_u32 m0, s6, 9216
    v_add_u32 v19, s4, v7
    global_load_lds_dwordx4 v19, s[24:25] nt
    s_add_u32 m0, s6, 10240
    v_add_u32 v19, s4, v8
    global_load_lds_dwordx4 v19, s[24:25] nt
    s_add_u32 m0, s6, 11264
    v_add_u32 v19, s4, v9
    global_load_lds_dwordx4 v19, s[24:25] nt
    s_add_u32 m0, s6, 12288
    s_add_u32 s4, s4, 131072
    v_add_u32 v19, s4, v6
    global_load_lds_dwordx4 v19, s[24:25] nt
    s_add_u32 m0, s6, 13312
    v_add_u32 v19, s4, v7
    global_load_lds_dwordx4 v19, s[24:25] nt
    s_add_u32 m0, s6, 14336
    v_add_u32 v19, s4, v8
    global_load_lds_dwordx4 v19, s[24:25] nt
    s_add_u32 m0, s6, 15360
    v_add_u32 v19, s4, v9
    global_load_lds_dwordx4 v19, s[24:25] nt
    s_waitcnt vmcnt(36)
    v_mfma_f32_16x16x32_bf16 v[20:23], v[160:163], a[112:115], v[20:23]
    v_mfma_f32_16x16x32_bf16 v[24:27], v[160:163], a[116:119], v[24:27]
    v_mfma_f32_16x16x32_bf16 v[28:31], v[160:163], a[120:123], v[28:31]
    v_mfma_f32_16x16x32_bf16 v[32:35], v[160:163], a[124:127], v[32:35]
    s_waitcnt vmcnt(35)
    v_mfma_f32_16x16x32_bf16 v[36:39], v[164:167], a[112:115], v[36:39]
    v_mfma_f32_16x16x32_bf16 v[40:43], v[164:167], a[116:119], v[40:43]
    v_mfma_f32_16x16x32_bf16 v[44:47], v[164:167], a[120:123], v[44:47]
    v_mfma_f32_16x16x32_bf16 v[48:51], v[164:167], a[124:127], v[48:51]
    s_waitcnt vmcnt(34)
    v_mfma_f32_16x16x32_bf16 v[52:55], v[168:171], a[112:115], v[52:55]
    v_mfma_f32_16x16x32_bf16 v[56:59], v[168:171], a[116:119], v[56:59]
    v_mfma_f32_16x16x32_bf16 v[60:63], v[168:171], a[120:123], v[60:63]
    v_mfma_f32_16x16x32_bf16 v[64:67], v[168:171], a[124:127], v[64:67]
    s_waitcnt vmcnt(33)
    v_mfma_f32_16x16x32_bf16 v[68:71], v[172:175], a[112:115], v[68:71]
    v_mfma_f32_16x16x32_bf16 v[72:75], v[172:175], a[116:119], v[72:75]
    v_mfma_f32_16x16x32_bf16 v[76:79], v[172:175], a[120:123], v[76:79]
    v_mfma_f32_16x16x32_bf16 v[80:83], v[172:175], a[124:127], v[80:83]
    s_waitcnt vmcnt(32)
    v_mfma_f32_16x16x32_bf16 v[84:87], v[176:179], a[112:115], v[84:87]
    v_mfma_f32_16x16x32_bf16 v[88:91], v[176:179], a[116:119], v[88:91]
    v_mfma_f32_16x16x32_bf16 v[92:95], v[176:179], a[120:123], v[92:95]
    v_mfma_f32_16x16x32_bf16 v[96:99], v[176:179], a[124:127], v[96:99]
    s_waitcnt vmcnt(31)
    v_mfma_f32_16x16x32_bf16 v[100:103], v[180:183], a[112:115], v[100:103]
    v_mfma_f32_16x16x32_bf16 v[104:107], v[180:183], a[116:119], v[104:107]
    v_mfma_f32_16x16x32_bf16 v[108:111], v[180:183], a[120:123], v[108:111]
    v_mfma_f32_16x16x32_bf16 v[112:115], v[180:183], a[124:127], v[112:115]
    s_waitcnt vmcnt(30)
    v_mfma_f32_16x16x32_bf16 v[116:119], v[184:187], a[112:115], v[116:119]
    v_mfma_f32_16x16x32_bf16 v[120:123], v[184:187], a[116:119], v[120:123]
    v_mfma_f32_16x16x32_bf16 v[124:127], v[184:187], a[120:123], v[124:127]
    v_mfma_f32_16x16x32_bf16 v[128:131], v[184:187], a[124:127], v[128:131]
    s_waitcnt vmcnt(22)
    ds_read_b128 a[128:131], v10 offset:0
    ds_read_b128 a[132:135], v12 offset:0
    ds_read_b128 a[136:139], v14 offset:0
    ds_read_b128 a[140:143], v16 offset:0
    ds_read_b128 a[144:147], v11 offset:0
    ds_read_b128 a[148:151], v13 offset:0
    ds_read_b128 a[152:155], v15 offset:0
    ds_read_b128 a[156:159], v17 offset:0
    s_mul_i32 s5, s53, 14336
    v_add_u32 v216, s5, v217
    global_load_dwordx4 v[160:163], v216, s[38:39] offset:-3072 sc1
    global_load_dwordx4 v[164:167], v216, s[38:39] offset:-2048 sc1
    global_load_dwordx4 v[168:171], v216, s[38:39] offset:-1024 sc1
    global_load_dwordx4 v[172:175], v216, s[38:39] offset:0 sc1
    global_load_dwordx4 v[176:179], v216, s[38:39] offset:1024 sc1
    global_load_dwordx4 v[180:183], v216, s[38:39] offset:2048 sc1
    global_load_dwordx4 v[184:187], v216, s[38:39] offset:3072 sc1
    s_waitcnt vmcnt(28) lgkmcnt(7)
    v_mfma_f32_16x16x32_bf16 v[20:23], v[188:191], a[128:131], v[20:23]
    s_waitcnt lgkmcnt(6)
    v_mfma_f32_16x16x32_bf16 v[24:27], v[188:191], a[132:135], v[24:27]
    s_waitcnt lgkmcnt(5)
    v_mfma_f32_16x16x32_bf16 v[28:31], v[188:191], a[136:139], v[28:31]
    s_waitcnt lgkmcnt(4)
    v_mfma_f32_16x16x32_bf16 v[32:35], v[188:191], a[140:143], v[32:35]
    s_waitcnt vmcnt(27)
    v_mfma_f32_16x16x32_bf16 v[36:39], v[192:195], a[128:131], v[36:39]
    v_mfma_f32_16x16x32_bf16 v[40:43], v[192:195], a[132:135], v[40:43]
    v_mfma_f32_16x16x32_bf16 v[44:47], v[192:195], a[136:139], v[44:47]
    v_mfma_f32_16x16x32_bf16 v[48:51], v[192:195], a[140:143], v[48:51]
    s_waitcnt vmcnt(26)
    v_mfma_f32_16x16x32_bf16 v[52:55], v[196:199], a[128:131], v[52:55]
    v_mfma_f32_16x16x32_bf16 v[56:59], v[196:199], a[132:135], v[56:59]
    v_mfma_f32_16x16x32_bf16 v[60:63], v[196:199], a[136:139], v[60:63]
    v_mfma_f32_16x16x32_bf16 v[64:67], v[196:199], a[140:143], v[64:67]
    s_waitcnt vmcnt(25)
    v_mfma_f32_16x16x32_bf16 v[68:71], v[200:203], a[128:131], v[68:71]
    v_mfma_f32_16x16x32_bf16 v[72:75], v[200:203], a[132:135], v[72:75]
    v_mfma_f32_16x16x32_bf16 v[76:79], v[200:203], a[136:139], v[76:79]
    v_mfma_f32_16x16x32_bf16 v[80:83], v[200:203], a[140:143], v[80:83]
    s_waitcnt vmcnt(24)
    v_mfma_f32_16x16x32_bf16 v[84:87], v[204:207], a[128:131], v[84:87]
    v_mfma_f32_16x16x32_bf16 v[88:91], v[204:207], a[132:135], v[88:91]
    v_mfma_f32_16x16x32_bf16 v[92:95], v[204:207], a[136:139], v[92:95]
    v_mfma_f32_16x16x32_bf16 v[96:99], v[204:207], a[140:143], v[96:99]
    s_waitcnt vmcnt(23)
    v_mfma_f32_16x16x32_bf16 v[100:103], v[208:211], a[128:131], v[100:103]
    v_mfma_f32_16x16x32_bf16 v[104:107], v[208:211], a[132:135], v[104:107]
    v_mfma_f32_16x16x32_bf16 v[108:111], v[208:211], a[136:139], v[108:111]
    v_mfma_f32_16x16x32_bf16 v[112:115], v[208:211], a[140:143], v[112:115]
    s_waitcnt vmcnt(22)
    v_mfma_f32_16x16x32_bf16 v[116:119], v[212:215], a[128:131], v[116:119]
    v_mfma_f32_16x16x32_bf16 v[120:123], v[212:215], a[132:135], v[120:123]
    v_mfma_f32_16x16x32_bf16 v[124:127], v[212:215], a[136:139], v[124:127]
    v_mfma_f32_16x16x32_bf16 v[128:131], v[212:215], a[140:143], v[128:131]
    s_mul_i32 s5, s53, 14336
    s_add_u32 s5, s5, 7168
    v_add_u32 v216, s5, v217
    global_load_dwordx4 v[188:191], v216, s[38:39] offset:-3072 sc1
    global_load_dwordx4 v[192:195], v216, s[38:39] offset:-2048 sc1
    global_load_dwordx4 v[196:199], v216, s[38:39] offset:-1024 sc1
    global_load_dwordx4 v[200:203], v216, s[38:39] offset:0 sc1
    global_load_dwordx4 v[204:207], v216, s[38:39] offset:1024 sc1
    global_load_dwordx4 v[208:211], v216, s[38:39] offset:2048 sc1
    global_load_dwordx4 v[212:215], v216, s[38:39] offset:3072 sc1
    s_waitcnt lgkmcnt(0)
    s_lshl_b32 s4, s54, 7
    s_add_u32 m0, s6, 0
    v_add_u32 v19, s4, v6
    global_load_lds_dwordx4 v19, s[24:25] nt
    s_add_u32 m0, s6, 1024
    v_add_u32 v19, s4, v7
    global_load_lds_dwordx4 v19, s[24:25] nt
    s_add_u32 m0, s6, 2048
    v_add_u32 v19, s4, v8
    global_load_lds_dwordx4 v19, s[24:25] nt
    s_add_u32 m0, s6, 3072
    v_add_u32 v19, s4, v9
    global_load_lds_dwordx4 v19, s[24:25] nt
    s_add_u32 m0, s6, 4096
    s_add_u32 s4, s4, 131072
    v_add_u32 v19, s4, v6
    global_load_lds_dwordx4 v19, s[24:25] nt
    s_add_u32 m0, s6, 5120
    v_add_u32 v19, s4, v7
    global_load_lds_dwordx4 v19, s[24:25] nt
    s_add_u32 m0, s6, 6144
    v_add_u32 v19, s4, v8
    global_load_lds_dwordx4 v19, s[24:25] nt
    s_add_u32 m0, s6, 7168
    v_add_u32 v19, s4, v9
    global_load_lds_dwordx4 v19, s[24:25] nt
    s_waitcnt vmcnt(36)
    v_mfma_f32_16x16x32_bf16 v[20:23], v[132:135], a[144:147], v[20:23]
    v_mfma_f32_16x16x32_bf16 v[24:27], v[132:135], a[148:151], v[24:27]
    v_mfma_f32_16x16x32_bf16 v[28:31], v[132:135], a[152:155], v[28:31]
    v_mfma_f32_16x16x32_bf16 v[32:35], v[132:135], a[156:159], v[32:35]
    s_waitcnt vmcnt(35)
    v_mfma_f32_16x16x32_bf16 v[36:39], v[136:139], a[144:147], v[36:39]
    v_mfma_f32_16x16x32_bf16 v[40:43], v[136:139], a[148:151], v[40:43]
    v_mfma_f32_16x16x32_bf16 v[44:47], v[136:139], a[152:155], v[44:47]
    v_mfma_f32_16x16x32_bf16 v[48:51], v[136:139], a[156:159], v[48:51]
    s_waitcnt vmcnt(34)
    v_mfma_f32_16x16x32_bf16 v[52:55], v[140:143], a[144:147], v[52:55]
    v_mfma_f32_16x16x32_bf16 v[56:59], v[140:143], a[148:151], v[56:59]
    v_mfma_f32_16x16x32_bf16 v[60:63], v[140:143], a[152:155], v[60:63]
    v_mfma_f32_16x16x32_bf16 v[64:67], v[140:143], a[156:159], v[64:67]
    s_waitcnt vmcnt(33)
    v_mfma_f32_16x16x32_bf16 v[68:71], v[144:147], a[144:147], v[68:71]
    v_mfma_f32_16x16x32_bf16 v[72:75], v[144:147], a[148:151], v[72:75]
    v_mfma_f32_16x16x32_bf16 v[76:79], v[144:147], a[152:155], v[76:79]
    v_mfma_f32_16x16x32_bf16 v[80:83], v[144:147], a[156:159], v[80:83]
    s_waitcnt vmcnt(32)
    v_mfma_f32_16x16x32_bf16 v[84:87], v[148:151], a[144:147], v[84:87]
    v_mfma_f32_16x16x32_bf16 v[88:91], v[148:151], a[148:151], v[88:91]
    v_mfma_f32_16x16x32_bf16 v[92:95], v[148:151], a[152:155], v[92:95]
    v_mfma_f32_16x16x32_bf16 v[96:99], v[148:151], a[156:159], v[96:99]
    s_waitcnt vmcnt(31)
    v_mfma_f32_16x16x32_bf16 v[100:103], v[152:155], a[144:147], v[100:103]
    v_mfma_f32_16x16x32_bf16 v[104:107], v[152:155], a[148:151], v[104:107]
    v_mfma_f32_16x16x32_bf16 v[108:111], v[152:155], a[152:155], v[108:111]
    v_mfma_f32_16x16x32_bf16 v[112:115], v[152:155], a[156:159], v[112:115]
    s_waitcnt vmcnt(30)
    v_mfma_f32_16x16x32_bf16 v[116:119], v[156:159], a[144:147], v[116:119]
    v_mfma_f32_16x16x32_bf16 v[120:123], v[156:159], a[148:151], v[120:123]
    v_mfma_f32_16x16x32_bf16 v[124:127], v[156:159], a[152:155], v[124:127]
    v_mfma_f32_16x16x32_bf16 v[128:131], v[156:159], a[156:159], v[128:131]
    s_waitcnt vmcnt(22)
    ds_read_b128 a[160:163], v10 offset:8192
    ds_read_b128 a[164:167], v12 offset:8192
    ds_read_b128 a[168:171], v14 offset:8192
    ds_read_b128 a[172:175], v16 offset:8192
    ds_read_b128 a[176:179], v11 offset:8192
    ds_read_b128 a[180:183], v13 offset:8192
    ds_read_b128 a[184:187], v15 offset:8192
    ds_read_b128 a[188:191], v17 offset:8192
    s_mul_i32 s5, s54, 14336
    v_add_u32 v216, s5, v217
    global_load_dwordx4 v[132:135], v216, s[38:39] offset:-3072 sc1
    global_load_dwordx4 v[136:139], v216, s[38:39] offset:-2048 sc1
    global_load_dwordx4 v[140:143], v216, s[38:39] offset:-1024 sc1
    global_load_dwordx4 v[144:147], v216, s[38:39] offset:0 sc1
    global_load_dwordx4 v[148:151], v216, s[38:39] offset:1024 sc1
    global_load_dwordx4 v[152:155], v216, s[38:39] offset:2048 sc1
    global_load_dwordx4 v[156:159], v216, s[38:39] offset:3072 sc1
    s_waitcnt vmcnt(28) lgkmcnt(7)
    v_mfma_f32_16x16x32_bf16 v[20:23], v[160:163], a[160:163], v[20:23]
    s_waitcnt lgkmcnt(6)
    v_mfma_f32_16x16x32_bf16 v[24:27], v[160:163], a[164:167], v[24:27]
    s_waitcnt lgkmcnt(5)
    v_mfma_f32_16x16x32_bf16 v[28:31], v[160:163], a[168:171], v[28:31]
    s_waitcnt lgkmcnt(4)
    v_mfma_f32_16x16x32_bf16 v[32:35], v[160:163], a[172:175], v[32:35]
    s_waitcnt vmcnt(27)
    v_mfma_f32_16x16x32_bf16 v[36:39], v[164:167], a[160:163], v[36:39]
    v_mfma_f32_16x16x32_bf16 v[40:43], v[164:167], a[164:167], v[40:43]
    v_mfma_f32_16x16x32_bf16 v[44:47], v[164:167], a[168:171], v[44:47]
    v_mfma_f32_16x16x32_bf16 v[48:51], v[164:167], a[172:175], v[48:51]
    s_waitcnt vmcnt(26)
    v_mfma_f32_16x16x32_bf16 v[52:55], v[168:171], a[160:163], v[52:55]
    v_mfma_f32_16x16x32_bf16 v[56:59], v[168:171], a[164:167], v[56:59]
    v_mfma_f32_16x16x32_bf16 v[60:63], v[168:171], a[168:171], v[60:63]
    v_mfma_f32_16x16x32_bf16 v[64:67], v[168:171], a[172:175], v[64:67]
    s_waitcnt vmcnt(25)
    v_mfma_f32_16x16x32_bf16 v[68:71], v[172:175], a[160:163], v[68:71]
    v_mfma_f32_16x16x32_bf16 v[72:75], v[172:175], a[164:167], v[72:75]
    v_mfma_f32_16x16x32_bf16 v[76:79], v[172:175], a[168:171], v[76:79]
    v_mfma_f32_16x16x32_bf16 v[80:83], v[172:175], a[172:175], v[80:83]
    s_waitcnt vmcnt(24)
    v_mfma_f32_16x16x32_bf16 v[84:87], v[176:179], a[160:163], v[84:87]
    v_mfma_f32_16x16x32_bf16 v[88:91], v[176:179], a[164:167], v[88:91]
    v_mfma_f32_16x16x32_bf16 v[92:95], v[176:179], a[168:171], v[92:95]
    v_mfma_f32_16x16x32_bf16 v[96:99], v[176:179], a[172:175], v[96:99]
    s_waitcnt vmcnt(23)
    v_mfma_f32_16x16x32_bf16 v[100:103], v[180:183], a[160:163], v[100:103]
    v_mfma_f32_16x16x32_bf16 v[104:107], v[180:183], a[164:167], v[104:107]
    v_mfma_f32_16x16x32_bf16 v[108:111], v[180:183], a[168:171], v[108:111]
    v_mfma_f32_16x16x32_bf16 v[112:115], v[180:183], a[172:175], v[112:115]
    s_waitcnt vmcnt(22)
    v_mfma_f32_16x16x32_bf16 v[116:119], v[184:187], a[160:163], v[116:119]
    v_mfma_f32_16x16x32_bf16 v[120:123], v[184:187], a[164:167], v[120:123]
    v_mfma_f32_16x16x32_bf16 v[124:127], v[184:187], a[168:171], v[124:127]
    v_mfma_f32_16x16x32_bf16 v[128:131], v[184:187], a[172:175], v[128:131]
    s_mul_i32 s5, s54, 14336
    s_add_u32 s5, s5, 7168
    v_add_u32 v216, s5, v217
    global_load_dwordx4 v[160:163], v216, s[38:39] offset:-3072 sc1
    global_load_dwordx4 v[164:167], v216, s[38:39] offset:-2048 sc1
    global_load_dwordx4 v[168:171], v216, s[38:39] offset:-1024 sc1
    global_load_dwordx4 v[172:175], v216, s[38:39] offset:0 sc1
    global_load_dwordx4 v[176:179], v216, s[38:39] offset:1024 sc1
    global_load_dwordx4 v[180:183], v216, s[38:39] offset:2048 sc1
    global_load_dwordx4 v[184:187], v216, s[38:39] offset:3072 sc1
    s_waitcnt lgkmcnt(0)
    s_lshl_b32 s4, s55, 7
    s_add_u32 m0, s6, 8192
    v_add_u32 v19, s4, v6
    global_load_lds_dwordx4 v19, s[24:25] nt
    s_add_u32 m0, s6, 9216
    v_add_u32 v19, s4, v7
    global_load_lds_dwordx4 v19, s[24:25] nt
    s_add_u32 m0, s6, 10240
    v_add_u32 v19, s4, v8
    global_load_lds_dwordx4 v19, s[24:25] nt
    s_add_u32 m0, s6, 11264
    v_add_u32 v19, s4, v9
    global_load_lds_dwordx4 v19, s[24:25] nt
    s_add_u32 m0, s6, 12288
    s_add_u32 s4, s4, 131072
    v_add_u32 v19, s4, v6
    global_load_lds_dwordx4 v19, s[24:25] nt
    s_add_u32 m0, s6, 13312
    v_add_u32 v19, s4, v7
    global_load_lds_dwordx4 v19, s[24:25] nt
    s_add_u32 m0, s6, 14336
    v_add_u32 v19, s4, v8
    global_load_lds_dwordx4 v19, s[24:25] nt
    s_add_u32 m0, s6, 15360
    v_add_u32 v19, s4, v9
    global_load_lds_dwordx4 v19, s[24:25] nt
    s_waitcnt vmcnt(36)
    v_mfma_f32_16x16x32_bf16 v[20:23], v[188:191], a[176:179], v[20:23]
    v_mfma_f32_16x16x32_bf16 v[24:27], v[188:191], a[180:183], v[24:27]
    v_mfma_f32_16x16x32_bf16 v[28:31], v[188:191], a[184:187], v[28:31]
    v_mfma_f32_16x16x32_bf16 v[32:35], v[188:191], a[188:191], v[32:35]
    s_waitcnt vmcnt(35)
    v_mfma_f32_16x16x32_bf16 v[36:39], v[192:195], a[176:179], v[36:39]
    v_mfma_f32_16x16x32_bf16 v[40:43], v[192:195], a[180:183], v[40:43]
    v_mfma_f32_16x16x32_bf16 v[44:47], v[192:195], a[184:187], v[44:47]
    v_mfma_f32_16x16x32_bf16 v[48:51], v[192:195], a[188:191], v[48:51]
    s_waitcnt vmcnt(34)
    v_mfma_f32_16x16x32_bf16 v[52:55], v[196:199], a[176:179], v[52:55]
    v_mfma_f32_16x16x32_bf16 v[56:59], v[196:199], a[180:183], v[56:59]
    v_mfma_f32_16x16x32_bf16 v[60:63], v[196:199], a[184:187], v[60:63]
    v_mfma_f32_16x16x32_bf16 v[64:67], v[196:199], a[188:191], v[64:67]
    s_waitcnt vmcnt(33)
    v_mfma_f32_16x16x32_bf16 v[68:71], v[200:203], a[176:179], v[68:71]
    v_mfma_f32_16x16x32_bf16 v[72:75], v[200:203], a[180:183], v[72:75]
    v_mfma_f32_16x16x32_bf16 v[76:79], v[200:203], a[184:187], v[76:79]
    v_mfma_f32_16x16x32_bf16 v[80:83], v[200:203], a[188:191], v[80:83]
    s_waitcnt vmcnt(32)
    v_mfma_f32_16x16x32_bf16 v[84:87], v[204:207], a[176:179], v[84:87]
    v_mfma_f32_16x16x32_bf16 v[88:91], v[204:207], a[180:183], v[88:91]
    v_mfma_f32_16x16x32_bf16 v[92:95], v[204:207], a[184:187], v[92:95]
    v_mfma_f32_16x16x32_bf16 v[96:99], v[204:207], a[188:191], v[96:99]
    s_waitcnt vmcnt(31)
    v_mfma_f32_16x16x32_bf16 v[100:103], v[208:211], a[176:179], v[100:103]
    v_mfma_f32_16x16x32_bf16 v[104:107], v[208:211], a[180:183], v[104:107]
    v_mfma_f32_16x16x32_bf16 v[108:111], v[208:211], a[184:187], v[108:111]
    v_mfma_f32_16x16x32_bf16 v[112:115], v[208:211], a[188:191], v[112:115]
    s_waitcnt vmcnt(30)
    v_mfma_f32_16x16x32_bf16 v[116:119], v[212:215], a[176:179], v[116:119]
    v_mfma_f32_16x16x32_bf16 v[120:123], v[212:215], a[180:183], v[120:123]
    v_mfma_f32_16x16x32_bf16 v[124:127], v[212:215], a[184:187], v[124:127]
    v_mfma_f32_16x16x32_bf16 v[128:131], v[212:215], a[188:191], v[128:131]
    s_waitcnt vmcnt(22)
    ds_read_b128 a[192:195], v10 offset:0
    ds_read_b128 a[196:199], v12 offset:0
    ds_read_b128 a[200:203], v14 offset:0
    ds_read_b128 a[204:207], v16 offset:0
    ds_read_b128 a[208:211], v11 offset:0
    ds_read_b128 a[212:215], v13 offset:0
    ds_read_b128 a[216:219], v15 offset:0
    ds_read_b128 a[220:223], v17 offset:0
    s_mul_i32 s5, s55, 14336
    v_add_u32 v216, s5, v217
    global_load_dwordx4 v[188:191], v216, s[38:39] offset:-3072 sc1
    global_load_dwordx4 v[192:195], v216, s[38:39] offset:-2048 sc1
    global_load_dwordx4 v[196:199], v216, s[38:39] offset:-1024 sc1
    global_load_dwordx4 v[200:203], v216, s[38:39] offset:0 sc1
    global_load_dwordx4 v[204:207], v216, s[38:39] offset:1024 sc1
    global_load_dwordx4 v[208:211], v216, s[38:39] offset:2048 sc1
    global_load_dwordx4 v[212:215], v216, s[38:39] offset:3072 sc1
    s_waitcnt vmcnt(28) lgkmcnt(7)
    v_mfma_f32_16x16x32_bf16 v[20:23], v[132:135], a[192:195], v[20:23]
    s_waitcnt lgkmcnt(6)
    v_mfma_f32_16x16x32_bf16 v[24:27], v[132:135], a[196:199], v[24:27]
    s_waitcnt lgkmcnt(5)
    v_mfma_f32_16x16x32_bf16 v[28:31], v[132:135], a[200:203], v[28:31]
    s_waitcnt lgkmcnt(4)
    v_mfma_f32_16x16x32_bf16 v[32:35], v[132:135], a[204:207], v[32:35]
    s_waitcnt vmcnt(27)
    v_mfma_f32_16x16x32_bf16 v[36:39], v[136:139], a[192:195], v[36:39]
    v_mfma_f32_16x16x32_bf16 v[40:43], v[136:139], a[196:199], v[40:43]
    v_mfma_f32_16x16x32_bf16 v[44:47], v[136:139], a[200:203], v[44:47]
    v_mfma_f32_16x16x32_bf16 v[48:51], v[136:139], a[204:207], v[48:51]
    s_waitcnt vmcnt(26)
    v_mfma_f32_16x16x32_bf16 v[52:55], v[140:143], a[192:195], v[52:55]
    v_mfma_f32_16x16x32_bf16 v[56:59], v[140:143], a[196:199], v[56:59]
    v_mfma_f32_16x16x32_bf16 v[60:63], v[140:143], a[200:203], v[60:63]
    v_mfma_f32_16x16x32_bf16 v[64:67], v[140:143], a[204:207], v[64:67]
    s_waitcnt vmcnt(25)
    v_mfma_f32_16x16x32_bf16 v[68:71], v[144:147], a[192:195], v[68:71]
    v_mfma_f32_16x16x32_bf16 v[72:75], v[144:147], a[196:199], v[72:75]
    v_mfma_f32_16x16x32_bf16 v[76:79], v[144:147], a[200:203], v[76:79]
    v_mfma_f32_16x16x32_bf16 v[80:83], v[144:147], a[204:207], v[80:83]
    s_waitcnt vmcnt(24)
    v_mfma_f32_16x16x32_bf16 v[84:87], v[148:151], a[192:195], v[84:87]
    v_mfma_f32_16x16x32_bf16 v[88:91], v[148:151], a[196:199], v[88:91]
    v_mfma_f32_16x16x32_bf16 v[92:95], v[148:151], a[200:203], v[92:95]
    v_mfma_f32_16x16x32_bf16 v[96:99], v[148:151], a[204:207], v[96:99]
    s_waitcnt vmcnt(23)
    v_mfma_f32_16x16x32_bf16 v[100:103], v[152:155], a[192:195], v[100:103]
    v_mfma_f32_16x16x32_bf16 v[104:107], v[152:155], a[196:199], v[104:107]
    v_mfma_f32_16x16x32_bf16 v[108:111], v[152:155], a[200:203], v[108:111]
    v_mfma_f32_16x16x32_bf16 v[112:115], v[152:155], a[204:207], v[112:115]
    s_waitcnt vmcnt(22)
    v_mfma_f32_16x16x32_bf16 v[116:119], v[156:159], a[192:195], v[116:119]
    v_mfma_f32_16x16x32_bf16 v[120:123], v[156:159], a[196:199], v[120:123]
    v_mfma_f32_16x16x32_bf16 v[124:127], v[156:159], a[200:203], v[124:127]
    v_mfma_f32_16x16x32_bf16 v[128:131], v[156:159], a[204:207], v[128:131]
    s_mul_i32 s5, s55, 14336
    s_add_u32 s5, s5, 7168
    v_add_u32 v216, s5, v217
    global_load_dwordx4 v[132:135], v216, s[38:39] offset:-3072 sc1
    global_load_dwordx4 v[136:139], v216, s[38:39] offset:-2048 sc1
    global_load_dwordx4 v[140:143], v216, s[38:39] offset:-1024 sc1
    global_load_dwordx4 v[144:147], v216, s[38:39] offset:0 sc1
    global_load_dwordx4 v[148:151], v216, s[38:39] offset:1024 sc1
    global_load_dwordx4 v[152:155], v216, s[38:39] offset:2048 sc1
    global_load_dwordx4 v[156:159], v216, s[38:39] offset:3072 sc1
    s_waitcnt vmcnt(28) lgkmcnt(3)
    v_mfma_f32_16x16x32_bf16 v[20:23], v[160:163], a[208:211], v[20:23]
    s_waitcnt lgkmcnt(2)
    v_mfma_f32_16x16x32_bf16 v[24:27], v[160:163], a[212:215], v[24:27]
    s_waitcnt lgkmcnt(1)
    v_mfma_f32_16x16x32_bf16 v[28:31], v[160:163], a[216:219], v[28:31]
    s_waitcnt lgkmcnt(0)
    v_mfma_f32_16x16x32_bf16 v[32:35], v[160:163], a[220:223], v[32:35]
    s_waitcnt vmcnt(27)
    v_mfma_f32_16x16x32_bf16 v[36:39], v[164:167], a[208:211], v[36:39]
    v_mfma_f32_16x16x32_bf16 v[40:43], v[164:167], a[212:215], v[40:43]
    v_mfma_f32_16x16x32_bf16 v[44:47], v[164:167], a[216:219], v[44:47]
    v_mfma_f32_16x16x32_bf16 v[48:51], v[164:167], a[220:223], v[48:51]
    s_waitcnt vmcnt(26)
    v_mfma_f32_16x16x32_bf16 v[52:55], v[168:171], a[208:211], v[52:55]
    v_mfma_f32_16x16x32_bf16 v[56:59], v[168:171], a[212:215], v[56:59]
    v_mfma_f32_16x16x32_bf16 v[60:63], v[168:171], a[216:219], v[60:63]
    v_mfma_f32_16x16x32_bf16 v[64:67], v[168:171], a[220:223], v[64:67]
    s_waitcnt vmcnt(25)
    v_mfma_f32_16x16x32_bf16 v[68:71], v[172:175], a[208:211], v[68:71]
    v_mfma_f32_16x16x32_bf16 v[72:75], v[172:175], a[212:215], v[72:75]
    v_mfma_f32_16x16x32_bf16 v[76:79], v[172:175], a[216:219], v[76:79]
    v_mfma_f32_16x16x32_bf16 v[80:83], v[172:175], a[220:223], v[80:83]
    s_waitcnt vmcnt(24)
    v_mfma_f32_16x16x32_bf16 v[84:87], v[176:179], a[208:211], v[84:87]
    v_mfma_f32_16x16x32_bf16 v[88:91], v[176:179], a[212:215], v[88:91]
    v_mfma_f32_16x16x32_bf16 v[92:95], v[176:179], a[216:219], v[92:95]
    v_mfma_f32_16x16x32_bf16 v[96:99], v[176:179], a[220:223], v[96:99]
    s_waitcnt vmcnt(23)
    v_mfma_f32_16x16x32_bf16 v[100:103], v[180:183], a[208:211], v[100:103]
    v_mfma_f32_16x16x32_bf16 v[104:107], v[180:183], a[212:215], v[104:107]
    v_mfma_f32_16x16x32_bf16 v[108:111], v[180:183], a[216:219], v[108:111]
    v_mfma_f32_16x16x32_bf16 v[112:115], v[180:183], a[220:223], v[112:115]
    s_waitcnt vmcnt(22)
    v_mfma_f32_16x16x32_bf16 v[116:119], v[184:187], a[208:211], v[116:119]
    v_mfma_f32_16x16x32_bf16 v[120:123], v[184:187], a[212:215], v[120:123]
    v_mfma_f32_16x16x32_bf16 v[124:127], v[184:187], a[216:219], v[124:127]
    v_mfma_f32_16x16x32_bf16 v[128:131], v[184:187], a[220:223], v[128:131]
    s_waitcnt vmcnt(14)
    ds_read_b128 a[224:227], v10 offset:8192
    ds_read_b128 a[228:231], v12 offset:8192
    ds_read_b128 a[232:235], v14 offset:8192
    ds_read_b128 a[236:239], v16 offset:8192
    ds_read_b128 a[240:243], v11 offset:8192
    ds_read_b128 a[244:247], v13 offset:8192
    ds_read_b128 a[248:251], v15 offset:8192
    ds_read_b128 a[252:255], v17 offset:8192
    s_waitcnt vmcnt(13) lgkmcnt(7)
    v_mfma_f32_16x16x32_bf16 v[20:23], v[188:191], a[224:227], v[20:23]
    s_waitcnt lgkmcnt(6)
    v_mfma_f32_16x16x32_bf16 v[24:27], v[188:191], a[228:231], v[24:27]
    s_waitcnt lgkmcnt(5)
    v_mfma_f32_16x16x32_bf16 v[28:31], v[188:191], a[232:235], v[28:31]
    s_waitcnt lgkmcnt(4)
    v_mfma_f32_16x16x32_bf16 v[32:35], v[188:191], a[236:239], v[32:35]
    s_waitcnt vmcnt(12)
    v_mfma_f32_16x16x32_bf16 v[36:39], v[192:195], a[224:227], v[36:39]
    v_mfma_f32_16x16x32_bf16 v[40:43], v[192:195], a[228:231], v[40:43]
    v_mfma_f32_16x16x32_bf16 v[44:47], v[192:195], a[232:235], v[44:47]
    v_mfma_f32_16x16x32_bf16 v[48:51], v[192:195], a[236:239], v[48:51]
    s_waitcnt vmcnt(11)
    v_mfma_f32_16x16x32_bf16 v[52:55], v[196:199], a[224:227], v[52:55]
    v_mfma_f32_16x16x32_bf16 v[56:59], v[196:199], a[228:231], v[56:59]
    v_mfma_f32_16x16x32_bf16 v[60:63], v[196:199], a[232:235], v[60:63]
    v_mfma_f32_16x16x32_bf16 v[64:67], v[196:199], a[236:239], v[64:67]
    s_waitcnt vmcnt(10)
    v_mfma_f32_16x16x32_bf16 v[68:71], v[200:203], a[224:227], v[68:71]
    v_mfma_f32_16x16x32_bf16 v[72:75], v[200:203], a[228:231], v[72:75]
    v_mfma_f32_16x16x32_bf16 v[76:79], v[200:203], a[232:235], v[76:79]
    v_mfma_f32_16x16x32_bf16 v[80:83], v[200:203], a[236:239], v[80:83]
    s_waitcnt vmcnt(9)
    v_mfma_f32_16x16x32_bf16 v[84:87], v[204:207], a[224:227], v[84:87]
    v_mfma_f32_16x16x32_bf16 v[88:91], v[204:207], a[228:231], v[88:91]
    v_mfma_f32_16x16x32_bf16 v[92:95], v[204:207], a[232:235], v[92:95]
    v_mfma_f32_16x16x32_bf16 v[96:99], v[204:207], a[236:239], v[96:99]
    s_waitcnt vmcnt(8)
    v_mfma_f32_16x16x32_bf16 v[100:103], v[208:211], a[224:227], v[100:103]
    v_mfma_f32_16x16x32_bf16 v[104:107], v[208:211], a[228:231], v[104:107]
    v_mfma_f32_16x16x32_bf16 v[108:111], v[208:211], a[232:235], v[108:111]
    v_mfma_f32_16x16x32_bf16 v[112:115], v[208:211], a[236:239], v[112:115]
    s_waitcnt vmcnt(7)
    v_mfma_f32_16x16x32_bf16 v[116:119], v[212:215], a[224:227], v[116:119]
    v_mfma_f32_16x16x32_bf16 v[120:123], v[212:215], a[228:231], v[120:123]
    v_mfma_f32_16x16x32_bf16 v[124:127], v[212:215], a[232:235], v[124:127]
    v_mfma_f32_16x16x32_bf16 v[128:131], v[212:215], a[236:239], v[128:131]
    s_waitcnt vmcnt(6) lgkmcnt(3)
    v_mfma_f32_16x16x32_bf16 v[20:23], v[132:135], a[240:243], v[20:23]
    s_waitcnt lgkmcnt(2)
    v_mfma_f32_16x16x32_bf16 v[24:27], v[132:135], a[244:247], v[24:27]
    s_waitcnt lgkmcnt(1)
    v_mfma_f32_16x16x32_bf16 v[28:31], v[132:135], a[248:251], v[28:31]
    s_waitcnt lgkmcnt(0)
    v_mfma_f32_16x16x32_bf16 v[32:35], v[132:135], a[252:255], v[32:35]
    s_waitcnt vmcnt(5)
    v_mfma_f32_16x16x32_bf16 v[36:39], v[136:139], a[240:243], v[36:39]
    v_mfma_f32_16x16x32_bf16 v[40:43], v[136:139], a[244:247], v[40:43]
    v_mfma_f32_16x16x32_bf16 v[44:47], v[136:139], a[248:251], v[44:47]
    v_mfma_f32_16x16x32_bf16 v[48:51], v[136:139], a[252:255], v[48:51]
    s_waitcnt vmcnt(4)
    v_mfma_f32_16x16x32_bf16 v[52:55], v[140:143], a[240:243], v[52:55]
    v_mfma_f32_16x16x32_bf16 v[56:59], v[140:143], a[244:247], v[56:59]
    v_mfma_f32_16x16x32_bf16 v[60:63], v[140:143], a[248:251], v[60:63]
    v_mfma_f32_16x16x32_bf16 v[64:67], v[140:143], a[252:255], v[64:67]
    s_waitcnt vmcnt(3)
    v_mfma_f32_16x16x32_bf16 v[68:71], v[144:147], a[240:243], v[68:71]
    v_mfma_f32_16x16x32_bf16 v[72:75], v[144:147], a[244:247], v[72:75]
    v_mfma_f32_16x16x32_bf16 v[76:79], v[144:147], a[248:251], v[76:79]
    v_mfma_f32_16x16x32_bf16 v[80:83], v[144:147], a[252:255], v[80:83]
    s_waitcnt vmcnt(2)
    v_mfma_f32_16x16x32_bf16 v[84:87], v[148:151], a[240:243], v[84:87]
    v_mfma_f32_16x16x32_bf16 v[88:91], v[148:151], a[244:247], v[88:91]
    v_mfma_f32_16x16x32_bf16 v[92:95], v[148:151], a[248:251], v[92:95]
    v_mfma_f32_16x16x32_bf16 v[96:99], v[148:151], a[252:255], v[96:99]
    s_waitcnt vmcnt(1)
    v_mfma_f32_16x16x32_bf16 v[100:103], v[152:155], a[240:243], v[100:103]
    v_mfma_f32_16x16x32_bf16 v[104:107], v[152:155], a[244:247], v[104:107]
    v_mfma_f32_16x16x32_bf16 v[108:111], v[152:155], a[248:251], v[108:111]
    v_mfma_f32_16x16x32_bf16 v[112:115], v[152:155], a[252:255], v[112:115]
    s_waitcnt vmcnt(0)
    v_mfma_f32_16x16x32_bf16 v[116:119], v[156:159], a[240:243], v[116:119]
    v_mfma_f32_16x16x32_bf16 v[120:123], v[156:159], a[244:247], v[120:123]
    v_mfma_f32_16x16x32_bf16 v[124:127], v[156:159], a[248:251], v[124:127]
    v_mfma_f32_16x16x32_bf16 v[128:131], v[156:159], a[252:255], v[128:131]
    s_lshl_b32 s4, s60, 3
    s_add_u32 s4, s4, s61
    s_lshl_b32 s4, s4, 2
    s_add_u32 s4, s4, s3
    s_mul_i32 s4, s4, 3584
    s_add_u32 s4, s4, 20971520
    v_lshl_add_u32 v4, v1, 3, s4
    global_load_dwordx2 v[160:161], v4, s[38:39] offset:0 sc1
    global_load_dwordx2 v[162:163], v4, s[38:39] offset:512 sc1
    global_load_dwordx2 v[164:165], v4, s[38:39] offset:1024 sc1
    global_load_dwordx2 v[166:167], v4, s[38:39] offset:1536 sc1
    global_load_dwordx2 v[168:169], v4, s[38:39] offset:2048 sc1
    global_load_dwordx2 v[170:171], v4, s[38:39] offset:2560 sc1
    global_load_dwordx2 v[172:173], v4, s[38:39] offset:3072 sc1
    s_lshr_b32 s5, s3, 1
    s_lshl_b32 s5, s5, 5
    s_and_b32 s4, s3, 1
    s_lshl_b32 s4, s4, 2
    s_add_u32 s4, s4, s5
    s_lshl_b32 s5, s60, 6
    s_add_u32 s4, s4, s5
    v_add_lshl_u32 v4, v18, s4, 1
    global_load_ushort v218, v4, s[26:27]
    s_waitcnt lgkmcnt(0)
    s_barrier
    s_xor_b32 s4, s3, 1
    s_mul_i32 s4, s4, 21504
    s_add_u32 s4, s4, 0
    v_lshl_add_u32 v219, v1, 4, s4
    s_xor_b32 s4, s3, 2
    s_mul_i32 s4, s4, 21504
    s_add_u32 s4, s4, 1024
    v_lshl_add_u32 v220, v1, 4, s4
    s_xor_b32 s4, s3, 3
    s_mul_i32 s4, s4, 21504
    s_add_u32 s4, s4, 2048
    v_lshl_add_u32 v221, v1, 4, s4
    ds_write_b128 v219, v[24:27] offset:0
    ds_write_b128 v220, v[28:31] offset:0
    ds_write_b128 v221, v[32:35] offset:0
    ds_write_b128 v219, v[40:43] offset:3072
    ds_write_b128 v220, v[44:47] offset:3072
    ds_write_b128 v221, v[48:51] offset:3072
    ds_write_b128 v219, v[56:59] offset:6144
    ds_write_b128 v220, v[60:63] offset:6144
    ds_write_b128 v221, v[64:67] offset:6144
    ds_write_b128 v219, v[72:75] offset:9216
    ds_write_b128 v220, v[76:79] offset:9216
    ds_write_b128 v221, v[80:83] offset:9216
    ds_write_b128 v219, v[88:91] offset:12288
    ds_write_b128 v220, v[92:95] offset:12288
    ds_write_b128 v221, v[96:99] offset:12288
    ds_write_b128 v219, v[104:107] offset:15360
    ds_write_b128 v220, v[108:111] offset:15360
    ds_write_b128 v221, v[112:115] offset:15360
    ds_write_b128 v219, v[120:123] offset:18432
    ds_write_b128 v220, v[124:127] offset:18432
    ds_write_b128 v221, v[128:131] offset:18432
    s_waitcnt lgkmcnt(0)
    s_barrier
    s_mul_i32 s4, s3, 21504
    v_lshl_add_u32 v4, v1, 4, s4
    ds_read_b128 v[24:27], v4 offset:0
    ds_read_b128 v[28:31], v4 offset:1024
    ds_read_b128 v[32:35], v4 offset:2048
    ds_read_b128 v[40:43], v4 offset:3072
    ds_read_b128 v[44:47], v4 offset:4096
    ds_read_b128 v[48:51], v4 offset:5120
    ds_read_b128 v[56:59], v4 offset:6144
    ds_read_b128 v[60:63], v4 offset:7168
    ds_read_b128 v[64:67], v4 offset:8192
    ds_read_b128 v[72:75], v4 offset:9216
    ds_read_b128 v[76:79], v4 offset:10240
    ds_read_b128 v[80:83], v4 offset:11264
    ds_read_b128 v[88:91], v4 offset:12288
    ds_read_b128 v[92:95], v4 offset:13312
    ds_read_b128 v[96:99], v4 offset:14336
    ds_read_b128 v[104:107], v4 offset:15360
    ds_read_b128 v[108:111], v4 offset:16384
    ds_read_b128 v[112:115], v4 offset:17408
    ds_read_b128 v[120:123], v4 offset:18432
    ds_read_b128 v[124:127], v4 offset:19456
    ds_read_b128 v[128:131], v4 offset:20480
    s_waitcnt vmcnt(0)
    v_lshlrev_b32 v218, 16, v218
    v_pk_add_f32 v[20:21], v[218:219], v[20:21] op_sel:[0,0] op_sel_hi:[0,1]
    s_waitcnt lgkmcnt(15)
    v_pk_add_f32 v[24:25], v[24:25], v[28:29] op_sel:[0,0] op_sel_hi:[1,1]
    v_lshlrev_b32 v132, 16, v160
    v_and_b32 v133, 0xffff0000, v160
    v_pk_add_f32 v[22:23], v[218:219], v[22:23] op_sel:[0,0] op_sel_hi:[0,1]
    v_pk_add_f32 v[26:27], v[26:27], v[30:31] op_sel:[0,0] op_sel_hi:[1,1]
    v_lshlrev_b32 v134, 16, v161
    v_and_b32 v135, 0xffff0000, v161
    v_pk_add_f32 v[20:21], v[20:21], v[32:33] op_sel:[0,0] op_sel_hi:[1,1]
    v_pk_add_f32 v[22:23], v[22:23], v[34:35] op_sel:[0,0] op_sel_hi:[1,1]
    v_pk_add_f32 v[20:21], v[20:21], v[24:25] op_sel:[0,0] op_sel_hi:[1,1]
    v_pk_add_f32 v[22:23], v[22:23], v[26:27] op_sel:[0,0] op_sel_hi:[1,1]
    v_pk_mul_f32 v[20:21], v[20:21], v[132:133] op_sel:[0,0] op_sel_hi:[1,1]
    v_pk_mul_f32 v[22:23], v[22:23], v[134:135] op_sel:[0,0] op_sel_hi:[1,1]
    v_cvt_pk_bf16_f32 v188, v20, v21
    v_cvt_pk_bf16_f32 v189, v22, v23
    v_min_u32 v188, -2, v188
    v_min_u32 v189, -2, v189
    v_pk_add_f32 v[36:37], v[218:219], v[36:37] op_sel:[0,0] op_sel_hi:[0,1]
    v_pk_add_f32 v[40:41], v[40:41], v[44:45] op_sel:[0,0] op_sel_hi:[1,1]
    v_lshlrev_b32 v136, 16, v162
    v_and_b32 v137, 0xffff0000, v162
    v_pk_add_f32 v[38:39], v[218:219], v[38:39] op_sel:[0,0] op_sel_hi:[0,1]
    v_pk_add_f32 v[42:43], v[42:43], v[46:47] op_sel:[0,0] op_sel_hi:[1,1]
    v_lshlrev_b32 v138, 16, v163
    v_and_b32 v139, 0xffff0000, v163
    v_pk_add_f32 v[36:37], v[36:37], v[48:49] op_sel:[0,0] op_sel_hi:[1,1]
    v_pk_add_f32 v[38:39], v[38:39], v[50:51] op_sel:[0,0] op_sel_hi:[1,1]
    v_pk_add_f32 v[36:37], v[36:37], v[40:41] op_sel:[0,0] op_sel_hi:[1,1]
    v_pk_add_f32 v[38:39], v[38:39], v[42:43] op_sel:[0,0] op_sel_hi:[1,1]
    v_pk_mul_f32 v[36:37], v[36:37], v[136:137] op_sel:[0,0] op_sel_hi:[1,1]
    v_pk_mul_f32 v[38:39], v[38:39], v[138:139] op_sel:[0,0] op_sel_hi:[1,1]
    v_cvt_pk_bf16_f32 v190, v36, v37
    v_cvt_pk_bf16_f32 v191, v38, v39
    v_min_u32 v190, -2, v190
    v_min_u32 v191, -2, v191
    v_pk_add_f32 v[52:53], v[218:219], v[52:53] op_sel:[0,0] op_sel_hi:[0,1]
    s_waitcnt lgkmcnt(13)
    v_pk_add_f32 v[56:57], v[56:57], v[60:61] op_sel:[0,0] op_sel_hi:[1,1]
    v_lshlrev_b32 v140, 16, v164
    v_and_b32 v141, 0xffff0000, v164
    v_pk_add_f32 v[54:55], v[218:219], v[54:55] op_sel:[0,0] op_sel_hi:[0,1]
    v_pk_add_f32 v[58:59], v[58:59], v[62:63] op_sel:[0,0] op_sel_hi:[1,1]
    v_lshlrev_b32 v142, 16, v165
    v_and_b32 v143, 0xffff0000, v165
    s_waitcnt lgkmcnt(12)
    v_pk_add_f32 v[52:53], v[52:53], v[64:65] op_sel:[0,0] op_sel_hi:[1,1]
    v_pk_add_f32 v[54:55], v[54:55], v[66:67] op_sel:[0,0] op_sel_hi:[1,1]
    v_pk_add_f32 v[52:53], v[52:53], v[56:57] op_sel:[0,0] op_sel_hi:[1,1]
    v_pk_add_f32 v[54:55], v[54:55], v[58:59] op_sel:[0,0] op_sel_hi:[1,1]
    v_pk_mul_f32 v[52:53], v[52:53], v[140:141] op_sel:[0,0] op_sel_hi:[1,1]
    v_pk_mul_f32 v[54:55], v[54:55], v[142:143] op_sel:[0,0] op_sel_hi:[1,1]
    v_cvt_pk_bf16_f32 v192, v52, v53
    v_cvt_pk_bf16_f32 v193, v54, v55
    v_min_u32 v192, -2, v192
    v_min_u32 v193, -2, v193
    v_pk_add_f32 v[68:69], v[218:219], v[68:69] op_sel:[0,0] op_sel_hi:[0,1]
    s_waitcnt lgkmcnt(10)
    v_pk_add_f32 v[72:73], v[72:73], v[76:77] op_sel:[0,0] op_sel_hi:[1,1]
    v_lshlrev_b32 v144, 16, v166
    v_and_b32 v145, 0xffff0000, v166
    v_pk_add_f32 v[70:71], v[218:219], v[70:71] op_sel:[0,0] op_sel_hi:[0,1]
    v_pk_add_f32 v[74:75], v[74:75], v[78:79] op_sel:[0,0] op_sel_hi:[1,1]
    v_lshlrev_b32 v146, 16, v167
    v_and_b32 v147, 0xffff0000, v167
    s_waitcnt lgkmcnt(9)
    v_pk_add_f32 v[68:69], v[68:69], v[80:81] op_sel:[0,0] op_sel_hi:[1,1]
    v_pk_add_f32 v[70:71], v[70:71], v[82:83] op_sel:[0,0] op_sel_hi:[1,1]
    v_pk_add_f32 v[68:69], v[68:69], v[72:73] op_sel:[0,0] op_sel_hi:[1,1]
    v_pk_add_f32 v[70:71], v[70:71], v[74:75] op_sel:[0,0] op_sel_hi:[1,1]
    v_pk_mul_f32 v[68:69], v[68:69], v[144:145] op_sel:[0,0] op_sel_hi:[1,1]
    v_pk_mul_f32 v[70:71], v[70:71], v[146:147] op_sel:[0,0] op_sel_hi:[1,1]
    v_cvt_pk_bf16_f32 v194, v68, v69
    v_cvt_pk_bf16_f32 v195, v70, v71
    v_min_u32 v194, -2, v194
    v_min_u32 v195, -2, v195
    v_pk_add_f32 v[84:85], v[218:219], v[84:85] op_sel:[0,0] op_sel_hi:[0,1]
    s_waitcnt lgkmcnt(7)
    v_pk_add_f32 v[88:89], v[88:89], v[92:93] op_sel:[0,0] op_sel_hi:[1,1]
    v_lshlrev_b32 v148, 16, v168
    v_and_b32 v149, 0xffff0000, v168
    v_pk_add_f32 v[86:87], v[218:219], v[86:87] op_sel:[0,0] op_sel_hi:[0,1]
    v_pk_add_f32 v[90:91], v[90:91], v[94:95] op_sel:[0,0] op_sel_hi:[1,1]
    v_lshlrev_b32 v150, 16, v169
    v_and_b32 v151, 0xffff0000, v169
    s_waitcnt lgkmcnt(6)
    v_pk_add_f32 v[84:85], v[84:85], v[96:97] op_sel:[0,0] op_sel_hi:[1,1]
    v_pk_add_f32 v[86:87], v[86:87], v[98:99] op_sel:[0,0] op_sel_hi:[1,1]
    v_pk_add_f32 v[84:85], v[84:85], v[88:89] op_sel:[0,0] op_sel_hi:[1,1]
    v_pk_add_f32 v[86:87], v[86:87], v[90:91] op_sel:[0,0] op_sel_hi:[1,1]
    v_pk_mul_f32 v[84:85], v[84:85], v[148:149] op_sel:[0,0] op_sel_hi:[1,1]
    v_pk_mul_f32 v[86:87], v[86:87], v[150:151] op_sel:[0,0] op_sel_hi:[1,1]
    v_cvt_pk_bf16_f32 v196, v84, v85
    v_cvt_pk_bf16_f32 v197, v86, v87
    v_min_u32 v196, -2, v196
    v_min_u32 v197, -2, v197
    v_pk_add_f32 v[100:101], v[218:219], v[100:101] op_sel:[0,0] op_sel_hi:[0,1]
    s_waitcnt lgkmcnt(4)
    v_pk_add_f32 v[104:105], v[104:105], v[108:109] op_sel:[0,0] op_sel_hi:[1,1]
    v_lshlrev_b32 v152, 16, v170
    v_and_b32 v153, 0xffff0000, v170
    v_pk_add_f32 v[102:103], v[218:219], v[102:103] op_sel:[0,0] op_sel_hi:[0,1]
    v_pk_add_f32 v[106:107], v[106:107], v[110:111] op_sel:[0,0] op_sel_hi:[1,1]
    v_lshlrev_b32 v154, 16, v171
    v_and_b32 v155, 0xffff0000, v171
    s_waitcnt lgkmcnt(3)
    v_pk_add_f32 v[100:101], v[100:101], v[112:113] op_sel:[0,0] op_sel_hi:[1,1]
    v_pk_add_f32 v[102:103], v[102:103], v[114:115] op_sel:[0,0] op_sel_hi:[1,1]
    v_pk_add_f32 v[100:101], v[100:101], v[104:105] op_sel:[0,0] op_sel_hi:[1,1]
    v_pk_add_f32 v[102:103], v[102:103], v[106:107] op_sel:[0,0] op_sel_hi:[1,1]
    v_pk_mul_f32 v[100:101], v[100:101], v[152:153] op_sel:[0,0] op_sel_hi:[1,1]
    v_pk_mul_f32 v[102:103], v[102:103], v[154:155] op_sel:[0,0] op_sel_hi:[1,1]
    v_cvt_pk_bf16_f32 v198, v100, v101
    v_cvt_pk_bf16_f32 v199, v102, v103
    v_min_u32 v198, -2, v198
    v_min_u32 v199, -2, v199
    v_pk_add_f32 v[116:117], v[218:219], v[116:117] op_sel:[0,0] op_sel_hi:[0,1]
    s_waitcnt lgkmcnt(1)
    v_pk_add_f32 v[120:121], v[120:121], v[124:125] op_sel:[0,0] op_sel_hi:[1,1]
    v_lshlrev_b32 v156, 16, v172
    v_and_b32 v157, 0xffff0000, v172
    v_pk_add_f32 v[118:119], v[218:219], v[118:119] op_sel:[0,0] op_sel_hi:[0,1]
    v_pk_add_f32 v[122:123], v[122:123], v[126:127] op_sel:[0,0] op_sel_hi:[1,1]
    v_lshlrev_b32 v158, 16, v173
    v_and_b32 v159, 0xffff0000, v173
    s_waitcnt lgkmcnt(0)
    v_pk_add_f32 v[116:117], v[116:117], v[128:129] op_sel:[0,0] op_sel_hi:[1,1]
    v_pk_add_f32 v[118:119], v[118:119], v[130:131] op_sel:[0,0] op_sel_hi:[1,1]
    v_pk_add_f32 v[116:117], v[116:117], v[120:121] op_sel:[0,0] op_sel_hi:[1,1]
    v_pk_add_f32 v[118:119], v[118:119], v[122:123] op_sel:[0,0] op_sel_hi:[1,1]
    v_pk_mul_f32 v[116:117], v[116:117], v[156:157] op_sel:[0,0] op_sel_hi:[1,1]
    v_pk_mul_f32 v[118:119], v[118:119], v[158:159] op_sel:[0,0] op_sel_hi:[1,1]
    v_cvt_pk_bf16_f32 v200, v116, v117
    v_cvt_pk_bf16_f32 v201, v118, v119
    v_min_u32 v200, -2, v200
    v_min_u32 v201, -2, v201
    s_lshl_b32 s4, s60, 2
    s_add_u32 s4, s4, s3
    s_mul_i32 s4, s4, 28
    s_mul_i32 s5, s61, 7
    s_lshr_b32 s5, s5, 1
    s_add_u32 s4, s4, s5
    s_lshl_b32 s4, s4, 10
    s_add_u32 s4, s4, 16777216
    v_lshl_add_u32 v4, v1, 4, s4
    s_bitcmp1_b32 s61, 0
    s_cbranch_scc1 Lg2_odd_a
    global_store_dwordx4 v4, v[188:191], s[38:39] offset:0 sc1
    global_store_dwordx4 v4, v[192:195], s[38:39] offset:1024 sc1
    global_store_dwordx4 v4, v[196:199], s[38:39] offset:2048 sc1
    global_store_dwordx2 v4, v[200:201], s[38:39] offset:3072 sc1
    s_branch Lg2_end_a
Lg2_odd_a:
    global_store_dwordx2 v4, v[188:189], s[38:39] offset:8 sc1
    global_store_dwordx4 v4, v[190:193], s[38:39] offset:1024 sc1
    global_store_dwordx4 v4, v[194:197], s[38:39] offset:2048 sc1
    global_store_dwordx4 v4, v[198:201], s[38:39] offset:3072 sc1
Lg2_end_a:
Ldone_g2_kernel:
Lend_g2_kernel:
    s_endpgm
.p2align 8
.globl g3_kernel
.type g3_kernel,@function
g3_kernel:
    s_cmp_ge_u32 s2, 256
    s_cbranch_scc1 Lend_g3_kernel
    s_load_dwordx16 s[8:23], s[0:1], 0
    s_load_dwordx16 s[24:39], s[0:1], 64
    v_lshrrev_b32 v2, 6, v0
    v_and_b32 v1, 63, v0
    v_readfirstlane_b32 s3, v2
    s_waitcnt lgkmcnt(0)
    s_and_b32 s4, s2, 7
    s_lshr_b32 s5, s2, 3
    s_lshr_b32 s60, s4, 1
    s_lshl_b32 s60, s60, 3
    s_lshr_b32 s6, s5, 2
    s_add_u32 s60, s60, s6
    s_and_b32 s61, s4, 1
    s_lshl_b32 s61, s61, 2
    s_and_b32 s6, s5, 3
    s_add_u32 s61, s61, s6
    v_and_b32 v2, 15, v1
    v_lshrrev_b32 v3, 4, v1
    s_lshl_b32 s4, s60, 2
    s_add_u32 s4, s4, s3
    s_mul_i32 s4, s4, 28672
    s_add_u32 s4, s4, 16781312
    v_lshl_add_u32 v6, v1, 4, s4
    s_mul_i32 s4, s61, 138240
    s_lshl_b32 s6, s3, 10
    s_add_u32 s4, s4, s6
    s_add_u32 s4, s4, 10485760
    v_lshl_add_u32 v7, v1, 4, s4
    s_add_u32 m0, s6, 0
    s_nop 0
    global_load_lds_dwordx4 v7, s[38:39] sc1
    v_add_u32 v7, 4096, v7
    global_load_dwordx4 v[8:11], v6, s[38:39] offset:-4096 sc1
    s_add_u32 m0, s6, 4096
    s_nop 0
    global_load_lds_dwordx4 v7, s[38:39] sc1
    v_add_u32 v7, 4096, v7
    global_load_dwordx4 v[12:15], v6, s[38:39] offset:-3072 sc1
    s_add_u32 m0, s6, 8192
    s_nop 0
    global_load_lds_dwordx4 v7, s[38:39] sc1
    v_add_u32 v7, 4096, v7
    global_load_dwordx4 v[16:19], v6, s[38:39] offset:-2048 sc1
    s_add_u32 m0, s6, 12288
    s_nop 0
    global_load_lds_dwordx4 v7, s[38:39] sc1
    v_add_u32 v7, 4096, v7
    global_load_dwordx4 v[20:23], v6, s[38:39] offset:-1024 sc1
    s_add_u32 m0, s6, 16384
    s_nop 0
    global_load_lds_dwordx4 v7, s[38:39] sc1
    v_add_u32 v7, 4096, v7
    s_add_u32 m0, s6, 20480
    s_nop 0
    global_load_lds_dwordx4 v7, s[38:39] sc1
    v_add_u32 v7, 4096, v7
    global_load_dwordx4 v[24:27], v6, s[38:39] offset:0 sc1
    s_add_u32 m0, s6, 24576
    s_nop 0
    global_load_lds_dwordx4 v7, s[38:39] sc1
    v_add_u32 v7, 4096, v7
    global_load_dwordx4 v[28:31], v6, s[38:39] offset:1024 sc1
    s_add_u32 m0, s6, 28672
    s_nop 0
    global_load_lds_dwordx4 v7, s[38:39] sc1
    v_add_u32 v7, 4096, v7
    global_load_dwordx4 v[32:35], v6, s[38:39] offset:2048 sc1
    s_add_u32 m0, s6, 32768
    s_nop 0
    global_load_lds_dwordx4 v7, s[38:39] sc1
    v_add_u32 v7, 4096, v7
    global_load_dwordx4 v[36:39], v6, s[38:39] offset:3072 sc1
    v_add_u32 v6, 8192, v6
    s_add_u32 m0, s6, 36864
    s_nop 0
    global_load_lds_dwordx4 v7, s[38:39] sc1
    v_add_u32 v7, 4096, v7
    s_add_u32 m0, s6, 40960
    s_nop 0
    global_load_lds_dwordx4 v7, s[38:39] sc1
    v_add_u32 v7, 4096, v7
    global_load_dwordx4 v[40:43], v6, s[38:39] offset:-4096 sc1
    s_add_u32 m0, s6, 45056
    s_nop 0
    global_load_lds_dwordx4 v7, s[38:39] sc1
    v_add_u32 v7, 4096, v7
    global_load_dwordx4 v[44:47], v6, s[38:39] offset:-3072 sc1
    s_add_u32 m0, s6, 49152
    s_nop 0
    global_load_lds_dwordx4 v7, s[38:39] sc1
    v_add_u32 v7, 4096, v7
    global_load_dwordx4 v[48:51], v6, s[38:39] offset:-2048 sc1
    s_add_u32 m0, s6, 53248
    s_nop 0
    global_load_lds_dwordx4 v7, s[38:39] sc1
    v_add_u32 v7, 4096, v7
    global_load_dwordx4 v[52:55], v6, s[38:39] offset:-1024 sc1
    s_add_u32 m0, s6, 57344
    s_nop 0
    global_load_lds_dwordx4 v7, s[38:39] sc1
    v_add_u32 v7, 4096, v7
    s_add_u32 m0, s6, 61440
    s_nop 0
    global_load_lds_dwordx4 v7, s[38:39] sc1
    v_add_u32 v7, 4096, v7
    global_load_dwordx4 v[56:59], v6, s[38:39] offset:0 sc1
    s_add_u32 m0, s6, 65536
    s_nop 0
    global_load_lds_dwordx4 v7, s[38:39] sc1
    v_add_u32 v7, 4096, v7
    global_load_dwordx4 v[60:63], v6, s[38:39] offset:1024 sc1
    s_add_u32 m0, s6, 69632
    s_nop 0
    global_load_lds_dwordx4 v7, s[38:39] sc1
    v_add_u32 v7, 4096, v7
    global_load_dwordx4 v[64:67], v6, s[38:39] offset:2048 sc1
    s_add_u32 m0, s6, 73728
    s_nop 0
    global_load_lds_dwordx4 v7, s[38:39] sc1
    v_add_u32 v7, 4096, v7
    global_load_dwordx4 v[68:71], v6, s[38:39] offset:3072 sc1
    v_add_u32 v6, 8192, v6
    s_add_u32 m0, s6, 77824
    s_nop 0
    global_load_lds_dwordx4 v7, s[38:39] sc1
    v_add_u32 v7, 4096, v7
    s_add_u32 m0, s6, 81920
    s_nop 0
    global_load_lds_dwordx4 v7, s[38:39] sc1
    v_add_u32 v7, 4096, v7
    global_load_dwordx4 v[72:75], v6, s[38:39] offset:-4096 sc1
    s_add_u32 m0, s6, 86016
    s_nop 0
    global_load_lds_dwordx4 v7, s[38:39] sc1
    v_add_u32 v7, 4096, v7
    global_load_dwordx4 v[76:79], v6, s[38:39] offset:-3072 sc1
    s_add_u32 m0, s6, 90112
    s_nop 0
    global_load_lds_dwordx4 v7, s[38:39] sc1
    v_add_u32 v7, 4096, v7
    global_load_dwordx4 v[80:83], v6, s[38:39] offset:-2048 sc1
    s_add_u32 m0, s6, 94208
    s_nop 0
    global_load_lds_dwordx4 v7, s[38:39] sc1
    v_add_u32 v7, 4096, v7
    global_load_dwordx4 v[84:87], v6, s[38:39] offset:-1024 sc1
    s_add_u32 m0, s6, 98304
    s_nop 0
    global_load_lds_dwordx4 v7, s[38:39] sc1
    v_add_u32 v7, 4096, v7
    s_add_u32 m0, s6, 102400
    s_nop 0
    global_load_lds_dwordx4 v7, s[38:39] sc1
    v_add_u32 v7, 4096, v7
    global_load_dwordx4 v[88:91], v6, s[38:39] offset:0 sc1
    s_add_u32 m0, s6, 106496
    s_nop 0
    global_load_lds_dwordx4 v7, s[38:39] sc1
    v_add_u32 v7, 4096, v7
    global_load_dwordx4 v[92:95], v6, s[38:39] offset:1024 sc1
    s_add_u32 m0, s6, 110592
    s_nop 0
    global_load_lds_dwordx4 v7, s[38:39] sc1
    v_add_u32 v7, 4096, v7
    global_load_dwordx4 v[96:99], v6, s[38:39] offset:2048 sc1
    s_add_u32 m0, s6, 114688
    s_nop 0
    global_load_lds_dwordx4 v7, s[38:39] sc1
    v_add_u32 v7, 4096, v7
    global_load_dwordx4 v[100:103], v6, s[38:39] offset:3072 sc1
    v_add_u32 v6, 8192, v6
    s_add_u32 m0, s6, 118784
    s_nop 0
    global_load_lds_dwordx4 v7, s[38:39] sc1
    v_add_u32 v7, 4096, v7
    s_add_u32 m0, s6, 122880
    s_nop 0
    global_load_lds_dwordx4 v7, s[38:39] sc1
    v_add_u32 v7, 4096, v7
    global_load_dwordx4 v[104:107], v6, s[38:39] offset:-4096 sc1
    s_add_u32 m0, s6, 126976
    s_nop 0
    global_load_lds_dwordx4 v7, s[38:39] sc1
    v_add_u32 v7, 4096, v7
    global_load_dwordx4 v[108:111], v6, s[38:39] offset:-3072 sc1
    s_add_u32 m0, s6, 131072
    s_nop 0
    global_load_lds_dwordx4 v7, s[38:39] sc1
    v_add_u32 v7, 4096, v7
    global_load_dwordx4 v[112:115], v6, s[38:39] offset:-2048 sc1
    s_add_u32 m0, s6, 135168
    s_nop 0
    global_load_lds_dwordx4 v7, s[38:39] sc1
    v_add_u32 v7, 4096, v7
    v_lshrrev_b32 v4, 2, v2
    v_and_b32 v116, 3, v2
    v_lshl_add_u32 v116, v4, 3, v116
    s_lshr_b32 s5, s3, 1
    s_lshl_b32 s5, s5, 5
    s_and_b32 s4, s3, 1
    s_lshl_b32 s4, s4, 2
    s_add_u32 s4, s4, s5
    s_lshl_b32 s5, s60, 6
    s_add_u32 s4, s4, s5
    v_add_u32 v116, s4, v116
    v_lshlrev_b32 v180, 4, v1
    v_add_u32 v181, 46080, v180
    v_add_u32 v182, 92160, v180
    s_waitcnt vmcnt(40)
    s_barrier
    ds_read_b128 v[140:143], v180 offset:0
    ds_read_b128 v[144:147], v180 offset:1024
    ds_read_b128 v[148:151], v180 offset:2048
    ds_read_b128 v[152:155], v180 offset:3072
    ds_read_b128 v[156:159], v180 offset:4096
    ds_read_b128 v[160:163], v180 offset:5120
    ds_read_b128 v[164:167], v180 offset:6144
    ds_read_b128 v[168:171], v180 offset:7168
    ds_read_b128 v[172:175], v180 offset:8192
    ds_read_b128 v[176:179], v180 offset:9216
    s_waitcnt lgkmcnt(9)
    v_mfma_f32_16x16x32_bf16 v[120:123], v[140:143], v[8:11], 0
    s_waitcnt lgkmcnt(8)
    v_mfma_f32_16x16x32_bf16 v[124:127], v[144:147], v[8:11], 0
    s_waitcnt lgkmcnt(7)
    v_mfma_f32_16x16x32_bf16 v[128:131], v[148:151], v[8:11], 0
    s_waitcnt lgkmcnt(6)
    v_mfma_f32_16x16x32_bf16 v[132:135], v[152:155], v[8:11], 0
    s_waitcnt lgkmcnt(5)
    v_mfma_f32_16x16x32_bf16 v[136:139], v[156:159], v[8:11], 0
    ds_read_b128 v[140:143], v180 offset:10240
    ds_read_b128 v[144:147], v180 offset:11264
    ds_read_b128 v[148:151], v180 offset:12288
    ds_read_b128 v[152:155], v180 offset:13312
    ds_read_b128 v[156:159], v180 offset:14336
    s_waitcnt lgkmcnt(9)
    v_mfma_f32_16x16x32_bf16 v[120:123], v[160:163], v[12:15], v[120:123]
    s_waitcnt lgkmcnt(8)
    v_mfma_f32_16x16x32_bf16 v[124:127], v[164:167], v[12:15], v[124:127]
    s_waitcnt lgkmcnt(7)
    v_mfma_f32_16x16x32_bf16 v[128:131], v[168:171], v[12:15], v[128:131]
    s_waitcnt lgkmcnt(6)
    v_mfma_f32_16x16x32_bf16 v[132:135], v[172:175], v[12:15], v[132:135]
    s_waitcnt lgkmcnt(5)
    v_mfma_f32_16x16x32_bf16 v[136:139], v[176:179], v[12:15], v[136:139]
    ds_read_b128 v[160:163], v180 offset:15360
    ds_read_b128 v[164:167], v180 offset:16384
    ds_read_b128 v[168:171], v180 offset:17408
    ds_read_b128 v[172:175], v180 offset:18432
    ds_read_b128 v[176:179], v180 offset:19456
    s_waitcnt lgkmcnt(9)
    v_mfma_f32_16x16x32_bf16 v[120:123], v[140:143], v[16:19], v[120:123]
    s_waitcnt lgkmcnt(8)
    v_mfma_f32_16x16x32_bf16 v[124:127], v[144:147], v[16:19], v[124:127]
    s_waitcnt lgkmcnt(7)
    v_mfma_f32_16x16x32_bf16 v[128:131], v[148:151], v[16:19], v[128:131]
    s_waitcnt lgkmcnt(6)
    v_mfma_f32_16x16x32_bf16 v[132:135], v[152:155], v[16:19], v[132:135]
    s_waitcnt lgkmcnt(5)
    v_mfma_f32_16x16x32_bf16 v[136:139], v[156:159], v[16:19], v[136:139]
    ds_read_b128 v[140:143], v180 offset:20480
    ds_read_b128 v[144:147], v180 offset:21504
    ds_read_b128 v[148:151], v180 offset:22528
    ds_read_b128 v[152:155], v180 offset:23552
    ds_read_b128 v[156:159], v180 offset:24576
    s_waitcnt lgkmcnt(9)
    v_mfma_f32_16x16x32_bf16 v[120:123], v[160:163], v[20:23], v[120:123]
    s_waitcnt lgkmcnt(8)
    v_mfma_f32_16x16x32_bf16 v[124:127], v[164:167], v[20:23], v[124:127]
    s_waitcnt lgkmcnt(7)
    v_mfma_f32_16x16x32_bf16 v[128:131], v[168:171], v[20:23], v[128:131]
    s_waitcnt lgkmcnt(6)
    v_mfma_f32_16x16x32_bf16 v[132:135], v[172:175], v[20:23], v[132:135]
    s_waitcnt lgkmcnt(5)
    v_mfma_f32_16x16x32_bf16 v[136:139], v[176:179], v[20:23], v[136:139]
    ds_read_b128 v[160:163], v180 offset:25600
    ds_read_b128 v[164:167], v180 offset:26624
    ds_read_b128 v[168:171], v180 offset:27648
    ds_read_b128 v[172:175], v180 offset:28672
    ds_read_b128 v[176:179], v180 offset:29696
    s_waitcnt lgkmcnt(9)
    v_mfma_f32_16x16x32_bf16 v[120:123], v[140:143], v[24:27], v[120:123]
    s_waitcnt lgkmcnt(8)
    v_mfma_f32_16x16x32_bf16 v[124:127], v[144:147], v[24:27], v[124:127]
    s_waitcnt lgkmcnt(7)
    v_mfma_f32_16x16x32_bf16 v[128:131], v[148:151], v[24:27], v[128:131]
    s_waitcnt lgkmcnt(6)
    v_mfma_f32_16x16x32_bf16 v[132:135], v[152:155], v[24:27], v[132:135]
    s_waitcnt lgkmcnt(5)
    v_mfma_f32_16x16x32_bf16 v[136:139], v[156:159], v[24:27], v[136:139]
    ds_read_b128 v[140:143], v180 offset:30720
    ds_read_b128 v[144:147], v180 offset:31744
    ds_read_b128 v[148:151], v180 offset:32768
    ds_read_b128 v[152:155], v180 offset:33792
    ds_read_b128 v[156:159], v180 offset:34816
    s_waitcnt lgkmcnt(9)
    v_mfma_f32_16x16x32_bf16 v[120:123], v[160:163], v[28:31], v[120:123]
    s_waitcnt lgkmcnt(8)
    v_mfma_f32_16x16x32_bf16 v[124:127], v[164:167], v[28:31], v[124:127]
    s_waitcnt lgkmcnt(7)
    v_mfma_f32_16x16x32_bf16 v[128:131], v[168:171], v[28:31], v[128:131]
    s_waitcnt lgkmcnt(6)
    v_mfma_f32_16x16x32_bf16 v[132:135], v[172:175], v[28:31], v[132:135]
    s_waitcnt lgkmcnt(5)
    v_mfma_f32_16x16x32_bf16 v[136:139], v[176:179], v[28:31], v[136:139]
    ds_read_b128 v[160:163], v180 offset:35840
    ds_read_b128 v[164:167], v180 offset:36864
    ds_read_b128 v[168:171], v180 offset:37888
    ds_read_b128 v[172:175], v180 offset:38912
    ds_read_b128 v[176:179], v180 offset:39936
    s_waitcnt lgkmcnt(9)
    v_mfma_f32_16x16x32_bf16 v[120:123], v[140:143], v[32:35], v[120:123]
    s_waitcnt lgkmcnt(8)
    v_mfma_f32_16x16x32_bf16 v[124:127], v[144:147], v[32:35], v[124:127]
    s_waitcnt lgkmcnt(7)
    v_mfma_f32_16x16x32_bf16 v[128:131], v[148:151], v[32:35], v[128:131]
    s_waitcnt lgkmcnt(6)
    v_mfma_f32_16x16x32_bf16 v[132:135], v[152:155], v[32:35], v[132:135]
    s_waitcnt lgkmcnt(5)
    v_mfma_f32_16x16x32_bf16 v[136:139], v[156:159], v[32:35], v[136:139]
    ds_read_b128 v[140:143], v180 offset:40960
    ds_read_b128 v[144:147], v180 offset:41984
    ds_read_b128 v[148:151], v180 offset:43008
    ds_read_b128 v[152:155], v180 offset:44032
    ds_read_b128 v[156:159], v180 offset:45056
    s_waitcnt lgkmcnt(9)
    v_mfma_f32_16x16x32_bf16 v[120:123], v[160:163], v[36:39], v[120:123]
    s_waitcnt lgkmcnt(8)
    v_mfma_f32_16x16x32_bf16 v[124:127], v[164:167], v[36:39], v[124:127]
    s_waitcnt lgkmcnt(7)
    v_mfma_f32_16x16x32_bf16 v[128:131], v[168:171], v[36:39], v[128:131]
    s_waitcnt lgkmcnt(6)
    v_mfma_f32_16x16x32_bf16 v[132:135], v[172:175], v[36:39], v[132:135]
    s_waitcnt lgkmcnt(5)
    v_mfma_f32_16x16x32_bf16 v[136:139], v[176:179], v[36:39], v[136:139]
    s_waitcnt lgkmcnt(4)
    v_mfma_f32_16x16x32_bf16 v[120:123], v[140:143], v[40:43], v[120:123]
    s_waitcnt lgkmcnt(3)
    v_mfma_f32_16x16x32_bf16 v[124:127], v[144:147], v[40:43], v[124:127]
    s_waitcnt lgkmcnt(2)
    v_mfma_f32_16x16x32_bf16 v[128:131], v[148:151], v[40:43], v[128:131]
    s_waitcnt lgkmcnt(1)
    v_mfma_f32_16x16x32_bf16 v[132:135], v[152:155], v[40:43], v[132:135]
    s_waitcnt lgkmcnt(0)
    v_mfma_f32_16x16x32_bf16 v[136:139], v[156:159], v[40:43], v[136:139]
    s_waitcnt vmcnt(20)
    s_barrier
    ds_read_b128 v[160:163], v181 offset:0
    ds_read_b128 v[164:167], v181 offset:1024
    ds_read_b128 v[168:171], v181 offset:2048
    ds_read_b128 v[172:175], v181 offset:3072
    ds_read_b128 v[176:179], v181 offset:4096
    ds_read_b128 v[140:143], v181 offset:5120
    ds_read_b128 v[144:147], v181 offset:6144
    ds_read_b128 v[148:151], v181 offset:7168
    ds_read_b128 v[152:155], v181 offset:8192
    ds_read_b128 v[156:159], v181 offset:9216
    s_waitcnt lgkmcnt(9)
    v_mfma_f32_16x16x32_bf16 v[120:123], v[160:163], v[44:47], v[120:123]
    s_waitcnt lgkmcnt(8)
    v_mfma_f32_16x16x32_bf16 v[124:127], v[164:167], v[44:47], v[124:127]
    s_waitcnt lgkmcnt(7)
    v_mfma_f32_16x16x32_bf16 v[128:131], v[168:171], v[44:47], v[128:131]
    s_waitcnt lgkmcnt(6)
    v_mfma_f32_16x16x32_bf16 v[132:135], v[172:175], v[44:47], v[132:135]
    s_waitcnt lgkmcnt(5)
    v_mfma_f32_16x16x32_bf16 v[136:139], v[176:179], v[44:47], v[136:139]
    ds_read_b128 v[160:163], v181 offset:10240
    ds_read_b128 v[164:167], v181 offset:11264
    ds_read_b128 v[168:171], v181 offset:12288
    ds_read_b128 v[172:175], v181 offset:13312
    ds_read_b128 v[176:179], v181 offset:14336
    s_waitcnt lgkmcnt(9)
    v_mfma_f32_16x16x32_bf16 v[120:123], v[140:143], v[48:51], v[120:123]
    s_waitcnt lgkmcnt(8)
    v_mfma_f32_16x16x32_bf16 v[124:127], v[144:147], v[48:51], v[124:127]
    s_waitcnt lgkmcnt(7)
    v_mfma_f32_16x16x32_bf16 v[128:131], v[148:151], v[48:51], v[128:131]
    s_waitcnt lgkmcnt(6)
    v_mfma_f32_16x16x32_bf16 v[132:135], v[152:155], v[48:51], v[132:135]
    s_waitcnt lgkmcnt(5)
    v_mfma_f32_16x16x32_bf16 v[136:139], v[156:159], v[48:51], v[136:139]
    ds_read_b128 v[140:143], v181 offset:15360
    ds_read_b128 v[144:147], v181 offset:16384
    ds_read_b128 v[148:151], v181 offset:17408
    ds_read_b128 v[152:155], v181 offset:18432
    ds_read_b128 v[156:159], v181 offset:19456
    s_waitcnt lgkmcnt(9)
    v_mfma_f32_16x16x32_bf16 v[120:123], v[160:163], v[52:55], v[120:123]
    s_waitcnt lgkmcnt(8)
    v_mfma_f32_16x16x32_bf16 v[124:127], v[164:167], v[52:55], v[124:127]
    s_waitcnt lgkmcnt(7)
    v_mfma_f32_16x16x32_bf16 v[128:131], v[168:171], v[52:55], v[128:131]
    s_waitcnt lgkmcnt(6)
    v_mfma_f32_16x16x32_bf16 v[132:135], v[172:175], v[52:55], v[132:135]
    s_waitcnt lgkmcnt(5)
    v_mfma_f32_16x16x32_bf16 v[136:139], v[176:179], v[52:55], v[136:139]
    ds_read_b128 v[160:163], v181 offset:20480
    ds_read_b128 v[164:167], v181 offset:21504
    ds_read_b128 v[168:171], v181 offset:22528
    ds_read_b128 v[172:175], v181 offset:23552
    ds_read_b128 v[176:179], v181 offset:24576
    s_waitcnt lgkmcnt(9)
    v_mfma_f32_16x16x32_bf16 v[120:123], v[140:143], v[56:59], v[120:123]
    s_waitcnt lgkmcnt(8)
    v_mfma_f32_16x16x32_bf16 v[124:127], v[144:147], v[56:59], v[124:127]
    s_waitcnt lgkmcnt(7)
    v_mfma_f32_16x16x32_bf16 v[128:131], v[148:151], v[56:59], v[128:131]
    s_waitcnt lgkmcnt(6)
    v_mfma_f32_16x16x32_bf16 v[132:135], v[152:155], v[56:59], v[132:135]
    s_waitcnt lgkmcnt(5)
    v_mfma_f32_16x16x32_bf16 v[136:139], v[156:159], v[56:59], v[136:139]
    ds_read_b128 v[140:143], v181 offset:25600
    ds_read_b128 v[144:147], v181 offset:26624
    ds_read_b128 v[148:151], v181 offset:27648
    ds_read_b128 v[152:155], v181 offset:28672
    ds_read_b128 v[156:159], v181 offset:29696
    s_waitcnt lgkmcnt(9)
    v_mfma_f32_16x16x32_bf16 v[120:123], v[160:163], v[60:63], v[120:123]
    s_waitcnt lgkmcnt(8)
    v_mfma_f32_16x16x32_bf16 v[124:127], v[164:167], v[60:63], v[124:127]
    s_waitcnt lgkmcnt(7)
    v_mfma_f32_16x16x32_bf16 v[128:131], v[168:171], v[60:63], v[128:131]
    s_waitcnt lgkmcnt(6)
    v_mfma_f32_16x16x32_bf16 v[132:135], v[172:175], v[60:63], v[132:135]
    s_waitcnt lgkmcnt(5)
    v_mfma_f32_16x16x32_bf16 v[136:139], v[176:179], v[60:63], v[136:139]
    ds_read_b128 v[160:163], v181 offset:30720
    ds_read_b128 v[164:167], v181 offset:31744
    ds_read_b128 v[168:171], v181 offset:32768
    ds_read_b128 v[172:175], v181 offset:33792
    ds_read_b128 v[176:179], v181 offset:34816
    s_waitcnt lgkmcnt(9)
    v_mfma_f32_16x16x32_bf16 v[120:123], v[140:143], v[64:67], v[120:123]
    s_waitcnt lgkmcnt(8)
    v_mfma_f32_16x16x32_bf16 v[124:127], v[144:147], v[64:67], v[124:127]
    s_waitcnt lgkmcnt(7)
    v_mfma_f32_16x16x32_bf16 v[128:131], v[148:151], v[64:67], v[128:131]
    s_waitcnt lgkmcnt(6)
    v_mfma_f32_16x16x32_bf16 v[132:135], v[152:155], v[64:67], v[132:135]
    s_waitcnt lgkmcnt(5)
    v_mfma_f32_16x16x32_bf16 v[136:139], v[156:159], v[64:67], v[136:139]
    ds_read_b128 v[140:143], v181 offset:35840
    ds_read_b128 v[144:147], v181 offset:36864
    ds_read_b128 v[148:151], v181 offset:37888
    ds_read_b128 v[152:155], v181 offset:38912
    ds_read_b128 v[156:159], v181 offset:39936
    s_waitcnt lgkmcnt(9)
    v_mfma_f32_16x16x32_bf16 v[120:123], v[160:163], v[68:71], v[120:123]
    s_waitcnt lgkmcnt(8)
    v_mfma_f32_16x16x32_bf16 v[124:127], v[164:167], v[68:71], v[124:127]
    s_waitcnt lgkmcnt(7)
    v_mfma_f32_16x16x32_bf16 v[128:131], v[168:171], v[68:71], v[128:131]
    s_waitcnt lgkmcnt(6)
    v_mfma_f32_16x16x32_bf16 v[132:135], v[172:175], v[68:71], v[132:135]
    s_waitcnt lgkmcnt(5)
    v_mfma_f32_16x16x32_bf16 v[136:139], v[176:179], v[68:71], v[136:139]
    ds_read_b128 v[160:163], v181 offset:40960
    ds_read_b128 v[164:167], v181 offset:41984
    ds_read_b128 v[168:171], v181 offset:43008
    ds_read_b128 v[172:175], v181 offset:44032
    ds_read_b128 v[176:179], v181 offset:45056
    s_waitcnt lgkmcnt(9)
    v_mfma_f32_16x16x32_bf16 v[120:123], v[140:143], v[72:75], v[120:123]
    s_waitcnt lgkmcnt(8)
    v_mfma_f32_16x16x32_bf16 v[124:127], v[144:147], v[72:75], v[124:127]
    s_waitcnt lgkmcnt(7)
    v_mfma_f32_16x16x32_bf16 v[128:131], v[148:151], v[72:75], v[128:131]
    s_waitcnt lgkmcnt(6)
    v_mfma_f32_16x16x32_bf16 v[132:135], v[152:155], v[72:75], v[132:135]
    s_waitcnt lgkmcnt(5)
    v_mfma_f32_16x16x32_bf16 v[136:139], v[156:159], v[72:75], v[136:139]
    s_waitcnt lgkmcnt(4)
    v_mfma_f32_16x16x32_bf16 v[120:123], v[160:163], v[76:79], v[120:123]
    s_waitcnt lgkmcnt(3)
    v_mfma_f32_16x16x32_bf16 v[124:127], v[164:167], v[76:79], v[124:127]
    s_waitcnt lgkmcnt(2)
    v_mfma_f32_16x16x32_bf16 v[128:131], v[168:171], v[76:79], v[128:131]
    s_waitcnt lgkmcnt(1)
    v_mfma_f32_16x16x32_bf16 v[132:135], v[172:175], v[76:79], v[132:135]
    s_waitcnt lgkmcnt(0)
    v_mfma_f32_16x16x32_bf16 v[136:139], v[176:179], v[76:79], v[136:139]
    s_waitcnt vmcnt(0)
    s_barrier
    s_mul_i32 s4, s61, 327680
    s_add_u32 s4, s4, 4194304
    v_lshl_add_u32 v4, v116, 3, s4
    v_lshl_add_u32 v5, v3, 15, v4
    global_load_dwordx2 v[184:185], v5, s[38:39] sc1
    v_add_u32 v5, 16384, v5
    global_load_dwordx2 v[186:187], v5, s[38:39] sc1
    v_add_u32 v5, 114688, v5
    global_load_dwordx2 v[188:189], v5, s[38:39] sc1
    v_add_u32 v5, 16384, v5
    global_load_dwordx2 v[190:191], v5, s[38:39] sc1
    v_add_u32 v5, 114688, v5
    v_lshl_add_u32 v5, v3, 14, v4
    v_add_u32 v5, 262144, v5
    global_load_dwordx2 v[192:193], v5, s[38:39] sc1
    ds_read_b128 v[140:143], v182 offset:0
    ds_read_b128 v[144:147], v182 offset:1024
    ds_read_b128 v[148:151], v182 offset:2048
    ds_read_b128 v[152:155], v182 offset:3072
    ds_read_b128 v[156:159], v182 offset:4096
    ds_read_b128 v[160:163], v182 offset:5120
    ds_read_b128 v[164:167], v182 offset:6144
    ds_read_b128 v[168:171], v182 offset:7168
    ds_read_b128 v[172:175], v182 offset:8192
    ds_read_b128 v[176:179], v182 offset:9216
    s_waitcnt lgkmcnt(9)
    v_mfma_f32_16x16x32_bf16 v[120:123], v[140:143], v[80:83], v[120:123]
    s_waitcnt lgkmcnt(8)
    v_mfma_f32_16x16x32_bf16 v[124:127], v[144:147], v[80:83], v[124:127]
    s_waitcnt lgkmcnt(7)
    v_mfma_f32_16x16x32_bf16 v[128:131], v[148:151], v[80:83], v[128:131]
    s_waitcnt lgkmcnt(6)
    v_mfma_f32_16x16x32_bf16 v[132:135], v[152:155], v[80:83], v[132:135]
    s_waitcnt lgkmcnt(5)
    v_mfma_f32_16x16x32_bf16 v[136:139], v[156:159], v[80:83], v[136:139]
    ds_read_b128 v[140:143], v182 offset:10240
    ds_read_b128 v[144:147], v182 offset:11264
    ds_read_b128 v[148:151], v182 offset:12288
    ds_read_b128 v[152:155], v182 offset:13312
    ds_read_b128 v[156:159], v182 offset:14336
    s_waitcnt lgkmcnt(9)
    v_mfma_f32_16x16x32_bf16 v[120:123], v[160:163], v[84:87], v[120:123]
    s_waitcnt lgkmcnt(8)
    v_mfma_f32_16x16x32_bf16 v[124:127], v[164:167], v[84:87], v[124:127]
    s_waitcnt lgkmcnt(7)
    v_mfma_f32_16x16x32_bf16 v[128:131], v[168:171], v[84:87], v[128:131]
    s_waitcnt lgkmcnt(6)
    v_mfma_f32_16x16x32_bf16 v[132:135], v[172:175], v[84:87], v[132:135]
    s_waitcnt lgkmcnt(5)
    v_mfma_f32_16x16x32_bf16 v[136:139], v[176:179], v[84:87], v[136:139]
    ds_read_b128 v[160:163], v182 offset:15360
    ds_read_b128 v[164:167], v182 offset:16384
    ds_read_b128 v[168:171], v182 offset:17408
    ds_read_b128 v[172:175], v182 offset:18432
    ds_read_b128 v[176:179], v182 offset:19456
    s_waitcnt lgkmcnt(9)
    v_mfma_f32_16x16x32_bf16 v[120:123], v[140:143], v[88:91], v[120:123]
    s_waitcnt lgkmcnt(8)
    v_mfma_f32_16x16x32_bf16 v[124:127], v[144:147], v[88:91], v[124:127]
    s_waitcnt lgkmcnt(7)
    v_mfma_f32_16x16x32_bf16 v[128:131], v[148:151], v[88:91], v[128:131]
    s_waitcnt lgkmcnt(6)
    v_mfma_f32_16x16x32_bf16 v[132:135], v[152:155], v[88:91], v[132:135]
    s_waitcnt lgkmcnt(5)
    v_mfma_f32_16x16x32_bf16 v[136:139], v[156:159], v[88:91], v[136:139]
    ds_read_b128 v[140:143], v182 offset:20480
    ds_read_b128 v[144:147], v182 offset:21504
    ds_read_b128 v[148:151], v182 offset:22528
    ds_read_b128 v[152:155], v182 offset:23552
    ds_read_b128 v[156:159], v182 offset:24576
    s_waitcnt lgkmcnt(9)
    v_mfma_f32_16x16x32_bf16 v[120:123], v[160:163], v[92:95], v[120:123]
    s_waitcnt lgkmcnt(8)
    v_mfma_f32_16x16x32_bf16 v[124:127], v[164:167], v[92:95], v[124:127]
    s_waitcnt lgkmcnt(7)
    v_mfma_f32_16x16x32_bf16 v[128:131], v[168:171], v[92:95], v[128:131]
    s_waitcnt lgkmcnt(6)
    v_mfma_f32_16x16x32_bf16 v[132:135], v[172:175], v[92:95], v[132:135]
    s_waitcnt lgkmcnt(5)
    v_mfma_f32_16x16x32_bf16 v[136:139], v[176:179], v[92:95], v[136:139]
    ds_read_b128 v[160:163], v182 offset:25600
    ds_read_b128 v[164:167], v182 offset:26624
    ds_read_b128 v[168:171], v182 offset:27648
    ds_read_b128 v[172:175], v182 offset:28672
    ds_read_b128 v[176:179], v182 offset:29696
    s_waitcnt lgkmcnt(9)
    v_mfma_f32_16x16x32_bf16 v[120:123], v[140:143], v[96:99], v[120:123]
    s_waitcnt lgkmcnt(8)
    v_mfma_f32_16x16x32_bf16 v[124:127], v[144:147], v[96:99], v[124:127]
    s_waitcnt lgkmcnt(7)
    v_mfma_f32_16x16x32_bf16 v[128:131], v[148:151], v[96:99], v[128:131]
    s_waitcnt lgkmcnt(6)
    v_mfma_f32_16x16x32_bf16 v[132:135], v[152:155], v[96:99], v[132:135]
    s_waitcnt lgkmcnt(5)
    v_mfma_f32_16x16x32_bf16 v[136:139], v[156:159], v[96:99], v[136:139]
    ds_read_b128 v[140:143], v182 offset:30720
    ds_read_b128 v[144:147], v182 offset:31744
    ds_read_b128 v[148:151], v182 offset:32768
    ds_read_b128 v[152:155], v182 offset:33792
    ds_read_b128 v[156:159], v182 offset:34816
    s_waitcnt lgkmcnt(9)
    v_mfma_f32_16x16x32_bf16 v[120:123], v[160:163], v[100:103], v[120:123]
    s_waitcnt lgkmcnt(8)
    v_mfma_f32_16x16x32_bf16 v[124:127], v[164:167], v[100:103], v[124:127]
    s_waitcnt lgkmcnt(7)
    v_mfma_f32_16x16x32_bf16 v[128:131], v[168:171], v[100:103], v[128:131]
    s_waitcnt lgkmcnt(6)
    v_mfma_f32_16x16x32_bf16 v[132:135], v[172:175], v[100:103], v[132:135]
    s_waitcnt lgkmcnt(5)
    v_mfma_f32_16x16x32_bf16 v[136:139], v[176:179], v[100:103], v[136:139]
    ds_read_b128 v[160:163], v182 offset:35840
    ds_read_b128 v[164:167], v182 offset:36864
    ds_read_b128 v[168:171], v182 offset:37888
    ds_read_b128 v[172:175], v182 offset:38912
    ds_read_b128 v[176:179], v182 offset:39936
    s_waitcnt lgkmcnt(9)
    v_mfma_f32_16x16x32_bf16 v[120:123], v[140:143], v[104:107], v[120:123]
    s_waitcnt lgkmcnt(8)
    v_mfma_f32_16x16x32_bf16 v[124:127], v[144:147], v[104:107], v[124:127]
    s_waitcnt lgkmcnt(7)
    v_mfma_f32_16x16x32_bf16 v[128:131], v[148:151], v[104:107], v[128:131]
    s_waitcnt lgkmcnt(6)
    v_mfma_f32_16x16x32_bf16 v[132:135], v[152:155], v[104:107], v[132:135]
    s_waitcnt lgkmcnt(5)
    v_mfma_f32_16x16x32_bf16 v[136:139], v[156:159], v[104:107], v[136:139]
    ds_read_b128 v[140:143], v182 offset:40960
    ds_read_b128 v[144:147], v182 offset:41984
    ds_read_b128 v[148:151], v182 offset:43008
    ds_read_b128 v[152:155], v182 offset:44032
    ds_read_b128 v[156:159], v182 offset:45056
    s_waitcnt lgkmcnt(9)
    v_mfma_f32_16x16x32_bf16 v[120:123], v[160:163], v[108:111], v[120:123]
    s_waitcnt lgkmcnt(8)
    v_mfma_f32_16x16x32_bf16 v[124:127], v[164:167], v[108:111], v[124:127]
    s_waitcnt lgkmcnt(7)
    v_mfma_f32_16x16x32_bf16 v[128:131], v[168:171], v[108:111], v[128:131]
    s_waitcnt lgkmcnt(6)
    v_mfma_f32_16x16x32_bf16 v[132:135], v[172:175], v[108:111], v[132:135]
    s_waitcnt lgkmcnt(5)
    v_mfma_f32_16x16x32_bf16 v[136:139], v[176:179], v[108:111], v[136:139]
    s_waitcnt lgkmcnt(4)
    v_mfma_f32_16x16x32_bf16 v[120:123], v[140:143], v[112:115], v[120:123]
    s_waitcnt lgkmcnt(3)
    v_mfma_f32_16x16x32_bf16 v[124:127], v[144:147], v[112:115], v[124:127]
    s_waitcnt lgkmcnt(2)
    v_mfma_f32_16x16x32_bf16 v[128:131], v[148:151], v[112:115], v[128:131]
    s_waitcnt lgkmcnt(1)
    v_mfma_f32_16x16x32_bf16 v[132:135], v[152:155], v[112:115], v[132:135]
    s_waitcnt lgkmcnt(0)
    v_mfma_f32_16x16x32_bf16 v[136:139], v[156:159], v[112:115], v[136:139]
    s_mul_i32 s4, s61, 320
    v_lshl_add_u32 v4, v3, 5, s4
    v_add_u32 v12, 12800, v4
    global_load_dwordx4 v[196:199], v12, s[38:39] sc1
    v_add_u32 v12, 28160, v4
    global_load_dwordx4 v[8:11], v12, s[38:39] sc1
    v_add_u32 v4, 16, v4
    v_add_u32 v20, 12800, v4
    global_load_dwordx4 v[200:203], v20, s[38:39] sc1
    v_add_u32 v20, 28160, v4
    global_load_dwordx4 v[16:19], v20, s[38:39] sc1
    v_add_u32 v4, 112, v4
    v_add_u32 v28, 12800, v4
    global_load_dwordx4 v[204:207], v28, s[38:39] sc1
    v_add_u32 v28, 28160, v4
    global_load_dwordx4 v[24:27], v28, s[38:39] sc1
    v_add_u32 v4, 16, v4
    v_add_u32 v36, 12800, v4
    global_load_dwordx4 v[208:211], v36, s[38:39] sc1
    v_add_u32 v36, 28160, v4
    global_load_dwordx4 v[32:35], v36, s[38:39] sc1
    v_add_u32 v4, 112, v4
    s_add_u32 s4, s4, 256
    v_lshl_add_u32 v4, v3, 4, s4
    v_add_u32 v44, 12800, v4
    global_load_dwordx4 v[212:215], v44, s[38:39] sc1
    v_add_u32 v44, 28160, v4
    global_load_dwordx4 v[40:43], v44, s[38:39] sc1
    s_waitcnt vmcnt(8)
    v_add_f32 v196, v196, v8
    v_add_f32 v197, v197, v9
    v_add_f32 v198, v198, v10
    v_add_f32 v199, v199, v11
    v_cvt_pk_bf16_f32 v196, v196, v196
    v_lshlrev_b32 v196, 16, v196
    v_cvt_pk_bf16_f32 v197, v197, v197
    v_lshlrev_b32 v197, 16, v197
    v_cvt_pk_bf16_f32 v198, v198, v198
    v_lshlrev_b32 v198, 16, v198
    v_cvt_pk_bf16_f32 v199, v199, v199
    v_lshlrev_b32 v199, 16, v199
    s_waitcnt vmcnt(6)
    v_add_f32 v200, v200, v16
    v_add_f32 v201, v201, v17
    v_add_f32 v202, v202, v18
    v_add_f32 v203, v203, v19
    v_cvt_pk_bf16_f32 v200, v200, v200
    v_lshlrev_b32 v200, 16, v200
    v_cvt_pk_bf16_f32 v201, v201, v201
    v_lshlrev_b32 v201, 16, v201
    v_cvt_pk_bf16_f32 v202, v202, v202
    v_lshlrev_b32 v202, 16, v202
    v_cvt_pk_bf16_f32 v203, v203, v203
    v_lshlrev_b32 v203, 16, v203
    s_waitcnt vmcnt(4)
    v_add_f32 v204, v204, v24
    v_add_f32 v205, v205, v25
    v_add_f32 v206, v206, v26
    v_add_f32 v207, v207, v27
    v_cvt_pk_bf16_f32 v204, v204, v204
    v_lshlrev_b32 v204, 16, v204
    v_cvt_pk_bf16_f32 v205, v205, v205
    v_lshlrev_b32 v205, 16, v205
    v_cvt_pk_bf16_f32 v206, v206, v206
    v_lshlrev_b32 v206, 16, v206
    v_cvt_pk_bf16_f32 v207, v207, v207
    v_lshlrev_b32 v207, 16, v207
    s_waitcnt vmcnt(2)
    v_add_f32 v208, v208, v32
    v_add_f32 v209, v209, v33
    v_add_f32 v210, v210, v34
    v_add_f32 v211, v211, v35
    v_cvt_pk_bf16_f32 v208, v208, v208
    v_lshlrev_b32 v208, 16, v208
    v_cvt_pk_bf16_f32 v209, v209, v209
    v_lshlrev_b32 v209, 16, v209
    v_cvt_pk_bf16_f32 v210, v210, v210
    v_lshlrev_b32 v210, 16, v210
    v_cvt_pk_bf16_f32 v211, v211, v211
    v_lshlrev_b32 v211, 16, v211
    s_waitcnt vmcnt(0)
    v_add_f32 v212, v212, v40
    v_add_f32 v213, v213, v41
    v_add_f32 v214, v214, v42
    v_add_f32 v215, v215, v43
    v_cvt_pk_bf16_f32 v212, v212, v212
    v_lshlrev_b32 v212, 16, v212
    v_cvt_pk_bf16_f32 v213, v213, v213
    v_lshlrev_b32 v213, 16, v213
    v_cvt_pk_bf16_f32 v214, v214, v214
    v_lshlrev_b32 v214, 16, v214
    v_cvt_pk_bf16_f32 v215, v215, v215
    v_lshlrev_b32 v215, 16, v215
    v_lshlrev_b32 v140, 16, v184
    v_and_b32 v141, 0xffff0000, v184
    v_lshlrev_b32 v142, 16, v185
    v_and_b32 v143, 0xffff0000, v185
    v_lshlrev_b32 v144, 16, v186
    v_and_b32 v145, 0xffff0000, v186
    v_lshlrev_b32 v146, 16, v187
    v_and_b32 v147, 0xffff0000, v187
    v_lshlrev_b32 v148, 16, v188
    v_and_b32 v149, 0xffff0000, v188
    v_lshlrev_b32 v150, 16, v189
    v_and_b32 v151, 0xffff0000, v189
    v_lshlrev_b32 v152, 16, v190
    v_and_b32 v153, 0xffff0000, v190
    v_lshlrev_b32 v154, 16, v191
    v_and_b32 v155, 0xffff0000, v191
    v_lshlrev_b32 v156, 16, v192
    v_and_b32 v157, 0xffff0000, v192
    v_lshlrev_b32 v158, 16, v193
    v_and_b32 v159, 0xffff0000, v193
    v_fma_f32 v140, v120, v196, v140
    v_fma_f32 v141, v124, v197, v141
    v_fma_f32 v142, v121, v198, v142
    v_fma_f32 v143, v125, v199, v143
    v_fma_f32 v144, v122, v200, v144
    v_fma_f32 v145, v126, v201, v145
    v_fma_f32 v146, v123, v202, v146
    v_fma_f32 v147, v127, v203, v147
    v_fma_f32 v148, v128, v204, v148
    v_fma_f32 v149, v132, v205, v149
    v_fma_f32 v150, v129, v206, v150
    v_fma_f32 v151, v133, v207, v151
    v_fma_f32 v152, v130, v208, v152
    v_fma_f32 v153, v134, v209, v153
    v_fma_f32 v154, v131, v210, v154
    v_fma_f32 v155, v135, v211, v155
    v_fma_f32 v156, v136, v212, v156
    v_fma_f32 v157, v137, v213, v157
    v_fma_f32 v158, v138, v214, v158
    v_fma_f32 v159, v139, v215, v159
    v_cvt_pk_bf16_f32 v160, v140, v141
    v_cvt_pk_bf16_f32 v161, v142, v143
    v_cvt_pk_bf16_f32 v162, v144, v145
    v_cvt_pk_bf16_f32 v163, v146, v147
    v_cvt_pk_bf16_f32 v164, v148, v149
    v_cvt_pk_bf16_f32 v165, v150, v151
    v_cvt_pk_bf16_f32 v166, v152, v153
    v_cvt_pk_bf16_f32 v167, v154, v155
    v_cvt_pk_bf16_f32 v168, v156, v157
    v_cvt_pk_bf16_f32 v169, v158, v159
    v_mul_u32_u24 v4, 1280, v116
    s_mul_i32 s4, s61, 160
    v_add_u32 v4, s4, v4
    v_lshl_add_u32 v5, v3, 4, v4
    global_store_dwordx4 v5, v[160:163], s[34:35]
    global_store_dwordx4 v5, v[164:167], s[34:35] offset:64
    v_lshl_add_u32 v5, v3, 3, v4
    global_store_dwordx2 v5, v[168:169], s[34:35] offset:128
Ldone_g3_kernel:
Lend_g3_kernel:
    s_endpgm
.section .rodata,"a"
.p2align 6
.amdhsa_kernel side_kernel
  .amdhsa_next_free_vgpr 512
  .amdhsa_next_free_sgpr 102
  .amdhsa_accum_offset 256
  .amdhsa_group_segment_fixed_size 0
  .amdhsa_kernarg_size 128
  .amdhsa_user_sgpr_count 2
  .amdhsa_user_sgpr_kernarg_segment_ptr 1
  .amdhsa_system_sgpr_workgroup_id_x 1
  .amdhsa_float_denorm_mode_32 3
.end_amdhsa_kernel
.p2align 6
.amdhsa_kernel conv_kernel
  .amdhsa_next_free_vgpr 512
  .amdhsa_next_free_sgpr 102
  .amdhsa_accum_offset 256
  .amdhsa_group_segment_fixed_size 0
  .amdhsa_kernarg_size 128
  .amdhsa_user_sgpr_count 2
  .amdhsa_user_sgpr_kernarg_segment_ptr 1
  .amdhsa_system_sgpr_workgroup_id_x 1
  .amdhsa_float_denorm_mode_32 3
.end_amdhsa_kernel
.p2align 6
.amdhsa_kernel g1_kernel
  .amdhsa_next_free_vgpr 512
  .amdhsa_next_free_sgpr 102
  .amdhsa_accum_offset 256
  .amdhsa_group_segment_fixed_size 0
  .amdhsa_kernarg_size 128
  .amdhsa_user_sgpr_count 2
  .amdhsa_user_sgpr_kernarg_segment_ptr 1
  .amdhsa_system_sgpr_workgroup_id_x 1
  .amdhsa_float_denorm_mode_32 3
.end_amdhsa_kernel
.p2align 6
.amdhsa_kernel g2_kernel
  .amdhsa_next_free_vgpr 512
  .amdhsa_next_free_sgpr 102
  .amdhsa_accum_offset 256
  .amdhsa_group_segment_fixed_size 0
  .amdhsa_kernarg_size 128
  .amdhsa_user_sgpr_count 2
  .amdhsa_user_sgpr_kernarg_segment_ptr 1
  .amdhsa_system_sgpr_workgroup_id_x 1
  .amdhsa_float_denorm_mode_32 3
.end_amdhsa_kernel
.p2align 6
.amdhsa_kernel g3_kernel
  .amdhsa_next_free_vgpr 512
  .amdhsa_next_free_sgpr 102
  .amdhsa_accum_offset 256
  .amdhsa_group_segment_fixed_size 0
  .amdhsa_kernarg_size 128
  .amdhsa_user_sgpr_count 2
  .amdhsa_user_sgpr_kernarg_segment_ptr 1
  .amdhsa_system_sgpr_workgroup_id_x 1
  .amdhsa_float_denorm_mode_32 3
.end_amdhsa_kernel
```

```asm
; @launch kernel=side_kernel grid=(256,1,1) block=(256,1,1) lds=43008
; @launch kernel=main_kernel grid=(256,1,1) block=(256,1,1) lds=162816
.amdgcn_target "amdgcn-amd-amdhsa--gfx950"
.text
.p2align 8
.globl side_kernel
.type side_kernel,@function
side_kernel:
    s_cmp_ge_u32 s2, 256
    s_cbranch_scc1 Lend_side_kernel
    s_load_dwordx16 s[8:23], s[0:1], 0
    s_load_dwordx16 s[24:39], s[0:1], 64
    v_lshrrev_b32 v2, 6, v0
    v_and_b32 v1, 63, v0
    v_readfirstlane_b32 s3, v2
    s_getpc_b64 s[4:5]
Lpf_side_kernel_8:
    s_add_u32 s4, s4, side_kernel-Lpf_side_kernel_8
    s_addc_u32 s5, s5, -1
    s_lshr_b32 s6, s2, 3
    s_and_b32 s6, s6, 31
    v_mul_u32_u24 v254, 32, v0
    v_add_lshl_u32 v254, v254, s6, 7
    v_min_u32 v254, (Lcode_end-side_kernel-4), v254
    global_load_dword v254, v254, s[4:5]
    s_waitcnt lgkmcnt(0)
    v_mov_b32 v4, -1
    v_mov_b32 v5, -1
    v_mov_b32 v6, -1
    v_mov_b32 v7, -1
    s_mul_i32 s4, s2, 12288
    s_add_u32 s4, s4, 4194304
    v_lshl_add_u32 v2, v0, 4, s4
    global_store_dwordx4 v2, v[4:7], s[38:39] sc1
    v_add_u32 v2, 4096, v2
    global_store_dwordx4 v2, v[4:7], s[38:39] sc1
    v_add_u32 v2, 4096, v2
    global_store_dwordx4 v2, v[4:7], s[38:39] sc1
    v_add_u32 v2, 4096, v2
    s_nop 0
    v_mov_b32 v4, -1
    v_mov_b32 v5, -1
    v_mov_b32 v6, -1
    v_mov_b32 v7, -1
    s_mul_i32 s4, s2, 32768
    s_add_u32 s4, s4, 12582912
    v_lshl_add_u32 v2, v0, 4, s4
    global_store_dwordx4 v2, v[4:7], s[38:39] sc1
    v_add_u32 v2, 4096, v2
    global_store_dwordx4 v2, v[4:7], s[38:39] sc1
    v_add_u32 v2, 4096, v2
    global_store_dwordx4 v2, v[4:7], s[38:39] sc1
    v_add_u32 v2, 4096, v2
    global_store_dwordx4 v2, v[4:7], s[38:39] sc1
    v_add_u32 v2, 4096, v2
    global_store_dwordx4 v2, v[4:7], s[38:39] sc1
    v_add_u32 v2, 4096, v2
    global_store_dwordx4 v2, v[4:7], s[38:39] sc1
    v_add_u32 v2, 4096, v2
    global_store_dwordx4 v2, v[4:7], s[38:39] sc1
    v_add_u32 v2, 4096, v2
    global_store_dwordx4 v2, v[4:7], s[38:39] sc1
    v_add_u32 v2, 4096, v2
    s_mov_b32 s42, s2
    s_cmp_ge_u32 s42, 120
    s_cbranch_scc1 Lrole_side_kernel_0
    s_cmp_ge_u32 s42, 60
    s_cselect_b32 s4, 1, 0
    s_mul_i32 s5, s4, 60
    s_sub_u32 s5, s42, s5
    s_mul_i32 s6, s4, 320
    s_mul_i32 s7, s3, 80
    s_add_u32 s6, s6, s7
    v_lshrrev_b32 v2, 3, v1
    v_add_u32 v2, s6, v2
    v_lshlrev_b32 v4, 1, v2
    v_mul_u32_u24 v3, 7680, v2
    v_and_b32 v2, 7, v1
    v_lshl_add_u32 v3, v2, 4, v3
    s_lshl_b32 s7, s5, 7
    v_add_u32 v3, s7, v3
    global_load_ushort v6, v4, s[30:31] offset:0
    global_load_ushort v7, v4, s[30:31] offset:16
    global_load_ushort v8, v4, s[30:31] offset:32
    global_load_ushort v9, v4, s[30:31] offset:48
    global_load_ushort v10, v4, s[30:31] offset:64
    global_load_ushort v11, v4, s[30:31] offset:80
    global_load_ushort v12, v4, s[30:31] offset:96
    global_load_ushort v13, v4, s[30:31] offset:112
    global_load_ushort v14, v4, s[30:31] offset:128
    global_load_ushort v15, v4, s[30:31] offset:144
    global_load_dwordx4 v[16:19], v3, s[32:33] nt
    v_add_u32 v3, 61440, v3
    global_load_dwordx4 v[20:23], v3, s[32:33] nt
    v_add_u32 v3, 61440, v3
    global_load_dwordx4 v[24:27], v3, s[32:33] nt
    v_add_u32 v3, 61440, v3
    global_load_dwordx4 v[28:31], v3, s[32:33] nt
    v_add_u32 v3, 61440, v3
    global_load_dwordx4 v[32:35], v3, s[32:33] nt
    v_add_u32 v3, 61440, v3
    global_load_dwordx4 v[36:39], v3, s[32:33] nt
    v_add_u32 v3, 61440, v3
    global_load_dwordx4 v[40:43], v3, s[32:33] nt
    v_add_u32 v3, 61440, v3
    global_load_dwordx4 v[44:47], v3, s[32:33] nt
    v_add_u32 v3, 61440, v3
    global_load_dwordx4 v[48:51], v3, s[32:33] nt
    v_add_u32 v3, 61440, v3
    global_load_dwordx4 v[52:55], v3, s[32:33] nt
    s_waitcnt vmcnt(19)
    v_lshlrev_b32 v6, 16, v6
    v_mul_f32 v56, 0xbfb8aa3b, v6
    s_waitcnt vmcnt(18)
    v_lshlrev_b32 v7, 16, v7
    v_mul_f32 v57, 0xbfb8aa3b, v7
    s_waitcnt vmcnt(17)
    v_lshlrev_b32 v8, 16, v8
    v_mul_f32 v58, 0xbfb8aa3b, v8
    s_waitcnt vmcnt(16)
    v_lshlrev_b32 v9, 16, v9
    v_mul_f32 v59, 0xbfb8aa3b, v9
    s_waitcnt vmcnt(15)
    v_lshlrev_b32 v10, 16, v10
    v_mul_f32 v60, 0xbfb8aa3b, v10
    s_waitcnt vmcnt(14)
    v_lshlrev_b32 v11, 16, v11
    v_mul_f32 v61, 0xbfb8aa3b, v11
    s_waitcnt vmcnt(13)
    v_lshlrev_b32 v12, 16, v12
    v_mul_f32 v62, 0xbfb8aa3b, v12
    s_waitcnt vmcnt(12)
    v_lshlrev_b32 v13, 16, v13
    v_mul_f32 v63, 0xbfb8aa3b, v13
    s_waitcnt vmcnt(11)
    v_lshlrev_b32 v14, 16, v14
    v_mul_f32 v64, 0xbfb8aa3b, v14
    s_waitcnt vmcnt(10)
    v_lshlrev_b32 v15, 16, v15
    v_mul_f32 v65, 0xbfb8aa3b, v15
    v_exp_f32 v56, v56
    v_exp_f32 v57, v57
    v_exp_f32 v58, v58
    v_exp_f32 v59, v59
    v_exp_f32 v60, v60
    v_exp_f32 v61, v61
    v_exp_f32 v62, v62
    v_exp_f32 v63, v63
    v_exp_f32 v64, v64
    v_exp_f32 v65, v65
    v_add_f32 v56, 1.0, v56
    v_add_f32 v57, 1.0, v57
    v_add_f32 v58, 1.0, v58
    v_add_f32 v59, 1.0, v59
    v_add_f32 v60, 1.0, v60
    v_add_f32 v61, 1.0, v61
    v_add_f32 v62, 1.0, v62
    v_add_f32 v63, 1.0, v63
    v_add_f32 v64, 1.0, v64
    v_add_f32 v65, 1.0, v65
    v_rcp_f32 v56, v56
    v_rcp_f32 v57, v57
    v_rcp_f32 v58, v58
    v_rcp_f32 v59, v59
    v_rcp_f32 v60, v60
    v_rcp_f32 v61, v61
    v_rcp_f32 v62, v62
    v_rcp_f32 v63, v63
    v_rcp_f32 v64, v64
    v_rcp_f32 v65, v65
    v_mul_f32 v6, v6, v56
    v_mul_f32 v7, v7, v57
    v_mul_f32 v8, v8, v58
    v_mul_f32 v9, v9, v59
    v_mul_f32 v10, v10, v60
    v_mul_f32 v11, v11, v61
    v_mul_f32 v12, v12, v62
    v_mul_f32 v13, v13, v63
    v_mul_f32 v14, v14, v64
    v_mul_f32 v15, v15, v65
    v_cvt_pk_bf16_f32 v6, v6, v6
    v_lshlrev_b32 v6, 16, v6
    v_cvt_pk_bf16_f32 v7, v7, v7
    v_lshlrev_b32 v7, 16, v7
    v_cvt_pk_bf16_f32 v8, v8, v8
    v_lshlrev_b32 v8, 16, v8
    v_cvt_pk_bf16_f32 v9, v9, v9
    v_lshlrev_b32 v9, 16, v9
    v_cvt_pk_bf16_f32 v10, v10, v10
    v_lshlrev_b32 v10, 16, v10
    v_cvt_pk_bf16_f32 v11, v11, v11
    v_lshlrev_b32 v11, 16, v11
    v_cvt_pk_bf16_f32 v12, v12, v12
    v_lshlrev_b32 v12, 16, v12
    v_cvt_pk_bf16_f32 v13, v13, v13
    v_lshlrev_b32 v13, 16, v13
    v_cvt_pk_bf16_f32 v14, v14, v14
    v_lshlrev_b32 v14, 16, v14
    v_cvt_pk_bf16_f32 v15, v15, v15
    v_lshlrev_b32 v15, 16, v15
    s_waitcnt vmcnt(9)
    v_lshlrev_b32 v74, 16, v16
    v_and_b32 v75, 0xffff0000, v16
    v_lshlrev_b32 v76, 16, v17
    v_and_b32 v77, 0xffff0000, v17
    v_lshlrev_b32 v78, 16, v18
    v_and_b32 v79, 0xffff0000, v18
    v_lshlrev_b32 v80, 16, v19
    v_and_b32 v81, 0xffff0000, v19
    v_pk_mul_f32 v[66:67], v[6:7], v[74:75] op_sel:[0,0] op_sel_hi:[0,1]
    v_pk_mul_f32 v[68:69], v[6:7], v[76:77] op_sel:[0,0] op_sel_hi:[0,1]
    v_pk_mul_f32 v[70:71], v[6:7], v[78:79] op_sel:[0,0] op_sel_hi:[0,1]
    v_pk_mul_f32 v[72:73], v[6:7], v[80:81] op_sel:[0,0] op_sel_hi:[0,1]
    s_waitcnt vmcnt(8)
    v_lshlrev_b32 v74, 16, v20
    v_and_b32 v75, 0xffff0000, v20
    v_lshlrev_b32 v76, 16, v21
    v_and_b32 v77, 0xffff0000, v21
    v_lshlrev_b32 v78, 16, v22
    v_and_b32 v79, 0xffff0000, v22
    v_lshlrev_b32 v80, 16, v23
    v_and_b32 v81, 0xffff0000, v23
    v_pk_fma_f32 v[66:67], v[6:7], v[74:75], v[66:67] op_sel:[1,0,0] op_sel_hi:[1,1,1]
    v_pk_fma_f32 v[68:69], v[6:7], v[76:77], v[68:69] op_sel:[1,0,0] op_sel_hi:[1,1,1]
    v_pk_fma_f32 v[70:71], v[6:7], v[78:79], v[70:71] op_sel:[1,0,0] op_sel_hi:[1,1,1]
    v_pk_fma_f32 v[72:73], v[6:7], v[80:81], v[72:73] op_sel:[1,0,0] op_sel_hi:[1,1,1]
    s_waitcnt vmcnt(7)
    v_lshlrev_b32 v74, 16, v24
    v_and_b32 v75, 0xffff0000, v24
    v_lshlrev_b32 v76, 16, v25
    v_and_b32 v77, 0xffff0000, v25
    v_lshlrev_b32 v78, 16, v26
    v_and_b32 v79, 0xffff0000, v26
    v_lshlrev_b32 v80, 16, v27
    v_and_b32 v81, 0xffff0000, v27
    v_pk_fma_f32 v[66:67], v[8:9], v[74:75], v[66:67] op_sel:[0,0,0] op_sel_hi:[0,1,1]
    v_pk_fma_f32 v[68:69], v[8:9], v[76:77], v[68:69] op_sel:[0,0,0] op_sel_hi:[0,1,1]
    v_pk_fma_f32 v[70:71], v[8:9], v[78:79], v[70:71] op_sel:[0,0,0] op_sel_hi:[0,1,1]
    v_pk_fma_f32 v[72:73], v[8:9], v[80:81], v[72:73] op_sel:[0,0,0] op_sel_hi:[0,1,1]
    s_waitcnt vmcnt(6)
    v_lshlrev_b32 v74, 16, v28
    v_and_b32 v75, 0xffff0000, v28
    v_lshlrev_b32 v76, 16, v29
    v_and_b32 v77, 0xffff0000, v29
    v_lshlrev_b32 v78, 16, v30
    v_and_b32 v79, 0xffff0000, v30
    v_lshlrev_b32 v80, 16, v31
    v_and_b32 v81, 0xffff0000, v31
    v_pk_fma_f32 v[66:67], v[8:9], v[74:75], v[66:67] op_sel:[1,0,0] op_sel_hi:[1,1,1]
    v_pk_fma_f32 v[68:69], v[8:9], v[76:77], v[68:69] op_sel:[1,0,0] op_sel_hi:[1,1,1]
    v_pk_fma_f32 v[70:71], v[8:9], v[78:79], v[70:71] op_sel:[1,0,0] op_sel_hi:[1,1,1]
    v_pk_fma_f32 v[72:73], v[8:9], v[80:81], v[72:73] op_sel:[1,0,0] op_sel_hi:[1,1,1]
    s_waitcnt vmcnt(5)
    v_lshlrev_b32 v74, 16, v32
    v_and_b32 v75, 0xffff0000, v32
    v_lshlrev_b32 v76, 16, v33
    v_and_b32 v77, 0xffff0000, v33
    v_lshlrev_b32 v78, 16, v34
    v_and_b32 v79, 0xffff0000, v34
    v_lshlrev_b32 v80, 16, v35
    v_and_b32 v81, 0xffff0000, v35
    v_pk_fma_f32 v[66:67], v[10:11], v[74:75], v[66:67] op_sel:[0,0,0] op_sel_hi:[0,1,1]
    v_pk_fma_f32 v[68:69], v[10:11], v[76:77], v[68:69] op_sel:[0,0,0] op_sel_hi:[0,1,1]
    v_pk_fma_f32 v[70:71], v[10:11], v[78:79], v[70:71] op_sel:[0,0,0] op_sel_hi:[0,1,1]
    v_pk_fma_f32 v[72:73], v[10:11], v[80:81], v[72:73] op_sel:[0,0,0] op_sel_hi:[0,1,1]
    s_waitcnt vmcnt(4)
    v_lshlrev_b32 v74, 16, v36
    v_and_b32 v75, 0xffff0000, v36
    v_lshlrev_b32 v76, 16, v37
    v_and_b32 v77, 0xffff0000, v37
    v_lshlrev_b32 v78, 16, v38
    v_and_b32 v79, 0xffff0000, v38
    v_lshlrev_b32 v80, 16, v39
    v_and_b32 v81, 0xffff0000, v39
    v_pk_fma_f32 v[66:67], v[10:11], v[74:75], v[66:67] op_sel:[1,0,0] op_sel_hi:[1,1,1]
    v_pk_fma_f32 v[68:69], v[10:11], v[76:77], v[68:69] op_sel:[1,0,0] op_sel_hi:[1,1,1]
    v_pk_fma_f32 v[70:71], v[10:11], v[78:79], v[70:71] op_sel:[1,0,0] op_sel_hi:[1,1,1]
    v_pk_fma_f32 v[72:73], v[10:11], v[80:81], v[72:73] op_sel:[1,0,0] op_sel_hi:[1,1,1]
    s_waitcnt vmcnt(3)
    v_lshlrev_b32 v74, 16, v40
    v_and_b32 v75, 0xffff0000, v40
    v_lshlrev_b32 v76, 16, v41
    v_and_b32 v77, 0xffff0000, v41
    v_lshlrev_b32 v78, 16, v42
    v_and_b32 v79, 0xffff0000, v42
    v_lshlrev_b32 v80, 16, v43
    v_and_b32 v81, 0xffff0000, v43
    v_pk_fma_f32 v[66:67], v[12:13], v[74:75], v[66:67] op_sel:[0,0,0] op_sel_hi:[0,1,1]
    v_pk_fma_f32 v[68:69], v[12:13], v[76:77], v[68:69] op_sel:[0,0,0] op_sel_hi:[0,1,1]
    v_pk_fma_f32 v[70:71], v[12:13], v[78:79], v[70:71] op_sel:[0,0,0] op_sel_hi:[0,1,1]
    v_pk_fma_f32 v[72:73], v[12:13], v[80:81], v[72:73] op_sel:[0,0,0] op_sel_hi:[0,1,1]
    s_waitcnt vmcnt(2)
    v_lshlrev_b32 v74, 16, v44
    v_and_b32 v75, 0xffff0000, v44
    v_lshlrev_b32 v76, 16, v45
    v_and_b32 v77, 0xffff0000, v45
    v_lshlrev_b32 v78, 16, v46
    v_and_b32 v79, 0xffff0000, v46
    v_lshlrev_b32 v80, 16, v47
    v_and_b32 v81, 0xffff0000, v47
    v_pk_fma_f32 v[66:67], v[12:13], v[74:75], v[66:67] op_sel:[1,0,0] op_sel_hi:[1,1,1]
    v_pk_fma_f32 v[68:69], v[12:13], v[76:77], v[68:69] op_sel:[1,0,0] op_sel_hi:[1,1,1]
    v_pk_fma_f32 v[70:71], v[12:13], v[78:79], v[70:71] op_sel:[1,0,0] op_sel_hi:[1,1,1]
    v_pk_fma_f32 v[72:73], v[12:13], v[80:81], v[72:73] op_sel:[1,0,0] op_sel_hi:[1,1,1]
    s_waitcnt vmcnt(1)
    v_lshlrev_b32 v74, 16, v48
    v_and_b32 v75, 0xffff0000, v48
    v_lshlrev_b32 v76, 16, v49
    v_and_b32 v77, 0xffff0000, v49
    v_lshlrev_b32 v78, 16, v50
    v_and_b32 v79, 0xffff0000, v50
    v_lshlrev_b32 v80, 16, v51
    v_and_b32 v81, 0xffff0000, v51
    v_pk_fma_f32 v[66:67], v[14:15], v[74:75], v[66:67] op_sel:[0,0,0] op_sel_hi:[0,1,1]
    v_pk_fma_f32 v[68:69], v[14:15], v[76:77], v[68:69] op_sel:[0,0,0] op_sel_hi:[0,1,1]
    v_pk_fma_f32 v[70:71], v[14:15], v[78:79], v[70:71] op_sel:[0,0,0] op_sel_hi:[0,1,1]
    v_pk_fma_f32 v[72:73], v[14:15], v[80:81], v[72:73] op_sel:[0,0,0] op_sel_hi:[0,1,1]
    s_waitcnt vmcnt(0)
    v_lshlrev_b32 v74, 16, v52
    v_and_b32 v75, 0xffff0000, v52
    v_lshlrev_b32 v76, 16, v53
    v_and_b32 v77, 0xffff0000, v53
    v_lshlrev_b32 v78, 16, v54
    v_and_b32 v79, 0xffff0000, v54
    v_lshlrev_b32 v80, 16, v55
    v_and_b32 v81, 0xffff0000, v55
    v_pk_fma_f32 v[66:67], v[14:15], v[74:75], v[66:67] op_sel:[1,0,0] op_sel_hi:[1,1,1]
    v_pk_fma_f32 v[68:69], v[14:15], v[76:77], v[68:69] op_sel:[1,0,0] op_sel_hi:[1,1,1]
    v_pk_fma_f32 v[70:71], v[14:15], v[78:79], v[70:71] op_sel:[1,0,0] op_sel_hi:[1,1,1]
    v_pk_fma_f32 v[72:73], v[14:15], v[80:81], v[72:73] op_sel:[1,0,0] op_sel_hi:[1,1,1]
    s_nop 0
    v_permlane32_swap_b32 v66, v70
    v_permlane32_swap_b32 v67, v71
    v_permlane32_swap_b32 v68, v72
    v_permlane32_swap_b32 v69, v73
    v_add_f32 v66, v66, v70
    v_add_f32 v67, v67, v71
    v_add_f32 v68, v68, v72
    v_add_f32 v69, v69, v73
    s_nop 0
    v_permlane16_swap_b32 v66, v68
    v_permlane16_swap_b32 v67, v69
    v_add_f32 v66, v66, v68
    v_add_f32 v67, v67, v69
    s_nop 0
    v_add_f32_dpp v74, v66, v66 row_ror:8 row_mask:0xf bank_mask:0x3
    s_nop 1
    v_add_f32_dpp v74, v67, v67 row_ror:8 row_mask:0xf bank_mask:0xc
    v_and_b32 v75, 7, v1
    v_lshrrev_b32 v76, 3, v1
    v_lshl_add_u32 v75, v75, 3, v76
    s_lshl_b32 s7, s3, 6
    v_add_lshl_u32 v75, v75, s7, 2
    ds_write_b32 v75, v74
    s_waitcnt lgkmcnt(0)
    s_barrier
    v_lshlrev_b32 v75, 2, v1
    ds_read_b32 v66, v75 offset:0
    ds_read_b32 v67, v75 offset:256
    ds_read_b32 v68, v75 offset:512
    ds_read_b32 v69, v75 offset:768
    s_mul_i32 s6, s4, 15360
    s_lshl_b32 s7, s5, 8
    s_add_u32 s6, s6, s7
    s_add_u32 s6, s6, 0
    v_add_u32 v75, s6, v75
    s_waitcnt lgkmcnt(2)
    v_add_f32 v66, v66, v67
    s_waitcnt lgkmcnt(0)
    v_add_f32 v68, v68, v69
    v_add_f32 v66, v66, v68
    s_cmp_lg_u32 s3, 0
    s_cbranch_scc1 Lmod_skip_57696_282
    global_store_dword v75, v66, s[38:39] sc1
Lmod_skip_57696_282:
    s_branch Ldone_side_kernel
Lrole_side_kernel_0:
    s_sub_u32 s42, s42, 120
    s_cmp_ge_u32 s42, 64
    s_cbranch_scc1 Lrole_side_kernel_1
    s_lshl_b32 s4, s42, 2
    s_add_u32 s4, s4, s3
    s_mul_i32 s4, s4, 10240
    s_add_u32 s4, s4, 4096
    v_lshl_add_u32 v2, v1, 4, s4
    global_load_dwordx4 v[8:11], v2, s[8:9] offset:-4096 nt
    global_load_dwordx4 v[12:15], v2, s[8:9] offset:-3072 nt
    global_load_dwordx4 v[16:19], v2, s[8:9] offset:-2048 nt
    global_load_dwordx4 v[20:23], v2, s[8:9] offset:-1024 nt
    global_load_dwordx4 v[24:27], v2, s[8:9] offset:0 nt
    global_load_dwordx4 v[28:31], v2, s[8:9] offset:1024 nt
    global_load_dwordx4 v[32:35], v2, s[8:9] offset:2048 nt
    global_load_dwordx4 v[36:39], v2, s[8:9] offset:3072 nt
    v_add_u32 v2, 8192, v2
    global_load_dwordx4 v[40:43], v2, s[8:9] offset:-4096 nt
    global_load_dwordx4 v[44:47], v2, s[8:9] offset:-3072 nt
    s_mul_i32 s5, s3, 10304
    v_lshl_add_u32 v3, v1, 4, s5
    v_lshrrev_b32 v4, 5, v1
    v_lshl_add_u32 v4, v4, 4, v3
    s_waitcnt vmcnt(9)
    ds_write_b128 v3, v[8:11] offset:0
    s_waitcnt vmcnt(8)
    ds_write_b128 v3, v[12:15] offset:1024
    s_waitcnt vmcnt(7)
    ds_write_b128 v4, v[16:19] offset:2048
    s_waitcnt vmcnt(6)
    ds_write_b128 v3, v[20:23] offset:3088
    s_waitcnt vmcnt(5)
    ds_write_b128 v3, v[24:27] offset:4112
    s_waitcnt vmcnt(4)
    ds_write_b128 v3, v[28:31] offset:5152
    s_waitcnt vmcnt(3)
    ds_write_b128 v3, v[32:35] offset:6176
    s_waitcnt vmcnt(2)
    ds_write_b128 v4, v[36:39] offset:7200
    s_waitcnt vmcnt(1)
    ds_write_b128 v3, v[40:43] offset:8240
    s_waitcnt vmcnt(0)
    ds_write_b128 v3, v[44:47] offset:9264
    s_waitcnt lgkmcnt(0)
    s_barrier
    v_and_b32 v48, 15, v1
    v_lshrrev_b32 v49, 4, v1
    v_mul_u32_u24 v3, 2576, v48
    v_lshl_add_u32 v3, v49, 3, v3
    s_mul_i32 s5, s3, 320
    v_add_u32 v3, s5, v3
    ds_read2_b64 v[8:11], v3 offset0:0 offset1:160
    ds_read2_b64 v[12:15], v3 offset0:4 offset1:164
    ds_read2_b64 v[16:19], v3 offset0:8 offset1:168
    ds_read2_b64 v[20:23], v3 offset0:12 offset1:172
    ds_read2_b64 v[24:27], v3 offset0:16 offset1:176
    ds_read2_b64 v[28:31], v3 offset0:20 offset1:180
    ds_read2_b64 v[32:35], v3 offset0:24 offset1:184
    ds_read2_b64 v[36:39], v3 offset0:28 offset1:188
    ds_read2_b64 v[40:43], v3 offset0:32 offset1:192
    ds_read2_b64 v[44:47], v3 offset0:36 offset1:196
    s_mul_i32 s5, s3, 655360
    s_lshl_b32 s6, s42, 8
    s_add_u32 s5, s5, s6
    s_add_u32 s5, s5, 1048576
    v_lshlrev_b32 v2, 14, v49
    v_lshl_add_u32 v2, v48, 4, v2
    v_add_u32 v2, s5, v2
    s_mov_b32 s7, 0x3f803f80
    v_mov_b32 v50, 0
    v_mov_b32 v51, 0
    v_mov_b32 v52, 0
    v_mov_b32 v53, 0
    s_waitcnt lgkmcnt(9)
    global_store_dwordx4 v2, v[8:11], s[38:39] sc1
    v_add_u32 v2, 65536, v2
    v_dot2_f32_bf16 v50, v8, s7, v50
    v_dot2_f32_bf16 v51, v8, v8, v51
    v_dot2_f32_bf16 v52, v10, s7, v52
    v_dot2_f32_bf16 v53, v10, v10, v53
    v_dot2_f32_bf16 v50, v9, s7, v50
    v_dot2_f32_bf16 v51, v9, v9, v51
    v_dot2_f32_bf16 v52, v11, s7, v52
    v_dot2_f32_bf16 v53, v11, v11, v53
    s_waitcnt lgkmcnt(8)
    global_store_dwordx4 v2, v[12:15], s[38:39] sc1
    v_add_u32 v2, 65536, v2
    v_dot2_f32_bf16 v50, v12, s7, v50
    v_dot2_f32_bf16 v51, v12, v12, v51
    v_dot2_f32_bf16 v52, v14, s7, v52
    v_dot2_f32_bf16 v53, v14, v14, v53
    v_dot2_f32_bf16 v50, v13, s7, v50
    v_dot2_f32_bf16 v51, v13, v13, v51
    v_dot2_f32_bf16 v52, v15, s7, v52
    v_dot2_f32_bf16 v53, v15, v15, v53
    s_waitcnt lgkmcnt(7)
    global_store_dwordx4 v2, v[16:19], s[38:39] sc1
    v_add_u32 v2, 65536, v2
    v_dot2_f32_bf16 v50, v16, s7, v50
    v_dot2_f32_bf16 v51, v16, v16, v51
    v_dot2_f32_bf16 v52, v18, s7, v52
    v_dot2_f32_bf16 v53, v18, v18, v53
    v_dot2_f32_bf16 v50, v17, s7, v50
    v_dot2_f32_bf16 v51, v17, v17, v51
    v_dot2_f32_bf16 v52, v19, s7, v52
    v_dot2_f32_bf16 v53, v19, v19, v53
    s_waitcnt lgkmcnt(6)
    global_store_dwordx4 v2, v[20:23], s[38:39] sc1
    v_add_u32 v2, 65536, v2
    v_dot2_f32_bf16 v50, v20, s7, v50
    v_dot2_f32_bf16 v51, v20, v20, v51
    v_dot2_f32_bf16 v52, v22, s7, v52
    v_dot2_f32_bf16 v53, v22, v22, v53
    v_dot2_f32_bf16 v50, v21, s7, v50
    v_dot2_f32_bf16 v51, v21, v21, v51
    v_dot2_f32_bf16 v52, v23, s7, v52
    v_dot2_f32_bf16 v53, v23, v23, v53
    s_waitcnt lgkmcnt(5)
    global_store_dwordx4 v2, v[24:27], s[38:39] sc1
    v_add_u32 v2, 65536, v2
    v_dot2_f32_bf16 v50, v24, s7, v50
    v_dot2_f32_bf16 v51, v24, v24, v51
    v_dot2_f32_bf16 v52, v26, s7, v52
    v_dot2_f32_bf16 v53, v26, v26, v53
    v_dot2_f32_bf16 v50, v25, s7, v50
    v_dot2_f32_bf16 v51, v25, v25, v51
    v_dot2_f32_bf16 v52, v27, s7, v52
    v_dot2_f32_bf16 v53, v27, v27, v53
    s_waitcnt lgkmcnt(4)
    global_store_dwordx4 v2, v[28:31], s[38:39] sc1
    v_add_u32 v2, 65536, v2
    v_dot2_f32_bf16 v50, v28, s7, v50
    v_dot2_f32_bf16 v51, v28, v28, v51
    v_dot2_f32_bf16 v52, v30, s7, v52
    v_dot2_f32_bf16 v53, v30, v30, v53
    v_dot2_f32_bf16 v50, v29, s7, v50
    v_dot2_f32_bf16 v51, v29, v29, v51
    v_dot2_f32_bf16 v52, v31, s7, v52
    v_dot2_f32_bf16 v53, v31, v31, v53
    s_waitcnt lgkmcnt(3)
    global_store_dwordx4 v2, v[32:35], s[38:39] sc1
    v_add_u32 v2, 65536, v2
    v_dot2_f32_bf16 v50, v32, s7, v50
    v_dot2_f32_bf16 v51, v32, v32, v51
    v_dot2_f32_bf16 v52, v34, s7, v52
    v_dot2_f32_bf16 v53, v34, v34, v53
    v_dot2_f32_bf16 v50, v33, s7, v50
    v_dot2_f32_bf16 v51, v33, v33, v51
    v_dot2_f32_bf16 v52, v35, s7, v52
    v_dot2_f32_bf16 v53, v35, v35, v53
    s_waitcnt lgkmcnt(2)
    global_store_dwordx4 v2, v[36:39], s[38:39] sc1
    v_add_u32 v2, 65536, v2
    v_dot2_f32_bf16 v50, v36, s7, v50
    v_dot2_f32_bf16 v51, v36, v36, v51
    v_dot2_f32_bf16 v52, v38, s7, v52
    v_dot2_f32_bf16 v53, v38, v38, v53
    v_dot2_f32_bf16 v50, v37, s7, v50
    v_dot2_f32_bf16 v51, v37, v37, v51
    v_dot2_f32_bf16 v52, v39, s7, v52
    v_dot2_f32_bf16 v53, v39, v39, v53
    s_waitcnt lgkmcnt(1)
    global_store_dwordx4 v2, v[40:43], s[38:39] sc1
    v_add_u32 v2, 65536, v2
    v_dot2_f32_bf16 v50, v40, s7, v50
    v_dot2_f32_bf16 v51, v40, v40, v51
    v_dot2_f32_bf16 v52, v42, s7, v52
    v_dot2_f32_bf16 v53, v42, v42, v53
    v_dot2_f32_bf16 v50, v41, s7, v50
    v_dot2_f32_bf16 v51, v41, v41, v51
    v_dot2_f32_bf16 v52, v43, s7, v52
    v_dot2_f32_bf16 v53, v43, v43, v53
    s_waitcnt lgkmcnt(0)
    global_store_dwordx4 v2, v[44:47], s[38:39] sc1
    v_dot2_f32_bf16 v50, v44, s7, v50
    v_dot2_f32_bf16 v51, v44, v44, v51
    v_dot2_f32_bf16 v52, v46, s7, v52
    v_dot2_f32_bf16 v53, v46, v46, v53
    v_dot2_f32_bf16 v50, v45, s7, v50
    v_dot2_f32_bf16 v51, v45, v45, v51
    v_dot2_f32_bf16 v52, v47, s7, v52
    v_dot2_f32_bf16 v53, v47, v47, v53
    s_nop 1
    v_permlane32_swap_b32 v50, v52
    v_permlane32_swap_b32 v51, v53
    v_add_f32 v50, v50, v52
    v_add_f32 v51, v51, v53
    s_nop 1
    v_permlane16_swap_b32 v50, v51
    v_add_f32 v50, v50, v51
    v_lshlrev_b32 v3, 4, v48
    v_lshl_add_u32 v3, v49, 2, v3
    s_lshl_b32 s5, s3, 8
    v_add_u32 v3, s5, v3
    ds_write_b32 v3, v50 offset:41472
    s_waitcnt lgkmcnt(0)
    s_barrier
    v_and_b32 v3, 31, v1
    v_lshlrev_b32 v3, 3, v3
    ds_read_b64 v[54:55], v3 offset:41472
    ds_read_b64 v[56:57], v3 offset:41728
    ds_read_b64 v[58:59], v3 offset:41984
    ds_read_b64 v[60:61], v3 offset:42240
    s_waitcnt lgkmcnt(2)
    v_pk_add_f32 v[54:55], v[54:55], v[56:57] op_sel:[0,0] op_sel_hi:[1,1]
    s_waitcnt lgkmcnt(0)
    v_pk_add_f32 v[58:59], v[58:59], v[60:61] op_sel:[0,0] op_sel_hi:[1,1]
    v_pk_add_f32 v[54:55], v[54:55], v[58:59] op_sel:[0,0] op_sel_hi:[1,1]
    v_mul_f32 v54, 0x3acccccd, v54
    v_mul_f32 v55, 0x3acccccd, v55
    v_fma_f32 v55, -v54, v54, v55
    v_max_f32 v55, 0, v55
    v_add_f32 v55, 0x3727c5ac, v55
    v_rsq_f32 v56, v55
    s_nop 0
    v_mul_f32_e64 v55, -v54, v56
    v_mov_b32 v54, v56
    s_lshl_b32 s5, s42, 8
    s_add_u32 s5, s5, 32768
    v_add_u32 v3, s5, v3
    s_cmp_lg_u32 s3, 0
    s_cbranch_scc1 Lx_skip_6704_194
    global_store_dwordx2 v3, v[54:55], s[38:39] sc1
Lx_skip_6704_194:
    s_branch Ldone_side_kernel
Lrole_side_kernel_1:
    s_sub_u32 s42, s42, 64
    s_cmp_ge_u32 s42, 27
    s_cbranch_scc1 Lrole_side_kernel_2
    s_mul_i32 s4, s42, 40960
    s_mul_i32 s5, s3, 10240
    s_add_u32 s4, s4, s5
    v_lshl_add_u32 v2, v1, 4, s4
    s_add_u32 m0, s5, 0
    s_nop 0
    global_load_lds_dwordx4 v2, s[28:29] offset:0 nt
    global_load_lds_dwordx4 v2, s[28:29] offset:1024 nt
    global_load_lds_dwordx4 v2, s[28:29] offset:2048 nt
    global_load_lds_dwordx4 v2, s[28:29] offset:3072 nt
    s_add_u32 m0, s5, 4096
    v_add_u32 v2, 4096, v2
    global_load_lds_dwordx4 v2, s[28:29] offset:0 nt
    global_load_lds_dwordx4 v2, s[28:29] offset:1024 nt
    global_load_lds_dwordx4 v2, s[28:29] offset:2048 nt
    global_load_lds_dwordx4 v2, s[28:29] offset:3072 nt
    s_add_u32 m0, s5, 8192
    v_add_u32 v2, 4096, v2
    global_load_lds_dwordx4 v2, s[28:29] offset:0 nt
    global_load_lds_dwordx4 v2, s[28:29] offset:1024 nt
    v_and_b32 v5, 15, v1
    v_lshrrev_b32 v6, 4, v1
    v_mul_u32_u24 v6, 10240, v6
    s_mul_i32 s5, s3, 320
    v_add_u32 v6, s5, v6
    v_lshl_add_u32 v3, v5, 2, v6
    v_lshl_add_u32 v4, v5, 1, v6
    s_mul_i32 s5, s3, 276480
    s_mul_i32 s6, s42, 5120
    s_add_u32 s5, s5, s6
    s_add_u32 s5, s5, 10487808
    v_lshl_add_u32 v2, v1, 4, s5
    s_mov_b32 s6, 0x5040100
    s_mov_b32 s7, 0x7060302
    s_waitcnt vmcnt(0)
    s_barrier
    ds_read_b32 v8, v3 offset:0
    ds_read_b32 v9, v3 offset:2560
    ds_read_b32 v10, v3 offset:5120
    ds_read_b32 v11, v3 offset:7680
    ds_read_b32 v12, v3 offset:1280
    ds_read_b32 v13, v3 offset:3840
    ds_read_b32 v14, v3 offset:6400
    ds_read_b32 v15, v3 offset:8960
    ds_read_b32 v16, v3 offset:64
    ds_read_b32 v17, v3 offset:2624
    ds_read_b32 v18, v3 offset:5184
    ds_read_b32 v19, v3 offset:7744
    ds_read_b32 v20, v3 offset:1344
    ds_read_b32 v21, v3 offset:3904
    ds_read_b32 v22, v3 offset:6464
    ds_read_b32 v23, v3 offset:9024
    ds_read_u16 v24, v4 offset:128
    ds_read_u16 v25, v4 offset:2688
    ds_read_u16 v26, v4 offset:5248
    ds_read_u16 v27, v4 offset:7808
    ds_read_u16 v28, v4 offset:1408
    ds_read_u16 v29, v4 offset:3968
    ds_read_u16 v30, v4 offset:6528
    ds_read_u16 v31, v4 offset:9088
    s_waitcnt lgkmcnt(15)
    v_perm_b32 v32, v9, v8, s6
    v_perm_b32 v33, v11, v10, s6
    v_perm_b32 v34, v13, v12, s6
    v_perm_b32 v35, v15, v14, s6
    v_perm_b32 v36, v9, v8, s7
    v_perm_b32 v37, v11, v10, s7
    v_perm_b32 v38, v13, v12, s7
    v_perm_b32 v39, v15, v14, s7
    s_waitcnt lgkmcnt(14)
    v_perm_b32 v40, v17, v16, s6
    s_waitcnt lgkmcnt(12)
    v_perm_b32 v41, v19, v18, s6
    s_waitcnt lgkmcnt(10)
    v_perm_b32 v42, v21, v20, s6
    s_waitcnt lgkmcnt(8)
    v_perm_b32 v43, v23, v22, s6
    v_perm_b32 v44, v17, v16, s7
    v_perm_b32 v45, v19, v18, s7
    v_perm_b32 v46, v21, v20, s7
    v_perm_b32 v47, v23, v22, s7
    s_waitcnt lgkmcnt(6)
    v_perm_b32 v48, v25, v24, s6
    s_waitcnt lgkmcnt(4)
    v_perm_b32 v49, v27, v26, s6
    s_waitcnt lgkmcnt(2)
    v_perm_b32 v50, v29, v28, s6
    s_waitcnt lgkmcnt(0)
    v_perm_b32 v51, v31, v30, s6
    global_store_dwordx4 v2, v[32:35], s[38:39] offset:-2048 sc1
    global_store_dwordx4 v2, v[36:39], s[38:39] offset:-1024 sc1
    global_store_dwordx4 v2, v[40:43], s[38:39] offset:0 sc1
    global_store_dwordx4 v2, v[44:47], s[38:39] offset:1024 sc1
    global_store_dwordx4 v2, v[48:51], s[38:39] offset:2048 sc1
    v_add_u32 v2, 138240, v2
    ds_read_b32 v52, v3 offset:160
    ds_read_b32 v53, v3 offset:2720
    ds_read_b32 v54, v3 offset:5280
    ds_read_b32 v55, v3 offset:7840
    ds_read_b32 v56, v3 offset:1440
    ds_read_b32 v57, v3 offset:4000
    ds_read_b32 v58, v3 offset:6560
    ds_read_b32 v59, v3 offset:9120
    ds_read_b32 v60, v3 offset:224
    ds_read_b32 v61, v3 offset:2784
    ds_read_b32 v62, v3 offset:5344
    ds_read_b32 v63, v3 offset:7904
    ds_read_b32 v64, v3 offset:1504
    ds_read_b32 v65, v3 offset:4064
    ds_read_b32 v66, v3 offset:6624
    ds_read_b32 v67, v3 offset:9184
    ds_read_u16 v68, v4 offset:288
    ds_read_u16 v69, v4 offset:2848
    ds_read_u16 v70, v4 offset:5408
    ds_read_u16 v71, v4 offset:7968
    ds_read_u16 v72, v4 offset:1568
    ds_read_u16 v73, v4 offset:4128
    ds_read_u16 v74, v4 offset:6688
    ds_read_u16 v75, v4 offset:9248
    s_waitcnt lgkmcnt(15)
    v_perm_b32 v76, v53, v52, s6
    v_perm_b32 v77, v55, v54, s6
    v_perm_b32 v78, v57, v56, s6
    v_perm_b32 v79, v59, v58, s6
    v_perm_b32 v80, v53, v52, s7
    v_perm_b32 v81, v55, v54, s7
    v_perm_b32 v82, v57, v56, s7
    v_perm_b32 v83, v59, v58, s7
    s_waitcnt lgkmcnt(14)
    v_perm_b32 v84, v61, v60, s6
    s_waitcnt lgkmcnt(12)
    v_perm_b32 v85, v63, v62, s6
    s_waitcnt lgkmcnt(10)
    v_perm_b32 v86, v65, v64, s6
    s_waitcnt lgkmcnt(8)
    v_perm_b32 v87, v67, v66, s6
    v_perm_b32 v88, v61, v60, s7
    v_perm_b32 v89, v63, v62, s7
    v_perm_b32 v90, v65, v64, s7
    v_perm_b32 v91, v67, v66, s7
    s_waitcnt lgkmcnt(6)
    v_perm_b32 v92, v69, v68, s6
    s_waitcnt lgkmcnt(4)
    v_perm_b32 v93, v71, v70, s6
    s_waitcnt lgkmcnt(2)
    v_perm_b32 v94, v73, v72, s6
    s_waitcnt lgkmcnt(0)
    v_perm_b32 v95, v75, v74, s6
    global_store_dwordx4 v2, v[76:79], s[38:39] offset:-2048 sc1
    global_store_dwordx4 v2, v[80:83], s[38:39] offset:-1024 sc1
    global_store_dwordx4 v2, v[84:87], s[38:39] offset:0 sc1
    global_store_dwordx4 v2, v[88:91], s[38:39] offset:1024 sc1
    global_store_dwordx4 v2, v[92:95], s[38:39] offset:2048 sc1
    s_branch Ldone_side_kernel
Lrole_side_kernel_2:
    s_sub_u32 s42, s42, 27
    s_cmp_ge_u32 s42, 2
    s_cbranch_scc1 Lrole_side_kernel_3
    v_mov_b32 v4, -1
    s_mul_i32 s4, s42, 7168
    s_add_u32 s4, s4, 49152
    v_lshl_add_u32 v2, v0, 2, s4
    global_store_dword v2, v4, s[38:39] sc1
    v_add_u32 v2, 1024, v2
    global_store_dword v2, v4, s[38:39] sc1
    v_add_u32 v2, 1024, v2
    global_store_dword v2, v4, s[38:39] sc1
    v_add_u32 v2, 1024, v2
    global_store_dword v2, v4, s[38:39] sc1
    v_add_u32 v2, 1024, v2
    global_store_dword v2, v4, s[38:39] sc1
    v_add_u32 v2, 1024, v2
    global_store_dword v2, v4, s[38:39] sc1
    v_add_u32 v2, 1024, v2
    v_min_u32 v3, 191, v0
    v_lshl_add_u32 v2, v3, 2, s4
    v_add_u32 v2, 6144, v2
    global_store_dword v2, v4, s[38:39] sc1
    v_add_u32 v2, 1024, v2
    v_mov_b32 v4, 0
    v_mov_b32 v5, 0
    v_mov_b32 v6, 0
    v_mov_b32 v7, 0
    s_mul_i32 s4, s42, 1146880
    s_add_u32 s4, s4, 8445952
    v_lshl_add_u32 v2, v0, 4, s4
    global_store_dwordx4 v2, v[4:7], s[38:39] sc1
    v_add_u32 v2, 4096, v2
    global_store_dwordx4 v2, v[4:7], s[38:39] sc1
    v_add_u32 v2, 4096, v2
    global_store_dwordx4 v2, v[4:7], s[38:39] sc1
    v_add_u32 v2, 4096, v2
    global_store_dwordx4 v2, v[4:7], s[38:39] sc1
    v_add_u32 v2, 4096, v2
    global_store_dwordx4 v2, v[4:7], s[38:39] sc1
    v_add_u32 v2, 4096, v2
    global_store_dwordx4 v2, v[4:7], s[38:39] sc1
    v_add_u32 v2, 4096, v2
    global_store_dwordx4 v2, v[4:7], s[38:39] sc1
    v_add_u32 v2, 4096, v2
    global_store_dwordx4 v2, v[4:7], s[38:39] sc1
    v_add_u32 v2, 4096, v2
    global_store_dwordx4 v2, v[4:7], s[38:39] sc1
    v_add_u32 v2, 4096, v2
    global_store_dwordx4 v2, v[4:7], s[38:39] sc1
    v_add_u32 v2, 4096, v2
    s_mul_i32 s4, s42, 7168
    s_add_u32 s4, s4, 56064
    v_lshl_add_u32 v2, v1, 2, s4
    global_store_dword v2, v4, s[38:39] sc1
    s_branch Ldone_side_kernel
Lrole_side_kernel_3:
    s_sub_u32 s42, s42, 2
    s_cmp_ge_u32 s42, 32
    s_cbranch_scc1 Lrole_side_kernel_4
    v_mov_b32 v4, -1
    v_mov_b32 v5, -1
    v_mov_b32 v6, -1
    v_mov_b32 v7, -1
    s_mul_i32 s4, s42, 4096
    s_add_u32 s4, s4, 65536
    v_lshl_add_u32 v2, v0, 4, s4
    global_store_dwordx4 v2, v[4:7], s[38:39] sc1
    v_add_u32 v2, 4096, v2
    s_branch Ldone_side_kernel
Lrole_side_kernel_4:
    s_sub_u32 s42, s42, 32
Ldone_side_kernel:
Lend_side_kernel:
    s_endpgm
.p2align 8
.globl main_kernel
.type main_kernel,@function
main_kernel:
    s_cmp_ge_u32 s2, 256
    s_cbranch_scc1 Lend_main_kernel
    s_load_dwordx16 s[8:23], s[0:1], 0
    s_load_dwordx16 s[24:39], s[0:1], 64
    v_lshrrev_b32 v2, 6, v0
    v_and_b32 v1, 63, v0
    v_readfirstlane_b32 s3, v2
    s_getpc_b64 s[4:5]
Lpf_main_kernel_8:
    s_add_u32 s4, s4, main_kernel-Lpf_main_kernel_8
    s_addc_u32 s5, s5, -1
    s_lshr_b32 s6, s2, 3
    s_and_b32 s6, s6, 31
    v_mul_u32_u24 v254, 32, v0
    v_add_lshl_u32 v254, v254, s6, 7
    v_min_u32 v254, (Lcode_end-main_kernel-4), v254
    global_load_dword v254, v254, s[4:5]
    s_waitcnt lgkmcnt(0)
    s_mov_b32 s100, 0
    s_and_b32 s4, s2, 7
    s_lshr_b32 s5, s2, 3
    s_lshr_b32 s43, s5, 2
    s_lshr_b32 s6, s43, 1
    s_lshl_b32 s6, s6, 3
    s_and_b32 s7, s4, 6
    s_add_u32 s6, s6, s7
    s_and_b32 s7, s43, 1
    s_add_u32 s40, s6, s7
    s_and_b32 s6, s4, 1
    s_lshl_b32 s6, s6, 2
    s_and_b32 s7, s5, 3
    s_add_u32 s41, s6, s7
    s_cmp_ge_u32 s2, 160
    s_cbranch_scc1 Lspare
    s_mul_i32 s4, s4, 20
    s_add_u32 s42, s4, s5
    v_and_b32 v2, 15, v1
    v_lshrrev_b32 v3, 4, v1
    v_lshlrev_b32 v4, 4, v1
    v_lshrrev_b32 v6, 2, v2
    v_and_b32 v5, 3, v2
    v_lshl_add_u32 v5, v6, 3, v5
    s_lshl_b32 s4, s42, 2
    s_add_u32 s4, s4, s3
    s_lshl_b32 s4, s4, 12
    v_add_u32 v28, s4, v4
    s_mul_i32 s5, s3, 8448
    s_add_u32 m0, s5, 4288
    s_nop 0
    global_load_lds_dwordx4 v28, s[16:17] offset:0 nt
    global_load_lds_dwordx4 v28, s[16:17] offset:1024 nt
    global_load_lds_dwordx4 v28, s[16:17] offset:2048 nt
    global_load_lds_dwordx4 v28, s[16:17] offset:3072 nt
    s_mul_i32 s6, s3, 163840
    s_lshl_b32 s7, s42, 3
    s_add_u32 s6, s6, s7
    v_mul_u32_u24 v30, 2560, v1
    v_add_u32 v30, s6, v30
    global_load_dwordx2 v[32:33], v30, s[10:11] offset:0 nt
    global_load_dwordx2 v[34:35], v30, s[10:11] offset:1280 nt
    global_load_dwordx2 v[48:49], v30, s[12:13] offset:0 nt
    global_load_dwordx2 v[50:51], v30, s[12:13] offset:1280 nt
    v_add_u32 v30, 655360, v30
    s_lshl_b32 s4, s42, 5
    s_load_dwordx8 s[44:51], s[14:15], s4
    s_load_dwordx2 s[52:53], s[18:19], s7
    s_add_i32 s4, s6, -3840
    s_max_i32 s4, s4, 0
    s_load_dwordx2 s[54:55], s[10:11], s4
    s_add_i32 s4, s6, -2560
    s_max_i32 s4, s4, 0
    s_load_dwordx2 s[56:57], s[10:11], s4
    s_add_i32 s4, s6, -1280
    s_max_i32 s4, s4, 0
    s_load_dwordx2 s[58:59], s[10:11], s4
    s_add_i32 s4, s6, 651520
    s_load_dwordx2 s[60:61], s[10:11], s4
    s_add_i32 s4, s6, 652800
    s_load_dwordx2 s[62:63], s[10:11], s4
    s_add_i32 s4, s6, 654080
    s_load_dwordx2 s[64:65], s[10:11], s4
    s_add_i32 s4, s6, 1306880
    s_load_dwordx2 s[66:67], s[10:11], s4
    s_add_i32 s4, s6, 1308160
    s_load_dwordx2 s[68:69], s[10:11], s4
    s_add_i32 s4, s6, 1309440
    s_load_dwordx2 s[70:71], s[10:11], s4
    s_add_i32 s4, s6, 1962240
    s_load_dwordx2 s[72:73], s[10:11], s4
    s_add_i32 s4, s6, 1963520
    s_load_dwordx2 s[74:75], s[10:11], s4
    s_add_i32 s4, s6, 1964800
    s_load_dwordx2 s[76:77], s[10:11], s4
    v_mov_b32 v64, 0
    v_mov_b32 v65, 0
    v_mov_b32 v66, 0
    v_mov_b32 v67, 0
    v_and_b32 v28, 48, v4
    v_add_u32 v28, s5, v28
    ds_write_b128 v28, v[64:67] offset:0
    ds_write_b128 v28, v[64:67] offset:4224
    v_min_u32 v28, 448, v4
    s_mul_i32 s4, s3, 9280
    v_add_u32 v28, s4, v28
    ds_write_b128 v28, v[64:67] offset:37888
    ds_write_b128 v28, v[64:67] offset:42528
    v_add_u32 v69, s5, v4
    v_and_b32 v28, 1, v2
    v_lshrrev_b32 v29, 1, v2
    v_mul_u32_u24 v68, 4224, v28
    v_lshl_add_u32 v68, v29, 3, v68
    v_lshl_add_u32 v68, v3, 4, v68
    v_add_u32 v68, s5, v68
    v_mul_u32_u24 v70, 4640, v28
    v_lshlrev_b32 v29, 6, v29
    v_sub_u32 v70, v70, v29
    v_lshl_add_u32 v70, v3, 4, v70
    s_add_u32 s4, s4, 34256
    v_add_u32 v70, s4, v70
    v_lshl_add_u32 v72, v28, 2, v29
    v_lshl_add_u32 v72, v3, 4, v72
    s_mul_i32 s4, s3, 1056
    s_add_u32 s4, s4, 83200
    v_add_u32 v72, s4, v72
    v_lshlrev_b32 v28, 2, v0
    v_sub_u32 v71, 34824, v28
    v_add_u32 v73, 83200, v28
    s_lshl_b32 s4, s42, 14
    s_add_u32 s4, s4, 1052672
    v_lshl_add_u32 v74, v0, 4, s4
    v_add_u32 v75, 3145728, v74
    s_and_b32 s4, s41, 1
    s_lshl_b32 s5, s3, 1
    s_add_u32 s5, s5, s4
    s_cmp_eq_u32 s5, 7
    s_cselect_b32 s5, 0, s5
    s_mul_i32 s96, s41, 7
    s_add_u32 s96, s96, s5
    s_add_u32 s97, s96, 1
    s_cmp_eq_u32 s3, 3
    s_cselect_b32 s97, 55, s97
    s_cselect_b32 s5, 0, -1
    s_mul_i32 s4, s96, 20480
    s_add_u32 s4, s4, 7344128
    v_add_u32 v6, s4, v4
    s_mul_i32 s4, s97, 20480
    s_add_u32 s4, s4, 7344128
    v_and_b32 v7, s5, v4
    v_add_u32 v7, s4, v7
    s_waitcnt lgkmcnt(0)
    s_lshl_b32 s78, s44, 16
    s_lshl_b32 s79, s46, 16
    s_lshl_b32 s80, s48, 16
    s_lshl_b32 s81, s50, 16
    s_and_b32 s82, s44, 0xffff0000
    s_and_b32 s83, s46, 0xffff0000
    s_and_b32 s84, s48, 0xffff0000
    s_and_b32 s85, s50, 0xffff0000
    s_lshl_b32 s86, s45, 16
    s_lshl_b32 s87, s47, 16
    s_lshl_b32 s88, s49, 16
    s_lshl_b32 s89, s51, 16
    s_and_b32 s90, s45, 0xffff0000
    s_and_b32 s91, s47, 0xffff0000
    s_and_b32 s92, s49, 0xffff0000
    s_and_b32 s93, s51, 0xffff0000
    s_lshl_b32 s44, s52, 16
    s_lshr_b32 s48, s44, 16
    s_and_b32 s45, s52, 0xffff0000
    s_lshr_b32 s49, s45, 16
    s_lshl_b32 s46, s53, 16
    s_lshr_b32 s50, s46, 16
    s_and_b32 s47, s53, 0xffff0000
    s_lshr_b32 s51, s47, 16
    s_cmp_eq_u32 s3, 0
    s_cselect_b32 s54, 0, s54
    s_cselect_b32 s55, 0, s55
    s_cselect_b32 s56, 0, s56
    s_cselect_b32 s57, 0, s57
    s_cselect_b32 s58, 0, s58
    s_cselect_b32 s59, 0, s59
    s_waitcnt vmcnt(4)
    ds_read_b128 v[110:113], v69 offset:4288
    ds_read_b32 v109, v69 offset:4284
    ds_read_b128 v[118:121], v69 offset:5312
    ds_read_b32 v117, v69 offset:5308
    ds_read_b128 v[126:129], v69 offset:6336
    ds_read_b32 v125, v69 offset:6332
    ds_read_b128 v[134:137], v69 offset:7360
    ds_read_b32 v133, v69 offset:7356
    s_waitcnt lgkmcnt(6)
    v_alignbit_b32 v140, v110, v109, 16
    v_alignbit_b32 v141, v111, v110, 16
    v_alignbit_b32 v142, v112, v111, 16
    v_alignbit_b32 v143, v113, v112, 16
    ds_write_b128 v69, v[140:143] offset:64
    s_waitcnt lgkmcnt(5)
    v_alignbit_b32 v144, v118, v117, 16
    v_alignbit_b32 v145, v119, v118, 16
    v_alignbit_b32 v146, v120, v119, 16
    v_alignbit_b32 v147, v121, v120, 16
    ds_write_b128 v69, v[144:147] offset:1088
    s_waitcnt lgkmcnt(4)
    v_alignbit_b32 v148, v126, v125, 16
    v_alignbit_b32 v149, v127, v126, 16
    v_alignbit_b32 v150, v128, v127, 16
    v_alignbit_b32 v151, v129, v128, 16
    ds_write_b128 v69, v[148:151] offset:2112
    s_waitcnt lgkmcnt(3)
    v_alignbit_b32 v152, v134, v133, 16
    v_alignbit_b32 v153, v135, v134, 16
    v_alignbit_b32 v154, v136, v135, 16
    v_alignbit_b32 v155, v137, v136, 16
    ds_write_b128 v69, v[152:155] offset:3136
    ds_read_b64 a[0:1], v68 offset:8
    ds_read_b64 a[2:3], v68 offset:16
    ds_read_b64 a[4:5], v68 offset:72
    ds_read_b64 a[6:7], v68 offset:80
    ds_read_b64 a[8:9], v68 offset:136
    ds_read_b64 a[10:11], v68 offset:144
    ds_read_b64 a[12:13], v68 offset:200
    ds_read_b64 a[14:15], v68 offset:208
    ds_read_b64 a[16:17], v68 offset:264
    ds_read_b64 a[18:19], v68 offset:272
    ds_read_b64 a[20:21], v68 offset:328
    ds_read_b64 a[22:23], v68 offset:336
    ds_read_b64 a[24:25], v68 offset:392
    ds_read_b64 a[26:27], v68 offset:400
    ds_read_b64 a[28:29], v68 offset:456
    ds_read_b64 a[30:31], v68 offset:464
    ds_read_b64 a[32:33], v68 offset:520
    ds_read_b64 a[34:35], v68 offset:528
    global_load_dwordx2 v[36:37], v30, s[10:11] offset:0 nt
    ds_read_b64 a[36:37], v68 offset:584
    ds_read_b64 a[38:39], v68 offset:592
    ds_read_b64 a[40:41], v68 offset:648
    ds_read_b64 a[42:43], v68 offset:656
    ds_read_b64 a[44:45], v68 offset:712
    ds_read_b64 a[46:47], v68 offset:720
    ds_read_b64 a[48:49], v68 offset:776
    ds_read_b64 a[50:51], v68 offset:784
    ds_read_b64 a[52:53], v68 offset:840
    ds_read_b64 a[54:55], v68 offset:848
    ds_read_b64 a[56:57], v68 offset:904
    ds_read_b64 a[58:59], v68 offset:912
    ds_read_b64 a[60:61], v68 offset:968
    ds_read_b64 a[62:63], v68 offset:976
    ds_read_b64 a[64:65], v68 offset:1032
    ds_read_b64 a[66:67], v68 offset:1040
    ds_read_b64 a[68:69], v68 offset:1096
    ds_read_b64 a[70:71], v68 offset:1104
    ds_read_b64 a[72:73], v68 offset:1160
    ds_read_b64 a[74:75], v68 offset:1168
    ds_read_b64 a[76:77], v68 offset:1224
    ds_read_b64 a[78:79], v68 offset:1232
    global_load_dwordx2 v[38:39], v30, s[10:11] offset:1280 nt
    ds_read_b64 a[80:81], v68 offset:1288
    ds_read_b64 a[82:83], v68 offset:1296
    ds_read_b64 a[84:85], v68 offset:1352
    ds_read_b64 a[86:87], v68 offset:1360
    ds_read_b64 a[88:89], v68 offset:1416
    ds_read_b64 a[90:91], v68 offset:1424
    ds_read_b64 a[92:93], v68 offset:1480
    ds_read_b64 a[94:95], v68 offset:1488
    ds_read_b64 a[96:97], v68 offset:1544
    ds_read_b64 a[98:99], v68 offset:1552
    ds_read_b64 a[100:101], v68 offset:1608
    ds_read_b64 a[102:103], v68 offset:1616
    ds_read_b64 a[104:105], v68 offset:1672
    ds_read_b64 a[106:107], v68 offset:1680
    ds_read_b64 a[108:109], v68 offset:1736
    ds_read_b64 a[110:111], v68 offset:1744
    ds_read_b64 a[112:113], v68 offset:1800
    ds_read_b64 a[114:115], v68 offset:1808
    ds_read_b64 a[116:117], v68 offset:1864
    ds_read_b64 a[118:119], v68 offset:1872
    ds_read_b64 a[120:121], v68 offset:1928
    ds_read_b64 a[122:123], v68 offset:1936
    global_load_dwordx2 v[52:53], v30, s[12:13] offset:0 nt
    ds_read_b64 a[124:125], v68 offset:1992
    ds_read_b64 a[126:127], v68 offset:2000
    ds_read_b64 a[128:129], v68 offset:2056
    ds_read_b64 a[130:131], v68 offset:2064
    ds_read_b64 a[132:133], v68 offset:2120
    ds_read_b64 a[134:135], v68 offset:2128
    ds_read_b64 a[136:137], v68 offset:2184
    ds_read_b64 a[138:139], v68 offset:2192
    ds_read_b64 a[140:141], v68 offset:2248
    ds_read_b64 a[142:143], v68 offset:2256
    ds_read_b64 a[144:145], v68 offset:2312
    ds_read_b64 a[146:147], v68 offset:2320
    ds_read_b64 a[148:149], v68 offset:2376
    ds_read_b64 a[150:151], v68 offset:2384
    ds_read_b64 a[152:153], v68 offset:2440
    ds_read_b64 a[154:155], v68 offset:2448
    ds_read_b64 a[156:157], v68 offset:2504
    ds_read_b64 a[158:159], v68 offset:2512
    ds_read_b64 a[160:161], v68 offset:2568
    ds_read_b64 a[162:163], v68 offset:2576
    ds_read_b64 a[164:165], v68 offset:2632
    ds_read_b64 a[166:167], v68 offset:2640
    global_load_dwordx2 v[54:55], v30, s[12:13] offset:1280 nt
    ds_read_b64 a[168:169], v68 offset:2696
    ds_read_b64 a[170:171], v68 offset:2704
    ds_read_b64 a[172:173], v68 offset:2760
    ds_read_b64 a[174:175], v68 offset:2768
    ds_read_b64 a[176:177], v68 offset:2824
    ds_read_b64 a[178:179], v68 offset:2832
    ds_read_b64 a[180:181], v68 offset:2888
    ds_read_b64 a[182:183], v68 offset:2896
    ds_read_b64 a[184:185], v68 offset:2952
    ds_read_b64 a[186:187], v68 offset:2960
    ds_read_b64 a[188:189], v68 offset:3016
    ds_read_b64 a[190:191], v68 offset:3024
    ds_read_b64 a[192:193], v68 offset:3080
    ds_read_b64 a[194:195], v68 offset:3088
    ds_read_b64 a[196:197], v68 offset:3144
    ds_read_b64 a[198:199], v68 offset:3152
    ds_read_b64 a[200:201], v68 offset:3208
    ds_read_b64 a[202:203], v68 offset:3216
    ds_read_b64 a[204:205], v68 offset:3272
    ds_read_b64 a[206:207], v68 offset:3280
    ds_read_b64 a[208:209], v68 offset:3336
    ds_read_b64 a[210:211], v68 offset:3344
    v_add_u32 v30, 655360, v30
    ds_read_b64 a[212:213], v68 offset:3400
    ds_read_b64 a[214:215], v68 offset:3408
    ds_read_b64 a[216:217], v68 offset:3464
    ds_read_b64 a[218:219], v68 offset:3472
    ds_read_b64 a[220:221], v68 offset:3528
    ds_read_b64 a[222:223], v68 offset:3536
    ds_read_b64 a[224:225], v68 offset:3592
    ds_read_b64 a[226:227], v68 offset:3600
    ds_read_b64 a[228:229], v68 offset:3656
    ds_read_b64 a[230:231], v68 offset:3664
    ds_read_b64 a[232:233], v68 offset:3720
    ds_read_b64 a[234:235], v68 offset:3728
    ds_read_b64 a[236:237], v68 offset:3784
    ds_read_b64 a[238:239], v68 offset:3792
    ds_read_b64 a[240:241], v68 offset:3848
    ds_read_b64 a[242:243], v68 offset:3856
    ds_read_b64 a[244:245], v68 offset:3912
    ds_read_b64 a[246:247], v68 offset:3920
    ds_read_b64 a[248:249], v68 offset:3976
    ds_read_b64 a[250:251], v68 offset:3984
    ds_read_b64 a[252:253], v68 offset:4040
    ds_read_b64 a[254:255], v68 offset:4048
    s_waitcnt lgkmcnt(0)
    s_barrier
    v_mov_b32 v196, s54
    v_mov_b32 v197, s55
    v_mov_b32 v198, s56
    v_mov_b32 v199, s57
    v_mov_b32 v200, s58
    v_mov_b32 v201, s59
    s_waitcnt vmcnt(7)
    v_mov_b32_dpp v198, v32 wave_shr:1 row_mask:0xf bank_mask:0xf
    v_mov_b32_dpp v199, v33 wave_shr:1 row_mask:0xf bank_mask:0xf
    s_waitcnt vmcnt(6)
    v_mov_b32_dpp v200, v34 wave_shr:1 row_mask:0xf bank_mask:0xf
    v_mov_b32_dpp v201, v35 wave_shr:1 row_mask:0xf bank_mask:0xf
    v_lshlrev_b32 v214, 16, v32
    v_and_b32 v215, 0xffff0000, v32
    v_lshlrev_b32 v216, 16, v33
    v_and_b32 v217, 0xffff0000, v33
    v_lshlrev_b32 v218, 16, v34
    v_and_b32 v219, 0xffff0000, v34
    v_lshlrev_b32 v220, 16, v35
    v_and_b32 v221, 0xffff0000, v35
    v_mov_b32_dpp v196, v200 wave_shr:1 row_mask:0xf bank_mask:0xf
    v_mov_b32_dpp v197, v201 wave_shr:1 row_mask:0xf bank_mask:0xf
    v_lshlrev_b32 v210, 16, v200
    v_and_b32 v211, 0xffff0000, v200
    v_lshlrev_b32 v212, 16, v201
    v_and_b32 v213, 0xffff0000, v201
    v_lshlrev_b32 v206, 16, v198
    v_and_b32 v207, 0xffff0000, v198
    v_lshlrev_b32 v208, 16, v199
    v_and_b32 v209, 0xffff0000, v199
    v_lshlrev_b32 v202, 16, v196
    v_and_b32 v203, 0xffff0000, v196
    v_lshlrev_b32 v204, 16, v197
    v_and_b32 v205, 0xffff0000, v197
    v_pk_mul_f32 v[188:189], v[214:215], s[78:79] op_sel:[0,0] op_sel_hi:[1,1]
    v_pk_mul_f32 v[190:191], v[216:217], s[80:81] op_sel:[0,0] op_sel_hi:[1,1]
    v_pk_mul_f32 v[192:193], v[218:219], s[78:79] op_sel:[0,0] op_sel_hi:[1,1]
    v_pk_mul_f32 v[194:195], v[220:221], s[80:81] op_sel:[0,0] op_sel_hi:[1,1]
    v_pk_fma_f32 v[188:189], v[210:211], s[82:83], v[188:189] op_sel:[0,0,0] op_sel_hi:[1,1,1]
    v_pk_fma_f32 v[190:191], v[212:213], s[84:85], v[190:191] op_sel:[0,0,0] op_sel_hi:[1,1,1]
    v_pk_fma_f32 v[192:193], v[214:215], s[82:83], v[192:193] op_sel:[0,0,0] op_sel_hi:[1,1,1]
    v_pk_fma_f32 v[194:195], v[216:217], s[84:85], v[194:195] op_sel:[0,0,0] op_sel_hi:[1,1,1]
    v_pk_fma_f32 v[188:189], v[206:207], s[86:87], v[188:189] op_sel:[0,0,0] op_sel_hi:[1,1,1]
    v_pk_fma_f32 v[190:191], v[208:209], s[88:89], v[190:191] op_sel:[0,0,0] op_sel_hi:[1,1,1]
    v_pk_fma_f32 v[192:193], v[210:211], s[86:87], v[192:193] op_sel:[0,0,0] op_sel_hi:[1,1,1]
    v_pk_fma_f32 v[194:195], v[212:213], s[88:89], v[194:195] op_sel:[0,0,0] op_sel_hi:[1,1,1]
    v_pk_fma_f32 v[188:189], v[202:203], s[90:91], v[188:189] op_sel:[0,0,0] op_sel_hi:[1,1,1]
    v_pk_fma_f32 v[190:191], v[204:205], s[92:93], v[190:191] op_sel:[0,0,0] op_sel_hi:[1,1,1]
    v_pk_fma_f32 v[192:193], v[206:207], s[90:91], v[192:193] op_sel:[0,0,0] op_sel_hi:[1,1,1]
    v_pk_fma_f32 v[194:195], v[208:209], s[92:93], v[194:195] op_sel:[0,0,0] op_sel_hi:[1,1,1]
    s_waitcnt vmcnt(5)
    v_lshlrev_b32 v202, 16, v48
    v_and_b32 v203, 0xffff0000, v48
    v_lshlrev_b32 v204, 16, v49
    v_and_b32 v205, 0xffff0000, v49
    s_waitcnt vmcnt(4)
    v_lshlrev_b32 v206, 16, v50
    v_and_b32 v207, 0xffff0000, v50
    v_lshlrev_b32 v208, 16, v51
    v_and_b32 v209, 0xffff0000, v51
    v_pk_mul_f32 v[188:189], v[188:189], v[202:203] op_sel:[0,0] op_sel_hi:[1,1]
    v_pk_mul_f32 v[190:191], v[190:191], v[204:205] op_sel:[0,0] op_sel_hi:[1,1]
    v_pk_mul_f32 v[192:193], v[192:193], v[206:207] op_sel:[0,0] op_sel_hi:[1,1]
    v_pk_mul_f32 v[194:195], v[194:195], v[208:209] op_sel:[0,0] op_sel_hi:[1,1]
    v_cvt_pk_bf16_f32 v172, v192, v188
    v_cvt_pk_bf16_f32 v173, v193, v189
    v_cvt_pk_bf16_f32 v174, v194, v190
    v_cvt_pk_bf16_f32 v175, v195, v191
    ds_write_b32 v71, v172 offset:3072
    ds_write_b32 v71, v172 offset:7716
    ds_write_b32 v71, v173 offset:12352
    ds_write_b32 v71, v173 offset:16996
    ds_write_b32 v71, v174 offset:21632
    ds_write_b32 v71, v174 offset:26276
    ds_write_b32 v71, v175 offset:30912
    ds_write_b32 v71, v175 offset:35556
    s_waitcnt lgkmcnt(0)
    s_barrier
    ds_read_b128 v[108:111], v70 offset:3584
    ds_read_b128 v[112:115], v70 offset:3648
    ds_read_b128 v[116:119], v70 offset:3712
    ds_read_b128 v[120:123], v70 offset:3776
    ds_read_b128 v[124:127], v70 offset:3840
    ds_read_b128 v[128:131], v70 offset:3904
    ds_read_b128 v[132:135], v70 offset:3968
    ds_read_b128 v[136:139], v70 offset:4032
    s_waitcnt lgkmcnt(7)
    v_mfma_f32_16x16x32_bf16 v[76:79], a[0:3], v[108:111], 0
    ds_read_b128 v[140:143], v70 offset:3072
    v_mfma_f32_16x16x32_bf16 v[80:83], a[32:35], v[108:111], 0
    ds_read_b128 v[144:147], v70 offset:3136
    s_waitcnt lgkmcnt(8)
    v_mfma_f32_16x16x32_bf16 v[76:79], a[4:7], v[112:115], v[76:79]
    ds_read_b128 v[148:151], v70 offset:3200
    v_mfma_f32_16x16x32_bf16 v[80:83], a[36:39], v[112:115], v[80:83]
    ds_read_b128 v[152:155], v70 offset:3264
    s_waitcnt lgkmcnt(9)
    v_mfma_f32_16x16x32_bf16 v[76:79], a[8:11], v[116:119], v[76:79]
    ds_read_b128 v[156:159], v70 offset:3328
    global_load_dwordx2 v[40:41], v30, s[10:11] offset:0 nt
    v_mfma_f32_16x16x32_bf16 v[80:83], a[40:43], v[116:119], v[80:83]
    ds_read_b128 v[160:163], v70 offset:3392
    s_waitcnt lgkmcnt(10)
    v_mfma_f32_16x16x32_bf16 v[76:79], a[12:15], v[120:123], v[76:79]
    ds_read_b128 v[164:167], v70 offset:3456
    v_mfma_f32_16x16x32_bf16 v[80:83], a[44:47], v[120:123], v[80:83]
    ds_read_b128 v[168:171], v70 offset:3520
    s_waitcnt lgkmcnt(11)
    v_mfma_f32_16x16x32_bf16 v[76:79], a[16:19], v[124:127], v[76:79]
    v_mfma_f32_16x16x32_bf16 v[80:83], a[48:51], v[124:127], v[80:83]
    s_waitcnt lgkmcnt(10)
    v_mfma_f32_16x16x32_bf16 v[76:79], a[20:23], v[128:131], v[76:79]
    v_mfma_f32_16x16x32_bf16 v[80:83], a[52:55], v[128:131], v[80:83]
    global_load_dwordx2 v[42:43], v30, s[10:11] offset:1280 nt
    s_waitcnt lgkmcnt(9)
    v_mfma_f32_16x16x32_bf16 v[76:79], a[24:27], v[132:135], v[76:79]
    v_mfma_f32_16x16x32_bf16 v[80:83], a[56:59], v[132:135], v[80:83]
    s_waitcnt lgkmcnt(8)
    v_mfma_f32_16x16x32_bf16 v[76:79], a[28:31], v[136:139], v[76:79]
    v_mfma_f32_16x16x32_bf16 v[80:83], a[60:63], v[136:139], v[80:83]
    s_waitcnt lgkmcnt(7)
    v_mfma_f32_16x16x32_bf16 v[80:83], a[0:3], v[140:143], v[80:83]
    s_waitcnt lgkmcnt(6)
    v_mfma_f32_16x16x32_bf16 v[80:83], a[4:7], v[144:147], v[80:83]
    s_waitcnt lgkmcnt(5)
    v_mfma_f32_16x16x32_bf16 v[80:83], a[8:11], v[148:151], v[80:83]
    global_load_dwordx2 v[56:57], v30, s[12:13] offset:0 nt
    s_waitcnt lgkmcnt(4)
    v_mfma_f32_16x16x32_bf16 v[80:83], a[12:15], v[152:155], v[80:83]
    s_waitcnt lgkmcnt(3)
    v_mfma_f32_16x16x32_bf16 v[80:83], a[16:19], v[156:159], v[80:83]
    s_waitcnt lgkmcnt(2)
    v_mfma_f32_16x16x32_bf16 v[80:83], a[20:23], v[160:163], v[80:83]
    s_waitcnt lgkmcnt(1)
    v_mfma_f32_16x16x32_bf16 v[80:83], a[24:27], v[164:167], v[80:83]
    s_waitcnt lgkmcnt(0)
    v_mfma_f32_16x16x32_bf16 v[80:83], a[28:31], v[168:171], v[80:83]
    v_mfma_f32_16x16x32_bf16 v[84:87], a[64:67], v[108:111], 0
    v_mfma_f32_16x16x32_bf16 v[88:91], a[96:99], v[108:111], 0
    v_mfma_f32_16x16x32_bf16 v[92:95], a[128:131], v[108:111], 0
    global_load_dwordx2 v[58:59], v30, s[12:13] offset:1280 nt
    v_mfma_f32_16x16x32_bf16 v[96:99], a[160:163], v[108:111], 0
    v_mfma_f32_16x16x32_bf16 v[100:103], a[192:195], v[108:111], 0
    v_cvt_pk_bf16_f32 v64, v76, v77
    v_mfma_f32_16x16x32_bf16 v[104:107], a[224:227], v[108:111], 0
    v_cvt_pk_bf16_f32 v65, v78, v79
    v_mfma_f32_16x16x32_bf16 v[84:87], a[68:71], v[112:115], v[84:87]
    ds_write2_b32 v72, v64, v65 offset0:0 offset1:2
    v_mfma_f32_16x16x32_bf16 v[88:91], a[100:103], v[112:115], v[88:91]
    v_cvt_pk_bf16_f32 v66, v80, v81
    v_mfma_f32_16x16x32_bf16 v[92:95], a[132:135], v[112:115], v[92:95]
    v_cvt_pk_bf16_f32 v67, v82, v83
    v_mfma_f32_16x16x32_bf16 v[96:99], a[164:167], v[112:115], v[96:99]
    ds_write2_b32 v72, v66, v67 offset0:128 offset1:130
    v_add_u32 v30, 655360, v30
    v_mfma_f32_16x16x32_bf16 v[100:103], a[196:199], v[112:115], v[100:103]
    v_add_u32 v72, 4224, v72
    v_mfma_f32_16x16x32_bf16 v[104:107], a[228:231], v[112:115], v[104:107]
    v_mfma_f32_16x16x32_bf16 v[84:87], a[72:75], v[116:119], v[84:87]
    v_mfma_f32_16x16x32_bf16 v[88:91], a[104:107], v[116:119], v[88:91]
    v_mfma_f32_16x16x32_bf16 v[92:95], a[136:139], v[116:119], v[92:95]
    v_mfma_f32_16x16x32_bf16 v[96:99], a[168:171], v[116:119], v[96:99]
    v_mfma_f32_16x16x32_bf16 v[100:103], a[200:203], v[116:119], v[100:103]
    v_mfma_f32_16x16x32_bf16 v[104:107], a[232:235], v[116:119], v[104:107]
    v_mfma_f32_16x16x32_bf16 v[84:87], a[76:79], v[120:123], v[84:87]
    v_mfma_f32_16x16x32_bf16 v[88:91], a[108:111], v[120:123], v[88:91]
    v_mfma_f32_16x16x32_bf16 v[92:95], a[140:143], v[120:123], v[92:95]
    v_mfma_f32_16x16x32_bf16 v[96:99], a[172:175], v[120:123], v[96:99]
    v_mfma_f32_16x16x32_bf16 v[100:103], a[204:207], v[120:123], v[100:103]
    v_mfma_f32_16x16x32_bf16 v[104:107], a[236:239], v[120:123], v[104:107]
    v_mfma_f32_16x16x32_bf16 v[84:87], a[80:83], v[124:127], v[84:87]
    v_mfma_f32_16x16x32_bf16 v[88:91], a[112:115], v[124:127], v[88:91]
    v_mfma_f32_16x16x32_bf16 v[92:95], a[144:147], v[124:127], v[92:95]
    v_mov_b32 v196, s60
    v_mov_b32 v197, s61
    v_mfma_f32_16x16x32_bf16 v[96:99], a[176:179], v[124:127], v[96:99]
    v_mov_b32 v198, s62
    v_mov_b32 v199, s63
    v_mfma_f32_16x16x32_bf16 v[100:103], a[208:211], v[124:127], v[100:103]
    v_mov_b32 v200, s64
    v_mfma_f32_16x16x32_bf16 v[104:107], a[240:243], v[124:127], v[104:107]
    v_mov_b32 v201, s65
    s_waitcnt vmcnt(7)
    v_mov_b32_dpp v198, v36 wave_shr:1 row_mask:0xf bank_mask:0xf
    v_mfma_f32_16x16x32_bf16 v[84:87], a[84:87], v[128:131], v[84:87]
    v_mov_b32_dpp v199, v37 wave_shr:1 row_mask:0xf bank_mask:0xf
    s_waitcnt vmcnt(6)
    v_mov_b32_dpp v200, v38 wave_shr:1 row_mask:0xf bank_mask:0xf
    v_mfma_f32_16x16x32_bf16 v[88:91], a[116:119], v[128:131], v[88:91]
    v_mov_b32_dpp v201, v39 wave_shr:1 row_mask:0xf bank_mask:0xf
    v_mfma_f32_16x16x32_bf16 v[92:95], a[148:151], v[128:131], v[92:95]
    v_lshlrev_b32 v214, 16, v36
    v_and_b32 v215, 0xffff0000, v36
    v_mfma_f32_16x16x32_bf16 v[96:99], a[180:183], v[128:131], v[96:99]
    v_lshlrev_b32 v216, 16, v37
    v_mfma_f32_16x16x32_bf16 v[100:103], a[212:215], v[128:131], v[100:103]
    v_and_b32 v217, 0xffff0000, v37
    v_lshlrev_b32 v218, 16, v38
    v_mfma_f32_16x16x32_bf16 v[104:107], a[244:247], v[128:131], v[104:107]
    v_and_b32 v219, 0xffff0000, v38
    v_lshlrev_b32 v220, 16, v39
    v_mfma_f32_16x16x32_bf16 v[84:87], a[88:91], v[132:135], v[84:87]
    v_lshlrev_b32 v28, 4, v0
    v_and_b32 v221, 0xffff0000, v39
    v_mfma_f32_16x16x32_bf16 v[88:91], a[120:123], v[132:135], v[88:91]
    v_mov_b32_dpp v196, v200 wave_shr:1 row_mask:0xf bank_mask:0xf
    v_mov_b32_dpp v197, v201 wave_shr:1 row_mask:0xf bank_mask:0xf
    v_mfma_f32_16x16x32_bf16 v[92:95], a[152:155], v[132:135], v[92:95]
    v_add_u32 v28, 36864, v28
    v_lshlrev_b32 v210, 16, v200
    v_mfma_f32_16x16x32_bf16 v[96:99], a[184:187], v[132:135], v[96:99]
    v_and_b32 v211, 0xffff0000, v200
    v_lshlrev_b32 v212, 16, v201
    v_mfma_f32_16x16x32_bf16 v[100:103], a[216:219], v[132:135], v[100:103]
    v_and_b32 v213, 0xffff0000, v201
    v_lshlrev_b32 v206, 16, v198
    v_mfma_f32_16x16x32_bf16 v[104:107], a[248:251], v[132:135], v[104:107]
    global_load_dwordx4 v[48:51], v28, s[38:39] offset:-4096 sc1
    v_and_b32 v207, 0xffff0000, v198
    v_mfma_f32_16x16x32_bf16 v[84:87], a[92:95], v[136:139], v[84:87]
    v_lshlrev_b32 v208, 16, v199
    v_and_b32 v209, 0xffff0000, v199
    v_mfma_f32_16x16x32_bf16 v[88:91], a[124:127], v[136:139], v[88:91]
    v_lshlrev_b32 v202, 16, v196
    v_mfma_f32_16x16x32_bf16 v[92:95], a[156:159], v[136:139], v[92:95]
    global_load_dwordx4 v[32:35], v28, s[38:39] offset:0 sc1
    v_and_b32 v203, 0xffff0000, v196
    v_lshlrev_b32 v204, 16, v197
    v_mfma_f32_16x16x32_bf16 v[96:99], a[188:191], v[136:139], v[96:99]
    v_and_b32 v205, 0xffff0000, v197
    v_mul_f32 v188, s78, v214
    v_mfma_f32_16x16x32_bf16 v[100:103], a[220:223], v[136:139], v[100:103]
    v_mul_f32 v189, s79, v215
    v_mfma_f32_16x16x32_bf16 v[104:107], a[252:255], v[136:139], v[104:107]
    v_add_u32 v28, 8192, v28
    v_mul_f32 v190, s80, v216
    v_mul_f32 v191, s81, v217
    v_mfma_f32_16x16x32_bf16 v[84:87], a[32:35], v[140:143], v[84:87]
    v_mul_f32 v192, s78, v218
    v_mfma_f32_16x16x32_bf16 v[88:91], a[64:67], v[140:143], v[88:91]
    v_mul_f32 v193, s79, v219
    v_mul_f32 v194, s80, v220
    v_mfma_f32_16x16x32_bf16 v[92:95], a[96:99], v[140:143], v[92:95]
    global_load_dwordx4 v[76:79], v28, s[38:39] offset:-4096 sc1
    v_mul_f32 v195, s81, v221
    v_fma_f32 v188, v210, s82, v188
    v_mfma_f32_16x16x32_bf16 v[96:99], a[128:131], v[140:143], v[96:99]
    v_fma_f32 v189, v211, s83, v189
    v_mfma_f32_16x16x32_bf16 v[100:103], a[160:163], v[140:143], v[100:103]
    v_fma_f32 v190, v212, s84, v190
    v_fma_f32 v191, v213, s85, v191
    v_mfma_f32_16x16x32_bf16 v[104:107], a[192:195], v[140:143], v[104:107]
    global_load_dwordx4 v[80:83], v28, s[38:39] offset:0 sc1
    v_fma_f32 v192, v214, s82, v192
    v_mfma_f32_16x16x32_bf16 v[84:87], a[36:39], v[144:147], v[84:87]
    v_fma_f32 v193, v215, s83, v193
    v_fma_f32 v194, v216, s84, v194
    v_mfma_f32_16x16x32_bf16 v[88:91], a[68:71], v[144:147], v[88:91]
    v_fma_f32 v195, v217, s85, v195
    v_fma_f32 v188, v206, s86, v188
    v_mfma_f32_16x16x32_bf16 v[92:95], a[100:103], v[144:147], v[92:95]
    v_min_u32 v28, 11, v1
    v_fma_f32 v189, v207, s87, v189
    v_mfma_f32_16x16x32_bf16 v[96:99], a[132:135], v[144:147], v[96:99]
    v_fma_f32 v190, v208, s88, v190
    v_fma_f32 v191, v209, s89, v191
    v_mfma_f32_16x16x32_bf16 v[100:103], a[164:167], v[144:147], v[100:103]
    v_fma_f32 v192, v210, s86, v192
    v_mfma_f32_16x16x32_bf16 v[104:107], a[196:199], v[144:147], v[104:107]
    v_lshrrev_b32 v29, 2, v28
    v_fma_f32 v193, v211, s87, v193
    v_fma_f32 v194, v212, s88, v194
    v_mfma_f32_16x16x32_bf16 v[84:87], a[40:43], v[148:151], v[84:87]
    v_fma_f32 v195, v213, s89, v195
    v_fma_f32 v188, v202, s90, v188
    v_mfma_f32_16x16x32_bf16 v[88:91], a[72:75], v[148:151], v[88:91]
    v_fma_f32 v189, v203, s91, v189
    v_mfma_f32_16x16x32_bf16 v[92:95], a[104:107], v[148:151], v[92:95]
    v_mul_u32_u24 v29, 2544, v29
    v_fma_f32 v190, v204, s92, v190
    v_fma_f32 v191, v205, s93, v191
    v_mfma_f32_16x16x32_bf16 v[96:99], a[136:139], v[148:151], v[96:99]
    v_fma_f32 v192, v206, s90, v192
    v_mfma_f32_16x16x32_bf16 v[100:103], a[168:171], v[148:151], v[100:103]
    v_fma_f32 v193, v207, s91, v193
    v_fma_f32 v194, v208, s92, v194
    v_mfma_f32_16x16x32_bf16 v[104:107], a[200:203], v[148:151], v[104:107]
    v_lshl_add_u32 v28, v28, 2, v29
    v_fma_f32 v195, v209, s93, v195
    s_waitcnt vmcnt(9)
    v_lshlrev_b32 v202, 16, v52
    v_mfma_f32_16x16x32_bf16 v[84:87], a[44:47], v[152:155], v[84:87]
    v_and_b32 v203, 0xffff0000, v52
    v_mfma_f32_16x16x32_bf16 v[88:91], a[76:79], v[152:155], v[88:91]
    v_lshlrev_b32 v204, 16, v53
    v_and_b32 v205, 0xffff0000, v53
    v_mfma_f32_16x16x32_bf16 v[92:95], a[108:111], v[152:155], v[92:95]
    s_lshl_b32 s4, s42, 4
    s_add_u32 s4, s4, 0
    v_add_u32 v28, s4, v28
    s_waitcnt vmcnt(8)
    v_lshlrev_b32 v206, 16, v54
    v_mfma_f32_16x16x32_bf16 v[96:99], a[140:143], v[152:155], v[96:99]
    v_and_b32 v207, 0xffff0000, v54
    v_lshlrev_b32 v208, 16, v55
    v_mfma_f32_16x16x32_bf16 v[100:103], a[172:175], v[152:155], v[100:103]
    v_and_b32 v209, 0xffff0000, v55
    v_mul_f32 v188, v188, v202
    v_mfma_f32_16x16x32_bf16 v[104:107], a[204:207], v[152:155], v[104:107]
    global_load_dword v226, v28, s[38:39] sc1
    v_mul_f32 v189, v189, v203
    v_mfma_f32_16x16x32_bf16 v[84:87], a[48:51], v[156:159], v[84:87]
    v_mul_f32 v190, v190, v204
    v_mul_f32 v191, v191, v205
    v_mfma_f32_16x16x32_bf16 v[88:91], a[80:83], v[156:159], v[88:91]
    v_mul_f32 v192, v192, v206
    v_mfma_f32_16x16x32_bf16 v[92:95], a[112:115], v[156:159], v[92:95]
    v_add_u32 v28, 15360, v28
    v_mul_f32 v193, v193, v207
    v_mul_f32 v194, v194, v208
    v_mfma_f32_16x16x32_bf16 v[96:99], a[144:147], v[156:159], v[96:99]
    v_mul_f32 v195, v195, v209
    v_cvt_pk_bf16_f32 v176, v192, v188
    v_mfma_f32_16x16x32_bf16 v[100:103], a[176:179], v[156:159], v[100:103]
    v_cvt_pk_bf16_f32 v177, v193, v189
    v_mfma_f32_16x16x32_bf16 v[104:107], a[208:211], v[156:159], v[104:107]
    global_load_dword v227, v28, s[38:39] sc1
    v_cvt_pk_bf16_f32 v178, v194, v190
    v_cvt_pk_bf16_f32 v179, v195, v191
    v_mfma_f32_16x16x32_bf16 v[84:87], a[52:55], v[160:163], v[84:87]
    ds_write_b32 v71, v176 offset:2048
    v_mfma_f32_16x16x32_bf16 v[88:91], a[84:87], v[160:163], v[88:91]
    ds_write_b32 v71, v176 offset:6692
    ds_write_b32 v71, v177 offset:11328
    v_mfma_f32_16x16x32_bf16 v[92:95], a[116:119], v[160:163], v[92:95]
    global_load_dwordx4 v[228:231], v74, s[38:39] offset:-4096 sc1
    ds_write_b32 v71, v177 offset:15972
    ds_write_b32 v71, v178 offset:20608
    v_mfma_f32_16x16x32_bf16 v[96:99], a[148:151], v[160:163], v[96:99]
    ds_write_b32 v71, v178 offset:25252
    v_mfma_f32_16x16x32_bf16 v[100:103], a[180:183], v[160:163], v[100:103]
    ds_write_b32 v71, v179 offset:29888
    ds_write_b32 v71, v179 offset:34532
    v_mfma_f32_16x16x32_bf16 v[104:107], a[212:215], v[160:163], v[104:107]
    global_load_dwordx4 v[232:235], v74, s[38:39] offset:0 sc1
    s_waitcnt lgkmcnt(0)
    s_barrier
    v_mfma_f32_16x16x32_bf16 v[84:87], a[56:59], v[164:167], v[84:87]
    ds_read_b128 v[108:111], v70 offset:2560
    v_mfma_f32_16x16x32_bf16 v[88:91], a[88:91], v[164:167], v[88:91]
    ds_read_b128 v[112:115], v70 offset:2624
    v_mfma_f32_16x16x32_bf16 v[92:95], a[120:123], v[164:167], v[92:95]
    v_add_u32 v74, 8192, v74
    ds_read_b128 v[116:119], v70 offset:2688
    v_mfma_f32_16x16x32_bf16 v[96:99], a[152:155], v[164:167], v[96:99]
    ds_read_b128 v[120:123], v70 offset:2752
    v_mfma_f32_16x16x32_bf16 v[100:103], a[184:187], v[164:167], v[100:103]
    ds_read_b128 v[124:127], v70 offset:2816
    v_mfma_f32_16x16x32_bf16 v[104:107], a[216:219], v[164:167], v[104:107]
    global_load_dwordx4 v[236:239], v74, s[38:39] offset:-4096 sc1
    ds_read_b128 v[128:131], v70 offset:2880
    v_mfma_f32_16x16x32_bf16 v[84:87], a[60:63], v[168:171], v[84:87]
    ds_read_b128 v[132:135], v70 offset:2944
    v_mfma_f32_16x16x32_bf16 v[88:91], a[92:95], v[168:171], v[88:91]
    ds_read_b128 v[136:139], v70 offset:3008
    v_mfma_f32_16x16x32_bf16 v[92:95], a[124:127], v[168:171], v[92:95]
    global_load_dwordx4 v[240:243], v74, s[38:39] offset:0 sc1
    v_mfma_f32_16x16x32_bf16 v[96:99], a[156:159], v[168:171], v[96:99]
    v_mfma_f32_16x16x32_bf16 v[100:103], a[188:191], v[168:171], v[100:103]
    v_mfma_f32_16x16x32_bf16 v[104:107], a[220:223], v[168:171], v[104:107]
    s_waitcnt lgkmcnt(7)
    v_mfma_f32_16x16x32_bf16 v[84:87], a[0:3], v[108:111], v[84:87]
    ds_read_b128 v[140:143], v70 offset:2048
    v_mfma_f32_16x16x32_bf16 v[88:91], a[32:35], v[108:111], v[88:91]
    ds_read_b128 v[144:147], v70 offset:2112
    s_waitcnt lgkmcnt(8)
    v_mfma_f32_16x16x32_bf16 v[84:87], a[4:7], v[112:115], v[84:87]
    ds_read_b128 v[148:151], v70 offset:2176
    global_load_dwordx2 v[44:45], v30, s[10:11] offset:0 nt
    v_mfma_f32_16x16x32_bf16 v[88:91], a[36:39], v[112:115], v[88:91]
    ds_read_b128 v[152:155], v70 offset:2240
    s_waitcnt lgkmcnt(9)
    v_mfma_f32_16x16x32_bf16 v[84:87], a[8:11], v[116:119], v[84:87]
    ds_read_b128 v[156:159], v70 offset:2304
    v_mfma_f32_16x16x32_bf16 v[88:91], a[40:43], v[116:119], v[88:91]
    ds_read_b128 v[160:163], v70 offset:2368
    s_waitcnt lgkmcnt(10)
    v_mfma_f32_16x16x32_bf16 v[84:87], a[12:15], v[120:123], v[84:87]
    ds_read_b128 v[164:167], v70 offset:2432
    v_mfma_f32_16x16x32_bf16 v[88:91], a[44:47], v[120:123], v[88:91]
    ds_read_b128 v[168:171], v70 offset:2496
    s_waitcnt lgkmcnt(11)
    v_mfma_f32_16x16x32_bf16 v[84:87], a[16:19], v[124:127], v[84:87]
    v_mfma_f32_16x16x32_bf16 v[88:91], a[48:51], v[124:127], v[88:91]
    global_load_dwordx2 v[46:47], v30, s[10:11] offset:1280 nt
    s_waitcnt lgkmcnt(10)
    v_mfma_f32_16x16x32_bf16 v[84:87], a[20:23], v[128:131], v[84:87]
    v_mfma_f32_16x16x32_bf16 v[88:91], a[52:55], v[128:131], v[88:91]
    s_waitcnt lgkmcnt(9)
    v_mfma_f32_16x16x32_bf16 v[84:87], a[24:27], v[132:135], v[84:87]
    v_mfma_f32_16x16x32_bf16 v[88:91], a[56:59], v[132:135], v[88:91]
    s_waitcnt lgkmcnt(8)
    v_mfma_f32_16x16x32_bf16 v[84:87], a[28:31], v[136:139], v[84:87]
    v_mfma_f32_16x16x32_bf16 v[88:91], a[60:63], v[136:139], v[88:91]
    s_waitcnt lgkmcnt(7)
    v_mfma_f32_16x16x32_bf16 v[88:91], a[0:3], v[140:143], v[88:91]
    global_load_dwordx2 v[60:61], v30, s[12:13] offset:0 nt
    s_waitcnt lgkmcnt(6)
    v_mfma_f32_16x16x32_bf16 v[88:91], a[4:7], v[144:147], v[88:91]
    s_waitcnt lgkmcnt(5)
    v_mfma_f32_16x16x32_bf16 v[88:91], a[8:11], v[148:151], v[88:91]
    s_waitcnt lgkmcnt(4)
    v_mfma_f32_16x16x32_bf16 v[88:91], a[12:15], v[152:155], v[88:91]
    s_waitcnt lgkmcnt(3)
    v_mfma_f32_16x16x32_bf16 v[88:91], a[16:19], v[156:159], v[88:91]
    s_waitcnt lgkmcnt(2)
    v_mfma_f32_16x16x32_bf16 v[88:91], a[20:23], v[160:163], v[88:91]
    s_waitcnt lgkmcnt(1)
    v_mfma_f32_16x16x32_bf16 v[88:91], a[24:27], v[164:167], v[88:91]
    s_waitcnt lgkmcnt(0)
    v_mfma_f32_16x16x32_bf16 v[88:91], a[28:31], v[168:171], v[88:91]
    global_load_dwordx2 v[62:63], v30, s[12:13] offset:1280 nt
    v_mfma_f32_16x16x32_bf16 v[92:95], a[64:67], v[108:111], v[92:95]
    v_mfma_f32_16x16x32_bf16 v[96:99], a[96:99], v[108:111], v[96:99]
    v_mfma_f32_16x16x32_bf16 v[100:103], a[128:131], v[108:111], v[100:103]
    v_mfma_f32_16x16x32_bf16 v[104:107], a[160:163], v[108:111], v[104:107]
    v_mfma_f32_16x16x32_bf16 v[92:95], a[68:71], v[112:115], v[92:95]
    v_cvt_pk_bf16_f32 v64, v84, v85
    v_mfma_f32_16x16x32_bf16 v[96:99], a[100:103], v[112:115], v[96:99]
    v_cvt_pk_bf16_f32 v65, v86, v87
    v_mfma_f32_16x16x32_bf16 v[100:103], a[132:135], v[112:115], v[100:103]
    ds_write2_b32 v72, v64, v65 offset0:0 offset1:2
    v_mfma_f32_16x16x32_bf16 v[104:107], a[164:167], v[112:115], v[104:107]
    v_cvt_pk_bf16_f32 v66, v88, v89
    v_mfma_f32_16x16x32_bf16 v[92:95], a[72:75], v[116:119], v[92:95]
    v_cvt_pk_bf16_f32 v67, v90, v91
    v_mfma_f32_16x16x32_bf16 v[96:99], a[104:107], v[116:119], v[96:99]
    ds_write2_b32 v72, v66, v67 offset0:128 offset1:130
    v_mfma_f32_16x16x32_bf16 v[100:103], a[136:139], v[116:119], v[100:103]
    v_add_u32 v72, 4224, v72
    v_mfma_f32_16x16x32_bf16 v[104:107], a[168:171], v[116:119], v[104:107]
    v_mfma_f32_16x16x32_bf16 v[92:95], a[76:79], v[120:123], v[92:95]
    v_mov_b32 v196, s66
    v_mov_b32 v197, s67
    v_mov_b32 v198, s68
    v_mfma_f32_16x16x32_bf16 v[96:99], a[108:111], v[120:123], v[96:99]
    v_mov_b32 v199, s69
    v_mov_b32 v200, s70
    v_mfma_f32_16x16x32_bf16 v[100:103], a[140:143], v[120:123], v[100:103]
    v_mov_b32 v201, s71
    s_waitcnt vmcnt(17)
    v_mov_b32_dpp v198, v40 wave_shr:1 row_mask:0xf bank_mask:0xf
    v_mfma_f32_16x16x32_bf16 v[104:107], a[172:175], v[120:123], v[104:107]
    v_mov_b32_dpp v199, v41 wave_shr:1 row_mask:0xf bank_mask:0xf
    s_waitcnt vmcnt(16)
    v_mov_b32_dpp v200, v42 wave_shr:1 row_mask:0xf bank_mask:0xf
    v_mfma_f32_16x16x32_bf16 v[92:95], a[80:83], v[124:127], v[92:95]
    v_mov_b32_dpp v201, v43 wave_shr:1 row_mask:0xf bank_mask:0xf
    v_lshlrev_b32 v214, 16, v40
    v_mfma_f32_16x16x32_bf16 v[96:99], a[112:115], v[124:127], v[96:99]
    v_and_b32 v215, 0xffff0000, v40
    v_lshlrev_b32 v216, 16, v41
    v_mfma_f32_16x16x32_bf16 v[100:103], a[144:147], v[124:127], v[100:103]
    v_and_b32 v217, 0xffff0000, v41
    v_lshlrev_b32 v218, 16, v42
    v_mfma_f32_16x16x32_bf16 v[104:107], a[176:179], v[124:127], v[104:107]
    v_and_b32 v219, 0xffff0000, v42
    v_lshlrev_b32 v220, 16, v43
    v_mfma_f32_16x16x32_bf16 v[92:95], a[84:87], v[128:131], v[92:95]
    v_and_b32 v221, 0xffff0000, v43
    v_mov_b32_dpp v196, v200 wave_shr:1 row_mask:0xf bank_mask:0xf
    v_mov_b32_dpp v197, v201 wave_shr:1 row_mask:0xf bank_mask:0xf
    v_mfma_f32_16x16x32_bf16 v[96:99], a[116:119], v[128:131], v[96:99]
    v_lshlrev_b32 v210, 16, v200
    v_and_b32 v211, 0xffff0000, v200
    v_mfma_f32_16x16x32_bf16 v[100:103], a[148:151], v[128:131], v[100:103]
    v_lshlrev_b32 v212, 16, v201
    v_and_b32 v213, 0xffff0000, v201
    v_mfma_f32_16x16x32_bf16 v[104:107], a[180:183], v[128:131], v[104:107]
    v_lshlrev_b32 v206, 16, v198
    v_and_b32 v207, 0xffff0000, v198
    v_mfma_f32_16x16x32_bf16 v[92:95], a[88:91], v[132:135], v[92:95]
    v_lshlrev_b32 v208, 16, v199
    v_and_b32 v209, 0xffff0000, v199
    v_mfma_f32_16x16x32_bf16 v[96:99], a[120:123], v[132:135], v[96:99]
    v_lshlrev_b32 v202, 16, v196
    v_and_b32 v203, 0xffff0000, v196
    v_mfma_f32_16x16x32_bf16 v[100:103], a[152:155], v[132:135], v[100:103]
    v_lshlrev_b32 v204, 16, v197
    v_and_b32 v205, 0xffff0000, v197
    v_mfma_f32_16x16x32_bf16 v[104:107], a[184:187], v[132:135], v[104:107]
    v_mul_f32 v188, s78, v214
    v_mul_f32 v189, s79, v215
    v_mfma_f32_16x16x32_bf16 v[92:95], a[92:95], v[136:139], v[92:95]
    v_mul_f32 v190, s80, v216
    v_mul_f32 v191, s81, v217
    v_mfma_f32_16x16x32_bf16 v[96:99], a[124:127], v[136:139], v[96:99]
    v_mul_f32 v192, s78, v218
    v_mul_f32 v193, s79, v219
    v_mul_f32 v194, s80, v220
    v_mfma_f32_16x16x32_bf16 v[100:103], a[156:159], v[136:139], v[100:103]
    v_mul_f32 v195, s81, v221
    v_fma_f32 v188, v210, s82, v188
    v_mfma_f32_16x16x32_bf16 v[104:107], a[188:191], v[136:139], v[104:107]
    v_fma_f32 v189, v211, s83, v189
    v_fma_f32 v190, v212, s84, v190
    v_mfma_f32_16x16x32_bf16 v[92:95], a[32:35], v[140:143], v[92:95]
    v_fma_f32 v191, v213, s85, v191
    v_fma_f32 v192, v214, s82, v192
    v_mfma_f32_16x16x32_bf16 v[96:99], a[64:67], v[140:143], v[96:99]
    v_fma_f32 v193, v215, s83, v193
    v_fma_f32 v194, v216, s84, v194
    v_mfma_f32_16x16x32_bf16 v[100:103], a[96:99], v[140:143], v[100:103]
    v_fma_f32 v195, v217, s85, v195
    v_fma_f32 v188, v206, s86, v188
    v_mfma_f32_16x16x32_bf16 v[104:107], a[128:131], v[140:143], v[104:107]
    v_fma_f32 v189, v207, s87, v189
    v_fma_f32 v190, v208, s88, v190
    v_mfma_f32_16x16x32_bf16 v[92:95], a[36:39], v[144:147], v[92:95]
    v_fma_f32 v191, v209, s89, v191
    v_fma_f32 v192, v210, s86, v192
    v_mfma_f32_16x16x32_bf16 v[96:99], a[68:71], v[144:147], v[96:99]
    v_fma_f32 v193, v211, s87, v193
    v_fma_f32 v194, v212, s88, v194
    v_mfma_f32_16x16x32_bf16 v[100:103], a[100:103], v[144:147], v[100:103]
    v_fma_f32 v195, v213, s89, v195
    v_fma_f32 v188, v202, s90, v188
    v_fma_f32 v189, v203, s91, v189
    v_mfma_f32_16x16x32_bf16 v[104:107], a[132:135], v[144:147], v[104:107]
    v_fma_f32 v190, v204, s92, v190
    v_fma_f32 v191, v205, s93, v191
    v_mfma_f32_16x16x32_bf16 v[92:95], a[40:43], v[148:151], v[92:95]
    v_fma_f32 v192, v206, s90, v192
    v_fma_f32 v193, v207, s91, v193
    v_mfma_f32_16x16x32_bf16 v[96:99], a[72:75], v[148:151], v[96:99]
    v_fma_f32 v194, v208, s92, v194
    v_fma_f32 v195, v209, s93, v195
    v_mfma_f32_16x16x32_bf16 v[100:103], a[104:107], v[148:151], v[100:103]
    s_waitcnt vmcnt(15)
    v_lshlrev_b32 v202, 16, v56
    v_and_b32 v203, 0xffff0000, v56
    v_mfma_f32_16x16x32_bf16 v[104:107], a[136:139], v[148:151], v[104:107]
    v_lshlrev_b32 v204, 16, v57
    v_and_b32 v205, 0xffff0000, v57
    v_mfma_f32_16x16x32_bf16 v[92:95], a[44:47], v[152:155], v[92:95]
    s_waitcnt vmcnt(14)
    v_lshlrev_b32 v206, 16, v58
    v_and_b32 v207, 0xffff0000, v58
    v_mfma_f32_16x16x32_bf16 v[96:99], a[76:79], v[152:155], v[96:99]
    v_lshlrev_b32 v208, 16, v59
    v_and_b32 v209, 0xffff0000, v59
    v_mfma_f32_16x16x32_bf16 v[100:103], a[108:111], v[152:155], v[100:103]
    v_mul_f32 v188, v188, v202
    v_mul_f32 v189, v189, v203
    v_mfma_f32_16x16x32_bf16 v[104:107], a[140:143], v[152:155], v[104:107]
    v_mul_f32 v190, v190, v204
    v_mul_f32 v191, v191, v205
    v_mul_f32 v192, v192, v206
    v_mfma_f32_16x16x32_bf16 v[92:95], a[48:51], v[156:159], v[92:95]
    v_mul_f32 v193, v193, v207
    v_mul_f32 v194, v194, v208
    v_mfma_f32_16x16x32_bf16 v[96:99], a[80:83], v[156:159], v[96:99]
    v_mul_f32 v195, v195, v209
    v_cvt_pk_bf16_f32 v180, v192, v188
    v_mfma_f32_16x16x32_bf16 v[100:103], a[112:115], v[156:159], v[100:103]
    v_cvt_pk_bf16_f32 v181, v193, v189
    v_cvt_pk_bf16_f32 v182, v194, v190
    v_mfma_f32_16x16x32_bf16 v[104:107], a[144:147], v[156:159], v[104:107]
    v_cvt_pk_bf16_f32 v183, v195, v191
    ds_write_b32 v71, v180 offset:1024
    v_mfma_f32_16x16x32_bf16 v[92:95], a[52:55], v[160:163], v[92:95]
    ds_write_b32 v71, v180 offset:5668
    ds_write_b32 v71, v181 offset:10304
    v_mfma_f32_16x16x32_bf16 v[96:99], a[84:87], v[160:163], v[96:99]
    ds_write_b32 v71, v181 offset:14948
    ds_write_b32 v71, v182 offset:19584
    v_mfma_f32_16x16x32_bf16 v[100:103], a[116:119], v[160:163], v[100:103]
    ds_write_b32 v71, v182 offset:24228
    ds_write_b32 v71, v183 offset:28864
    v_mfma_f32_16x16x32_bf16 v[104:107], a[148:151], v[160:163], v[104:107]
    ds_write_b32 v71, v183 offset:33508
    s_waitcnt lgkmcnt(0)
    s_barrier
    v_mfma_f32_16x16x32_bf16 v[92:95], a[56:59], v[164:167], v[92:95]
    ds_read_b128 v[108:111], v70 offset:1536
    v_mfma_f32_16x16x32_bf16 v[96:99], a[88:91], v[164:167], v[96:99]
    ds_read_b128 v[112:115], v70 offset:1600
    v_mfma_f32_16x16x32_bf16 v[100:103], a[120:123], v[164:167], v[100:103]
    ds_read_b128 v[116:119], v70 offset:1664
    v_mfma_f32_16x16x32_bf16 v[104:107], a[152:155], v[164:167], v[104:107]
    ds_read_b128 v[120:123], v70 offset:1728
    v_mfma_f32_16x16x32_bf16 v[92:95], a[60:63], v[168:171], v[92:95]
    ds_read_b128 v[124:127], v70 offset:1792
    v_mfma_f32_16x16x32_bf16 v[96:99], a[92:95], v[168:171], v[96:99]
    ds_read_b128 v[128:131], v70 offset:1856
    v_mfma_f32_16x16x32_bf16 v[100:103], a[124:127], v[168:171], v[100:103]
    ds_read_b128 v[132:135], v70 offset:1920
    v_mfma_f32_16x16x32_bf16 v[104:107], a[156:159], v[168:171], v[104:107]
    ds_read_b128 v[136:139], v70 offset:1984
    s_waitcnt lgkmcnt(7)
    v_mfma_f32_16x16x32_bf16 v[92:95], a[0:3], v[108:111], v[92:95]
    ds_read_b128 v[140:143], v70 offset:1024
    v_mfma_f32_16x16x32_bf16 v[96:99], a[32:35], v[108:111], v[96:99]
    ds_read_b128 v[144:147], v70 offset:1088
    s_waitcnt lgkmcnt(8)
    v_mfma_f32_16x16x32_bf16 v[92:95], a[4:7], v[112:115], v[92:95]
    ds_read_b128 v[148:151], v70 offset:1152
    v_mfma_f32_16x16x32_bf16 v[96:99], a[36:39], v[112:115], v[96:99]
    ds_read_b128 v[152:155], v70 offset:1216
    s_waitcnt lgkmcnt(9)
    v_mfma_f32_16x16x32_bf16 v[92:95], a[8:11], v[116:119], v[92:95]
    ds_read_b128 v[156:159], v70 offset:1280
    v_mfma_f32_16x16x32_bf16 v[96:99], a[40:43], v[116:119], v[96:99]
    ds_read_b128 v[160:163], v70 offset:1344
    s_waitcnt lgkmcnt(10)
    v_mfma_f32_16x16x32_bf16 v[92:95], a[12:15], v[120:123], v[92:95]
    ds_read_b128 v[164:167], v70 offset:1408
    s_waitcnt vmcnt(8)
    v_add_f32 v226, v226, v227
    v_cvt_pk_bf16_f32 v226, v226, v226
    v_mfma_f32_16x16x32_bf16 v[96:99], a[44:47], v[120:123], v[96:99]
    ds_read_b128 v[168:171], v70 offset:1472
    v_lshlrev_b32 v226, 16, v226
    v_mov_b32 v29, 1.0
    s_waitcnt lgkmcnt(11)
    v_mfma_f32_16x16x32_bf16 v[92:95], a[16:19], v[124:127], v[92:95]
    v_add_f32_dpp v226, v226, v29 quad_perm:[0,1,2,3] row_mask:0xf bank_mask:0x2
    v_cvt_pk_bf16_f32 v226, v226, v226
    v_mfma_f32_16x16x32_bf16 v[96:99], a[48:51], v[124:127], v[96:99]
    v_lshlrev_b32 v226, 16, v226
    s_nop 1
    v_mul_f32_dpp v227, v226, v226 row_shl:8 row_mask:0xf bank_mask:0x1
    s_waitcnt lgkmcnt(10)
    v_mfma_f32_16x16x32_bf16 v[92:95], a[20:23], v[128:131], v[92:95]
    v_mul_f32_dpp v227, v226, v226 row_shl:4 row_mask:0xf bank_mask:0x2
    v_mfma_f32_16x16x32_bf16 v[96:99], a[52:55], v[128:131], v[96:99]
    v_readlane_b32 s58, v227, 0
    v_readlane_b32 s59, v227, 1
    s_waitcnt lgkmcnt(9)
    v_mfma_f32_16x16x32_bf16 v[92:95], a[24:27], v[132:135], v[92:95]
    v_readlane_b32 s60, v227, 2
    v_readlane_b32 s61, v227, 3
    v_mfma_f32_16x16x32_bf16 v[96:99], a[56:59], v[132:135], v[96:99]
    v_readlane_b32 s54, v227, 4
    v_readlane_b32 s55, v227, 5
    s_waitcnt lgkmcnt(8)
    v_mfma_f32_16x16x32_bf16 v[92:95], a[28:31], v[136:139], v[92:95]
    v_readlane_b32 s56, v227, 6
    v_readlane_b32 s57, v227, 7
    v_mfma_f32_16x16x32_bf16 v[96:99], a[60:63], v[136:139], v[96:99]
    v_mov_b32 v222, s58
    s_waitcnt lgkmcnt(7)
    v_mfma_f32_16x16x32_bf16 v[96:99], a[0:3], v[140:143], v[96:99]
    v_mov_b32 v223, s59
    v_mov_b32 v224, s60
    s_waitcnt lgkmcnt(6)
    v_mfma_f32_16x16x32_bf16 v[96:99], a[4:7], v[144:147], v[96:99]
    v_mov_b32 v225, s61
    ds_read_b32 v196, v73 offset:0
    s_waitcnt lgkmcnt(6)
    v_mfma_f32_16x16x32_bf16 v[96:99], a[8:11], v[148:151], v[96:99]
    ds_read_b32 v197, v73 offset:1056
    ds_read_b32 v198, v73 offset:2112
    s_waitcnt lgkmcnt(7)
    v_mfma_f32_16x16x32_bf16 v[96:99], a[12:15], v[152:155], v[96:99]
    ds_read_b32 v199, v73 offset:3168
    s_waitcnt vmcnt(7)
    v_lshlrev_b32 v202, 16, v228
    s_waitcnt lgkmcnt(7)
    v_mfma_f32_16x16x32_bf16 v[96:99], a[16:19], v[156:159], v[96:99]
    v_and_b32 v203, 0xffff0000, v228
    s_waitcnt lgkmcnt(6)
    v_mfma_f32_16x16x32_bf16 v[96:99], a[20:23], v[160:163], v[96:99]
    v_lshlrev_b32 v204, 16, v229
    v_and_b32 v205, 0xffff0000, v229
    s_waitcnt lgkmcnt(5)
    v_mfma_f32_16x16x32_bf16 v[96:99], a[24:27], v[164:167], v[96:99]
    v_lshlrev_b32 v206, 16, v230
    v_and_b32 v207, 0xffff0000, v230
    s_waitcnt lgkmcnt(4)
    v_mfma_f32_16x16x32_bf16 v[96:99], a[28:31], v[168:171], v[96:99]
    v_lshlrev_b32 v208, 16, v231
    v_and_b32 v209, 0xffff0000, v231
    v_mfma_f32_16x16x32_bf16 v[100:103], a[64:67], v[108:111], v[100:103]
    v_fma_f32 v210, v202, v48, v49
    v_fma_f32 v211, v203, v48, v49
    v_mfma_f32_16x16x32_bf16 v[104:107], a[96:99], v[108:111], v[104:107]
    v_fma_f32 v212, v204, v48, v49
    v_mfma_f32_16x16x32_bf16 v[100:103], a[68:71], v[112:115], v[100:103]
    v_fma_f32 v213, v205, v48, v49
    v_fma_f32 v214, v206, v50, v51
    v_mfma_f32_16x16x32_bf16 v[104:107], a[100:103], v[112:115], v[104:107]
    v_fma_f32 v215, v207, v50, v51
    v_fma_f32 v216, v208, v50, v51
    v_mfma_f32_16x16x32_bf16 v[100:103], a[72:75], v[116:119], v[100:103]
    v_cvt_pk_bf16_f32 v64, v92, v93
    v_cvt_pk_bf16_f32 v65, v94, v95
    v_fma_f32 v217, v209, v50, v51
    v_fma_f32 v210, v210, s54, v222
    v_mfma_f32_16x16x32_bf16 v[104:107], a[104:107], v[116:119], v[104:107]
    ds_write2_b32 v72, v64, v65 offset0:0 offset1:2
    v_fma_f32 v211, v211, s55, v223
    v_fma_f32 v212, v212, s56, v224
    v_mfma_f32_16x16x32_bf16 v[100:103], a[76:79], v[120:123], v[100:103]
    s_lshl_b32 s4, s96, 7
    s_add_u32 s4, s4, 49152
    v_lshl_add_u32 v28, v2, 2, s4
    v_cvt_pk_bf16_f32 v66, v96, v97
    v_cvt_pk_bf16_f32 v67, v98, v99
    v_fma_f32 v213, v213, s57, v225
    v_mfma_f32_16x16x32_bf16 v[104:107], a[108:111], v[120:123], v[104:107]
    ds_write2_b32 v72, v66, v67 offset0:128 offset1:130
    v_fma_f32 v214, v214, s54, v222
    v_fma_f32 v215, v215, s55, v223
    v_mfma_f32_16x16x32_bf16 v[100:103], a[80:83], v[124:127], v[100:103]
    global_load_dword v8, v28, s[38:39] sc1
    v_add_u32 v72, 4224, v72
    v_fma_f32 v216, v216, s56, v224
    v_fma_f32 v217, v217, s57, v225
    v_mfma_f32_16x16x32_bf16 v[104:107], a[112:115], v[124:127], v[104:107]
    s_waitcnt lgkmcnt(5)
    v_lshlrev_b32 v188, 16, v196
    v_and_b32 v192, 0xffff0000, v196
    v_mfma_f32_16x16x32_bf16 v[100:103], a[84:87], v[128:131], v[100:103]
    global_load_dword v9, v28, s[38:39] offset:64 sc1
    s_waitcnt lgkmcnt(4)
    v_lshlrev_b32 v189, 16, v197
    v_and_b32 v193, 0xffff0000, v197
    v_mfma_f32_16x16x32_bf16 v[104:107], a[116:119], v[128:131], v[104:107]
    s_waitcnt lgkmcnt(3)
    v_lshlrev_b32 v190, 16, v198
    v_mfma_f32_16x16x32_bf16 v[100:103], a[88:91], v[132:135], v[100:103]
    s_add_u32 s4, s4, 7168
    v_lshl_add_u32 v28, v3, 4, s4
    v_and_b32 v194, 0xffff0000, v198
    s_waitcnt lgkmcnt(2)
    v_lshlrev_b32 v191, 16, v199
    v_mfma_f32_16x16x32_bf16 v[104:107], a[120:123], v[132:135], v[104:107]
    v_and_b32 v195, 0xffff0000, v199
    v_and_b32 v218, 0xffff0000, v172
    v_mfma_f32_16x16x32_bf16 v[100:103], a[92:95], v[136:139], v[100:103]
    global_load_dwordx4 v[12:15], v28, s[38:39] sc1
    v_and_b32 v219, 0xffff0000, v173
    v_and_b32 v220, 0xffff0000, v174
    v_mfma_f32_16x16x32_bf16 v[104:107], a[124:127], v[136:139], v[104:107]
    v_and_b32 v221, 0xffff0000, v175
    v_fmac_f32 v188, s44, v218
    v_mfma_f32_16x16x32_bf16 v[100:103], a[32:35], v[140:143], v[100:103]
    global_load_dwordx4 v[16:19], v28, s[38:39] offset:64 sc1
    v_fmac_f32 v189, s45, v219
    v_mfma_f32_16x16x32_bf16 v[104:107], a[64:67], v[140:143], v[104:107]
    v_fmac_f32 v190, s46, v220
    v_fmac_f32 v191, s47, v221
    v_mfma_f32_16x16x32_bf16 v[100:103], a[36:39], v[144:147], v[100:103]
    v_lshlrev_b32 v218, 16, v172
    v_lshlrev_b32 v219, 16, v173
    v_mfma_f32_16x16x32_bf16 v[104:107], a[68:71], v[144:147], v[104:107]
    s_lshl_b32 s4, s97, 7
    s_add_u32 s4, s4, 49152
    v_lshl_add_u32 v28, v2, 2, s4
    v_lshlrev_b32 v220, 16, v174
    v_lshlrev_b32 v221, 16, v175
    v_mfma_f32_16x16x32_bf16 v[100:103], a[40:43], v[148:151], v[100:103]
    v_fmac_f32 v192, s44, v218
    v_fmac_f32 v193, s45, v219
    v_mfma_f32_16x16x32_bf16 v[104:107], a[72:75], v[148:151], v[104:107]
    global_load_dword v10, v28, s[38:39] sc1
    v_fmac_f32 v194, s46, v220
    v_mfma_f32_16x16x32_bf16 v[100:103], a[44:47], v[152:155], v[100:103]
    v_fmac_f32 v195, s47, v221
    v_fma_f32 v202, v210, v188, v202
    v_mfma_f32_16x16x32_bf16 v[104:107], a[76:79], v[152:155], v[104:107]
    global_load_dword v11, v28, s[38:39] offset:64 sc1
    v_fma_f32 v203, v211, v189, v203
    v_fma_f32 v204, v212, v190, v204
    v_mfma_f32_16x16x32_bf16 v[100:103], a[48:51], v[156:159], v[100:103]
    v_fma_f32 v205, v213, v191, v205
    v_fma_f32 v206, v214, v192, v206
    v_mfma_f32_16x16x32_bf16 v[104:107], a[80:83], v[156:159], v[104:107]
    s_add_u32 s4, s4, 7168
    v_lshl_add_u32 v28, v3, 4, s4
    v_fma_f32 v207, v215, v193, v207
    v_fma_f32 v208, v216, v194, v208
    v_mfma_f32_16x16x32_bf16 v[100:103], a[52:55], v[160:163], v[100:103]
    v_fma_f32 v209, v217, v195, v209
    v_mfma_f32_16x16x32_bf16 v[104:107], a[84:87], v[160:163], v[104:107]
    global_load_dwordx4 v[20:23], v28, s[38:39] sc1
    v_cvt_pk_bf16_f32 v228, v202, v203
    v_cvt_pk_bf16_f32 v229, v204, v205
    v_mfma_f32_16x16x32_bf16 v[100:103], a[56:59], v[164:167], v[100:103]
    v_cvt_pk_bf16_f32 v230, v206, v207
    v_cvt_pk_bf16_f32 v231, v208, v209
    v_mfma_f32_16x16x32_bf16 v[104:107], a[88:91], v[164:167], v[104:107]
    global_load_dwordx4 v[24:27], v28, s[38:39] offset:64 sc1
    v_min_u32 v228, -2, v228
    v_min_u32 v229, -2, v229
    v_mfma_f32_16x16x32_bf16 v[100:103], a[60:63], v[168:171], v[100:103]
    v_min_u32 v230, -2, v230
    v_min_u32 v231, -2, v231
    v_mfma_f32_16x16x32_bf16 v[104:107], a[92:95], v[168:171], v[104:107]
    global_store_dwordx4 v75, v[228:231], s[38:39] offset:-4096 sc1
    ds_read_b32 v196, v73 offset:4224
    ds_read_b32 v197, v73 offset:5280
    ds_read_b32 v198, v73 offset:6336
    ds_read_b32 v199, v73 offset:7392
    s_waitcnt vmcnt(15)
    v_lshlrev_b32 v202, 16, v232
    v_and_b32 v203, 0xffff0000, v232
    v_lshlrev_b32 v204, 16, v233
    v_and_b32 v205, 0xffff0000, v233
    v_lshlrev_b32 v206, 16, v234
    v_and_b32 v207, 0xffff0000, v234
    v_lshlrev_b32 v208, 16, v235
    v_and_b32 v209, 0xffff0000, v235
    v_pk_fma_f32 v[210:211], v[32:33], v[202:203], v[32:33] op_sel:[0,0,1] op_sel_hi:[0,1,1]
    v_pk_fma_f32 v[212:213], v[32:33], v[204:205], v[32:33] op_sel:[0,0,1] op_sel_hi:[0,1,1]
    v_pk_fma_f32 v[214:215], v[34:35], v[206:207], v[34:35] op_sel:[0,0,1] op_sel_hi:[0,1,1]
    v_pk_fma_f32 v[216:217], v[34:35], v[208:209], v[34:35] op_sel:[0,0,1] op_sel_hi:[0,1,1]
    v_pk_fma_f32 v[210:211], v[210:211], s[54:55], v[222:223] op_sel:[0,0,0] op_sel_hi:[1,1,1]
    v_pk_fma_f32 v[212:213], v[212:213], s[56:57], v[224:225] op_sel:[0,0,0] op_sel_hi:[1,1,1]
    v_pk_fma_f32 v[214:215], v[214:215], s[54:55], v[222:223] op_sel:[0,0,0] op_sel_hi:[1,1,1]
    v_pk_fma_f32 v[216:217], v[216:217], s[56:57], v[224:225] op_sel:[0,0,0] op_sel_hi:[1,1,1]
    s_waitcnt lgkmcnt(3)
    v_lshlrev_b32 v188, 16, v196
    v_and_b32 v192, 0xffff0000, v196
    s_waitcnt lgkmcnt(2)
    v_lshlrev_b32 v189, 16, v197
    v_and_b32 v193, 0xffff0000, v197
    s_waitcnt lgkmcnt(1)
    v_lshlrev_b32 v190, 16, v198
    v_and_b32 v194, 0xffff0000, v198
    s_waitcnt lgkmcnt(0)
    v_lshlrev_b32 v191, 16, v199
    v_and_b32 v195, 0xffff0000, v199
    v_dot2_f32_bf16 v188, v176, s44, v188
    v_dot2_f32_bf16 v189, v177, s45, v189
    v_dot2_f32_bf16 v190, v178, s46, v190
    v_dot2_f32_bf16 v191, v179, s47, v191
    v_dot2_f32_bf16 v192, v176, s48, v192
    v_dot2_f32_bf16 v193, v177, s49, v193
    v_dot2_f32_bf16 v194, v178, s50, v194
    v_dot2_f32_bf16 v195, v179, s51, v195
    v_pk_fma_f32 v[202:203], v[210:211], v[188:189], v[202:203] op_sel:[0,0,0] op_sel_hi:[1,1,1]
    v_pk_fma_f32 v[204:205], v[212:213], v[190:191], v[204:205] op_sel:[0,0,0] op_sel_hi:[1,1,1]
    v_pk_fma_f32 v[206:207], v[214:215], v[192:193], v[206:207] op_sel:[0,0,0] op_sel_hi:[1,1,1]
    v_pk_fma_f32 v[208:209], v[216:217], v[194:195], v[208:209] op_sel:[0,0,0] op_sel_hi:[1,1,1]
    v_cvt_pk_bf16_f32 v232, v202, v203
    v_cvt_pk_bf16_f32 v233, v204, v205
    v_cvt_pk_bf16_f32 v234, v206, v207
    v_cvt_pk_bf16_f32 v235, v208, v209
    v_min_u32 v232, -2, v232
    v_min_u32 v233, -2, v233
    v_min_u32 v234, -2, v234
    v_min_u32 v235, -2, v235
    global_store_dwordx4 v75, v[232:235], s[38:39] offset:0 sc1
    v_add_u32 v75, 8192, v75
    v_mov_b32 v196, s72
    v_mov_b32 v197, s73
    v_mov_b32 v198, s74
    v_mov_b32 v199, s75
    v_mov_b32 v200, s76
    v_mov_b32 v201, s77
    s_waitcnt vmcnt(13)
    v_mov_b32_dpp v198, v44 wave_shr:1 row_mask:0xf bank_mask:0xf
    v_mov_b32_dpp v199, v45 wave_shr:1 row_mask:0xf bank_mask:0xf
    s_waitcnt vmcnt(12)
    v_mov_b32_dpp v200, v46 wave_shr:1 row_mask:0xf bank_mask:0xf
    v_mov_b32_dpp v201, v47 wave_shr:1 row_mask:0xf bank_mask:0xf
    v_lshlrev_b32 v214, 16, v44
    v_and_b32 v215, 0xffff0000, v44
    v_lshlrev_b32 v216, 16, v45
    v_and_b32 v217, 0xffff0000, v45
    v_lshlrev_b32 v218, 16, v46
    v_and_b32 v219, 0xffff0000, v46
    v_lshlrev_b32 v220, 16, v47
    v_and_b32 v221, 0xffff0000, v47
    v_mov_b32_dpp v196, v200 wave_shr:1 row_mask:0xf bank_mask:0xf
    v_mov_b32_dpp v197, v201 wave_shr:1 row_mask:0xf bank_mask:0xf
    v_lshlrev_b32 v210, 16, v200
    v_and_b32 v211, 0xffff0000, v200
    v_lshlrev_b32 v212, 16, v201
    v_and_b32 v213, 0xffff0000, v201
    v_lshlrev_b32 v206, 16, v198
    v_and_b32 v207, 0xffff0000, v198
    v_lshlrev_b32 v208, 16, v199
    v_and_b32 v209, 0xffff0000, v199
    v_lshlrev_b32 v202, 16, v196
    v_and_b32 v203, 0xffff0000, v196
    v_lshlrev_b32 v204, 16, v197
    v_and_b32 v205, 0xffff0000, v197
    v_pk_mul_f32 v[188:189], v[214:215], s[78:79] op_sel:[0,0] op_sel_hi:[1,1]
    v_pk_mul_f32 v[190:191], v[216:217], s[80:81] op_sel:[0,0] op_sel_hi:[1,1]
    v_pk_mul_f32 v[192:193], v[218:219], s[78:79] op_sel:[0,0] op_sel_hi:[1,1]
    v_pk_mul_f32 v[194:195], v[220:221], s[80:81] op_sel:[0,0] op_sel_hi:[1,1]
    v_pk_fma_f32 v[188:189], v[210:211], s[82:83], v[188:189] op_sel:[0,0,0] op_sel_hi:[1,1,1]
    v_pk_fma_f32 v[190:191], v[212:213], s[84:85], v[190:191] op_sel:[0,0,0] op_sel_hi:[1,1,1]
    v_pk_fma_f32 v[192:193], v[214:215], s[82:83], v[192:193] op_sel:[0,0,0] op_sel_hi:[1,1,1]
    v_pk_fma_f32 v[194:195], v[216:217], s[84:85], v[194:195] op_sel:[0,0,0] op_sel_hi:[1,1,1]
    v_pk_fma_f32 v[188:189], v[206:207], s[86:87], v[188:189] op_sel:[0,0,0] op_sel_hi:[1,1,1]
    v_pk_fma_f32 v[190:191], v[208:209], s[88:89], v[190:191] op_sel:[0,0,0] op_sel_hi:[1,1,1]
    v_pk_fma_f32 v[192:193], v[210:211], s[86:87], v[192:193] op_sel:[0,0,0] op_sel_hi:[1,1,1]
    v_pk_fma_f32 v[194:195], v[212:213], s[88:89], v[194:195] op_sel:[0,0,0] op_sel_hi:[1,1,1]
    v_pk_fma_f32 v[188:189], v[202:203], s[90:91], v[188:189] op_sel:[0,0,0] op_sel_hi:[1,1,1]
    v_pk_fma_f32 v[190:191], v[204:205], s[92:93], v[190:191] op_sel:[0,0,0] op_sel_hi:[1,1,1]
    v_pk_fma_f32 v[192:193], v[206:207], s[90:91], v[192:193] op_sel:[0,0,0] op_sel_hi:[1,1,1]
    v_pk_fma_f32 v[194:195], v[208:209], s[92:93], v[194:195] op_sel:[0,0,0] op_sel_hi:[1,1,1]
    s_waitcnt vmcnt(11)
    v_lshlrev_b32 v202, 16, v60
    v_and_b32 v203, 0xffff0000, v60
    v_lshlrev_b32 v204, 16, v61
    v_and_b32 v205, 0xffff0000, v61
    s_waitcnt vmcnt(10)
    v_lshlrev_b32 v206, 16, v62
    v_and_b32 v207, 0xffff0000, v62
    v_lshlrev_b32 v208, 16, v63
    v_and_b32 v209, 0xffff0000, v63
    v_pk_mul_f32 v[188:189], v[188:189], v[202:203] op_sel:[0,0] op_sel_hi:[1,1]
    v_pk_mul_f32 v[190:191], v[190:191], v[204:205] op_sel:[0,0] op_sel_hi:[1,1]
    v_pk_mul_f32 v[192:193], v[192:193], v[206:207] op_sel:[0,0] op_sel_hi:[1,1]
    v_pk_mul_f32 v[194:195], v[194:195], v[208:209] op_sel:[0,0] op_sel_hi:[1,1]
    v_cvt_pk_bf16_f32 v184, v192, v188
    v_cvt_pk_bf16_f32 v185, v193, v189
    v_cvt_pk_bf16_f32 v186, v194, v190
    v_cvt_pk_bf16_f32 v187, v195, v191
    ds_write_b32 v71, v184 offset:0
    ds_write_b32 v71, v184 offset:4644
    ds_write_b32 v71, v185 offset:9280
    ds_write_b32 v71, v185 offset:13924
    ds_write_b32 v71, v186 offset:18560
    ds_write_b32 v71, v186 offset:23204
    ds_write_b32 v71, v187 offset:27840
    ds_write_b32 v71, v187 offset:32484
    s_waitcnt lgkmcnt(0)
    s_barrier
    ds_read_b128 v[108:111], v70 offset:512
    ds_read_b128 v[112:115], v70 offset:576
    ds_read_b128 v[116:119], v70 offset:640
    ds_read_b128 v[120:123], v70 offset:704
    ds_read_b128 v[124:127], v70 offset:768
    ds_read_b128 v[128:131], v70 offset:832
    ds_read_b128 v[132:135], v70 offset:896
    ds_read_b128 v[136:139], v70 offset:960
    ds_read_b128 v[140:143], v70 offset:0
    ds_read_b128 v[144:147], v70 offset:64
    ds_read_b128 v[148:151], v70 offset:128
    ds_read_b128 v[152:155], v70 offset:192
    ds_read_b128 v[156:159], v70 offset:256
    ds_read_b128 v[160:163], v70 offset:320
    ds_read_b128 v[164:167], v70 offset:384
    ds_read_b128 v[168:171], v70 offset:448
    s_waitcnt vmcnt(8)
    v_max_u32 v28, v8, v9
    s_waitcnt vmcnt(4)
    v_max3_u32 v28, v10, v11, v28
    v_max3_u32 v28, v12, v13, v28
    v_max3_u32 v28, v14, v15, v28
    v_max3_u32 v28, v16, v17, v28
    v_max3_u32 v28, v18, v19, v28
    s_waitcnt vmcnt(3)
    v_max3_u32 v28, v20, v21, v28
    v_max3_u32 v28, v22, v23, v28
    s_waitcnt vmcnt(2)
    v_max3_u32 v28, v24, v25, v28
    v_max3_u32 v28, v26, v27, v28
    v_cmp_eq_u32 vcc, -1, v28
    s_nop 0
    s_cbranch_vccnz Lcu_r
Lcu_ok:
    global_load_dwordx4 a[96:99], v6, s[38:39] offset:-4096 sc1
    ds_read_b32 v196, v73 offset:8448
    ds_read_b32 v197, v73 offset:9504
    ds_read_b32 v198, v73 offset:10560
    ds_read_b32 v199, v73 offset:11616
    v_lshlrev_b32 v202, 16, v236
    v_and_b32 v203, 0xffff0000, v236
    global_load_dwordx4 a[100:103], v7, s[38:39] offset:-4096 sc1
    v_lshlrev_b32 v204, 16, v237
    v_and_b32 v205, 0xffff0000, v237
    v_lshlrev_b32 v206, 16, v238
    v_and_b32 v207, 0xffff0000, v238
    v_lshlrev_b32 v208, 16, v239
    v_and_b32 v209, 0xffff0000, v239
    v_pk_fma_f32 v[210:211], v[76:77], v[202:203], v[76:77] op_sel:[0,0,1] op_sel_hi:[0,1,1]
    global_load_dwordx4 a[104:107], v6, s[38:39] offset:-3072 sc1
    v_pk_fma_f32 v[212:213], v[76:77], v[204:205], v[76:77] op_sel:[0,0,1] op_sel_hi:[0,1,1]
    v_pk_fma_f32 v[214:215], v[78:79], v[206:207], v[78:79] op_sel:[0,0,1] op_sel_hi:[0,1,1]
    v_pk_fma_f32 v[216:217], v[78:79], v[208:209], v[78:79] op_sel:[0,0,1] op_sel_hi:[0,1,1]
    v_pk_fma_f32 v[210:211], v[210:211], s[54:55], v[222:223] op_sel:[0,0,0] op_sel_hi:[1,1,1]
    v_pk_fma_f32 v[212:213], v[212:213], s[56:57], v[224:225] op_sel:[0,0,0] op_sel_hi:[1,1,1]
    v_pk_fma_f32 v[214:215], v[214:215], s[54:55], v[222:223] op_sel:[0,0,0] op_sel_hi:[1,1,1]
    v_pk_fma_f32 v[216:217], v[216:217], s[56:57], v[224:225] op_sel:[0,0,0] op_sel_hi:[1,1,1]
    global_load_dwordx4 a[108:111], v7, s[38:39] offset:-3072 sc1
    s_waitcnt lgkmcnt(3)
    v_lshlrev_b32 v188, 16, v196
    v_and_b32 v192, 0xffff0000, v196
    s_waitcnt lgkmcnt(2)
    v_lshlrev_b32 v189, 16, v197
    v_and_b32 v193, 0xffff0000, v197
    s_waitcnt lgkmcnt(1)
    v_lshlrev_b32 v190, 16, v198
    v_and_b32 v194, 0xffff0000, v198
    s_waitcnt lgkmcnt(0)
    v_lshlrev_b32 v191, 16, v199
    global_load_dwordx4 a[112:115], v6, s[38:39] offset:-2048 sc1
    v_and_b32 v195, 0xffff0000, v199
    v_dot2_f32_bf16 v188, v180, s44, v188
    v_dot2_f32_bf16 v189, v181, s45, v189
    v_dot2_f32_bf16 v190, v182, s46, v190
    v_dot2_f32_bf16 v191, v183, s47, v191
    v_dot2_f32_bf16 v192, v180, s48, v192
    v_dot2_f32_bf16 v193, v181, s49, v193
    global_load_dwordx4 a[116:119], v7, s[38:39] offset:-2048 sc1
    v_dot2_f32_bf16 v194, v182, s50, v194
    v_dot2_f32_bf16 v195, v183, s51, v195
    v_pk_fma_f32 v[202:203], v[210:211], v[188:189], v[202:203] op_sel:[0,0,0] op_sel_hi:[1,1,1]
    v_pk_fma_f32 v[204:205], v[212:213], v[190:191], v[204:205] op_sel:[0,0,0] op_sel_hi:[1,1,1]
    v_pk_fma_f32 v[206:207], v[214:215], v[192:193], v[206:207] op_sel:[0,0,0] op_sel_hi:[1,1,1]
    v_pk_fma_f32 v[208:209], v[216:217], v[194:195], v[208:209] op_sel:[0,0,0] op_sel_hi:[1,1,1]
    v_cvt_pk_bf16_f32 v236, v202, v203
    global_load_dwordx4 a[120:123], v6, s[38:39] offset:-1024 sc1
    v_cvt_pk_bf16_f32 v237, v204, v205
    v_cvt_pk_bf16_f32 v238, v206, v207
    v_cvt_pk_bf16_f32 v239, v208, v209
    v_min_u32 v236, -2, v236
    v_min_u32 v237, -2, v237
    v_min_u32 v238, -2, v238
    global_load_dwordx4 a[124:127], v7, s[38:39] offset:-1024 sc1
    v_min_u32 v239, -2, v239
    global_store_dwordx4 v75, v[236:239], s[38:39] offset:-4096 sc1
    v_mfma_f32_16x16x32_bf16 v[100:103], a[0:3], v[108:111], v[100:103]
    v_mfma_f32_16x16x32_bf16 v[104:107], a[32:35], v[108:111], v[104:107]
    v_mfma_f32_16x16x32_bf16 v[100:103], a[4:7], v[112:115], v[100:103]
    v_mfma_f32_16x16x32_bf16 v[104:107], a[36:39], v[112:115], v[104:107]
    v_mfma_f32_16x16x32_bf16 v[100:103], a[8:11], v[116:119], v[100:103]
    global_load_dwordx4 a[128:131], v6, s[38:39] offset:0 sc1
    v_mfma_f32_16x16x32_bf16 v[104:107], a[40:43], v[116:119], v[104:107]
    v_mfma_f32_16x16x32_bf16 v[100:103], a[12:15], v[120:123], v[100:103]
    v_mfma_f32_16x16x32_bf16 v[104:107], a[44:47], v[120:123], v[104:107]
    v_mfma_f32_16x16x32_bf16 v[100:103], a[16:19], v[124:127], v[100:103]
    v_mfma_f32_16x16x32_bf16 v[104:107], a[48:51], v[124:127], v[104:107]
    v_mfma_f32_16x16x32_bf16 v[100:103], a[20:23], v[128:131], v[100:103]
    v_mfma_f32_16x16x32_bf16 v[104:107], a[52:55], v[128:131], v[104:107]
    global_load_dwordx4 a[132:135], v7, s[38:39] offset:0 sc1
    v_mfma_f32_16x16x32_bf16 v[100:103], a[24:27], v[132:135], v[100:103]
    v_mfma_f32_16x16x32_bf16 v[104:107], a[56:59], v[132:135], v[104:107]
    v_mfma_f32_16x16x32_bf16 v[100:103], a[28:31], v[136:139], v[100:103]
    v_mfma_f32_16x16x32_bf16 v[104:107], a[60:63], v[136:139], v[104:107]
    v_mfma_f32_16x16x32_bf16 v[104:107], a[0:3], v[140:143], v[104:107]
    v_mfma_f32_16x16x32_bf16 v[104:107], a[4:7], v[144:147], v[104:107]
    v_mfma_f32_16x16x32_bf16 v[104:107], a[8:11], v[148:151], v[104:107]
    global_load_dwordx4 a[136:139], v6, s[38:39] offset:1024 sc1
    v_mfma_f32_16x16x32_bf16 v[104:107], a[12:15], v[152:155], v[104:107]
    v_mfma_f32_16x16x32_bf16 v[104:107], a[16:19], v[156:159], v[104:107]
    v_mfma_f32_16x16x32_bf16 v[104:107], a[20:23], v[160:163], v[104:107]
    v_mfma_f32_16x16x32_bf16 v[104:107], a[24:27], v[164:167], v[104:107]
    v_mfma_f32_16x16x32_bf16 v[104:107], a[28:31], v[168:171], v[104:107]
    v_cvt_pk_bf16_f32 v64, v100, v101
    v_cvt_pk_bf16_f32 v65, v102, v103
    global_load_dwordx4 a[140:143], v7, s[38:39] offset:1024 sc1
    ds_write2_b32 v72, v64, v65 offset0:0 offset1:2
    s_nop 3
    v_cvt_pk_bf16_f32 v66, v104, v105
    v_cvt_pk_bf16_f32 v67, v106, v107
    ds_write2_b32 v72, v66, v67 offset0:128 offset1:130
    s_waitcnt lgkmcnt(0)
    s_barrier
    ds_read_b32 v196, v73 offset:12672
    global_load_dwordx4 a[144:147], v6, s[38:39] offset:2048 sc1
    ds_read_b32 v197, v73 offset:13728
    ds_read_b32 v198, v73 offset:14784
    ds_read_b32 v199, v73 offset:15840
    v_lshlrev_b32 v202, 16, v240
    v_and_b32 v203, 0xffff0000, v240
    v_lshlrev_b32 v204, 16, v241
    global_load_dwordx4 a[148:151], v7, s[38:39] offset:2048 sc1
    v_and_b32 v205, 0xffff0000, v241
    v_lshlrev_b32 v206, 16, v242
    v_and_b32 v207, 0xffff0000, v242
    v_lshlrev_b32 v208, 16, v243
    v_and_b32 v209, 0xffff0000, v243
    v_pk_fma_f32 v[210:211], v[80:81], v[202:203], v[80:81] op_sel:[0,0,1] op_sel_hi:[0,1,1]
    v_pk_fma_f32 v[212:213], v[80:81], v[204:205], v[80:81] op_sel:[0,0,1] op_sel_hi:[0,1,1]
    global_load_dwordx4 a[152:155], v6, s[38:39] offset:3072 sc1
    v_pk_fma_f32 v[214:215], v[82:83], v[206:207], v[82:83] op_sel:[0,0,1] op_sel_hi:[0,1,1]
    v_pk_fma_f32 v[216:217], v[82:83], v[208:209], v[82:83] op_sel:[0,0,1] op_sel_hi:[0,1,1]
    v_pk_fma_f32 v[210:211], v[210:211], s[54:55], v[222:223] op_sel:[0,0,0] op_sel_hi:[1,1,1]
    v_pk_fma_f32 v[212:213], v[212:213], s[56:57], v[224:225] op_sel:[0,0,0] op_sel_hi:[1,1,1]
    v_pk_fma_f32 v[214:215], v[214:215], s[54:55], v[222:223] op_sel:[0,0,0] op_sel_hi:[1,1,1]
    v_pk_fma_f32 v[216:217], v[216:217], s[56:57], v[224:225] op_sel:[0,0,0] op_sel_hi:[1,1,1]
    s_waitcnt lgkmcnt(3)
    v_lshlrev_b32 v188, 16, v196
    global_load_dwordx4 a[156:159], v7, s[38:39] offset:3072 sc1
    v_and_b32 v192, 0xffff0000, v196
    s_waitcnt lgkmcnt(2)
    v_lshlrev_b32 v189, 16, v197
    v_and_b32 v193, 0xffff0000, v197
    s_waitcnt lgkmcnt(1)
    v_lshlrev_b32 v190, 16, v198
    v_and_b32 v194, 0xffff0000, v198
    s_waitcnt lgkmcnt(0)
    v_lshlrev_b32 v191, 16, v199
    v_and_b32 v195, 0xffff0000, v199
    v_add_u32 v6, 8192, v6
    v_dot2_f32_bf16 v188, v184, s44, v188
    v_dot2_f32_bf16 v189, v185, s45, v189
    v_dot2_f32_bf16 v190, v186, s46, v190
    v_dot2_f32_bf16 v191, v187, s47, v191
    v_dot2_f32_bf16 v192, v184, s48, v192
    v_dot2_f32_bf16 v193, v185, s49, v193
    v_dot2_f32_bf16 v194, v186, s50, v194
    v_add_u32 v7, 8192, v7
    v_dot2_f32_bf16 v195, v187, s51, v195
    v_pk_fma_f32 v[202:203], v[210:211], v[188:189], v[202:203] op_sel:[0,0,0] op_sel_hi:[1,1,1]
    v_pk_fma_f32 v[204:205], v[212:213], v[190:191], v[204:205] op_sel:[0,0,0] op_sel_hi:[1,1,1]
    v_pk_fma_f32 v[206:207], v[214:215], v[192:193], v[206:207] op_sel:[0,0,0] op_sel_hi:[1,1,1]
    v_pk_fma_f32 v[208:209], v[216:217], v[194:195], v[208:209] op_sel:[0,0,0] op_sel_hi:[1,1,1]
    v_cvt_pk_bf16_f32 v240, v202, v203
    v_cvt_pk_bf16_f32 v241, v204, v205
    v_cvt_pk_bf16_f32 v242, v206, v207
    v_cvt_pk_bf16_f32 v243, v208, v209
    v_min_u32 v240, -2, v240
    v_min_u32 v241, -2, v241
    v_min_u32 v242, -2, v242
    v_min_u32 v243, -2, v243
    global_store_dwordx4 v75, v[240:243], s[38:39] offset:0 sc1
Ljoin:
    global_load_dwordx4 a[160:163], v6, s[38:39] offset:-4096 sc1
    s_mul_i32 s4, s43, 43
    s_lshr_b32 s4, s4, 7
    s_mul_i32 s4, s4, 3
    s_sub_u32 s4, s43, s4
    s_lshl_b32 s5, s3, 1
    s_add_u32 s6, s5, 0
    s_and_b32 s6, s6, 7
    global_load_dwordx4 a[164:167], v7, s[38:39] offset:-4096 sc1
    s_lshl_b32 s7, s4, 3
    s_add_u32 s44, s6, s7
    s_add_u32 s6, s5, 1
    s_and_b32 s6, s6, 7
    s_lshl_b32 s7, s4, 3
    s_add_u32 s45, s6, s7
    s_add_u32 s4, s4, 1
    s_cmp_eq_u32 s4, 3
    global_load_dwordx4 a[168:171], v6, s[38:39] offset:-3072 sc1
    s_cselect_b32 s4, 0, s4
    s_add_u32 s6, s5, 0
    s_and_b32 s6, s6, 7
    s_lshl_b32 s7, s4, 3
    s_add_u32 s46, s6, s7
    s_add_u32 s6, s5, 1
    s_and_b32 s6, s6, 7
    s_lshl_b32 s7, s4, 3
    global_load_dwordx4 a[172:175], v7, s[38:39] offset:-3072 sc1
    s_add_u32 s47, s6, s7
    s_add_u32 s4, s4, 1
    s_cmp_eq_u32 s4, 3
    s_cselect_b32 s4, 0, s4
    s_add_u32 s6, s5, 0
    s_and_b32 s6, s6, 7
    s_lshl_b32 s7, s4, 3
    s_add_u32 s48, s6, s7
    global_load_dwordx4 a[176:179], v6, s[38:39] offset:-2048 sc1
    s_add_u32 s6, s5, 1
    s_and_b32 s6, s6, 7
    s_lshl_b32 s7, s4, 3
    s_add_u32 s49, s6, s7
    s_mov_b32 s4, 3
    s_add_u32 s6, s5, 0
    s_and_b32 s6, s6, 7
    s_lshl_b32 s7, s4, 3
    global_load_dwordx4 a[180:183], v7, s[38:39] offset:-2048 sc1
    s_add_u32 s50, s6, s7
    s_add_u32 s6, s5, 1
    s_and_b32 s6, s6, 7
    s_lshl_b32 s7, s4, 3
    s_add_u32 s51, s6, s7
    s_mul_i32 s4, s41, 458752
    s_add_u32 s4, s4, 12582912
    s_lshl_b32 s5, s40, 18
    global_load_dwordx4 a[184:187], v6, s[38:39] offset:-1024 sc1
    s_mul_i32 s6, s44, 14336
    s_add_u32 s6, s6, s4
    s_add_u32 s52, s38, s6
    s_addc_u32 s53, s39, 0
    s_lshl_b32 s6, s44, 7
    s_add_u32 s6, s6, s5
    s_add_u32 s68, s24, s6
    s_addc_u32 s69, s25, 0
    global_load_dwordx4 a[188:191], v7, s[38:39] offset:-1024 sc1
    s_mul_i32 s6, s45, 14336
    s_add_u32 s6, s6, s4
    s_add_u32 s54, s38, s6
    s_addc_u32 s55, s39, 0
    s_lshl_b32 s6, s45, 7
    s_add_u32 s6, s6, s5
    s_add_u32 s70, s24, s6
    global_load_dwordx4 a[192:195], v6, s[38:39] offset:0 sc1
    s_addc_u32 s71, s25, 0
    s_mul_i32 s6, s46, 14336
    s_add_u32 s6, s6, s4
    s_add_u32 s56, s38, s6
    s_addc_u32 s57, s39, 0
    s_lshl_b32 s6, s46, 7
    s_add_u32 s6, s6, s5
    s_add_u32 s72, s24, s6
    global_load_dwordx4 a[196:199], v7, s[38:39] offset:0 sc1
    s_addc_u32 s73, s25, 0
    s_mul_i32 s6, s47, 14336
    s_add_u32 s6, s6, s4
    s_add_u32 s58, s38, s6
    s_addc_u32 s59, s39, 0
    s_lshl_b32 s6, s47, 7
    s_add_u32 s6, s6, s5
    s_add_u32 s74, s24, s6
    global_load_dwordx4 a[200:203], v6, s[38:39] offset:1024 sc1
    s_addc_u32 s75, s25, 0
    s_mul_i32 s6, s48, 14336
    s_add_u32 s6, s6, s4
    s_add_u32 s60, s38, s6
    s_addc_u32 s61, s39, 0
    s_lshl_b32 s6, s48, 7
    s_add_u32 s6, s6, s5
    s_add_u32 s76, s24, s6
    global_load_dwordx4 a[204:207], v7, s[38:39] offset:1024 sc1
    s_addc_u32 s77, s25, 0
    s_mul_i32 s6, s49, 14336
    s_add_u32 s6, s6, s4
    s_add_u32 s62, s38, s6
    s_addc_u32 s63, s39, 0
    s_lshl_b32 s6, s49, 7
    s_add_u32 s6, s6, s5
    s_add_u32 s78, s24, s6
    global_load_dwordx4 a[208:211], v6, s[38:39] offset:2048 sc1
    s_addc_u32 s79, s25, 0
    s_mul_i32 s6, s50, 14336
    s_add_u32 s6, s6, s4
    s_add_u32 s64, s38, s6
    s_addc_u32 s65, s39, 0
    s_lshl_b32 s6, s50, 7
    s_add_u32 s6, s6, s5
    s_add_u32 s80, s24, s6
    global_load_dwordx4 a[212:215], v7, s[38:39] offset:2048 sc1
    s_addc_u32 s81, s25, 0
    s_mul_i32 s6, s51, 14336
    s_add_u32 s6, s6, s4
    s_add_u32 s66, s38, s6
    s_addc_u32 s67, s39, 0
    s_lshl_b32 s6, s51, 7
    s_add_u32 s6, s6, s5
    s_add_u32 s82, s24, s6
    global_load_dwordx4 a[216:219], v6, s[38:39] offset:3072 sc1
    s_addc_u32 s83, s25, 0
    s_mov_b32 s84, 0xc0135761
    s_mov_b32 s85, 0xbdd2d3e8
    s_cmp_eq_u32 s3, 3
    s_cselect_b64 s[86:87], 0, -1
    s_lshl_b32 s88, s3, 9
    s_lshl_b32 s89, s3, 14
    global_load_dwordx4 a[220:223], v7, s[38:39] offset:3072 sc1
    s_add_u32 s89, s89, 83200
    v_lshlrev_b32 v30, 3, v1
    v_and_b32 v28, 7, v1
    v_lshl_add_u32 v28, v3, 3, v28
    v_bfe_u32 v29, v1, 3, 1
    v_lshlrev_b32 v66, 14, v29
    v_lshl_add_u32 v66, v28, 4, v66
    s_lshl_b32 s4, s3, 15
    v_add_u32 v6, 8192, v6
    s_lshl_b32 s5, s40, 9
    s_add_u32 s4, s4, s5
    s_add_u32 s4, s4, 4194304
    v_add_u32 v66, s4, v66
    v_lshl_add_u32 v70, v28, 1, v29
    v_lshrrev_b32 v28, 5, v1
    v_bfe_u32 v68, v1, 1, 1
    v_lshl_add_u32 v28, v28, 1, v68
    v_add_u32 v7, 8192, v7
    v_mul_u32_u24 v68, 1040, v28
    v_lshl_add_u32 v68, v29, 3, v68
    v_bfe_u32 v28, v1, 2, 1
    v_lshl_add_u32 v68, v28, 6, v68
    v_bfe_u32 v28, v1, 4, 1
    v_lshl_add_u32 v68, v28, 7, v68
    v_bfe_u32 v28, v1, 0, 1
    v_lshl_add_u32 v68, v28, 5, v68
    global_load_dwordx4 a[224:227], v6, s[38:39] offset:-4096 sc1
    s_lshl_b32 s5, s3, 8
    v_add_u32 v68, s5, v68
    v_min_u32 v28, 39, v1
    v_lshrrev_b32 v72, 1, v28
    v_lshlrev_b32 v72, 17, v72
    v_and_b32 v28, 1, v28
    v_lshl_add_u32 v72, v28, 14, v72
    v_add_u32 v72, s4, v72
    global_load_dwordx4 a[228:231], v7, s[38:39] offset:-4096 sc1
    v_lshrrev_b32 v28, 3, v1
    v_lshlrev_b32 v28, 12, v28
    v_bfe_u32 v29, v1, 4, 1
    v_xor_b32 v29, v29, v1
    v_and_b32 v29, 7, v29
    v_xor_b32 v76, 0, v29
    v_lshl_add_u32 v76, v76, 4, v28
    v_add_u32 v80, 131072, v76
    global_load_dwordx4 a[232:235], v6, s[38:39] offset:-3072 sc1
    v_xor_b32 v77, 2, v29
    v_lshl_add_u32 v77, v77, 4, v28
    v_add_u32 v77, 32768, v77
    v_add_u32 v81, 131072, v77
    v_xor_b32 v78, 4, v29
    v_lshl_add_u32 v78, v78, 4, v28
    v_add_u32 v78, 65536, v78
    v_add_u32 v82, 131072, v78
    global_load_dwordx4 a[236:239], v7, s[38:39] offset:-3072 sc1
    v_xor_b32 v79, 6, v29
    v_lshl_add_u32 v79, v79, 4, v28
    v_add_u32 v79, 98304, v79
    v_add_u32 v83, 131072, v79
    v_lshrrev_b32 v29, 1, v2
    v_xor_b32 v29, v29, v3
    v_lshlrev_b32 v29, 4, v29
    global_load_dwordx4 a[240:243], v6, s[38:39] offset:-2048 sc1
    v_lshl_add_u32 v29, v5, 7, v29
    s_xor_b32 s4, s3, 0
    s_lshr_b32 s5, s4, 1
    s_lshl_b32 s5, s5, 12
    s_and_b32 s4, s4, 1
    s_lshl_b32 s4, s4, 9
    s_add_u32 s4, s4, s5
    s_add_u32 s4, s4, s89
    global_load_dwordx4 a[244:247], v7, s[38:39] offset:-2048 sc1
    v_add_u32 v84, s4, v29
    v_xor_b32 v85, 64, v84
    s_xor_b32 s4, s3, 1
    s_lshr_b32 s5, s4, 1
    s_lshl_b32 s5, s5, 12
    s_and_b32 s4, s4, 1
    s_lshl_b32 s4, s4, 9
    s_add_u32 s4, s4, s5
    global_load_dwordx4 a[248:251], v6, s[38:39] offset:-1024 sc1
    s_add_u32 s4, s4, s89
    v_add_u32 v86, s4, v29
    v_xor_b32 v87, 64, v86
    s_xor_b32 s4, s3, 2
    s_lshr_b32 s5, s4, 1
    s_lshl_b32 s5, s5, 12
    s_and_b32 s4, s4, 1
    s_lshl_b32 s4, s4, 9
    global_load_dwordx4 a[252:255], v7, s[38:39] offset:-1024 sc1
    s_add_u32 s4, s4, s5
    s_add_u32 s4, s4, s89
    v_add_u32 v88, s4, v29
    v_xor_b32 v89, 64, v88
    s_xor_b32 s4, s3, 3
    s_lshr_b32 s5, s4, 1
    s_lshl_b32 s5, s5, 12
    s_and_b32 s4, s4, 1
    v_add_u32 v6, 1130496, v6
    s_lshl_b32 s4, s4, 9
    s_add_u32 s4, s4, s5
    s_add_u32 s4, s4, s89
    v_add_u32 v90, s4, v29
    v_xor_b32 v91, 64, v90
    s_lshr_b32 s5, s3, 1
    s_lshl_b32 s5, s5, 5
    s_and_b32 s4, s3, 1
    v_add_u32 v7, 1130496, v7
    s_lshl_b32 s4, s4, 2
    s_add_u32 s4, s4, s5
    s_lshl_b32 s5, s40, 6
    s_add_u32 s90, s4, s5
    v_add_lshl_u32 v28, v5, s90, 1
    global_load_ushort v32, v28, s[26:27]
    s_and_b32 s94, s41, 3
    s_mul_i32 s94, s94, 5
Lx_redo:
Lxp:
    global_load_dword v71, v72, s[38:39] offset:508 sc1
    s_waitcnt vmcnt(0)
    v_mov_b32 v28, v71
    v_cmp_eq_u32 vcc, -1, v28
    s_add_u32 s100, s100, 1
    s_cmp_ge_u32 s100, 262144
    s_cbranch_scc1 Lxp_x
    s_cbranch_vccnz Lxp
Lxp_x:
    s_mov_b32 s7, 0x3f803f80
    s_mov_b32 s5, s94
    s_mov_b32 s6, s94
    v_mov_b32 v62, 0
    v_mov_b32 v63, 0
    v_mov_b32 v64, 0
    v_mov_b32 v65, 0
    v_mov_b32 v71, 0
    s_lshl_b32 s4, s5, 17
    v_add_u32 v67, s4, v66
    global_load_dwordx4 v[92:95], v67, s[38:39] sc1
    s_add_u32 s5, s5, 1
    s_lshl_b32 s4, s5, 17
    v_add_u32 v67, s4, v66
    global_load_dwordx4 v[96:99], v67, s[38:39] sc1
    s_add_u32 s5, s5, 1
    s_lshl_b32 s4, s5, 17
    v_add_u32 v67, s4, v66
    global_load_dwordx4 v[100:103], v67, s[38:39] sc1
    s_add_u32 s5, s5, 1
    s_lshl_b32 s4, s5, 17
    v_add_u32 v67, s4, v66
    global_load_dwordx4 v[104:107], v67, s[38:39] sc1
    s_add_u32 s5, s5, 1
    s_lshl_b32 s4, s5, 17
    v_add_u32 v67, s4, v66
    global_load_dwordx4 v[108:111], v67, s[38:39] sc1
    s_add_u32 s5, s5, 1
    s_cmp_eq_u32 s5, 20
    s_cselect_b32 s5, 0, s5
    s_lshl_b32 s4, s5, 17
    v_add_u32 v67, s4, v66
    global_load_dwordx4 v[112:115], v67, s[38:39] sc1
    s_add_u32 s5, s5, 1
    s_lshl_b32 s4, s5, 17
    v_add_u32 v67, s4, v66
    global_load_dwordx4 v[116:119], v67, s[38:39] sc1
    s_add_u32 s5, s5, 1
    s_lshl_b32 s4, s5, 17
    v_add_u32 v67, s4, v66
    global_load_dwordx4 v[120:123], v67, s[38:39] sc1
    s_add_u32 s5, s5, 1
    s_lshl_b32 s4, s5, 17
    v_add_u32 v67, s4, v66
    global_load_dwordx4 v[124:127], v67, s[38:39] sc1
    s_add_u32 s5, s5, 1
    s_mul_i32 s4, s6, 4160
    v_add_u32 v69, s4, v68
    s_waitcnt vmcnt(8)
    ds_write2_b64 v69, v[92:93], v[94:95] offset0:0 offset1:2
    s_add_u32 s6, s6, 1
    v_max3_u32 v71, v92, v93, v71
    v_max3_u32 v71, v94, v95, v71
    v_dot2_f32_bf16 v62, v92, s7, v62
    v_dot2_f32_bf16 v63, v92, v92, v63
    v_dot2_f32_bf16 v64, v94, s7, v64
    v_dot2_f32_bf16 v65, v94, v94, v65
    v_dot2_f32_bf16 v62, v93, s7, v62
    v_dot2_f32_bf16 v63, v93, v93, v63
    v_dot2_f32_bf16 v64, v95, s7, v64
    v_dot2_f32_bf16 v65, v95, v95, v65
    s_lshl_b32 s4, s5, 17
    v_add_u32 v67, s4, v66
    global_load_dwordx4 v[128:131], v67, s[38:39] sc1
    s_add_u32 s5, s5, 1
    s_cmp_eq_u32 s5, 20
    s_cselect_b32 s5, 0, s5
    s_mul_i32 s4, s6, 4160
    v_add_u32 v69, s4, v68
    s_waitcnt vmcnt(8)
    ds_write2_b64 v69, v[96:97], v[98:99] offset0:0 offset1:2
    s_add_u32 s6, s6, 1
    v_max3_u32 v71, v96, v97, v71
    v_max3_u32 v71, v98, v99, v71
    v_dot2_f32_bf16 v62, v96, s7, v62
    v_dot2_f32_bf16 v63, v96, v96, v63
    v_dot2_f32_bf16 v64, v98, s7, v64
    v_dot2_f32_bf16 v65, v98, v98, v65
    v_dot2_f32_bf16 v62, v97, s7, v62
    v_dot2_f32_bf16 v63, v97, v97, v63
    v_dot2_f32_bf16 v64, v99, s7, v64
    v_dot2_f32_bf16 v65, v99, v99, v65
    s_lshl_b32 s4, s5, 17
    v_add_u32 v67, s4, v66
    global_load_dwordx4 v[132:135], v67, s[38:39] sc1
    s_add_u32 s5, s5, 1
    s_mul_i32 s4, s6, 4160
    v_add_u32 v69, s4, v68
    s_waitcnt vmcnt(8)
    ds_write2_b64 v69, v[100:101], v[102:103] offset0:0 offset1:2
    s_add_u32 s6, s6, 1
    v_max3_u32 v71, v100, v101, v71
    v_max3_u32 v71, v102, v103, v71
    v_dot2_f32_bf16 v62, v100, s7, v62
    v_dot2_f32_bf16 v63, v100, v100, v63
    v_dot2_f32_bf16 v64, v102, s7, v64
    v_dot2_f32_bf16 v65, v102, v102, v65
    v_dot2_f32_bf16 v62, v101, s7, v62
    v_dot2_f32_bf16 v63, v101, v101, v63
    v_dot2_f32_bf16 v64, v103, s7, v64
    v_dot2_f32_bf16 v65, v103, v103, v65
    s_lshl_b32 s4, s5, 17
    v_add_u32 v67, s4, v66
    global_load_dwordx4 v[136:139], v67, s[38:39] sc1
    s_add_u32 s5, s5, 1
    s_mul_i32 s4, s6, 4160
    v_add_u32 v69, s4, v68
    s_waitcnt vmcnt(8)
    ds_write2_b64 v69, v[104:105], v[106:107] offset0:0 offset1:2
    s_add_u32 s6, s6, 1
    v_max3_u32 v71, v104, v105, v71
    v_max3_u32 v71, v106, v107, v71
    v_dot2_f32_bf16 v62, v104, s7, v62
    v_dot2_f32_bf16 v63, v104, v104, v63
    v_dot2_f32_bf16 v64, v106, s7, v64
    v_dot2_f32_bf16 v65, v106, v106, v65
    v_dot2_f32_bf16 v62, v105, s7, v62
    v_dot2_f32_bf16 v63, v105, v105, v63
    v_dot2_f32_bf16 v64, v107, s7, v64
    v_dot2_f32_bf16 v65, v107, v107, v65
    s_lshl_b32 s4, s5, 17
    v_add_u32 v67, s4, v66
    global_load_dwordx4 v[140:143], v67, s[38:39] sc1
    s_add_u32 s5, s5, 1
    s_mul_i32 s4, s6, 4160
    v_add_u32 v69, s4, v68
    s_waitcnt vmcnt(8)
    ds_write2_b64 v69, v[108:109], v[110:111] offset0:0 offset1:2
    s_add_u32 s6, s6, 1
    s_cmp_eq_u32 s6, 20
    s_cselect_b32 s6, 0, s6
    v_max3_u32 v71, v108, v109, v71
    v_max3_u32 v71, v110, v111, v71
    v_dot2_f32_bf16 v62, v108, s7, v62
    v_dot2_f32_bf16 v63, v108, v108, v63
    v_dot2_f32_bf16 v64, v110, s7, v64
    v_dot2_f32_bf16 v65, v110, v110, v65
    v_dot2_f32_bf16 v62, v109, s7, v62
    v_dot2_f32_bf16 v63, v109, v109, v63
    v_dot2_f32_bf16 v64, v111, s7, v64
    v_dot2_f32_bf16 v65, v111, v111, v65
    s_lshl_b32 s4, s5, 17
    v_add_u32 v67, s4, v66
    global_load_dwordx4 v[144:147], v67, s[38:39] sc1
    s_add_u32 s5, s5, 1
    s_mul_i32 s4, s6, 4160
    v_add_u32 v69, s4, v68
    s_waitcnt vmcnt(8)
    ds_write2_b64 v69, v[112:113], v[114:115] offset0:0 offset1:2
    s_add_u32 s6, s6, 1
    v_max3_u32 v71, v112, v113, v71
    v_max3_u32 v71, v114, v115, v71
    v_dot2_f32_bf16 v62, v112, s7, v62
    v_dot2_f32_bf16 v63, v112, v112, v63
    v_dot2_f32_bf16 v64, v114, s7, v64
    v_dot2_f32_bf16 v65, v114, v114, v65
    v_dot2_f32_bf16 v62, v113, s7, v62
    v_dot2_f32_bf16 v63, v113, v113, v63
    v_dot2_f32_bf16 v64, v115, s7, v64
    v_dot2_f32_bf16 v65, v115, v115, v65
    s_lshl_b32 s4, s5, 17
    v_add_u32 v67, s4, v66
    global_load_dwordx4 v[148:151], v67, s[38:39] sc1
    s_add_u32 s5, s5, 1
    s_cmp_eq_u32 s5, 20
    s_cselect_b32 s5, 0, s5
    s_mul_i32 s4, s6, 4160
    v_add_u32 v69, s4, v68
    s_waitcnt vmcnt(8)
    ds_write2_b64 v69, v[116:117], v[118:119] offset0:0 offset1:2
    s_add_u32 s6, s6, 1
    v_max3_u32 v71, v116, v117, v71
    v_max3_u32 v71, v118, v119, v71
    v_dot2_f32_bf16 v62, v116, s7, v62
    v_dot2_f32_bf16 v63, v116, v116, v63
    v_dot2_f32_bf16 v64, v118, s7, v64
    v_dot2_f32_bf16 v65, v118, v118, v65
    v_dot2_f32_bf16 v62, v117, s7, v62
    v_dot2_f32_bf16 v63, v117, v117, v63
    v_dot2_f32_bf16 v64, v119, s7, v64
    v_dot2_f32_bf16 v65, v119, v119, v65
    s_lshl_b32 s4, s5, 17
    v_add_u32 v67, s4, v66
    global_load_dwordx4 v[152:155], v67, s[38:39] sc1
    s_add_u32 s5, s5, 1
    s_mul_i32 s4, s6, 4160
    v_add_u32 v69, s4, v68
    s_waitcnt vmcnt(8)
    ds_write2_b64 v69, v[120:121], v[122:123] offset0:0 offset1:2
    s_add_u32 s6, s6, 1
    v_max3_u32 v71, v120, v121, v71
    v_max3_u32 v71, v122, v123, v71
    v_dot2_f32_bf16 v62, v120, s7, v62
    v_dot2_f32_bf16 v63, v120, v120, v63
    v_dot2_f32_bf16 v64, v122, s7, v64
    v_dot2_f32_bf16 v65, v122, v122, v65
    v_dot2_f32_bf16 v62, v121, s7, v62
    v_dot2_f32_bf16 v63, v121, v121, v63
    v_dot2_f32_bf16 v64, v123, s7, v64
    v_dot2_f32_bf16 v65, v123, v123, v65
    s_lshl_b32 s4, s5, 17
    v_add_u32 v67, s4, v66
    global_load_dwordx4 v[156:159], v67, s[38:39] sc1
    s_add_u32 s5, s5, 1
    s_mul_i32 s4, s6, 4160
    v_add_u32 v69, s4, v68
    s_waitcnt vmcnt(8)
    ds_write2_b64 v69, v[124:125], v[126:127] offset0:0 offset1:2
    s_add_u32 s6, s6, 1
    v_max3_u32 v71, v124, v125, v71
    v_max3_u32 v71, v126, v127, v71
    v_dot2_f32_bf16 v62, v124, s7, v62
    v_dot2_f32_bf16 v63, v124, v124, v63
    v_dot2_f32_bf16 v64, v126, s7, v64
    v_dot2_f32_bf16 v65, v126, v126, v65
    v_dot2_f32_bf16 v62, v125, s7, v62
    v_dot2_f32_bf16 v63, v125, v125, v63
    v_dot2_f32_bf16 v64, v127, s7, v64
    v_dot2_f32_bf16 v65, v127, v127, v65
    s_lshl_b32 s4, s5, 17
    v_add_u32 v67, s4, v66
    global_load_dwordx4 v[160:163], v67, s[38:39] sc1
    s_add_u32 s5, s5, 1
    s_mul_i32 s4, s6, 4160
    v_add_u32 v69, s4, v68
    s_waitcnt vmcnt(8)
    ds_write2_b64 v69, v[128:129], v[130:131] offset0:0 offset1:2
    s_add_u32 s6, s6, 1
    s_cmp_eq_u32 s6, 20
    s_cselect_b32 s6, 0, s6
    v_max3_u32 v71, v128, v129, v71
    v_max3_u32 v71, v130, v131, v71
    v_dot2_f32_bf16 v62, v128, s7, v62
    v_dot2_f32_bf16 v63, v128, v128, v63
    v_dot2_f32_bf16 v64, v130, s7, v64
    v_dot2_f32_bf16 v65, v130, v130, v65
    v_dot2_f32_bf16 v62, v129, s7, v62
    v_dot2_f32_bf16 v63, v129, v129, v63
    v_dot2_f32_bf16 v64, v131, s7, v64
    v_dot2_f32_bf16 v65, v131, v131, v65
    s_lshl_b32 s4, s5, 17
    v_add_u32 v67, s4, v66
    global_load_dwordx4 v[164:167], v67, s[38:39] sc1
    s_add_u32 s5, s5, 1
    s_mul_i32 s4, s6, 4160
    v_add_u32 v69, s4, v68
    s_waitcnt vmcnt(8)
    ds_write2_b64 v69, v[132:133], v[134:135] offset0:0 offset1:2
    s_add_u32 s6, s6, 1
    v_max3_u32 v71, v132, v133, v71
    v_max3_u32 v71, v134, v135, v71
    v_dot2_f32_bf16 v62, v132, s7, v62
    v_dot2_f32_bf16 v63, v132, v132, v63
    v_dot2_f32_bf16 v64, v134, s7, v64
    v_dot2_f32_bf16 v65, v134, v134, v65
    v_dot2_f32_bf16 v62, v133, s7, v62
    v_dot2_f32_bf16 v63, v133, v133, v63
    v_dot2_f32_bf16 v64, v135, s7, v64
    v_dot2_f32_bf16 v65, v135, v135, v65
    s_lshl_b32 s4, s5, 17
    v_add_u32 v67, s4, v66
    global_load_dwordx4 v[168:171], v67, s[38:39] sc1
    s_add_u32 s5, s5, 1
    s_cmp_eq_u32 s5, 20
    s_cselect_b32 s5, 0, s5
    s_mul_i32 s4, s6, 4160
    v_add_u32 v69, s4, v68
    s_waitcnt vmcnt(8)
    ds_write2_b64 v69, v[136:137], v[138:139] offset0:0 offset1:2
    s_add_u32 s6, s6, 1
    v_max3_u32 v71, v136, v137, v71
    v_max3_u32 v71, v138, v139, v71
    v_dot2_f32_bf16 v62, v136, s7, v62
    v_dot2_f32_bf16 v63, v136, v136, v63
    v_dot2_f32_bf16 v64, v138, s7, v64
    v_dot2_f32_bf16 v65, v138, v138, v65
    v_dot2_f32_bf16 v62, v137, s7, v62
    v_dot2_f32_bf16 v63, v137, v137, v63
    v_dot2_f32_bf16 v64, v139, s7, v64
    v_dot2_f32_bf16 v65, v139, v139, v65
    s_mul_i32 s4, s6, 4160
    v_add_u32 v69, s4, v68
    s_waitcnt vmcnt(7)
    ds_write2_b64 v69, v[140:141], v[142:143] offset0:0 offset1:2
    s_add_u32 s6, s6, 1
    v_max3_u32 v71, v140, v141, v71
    v_max3_u32 v71, v142, v143, v71
    v_dot2_f32_bf16 v62, v140, s7, v62
    v_dot2_f32_bf16 v63, v140, v140, v63
    v_dot2_f32_bf16 v64, v142, s7, v64
    v_dot2_f32_bf16 v65, v142, v142, v65
    v_dot2_f32_bf16 v62, v141, s7, v62
    v_dot2_f32_bf16 v63, v141, v141, v63
    v_dot2_f32_bf16 v64, v143, s7, v64
    v_dot2_f32_bf16 v65, v143, v143, v65
    s_mul_i32 s4, s6, 4160
    v_add_u32 v69, s4, v68
    s_waitcnt vmcnt(6)
    ds_write2_b64 v69, v[144:145], v[146:147] offset0:0 offset1:2
    s_add_u32 s6, s6, 1
    v_max3_u32 v71, v144, v145, v71
    v_max3_u32 v71, v146, v147, v71
    v_dot2_f32_bf16 v62, v144, s7, v62
    v_dot2_f32_bf16 v63, v144, v144, v63
    v_dot2_f32_bf16 v64, v146, s7, v64
    v_dot2_f32_bf16 v65, v146, v146, v65
    v_dot2_f32_bf16 v62, v145, s7, v62
    v_dot2_f32_bf16 v63, v145, v145, v63
    v_dot2_f32_bf16 v64, v147, s7, v64
    v_dot2_f32_bf16 v65, v147, v147, v65
    s_mul_i32 s4, s6, 4160
    v_add_u32 v69, s4, v68
    s_waitcnt vmcnt(5)
    ds_write2_b64 v69, v[148:149], v[150:151] offset0:0 offset1:2
    s_add_u32 s6, s6, 1
    s_cmp_eq_u32 s6, 20
    s_cselect_b32 s6, 0, s6
    v_max3_u32 v71, v148, v149, v71
    v_max3_u32 v71, v150, v151, v71
    v_dot2_f32_bf16 v62, v148, s7, v62
    v_dot2_f32_bf16 v63, v148, v148, v63
    v_dot2_f32_bf16 v64, v150, s7, v64
    v_dot2_f32_bf16 v65, v150, v150, v65
    v_dot2_f32_bf16 v62, v149, s7, v62
    v_dot2_f32_bf16 v63, v149, v149, v63
    v_dot2_f32_bf16 v64, v151, s7, v64
    v_dot2_f32_bf16 v65, v151, v151, v65
    s_mul_i32 s4, s6, 4160
    v_add_u32 v69, s4, v68
    s_waitcnt vmcnt(4)
    ds_write2_b64 v69, v[152:153], v[154:155] offset0:0 offset1:2
    s_add_u32 s6, s6, 1
    v_max3_u32 v71, v152, v153, v71
    v_max3_u32 v71, v154, v155, v71
    v_dot2_f32_bf16 v62, v152, s7, v62
    v_dot2_f32_bf16 v63, v152, v152, v63
    v_dot2_f32_bf16 v64, v154, s7, v64
    v_dot2_f32_bf16 v65, v154, v154, v65
    v_dot2_f32_bf16 v62, v153, s7, v62
    v_dot2_f32_bf16 v63, v153, v153, v63
    v_dot2_f32_bf16 v64, v155, s7, v64
    v_dot2_f32_bf16 v65, v155, v155, v65
    s_mul_i32 s4, s6, 4160
    v_add_u32 v69, s4, v68
    s_waitcnt vmcnt(3)
    ds_write2_b64 v69, v[156:157], v[158:159] offset0:0 offset1:2
    s_add_u32 s6, s6, 1
    v_max3_u32 v71, v156, v157, v71
    v_max3_u32 v71, v158, v159, v71
    v_dot2_f32_bf16 v62, v156, s7, v62
    v_dot2_f32_bf16 v63, v156, v156, v63
    v_dot2_f32_bf16 v64, v158, s7, v64
    v_dot2_f32_bf16 v65, v158, v158, v65
    v_dot2_f32_bf16 v62, v157, s7, v62
    v_dot2_f32_bf16 v63, v157, v157, v63
    v_dot2_f32_bf16 v64, v159, s7, v64
    v_dot2_f32_bf16 v65, v159, v159, v65
    s_mul_i32 s4, s6, 4160
    v_add_u32 v69, s4, v68
    s_waitcnt vmcnt(2)
    ds_write2_b64 v69, v[160:161], v[162:163] offset0:0 offset1:2
    s_add_u32 s6, s6, 1
    v_max3_u32 v71, v160, v161, v71
    v_max3_u32 v71, v162, v163, v71
    v_dot2_f32_bf16 v62, v160, s7, v62
    v_dot2_f32_bf16 v63, v160, v160, v63
    v_dot2_f32_bf16 v64, v162, s7, v64
    v_dot2_f32_bf16 v65, v162, v162, v65
    v_dot2_f32_bf16 v62, v161, s7, v62
    v_dot2_f32_bf16 v63, v161, v161, v63
    v_dot2_f32_bf16 v64, v163, s7, v64
    v_dot2_f32_bf16 v65, v163, v163, v65
    s_mul_i32 s4, s6, 4160
    v_add_u32 v69, s4, v68
    s_waitcnt vmcnt(1)
    ds_write2_b64 v69, v[164:165], v[166:167] offset0:0 offset1:2
    s_add_u32 s6, s6, 1
    v_max3_u32 v71, v164, v165, v71
    v_max3_u32 v71, v166, v167, v71
    v_dot2_f32_bf16 v62, v164, s7, v62
    v_dot2_f32_bf16 v63, v164, v164, v63
    v_dot2_f32_bf16 v64, v166, s7, v64
    v_dot2_f32_bf16 v65, v166, v166, v65
    v_dot2_f32_bf16 v62, v165, s7, v62
    v_dot2_f32_bf16 v63, v165, v165, v63
    v_dot2_f32_bf16 v64, v167, s7, v64
    v_dot2_f32_bf16 v65, v167, v167, v65
    s_mul_i32 s4, s6, 4160
    v_add_u32 v69, s4, v68
    s_waitcnt vmcnt(0)
    ds_write2_b64 v69, v[168:169], v[170:171] offset0:0 offset1:2
    s_add_u32 s6, s6, 1
    s_cmp_eq_u32 s6, 20
    s_cselect_b32 s6, 0, s6
    v_max3_u32 v71, v168, v169, v71
    v_max3_u32 v71, v170, v171, v71
    v_dot2_f32_bf16 v62, v168, s7, v62
    v_dot2_f32_bf16 v63, v168, v168, v63
    v_dot2_f32_bf16 v64, v170, s7, v64
    v_dot2_f32_bf16 v65, v170, v170, v65
    v_dot2_f32_bf16 v62, v169, s7, v62
    v_dot2_f32_bf16 v63, v169, v169, v63
    v_dot2_f32_bf16 v64, v171, s7, v64
    v_dot2_f32_bf16 v65, v171, v171, v65
    v_cmp_eq_u32 vcc, -1, v71
    s_cmp_ge_u32 s100, 262144
    s_cbranch_scc1 Lx_go
    s_cbranch_vccnz Lx_redo
Lx_go:
    v_add_f32_dpp v172, v62, v62 row_ror:8 row_mask:0xf bank_mask:0x3
    s_nop 1
    v_add_f32_dpp v172, v64, v64 row_ror:8 row_mask:0xf bank_mask:0xc
    v_add_f32_dpp v173, v63, v63 row_ror:8 row_mask:0xf bank_mask:0x3
    s_nop 1
    v_add_f32_dpp v173, v65, v65 row_ror:8 row_mask:0xf bank_mask:0xc
    s_add_u32 s4, s88, 148736
    v_lshl_add_u32 v28, v70, 3, s4
    ds_write_b64 v28, v[172:173]
    s_waitcnt lgkmcnt(0)
    s_barrier
    v_mov_b32 v167, v4
    v_add_u32 v168, 41600, v4
    ds_read_b128 v[48:51], v167 offset:0
    ds_read_b128 v[52:55], v167 offset:1040
    ds_read_b128 v[56:59], v167 offset:2080
    ds_read_b128 v[60:63], v167 offset:3120
    ds_read_b128 v[64:67], v167 offset:4160
    s_waitcnt lgkmcnt(4)
    v_mfma_f32_16x16x32_bf16 v[180:183], v[48:51], a[96:99], 0
    global_load_dwordx4 a[0:3], v6, s[38:39] offset:-4096 sc1
    ds_read_b128 v[68:71], v167 offset:5200
    v_mfma_f32_16x16x32_bf16 v[196:199], v[48:51], a[100:103], 0
    s_waitcnt lgkmcnt(4)
    v_mfma_f32_16x16x32_bf16 v[184:187], v[52:55], a[96:99], 0
    ds_read_b128 v[48:51], v167 offset:6240
    v_mfma_f32_16x16x32_bf16 v[200:203], v[52:55], a[100:103], 0
    global_load_dwordx4 a[4:7], v7, s[38:39] offset:-4096 sc1
    s_waitcnt lgkmcnt(4)
    v_mfma_f32_16x16x32_bf16 v[188:191], v[56:59], a[96:99], 0
    v_add_u32 v28, 148736, v30
    ds_read_b128 v[52:55], v167 offset:7280
    v_mfma_f32_16x16x32_bf16 v[204:207], v[56:59], a[100:103], 0
    ds_read_b64 v[172:173], v28 offset:0
    s_waitcnt lgkmcnt(5)
    v_mfma_f32_16x16x32_bf16 v[192:195], v[60:63], a[96:99], 0
    ds_read_b128 v[56:59], v167 offset:8320
    v_mfma_f32_16x16x32_bf16 v[208:211], v[60:63], a[100:103], 0
    ds_read_b64 v[174:175], v28 offset:512
    global_load_dwordx4 a[8:11], v6, s[38:39] offset:-3072 sc1
    s_waitcnt lgkmcnt(6)
    v_mfma_f32_16x16x32_bf16 v[180:183], v[64:67], a[104:107], v[180:183]
    ds_read_b128 v[60:63], v167 offset:9360
    v_mfma_f32_16x16x32_bf16 v[196:199], v[64:67], a[108:111], v[196:199]
    ds_read_b64 v[176:177], v28 offset:1024
    s_waitcnt lgkmcnt(7)
    v_mfma_f32_16x16x32_bf16 v[184:187], v[68:71], a[104:107], v[184:187]
    ds_read_b128 v[64:67], v167 offset:10400
    v_mfma_f32_16x16x32_bf16 v[200:203], v[68:71], a[108:111], v[200:203]
    ds_read_b64 v[178:179], v28 offset:1536
    global_load_dwordx4 a[12:15], v7, s[38:39] offset:-3072 sc1
    s_waitcnt lgkmcnt(8)
    v_mfma_f32_16x16x32_bf16 v[188:191], v[48:51], a[104:107], v[188:191]
    ds_read_b128 v[68:71], v167 offset:11440
    v_mfma_f32_16x16x32_bf16 v[204:207], v[48:51], a[108:111], v[204:207]
    s_add_u32 s4, s88, 150784
    v_lshl_add_u32 v164, v1, 2, s4
    s_waitcnt lgkmcnt(8)
    v_mfma_f32_16x16x32_bf16 v[192:195], v[52:55], a[104:107], v[192:195]
    global_load_dwordx4 a[16:19], v6, s[38:39] offset:-2048 sc1
    ds_read_b128 v[48:51], v167 offset:12480
    v_mfma_f32_16x16x32_bf16 v[208:211], v[52:55], a[108:111], v[208:211]
    v_lshl_add_u32 v165, v3, 5, s4
    s_waitcnt lgkmcnt(7)
    v_mfma_f32_16x16x32_bf16 v[180:183], v[56:59], a[112:115], v[180:183]
    ds_read_b128 v[52:55], v167 offset:13520
    v_mfma_f32_16x16x32_bf16 v[196:199], v[56:59], a[116:119], v[196:199]
    v_lshl_add_u32 v166, v5, 2, s4
    s_waitcnt lgkmcnt(6)
    v_mfma_f32_16x16x32_bf16 v[184:187], v[60:63], a[112:115], v[184:187]
    global_load_dwordx4 a[20:23], v7, s[38:39] offset:-2048 sc1
    ds_read_b128 v[56:59], v167 offset:14560
    v_mfma_f32_16x16x32_bf16 v[200:203], v[60:63], a[116:119], v[200:203]
    v_add_f32 v172, v172, v174
    s_waitcnt lgkmcnt(5)
    v_mfma_f32_16x16x32_bf16 v[188:191], v[64:67], a[112:115], v[188:191]
    ds_read_b128 v[60:63], v167 offset:15600
    v_mfma_f32_16x16x32_bf16 v[204:207], v[64:67], a[116:119], v[204:207]
    v_add_f32 v173, v173, v175
    s_waitcnt lgkmcnt(4)
    v_mfma_f32_16x16x32_bf16 v[192:195], v[68:71], a[112:115], v[192:195]
    global_load_dwordx4 a[24:27], v6, s[38:39] offset:-1024 sc1
    ds_read_b128 v[64:67], v167 offset:16640
    v_mfma_f32_16x16x32_bf16 v[208:211], v[68:71], a[116:119], v[208:211]
    v_add_f32 v176, v176, v178
    s_waitcnt lgkmcnt(4)
    v_mfma_f32_16x16x32_bf16 v[180:183], v[48:51], a[120:123], v[180:183]
    ds_read_b128 v[68:71], v167 offset:17680
    v_mfma_f32_16x16x32_bf16 v[196:199], v[48:51], a[124:127], v[196:199]
    v_add_f32 v177, v177, v179
    global_load_dwordx4 a[28:31], v7, s[38:39] offset:-1024 sc1
    s_waitcnt lgkmcnt(4)
    v_mfma_f32_16x16x32_bf16 v[184:187], v[52:55], a[120:123], v[184:187]
    ds_read_b128 v[48:51], v167 offset:18720
    v_mfma_f32_16x16x32_bf16 v[200:203], v[52:55], a[124:127], v[200:203]
    v_add_f32 v172, v172, v176
    s_waitcnt lgkmcnt(4)
    v_mfma_f32_16x16x32_bf16 v[188:191], v[56:59], a[120:123], v[188:191]
    ds_read_b128 v[52:55], v167 offset:19760
    v_mfma_f32_16x16x32_bf16 v[204:207], v[56:59], a[124:127], v[204:207]
    v_add_f32 v173, v173, v177
    global_load_dwordx4 a[32:35], v6, s[38:39] offset:0 sc1
    s_waitcnt lgkmcnt(4)
    v_mfma_f32_16x16x32_bf16 v[192:195], v[60:63], a[120:123], v[192:195]
    ds_read_b128 v[56:59], v167 offset:20800
    v_mfma_f32_16x16x32_bf16 v[208:211], v[60:63], a[124:127], v[208:211]
    v_mul_f32 v172, 0x3acccccd, v172
    s_waitcnt lgkmcnt(4)
    v_mfma_f32_16x16x32_bf16 v[180:183], v[64:67], a[128:131], v[180:183]
    ds_read_b128 v[60:63], v167 offset:21840
    v_mfma_f32_16x16x32_bf16 v[196:199], v[64:67], a[132:135], v[196:199]
    v_mul_f32 v173, 0x3acccccd, v173
    global_load_dwordx4 a[36:39], v7, s[38:39] offset:0 sc1
    s_waitcnt lgkmcnt(4)
    v_mfma_f32_16x16x32_bf16 v[184:187], v[68:71], a[128:131], v[184:187]
    ds_read_b128 v[64:67], v167 offset:22880
    v_mfma_f32_16x16x32_bf16 v[200:203], v[68:71], a[132:135], v[200:203]
    v_fma_f32 v173, -v172, v172, v173
    s_waitcnt lgkmcnt(4)
    v_mfma_f32_16x16x32_bf16 v[188:191], v[48:51], a[128:131], v[188:191]
    global_load_dwordx4 a[40:43], v6, s[38:39] offset:1024 sc1
    ds_read_b128 v[68:71], v167 offset:23920
    v_mfma_f32_16x16x32_bf16 v[204:207], v[48:51], a[132:135], v[204:207]
    v_max_f32 v173, 0, v173
    s_waitcnt lgkmcnt(4)
    v_mfma_f32_16x16x32_bf16 v[192:195], v[52:55], a[128:131], v[192:195]
    ds_read_b128 v[48:51], v167 offset:24960
    v_mfma_f32_16x16x32_bf16 v[208:211], v[52:55], a[132:135], v[208:211]
    v_add_f32 v173, 0x3727c5ac, v173
    s_waitcnt lgkmcnt(4)
    v_mfma_f32_16x16x32_bf16 v[180:183], v[56:59], a[136:139], v[180:183]
    global_load_dwordx4 a[44:47], v7, s[38:39] offset:1024 sc1
    ds_read_b128 v[52:55], v167 offset:26000
    v_mfma_f32_16x16x32_bf16 v[196:199], v[56:59], a[140:143], v[196:199]
    v_rsq_f32 v174, v173
    s_waitcnt lgkmcnt(4)
    v_mfma_f32_16x16x32_bf16 v[184:187], v[60:63], a[136:139], v[184:187]
    ds_read_b128 v[56:59], v167 offset:27040
    v_mfma_f32_16x16x32_bf16 v[200:203], v[60:63], a[140:143], v[200:203]
    v_mul_f32_e64 v173, -v172, v174
    s_waitcnt lgkmcnt(4)
    v_mfma_f32_16x16x32_bf16 v[188:191], v[64:67], a[136:139], v[188:191]
    global_load_dwordx4 a[48:51], v6, s[38:39] offset:2048 sc1
    ds_read_b128 v[60:63], v167 offset:28080
    v_mfma_f32_16x16x32_bf16 v[204:207], v[64:67], a[140:143], v[204:207]
    v_mov_b32 v172, v174
    s_waitcnt lgkmcnt(4)
    v_mfma_f32_16x16x32_bf16 v[192:195], v[68:71], a[136:139], v[192:195]
    ds_read_b128 v[64:67], v167 offset:29120
    v_mfma_f32_16x16x32_bf16 v[208:211], v[68:71], a[140:143], v[208:211]
    ds_write2st64_b32 v164, v172, v173 offset0:0 offset1:1
    s_waitcnt lgkmcnt(5)
    v_mfma_f32_16x16x32_bf16 v[180:183], v[48:51], a[144:147], v[180:183]
    global_load_dwordx4 a[52:55], v7, s[38:39] offset:2048 sc1
    ds_read_b128 v[68:71], v167 offset:30160
    v_mfma_f32_16x16x32_bf16 v[196:199], v[48:51], a[148:151], v[196:199]
    ds_read_b128 v[92:95], v165 offset:0
    s_waitcnt lgkmcnt(6)
    v_mfma_f32_16x16x32_bf16 v[184:187], v[52:55], a[144:147], v[184:187]
    ds_read_b128 v[48:51], v167 offset:31200
    v_mfma_f32_16x16x32_bf16 v[200:203], v[52:55], a[148:151], v[200:203]
    ds_read_b128 v[96:99], v165 offset:16
    global_load_dwordx4 a[56:59], v6, s[38:39] offset:3072 sc1
    s_waitcnt lgkmcnt(7)
    v_mfma_f32_16x16x32_bf16 v[188:191], v[56:59], a[144:147], v[188:191]
    ds_read_b128 v[52:55], v167 offset:32240
    v_mfma_f32_16x16x32_bf16 v[204:207], v[56:59], a[148:151], v[204:207]
    ds_read_b128 v[100:103], v165 offset:128
    s_waitcnt lgkmcnt(8)
    v_mfma_f32_16x16x32_bf16 v[192:195], v[60:63], a[144:147], v[192:195]
    ds_read_b128 v[104:107], v165 offset:144
    ds_read_b128 v[56:59], v167 offset:33280
    v_mfma_f32_16x16x32_bf16 v[208:211], v[60:63], a[148:151], v[208:211]
    global_load_dwordx4 a[60:63], v7, s[38:39] offset:3072 sc1
    s_waitcnt lgkmcnt(9)
    v_mfma_f32_16x16x32_bf16 v[180:183], v[64:67], a[152:155], v[180:183]
    ds_read_b128 v[108:111], v165 offset:256
    ds_read_b128 v[60:63], v167 offset:34320
    v_mfma_f32_16x16x32_bf16 v[196:199], v[64:67], a[156:159], v[196:199]
    s_waitcnt lgkmcnt(9)
    v_mfma_f32_16x16x32_bf16 v[184:187], v[68:71], a[152:155], v[184:187]
    ds_read_b128 v[112:115], v165 offset:272
    ds_read_b128 v[64:67], v167 offset:35360
    v_mfma_f32_16x16x32_bf16 v[200:203], v[68:71], a[156:159], v[200:203]
    v_add_u32 v6, 8192, v6
    s_waitcnt lgkmcnt(9)
    v_mfma_f32_16x16x32_bf16 v[188:191], v[48:51], a[152:155], v[188:191]
    ds_read_b128 v[116:119], v165 offset:384
    ds_read_b128 v[68:71], v167 offset:36400
    v_mfma_f32_16x16x32_bf16 v[204:207], v[48:51], a[156:159], v[204:207]
    s_waitcnt lgkmcnt(9)
    v_mfma_f32_16x16x32_bf16 v[192:195], v[52:55], a[152:155], v[192:195]
    ds_read_b128 v[120:123], v165 offset:400
    v_add_u32 v7, 8192, v7
    ds_read_b128 v[48:51], v167 offset:37440
    v_mfma_f32_16x16x32_bf16 v[208:211], v[52:55], a[156:159], v[208:211]
    s_waitcnt lgkmcnt(8)
    v_mfma_f32_16x16x32_bf16 v[180:183], v[56:59], a[160:163], v[180:183]
    ds_read_b32 v156, v166 offset:0
    ds_read_b128 v[52:55], v167 offset:38480
    v_mfma_f32_16x16x32_bf16 v[196:199], v[56:59], a[164:167], v[196:199]
    s_waitcnt lgkmcnt(8)
    v_mfma_f32_16x16x32_bf16 v[184:187], v[60:63], a[160:163], v[184:187]
    ds_read_b32 v157, v166 offset:256
    global_load_dwordx4 a[64:67], v6, s[38:39] offset:-4096 sc1
    ds_read_b128 v[56:59], v167 offset:39520
    v_mfma_f32_16x16x32_bf16 v[200:203], v[60:63], a[164:167], v[200:203]
    s_waitcnt lgkmcnt(8)
    v_mfma_f32_16x16x32_bf16 v[188:191], v[64:67], a[160:163], v[188:191]
    ds_read_b32 v158, v166 offset:16
    ds_read_b128 v[60:63], v167 offset:40560
    v_mfma_f32_16x16x32_bf16 v[204:207], v[64:67], a[164:167], v[204:207]
    s_waitcnt lgkmcnt(8)
    v_mfma_f32_16x16x32_bf16 v[192:195], v[68:71], a[160:163], v[192:195]
    ds_read_b32 v159, v166 offset:272
    global_load_dwordx4 a[68:71], v7, s[38:39] offset:-4096 sc1
    ds_read_b128 v[64:67], v168 offset:0
    v_mfma_f32_16x16x32_bf16 v[208:211], v[68:71], a[164:167], v[208:211]
    s_waitcnt lgkmcnt(8)
    v_mfma_f32_16x16x32_bf16 v[180:183], v[48:51], a[168:171], v[180:183]
    ds_read_b32 v160, v166 offset:128
    ds_read_b128 v[68:71], v168 offset:1040
    v_mfma_f32_16x16x32_bf16 v[196:199], v[48:51], a[172:175], v[196:199]
    global_load_dwordx4 a[72:75], v6, s[38:39] offset:-3072 sc1
    s_waitcnt lgkmcnt(8)
    v_mfma_f32_16x16x32_bf16 v[184:187], v[52:55], a[168:171], v[184:187]
    ds_read_b32 v161, v166 offset:384
    ds_read_b128 v[48:51], v168 offset:2080
    v_mfma_f32_16x16x32_bf16 v[200:203], v[52:55], a[172:175], v[200:203]
    s_waitcnt lgkmcnt(8)
    v_mfma_f32_16x16x32_bf16 v[188:191], v[56:59], a[168:171], v[188:191]
    ds_read_b32 v162, v166 offset:144
    ds_read_b128 v[52:55], v168 offset:3120
    v_mfma_f32_16x16x32_bf16 v[204:207], v[56:59], a[172:175], v[204:207]
    global_load_dwordx4 a[76:79], v7, s[38:39] offset:-3072 sc1
    s_waitcnt lgkmcnt(8)
    v_mfma_f32_16x16x32_bf16 v[192:195], v[60:63], a[168:171], v[192:195]
    ds_read_b32 v163, v166 offset:400
    ds_read_b128 v[56:59], v168 offset:4160
    v_mfma_f32_16x16x32_bf16 v[208:211], v[60:63], a[172:175], v[208:211]
    s_waitcnt lgkmcnt(8)
    v_mfma_f32_16x16x32_bf16 v[180:183], v[64:67], a[176:179], v[180:183]
    v_fma_f32 v124, v108, v8, v9
    ds_read_b128 v[60:63], v168 offset:5200
    v_mfma_f32_16x16x32_bf16 v[196:199], v[64:67], a[180:183], v[196:199]
    global_load_dwordx4 a[80:83], v6, s[38:39] offset:-2048 sc1
    s_waitcnt lgkmcnt(7)
    v_mfma_f32_16x16x32_bf16 v[184:187], v[68:71], a[176:179], v[184:187]
    v_fma_f32 v125, v109, v8, v9
    ds_read_b128 v[64:67], v168 offset:6240
    v_mfma_f32_16x16x32_bf16 v[200:203], v[68:71], a[180:183], v[200:203]
    s_waitcnt lgkmcnt(6)
    v_mfma_f32_16x16x32_bf16 v[188:191], v[48:51], a[176:179], v[188:191]
    v_fma_f32 v126, v110, v8, v9
    global_load_dwordx4 a[84:87], v7, s[38:39] offset:-2048 sc1
    ds_read_b128 v[68:71], v168 offset:7280
    v_mfma_f32_16x16x32_bf16 v[204:207], v[48:51], a[180:183], v[204:207]
    s_waitcnt lgkmcnt(5)
    v_mfma_f32_16x16x32_bf16 v[192:195], v[52:55], a[176:179], v[192:195]
    v_fma_f32 v127, v111, v8, v9
    ds_read_b128 v[48:51], v168 offset:8320
    v_mfma_f32_16x16x32_bf16 v[208:211], v[52:55], a[180:183], v[208:211]
    s_waitcnt lgkmcnt(4)
    v_mfma_f32_16x16x32_bf16 v[180:183], v[56:59], a[184:187], v[180:183]
    v_fma_f32 v128, v112, v8, v9
    global_load_dwordx4 a[88:91], v6, s[38:39] offset:-1024 sc1
    ds_read_b128 v[52:55], v168 offset:9360
    v_mfma_f32_16x16x32_bf16 v[196:199], v[56:59], a[188:191], v[196:199]
    s_waitcnt lgkmcnt(4)
    v_mfma_f32_16x16x32_bf16 v[184:187], v[60:63], a[184:187], v[184:187]
    v_fma_f32 v129, v113, v8, v9
    ds_read_b128 v[56:59], v168 offset:10400
    v_mfma_f32_16x16x32_bf16 v[200:203], v[60:63], a[188:191], v[200:203]
    s_waitcnt lgkmcnt(4)
    v_mfma_f32_16x16x32_bf16 v[188:191], v[64:67], a[184:187], v[188:191]
    v_fma_f32 v130, v114, v8, v9
    global_load_dwordx4 a[92:95], v7, s[38:39] offset:-1024 sc1
    ds_read_b128 v[60:63], v168 offset:11440
    v_mfma_f32_16x16x32_bf16 v[204:207], v[64:67], a[188:191], v[204:207]
    s_waitcnt lgkmcnt(4)
    v_mfma_f32_16x16x32_bf16 v[192:195], v[68:71], a[184:187], v[192:195]
    v_fma_f32 v131, v115, v8, v9
    ds_read_b128 v[64:67], v168 offset:12480
    v_mfma_f32_16x16x32_bf16 v[208:211], v[68:71], a[188:191], v[208:211]
    s_waitcnt lgkmcnt(4)
    v_mfma_f32_16x16x32_bf16 v[180:183], v[48:51], a[192:195], v[180:183]
    v_fma_f32 v132, v116, v8, v9
    global_load_dwordx4 a[96:99], v6, s[38:39] offset:0 sc1
    ds_read_b128 v[68:71], v168 offset:13520
    v_mfma_f32_16x16x32_bf16 v[196:199], v[48:51], a[196:199], v[196:199]
    s_waitcnt lgkmcnt(4)
    v_mfma_f32_16x16x32_bf16 v[184:187], v[52:55], a[192:195], v[184:187]
    v_fma_f32 v133, v117, v8, v9
    ds_read_b128 v[48:51], v168 offset:14560
    v_mfma_f32_16x16x32_bf16 v[200:203], v[52:55], a[196:199], v[200:203]
    global_load_dwordx4 a[100:103], v7, s[38:39] offset:0 sc1
    s_waitcnt lgkmcnt(4)
    v_mfma_f32_16x16x32_bf16 v[188:191], v[56:59], a[192:195], v[188:191]
    v_fma_f32 v134, v118, v8, v9
    ds_read_b128 v[52:55], v168 offset:15600
    v_mfma_f32_16x16x32_bf16 v[204:207], v[56:59], a[196:199], v[204:207]
    s_waitcnt lgkmcnt(4)
    v_mfma_f32_16x16x32_bf16 v[192:195], v[60:63], a[192:195], v[192:195]
    v_fma_f32 v135, v119, v8, v9
    ds_read_b128 v[56:59], v168 offset:16640
    v_mfma_f32_16x16x32_bf16 v[208:211], v[60:63], a[196:199], v[208:211]
    v_fma_f32 v136, v120, v8, v9
    global_load_dwordx4 a[104:107], v6, s[38:39] offset:1024 sc1
    s_waitcnt lgkmcnt(4)
    v_mfma_f32_16x16x32_bf16 v[180:183], v[64:67], a[200:203], v[180:183]
    ds_read_b128 v[60:63], v168 offset:17680
    v_mfma_f32_16x16x32_bf16 v[196:199], v[64:67], a[204:207], v[196:199]
    v_fma_f32 v137, v121, v8, v9
    s_waitcnt lgkmcnt(4)
    v_mfma_f32_16x16x32_bf16 v[184:187], v[68:71], a[200:203], v[184:187]
    global_load_dwordx4 a[108:111], v7, s[38:39] offset:1024 sc1
    ds_read_b128 v[64:67], v168 offset:18720
    v_mfma_f32_16x16x32_bf16 v[200:203], v[68:71], a[204:207], v[200:203]
    v_fma_f32 v138, v122, v8, v9
    s_waitcnt lgkmcnt(4)
    v_mfma_f32_16x16x32_bf16 v[188:191], v[48:51], a[200:203], v[188:191]
    ds_read_b128 v[68:71], v168 offset:19760
    v_mfma_f32_16x16x32_bf16 v[204:207], v[48:51], a[204:207], v[204:207]
    v_fma_f32 v139, v123, v8, v9
    s_waitcnt lgkmcnt(4)
    v_mfma_f32_16x16x32_bf16 v[192:195], v[52:55], a[200:203], v[192:195]
    global_load_dwordx4 a[112:115], v6, s[38:39] offset:2048 sc1
    ds_read_b128 v[48:51], v168 offset:20800
    v_mfma_f32_16x16x32_bf16 v[208:211], v[52:55], a[204:207], v[208:211]
    v_fma_f32 v140, v108, v10, v11
    s_waitcnt lgkmcnt(4)
    v_mfma_f32_16x16x32_bf16 v[180:183], v[56:59], a[208:211], v[180:183]
    ds_read_b128 v[52:55], v168 offset:21840
    v_mfma_f32_16x16x32_bf16 v[196:199], v[56:59], a[212:215], v[196:199]
    v_fma_f32 v141, v109, v10, v11
    global_load_dwordx4 a[116:119], v7, s[38:39] offset:2048 sc1
    s_waitcnt lgkmcnt(4)
    v_mfma_f32_16x16x32_bf16 v[184:187], v[60:63], a[208:211], v[184:187]
    ds_read_b128 v[56:59], v168 offset:22880
    v_mfma_f32_16x16x32_bf16 v[200:203], v[60:63], a[212:215], v[200:203]
    v_fma_f32 v142, v110, v10, v11
    s_waitcnt lgkmcnt(4)
    v_mfma_f32_16x16x32_bf16 v[188:191], v[64:67], a[208:211], v[188:191]
    ds_read_b128 v[60:63], v168 offset:23920
    v_mfma_f32_16x16x32_bf16 v[204:207], v[64:67], a[212:215], v[204:207]
    v_fma_f32 v143, v111, v10, v11
    global_load_dwordx4 a[120:123], v6, s[38:39] offset:3072 sc1
    s_waitcnt lgkmcnt(4)
    v_mfma_f32_16x16x32_bf16 v[192:195], v[68:71], a[208:211], v[192:195]
    ds_read_b128 v[64:67], v168 offset:24960
    v_mfma_f32_16x16x32_bf16 v[208:211], v[68:71], a[212:215], v[208:211]
    v_fma_f32 v144, v112, v10, v11
    s_waitcnt lgkmcnt(4)
    v_mfma_f32_16x16x32_bf16 v[180:183], v[48:51], a[216:219], v[180:183]
    global_load_dwordx4 a[124:127], v7, s[38:39] offset:3072 sc1
    ds_read_b128 v[68:71], v168 offset:26000
    v_mfma_f32_16x16x32_bf16 v[196:199], v[48:51], a[220:223], v[196:199]
    v_fma_f32 v145, v113, v10, v11
    s_waitcnt lgkmcnt(4)
    v_mfma_f32_16x16x32_bf16 v[184:187], v[52:55], a[216:219], v[184:187]
    ds_read_b128 v[48:51], v168 offset:27040
    v_mfma_f32_16x16x32_bf16 v[200:203], v[52:55], a[220:223], v[200:203]
    v_fma_f32 v146, v114, v10, v11
    s_waitcnt lgkmcnt(4)
    v_mfma_f32_16x16x32_bf16 v[188:191], v[56:59], a[216:219], v[188:191]
    v_add_u32 v6, 8192, v6
    ds_read_b128 v[52:55], v168 offset:28080
    v_mfma_f32_16x16x32_bf16 v[204:207], v[56:59], a[220:223], v[204:207]
    v_fma_f32 v147, v115, v10, v11
    s_waitcnt lgkmcnt(4)
    v_mfma_f32_16x16x32_bf16 v[192:195], v[60:63], a[216:219], v[192:195]
    ds_read_b128 v[56:59], v168 offset:29120
    v_mfma_f32_16x16x32_bf16 v[208:211], v[60:63], a[220:223], v[208:211]
    v_fma_f32 v148, v116, v10, v11
    s_waitcnt lgkmcnt(4)
    v_mfma_f32_16x16x32_bf16 v[180:183], v[64:67], a[224:227], v[180:183]
    v_add_u32 v7, 8192, v7
    ds_read_b128 v[60:63], v168 offset:30160
    v_mfma_f32_16x16x32_bf16 v[196:199], v[64:67], a[228:231], v[196:199]
    v_fma_f32 v149, v117, v10, v11
    s_waitcnt lgkmcnt(4)
    v_mfma_f32_16x16x32_bf16 v[184:187], v[68:71], a[224:227], v[184:187]
    ds_read_b128 v[64:67], v168 offset:31200
    v_mfma_f32_16x16x32_bf16 v[200:203], v[68:71], a[228:231], v[200:203]
    v_fma_f32 v150, v118, v10, v11
    global_load_dwordx4 a[128:131], v6, s[38:39] offset:-4096 sc1
    s_waitcnt lgkmcnt(4)
    v_mfma_f32_16x16x32_bf16 v[188:191], v[48:51], a[224:227], v[188:191]
    ds_read_b128 v[68:71], v168 offset:32240
    v_mfma_f32_16x16x32_bf16 v[204:207], v[48:51], a[228:231], v[204:207]
    v_fma_f32 v151, v119, v10, v11
    s_waitcnt lgkmcnt(4)
    v_mfma_f32_16x16x32_bf16 v[192:195], v[52:55], a[224:227], v[192:195]
    ds_read_b128 v[48:51], v168 offset:33280
    v_mfma_f32_16x16x32_bf16 v[208:211], v[52:55], a[228:231], v[208:211]
    v_fma_f32 v152, v120, v10, v11
    global_load_dwordx4 a[132:135], v7, s[38:39] offset:-4096 sc1
    s_waitcnt lgkmcnt(4)
    v_mfma_f32_16x16x32_bf16 v[180:183], v[56:59], a[232:235], v[180:183]
    ds_read_b128 v[52:55], v168 offset:34320
    v_mfma_f32_16x16x32_bf16 v[196:199], v[56:59], a[236:239], v[196:199]
    v_fma_f32 v153, v121, v10, v11
    s_waitcnt lgkmcnt(4)
    v_mfma_f32_16x16x32_bf16 v[184:187], v[60:63], a[232:235], v[184:187]
    global_load_dwordx4 a[136:139], v6, s[38:39] offset:-3072 sc1
    ds_read_b128 v[56:59], v168 offset:35360
    v_mfma_f32_16x16x32_bf16 v[200:203], v[60:63], a[236:239], v[200:203]
    v_fma_f32 v154, v122, v10, v11
    s_waitcnt lgkmcnt(4)
    v_mfma_f32_16x16x32_bf16 v[188:191], v[64:67], a[232:235], v[188:191]
    ds_read_b128 v[60:63], v168 offset:36400
    v_mfma_f32_16x16x32_bf16 v[204:207], v[64:67], a[236:239], v[204:207]
    v_fma_f32 v155, v123, v10, v11
    s_waitcnt lgkmcnt(4)
    v_mfma_f32_16x16x32_bf16 v[192:195], v[68:71], a[232:235], v[192:195]
    global_load_dwordx4 a[140:143], v7, s[38:39] offset:-3072 sc1
    ds_read_b128 v[64:67], v168 offset:37440
    v_mfma_f32_16x16x32_bf16 v[208:211], v[68:71], a[236:239], v[208:211]
    v_lshlrev_b32 v32, 16, v32
    s_waitcnt lgkmcnt(4)
    v_mfma_f32_16x16x32_bf16 v[180:183], v[48:51], a[240:243], v[180:183]
    ds_read_b128 v[68:71], v168 offset:38480
    v_mfma_f32_16x16x32_bf16 v[196:199], v[48:51], a[244:247], v[196:199]
    v_mov_b32 v33, v32
    global_load_dwordx4 a[144:147], v6, s[38:39] offset:-2048 sc1
    s_waitcnt lgkmcnt(4)
    v_mfma_f32_16x16x32_bf16 v[184:187], v[52:55], a[240:243], v[184:187]
    ds_read_b128 v[48:51], v168 offset:39520
    v_mfma_f32_16x16x32_bf16 v[200:203], v[52:55], a[244:247], v[200:203]
    v_mov_b32 v34, v32
    s_waitcnt lgkmcnt(4)
    v_mfma_f32_16x16x32_bf16 v[188:191], v[56:59], a[240:243], v[188:191]
    ds_read_b128 v[52:55], v168 offset:40560
    v_mfma_f32_16x16x32_bf16 v[204:207], v[56:59], a[244:247], v[204:207]
    v_mov_b32 v35, v32
    global_load_dwordx4 a[148:151], v7, s[38:39] offset:-2048 sc1
    s_waitcnt lgkmcnt(4)
    v_mfma_f32_16x16x32_bf16 v[192:195], v[60:63], a[240:243], v[192:195]
    v_mfma_f32_16x16x32_bf16 v[208:211], v[60:63], a[244:247], v[208:211]
    s_waitcnt lgkmcnt(3)
    v_mfma_f32_16x16x32_bf16 v[180:183], v[64:67], a[248:251], v[180:183]
    global_load_dwordx4 a[152:155], v6, s[38:39] offset:-1024 sc1
    v_mfma_f32_16x16x32_bf16 v[196:199], v[64:67], a[252:255], v[196:199]
    s_waitcnt lgkmcnt(2)
    v_mfma_f32_16x16x32_bf16 v[184:187], v[68:71], a[248:251], v[184:187]
    v_mfma_f32_16x16x32_bf16 v[200:203], v[68:71], a[252:255], v[200:203]
    s_waitcnt lgkmcnt(1)
    v_mfma_f32_16x16x32_bf16 v[188:191], v[48:51], a[248:251], v[188:191]
    global_load_dwordx4 a[156:159], v7, s[38:39] offset:-1024 sc1
    v_mfma_f32_16x16x32_bf16 v[204:207], v[48:51], a[252:255], v[204:207]
    s_waitcnt lgkmcnt(0)
    v_mfma_f32_16x16x32_bf16 v[192:195], v[52:55], a[248:251], v[192:195]
    v_mfma_f32_16x16x32_bf16 v[208:211], v[52:55], a[252:255], v[208:211]
    s_add_u32 m0, s89, 0
    s_nop 0
    global_load_lds_dwordx4 v76, s[68:69]
    v_pk_fma_f32 v[180:181], v[180:181], v[92:93], v[124:125] op_sel:[0,0,0] op_sel_hi:[1,1,1]
    v_pk_fma_f32 v[182:183], v[182:183], v[94:95], v[126:127] op_sel:[0,0,0] op_sel_hi:[1,1,1]
    v_pk_fma_f32 v[184:185], v[184:185], v[96:97], v[128:129] op_sel:[0,0,0] op_sel_hi:[1,1,1]
    v_pk_fma_f32 v[186:187], v[186:187], v[98:99], v[130:131] op_sel:[0,0,0] op_sel_hi:[1,1,1]
    v_pk_fma_f32 v[188:189], v[188:189], v[100:101], v[132:133] op_sel:[0,0,0] op_sel_hi:[1,1,1]
    v_pk_fma_f32 v[190:191], v[190:191], v[102:103], v[134:135] op_sel:[0,0,0] op_sel_hi:[1,1,1]
    v_pk_fma_f32 v[192:193], v[192:193], v[104:105], v[136:137] op_sel:[0,0,0] op_sel_hi:[1,1,1]
    v_pk_fma_f32 v[194:195], v[194:195], v[106:107], v[138:139] op_sel:[0,0,0] op_sel_hi:[1,1,1]
    v_pk_fma_f32 v[196:197], v[196:197], v[92:93], v[140:141] op_sel:[0,0,0] op_sel_hi:[1,1,1]
    s_add_u32 m0, s89, 1024
    s_nop 0
    global_load_lds_dwordx4 v77, s[68:69]
    v_pk_fma_f32 v[198:199], v[198:199], v[94:95], v[142:143] op_sel:[0,0,0] op_sel_hi:[1,1,1]
    v_pk_fma_f32 v[200:201], v[200:201], v[96:97], v[144:145] op_sel:[0,0,0] op_sel_hi:[1,1,1]
    v_pk_fma_f32 v[202:203], v[202:203], v[98:99], v[146:147] op_sel:[0,0,0] op_sel_hi:[1,1,1]
    v_pk_fma_f32 v[204:205], v[204:205], v[100:101], v[148:149] op_sel:[0,0,0] op_sel_hi:[1,1,1]
    v_pk_fma_f32 v[206:207], v[206:207], v[102:103], v[150:151] op_sel:[0,0,0] op_sel_hi:[1,1,1]
    v_pk_fma_f32 v[208:209], v[208:209], v[104:105], v[152:153] op_sel:[0,0,0] op_sel_hi:[1,1,1]
    v_pk_fma_f32 v[210:211], v[210:211], v[106:107], v[154:155] op_sel:[0,0,0] op_sel_hi:[1,1,1]
    v_pk_mul_f32 v[124:125], v[180:181], v[180:181] op_sel:[0,0] op_sel_hi:[1,1]
    v_pk_mul_f32 v[126:127], v[182:183], v[182:183] op_sel:[0,0] op_sel_hi:[1,1]
    v_pk_mul_f32 v[128:129], v[184:185], v[184:185] op_sel:[0,0] op_sel_hi:[1,1]
    s_add_u32 m0, s89, 2048
    s_nop 0
    global_load_lds_dwordx4 v78, s[68:69]
    v_pk_mul_f32 v[130:131], v[186:187], v[186:187] op_sel:[0,0] op_sel_hi:[1,1]
    v_pk_mul_f32 v[132:133], v[188:189], v[188:189] op_sel:[0,0] op_sel_hi:[1,1]
    v_pk_mul_f32 v[134:135], v[190:191], v[190:191] op_sel:[0,0] op_sel_hi:[1,1]
    v_pk_mul_f32 v[136:137], v[192:193], v[192:193] op_sel:[0,0] op_sel_hi:[1,1]
    v_pk_mul_f32 v[138:139], v[194:195], v[194:195] op_sel:[0,0] op_sel_hi:[1,1]
    v_pk_mul_f32 v[140:141], v[196:197], v[196:197] op_sel:[0,0] op_sel_hi:[1,1]
    v_pk_mul_f32 v[142:143], v[198:199], v[198:199] op_sel:[0,0] op_sel_hi:[1,1]
    v_pk_mul_f32 v[144:145], v[200:201], v[200:201] op_sel:[0,0] op_sel_hi:[1,1]
    v_pk_mul_f32 v[146:147], v[202:203], v[202:203] op_sel:[0,0] op_sel_hi:[1,1]
    s_add_u32 m0, s89, 3072
    s_nop 0
    global_load_lds_dwordx4 v79, s[68:69]
    v_pk_mul_f32 v[148:149], v[204:205], v[204:205] op_sel:[0,0] op_sel_hi:[1,1]
    v_pk_mul_f32 v[150:151], v[206:207], v[206:207] op_sel:[0,0] op_sel_hi:[1,1]
    v_pk_mul_f32 v[152:153], v[208:209], v[208:209] op_sel:[0,0] op_sel_hi:[1,1]
    v_pk_mul_f32 v[154:155], v[210:211], v[210:211] op_sel:[0,0] op_sel_hi:[1,1]
    v_pk_fma_f32 v[124:125], v[124:125], s[84:85], s[84:85] op_sel:[0,1,0] op_sel_hi:[1,1,0]
    v_pk_fma_f32 v[126:127], v[126:127], s[84:85], s[84:85] op_sel:[0,1,0] op_sel_hi:[1,1,0]
    v_pk_fma_f32 v[128:129], v[128:129], s[84:85], s[84:85] op_sel:[0,1,0] op_sel_hi:[1,1,0]
    v_pk_fma_f32 v[130:131], v[130:131], s[84:85], s[84:85] op_sel:[0,1,0] op_sel_hi:[1,1,0]
    v_pk_fma_f32 v[132:133], v[132:133], s[84:85], s[84:85] op_sel:[0,1,0] op_sel_hi:[1,1,0]
    v_pk_fma_f32 v[134:135], v[134:135], s[84:85], s[84:85] op_sel:[0,1,0] op_sel_hi:[1,1,0]
    s_add_u32 m0, s89, 4096
    s_nop 0
    global_load_lds_dwordx4 v80, s[68:69]
    v_pk_fma_f32 v[136:137], v[136:137], s[84:85], s[84:85] op_sel:[0,1,0] op_sel_hi:[1,1,0]
    v_pk_fma_f32 v[138:139], v[138:139], s[84:85], s[84:85] op_sel:[0,1,0] op_sel_hi:[1,1,0]
    v_pk_fma_f32 v[140:141], v[140:141], s[84:85], s[84:85] op_sel:[0,1,0] op_sel_hi:[1,1,0]
    v_pk_fma_f32 v[142:143], v[142:143], s[84:85], s[84:85] op_sel:[0,1,0] op_sel_hi:[1,1,0]
    v_pk_fma_f32 v[144:145], v[144:145], s[84:85], s[84:85] op_sel:[0,1,0] op_sel_hi:[1,1,0]
    v_pk_fma_f32 v[146:147], v[146:147], s[84:85], s[84:85] op_sel:[0,1,0] op_sel_hi:[1,1,0]
    v_pk_fma_f32 v[148:149], v[148:149], s[84:85], s[84:85] op_sel:[0,1,0] op_sel_hi:[1,1,0]
    v_pk_fma_f32 v[150:151], v[150:151], s[84:85], s[84:85] op_sel:[0,1,0] op_sel_hi:[1,1,0]
    v_pk_fma_f32 v[152:153], v[152:153], s[84:85], s[84:85] op_sel:[0,1,0] op_sel_hi:[1,1,0]
    s_add_u32 m0, s89, 5120
    s_nop 0
    global_load_lds_dwordx4 v81, s[68:69]
    v_pk_fma_f32 v[154:155], v[154:155], s[84:85], s[84:85] op_sel:[0,1,0] op_sel_hi:[1,1,0]
    v_pk_mul_f32 v[124:125], v[124:125], v[180:181] op_sel:[0,0] op_sel_hi:[1,1]
    v_pk_mul_f32 v[126:127], v[126:127], v[182:183] op_sel:[0,0] op_sel_hi:[1,1]
    v_pk_mul_f32 v[128:129], v[128:129], v[184:185] op_sel:[0,0] op_sel_hi:[1,1]
    v_pk_mul_f32 v[130:131], v[130:131], v[186:187] op_sel:[0,0] op_sel_hi:[1,1]
    v_pk_mul_f32 v[132:133], v[132:133], v[188:189] op_sel:[0,0] op_sel_hi:[1,1]
    v_pk_mul_f32 v[134:135], v[134:135], v[190:191] op_sel:[0,0] op_sel_hi:[1,1]
    v_pk_mul_f32 v[136:137], v[136:137], v[192:193] op_sel:[0,0] op_sel_hi:[1,1]
    v_pk_mul_f32 v[138:139], v[138:139], v[194:195] op_sel:[0,0] op_sel_hi:[1,1]
    v_pk_mul_f32 v[140:141], v[140:141], v[196:197] op_sel:[0,0] op_sel_hi:[1,1]
    s_add_u32 m0, s89, 6144
    s_nop 0
    global_load_lds_dwordx4 v82, s[68:69]
    v_pk_mul_f32 v[142:143], v[142:143], v[198:199] op_sel:[0,0] op_sel_hi:[1,1]
    v_pk_mul_f32 v[144:145], v[144:145], v[200:201] op_sel:[0,0] op_sel_hi:[1,1]
    v_pk_mul_f32 v[146:147], v[146:147], v[202:203] op_sel:[0,0] op_sel_hi:[1,1]
    v_pk_mul_f32 v[148:149], v[148:149], v[204:205] op_sel:[0,0] op_sel_hi:[1,1]
    v_pk_mul_f32 v[150:151], v[150:151], v[206:207] op_sel:[0,0] op_sel_hi:[1,1]
    v_pk_mul_f32 v[152:153], v[152:153], v[208:209] op_sel:[0,0] op_sel_hi:[1,1]
    v_pk_mul_f32 v[154:155], v[154:155], v[210:211] op_sel:[0,0] op_sel_hi:[1,1]
    v_exp_f32 v124, v124
    v_exp_f32 v125, v125
    s_add_u32 m0, s89, 7168
    s_nop 0
    global_load_lds_dwordx4 v83, s[68:69]
    v_exp_f32 v126, v126
    v_exp_f32 v127, v127
    v_exp_f32 v128, v128
    v_exp_f32 v129, v129
    v_exp_f32 v130, v130
    v_exp_f32 v131, v131
    v_exp_f32 v132, v132
    v_exp_f32 v133, v133
    v_exp_f32 v134, v134
    v_exp_f32 v135, v135
    s_add_u32 m0, s89, 8192
    s_nop 0
    global_load_lds_dwordx4 v76, s[70:71]
    v_exp_f32 v136, v136
    v_exp_f32 v137, v137
    v_exp_f32 v138, v138
    v_exp_f32 v139, v139
    v_exp_f32 v140, v140
    v_exp_f32 v141, v141
    v_exp_f32 v142, v142
    v_exp_f32 v143, v143
    v_exp_f32 v144, v144
    v_exp_f32 v145, v145
    s_add_u32 m0, s89, 9216
    s_nop 0
    global_load_lds_dwordx4 v77, s[70:71]
    v_exp_f32 v146, v146
    v_exp_f32 v147, v147
    v_exp_f32 v148, v148
    v_exp_f32 v149, v149
    v_exp_f32 v150, v150
    v_exp_f32 v151, v151
    v_exp_f32 v152, v152
    v_exp_f32 v153, v153
    v_exp_f32 v154, v154
    s_add_u32 m0, s89, 10240
    s_nop 0
    global_load_lds_dwordx4 v78, s[70:71]
    v_exp_f32 v155, v155
    v_pk_add_f32 v[124:125], v[124:125], 1.0 op_sel:[0,0] op_sel_hi:[1,0]
    v_pk_add_f32 v[126:127], v[126:127], 1.0 op_sel:[0,0] op_sel_hi:[1,0]
    v_pk_add_f32 v[128:129], v[128:129], 1.0 op_sel:[0,0] op_sel_hi:[1,0]
    v_pk_add_f32 v[130:131], v[130:131], 1.0 op_sel:[0,0] op_sel_hi:[1,0]
    v_pk_add_f32 v[132:133], v[132:133], 1.0 op_sel:[0,0] op_sel_hi:[1,0]
    v_pk_add_f32 v[134:135], v[134:135], 1.0 op_sel:[0,0] op_sel_hi:[1,0]
    v_pk_add_f32 v[136:137], v[136:137], 1.0 op_sel:[0,0] op_sel_hi:[1,0]
    v_pk_add_f32 v[138:139], v[138:139], 1.0 op_sel:[0,0] op_sel_hi:[1,0]
    v_pk_add_f32 v[140:141], v[140:141], 1.0 op_sel:[0,0] op_sel_hi:[1,0]
    s_add_u32 m0, s89, 11264
    s_nop 0
    global_load_lds_dwordx4 v79, s[70:71]
    v_pk_add_f32 v[142:143], v[142:143], 1.0 op_sel:[0,0] op_sel_hi:[1,0]
    v_pk_add_f32 v[144:145], v[144:145], 1.0 op_sel:[0,0] op_sel_hi:[1,0]
    v_pk_add_f32 v[146:147], v[146:147], 1.0 op_sel:[0,0] op_sel_hi:[1,0]
    v_pk_add_f32 v[148:149], v[148:149], 1.0 op_sel:[0,0] op_sel_hi:[1,0]
    v_pk_add_f32 v[150:151], v[150:151], 1.0 op_sel:[0,0] op_sel_hi:[1,0]
    v_pk_add_f32 v[152:153], v[152:153], 1.0 op_sel:[0,0] op_sel_hi:[1,0]
    v_pk_add_f32 v[154:155], v[154:155], 1.0 op_sel:[0,0] op_sel_hi:[1,0]
    v_rcp_f32 v124, v124
    v_rcp_f32 v125, v125
    s_add_u32 m0, s89, 12288
    s_nop 0
    global_load_lds_dwordx4 v80, s[70:71]
    v_rcp_f32 v126, v126
    v_rcp_f32 v127, v127
    v_rcp_f32 v128, v128
    v_rcp_f32 v129, v129
    v_rcp_f32 v130, v130
    v_rcp_f32 v131, v131
    v_rcp_f32 v132, v132
    v_rcp_f32 v133, v133
    v_rcp_f32 v134, v134
    v_rcp_f32 v135, v135
    s_add_u32 m0, s89, 13312
    s_nop 0
    global_load_lds_dwordx4 v81, s[70:71]
    v_rcp_f32 v136, v136
    v_rcp_f32 v137, v137
    v_rcp_f32 v138, v138
    v_rcp_f32 v139, v139
    v_rcp_f32 v140, v140
    v_rcp_f32 v141, v141
    v_rcp_f32 v142, v142
    v_rcp_f32 v143, v143
    v_rcp_f32 v144, v144
    s_add_u32 m0, s89, 14336
    s_nop 0
    global_load_lds_dwordx4 v82, s[70:71]
    v_rcp_f32 v145, v145
    v_rcp_f32 v146, v146
    v_rcp_f32 v147, v147
    v_rcp_f32 v148, v148
    v_rcp_f32 v149, v149
    v_rcp_f32 v150, v150
    v_rcp_f32 v151, v151
    v_rcp_f32 v152, v152
    v_rcp_f32 v153, v153
    v_rcp_f32 v154, v154
    s_add_u32 m0, s89, 15360
    s_nop 0
    global_load_lds_dwordx4 v83, s[70:71]
    v_rcp_f32 v155, v155
    v_pk_mul_f32 v[180:181], v[180:181], v[124:125] op_sel:[0,0] op_sel_hi:[1,1]
    v_pk_mul_f32 v[182:183], v[182:183], v[126:127] op_sel:[0,0] op_sel_hi:[1,1]
    v_pk_mul_f32 v[184:185], v[184:185], v[128:129] op_sel:[0,0] op_sel_hi:[1,1]
    v_pk_mul_f32 v[186:187], v[186:187], v[130:131] op_sel:[0,0] op_sel_hi:[1,1]
    v_pk_mul_f32 v[188:189], v[188:189], v[132:133] op_sel:[0,0] op_sel_hi:[1,1]
    v_pk_mul_f32 v[190:191], v[190:191], v[134:135] op_sel:[0,0] op_sel_hi:[1,1]
    v_pk_mul_f32 v[192:193], v[192:193], v[136:137] op_sel:[0,0] op_sel_hi:[1,1]
    v_pk_mul_f32 v[194:195], v[194:195], v[138:139] op_sel:[0,0] op_sel_hi:[1,1]
    v_pk_mul_f32 v[196:197], v[196:197], v[140:141] op_sel:[0,0] op_sel_hi:[1,1]
    v_pk_mul_f32 v[198:199], v[198:199], v[142:143] op_sel:[0,0] op_sel_hi:[1,1]
    v_pk_mul_f32 v[200:201], v[200:201], v[144:145] op_sel:[0,0] op_sel_hi:[1,1]
    v_pk_mul_f32 v[202:203], v[202:203], v[146:147] op_sel:[0,0] op_sel_hi:[1,1]
    v_pk_mul_f32 v[204:205], v[204:205], v[148:149] op_sel:[0,0] op_sel_hi:[1,1]
    v_pk_mul_f32 v[206:207], v[206:207], v[150:151] op_sel:[0,0] op_sel_hi:[1,1]
    v_pk_mul_f32 v[208:209], v[208:209], v[152:153] op_sel:[0,0] op_sel_hi:[1,1]
    v_pk_mul_f32 v[210:211], v[210:211], v[154:155] op_sel:[0,0] op_sel_hi:[1,1]
    v_pk_add_f32 v[124:125], v[180:181], v[196:197] op_sel:[0,0] op_sel_hi:[1,1]
    v_pk_mul_f32 v[140:141], v[180:181], v[180:181] op_sel:[0,0] op_sel_hi:[1,1]
    v_pk_add_f32 v[126:127], v[182:183], v[198:199] op_sel:[0,0] op_sel_hi:[1,1]
    v_pk_mul_f32 v[142:143], v[182:183], v[182:183] op_sel:[0,0] op_sel_hi:[1,1]
    v_pk_add_f32 v[128:129], v[184:185], v[200:201] op_sel:[0,0] op_sel_hi:[1,1]
    v_pk_mul_f32 v[144:145], v[184:185], v[184:185] op_sel:[0,0] op_sel_hi:[1,1]
    v_pk_add_f32 v[130:131], v[186:187], v[202:203] op_sel:[0,0] op_sel_hi:[1,1]
    v_pk_mul_f32 v[146:147], v[186:187], v[186:187] op_sel:[0,0] op_sel_hi:[1,1]
    v_pk_add_f32 v[132:133], v[188:189], v[204:205] op_sel:[0,0] op_sel_hi:[1,1]
    v_pk_mul_f32 v[148:149], v[188:189], v[188:189] op_sel:[0,0] op_sel_hi:[1,1]
    v_pk_add_f32 v[134:135], v[190:191], v[206:207] op_sel:[0,0] op_sel_hi:[1,1]
    v_pk_mul_f32 v[150:151], v[190:191], v[190:191] op_sel:[0,0] op_sel_hi:[1,1]
    v_pk_add_f32 v[136:137], v[192:193], v[208:209] op_sel:[0,0] op_sel_hi:[1,1]
    v_pk_mul_f32 v[152:153], v[192:193], v[192:193] op_sel:[0,0] op_sel_hi:[1,1]
    v_pk_add_f32 v[138:139], v[194:195], v[210:211] op_sel:[0,0] op_sel_hi:[1,1]
    v_pk_mul_f32 v[154:155], v[194:195], v[194:195] op_sel:[0,0] op_sel_hi:[1,1]
    v_pk_fma_f32 v[140:141], v[196:197], v[196:197], v[140:141] op_sel:[0,0,0] op_sel_hi:[1,1,1]
    v_pk_fma_f32 v[142:143], v[198:199], v[198:199], v[142:143] op_sel:[0,0,0] op_sel_hi:[1,1,1]
    v_pk_fma_f32 v[144:145], v[200:201], v[200:201], v[144:145] op_sel:[0,0,0] op_sel_hi:[1,1,1]
    v_pk_fma_f32 v[146:147], v[202:203], v[202:203], v[146:147] op_sel:[0,0,0] op_sel_hi:[1,1,1]
    v_pk_fma_f32 v[148:149], v[204:205], v[204:205], v[148:149] op_sel:[0,0,0] op_sel_hi:[1,1,1]
    v_pk_fma_f32 v[150:151], v[206:207], v[206:207], v[150:151] op_sel:[0,0,0] op_sel_hi:[1,1,1]
    v_pk_fma_f32 v[152:153], v[208:209], v[208:209], v[152:153] op_sel:[0,0,0] op_sel_hi:[1,1,1]
    v_pk_fma_f32 v[154:155], v[210:211], v[210:211], v[154:155] op_sel:[0,0,0] op_sel_hi:[1,1,1]
    v_add_f32_dpp v92, v124, v124 row_ror:8 row_mask:0xf bank_mask:0x3
    v_add_f32_dpp v93, v125, v125 row_ror:8 row_mask:0xf bank_mask:0x3
    v_add_f32_dpp v94, v126, v126 row_ror:8 row_mask:0xf bank_mask:0x3
    v_add_f32_dpp v95, v127, v127 row_ror:8 row_mask:0xf bank_mask:0x3
    v_add_f32_dpp v96, v128, v128 row_ror:8 row_mask:0xf bank_mask:0x3
    v_add_f32_dpp v97, v129, v129 row_ror:8 row_mask:0xf bank_mask:0x3
    v_add_f32_dpp v98, v130, v130 row_ror:8 row_mask:0xf bank_mask:0x3
    v_add_f32_dpp v99, v131, v131 row_ror:8 row_mask:0xf bank_mask:0x3
    v_add_f32_dpp v100, v132, v132 row_ror:8 row_mask:0xf bank_mask:0x3
    v_add_f32_dpp v101, v133, v133 row_ror:8 row_mask:0xf bank_mask:0x3
    v_add_f32_dpp v102, v134, v134 row_ror:8 row_mask:0xf bank_mask:0x3
    v_add_f32_dpp v103, v135, v135 row_ror:8 row_mask:0xf bank_mask:0x3
    v_add_f32_dpp v104, v136, v136 row_ror:8 row_mask:0xf bank_mask:0x3
    v_add_f32_dpp v105, v137, v137 row_ror:8 row_mask:0xf bank_mask:0x3
    v_add_f32_dpp v106, v138, v138 row_ror:8 row_mask:0xf bank_mask:0x3
    v_add_f32_dpp v107, v139, v139 row_ror:8 row_mask:0xf bank_mask:0x3
    v_add_f32_dpp v92, v140, v140 row_ror:8 row_mask:0xf bank_mask:0xc
    v_add_f32_dpp v93, v141, v141 row_ror:8 row_mask:0xf bank_mask:0xc
    v_add_f32_dpp v94, v142, v142 row_ror:8 row_mask:0xf bank_mask:0xc
    v_add_f32_dpp v95, v143, v143 row_ror:8 row_mask:0xf bank_mask:0xc
    v_add_f32_dpp v96, v144, v144 row_ror:8 row_mask:0xf bank_mask:0xc
    v_add_f32_dpp v97, v145, v145 row_ror:8 row_mask:0xf bank_mask:0xc
    v_add_f32_dpp v98, v146, v146 row_ror:8 row_mask:0xf bank_mask:0xc
    v_add_f32_dpp v99, v147, v147 row_ror:8 row_mask:0xf bank_mask:0xc
    v_add_f32_dpp v100, v148, v148 row_ror:8 row_mask:0xf bank_mask:0xc
    v_add_f32_dpp v101, v149, v149 row_ror:8 row_mask:0xf bank_mask:0xc
    v_add_f32_dpp v102, v150, v150 row_ror:8 row_mask:0xf bank_mask:0xc
    v_add_f32_dpp v103, v151, v151 row_ror:8 row_mask:0xf bank_mask:0xc
    v_add_f32_dpp v104, v152, v152 row_ror:8 row_mask:0xf bank_mask:0xc
    v_add_f32_dpp v105, v153, v153 row_ror:8 row_mask:0xf bank_mask:0xc
    v_add_f32_dpp v106, v154, v154 row_ror:8 row_mask:0xf bank_mask:0xc
    v_add_f32_dpp v107, v155, v155 row_ror:8 row_mask:0xf bank_mask:0xc
    v_add_f32_dpp v124, v92, v92 row_half_mirror row_mask:0xf bank_mask:0x5
    v_add_f32_dpp v125, v93, v93 row_half_mirror row_mask:0xf bank_mask:0x5
    v_add_f32_dpp v126, v94, v94 row_half_mirror row_mask:0xf bank_mask:0x5
    v_add_f32_dpp v127, v95, v95 row_half_mirror row_mask:0xf bank_mask:0x5
    v_add_f32_dpp v128, v96, v96 row_half_mirror row_mask:0xf bank_mask:0x5
    v_add_f32_dpp v129, v97, v97 row_half_mirror row_mask:0xf bank_mask:0x5
    v_add_f32_dpp v130, v98, v98 row_half_mirror row_mask:0xf bank_mask:0x5
    v_add_f32_dpp v131, v99, v99 row_half_mirror row_mask:0xf bank_mask:0x5
    v_add_f32_dpp v124, v100, v100 row_half_mirror row_mask:0xf bank_mask:0xa
    v_add_f32_dpp v125, v101, v101 row_half_mirror row_mask:0xf bank_mask:0xa
    v_add_f32_dpp v126, v102, v102 row_half_mirror row_mask:0xf bank_mask:0xa
    v_add_f32_dpp v127, v103, v103 row_half_mirror row_mask:0xf bank_mask:0xa
    v_add_f32_dpp v128, v104, v104 row_half_mirror row_mask:0xf bank_mask:0xa
    v_add_f32_dpp v129, v105, v105 row_half_mirror row_mask:0xf bank_mask:0xa
    v_add_f32_dpp v130, v106, v106 row_half_mirror row_mask:0xf bank_mask:0xa
    v_add_f32_dpp v131, v107, v107 row_half_mirror row_mask:0xf bank_mask:0xa
    v_add_f32_dpp v124, v124, v124 quad_perm:[1,0,3,2] row_mask:0xf bank_mask:0xf
    v_add_f32_dpp v125, v125, v125 quad_perm:[1,0,3,2] row_mask:0xf bank_mask:0xf
    v_add_f32_dpp v126, v126, v126 quad_perm:[1,0,3,2] row_mask:0xf bank_mask:0xf
    v_add_f32_dpp v127, v127, v127 quad_perm:[1,0,3,2] row_mask:0xf bank_mask:0xf
    v_add_f32_dpp v128, v128, v128 quad_perm:[1,0,3,2] row_mask:0xf bank_mask:0xf
    v_add_f32_dpp v129, v129, v129 quad_perm:[1,0,3,2] row_mask:0xf bank_mask:0xf
    v_add_f32_dpp v130, v130, v130 quad_perm:[1,0,3,2] row_mask:0xf bank_mask:0xf
    v_add_f32_dpp v131, v131, v131 quad_perm:[1,0,3,2] row_mask:0xf bank_mask:0xf
    v_add_f32_dpp v124, v124, v124 quad_perm:[2,3,0,1] row_mask:0xf bank_mask:0xf
    v_add_f32_dpp v125, v125, v125 quad_perm:[2,3,0,1] row_mask:0xf bank_mask:0xf
    v_add_f32_dpp v126, v126, v126 quad_perm:[2,3,0,1] row_mask:0xf bank_mask:0xf
    v_add_f32_dpp v127, v127, v127 quad_perm:[2,3,0,1] row_mask:0xf bank_mask:0xf
    v_add_f32_dpp v128, v128, v128 quad_perm:[2,3,0,1] row_mask:0xf bank_mask:0xf
    v_add_f32_dpp v129, v129, v129 quad_perm:[2,3,0,1] row_mask:0xf bank_mask:0xf
    v_add_f32_dpp v130, v130, v130 quad_perm:[2,3,0,1] row_mask:0xf bank_mask:0xf
    v_add_f32_dpp v131, v131, v131 quad_perm:[2,3,0,1] row_mask:0xf bank_mask:0xf
    v_lshrrev_b32 v28, 2, v2
    v_lshlrev_b32 v28, 7, v28
    v_lshl_add_u32 v28, v3, 5, v28
    s_add_u32 s4, s88, 150784
    v_add_u32 v28, s4, v28
    ds_write_b128 v28, v[124:127]
    ds_write_b128 v28, v[128:131] offset:16
    s_waitcnt lgkmcnt(0)
    s_barrier
    v_lshlrev_b32 v28, 2, v1
    v_add_u32 v28, 150784, v28
    ds_read2st64_b32 v[172:173], v28 offset0:0 offset1:1
    ds_read2st64_b32 v[174:175], v28 offset0:2 offset1:3
    ds_read2st64_b32 v[176:177], v28 offset0:4 offset1:5
    ds_read2st64_b32 v[178:179], v28 offset0:6 offset1:7
    s_lshl_b32 s4, s40, 12
    s_add_u32 s4, s4, 65536
    v_add_u32 v169, s4, v30
    s_lshl_b32 s4, s41, 9
    v_add_u32 v28, s4, v169
    s_add_u32 s4, s88, 148736
    v_lshl_add_u32 v164, v1, 2, s4
    v_lshl_add_u32 v165, v3, 5, s4
    s_waitcnt lgkmcnt(2)
    v_pk_add_f32 v[172:173], v[172:173], v[174:175] op_sel:[0,0] op_sel_hi:[1,1]
    s_waitcnt lgkmcnt(0)
    v_pk_add_f32 v[176:177], v[176:177], v[178:179] op_sel:[0,0] op_sel_hi:[1,1]
    v_pk_add_f32 v[172:173], v[172:173], v[176:177] op_sel:[0,0] op_sel_hi:[1,1]
    v_min_u32 v172, -2, v172
    v_min_u32 v173, -2, v173
    s_lshl_b32 s4, s3, 4
    s_lshl_b64 exec, 0xffff, s4
    global_store_dwordx2 v28, v[172:173], s[38:39] sc1
    s_mov_b64 exec, -1
    ds_read_b128 v[48:51], v167 offset:0
    ds_read_b128 v[52:55], v167 offset:1040
    ds_read_b128 v[56:59], v167 offset:2080
    ds_read_b128 v[60:63], v167 offset:3120
    ds_read_b128 v[64:67], v167 offset:4160
    s_waitcnt vmcnt(56) lgkmcnt(4)
    v_mfma_f32_16x16x32_bf16 v[212:215], a[0:3], v[48:51], 0
    s_waitcnt vmcnt(9)
    ds_read_b128 a[160:163], v84 offset:0
    ds_read_b128 a[164:167], v86 offset:0
    ds_read_b128 v[68:71], v167 offset:5200
    v_mfma_f32_16x16x32_bf16 v[228:231], a[4:7], v[48:51], 0
    ds_read_b128 a[168:171], v88 offset:0
    ds_read_b128 a[172:175], v90 offset:0
    s_waitcnt lgkmcnt(8)
    v_mfma_f32_16x16x32_bf16 v[216:219], a[0:3], v[52:55], 0
    ds_read_b128 a[176:179], v85 offset:0
    ds_read_b128 v[48:51], v167 offset:6240
    v_mfma_f32_16x16x32_bf16 v[232:235], a[4:7], v[52:55], 0
    ds_read_b128 a[180:183], v87 offset:0
    ds_read_b128 a[184:187], v89 offset:0
    s_waitcnt lgkmcnt(11)
    v_mfma_f32_16x16x32_bf16 v[220:223], a[0:3], v[56:59], 0
    ds_read_b128 a[188:191], v91 offset:0
    ds_read_b128 v[52:55], v167 offset:7280
    v_mfma_f32_16x16x32_bf16 v[236:239], a[4:7], v[56:59], 0
    s_waitcnt lgkmcnt(1)
    s_add_u32 m0, s89, 0
    s_nop 0
    global_load_lds_dwordx4 v76, s[72:73]
    s_add_u32 m0, s89, 1024
    s_nop 0
    global_load_lds_dwordx4 v77, s[72:73]
    v_mfma_f32_16x16x32_bf16 v[224:227], a[0:3], v[60:63], 0
    s_add_u32 m0, s89, 2048
    s_nop 0
    global_load_lds_dwordx4 v78, s[72:73]
    s_add_u32 m0, s89, 3072
    s_nop 0
    global_load_lds_dwordx4 v79, s[72:73]
    ds_read_b128 v[56:59], v167 offset:8320
    v_mfma_f32_16x16x32_bf16 v[240:243], a[4:7], v[60:63], 0
    s_add_u32 m0, s89, 4096
    s_nop 0
    global_load_lds_dwordx4 v80, s[72:73]
    v_mfma_f32_16x16x32_bf16 v[212:215], a[8:11], v[64:67], v[212:215]
    s_add_u32 m0, s89, 5120
    s_nop 0
    global_load_lds_dwordx4 v81, s[72:73]
    s_add_u32 m0, s89, 6144
    s_nop 0
    global_load_lds_dwordx4 v82, s[72:73]
    ds_read_b128 v[60:63], v167 offset:9360
    v_mfma_f32_16x16x32_bf16 v[228:231], a[12:15], v[64:67], v[228:231]
    s_add_u32 m0, s89, 7168
    s_nop 0
    global_load_lds_dwordx4 v83, s[72:73]
    v_mfma_f32_16x16x32_bf16 v[216:219], a[8:11], v[68:71], v[216:219]
    s_waitcnt vmcnt(9)
    ds_read_b128 a[192:195], v84 offset:8192
    ds_read_b128 v[64:67], v167 offset:10400
    v_mfma_f32_16x16x32_bf16 v[232:235], a[12:15], v[68:71], v[232:235]
    ds_read_b128 a[196:199], v86 offset:8192
    v_mfma_f32_16x16x32_bf16 v[220:223], a[8:11], v[48:51], v[220:223]
    ds_read_b128 v[68:71], v167 offset:11440
    v_mfma_f32_16x16x32_bf16 v[236:239], a[12:15], v[48:51], v[236:239]
    ds_read_b128 a[200:203], v88 offset:8192
    s_waitcnt lgkmcnt(7)
    v_mfma_f32_16x16x32_bf16 v[224:227], a[8:11], v[52:55], v[224:227]
    ds_read_b128 v[48:51], v167 offset:12480
    v_mfma_f32_16x16x32_bf16 v[240:243], a[12:15], v[52:55], v[240:243]
    ds_read_b128 a[204:207], v90 offset:8192
    s_waitcnt lgkmcnt(8)
    v_mfma_f32_16x16x32_bf16 v[212:215], a[16:19], v[56:59], v[212:215]
    ds_read_b128 v[52:55], v167 offset:13520
    v_mfma_f32_16x16x32_bf16 v[228:231], a[20:23], v[56:59], v[228:231]
    ds_read_b128 a[208:211], v85 offset:8192
    s_waitcnt lgkmcnt(9)
    v_mfma_f32_16x16x32_bf16 v[216:219], a[16:19], v[60:63], v[216:219]
    ds_read_b128 v[56:59], v167 offset:14560
    v_mfma_f32_16x16x32_bf16 v[232:235], a[20:23], v[60:63], v[232:235]
    ds_read_b128 a[212:215], v87 offset:8192
    s_waitcnt lgkmcnt(9)
    v_mfma_f32_16x16x32_bf16 v[220:223], a[16:19], v[64:67], v[220:223]
    s_mul_i32 s5, s41, 10
    s_mul_i32 s6, s3, 1040
    v_add_u32 v28, s5, v3
    ds_read_b128 v[60:63], v167 offset:15600
    v_mfma_f32_16x16x32_bf16 v[236:239], a[20:23], v[64:67], v[236:239]
    ds_read_b128 a[216:219], v89 offset:8192
    s_waitcnt lgkmcnt(9)
    v_mfma_f32_16x16x32_bf16 v[224:227], a[16:19], v[68:71], v[224:227]
    ds_read_b128 v[64:67], v167 offset:16640
    v_mfma_f32_16x16x32_bf16 v[240:243], a[20:23], v[68:71], v[240:243]
    ds_read_b128 a[220:223], v91 offset:8192
    s_waitcnt lgkmcnt(9)
    v_mfma_f32_16x16x32_bf16 v[212:215], a[24:27], v[48:51], v[212:215]
    s_add_u32 s5, s5, 4
    v_lshrrev_b32 v29, 2, v28
    ds_read_b128 v[68:71], v167 offset:17680
    v_mfma_f32_16x16x32_bf16 v[228:231], a[28:31], v[48:51], v[228:231]
    s_waitcnt lgkmcnt(1)
    s_add_u32 m0, s89, 8192
    s_nop 0
    global_load_lds_dwordx4 v76, s[74:75]
    v_mfma_f32_16x16x32_bf16 v[216:219], a[24:27], v[52:55], v[216:219]
    s_add_u32 m0, s89, 9216
    s_nop 0
    global_load_lds_dwordx4 v77, s[74:75]
    ds_read_b128 v[48:51], v167 offset:18720
    v_mfma_f32_16x16x32_bf16 v[232:235], a[28:31], v[52:55], v[232:235]
    v_mfma_f32_16x16x32_bf16 v[220:223], a[24:27], v[56:59], v[220:223]
    s_add_u32 m0, s89, 10240
    s_nop 0
    global_load_lds_dwordx4 v78, s[74:75]
    v_mul_u32_u24 v29, 4160, v29
    ds_read_b128 v[52:55], v167 offset:19760
    v_mfma_f32_16x16x32_bf16 v[236:239], a[28:31], v[56:59], v[236:239]
    v_mfma_f32_16x16x32_bf16 v[224:227], a[24:27], v[60:63], v[224:227]
    s_add_u32 m0, s89, 11264
    s_nop 0
    global_load_lds_dwordx4 v79, s[74:75]
    ds_read_b128 v[56:59], v167 offset:20800
    v_mfma_f32_16x16x32_bf16 v[240:243], a[28:31], v[60:63], v[240:243]
    v_mfma_f32_16x16x32_bf16 v[212:215], a[32:35], v[64:67], v[212:215]
    s_add_u32 m0, s89, 12288
    s_nop 0
    global_load_lds_dwordx4 v80, s[74:75]
    v_and_b32 v28, 3, v28
    ds_read_b128 v[60:63], v167 offset:21840
    v_mfma_f32_16x16x32_bf16 v[228:231], a[36:39], v[64:67], v[228:231]
    s_waitcnt lgkmcnt(4)
    v_mfma_f32_16x16x32_bf16 v[216:219], a[32:35], v[68:71], v[216:219]
    s_add_u32 m0, s89, 13312
    s_nop 0
    global_load_lds_dwordx4 v81, s[74:75]
    ds_read_b128 v[64:67], v167 offset:22880
    v_mfma_f32_16x16x32_bf16 v[232:235], a[36:39], v[68:71], v[232:235]
    s_waitcnt lgkmcnt(4)
    v_mfma_f32_16x16x32_bf16 v[220:223], a[32:35], v[48:51], v[220:223]
    s_add_u32 m0, s89, 14336
    s_nop 0
    global_load_lds_dwordx4 v82, s[74:75]
    v_lshl_add_u32 v29, v28, 8, v29
    ds_read_b128 v[68:71], v167 offset:23920
    v_mfma_f32_16x16x32_bf16 v[236:239], a[36:39], v[48:51], v[236:239]
    s_waitcnt lgkmcnt(4)
    v_mfma_f32_16x16x32_bf16 v[224:227], a[32:35], v[52:55], v[224:227]
    s_add_u32 m0, s89, 15360
    s_nop 0
    global_load_lds_dwordx4 v83, s[74:75]
    ds_read_b128 v[48:51], v167 offset:24960
    v_mfma_f32_16x16x32_bf16 v[240:243], a[36:39], v[52:55], v[240:243]
    s_waitcnt lgkmcnt(4)
    v_mfma_f32_16x16x32_bf16 v[212:215], a[40:43], v[56:59], v[212:215]
    s_waitcnt vmcnt(8)
    ds_read_b128 a[224:227], v84 offset:0
    v_lshl_add_u32 v29, v2, 4, v29
    ds_read_b128 v[52:55], v167 offset:26000
    v_mfma_f32_16x16x32_bf16 v[228:231], a[44:47], v[56:59], v[228:231]
    ds_read_b128 a[228:231], v86 offset:0
    s_waitcnt lgkmcnt(6)
    v_mfma_f32_16x16x32_bf16 v[216:219], a[40:43], v[60:63], v[216:219]
    ds_read_b128 a[232:235], v88 offset:0
    ds_read_b128 v[56:59], v167 offset:27040
    v_mfma_f32_16x16x32_bf16 v[232:235], a[44:47], v[60:63], v[232:235]
    s_waitcnt lgkmcnt(7)
    v_mfma_f32_16x16x32_bf16 v[220:223], a[40:43], v[64:67], v[220:223]
    ds_read_b128 a[236:239], v90 offset:0
    v_add_u32 v29, s6, v29
    ds_read_b128 v[60:63], v167 offset:28080
    v_mfma_f32_16x16x32_bf16 v[236:239], a[44:47], v[64:67], v[236:239]
    ds_read_b128 a[240:243], v85 offset:0
    s_waitcnt lgkmcnt(9)
    v_mfma_f32_16x16x32_bf16 v[224:227], a[40:43], v[68:71], v[224:227]
    ds_read_b128 a[244:247], v87 offset:0
    ds_read_b128 v[64:67], v167 offset:29120
    v_mfma_f32_16x16x32_bf16 v[240:243], a[44:47], v[68:71], v[240:243]
    s_waitcnt lgkmcnt(10)
    v_mfma_f32_16x16x32_bf16 v[212:215], a[48:51], v[48:51], v[212:215]
    ds_read_b128 a[248:251], v89 offset:0
    ds_read_b128 v[36:39], v29 offset:0
    ds_read_b128 v[68:71], v167 offset:30160
    v_mfma_f32_16x16x32_bf16 v[228:231], a[52:55], v[48:51], v[228:231]
    ds_read_b128 a[252:255], v91 offset:0
    s_waitcnt lgkmcnt(12)
    v_mfma_f32_16x16x32_bf16 v[216:219], a[48:51], v[52:55], v[216:219]
    ds_read_b128 v[48:51], v167 offset:31200
    v_mfma_f32_16x16x32_bf16 v[232:235], a[52:55], v[52:55], v[232:235]
    s_waitcnt lgkmcnt(1)
    s_add_u32 m0, s89, 0
    s_nop 0
    global_load_lds_dwordx4 v76, s[76:77]
    v_mfma_f32_16x16x32_bf16 v[220:223], a[48:51], v[56:59], v[220:223]
    s_add_u32 m0, s89, 1024
    s_nop 0
    global_load_lds_dwordx4 v77, s[76:77]
    v_add_u32 v28, s5, v3
    ds_read_b128 v[52:55], v167 offset:32240
    v_mfma_f32_16x16x32_bf16 v[236:239], a[52:55], v[56:59], v[236:239]
    s_add_u32 m0, s89, 2048
    s_nop 0
    global_load_lds_dwordx4 v78, s[76:77]
    v_mfma_f32_16x16x32_bf16 v[224:227], a[48:51], v[60:63], v[224:227]
    ds_read_b128 v[56:59], v167 offset:33280
    v_mfma_f32_16x16x32_bf16 v[240:243], a[52:55], v[60:63], v[240:243]
    s_add_u32 m0, s89, 3072
    s_nop 0
    global_load_lds_dwordx4 v79, s[76:77]
    v_mfma_f32_16x16x32_bf16 v[212:215], a[56:59], v[64:67], v[212:215]
    s_add_u32 m0, s89, 4096
    s_nop 0
    global_load_lds_dwordx4 v80, s[76:77]
    ds_read_b128 v[60:63], v167 offset:34320
    v_mfma_f32_16x16x32_bf16 v[228:231], a[60:63], v[64:67], v[228:231]
    s_add_u32 m0, s89, 5120
    s_nop 0
    global_load_lds_dwordx4 v81, s[76:77]
    s_add_u32 s5, s5, 4
    v_lshrrev_b32 v29, 2, v28
    v_mfma_f32_16x16x32_bf16 v[216:219], a[56:59], v[68:71], v[216:219]
    ds_read_b128 v[64:67], v167 offset:35360
    v_mfma_f32_16x16x32_bf16 v[232:235], a[60:63], v[68:71], v[232:235]
    s_add_u32 m0, s89, 6144
    s_nop 0
    global_load_lds_dwordx4 v82, s[76:77]
    s_waitcnt lgkmcnt(4)
    v_mfma_f32_16x16x32_bf16 v[220:223], a[56:59], v[48:51], v[220:223]
    s_add_u32 m0, s89, 7168
    s_nop 0
    global_load_lds_dwordx4 v83, s[76:77]
    ds_read_b128 v[68:71], v167 offset:36400
    v_mfma_f32_16x16x32_bf16 v[236:239], a[60:63], v[48:51], v[236:239]
    v_mul_u32_u24 v29, 4160, v29
    s_waitcnt lgkmcnt(4)
    v_mfma_f32_16x16x32_bf16 v[224:227], a[56:59], v[52:55], v[224:227]
    s_waitcnt vmcnt(8)
    ds_read_b128 a[0:3], v84 offset:8192
    ds_read_b128 v[48:51], v167 offset:37440
    v_mfma_f32_16x16x32_bf16 v[240:243], a[60:63], v[52:55], v[240:243]
    ds_read_b128 a[4:7], v86 offset:8192
    s_waitcnt lgkmcnt(6)
    v_mfma_f32_16x16x32_bf16 v[212:215], a[64:67], v[56:59], v[212:215]
    ds_read_b128 a[8:11], v88 offset:8192
    ds_read_b128 v[52:55], v167 offset:38480
    v_mfma_f32_16x16x32_bf16 v[228:231], a[68:71], v[56:59], v[228:231]
    v_and_b32 v28, 3, v28
    s_waitcnt lgkmcnt(7)
    v_mfma_f32_16x16x32_bf16 v[216:219], a[64:67], v[60:63], v[216:219]
    ds_read_b128 a[12:15], v90 offset:8192
    ds_read_b128 v[56:59], v167 offset:39520
    v_mfma_f32_16x16x32_bf16 v[232:235], a[68:71], v[60:63], v[232:235]
    ds_read_b128 a[16:19], v85 offset:8192
    s_waitcnt lgkmcnt(9)
    v_mfma_f32_16x16x32_bf16 v[220:223], a[64:67], v[64:67], v[220:223]
    ds_read_b128 a[20:23], v87 offset:8192
    ds_read_b128 v[60:63], v167 offset:40560
    v_mfma_f32_16x16x32_bf16 v[236:239], a[68:71], v[64:67], v[236:239]
    v_lshl_add_u32 v29, v28, 8, v29
    s_waitcnt lgkmcnt(10)
    v_mfma_f32_16x16x32_bf16 v[224:227], a[64:67], v[68:71], v[224:227]
    ds_read_b128 a[24:27], v89 offset:8192
    ds_read_b128 v[64:67], v168 offset:0
    v_mfma_f32_16x16x32_bf16 v[240:243], a[68:71], v[68:71], v[240:243]
    ds_read_b128 a[28:31], v91 offset:8192
    s_waitcnt lgkmcnt(11)
    v_mfma_f32_16x16x32_bf16 v[212:215], a[72:75], v[48:51], v[212:215]
    ds_read_b128 v[68:71], v168 offset:1040
    v_mfma_f32_16x16x32_bf16 v[228:231], a[76:79], v[48:51], v[228:231]
    s_waitcnt lgkmcnt(1)
    s_add_u32 m0, s89, 8192
    s_nop 0
    global_load_lds_dwordx4 v76, s[78:79]
    v_lshl_add_u32 v29, v2, 4, v29
    v_mfma_f32_16x16x32_bf16 v[216:219], a[72:75], v[52:55], v[216:219]
    s_add_u32 m0, s89, 9216
    s_nop 0
    global_load_lds_dwordx4 v77, s[78:79]
    ds_read_b128 v[48:51], v168 offset:2080
    v_mfma_f32_16x16x32_bf16 v[232:235], a[76:79], v[52:55], v[232:235]
    s_add_u32 m0, s89, 10240
    s_nop 0
    global_load_lds_dwordx4 v78, s[78:79]
    v_mfma_f32_16x16x32_bf16 v[220:223], a[72:75], v[56:59], v[220:223]
    ds_read_b128 v[52:55], v168 offset:3120
    v_mfma_f32_16x16x32_bf16 v[236:239], a[76:79], v[56:59], v[236:239]
    s_add_u32 m0, s89, 11264
    s_nop 0
    global_load_lds_dwordx4 v79, s[78:79]
    v_add_u32 v29, s6, v29
    v_mfma_f32_16x16x32_bf16 v[224:227], a[72:75], v[60:63], v[224:227]
    s_add_u32 m0, s89, 12288
    s_nop 0
    global_load_lds_dwordx4 v80, s[78:79]
    ds_read_b128 v[56:59], v168 offset:4160
    v_mfma_f32_16x16x32_bf16 v[240:243], a[76:79], v[60:63], v[240:243]
    s_add_u32 m0, s89, 13312
    s_nop 0
    global_load_lds_dwordx4 v81, s[78:79]
    v_mfma_f32_16x16x32_bf16 v[212:215], a[80:83], v[64:67], v[212:215]
    ds_read_b128 v[60:63], v168 offset:5200
    v_mfma_f32_16x16x32_bf16 v[228:231], a[84:87], v[64:67], v[228:231]
    s_add_u32 m0, s89, 14336
    s_nop 0
    global_load_lds_dwordx4 v82, s[78:79]
    ds_read_b128 v[40:43], v29 offset:0
    s_waitcnt lgkmcnt(5)
    v_mfma_f32_16x16x32_bf16 v[216:219], a[80:83], v[68:71], v[216:219]
    s_add_u32 m0, s89, 15360
    s_nop 0
    global_load_lds_dwordx4 v83, s[78:79]
    ds_read_b128 v[64:67], v168 offset:6240
    v_mfma_f32_16x16x32_bf16 v[232:235], a[84:87], v[68:71], v[232:235]
    s_waitcnt lgkmcnt(5)
    v_mfma_f32_16x16x32_bf16 v[220:223], a[80:83], v[48:51], v[220:223]
    s_waitcnt vmcnt(8)
    ds_read_b128 a[32:35], v84 offset:0
    ds_read_b128 v[68:71], v168 offset:7280
    v_mfma_f32_16x16x32_bf16 v[236:239], a[84:87], v[48:51], v[236:239]
    ds_read_b128 a[36:39], v86 offset:0
    v_lshrrev_b32 v28, 1, v3
    s_waitcnt lgkmcnt(7)
    v_mfma_f32_16x16x32_bf16 v[224:227], a[80:83], v[52:55], v[224:227]
    ds_read_b128 a[40:43], v88 offset:0
    ds_read_b128 v[48:51], v168 offset:8320
    v_mfma_f32_16x16x32_bf16 v[240:243], a[84:87], v[52:55], v[240:243]
    s_waitcnt lgkmcnt(8)
    v_mfma_f32_16x16x32_bf16 v[212:215], a[88:91], v[56:59], v[212:215]
    ds_read_b128 a[44:47], v90 offset:0
    ds_read_b128 v[52:55], v168 offset:9360
    v_mfma_f32_16x16x32_bf16 v[228:231], a[92:95], v[56:59], v[228:231]
    ds_read_b128 a[48:51], v85 offset:0
    v_add_u32 v28, s5, v28
    s_waitcnt lgkmcnt(10)
    v_mfma_f32_16x16x32_bf16 v[216:219], a[88:91], v[60:63], v[216:219]
    ds_read_b128 a[52:55], v87 offset:0
    ds_read_b128 v[56:59], v168 offset:10400
    v_mfma_f32_16x16x32_bf16 v[232:235], a[92:95], v[60:63], v[232:235]
    s_waitcnt lgkmcnt(10)
    v_mfma_f32_16x16x32_bf16 v[220:223], a[88:91], v[64:67], v[220:223]
    ds_read_b128 a[56:59], v89 offset:0
    ds_read_b128 v[60:63], v168 offset:11440
    v_mfma_f32_16x16x32_bf16 v[236:239], a[92:95], v[64:67], v[236:239]
    ds_read_b128 a[60:63], v91 offset:0
    s_waitcnt lgkmcnt(11)
    v_mfma_f32_16x16x32_bf16 v[224:227], a[88:91], v[68:71], v[224:227]
    s_add_u32 s5, s5, 4
    v_lshrrev_b32 v29, 2, v28
    ds_read_b128 v[64:67], v168 offset:12480
    v_mfma_f32_16x16x32_bf16 v[240:243], a[92:95], v[68:71], v[240:243]
    s_waitcnt lgkmcnt(1)
    s_add_u32 m0, s89, 0
    s_nop 0
    global_load_lds_dwordx4 v76, s[80:81]
    v_mfma_f32_16x16x32_bf16 v[212:215], a[96:99], v[48:51], v[212:215]
    s_add_u32 m0, s89, 1024
    s_nop 0
    global_load_lds_dwordx4 v77, s[80:81]
    ds_read_b128 v[68:71], v168 offset:13520
    v_mfma_f32_16x16x32_bf16 v[228:231], a[100:103], v[48:51], v[228:231]
    s_add_u32 m0, s89, 2048
    s_nop 0
    global_load_lds_dwordx4 v78, s[80:81]
    v_mfma_f32_16x16x32_bf16 v[216:219], a[96:99], v[52:55], v[216:219]
    v_mul_u32_u24 v29, 4160, v29
    ds_read_b128 v[48:51], v168 offset:14560
    v_mfma_f32_16x16x32_bf16 v[232:235], a[100:103], v[52:55], v[232:235]
    s_add_u32 m0, s89, 3072
    s_nop 0
    global_load_lds_dwordx4 v79, s[80:81]
    v_mfma_f32_16x16x32_bf16 v[220:223], a[96:99], v[56:59], v[220:223]
    s_add_u32 m0, s89, 4096
    s_nop 0
    global_load_lds_dwordx4 v80, s[80:81]
    ds_read_b128 v[52:55], v168 offset:15600
    v_mfma_f32_16x16x32_bf16 v[236:239], a[100:103], v[56:59], v[236:239]
    s_add_u32 m0, s89, 5120
    s_nop 0
    global_load_lds_dwordx4 v81, s[80:81]
    v_mfma_f32_16x16x32_bf16 v[224:227], a[96:99], v[60:63], v[224:227]
    v_and_b32 v28, 3, v28
    ds_read_b128 v[56:59], v168 offset:16640
    v_mfma_f32_16x16x32_bf16 v[240:243], a[100:103], v[60:63], v[240:243]
    s_add_u32 m0, s89, 6144
    s_nop 0
    global_load_lds_dwordx4 v82, s[80:81]
    s_waitcnt lgkmcnt(4)
    v_mfma_f32_16x16x32_bf16 v[212:215], a[104:107], v[64:67], v[212:215]
    s_add_u32 m0, s89, 7168
    s_nop 0
    global_load_lds_dwordx4 v83, s[80:81]
    ds_read_b128 v[60:63], v168 offset:17680
    v_mfma_f32_16x16x32_bf16 v[228:231], a[108:111], v[64:67], v[228:231]
    s_waitcnt lgkmcnt(4)
    v_mfma_f32_16x16x32_bf16 v[216:219], a[104:107], v[68:71], v[216:219]
    s_waitcnt vmcnt(8)
    ds_read_b128 a[64:67], v84 offset:8192
    v_lshl_add_u32 v29, v28, 8, v29
    ds_read_b128 v[64:67], v168 offset:18720
    v_mfma_f32_16x16x32_bf16 v[232:235], a[108:111], v[68:71], v[232:235]
    ds_read_b128 a[68:71], v86 offset:8192
    s_waitcnt lgkmcnt(6)
    v_mfma_f32_16x16x32_bf16 v[220:223], a[104:107], v[48:51], v[220:223]
    ds_read_b128 v[68:71], v168 offset:19760
    v_mfma_f32_16x16x32_bf16 v[236:239], a[108:111], v[48:51], v[236:239]
    ds_read_b128 a[72:75], v88 offset:8192
    s_waitcnt lgkmcnt(7)
    v_mfma_f32_16x16x32_bf16 v[224:227], a[104:107], v[52:55], v[224:227]
    v_lshl_add_u32 v29, v2, 4, v29
    ds_read_b128 v[48:51], v168 offset:20800
    v_mfma_f32_16x16x32_bf16 v[240:243], a[108:111], v[52:55], v[240:243]
    ds_read_b128 a[76:79], v90 offset:8192
    s_waitcnt lgkmcnt(8)
    v_mfma_f32_16x16x32_bf16 v[212:215], a[112:115], v[56:59], v[212:215]
    ds_read_b128 v[52:55], v168 offset:21840
    v_mfma_f32_16x16x32_bf16 v[228:231], a[116:119], v[56:59], v[228:231]
    ds_read_b128 a[80:83], v85 offset:8192
    s_waitcnt lgkmcnt(9)
    v_mfma_f32_16x16x32_bf16 v[216:219], a[112:115], v[60:63], v[216:219]
    ds_read_b128 a[84:87], v87 offset:8192
    v_add_u32 v29, s6, v29
    ds_read_b128 v[56:59], v168 offset:22880
    v_mfma_f32_16x16x32_bf16 v[232:235], a[116:119], v[60:63], v[232:235]
    s_waitcnt lgkmcnt(9)
    v_mfma_f32_16x16x32_bf16 v[220:223], a[112:115], v[64:67], v[220:223]
    ds_read_b128 a[88:91], v89 offset:8192
    ds_read_b128 v[60:63], v168 offset:23920
    v_mfma_f32_16x16x32_bf16 v[236:239], a[116:119], v[64:67], v[236:239]
    s_waitcnt lgkmcnt(9)
    v_mfma_f32_16x16x32_bf16 v[224:227], a[112:115], v[68:71], v[224:227]
    ds_read_b128 a[92:95], v91 offset:8192
    v_and_b32 v28, 1, v3
    ds_read_b128 v[64:67], v168 offset:24960
    v_mfma_f32_16x16x32_bf16 v[240:243], a[116:119], v[68:71], v[240:243]
    s_waitcnt lgkmcnt(9)
    v_mfma_f32_16x16x32_bf16 v[212:215], a[120:123], v[48:51], v[212:215]
    s_waitcnt lgkmcnt(1)
    s_add_u32 m0, s89, 8192
    s_nop 0
    global_load_lds_dwordx4 v76, s[82:83]
    ds_read_b128 v[68:71], v168 offset:26000
    v_mfma_f32_16x16x32_bf16 v[228:231], a[124:127], v[48:51], v[228:231]
    s_add_u32 m0, s89, 9216
    s_nop 0
    global_load_lds_dwordx4 v77, s[82:83]
    v_mfma_f32_16x16x32_bf16 v[216:219], a[120:123], v[52:55], v[216:219]
    v_lshl_add_u32 v29, v28, 3, v29
    ds_read_b128 v[48:51], v168 offset:27040
    v_mfma_f32_16x16x32_bf16 v[232:235], a[124:127], v[52:55], v[232:235]
    s_add_u32 m0, s89, 10240
    s_nop 0
    global_load_lds_dwordx4 v78, s[82:83]
    v_mfma_f32_16x16x32_bf16 v[220:223], a[120:123], v[56:59], v[220:223]
    ds_read_b128 v[52:55], v168 offset:28080
    v_mfma_f32_16x16x32_bf16 v[236:239], a[124:127], v[56:59], v[236:239]
    s_add_u32 m0, s89, 11264
    s_nop 0
    global_load_lds_dwordx4 v79, s[82:83]
    v_mfma_f32_16x16x32_bf16 v[224:227], a[120:123], v[60:63], v[224:227]
    ds_read_b64 v[44:45], v29 offset:0
    ds_read_b128 v[56:59], v168 offset:29120
    v_mfma_f32_16x16x32_bf16 v[240:243], a[124:127], v[60:63], v[240:243]
    s_add_u32 m0, s89, 12288
    s_nop 0
    global_load_lds_dwordx4 v80, s[82:83]
    s_waitcnt lgkmcnt(5)
    v_mfma_f32_16x16x32_bf16 v[212:215], a[128:131], v[64:67], v[212:215]
    s_add_u32 m0, s89, 13312
    s_nop 0
    global_load_lds_dwordx4 v81, s[82:83]
    ds_read_b128 v[60:63], v168 offset:30160
    v_mfma_f32_16x16x32_bf16 v[228:231], a[132:135], v[64:67], v[228:231]
    s_waitcnt lgkmcnt(5)
    v_mfma_f32_16x16x32_bf16 v[216:219], a[128:131], v[68:71], v[216:219]
    s_add_u32 m0, s89, 14336
    s_nop 0
    global_load_lds_dwordx4 v82, s[82:83]
    ds_read_b128 v[64:67], v168 offset:31200
    v_mfma_f32_16x16x32_bf16 v[232:235], a[132:135], v[68:71], v[232:235]
    s_waitcnt lgkmcnt(5)
    v_mfma_f32_16x16x32_bf16 v[220:223], a[128:131], v[48:51], v[220:223]
    s_add_u32 m0, s89, 15360
    s_nop 0
    global_load_lds_dwordx4 v83, s[82:83]
    ds_read_b128 v[68:71], v168 offset:32240
    v_mfma_f32_16x16x32_bf16 v[236:239], a[132:135], v[48:51], v[236:239]
    s_waitcnt lgkmcnt(5)
    v_mfma_f32_16x16x32_bf16 v[224:227], a[128:131], v[52:55], v[224:227]
    s_waitcnt vmcnt(8)
    ds_read_b128 a[96:99], v84 offset:0
    ds_read_b128 v[48:51], v168 offset:33280
    v_mfma_f32_16x16x32_bf16 v[240:243], a[132:135], v[52:55], v[240:243]
    s_waitcnt lgkmcnt(5)
    v_mfma_f32_16x16x32_bf16 v[212:215], a[136:139], v[56:59], v[212:215]
    ds_read_b128 a[100:103], v86 offset:0
    ds_read_b128 v[52:55], v168 offset:34320
    v_mfma_f32_16x16x32_bf16 v[228:231], a[140:143], v[56:59], v[228:231]
    s_waitcnt lgkmcnt(6)
    v_mfma_f32_16x16x32_bf16 v[216:219], a[136:139], v[60:63], v[216:219]
    ds_read_b128 a[104:107], v88 offset:0
    ds_read_b128 v[56:59], v168 offset:35360
    v_mfma_f32_16x16x32_bf16 v[232:235], a[140:143], v[60:63], v[232:235]
    s_waitcnt lgkmcnt(7)
    v_mfma_f32_16x16x32_bf16 v[220:223], a[136:139], v[64:67], v[220:223]
    ds_read_b128 a[108:111], v90 offset:0
    global_load_dwordx2 v[124:125], v169, s[38:39] offset:0 sc1
    ds_read_b128 v[60:63], v168 offset:36400
    v_mfma_f32_16x16x32_bf16 v[236:239], a[140:143], v[64:67], v[236:239]
    global_load_dwordx2 v[126:127], v169, s[38:39] offset:512 sc1
    s_waitcnt lgkmcnt(8)
    v_mfma_f32_16x16x32_bf16 v[224:227], a[136:139], v[68:71], v[224:227]
    ds_read_b128 a[112:115], v85 offset:0
    global_load_dwordx2 v[128:129], v169, s[38:39] offset:1024 sc1
    ds_read_b128 v[64:67], v168 offset:37440
    v_mfma_f32_16x16x32_bf16 v[240:243], a[140:143], v[68:71], v[240:243]
    s_waitcnt lgkmcnt(8)
    v_mfma_f32_16x16x32_bf16 v[212:215], a[144:147], v[48:51], v[212:215]
    ds_read_b128 a[116:119], v87 offset:0
    global_load_dwordx2 v[130:131], v169, s[38:39] offset:1536 sc1
    ds_read_b128 v[68:71], v168 offset:38480
    v_mfma_f32_16x16x32_bf16 v[228:231], a[148:151], v[48:51], v[228:231]
    global_load_dwordx2 v[132:133], v169, s[38:39] offset:2048 sc1
    s_waitcnt lgkmcnt(8)
    v_mfma_f32_16x16x32_bf16 v[216:219], a[144:147], v[52:55], v[216:219]
    ds_read_b128 a[120:123], v89 offset:0
    global_load_dwordx2 v[134:135], v169, s[38:39] offset:2560 sc1
    ds_read_b128 v[48:51], v168 offset:39520
    v_mfma_f32_16x16x32_bf16 v[232:235], a[148:151], v[52:55], v[232:235]
    s_waitcnt lgkmcnt(8)
    v_mfma_f32_16x16x32_bf16 v[220:223], a[144:147], v[56:59], v[220:223]
    ds_read_b128 a[124:127], v91 offset:0
    global_load_dwordx2 v[136:137], v169, s[38:39] offset:3072 sc1
    ds_read_b128 v[52:55], v168 offset:40560
    v_mfma_f32_16x16x32_bf16 v[236:239], a[148:151], v[56:59], v[236:239]
    global_load_dwordx2 v[138:139], v169, s[38:39] offset:3584 sc1
    s_waitcnt lgkmcnt(8)
    v_mfma_f32_16x16x32_bf16 v[224:227], a[144:147], v[60:63], v[224:227]
    v_mfma_f32_16x16x32_bf16 v[240:243], a[148:151], v[60:63], v[240:243]
    s_waitcnt lgkmcnt(6)
    v_mfma_f32_16x16x32_bf16 v[212:215], a[152:155], v[64:67], v[212:215]
    v_mfma_f32_16x16x32_bf16 v[228:231], a[156:159], v[64:67], v[228:231]
    s_waitcnt lgkmcnt(4)
    v_mfma_f32_16x16x32_bf16 v[216:219], a[152:155], v[68:71], v[216:219]
    v_mfma_f32_16x16x32_bf16 v[232:235], a[156:159], v[68:71], v[232:235]
    s_waitcnt lgkmcnt(2)
    v_mfma_f32_16x16x32_bf16 v[220:223], a[152:155], v[48:51], v[220:223]
    v_mfma_f32_16x16x32_bf16 v[236:239], a[156:159], v[48:51], v[236:239]
    s_waitcnt lgkmcnt(0)
    v_mfma_f32_16x16x32_bf16 v[224:227], a[152:155], v[52:55], v[224:227]
    v_mfma_f32_16x16x32_bf16 v[240:243], a[156:159], v[52:55], v[240:243]
    s_waitcnt vmcnt(7)
    v_max_u32 v28, v124, v125
    s_waitcnt vmcnt(6)
    v_max3_u32 v28, v126, v127, v28
    s_waitcnt vmcnt(5)
    v_max3_u32 v28, v128, v129, v28
    s_waitcnt vmcnt(4)
    v_max3_u32 v28, v130, v131, v28
    s_waitcnt vmcnt(3)
    v_max3_u32 v28, v132, v133, v28
    s_waitcnt vmcnt(2)
    v_max3_u32 v28, v134, v135, v28
    s_waitcnt vmcnt(1)
    v_max3_u32 v28, v136, v137, v28
    s_waitcnt vmcnt(0)
    v_max3_u32 v28, v138, v139, v28
    v_cmp_eq_u32 vcc, -1, v28
    s_nop 0
    s_cbranch_vccnz Ls3_r
Ls3_ok:
    v_pk_add_f32 v[124:125], v[124:125], v[126:127] op_sel:[0,0] op_sel_hi:[1,1]
    v_pk_add_f32 v[128:129], v[128:129], v[130:131] op_sel:[0,0] op_sel_hi:[1,1]
    v_pk_add_f32 v[132:133], v[132:133], v[134:135] op_sel:[0,0] op_sel_hi:[1,1]
    v_pk_add_f32 v[136:137], v[136:137], v[138:139] op_sel:[0,0] op_sel_hi:[1,1]
    v_pk_add_f32 v[124:125], v[124:125], v[128:129] op_sel:[0,0] op_sel_hi:[1,1]
    v_pk_add_f32 v[132:133], v[132:133], v[136:137] op_sel:[0,0] op_sel_hi:[1,1]
    v_pk_add_f32 v[124:125], v[124:125], v[132:133] op_sel:[0,0] op_sel_hi:[1,1]
    v_mul_f32 v124, 0x3a97b426, v124
    v_mul_f32 v125, 0x3a97b426, v125
    v_fma_f32 v125, -v124, v124, v125
    v_max_f32 v125, 0, v125
    v_add_f32 v125, 0x3727c5ac, v125
    v_rsq_f32 v126, v125
    s_nop 0
    v_mul_f32_e64 v125, -v124, v126
    v_mov_b32 v124, v126
    ds_write2st64_b32 v164, v124, v125 offset0:0 offset1:1
    ds_read_b128 v[92:95], v165 offset:0
    ds_read_b128 v[96:99], v165 offset:16
    ds_read_b128 v[100:103], v165 offset:128
    ds_read_b128 v[104:107], v165 offset:144
    ds_read_b128 v[108:111], v165 offset:256
    ds_read_b128 v[112:115], v165 offset:272
    ds_read_b128 v[116:119], v165 offset:384
    ds_read_b128 v[120:123], v165 offset:400
    ds_read_b128 a[128:131], v84 offset:8192
    ds_read_b128 a[132:135], v86 offset:8192
    ds_read_b128 a[136:139], v88 offset:8192
    ds_read_b128 a[140:143], v90 offset:8192
    ds_read_b128 a[144:147], v85 offset:8192
    ds_read_b128 a[148:151], v87 offset:8192
    ds_read_b128 a[152:155], v89 offset:8192
    ds_read_b128 a[156:159], v91 offset:8192
    s_lshl_b32 s4, s41, 6
    s_lshl_b32 s5, s40, 1
    s_add_u32 s4, s4, s5
    s_mul_i32 s4, s4, 7168
    s_lshl_b32 s5, s3, 11
    s_add_u32 s4, s4, s5
    s_add_u32 s4, s4, 12582912
    v_add_u32 v28, s4, v4
    v_add_u32 v29, 7168, v28
    s_waitcnt lgkmcnt(11)
    v_pk_fma_f32 v[180:181], v[180:181], v[92:93], v[108:109] op_sel:[0,0,0] op_sel_hi:[1,1,1]
    v_pk_fma_f32 v[182:183], v[182:183], v[94:95], v[110:111] op_sel:[0,0,0] op_sel_hi:[1,1,1]
    s_waitcnt lgkmcnt(10)
    v_pk_fma_f32 v[184:185], v[184:185], v[96:97], v[112:113] op_sel:[0,0,0] op_sel_hi:[1,1,1]
    v_pk_fma_f32 v[186:187], v[186:187], v[98:99], v[114:115] op_sel:[0,0,0] op_sel_hi:[1,1,1]
    v_cvt_pk_bf16_f32 v124, v180, v181
    v_cvt_pk_bf16_f32 v125, v182, v183
    v_cvt_pk_bf16_f32 v126, v184, v185
    v_cvt_pk_bf16_f32 v127, v186, v187
    v_min_u32 v124, -2, v124
    v_min_u32 v125, -2, v125
    v_min_u32 v126, -2, v126
    v_min_u32 v127, -2, v127
    global_store_dwordx4 v28, v[124:127], s[38:39] offset:0 sc1
    s_waitcnt lgkmcnt(9)
    v_pk_fma_f32 v[188:189], v[188:189], v[100:101], v[116:117] op_sel:[0,0,0] op_sel_hi:[1,1,1]
    v_pk_fma_f32 v[190:191], v[190:191], v[102:103], v[118:119] op_sel:[0,0,0] op_sel_hi:[1,1,1]
    s_waitcnt lgkmcnt(8)
    v_pk_fma_f32 v[192:193], v[192:193], v[104:105], v[120:121] op_sel:[0,0,0] op_sel_hi:[1,1,1]
    v_pk_fma_f32 v[194:195], v[194:195], v[106:107], v[122:123] op_sel:[0,0,0] op_sel_hi:[1,1,1]
    v_cvt_pk_bf16_f32 v128, v188, v189
    v_cvt_pk_bf16_f32 v129, v190, v191
    v_cvt_pk_bf16_f32 v130, v192, v193
    v_cvt_pk_bf16_f32 v131, v194, v195
    v_min_u32 v128, -2, v128
    v_min_u32 v129, -2, v129
    v_min_u32 v130, -2, v130
    v_min_u32 v131, -2, v131
    global_store_dwordx4 v29, v[128:131], s[38:39] offset:0 sc1
    v_pk_fma_f32 v[196:197], v[196:197], v[92:93], v[108:109] op_sel:[0,0,0] op_sel_hi:[1,1,1]
    v_pk_fma_f32 v[198:199], v[198:199], v[94:95], v[110:111] op_sel:[0,0,0] op_sel_hi:[1,1,1]
    v_pk_fma_f32 v[200:201], v[200:201], v[96:97], v[112:113] op_sel:[0,0,0] op_sel_hi:[1,1,1]
    v_pk_fma_f32 v[202:203], v[202:203], v[98:99], v[114:115] op_sel:[0,0,0] op_sel_hi:[1,1,1]
    v_cvt_pk_bf16_f32 v132, v196, v197
    v_cvt_pk_bf16_f32 v133, v198, v199
    v_cvt_pk_bf16_f32 v134, v200, v201
    v_cvt_pk_bf16_f32 v135, v202, v203
    v_min_u32 v132, -2, v132
    v_min_u32 v133, -2, v133
    v_min_u32 v134, -2, v134
    v_min_u32 v135, -2, v135
    s_mov_b64 exec, s[86:87]
    global_store_dwordx4 v28, v[132:135], s[38:39] offset:1024 sc1
    s_mov_b64 exec, -1
    v_pk_fma_f32 v[204:205], v[204:205], v[100:101], v[116:117] op_sel:[0,0,0] op_sel_hi:[1,1,1]
    v_pk_fma_f32 v[206:207], v[206:207], v[102:103], v[118:119] op_sel:[0,0,0] op_sel_hi:[1,1,1]
    v_pk_fma_f32 v[208:209], v[208:209], v[104:105], v[120:121] op_sel:[0,0,0] op_sel_hi:[1,1,1]
    v_pk_fma_f32 v[210:211], v[210:211], v[106:107], v[122:123] op_sel:[0,0,0] op_sel_hi:[1,1,1]
    v_cvt_pk_bf16_f32 v136, v204, v205
    v_cvt_pk_bf16_f32 v137, v206, v207
    v_cvt_pk_bf16_f32 v138, v208, v209
    v_cvt_pk_bf16_f32 v139, v210, v211
    v_min_u32 v136, -2, v136
    v_min_u32 v137, -2, v137
    v_min_u32 v138, -2, v138
    v_min_u32 v139, -2, v139
    s_mov_b64 exec, s[86:87]
    global_store_dwordx4 v29, v[136:139], s[38:39] offset:1024 sc1
    s_mov_b64 exec, -1
    s_waitcnt lgkmcnt(0)
    s_barrier
    s_mul_i32 s5, s41, 138240
    s_add_u32 s5, s5, 10485760
    s_add_u32 s92, s38, s5
    s_addc_u32 s93, s39, 0
    s_mul_i32 s95, s3, 34816
    s_min_u32 s95, s95, 103424
    s_add_u32 s92, s92, s95
    s_addc_u32 s93, s93, 0
    s_add_u32 m0, s95, 0
    s_nop 0
    global_load_lds_dwordx4 v4, s[92:93] offset:0 sc1
    v_pk_fma_f32 v[180:181], v[156:157], v[12:13], v[16:17] op_sel:[1,0,0] op_sel_hi:[1,1,1]
    v_pk_fma_f32 v[182:183], v[156:157], v[14:15], v[18:19] op_sel:[1,0,0] op_sel_hi:[1,1,1]
    v_pk_fma_f32 v[184:185], v[158:159], v[12:13], v[16:17] op_sel:[1,0,0] op_sel_hi:[1,1,1]
    v_pk_fma_f32 v[186:187], v[158:159], v[14:15], v[18:19] op_sel:[1,0,0] op_sel_hi:[1,1,1]
    v_pk_fma_f32 v[188:189], v[160:161], v[12:13], v[16:17] op_sel:[1,0,0] op_sel_hi:[1,1,1]
    v_pk_fma_f32 v[190:191], v[160:161], v[14:15], v[18:19] op_sel:[1,0,0] op_sel_hi:[1,1,1]
    v_pk_fma_f32 v[192:193], v[162:163], v[12:13], v[16:17] op_sel:[1,0,0] op_sel_hi:[1,1,1]
    v_pk_fma_f32 v[194:195], v[162:163], v[14:15], v[18:19] op_sel:[1,0,0] op_sel_hi:[1,1,1]
    v_pk_fma_f32 v[212:213], v[156:157], v[212:213], v[180:181] op_sel:[0,0,0] op_sel_hi:[0,1,1]
    v_pk_fma_f32 v[214:215], v[156:157], v[214:215], v[182:183] op_sel:[0,0,0] op_sel_hi:[0,1,1]
    v_pk_fma_f32 v[216:217], v[158:159], v[216:217], v[184:185] op_sel:[0,0,0] op_sel_hi:[0,1,1]
    v_pk_fma_f32 v[218:219], v[158:159], v[218:219], v[186:187] op_sel:[0,0,0] op_sel_hi:[0,1,1]
    v_pk_fma_f32 v[220:221], v[160:161], v[220:221], v[188:189] op_sel:[0,0,0] op_sel_hi:[0,1,1]
    v_pk_fma_f32 v[222:223], v[160:161], v[222:223], v[190:191] op_sel:[0,0,0] op_sel_hi:[0,1,1]
    global_load_lds_dwordx4 v4, s[92:93] offset:1024 sc1
    v_pk_fma_f32 v[224:225], v[162:163], v[224:225], v[192:193] op_sel:[0,0,0] op_sel_hi:[0,1,1]
    v_pk_fma_f32 v[226:227], v[162:163], v[226:227], v[194:195] op_sel:[0,0,0] op_sel_hi:[0,1,1]
    v_pk_fma_f32 v[180:181], v[156:157], v[20:21], v[24:25] op_sel:[1,0,0] op_sel_hi:[1,1,1]
    v_pk_fma_f32 v[182:183], v[156:157], v[22:23], v[26:27] op_sel:[1,0,0] op_sel_hi:[1,1,1]
    v_pk_fma_f32 v[184:185], v[158:159], v[20:21], v[24:25] op_sel:[1,0,0] op_sel_hi:[1,1,1]
    v_pk_fma_f32 v[186:187], v[158:159], v[22:23], v[26:27] op_sel:[1,0,0] op_sel_hi:[1,1,1]
    v_pk_fma_f32 v[188:189], v[160:161], v[20:21], v[24:25] op_sel:[1,0,0] op_sel_hi:[1,1,1]
    v_pk_fma_f32 v[190:191], v[160:161], v[22:23], v[26:27] op_sel:[1,0,0] op_sel_hi:[1,1,1]
    v_pk_fma_f32 v[192:193], v[162:163], v[20:21], v[24:25] op_sel:[1,0,0] op_sel_hi:[1,1,1]
    v_pk_fma_f32 v[194:195], v[162:163], v[22:23], v[26:27] op_sel:[1,0,0] op_sel_hi:[1,1,1]
    v_pk_fma_f32 v[228:229], v[156:157], v[228:229], v[180:181] op_sel:[0,0,0] op_sel_hi:[0,1,1]
    v_pk_fma_f32 v[230:231], v[156:157], v[230:231], v[182:183] op_sel:[0,0,0] op_sel_hi:[0,1,1]
    v_pk_fma_f32 v[232:233], v[158:159], v[232:233], v[184:185] op_sel:[0,0,0] op_sel_hi:[0,1,1]
    v_pk_fma_f32 v[234:235], v[158:159], v[234:235], v[186:187] op_sel:[0,0,0] op_sel_hi:[0,1,1]
    v_pk_fma_f32 v[236:237], v[160:161], v[236:237], v[188:189] op_sel:[0,0,0] op_sel_hi:[0,1,1]
    global_load_lds_dwordx4 v4, s[92:93] offset:2048 sc1
    v_pk_fma_f32 v[238:239], v[160:161], v[238:239], v[190:191] op_sel:[0,0,0] op_sel_hi:[0,1,1]
    v_pk_fma_f32 v[240:241], v[162:163], v[240:241], v[192:193] op_sel:[0,0,0] op_sel_hi:[0,1,1]
    v_pk_fma_f32 v[242:243], v[162:163], v[242:243], v[194:195] op_sel:[0,0,0] op_sel_hi:[0,1,1]
    v_pk_mul_f32 v[180:181], v[212:213], v[212:213] op_sel:[0,0] op_sel_hi:[1,1]
    v_pk_mul_f32 v[182:183], v[214:215], v[214:215] op_sel:[0,0] op_sel_hi:[1,1]
    v_pk_mul_f32 v[184:185], v[216:217], v[216:217] op_sel:[0,0] op_sel_hi:[1,1]
    v_pk_mul_f32 v[186:187], v[218:219], v[218:219] op_sel:[0,0] op_sel_hi:[1,1]
    v_pk_mul_f32 v[188:189], v[220:221], v[220:221] op_sel:[0,0] op_sel_hi:[1,1]
    v_pk_mul_f32 v[190:191], v[222:223], v[222:223] op_sel:[0,0] op_sel_hi:[1,1]
    v_pk_mul_f32 v[192:193], v[224:225], v[224:225] op_sel:[0,0] op_sel_hi:[1,1]
    v_pk_mul_f32 v[194:195], v[226:227], v[226:227] op_sel:[0,0] op_sel_hi:[1,1]
    v_pk_mul_f32 v[196:197], v[228:229], v[228:229] op_sel:[0,0] op_sel_hi:[1,1]
    v_pk_mul_f32 v[198:199], v[230:231], v[230:231] op_sel:[0,0] op_sel_hi:[1,1]
    v_pk_mul_f32 v[200:201], v[232:233], v[232:233] op_sel:[0,0] op_sel_hi:[1,1]
    global_load_lds_dwordx4 v4, s[92:93] offset:3072 sc1
    v_pk_mul_f32 v[202:203], v[234:235], v[234:235] op_sel:[0,0] op_sel_hi:[1,1]
    v_pk_mul_f32 v[204:205], v[236:237], v[236:237] op_sel:[0,0] op_sel_hi:[1,1]
    v_pk_mul_f32 v[206:207], v[238:239], v[238:239] op_sel:[0,0] op_sel_hi:[1,1]
    v_pk_mul_f32 v[208:209], v[240:241], v[240:241] op_sel:[0,0] op_sel_hi:[1,1]
    v_pk_mul_f32 v[210:211], v[242:243], v[242:243] op_sel:[0,0] op_sel_hi:[1,1]
    v_pk_fma_f32 v[180:181], v[180:181], s[84:85], s[84:85] op_sel:[0,1,0] op_sel_hi:[1,1,0]
    v_pk_fma_f32 v[182:183], v[182:183], s[84:85], s[84:85] op_sel:[0,1,0] op_sel_hi:[1,1,0]
    v_pk_fma_f32 v[184:185], v[184:185], s[84:85], s[84:85] op_sel:[0,1,0] op_sel_hi:[1,1,0]
    v_pk_fma_f32 v[186:187], v[186:187], s[84:85], s[84:85] op_sel:[0,1,0] op_sel_hi:[1,1,0]
    v_pk_fma_f32 v[188:189], v[188:189], s[84:85], s[84:85] op_sel:[0,1,0] op_sel_hi:[1,1,0]
    v_pk_fma_f32 v[190:191], v[190:191], s[84:85], s[84:85] op_sel:[0,1,0] op_sel_hi:[1,1,0]
    v_pk_fma_f32 v[192:193], v[192:193], s[84:85], s[84:85] op_sel:[0,1,0] op_sel_hi:[1,1,0]
    v_pk_fma_f32 v[194:195], v[194:195], s[84:85], s[84:85] op_sel:[0,1,0] op_sel_hi:[1,1,0]
    v_pk_fma_f32 v[196:197], v[196:197], s[84:85], s[84:85] op_sel:[0,1,0] op_sel_hi:[1,1,0]
    v_pk_fma_f32 v[198:199], v[198:199], s[84:85], s[84:85] op_sel:[0,1,0] op_sel_hi:[1,1,0]
    s_add_u32 m0, s95, 4096
    s_add_u32 s92, s92, 4096
    s_addc_u32 s93, s93, 0
    global_load_lds_dwordx4 v4, s[92:93] offset:0 sc1
    v_pk_fma_f32 v[200:201], v[200:201], s[84:85], s[84:85] op_sel:[0,1,0] op_sel_hi:[1,1,0]
    v_pk_fma_f32 v[202:203], v[202:203], s[84:85], s[84:85] op_sel:[0,1,0] op_sel_hi:[1,1,0]
    v_pk_fma_f32 v[204:205], v[204:205], s[84:85], s[84:85] op_sel:[0,1,0] op_sel_hi:[1,1,0]
    v_pk_fma_f32 v[206:207], v[206:207], s[84:85], s[84:85] op_sel:[0,1,0] op_sel_hi:[1,1,0]
    v_pk_fma_f32 v[208:209], v[208:209], s[84:85], s[84:85] op_sel:[0,1,0] op_sel_hi:[1,1,0]
    v_pk_fma_f32 v[210:211], v[210:211], s[84:85], s[84:85] op_sel:[0,1,0] op_sel_hi:[1,1,0]
    v_pk_mul_f32 v[180:181], v[180:181], v[212:213] op_sel:[0,0] op_sel_hi:[1,1]
    v_pk_mul_f32 v[182:183], v[182:183], v[214:215] op_sel:[0,0] op_sel_hi:[1,1]
    v_pk_mul_f32 v[184:185], v[184:185], v[216:217] op_sel:[0,0] op_sel_hi:[1,1]
    v_pk_mul_f32 v[186:187], v[186:187], v[218:219] op_sel:[0,0] op_sel_hi:[1,1]
    v_pk_mul_f32 v[188:189], v[188:189], v[220:221] op_sel:[0,0] op_sel_hi:[1,1]
    v_pk_mul_f32 v[190:191], v[190:191], v[222:223] op_sel:[0,0] op_sel_hi:[1,1]
    v_pk_mul_f32 v[192:193], v[192:193], v[224:225] op_sel:[0,0] op_sel_hi:[1,1]
    v_pk_mul_f32 v[194:195], v[194:195], v[226:227] op_sel:[0,0] op_sel_hi:[1,1]
    global_load_lds_dwordx4 v4, s[92:93] offset:1024 sc1
    v_pk_mul_f32 v[196:197], v[196:197], v[228:229] op_sel:[0,0] op_sel_hi:[1,1]
    v_pk_mul_f32 v[198:199], v[198:199], v[230:231] op_sel:[0,0] op_sel_hi:[1,1]
    v_pk_mul_f32 v[200:201], v[200:201], v[232:233] op_sel:[0,0] op_sel_hi:[1,1]
    v_pk_mul_f32 v[202:203], v[202:203], v[234:235] op_sel:[0,0] op_sel_hi:[1,1]
    v_pk_mul_f32 v[204:205], v[204:205], v[236:237] op_sel:[0,0] op_sel_hi:[1,1]
    v_pk_mul_f32 v[206:207], v[206:207], v[238:239] op_sel:[0,0] op_sel_hi:[1,1]
    v_pk_mul_f32 v[208:209], v[208:209], v[240:241] op_sel:[0,0] op_sel_hi:[1,1]
    v_pk_mul_f32 v[210:211], v[210:211], v[242:243] op_sel:[0,0] op_sel_hi:[1,1]
    v_exp_f32 v180, v180
    v_exp_f32 v181, v181
    v_exp_f32 v182, v182
    v_exp_f32 v183, v183
    v_exp_f32 v184, v184
    v_exp_f32 v185, v185
    v_exp_f32 v186, v186
    global_load_lds_dwordx4 v4, s[92:93] offset:2048 sc1
    v_exp_f32 v187, v187
    v_exp_f32 v188, v188
    v_exp_f32 v189, v189
    v_exp_f32 v190, v190
    v_exp_f32 v191, v191
    v_exp_f32 v192, v192
    v_exp_f32 v193, v193
    v_exp_f32 v194, v194
    v_exp_f32 v195, v195
    v_exp_f32 v196, v196
    v_exp_f32 v197, v197
    v_exp_f32 v198, v198
    v_exp_f32 v199, v199
    v_exp_f32 v200, v200
    global_load_lds_dwordx4 v4, s[92:93] offset:3072 sc1
    v_exp_f32 v201, v201
    v_exp_f32 v202, v202
    v_exp_f32 v203, v203
    v_exp_f32 v204, v204
    v_exp_f32 v205, v205
    v_exp_f32 v206, v206
    v_exp_f32 v207, v207
    v_exp_f32 v208, v208
    v_exp_f32 v209, v209
    v_exp_f32 v210, v210
    v_exp_f32 v211, v211
    v_pk_add_f32 v[180:181], v[180:181], 1.0 op_sel:[0,0] op_sel_hi:[1,0]
    v_pk_add_f32 v[182:183], v[182:183], 1.0 op_sel:[0,0] op_sel_hi:[1,0]
    v_pk_add_f32 v[184:185], v[184:185], 1.0 op_sel:[0,0] op_sel_hi:[1,0]
    v_pk_add_f32 v[186:187], v[186:187], 1.0 op_sel:[0,0] op_sel_hi:[1,0]
    s_add_u32 m0, s95, 8192
    s_add_u32 s92, s92, 4096
    s_addc_u32 s93, s93, 0
    global_load_lds_dwordx4 v4, s[92:93] offset:0 sc1
    v_pk_add_f32 v[188:189], v[188:189], 1.0 op_sel:[0,0] op_sel_hi:[1,0]
    v_pk_add_f32 v[190:191], v[190:191], 1.0 op_sel:[0,0] op_sel_hi:[1,0]
    v_pk_add_f32 v[192:193], v[192:193], 1.0 op_sel:[0,0] op_sel_hi:[1,0]
    v_pk_add_f32 v[194:195], v[194:195], 1.0 op_sel:[0,0] op_sel_hi:[1,0]
    v_pk_add_f32 v[196:197], v[196:197], 1.0 op_sel:[0,0] op_sel_hi:[1,0]
    v_pk_add_f32 v[198:199], v[198:199], 1.0 op_sel:[0,0] op_sel_hi:[1,0]
    v_pk_add_f32 v[200:201], v[200:201], 1.0 op_sel:[0,0] op_sel_hi:[1,0]
    v_pk_add_f32 v[202:203], v[202:203], 1.0 op_sel:[0,0] op_sel_hi:[1,0]
    v_pk_add_f32 v[204:205], v[204:205], 1.0 op_sel:[0,0] op_sel_hi:[1,0]
    v_pk_add_f32 v[206:207], v[206:207], 1.0 op_sel:[0,0] op_sel_hi:[1,0]
    v_pk_add_f32 v[208:209], v[208:209], 1.0 op_sel:[0,0] op_sel_hi:[1,0]
    v_pk_add_f32 v[210:211], v[210:211], 1.0 op_sel:[0,0] op_sel_hi:[1,0]
    v_rcp_f32 v180, v180
    v_rcp_f32 v181, v181
    global_load_lds_dwordx4 v4, s[92:93] offset:1024 sc1
    v_rcp_f32 v182, v182
    v_rcp_f32 v183, v183
    v_rcp_f32 v184, v184
    v_rcp_f32 v185, v185
    v_rcp_f32 v186, v186
    v_rcp_f32 v187, v187
    v_rcp_f32 v188, v188
    v_rcp_f32 v189, v189
    v_rcp_f32 v190, v190
    v_rcp_f32 v191, v191
    v_rcp_f32 v192, v192
    v_rcp_f32 v193, v193
    v_rcp_f32 v194, v194
    v_rcp_f32 v195, v195
    v_rcp_f32 v196, v196
    global_load_lds_dwordx4 v4, s[92:93] offset:2048 sc1
    v_rcp_f32 v197, v197
    v_rcp_f32 v198, v198
    v_rcp_f32 v199, v199
    v_rcp_f32 v200, v200
    v_rcp_f32 v201, v201
    v_rcp_f32 v202, v202
    v_rcp_f32 v203, v203
    v_rcp_f32 v204, v204
    v_rcp_f32 v205, v205
    v_rcp_f32 v206, v206
    v_rcp_f32 v207, v207
    v_rcp_f32 v208, v208
    v_rcp_f32 v209, v209
    v_rcp_f32 v210, v210
    global_load_lds_dwordx4 v4, s[92:93] offset:3072 sc1
    v_rcp_f32 v211, v211
    v_pk_mul_f32 v[212:213], v[212:213], v[180:181] op_sel:[0,0] op_sel_hi:[1,1]
    v_pk_mul_f32 v[214:215], v[214:215], v[182:183] op_sel:[0,0] op_sel_hi:[1,1]
    v_pk_mul_f32 v[216:217], v[216:217], v[184:185] op_sel:[0,0] op_sel_hi:[1,1]
    v_pk_mul_f32 v[218:219], v[218:219], v[186:187] op_sel:[0,0] op_sel_hi:[1,1]
    v_pk_mul_f32 v[220:221], v[220:221], v[188:189] op_sel:[0,0] op_sel_hi:[1,1]
    v_pk_mul_f32 v[222:223], v[222:223], v[190:191] op_sel:[0,0] op_sel_hi:[1,1]
    v_pk_mul_f32 v[224:225], v[224:225], v[192:193] op_sel:[0,0] op_sel_hi:[1,1]
    v_pk_mul_f32 v[226:227], v[226:227], v[194:195] op_sel:[0,0] op_sel_hi:[1,1]
    v_pk_mul_f32 v[228:229], v[228:229], v[196:197] op_sel:[0,0] op_sel_hi:[1,1]
    v_pk_mul_f32 v[230:231], v[230:231], v[198:199] op_sel:[0,0] op_sel_hi:[1,1]
    v_pk_mul_f32 v[232:233], v[232:233], v[200:201] op_sel:[0,0] op_sel_hi:[1,1]
    v_pk_mul_f32 v[234:235], v[234:235], v[202:203] op_sel:[0,0] op_sel_hi:[1,1]
    v_pk_mul_f32 v[236:237], v[236:237], v[204:205] op_sel:[0,0] op_sel_hi:[1,1]
    v_pk_mul_f32 v[238:239], v[238:239], v[206:207] op_sel:[0,0] op_sel_hi:[1,1]
    s_add_u32 m0, s95, 12288
    s_add_u32 s92, s92, 4096
    s_addc_u32 s93, s93, 0
    global_load_lds_dwordx4 v4, s[92:93] offset:0 sc1
    v_pk_mul_f32 v[240:241], v[240:241], v[208:209] op_sel:[0,0] op_sel_hi:[1,1]
    v_pk_mul_f32 v[242:243], v[242:243], v[210:211] op_sel:[0,0] op_sel_hi:[1,1]
    v_cvt_pk_bf16_f32 v180, v212, v213
    v_cvt_pk_bf16_f32 v181, v214, v215
    v_cvt_pk_bf16_f32 v182, v216, v217
    v_cvt_pk_bf16_f32 v183, v218, v219
    v_cvt_pk_bf16_f32 v184, v220, v221
    v_cvt_pk_bf16_f32 v185, v222, v223
    v_cvt_pk_bf16_f32 v186, v224, v225
    v_cvt_pk_bf16_f32 v187, v226, v227
    v_cvt_pk_bf16_f32 v188, v228, v229
    v_cvt_pk_bf16_f32 v189, v230, v231
    v_cvt_pk_bf16_f32 v190, v232, v233
    v_cvt_pk_bf16_f32 v191, v234, v235
    global_load_lds_dwordx4 v4, s[92:93] offset:1024 sc1
    v_cvt_pk_bf16_f32 v192, v236, v237
    v_cvt_pk_bf16_f32 v193, v238, v239
    v_cvt_pk_bf16_f32 v194, v240, v241
    v_cvt_pk_bf16_f32 v195, v242, v243
    s_lshl_b32 s4, s3, 10
    s_add_u32 s4, s4, 138240
    v_add_u32 v28, s4, v30
    ds_write_b64 v28, v[180:181] offset:0
    ds_write_b64 v28, v[182:183] offset:4096
    ds_write_b64 v28, v[184:185] offset:8192
    ds_write_b64 v28, v[186:187] offset:12288
    ds_write_b64 v28, v[188:189] offset:512
    ds_write_b64 v28, v[190:191] offset:4608
    ds_write_b64 v28, v[192:193] offset:8704
    ds_write_b64 v28, v[194:195] offset:12800
    s_waitcnt lgkmcnt(0)
    s_barrier
    s_lshl_b32 s4, s3, 12
    s_add_u32 s4, s4, 138240
    v_add_u32 v28, s4, v30
    ds_read_b64 v[48:49], v28 offset:0
    ds_read_b64 v[50:51], v28 offset:512
    ds_read_b64 v[52:53], v28 offset:1024
    ds_read_b64 v[54:55], v28 offset:1536
    ds_read_b64 v[56:57], v28 offset:2048
    ds_read_b64 v[58:59], v28 offset:2560
    ds_read_b64 v[60:61], v28 offset:3072
    global_load_lds_dwordx4 v4, s[92:93] offset:2048 sc1
    global_load_lds_dwordx4 v4, s[92:93] offset:3072 sc1
    s_add_u32 m0, s95, 16384
    s_add_u32 s92, s92, 4096
    s_addc_u32 s93, s93, 0
    global_load_lds_dwordx4 v4, s[92:93] offset:0 sc1
    global_load_lds_dwordx4 v4, s[92:93] offset:1024 sc1
    v_add_u32 v30, 3072, v4
    v_add_u32 v31, 10240, v4
    s_xor_b32 s4, s3, 1
    s_mul_i32 s4, s4, 3072
    s_add_u32 s4, s4, 138240
    v_add_u32 v20, s4, v4
    s_xor_b32 s4, s3, 2
    s_mul_i32 s4, s4, 3072
    s_add_u32 s4, s4, 139264
    v_add_u32 v21, s4, v4
    s_xor_b32 s4, s3, 3
    s_mul_i32 s4, s4, 3072
    s_add_u32 s4, s4, 140288
    v_add_u32 v22, s4, v4
    s_mul_i32 s4, s3, 3072
    s_add_u32 s4, s4, 138240
    v_add_u32 v23, s4, v4
    s_lshl_b32 s4, s40, 2
    s_add_u32 s4, s4, s3
    s_mul_i32 s4, s4, 28672
    s_add_u32 s91, s4, 16777216
    s_mul_i32 s5, s41, 7
    s_add_u32 s5, s5, 1
    s_lshr_b32 s5, s5, 1
    s_lshl_b32 s5, s5, 10
    s_add_u32 s4, s91, s5
    v_add_u32 v24, s4, v4
    s_movk_i32 s5, 3072
    s_bitcmp1_b32 s41, 0
    s_cselect_b32 s5, -1016, s5
    v_add_u32 v25, s5, v24
    v_min_u32 v29, 13, v1
    v_lshlrev_b32 v29, 10, v29
Lzp:
    global_load_dword v174, v29, s[52:53] offset:1020 sc1
    global_load_dword v175, v29, s[54:55] offset:1020 sc1
    global_load_dword v176, v29, s[56:57] offset:1020 sc1
    global_load_dword v177, v29, s[58:59] offset:1020 sc1
    s_waitcnt vmcnt(0)
    v_max_u32 v28, v174, v175
    v_max3_u32 v28, v176, v177, v28
    v_cmp_eq_u32 vcc, -1, v28
    s_add_u32 s100, s100, 1
    s_cmp_ge_u32 s100, 262144
    s_cbranch_scc1 Lzp_x
    s_cbranch_vccnz Lzp
Lzp_x:
    s_waitcnt lgkmcnt(0)
    s_barrier
    s_add_u32 s4, s91, 4096
    v_add_u32 v6, s4, v4
    v_add_u32 v7, 8192, v6
    v_add_u32 v26, 16384, v6
    v_add_u32 v27, 24576, v6
    global_load_dwordx4 v[174:177], v30, s[52:53] offset:-3072 sc1
    global_load_dwordx4 v[178:181], v30, s[52:53] offset:-2048 sc1
    global_load_dwordx4 v[182:185], v30, s[52:53] offset:-1024 sc1
    global_load_dwordx4 v[186:189], v30, s[52:53] offset:0 sc1
    global_load_dwordx4 v[190:193], v30, s[52:53] offset:1024 sc1
    global_load_dwordx4 v[194:197], v30, s[52:53] offset:2048 sc1
    global_load_dwordx4 v[198:201], v30, s[52:53] offset:3072 sc1
    global_load_dwordx4 v[202:205], v31, s[52:53] offset:-3072 sc1
    global_load_dwordx4 v[206:209], v31, s[52:53] offset:-2048 sc1
    global_load_dwordx4 v[210:213], v31, s[52:53] offset:-1024 sc1
    global_load_dwordx4 v[214:217], v31, s[52:53] offset:0 sc1
    global_load_dwordx4 v[218:221], v31, s[52:53] offset:1024 sc1
    global_load_dwordx4 v[222:225], v31, s[52:53] offset:2048 sc1
    global_load_dwordx4 v[226:229], v31, s[52:53] offset:3072 sc1
    global_load_dwordx4 v[230:233], v30, s[54:55] offset:-3072 sc1
    global_load_dwordx4 v[234:237], v30, s[54:55] offset:-2048 sc1
    s_waitcnt vmcnt(15)
    v_max_u32 v28, v174, v175
    v_max3_u32 v28, v176, v177, v28
    s_waitcnt vmcnt(14)
    v_max3_u32 v28, v178, v179, v28
    v_max3_u32 v28, v180, v181, v28
    s_waitcnt vmcnt(13)
    v_max3_u32 v28, v182, v183, v28
    v_max3_u32 v28, v184, v185, v28
    s_waitcnt vmcnt(12)
    v_max3_u32 v28, v186, v187, v28
    v_max3_u32 v28, v188, v189, v28
    v_cmp_eq_u32 vcc, -1, v28
    s_nop 0
    s_cbranch_vccnz Lz0_r
Lz0_ok:
    v_mfma_f32_16x16x32_bf16 v[62:65], v[174:177], a[160:163], v[32:35]
    global_load_dwordx4 v[238:241], v30, s[54:55] offset:-1024 sc1
    v_mfma_f32_16x16x32_bf16 v[66:69], v[174:177], a[164:167], 0
    v_mfma_f32_16x16x32_bf16 v[70:73], v[174:177], a[168:171], 0
    v_mfma_f32_16x16x32_bf16 v[74:77], v[174:177], a[172:175], 0
    v_mfma_f32_16x16x32_bf16 v[78:81], v[178:181], a[160:163], v[32:35]
    global_load_dwordx4 v[242:245], v30, s[54:55] offset:0 sc1
    v_mfma_f32_16x16x32_bf16 v[82:85], v[178:181], a[164:167], 0
    v_mfma_f32_16x16x32_bf16 v[86:89], v[178:181], a[168:171], 0
    s_waitcnt vmcnt(13)
    v_max_u32 v28, v190, v191
    v_mfma_f32_16x16x32_bf16 v[90:93], v[178:181], a[172:175], 0
    v_max3_u32 v28, v192, v193, v28
    v_mfma_f32_16x16x32_bf16 v[94:97], v[182:185], a[160:163], v[32:35]
    global_load_dwordx4 v[246:249], v30, s[54:55] offset:1024 sc1
    s_waitcnt vmcnt(13)
    v_max3_u32 v28, v194, v195, v28
    v_mfma_f32_16x16x32_bf16 v[98:101], v[182:185], a[164:167], 0
    v_max3_u32 v28, v196, v197, v28
    v_mfma_f32_16x16x32_bf16 v[102:105], v[182:185], a[168:171], 0
    s_waitcnt vmcnt(12)
    v_max3_u32 v28, v198, v199, v28
    v_mfma_f32_16x16x32_bf16 v[106:109], v[182:185], a[172:175], 0
    v_max3_u32 v28, v200, v201, v28
    v_mfma_f32_16x16x32_bf16 v[110:113], v[186:189], a[160:163], v[32:35]
    global_load_dwordx4 v[250:253], v30, s[54:55] offset:2048 sc1
    s_waitcnt vmcnt(12)
    v_max3_u32 v28, v202, v203, v28
    v_mfma_f32_16x16x32_bf16 v[114:117], v[186:189], a[164:167], 0
    v_max3_u32 v28, v204, v205, v28
    v_mfma_f32_16x16x32_bf16 v[118:121], v[186:189], a[168:171], 0
    v_mfma_f32_16x16x32_bf16 v[122:125], v[186:189], a[172:175], 0
    v_cmp_eq_u32 vcc, -1, v28
    s_nop 0
    s_cbranch_vccnz Lz1_r
Lz1_ok:
    v_mfma_f32_16x16x32_bf16 v[126:129], v[190:193], a[160:163], v[32:35]
    global_load_dwordx4 v[174:177], v30, s[54:55] offset:3072 sc1
    v_mfma_f32_16x16x32_bf16 v[130:133], v[190:193], a[164:167], 0
    v_mfma_f32_16x16x32_bf16 v[134:137], v[190:193], a[168:171], 0
    v_mfma_f32_16x16x32_bf16 v[138:141], v[190:193], a[172:175], 0
    v_mfma_f32_16x16x32_bf16 v[142:145], v[194:197], a[160:163], v[32:35]
    global_load_dwordx4 v[178:181], v31, s[54:55] offset:-3072 sc1
    v_mfma_f32_16x16x32_bf16 v[146:149], v[194:197], a[164:167], 0
    v_mfma_f32_16x16x32_bf16 v[150:153], v[194:197], a[168:171], 0
    s_waitcnt vmcnt(13)
    v_max_u32 v28, v206, v207
    v_mfma_f32_16x16x32_bf16 v[154:157], v[194:197], a[172:175], 0
    v_max3_u32 v28, v208, v209, v28
    v_mfma_f32_16x16x32_bf16 v[158:161], v[198:201], a[160:163], v[32:35]
    global_load_dwordx4 v[182:185], v31, s[54:55] offset:-2048 sc1
    s_waitcnt vmcnt(13)
    v_max3_u32 v28, v210, v211, v28
    v_mfma_f32_16x16x32_bf16 v[162:165], v[198:201], a[164:167], 0
    v_max3_u32 v28, v212, v213, v28
    v_mfma_f32_16x16x32_bf16 v[166:169], v[198:201], a[168:171], 0
    s_waitcnt vmcnt(12)
    v_max3_u32 v28, v214, v215, v28
    v_mfma_f32_16x16x32_bf16 v[170:173], v[198:201], a[172:175], 0
    v_max3_u32 v28, v216, v217, v28
    v_mfma_f32_16x16x32_bf16 v[62:65], v[202:205], a[176:179], v[62:65]
    global_load_dwordx4 v[186:189], v31, s[54:55] offset:-1024 sc1
    s_waitcnt vmcnt(12)
    v_max3_u32 v28, v218, v219, v28
    v_mfma_f32_16x16x32_bf16 v[66:69], v[202:205], a[180:183], v[66:69]
    v_max3_u32 v28, v220, v221, v28
    v_mfma_f32_16x16x32_bf16 v[70:73], v[202:205], a[184:187], v[70:73]
    v_mfma_f32_16x16x32_bf16 v[74:77], v[202:205], a[188:191], v[74:77]
    v_cmp_eq_u32 vcc, -1, v28
    s_nop 0
    s_cbranch_vccnz Lz2_r
Lz2_ok:
    v_mfma_f32_16x16x32_bf16 v[78:81], v[206:209], a[176:179], v[78:81]
    global_load_dwordx4 v[190:193], v31, s[54:55] offset:0 sc1
    v_mfma_f32_16x16x32_bf16 v[82:85], v[206:209], a[180:183], v[82:85]
    v_mfma_f32_16x16x32_bf16 v[86:89], v[206:209], a[184:187], v[86:89]
    v_mfma_f32_16x16x32_bf16 v[90:93], v[206:209], a[188:191], v[90:93]
    v_mfma_f32_16x16x32_bf16 v[94:97], v[210:213], a[176:179], v[94:97]
    global_load_dwordx4 v[194:197], v31, s[54:55] offset:1024 sc1
    v_mfma_f32_16x16x32_bf16 v[98:101], v[210:213], a[180:183], v[98:101]
    v_mfma_f32_16x16x32_bf16 v[102:105], v[210:213], a[184:187], v[102:105]
    s_waitcnt vmcnt(13)
    v_max_u32 v28, v222, v223
    v_mfma_f32_16x16x32_bf16 v[106:109], v[210:213], a[188:191], v[106:109]
    v_max3_u32 v28, v224, v225, v28
    v_mfma_f32_16x16x32_bf16 v[110:113], v[214:217], a[176:179], v[110:113]
    global_load_dwordx4 v[198:201], v31, s[54:55] offset:2048 sc1
    s_waitcnt vmcnt(13)
    v_max3_u32 v28, v226, v227, v28
    v_mfma_f32_16x16x32_bf16 v[114:117], v[214:217], a[180:183], v[114:117]
    v_max3_u32 v28, v228, v229, v28
    v_mfma_f32_16x16x32_bf16 v[118:121], v[214:217], a[184:187], v[118:121]
    s_waitcnt vmcnt(12)
    v_max3_u32 v28, v230, v231, v28
    v_mfma_f32_16x16x32_bf16 v[122:125], v[214:217], a[188:191], v[122:125]
    v_max3_u32 v28, v232, v233, v28
    v_mfma_f32_16x16x32_bf16 v[126:129], v[218:221], a[176:179], v[126:129]
    global_load_dwordx4 v[202:205], v31, s[54:55] offset:3072 sc1
    s_waitcnt vmcnt(12)
    v_max3_u32 v28, v234, v235, v28
    v_mfma_f32_16x16x32_bf16 v[130:133], v[218:221], a[180:183], v[130:133]
    v_max3_u32 v28, v236, v237, v28
    v_mfma_f32_16x16x32_bf16 v[134:137], v[218:221], a[184:187], v[134:137]
    v_mfma_f32_16x16x32_bf16 v[138:141], v[218:221], a[188:191], v[138:141]
    v_cmp_eq_u32 vcc, -1, v28
    s_nop 0
    s_cbranch_vccnz Lz3_r
Lz3_ok:
    v_mfma_f32_16x16x32_bf16 v[142:145], v[222:225], a[176:179], v[142:145]
    global_load_dwordx4 v[206:209], v30, s[56:57] offset:-3072 sc1
    v_mfma_f32_16x16x32_bf16 v[146:149], v[222:225], a[180:183], v[146:149]
    v_mfma_f32_16x16x32_bf16 v[150:153], v[222:225], a[184:187], v[150:153]
    v_mfma_f32_16x16x32_bf16 v[154:157], v[222:225], a[188:191], v[154:157]
    v_mfma_f32_16x16x32_bf16 v[158:161], v[226:229], a[176:179], v[158:161]
    global_load_dwordx4 v[210:213], v30, s[56:57] offset:-2048 sc1
    v_mfma_f32_16x16x32_bf16 v[162:165], v[226:229], a[180:183], v[162:165]
    v_mfma_f32_16x16x32_bf16 v[166:169], v[226:229], a[184:187], v[166:169]
    s_waitcnt vmcnt(13)
    v_max_u32 v28, v238, v239
    v_mfma_f32_16x16x32_bf16 v[170:173], v[226:229], a[188:191], v[170:173]
    v_max3_u32 v28, v240, v241, v28
    v_mfma_f32_16x16x32_bf16 v[62:65], v[230:233], a[192:195], v[62:65]
    global_load_dwordx4 v[214:217], v30, s[56:57] offset:-1024 sc1
    s_waitcnt vmcnt(13)
    v_max3_u32 v28, v242, v243, v28
    v_mfma_f32_16x16x32_bf16 v[66:69], v[230:233], a[196:199], v[66:69]
    v_max3_u32 v28, v244, v245, v28
    v_mfma_f32_16x16x32_bf16 v[70:73], v[230:233], a[200:203], v[70:73]
    s_waitcnt vmcnt(12)
    v_max3_u32 v28, v246, v247, v28
    v_mfma_f32_16x16x32_bf16 v[74:77], v[230:233], a[204:207], v[74:77]
    v_max3_u32 v28, v248, v249, v28
    v_mfma_f32_16x16x32_bf16 v[78:81], v[234:237], a[192:195], v[78:81]
    global_load_dwordx4 v[218:221], v30, s[56:57] offset:0 sc1
    s_waitcnt vmcnt(12)
    v_max3_u32 v28, v250, v251, v28
    v_mfma_f32_16x16x32_bf16 v[82:85], v[234:237], a[196:199], v[82:85]
    v_max3_u32 v28, v252, v253, v28
    v_mfma_f32_16x16x32_bf16 v[86:89], v[234:237], a[200:203], v[86:89]
    v_mfma_f32_16x16x32_bf16 v[90:93], v[234:237], a[204:207], v[90:93]
    v_cmp_eq_u32 vcc, -1, v28
    s_nop 0
    s_cbranch_vccnz Lz4_r
Lz4_ok:
    v_mfma_f32_16x16x32_bf16 v[94:97], v[238:241], a[192:195], v[94:97]
    global_load_dwordx4 v[222:225], v30, s[56:57] offset:1024 sc1
    v_mfma_f32_16x16x32_bf16 v[98:101], v[238:241], a[196:199], v[98:101]
    v_mfma_f32_16x16x32_bf16 v[102:105], v[238:241], a[200:203], v[102:105]
    v_mfma_f32_16x16x32_bf16 v[106:109], v[238:241], a[204:207], v[106:109]
    v_mfma_f32_16x16x32_bf16 v[110:113], v[242:245], a[192:195], v[110:113]
    global_load_dwordx4 v[226:229], v30, s[56:57] offset:2048 sc1
    v_mfma_f32_16x16x32_bf16 v[114:117], v[242:245], a[196:199], v[114:117]
    v_mfma_f32_16x16x32_bf16 v[118:121], v[242:245], a[200:203], v[118:121]
    s_waitcnt vmcnt(13)
    v_max_u32 v28, v174, v175
    v_mfma_f32_16x16x32_bf16 v[122:125], v[242:245], a[204:207], v[122:125]
    v_max3_u32 v28, v176, v177, v28
    v_mfma_f32_16x16x32_bf16 v[126:129], v[246:249], a[192:195], v[126:129]
    global_load_dwordx4 v[230:233], v30, s[56:57] offset:3072 sc1
    s_waitcnt vmcnt(13)
    v_max3_u32 v28, v178, v179, v28
    v_mfma_f32_16x16x32_bf16 v[130:133], v[246:249], a[196:199], v[130:133]
    v_max3_u32 v28, v180, v181, v28
    v_mfma_f32_16x16x32_bf16 v[134:137], v[246:249], a[200:203], v[134:137]
    s_waitcnt vmcnt(12)
    v_max3_u32 v28, v182, v183, v28
    v_mfma_f32_16x16x32_bf16 v[138:141], v[246:249], a[204:207], v[138:141]
    v_max3_u32 v28, v184, v185, v28
    v_mfma_f32_16x16x32_bf16 v[142:145], v[250:253], a[192:195], v[142:145]
    global_load_dwordx4 v[234:237], v31, s[56:57] offset:-3072 sc1
    s_waitcnt vmcnt(12)
    v_max3_u32 v28, v186, v187, v28
    v_mfma_f32_16x16x32_bf16 v[146:149], v[250:253], a[196:199], v[146:149]
    v_max3_u32 v28, v188, v189, v28
    v_mfma_f32_16x16x32_bf16 v[150:153], v[250:253], a[200:203], v[150:153]
    v_mfma_f32_16x16x32_bf16 v[154:157], v[250:253], a[204:207], v[154:157]
    v_cmp_eq_u32 vcc, -1, v28
    s_nop 0
    s_cbranch_vccnz Lz5_r
Lz5_ok:
    v_mfma_f32_16x16x32_bf16 v[158:161], v[174:177], a[192:195], v[158:161]
    global_load_dwordx4 v[238:241], v31, s[56:57] offset:-2048 sc1
    v_mfma_f32_16x16x32_bf16 v[162:165], v[174:177], a[196:199], v[162:165]
    v_mfma_f32_16x16x32_bf16 v[166:169], v[174:177], a[200:203], v[166:169]
    v_mfma_f32_16x16x32_bf16 v[170:173], v[174:177], a[204:207], v[170:173]
    v_mfma_f32_16x16x32_bf16 v[62:65], v[178:181], a[208:211], v[62:65]
    global_load_dwordx4 v[242:245], v31, s[56:57] offset:-1024 sc1
    v_mfma_f32_16x16x32_bf16 v[66:69], v[178:181], a[212:215], v[66:69]
    v_mfma_f32_16x16x32_bf16 v[70:73], v[178:181], a[216:219], v[70:73]
    s_waitcnt vmcnt(13)
    v_max_u32 v28, v190, v191
    v_mfma_f32_16x16x32_bf16 v[74:77], v[178:181], a[220:223], v[74:77]
    v_max3_u32 v28, v192, v193, v28
    v_mfma_f32_16x16x32_bf16 v[78:81], v[182:185], a[208:211], v[78:81]
    global_load_dwordx4 v[246:249], v31, s[56:57] offset:0 sc1
    s_waitcnt vmcnt(13)
    v_max3_u32 v28, v194, v195, v28
    v_mfma_f32_16x16x32_bf16 v[82:85], v[182:185], a[212:215], v[82:85]
    v_max3_u32 v28, v196, v197, v28
    v_mfma_f32_16x16x32_bf16 v[86:89], v[182:185], a[216:219], v[86:89]
    s_waitcnt vmcnt(12)
    v_max3_u32 v28, v198, v199, v28
    v_mfma_f32_16x16x32_bf16 v[90:93], v[182:185], a[220:223], v[90:93]
    v_max3_u32 v28, v200, v201, v28
    v_mfma_f32_16x16x32_bf16 v[94:97], v[186:189], a[208:211], v[94:97]
    global_load_dwordx4 v[250:253], v31, s[56:57] offset:1024 sc1
    s_waitcnt vmcnt(12)
    v_max3_u32 v28, v202, v203, v28
    v_mfma_f32_16x16x32_bf16 v[98:101], v[186:189], a[212:215], v[98:101]
    v_max3_u32 v28, v204, v205, v28
    v_mfma_f32_16x16x32_bf16 v[102:105], v[186:189], a[216:219], v[102:105]
    v_mfma_f32_16x16x32_bf16 v[106:109], v[186:189], a[220:223], v[106:109]
    v_cmp_eq_u32 vcc, -1, v28
    s_nop 0
    s_cbranch_vccnz Lz6_r
Lz6_ok:
    v_mfma_f32_16x16x32_bf16 v[110:113], v[190:193], a[208:211], v[110:113]
    global_load_dwordx4 v[174:177], v31, s[56:57] offset:2048 sc1
    v_min_u32 v29, 27, v1
    v_mfma_f32_16x16x32_bf16 v[114:117], v[190:193], a[212:215], v[114:117]
    s_mul_i32 s4, s43, 28
    v_add_lshl_u32 v29, v29, s4, 7
    v_mfma_f32_16x16x32_bf16 v[118:121], v[190:193], a[216:219], v[118:121]
    global_load_dword v29, v29, s[64:65] sc1
    v_mfma_f32_16x16x32_bf16 v[122:125], v[190:193], a[220:223], v[122:125]
    v_mfma_f32_16x16x32_bf16 v[126:129], v[194:197], a[208:211], v[126:129]
    global_load_dwordx4 v[178:181], v31, s[56:57] offset:3072 sc1
    v_mfma_f32_16x16x32_bf16 v[130:133], v[194:197], a[212:215], v[130:133]
    v_mfma_f32_16x16x32_bf16 v[134:137], v[194:197], a[216:219], v[134:137]
    s_waitcnt vmcnt(14)
    v_max_u32 v28, v206, v207
    v_mfma_f32_16x16x32_bf16 v[138:141], v[194:197], a[220:223], v[138:141]
    v_max3_u32 v28, v208, v209, v28
    v_mfma_f32_16x16x32_bf16 v[142:145], v[198:201], a[208:211], v[142:145]
    global_load_dwordx4 v[182:185], v30, s[58:59] offset:-3072 sc1
    s_waitcnt vmcnt(14)
    v_max3_u32 v28, v210, v211, v28
    v_mfma_f32_16x16x32_bf16 v[146:149], v[198:201], a[212:215], v[146:149]
    v_max3_u32 v28, v212, v213, v28
    v_mfma_f32_16x16x32_bf16 v[150:153], v[198:201], a[216:219], v[150:153]
    s_waitcnt vmcnt(13)
    v_max3_u32 v28, v214, v215, v28
    v_mfma_f32_16x16x32_bf16 v[154:157], v[198:201], a[220:223], v[154:157]
    v_max3_u32 v28, v216, v217, v28
    v_mfma_f32_16x16x32_bf16 v[158:161], v[202:205], a[208:211], v[158:161]
    global_load_dwordx4 v[186:189], v30, s[58:59] offset:-2048 sc1
    s_waitcnt vmcnt(13)
    v_max3_u32 v28, v218, v219, v28
    v_mfma_f32_16x16x32_bf16 v[162:165], v[202:205], a[212:215], v[162:165]
    v_max3_u32 v28, v220, v221, v28
    v_mfma_f32_16x16x32_bf16 v[166:169], v[202:205], a[216:219], v[166:169]
    v_mfma_f32_16x16x32_bf16 v[170:173], v[202:205], a[220:223], v[170:173]
    v_cmp_eq_u32 vcc, -1, v28
    s_nop 0
    s_cbranch_vccnz Lz7_r
Lz7_ok:
    v_mfma_f32_16x16x32_bf16 v[62:65], v[206:209], a[224:227], v[62:65]
    global_load_dwordx4 v[190:193], v30, s[58:59] offset:-1024 sc1
    v_mfma_f32_16x16x32_bf16 v[66:69], v[206:209], a[228:231], v[66:69]
    v_mfma_f32_16x16x32_bf16 v[70:73], v[206:209], a[232:235], v[70:73]
    v_mfma_f32_16x16x32_bf16 v[74:77], v[206:209], a[236:239], v[74:77]
    v_mfma_f32_16x16x32_bf16 v[78:81], v[210:213], a[224:227], v[78:81]
    global_load_dwordx4 v[194:197], v30, s[58:59] offset:0 sc1
    v_mfma_f32_16x16x32_bf16 v[82:85], v[210:213], a[228:231], v[82:85]
    v_mfma_f32_16x16x32_bf16 v[86:89], v[210:213], a[232:235], v[86:89]
    s_waitcnt vmcnt(14)
    v_max_u32 v28, v222, v223
    v_mfma_f32_16x16x32_bf16 v[90:93], v[210:213], a[236:239], v[90:93]
    v_max3_u32 v28, v224, v225, v28
    v_mfma_f32_16x16x32_bf16 v[94:97], v[214:217], a[224:227], v[94:97]
    global_load_dwordx4 v[198:201], v30, s[58:59] offset:1024 sc1
    s_waitcnt vmcnt(14)
    v_max3_u32 v28, v226, v227, v28
    v_mfma_f32_16x16x32_bf16 v[98:101], v[214:217], a[228:231], v[98:101]
    v_max3_u32 v28, v228, v229, v28
    v_mfma_f32_16x16x32_bf16 v[102:105], v[214:217], a[232:235], v[102:105]
    s_waitcnt vmcnt(13)
    v_max3_u32 v28, v230, v231, v28
    v_mfma_f32_16x16x32_bf16 v[106:109], v[214:217], a[236:239], v[106:109]
    v_max3_u32 v28, v232, v233, v28
    v_mfma_f32_16x16x32_bf16 v[110:113], v[218:221], a[224:227], v[110:113]
    global_load_dwordx4 v[202:205], v30, s[58:59] offset:2048 sc1
    s_waitcnt vmcnt(13)
    v_max3_u32 v28, v234, v235, v28
    v_mfma_f32_16x16x32_bf16 v[114:117], v[218:221], a[228:231], v[114:117]
    v_max3_u32 v28, v236, v237, v28
    v_mfma_f32_16x16x32_bf16 v[118:121], v[218:221], a[232:235], v[118:121]
    v_mfma_f32_16x16x32_bf16 v[122:125], v[218:221], a[236:239], v[122:125]
    v_cmp_eq_u32 vcc, -1, v28
    s_nop 0
    s_cbranch_vccnz Lz8_r
Lz8_ok:
    v_mfma_f32_16x16x32_bf16 v[126:129], v[222:225], a[224:227], v[126:129]
    global_load_dwordx4 v[206:209], v30, s[58:59] offset:3072 sc1
    v_mfma_f32_16x16x32_bf16 v[130:133], v[222:225], a[228:231], v[130:133]
    v_mfma_f32_16x16x32_bf16 v[134:137], v[222:225], a[232:235], v[134:137]
    v_mfma_f32_16x16x32_bf16 v[138:141], v[222:225], a[236:239], v[138:141]
    v_mfma_f32_16x16x32_bf16 v[142:145], v[226:229], a[224:227], v[142:145]
    global_load_dwordx4 v[210:213], v31, s[58:59] offset:-3072 sc1
    v_mfma_f32_16x16x32_bf16 v[146:149], v[226:229], a[228:231], v[146:149]
    v_mfma_f32_16x16x32_bf16 v[150:153], v[226:229], a[232:235], v[150:153]
    s_waitcnt vmcnt(14)
    v_max_u32 v28, v238, v239
    v_mfma_f32_16x16x32_bf16 v[154:157], v[226:229], a[236:239], v[154:157]
    v_max3_u32 v28, v240, v241, v28
    v_mfma_f32_16x16x32_bf16 v[158:161], v[230:233], a[224:227], v[158:161]
    global_load_dwordx4 v[214:217], v31, s[58:59] offset:-2048 sc1
    s_waitcnt vmcnt(14)
    v_max3_u32 v28, v242, v243, v28
    v_mfma_f32_16x16x32_bf16 v[162:165], v[230:233], a[228:231], v[162:165]
    v_max3_u32 v28, v244, v245, v28
    v_mfma_f32_16x16x32_bf16 v[166:169], v[230:233], a[232:235], v[166:169]
    s_waitcnt vmcnt(13)
    v_max3_u32 v28, v246, v247, v28
    v_mfma_f32_16x16x32_bf16 v[170:173], v[230:233], a[236:239], v[170:173]
    v_max3_u32 v28, v248, v249, v28
    v_mfma_f32_16x16x32_bf16 v[62:65], v[234:237], a[240:243], v[62:65]
    global_load_dwordx4 v[218:221], v31, s[58:59] offset:-1024 sc1
    s_waitcnt vmcnt(13)
    v_max3_u32 v28, v250, v251, v28
    v_mfma_f32_16x16x32_bf16 v[66:69], v[234:237], a[244:247], v[66:69]
    v_max3_u32 v28, v252, v253, v28
    v_mfma_f32_16x16x32_bf16 v[70:73], v[234:237], a[248:251], v[70:73]
    v_mfma_f32_16x16x32_bf16 v[74:77], v[234:237], a[252:255], v[74:77]
    v_cmp_eq_u32 vcc, -1, v28
    s_nop 0
    s_cbranch_vccnz Lz9_r
Lz9_ok:
    v_mfma_f32_16x16x32_bf16 v[78:81], v[238:241], a[240:243], v[78:81]
    global_load_dwordx4 v[222:225], v31, s[58:59] offset:0 sc1
    v_mfma_f32_16x16x32_bf16 v[82:85], v[238:241], a[244:247], v[82:85]
    v_mfma_f32_16x16x32_bf16 v[86:89], v[238:241], a[248:251], v[86:89]
    v_mfma_f32_16x16x32_bf16 v[90:93], v[238:241], a[252:255], v[90:93]
    v_mfma_f32_16x16x32_bf16 v[94:97], v[242:245], a[240:243], v[94:97]
    global_load_dwordx4 v[226:229], v31, s[58:59] offset:1024 sc1
    v_mfma_f32_16x16x32_bf16 v[98:101], v[242:245], a[244:247], v[98:101]
    v_mfma_f32_16x16x32_bf16 v[102:105], v[242:245], a[248:251], v[102:105]
    s_waitcnt vmcnt(14)
    v_max_u32 v28, v174, v175
    v_mfma_f32_16x16x32_bf16 v[106:109], v[242:245], a[252:255], v[106:109]
    v_max3_u32 v28, v176, v177, v28
    v_mfma_f32_16x16x32_bf16 v[110:113], v[246:249], a[240:243], v[110:113]
    global_load_dwordx4 v[230:233], v31, s[58:59] offset:2048 sc1
    s_waitcnt vmcnt(13)
    v_max3_u32 v28, v178, v179, v28
    v_mfma_f32_16x16x32_bf16 v[114:117], v[246:249], a[244:247], v[114:117]
    v_max3_u32 v28, v180, v181, v28
    v_mfma_f32_16x16x32_bf16 v[118:121], v[246:249], a[248:251], v[118:121]
    s_waitcnt vmcnt(12)
    v_max3_u32 v28, v182, v183, v28
    v_mfma_f32_16x16x32_bf16 v[122:125], v[246:249], a[252:255], v[122:125]
    v_max3_u32 v28, v184, v185, v28
    v_mfma_f32_16x16x32_bf16 v[126:129], v[250:253], a[240:243], v[126:129]
    global_load_dwordx4 v[234:237], v31, s[58:59] offset:3072 sc1
    s_waitcnt vmcnt(12)
    v_max3_u32 v28, v186, v187, v28
    v_mfma_f32_16x16x32_bf16 v[130:133], v[250:253], a[244:247], v[130:133]
    v_max3_u32 v28, v188, v189, v28
    v_mfma_f32_16x16x32_bf16 v[134:137], v[250:253], a[248:251], v[134:137]
    v_mfma_f32_16x16x32_bf16 v[138:141], v[250:253], a[252:255], v[138:141]
    v_cmp_eq_u32 vcc, -1, v28
    s_nop 0
    s_cbranch_vccnz Lz10_r
Lz10_ok:
    v_mfma_f32_16x16x32_bf16 v[142:145], v[174:177], a[240:243], v[142:145]
    global_load_dwordx4 v[238:241], v30, s[60:61] offset:-3072 sc1
    v_mfma_f32_16x16x32_bf16 v[146:149], v[174:177], a[244:247], v[146:149]
    v_mfma_f32_16x16x32_bf16 v[150:153], v[174:177], a[248:251], v[150:153]
    v_mfma_f32_16x16x32_bf16 v[154:157], v[174:177], a[252:255], v[154:157]
    v_mfma_f32_16x16x32_bf16 v[158:161], v[178:181], a[240:243], v[158:161]
    global_load_dwordx4 v[242:245], v31, s[60:61] offset:-3072 sc1
    v_mfma_f32_16x16x32_bf16 v[162:165], v[178:181], a[244:247], v[162:165]
    v_mfma_f32_16x16x32_bf16 v[166:169], v[178:181], a[248:251], v[166:169]
    s_waitcnt vmcnt(13)
    v_max_u32 v28, v190, v191
    v_mfma_f32_16x16x32_bf16 v[170:173], v[178:181], a[252:255], v[170:173]
    v_max3_u32 v28, v192, v193, v28
    v_mfma_f32_16x16x32_bf16 v[62:65], v[182:185], a[0:3], v[62:65]
    global_load_dwordx4 v[246:249], v30, s[62:63] offset:-3072 sc1
    s_waitcnt vmcnt(13)
    v_max3_u32 v28, v194, v195, v28
    v_mfma_f32_16x16x32_bf16 v[66:69], v[182:185], a[4:7], v[66:69]
    v_max3_u32 v28, v196, v197, v28
    v_mfma_f32_16x16x32_bf16 v[70:73], v[182:185], a[8:11], v[70:73]
    s_waitcnt vmcnt(12)
    v_max3_u32 v28, v198, v199, v28
    v_mfma_f32_16x16x32_bf16 v[74:77], v[182:185], a[12:15], v[74:77]
    v_max3_u32 v28, v200, v201, v28
    v_mfma_f32_16x16x32_bf16 v[78:81], v[186:189], a[0:3], v[78:81]
    global_load_dwordx4 v[250:253], v31, s[62:63] offset:-3072 sc1
    s_waitcnt vmcnt(12)
    v_max3_u32 v28, v202, v203, v28
    v_mfma_f32_16x16x32_bf16 v[82:85], v[186:189], a[4:7], v[82:85]
    v_max3_u32 v28, v204, v205, v28
    v_mfma_f32_16x16x32_bf16 v[86:89], v[186:189], a[8:11], v[86:89]
    v_mfma_f32_16x16x32_bf16 v[90:93], v[186:189], a[12:15], v[90:93]
    v_cmp_eq_u32 vcc, -1, v28
    s_nop 0
    s_cbranch_vccnz Lz11_r
Lz11_ok:
    v_mfma_f32_16x16x32_bf16 v[94:97], v[190:193], a[0:3], v[94:97]
    global_load_dwordx4 v[174:177], v30, s[64:65] offset:-3072 sc1
    v_mfma_f32_16x16x32_bf16 v[98:101], v[190:193], a[4:7], v[98:101]
    v_mfma_f32_16x16x32_bf16 v[102:105], v[190:193], a[8:11], v[102:105]
    v_mfma_f32_16x16x32_bf16 v[106:109], v[190:193], a[12:15], v[106:109]
    v_mfma_f32_16x16x32_bf16 v[110:113], v[194:197], a[0:3], v[110:113]
    global_load_dwordx4 v[178:181], v31, s[64:65] offset:-3072 sc1
    v_mfma_f32_16x16x32_bf16 v[114:117], v[194:197], a[4:7], v[114:117]
    v_mfma_f32_16x16x32_bf16 v[118:121], v[194:197], a[8:11], v[118:121]
    s_waitcnt vmcnt(13)
    v_max_u32 v28, v206, v207
    v_mfma_f32_16x16x32_bf16 v[122:125], v[194:197], a[12:15], v[122:125]
    v_max3_u32 v28, v208, v209, v28
    v_mfma_f32_16x16x32_bf16 v[126:129], v[198:201], a[0:3], v[126:129]
    global_load_dwordx4 v[182:185], v30, s[66:67] offset:-3072 sc1
    s_waitcnt vmcnt(13)
    v_max3_u32 v28, v210, v211, v28
    v_mfma_f32_16x16x32_bf16 v[130:133], v[198:201], a[4:7], v[130:133]
    v_max3_u32 v28, v212, v213, v28
    v_mfma_f32_16x16x32_bf16 v[134:137], v[198:201], a[8:11], v[134:137]
    s_waitcnt vmcnt(12)
    v_max3_u32 v28, v214, v215, v28
    v_mfma_f32_16x16x32_bf16 v[138:141], v[198:201], a[12:15], v[138:141]
    v_max3_u32 v28, v216, v217, v28
    v_mfma_f32_16x16x32_bf16 v[142:145], v[202:205], a[0:3], v[142:145]
    global_load_dwordx4 v[186:189], v31, s[66:67] offset:-3072 sc1
    s_waitcnt vmcnt(12)
    v_max3_u32 v28, v218, v219, v28
    v_mfma_f32_16x16x32_bf16 v[146:149], v[202:205], a[4:7], v[146:149]
    v_max3_u32 v28, v220, v221, v28
    v_mfma_f32_16x16x32_bf16 v[150:153], v[202:205], a[8:11], v[150:153]
    v_mfma_f32_16x16x32_bf16 v[154:157], v[202:205], a[12:15], v[154:157]
    v_cmp_eq_u32 vcc, -1, v28
    s_nop 0
    s_cbranch_vccnz Lz12_r
Lz12_ok:
    v_mfma_f32_16x16x32_bf16 v[158:161], v[206:209], a[0:3], v[158:161]
    global_load_dwordx4 v[190:193], v30, s[60:61] offset:-2048 sc1
    v_mfma_f32_16x16x32_bf16 v[162:165], v[206:209], a[4:7], v[162:165]
    v_mfma_f32_16x16x32_bf16 v[166:169], v[206:209], a[8:11], v[166:169]
    v_mfma_f32_16x16x32_bf16 v[170:173], v[206:209], a[12:15], v[170:173]
    v_mfma_f32_16x16x32_bf16 v[62:65], v[210:213], a[16:19], v[62:65]
    global_load_dwordx4 v[194:197], v31, s[60:61] offset:-2048 sc1
    v_mfma_f32_16x16x32_bf16 v[66:69], v[210:213], a[20:23], v[66:69]
    v_mfma_f32_16x16x32_bf16 v[70:73], v[210:213], a[24:27], v[70:73]
    s_waitcnt vmcnt(13)
    v_max_u32 v28, v222, v223
    v_mfma_f32_16x16x32_bf16 v[74:77], v[210:213], a[28:31], v[74:77]
    v_max3_u32 v28, v224, v225, v28
    v_mfma_f32_16x16x32_bf16 v[78:81], v[214:217], a[16:19], v[78:81]
    global_load_dwordx4 v[198:201], v30, s[62:63] offset:-2048 sc1
    s_waitcnt vmcnt(13)
    v_max3_u32 v28, v226, v227, v28
    v_mfma_f32_16x16x32_bf16 v[82:85], v[214:217], a[20:23], v[82:85]
    v_max3_u32 v28, v228, v229, v28
    v_mfma_f32_16x16x32_bf16 v[86:89], v[214:217], a[24:27], v[86:89]
    s_waitcnt vmcnt(12)
    v_max3_u32 v28, v230, v231, v28
    v_mfma_f32_16x16x32_bf16 v[90:93], v[214:217], a[28:31], v[90:93]
    v_max3_u32 v28, v232, v233, v28
    v_mfma_f32_16x16x32_bf16 v[94:97], v[218:221], a[16:19], v[94:97]
    global_load_dwordx4 v[202:205], v31, s[62:63] offset:-2048 sc1
    s_waitcnt vmcnt(12)
    v_max3_u32 v28, v234, v235, v28
    v_mfma_f32_16x16x32_bf16 v[98:101], v[218:221], a[20:23], v[98:101]
    v_max3_u32 v28, v236, v237, v28
    v_mfma_f32_16x16x32_bf16 v[102:105], v[218:221], a[24:27], v[102:105]
    v_mfma_f32_16x16x32_bf16 v[106:109], v[218:221], a[28:31], v[106:109]
    v_cmp_eq_u32 vcc, -1, v28
    s_nop 0
    s_cbranch_vccnz Lz13_r
Lz13_ok:
    v_mfma_f32_16x16x32_bf16 v[110:113], v[222:225], a[16:19], v[110:113]
    global_load_dwordx4 v[206:209], v30, s[64:65] offset:-2048 sc1
    v_mfma_f32_16x16x32_bf16 v[114:117], v[222:225], a[20:23], v[114:117]
    v_mfma_f32_16x16x32_bf16 v[118:121], v[222:225], a[24:27], v[118:121]
    v_mfma_f32_16x16x32_bf16 v[122:125], v[222:225], a[28:31], v[122:125]
    v_mfma_f32_16x16x32_bf16 v[126:129], v[226:229], a[16:19], v[126:129]
    global_load_dwordx4 v[210:213], v31, s[64:65] offset:-2048 sc1
    v_mfma_f32_16x16x32_bf16 v[130:133], v[226:229], a[20:23], v[130:133]
    v_mfma_f32_16x16x32_bf16 v[134:137], v[226:229], a[24:27], v[134:137]
    s_waitcnt vmcnt(13)
    v_max_u32 v28, v238, v239
    v_mfma_f32_16x16x32_bf16 v[138:141], v[226:229], a[28:31], v[138:141]
    v_max3_u32 v28, v240, v241, v28
    v_mfma_f32_16x16x32_bf16 v[142:145], v[230:233], a[16:19], v[142:145]
    global_load_dwordx4 v[214:217], v30, s[66:67] offset:-2048 sc1
    s_waitcnt vmcnt(13)
    v_max3_u32 v28, v242, v243, v28
    v_mfma_f32_16x16x32_bf16 v[146:149], v[230:233], a[20:23], v[146:149]
    v_max3_u32 v28, v244, v245, v28
    v_mfma_f32_16x16x32_bf16 v[150:153], v[230:233], a[24:27], v[150:153]
    s_waitcnt vmcnt(12)
    v_max3_u32 v28, v246, v247, v28
    v_mfma_f32_16x16x32_bf16 v[154:157], v[230:233], a[28:31], v[154:157]
    v_max3_u32 v28, v248, v249, v28
    v_mfma_f32_16x16x32_bf16 v[158:161], v[234:237], a[16:19], v[158:161]
    global_load_dwordx4 v[218:221], v31, s[66:67] offset:-2048 sc1
    s_waitcnt vmcnt(12)
    v_max3_u32 v28, v250, v251, v28
    v_mfma_f32_16x16x32_bf16 v[162:165], v[234:237], a[20:23], v[162:165]
    v_max3_u32 v28, v252, v253, v28
    v_mfma_f32_16x16x32_bf16 v[166:169], v[234:237], a[24:27], v[166:169]
    v_mfma_f32_16x16x32_bf16 v[170:173], v[234:237], a[28:31], v[170:173]
    v_cmp_eq_u32 vcc, -1, v28
    s_nop 0
    s_cbranch_vccnz Lz14_r
Lz14_ok:
    v_mfma_f32_16x16x32_bf16 v[62:65], v[238:241], a[32:35], v[62:65]
    global_load_dwordx4 v[222:225], v30, s[60:61] offset:-1024 sc1
    v_mfma_f32_16x16x32_bf16 v[66:69], v[238:241], a[36:39], v[66:69]
    v_mfma_f32_16x16x32_bf16 v[70:73], v[238:241], a[40:43], v[70:73]
    v_mfma_f32_16x16x32_bf16 v[74:77], v[238:241], a[44:47], v[74:77]
    v_mfma_f32_16x16x32_bf16 v[62:65], v[242:245], a[48:51], v[62:65]
    global_load_dwordx4 v[226:229], v31, s[60:61] offset:-1024 sc1
    v_mfma_f32_16x16x32_bf16 v[66:69], v[242:245], a[52:55], v[66:69]
    v_mfma_f32_16x16x32_bf16 v[70:73], v[242:245], a[56:59], v[70:73]
    s_waitcnt vmcnt(13)
    v_max_u32 v28, v174, v175
    v_mfma_f32_16x16x32_bf16 v[74:77], v[242:245], a[60:63], v[74:77]
    v_max3_u32 v28, v176, v177, v28
    v_mfma_f32_16x16x32_bf16 v[62:65], v[246:249], a[64:67], v[62:65]
    global_load_dwordx4 v[230:233], v30, s[62:63] offset:-1024 sc1
    s_waitcnt vmcnt(13)
    v_max3_u32 v28, v178, v179, v28
    v_mfma_f32_16x16x32_bf16 v[66:69], v[246:249], a[68:71], v[66:69]
    v_max3_u32 v28, v180, v181, v28
    v_mfma_f32_16x16x32_bf16 v[70:73], v[246:249], a[72:75], v[70:73]
    s_waitcnt vmcnt(12)
    v_max3_u32 v28, v182, v183, v28
    v_mfma_f32_16x16x32_bf16 v[74:77], v[246:249], a[76:79], v[74:77]
    v_max3_u32 v28, v184, v185, v28
    v_mfma_f32_16x16x32_bf16 v[62:65], v[250:253], a[80:83], v[62:65]
    global_load_dwordx4 v[234:237], v31, s[62:63] offset:-1024 sc1
    s_waitcnt vmcnt(12)
    v_max3_u32 v28, v186, v187, v28
    v_mfma_f32_16x16x32_bf16 v[66:69], v[250:253], a[84:87], v[66:69]
    v_max3_u32 v28, v188, v189, v28
    v_mfma_f32_16x16x32_bf16 v[70:73], v[250:253], a[88:91], v[70:73]
    v_mfma_f32_16x16x32_bf16 v[74:77], v[250:253], a[92:95], v[74:77]
    v_cmp_eq_u32 vcc, -1, v28
    s_nop 0
    s_cbranch_vccnz Lz15_r
Lz15_ok:
    v_mfma_f32_16x16x32_bf16 v[62:65], v[174:177], a[96:99], v[62:65]
    global_load_dwordx4 v[238:241], v30, s[64:65] offset:-1024 sc1
    v_mfma_f32_16x16x32_bf16 v[66:69], v[174:177], a[100:103], v[66:69]
    v_mfma_f32_16x16x32_bf16 v[70:73], v[174:177], a[104:107], v[70:73]
    v_mfma_f32_16x16x32_bf16 v[74:77], v[174:177], a[108:111], v[74:77]
    v_mfma_f32_16x16x32_bf16 v[62:65], v[178:181], a[112:115], v[62:65]
    global_load_dwordx4 v[242:245], v31, s[64:65] offset:-1024 sc1
    v_mfma_f32_16x16x32_bf16 v[66:69], v[178:181], a[116:119], v[66:69]
    v_mfma_f32_16x16x32_bf16 v[70:73], v[178:181], a[120:123], v[70:73]
    s_waitcnt vmcnt(13)
    v_max_u32 v28, v190, v191
    v_mfma_f32_16x16x32_bf16 v[74:77], v[178:181], a[124:127], v[74:77]
    v_max3_u32 v28, v192, v193, v28
    v_mfma_f32_16x16x32_bf16 v[62:65], v[182:185], a[128:131], v[62:65]
    global_load_dwordx4 v[246:249], v30, s[66:67] offset:-1024 sc1
    s_waitcnt vmcnt(13)
    v_max3_u32 v28, v194, v195, v28
    v_mfma_f32_16x16x32_bf16 v[66:69], v[182:185], a[132:135], v[66:69]
    v_max3_u32 v28, v196, v197, v28
    v_mfma_f32_16x16x32_bf16 v[70:73], v[182:185], a[136:139], v[70:73]
    s_waitcnt vmcnt(12)
    v_max3_u32 v28, v198, v199, v28
    v_mfma_f32_16x16x32_bf16 v[74:77], v[182:185], a[140:143], v[74:77]
    v_max3_u32 v28, v200, v201, v28
    v_mfma_f32_16x16x32_bf16 v[62:65], v[186:189], a[144:147], v[62:65]
    global_load_dwordx4 v[250:253], v31, s[66:67] offset:-1024 sc1
    s_waitcnt vmcnt(12)
    v_max3_u32 v28, v202, v203, v28
    v_mfma_f32_16x16x32_bf16 v[66:69], v[186:189], a[148:151], v[66:69]
    v_max3_u32 v28, v204, v205, v28
    v_mfma_f32_16x16x32_bf16 v[70:73], v[186:189], a[152:155], v[70:73]
    v_mfma_f32_16x16x32_bf16 v[74:77], v[186:189], a[156:159], v[74:77]
    v_cmp_eq_u32 vcc, -1, v28
    s_nop 0
    s_cbranch_vccnz Lz16_r
Lz16_ok:
    v_mfma_f32_16x16x32_bf16 v[78:81], v[190:193], a[32:35], v[78:81]
    global_load_dwordx4 v[174:177], v30, s[60:61] offset:0 sc1
    v_mfma_f32_16x16x32_bf16 v[82:85], v[190:193], a[36:39], v[82:85]
    v_mfma_f32_16x16x32_bf16 v[86:89], v[190:193], a[40:43], v[86:89]
    v_mfma_f32_16x16x32_bf16 v[90:93], v[190:193], a[44:47], v[90:93]
    ds_write_b128 v20, v[66:69] offset:0
    v_mfma_f32_16x16x32_bf16 v[78:81], v[194:197], a[48:51], v[78:81]
    global_load_dwordx4 v[178:181], v31, s[60:61] offset:0 sc1
    v_mfma_f32_16x16x32_bf16 v[82:85], v[194:197], a[52:55], v[82:85]
    ds_write_b128 v21, v[70:73] offset:0
    v_mfma_f32_16x16x32_bf16 v[86:89], v[194:197], a[56:59], v[86:89]
    s_waitcnt vmcnt(13)
    v_max_u32 v28, v206, v207
    v_mfma_f32_16x16x32_bf16 v[90:93], v[194:197], a[60:63], v[90:93]
    v_max3_u32 v28, v208, v209, v28
    v_mfma_f32_16x16x32_bf16 v[78:81], v[198:201], a[64:67], v[78:81]
    global_load_dwordx4 v[182:185], v30, s[62:63] offset:0 sc1
    s_waitcnt vmcnt(13)
    v_max3_u32 v28, v210, v211, v28
    ds_write_b128 v22, v[74:77] offset:0
    v_mfma_f32_16x16x32_bf16 v[82:85], v[198:201], a[68:71], v[82:85]
    v_max3_u32 v28, v212, v213, v28
    v_mfma_f32_16x16x32_bf16 v[86:89], v[198:201], a[72:75], v[86:89]
    s_waitcnt vmcnt(12)
    v_max3_u32 v28, v214, v215, v28
    s_waitcnt lgkmcnt(0)
    s_barrier
    v_mfma_f32_16x16x32_bf16 v[90:93], v[198:201], a[76:79], v[90:93]
    v_max3_u32 v28, v216, v217, v28
    v_mfma_f32_16x16x32_bf16 v[78:81], v[202:205], a[80:83], v[78:81]
    global_load_dwordx4 v[186:189], v31, s[62:63] offset:0 sc1
    s_waitcnt vmcnt(12)
    v_max3_u32 v28, v218, v219, v28
    v_mfma_f32_16x16x32_bf16 v[82:85], v[202:205], a[84:87], v[82:85]
    v_max3_u32 v28, v220, v221, v28
    v_mfma_f32_16x16x32_bf16 v[86:89], v[202:205], a[88:91], v[86:89]
    v_mfma_f32_16x16x32_bf16 v[90:93], v[202:205], a[92:95], v[90:93]
    v_cmp_eq_u32 vcc, -1, v28
    s_nop 0
    s_cbranch_vccnz Lz17_r
Lz17_ok:
    v_mfma_f32_16x16x32_bf16 v[78:81], v[206:209], a[96:99], v[78:81]
    global_load_dwordx4 v[190:193], v30, s[64:65] offset:0 sc1
    ds_read_b128 v[66:69], v23 offset:0
    ds_read_b128 v[70:73], v23 offset:1024
    v_mfma_f32_16x16x32_bf16 v[82:85], v[206:209], a[100:103], v[82:85]
    ds_read_b128 v[74:77], v23 offset:2048
    v_lshlrev_b32 v12, 16, v48
    v_mfma_f32_16x16x32_bf16 v[86:89], v[206:209], a[104:107], v[86:89]
    v_and_b32 v13, 0xffff0000, v48
    v_lshlrev_b32 v14, 16, v49
    v_mfma_f32_16x16x32_bf16 v[90:93], v[206:209], a[108:111], v[90:93]
    v_and_b32 v15, 0xffff0000, v49
    v_mfma_f32_16x16x32_bf16 v[78:81], v[210:213], a[112:115], v[78:81]
    global_load_dwordx4 v[194:197], v31, s[64:65] offset:0 sc1
    s_waitcnt lgkmcnt(2)
    v_add_f32 v62, v62, v66
    v_add_f32 v63, v63, v67
    v_mfma_f32_16x16x32_bf16 v[82:85], v[210:213], a[116:119], v[82:85]
    v_add_f32 v64, v64, v68
    v_add_f32 v65, v65, v69
    v_mfma_f32_16x16x32_bf16 v[86:89], v[210:213], a[120:123], v[86:89]
    s_waitcnt vmcnt(13)
    v_max_u32 v28, v222, v223
    s_waitcnt lgkmcnt(1)
    v_add_f32 v62, v62, v70
    v_mfma_f32_16x16x32_bf16 v[90:93], v[210:213], a[124:127], v[90:93]
    v_max3_u32 v28, v224, v225, v28
    v_add_f32 v63, v63, v71
    v_add_f32 v64, v64, v72
    v_mfma_f32_16x16x32_bf16 v[78:81], v[214:217], a[128:131], v[78:81]
    global_load_dwordx4 v[198:201], v30, s[66:67] offset:0 sc1
    s_waitcnt vmcnt(13)
    v_max3_u32 v28, v226, v227, v28
    v_add_f32 v65, v65, v73
    s_waitcnt lgkmcnt(0)
    v_add_f32 v62, v62, v74
    v_mfma_f32_16x16x32_bf16 v[82:85], v[214:217], a[132:135], v[82:85]
    v_max3_u32 v28, v228, v229, v28
    v_add_f32 v63, v63, v75
    v_mfma_f32_16x16x32_bf16 v[86:89], v[214:217], a[136:139], v[86:89]
    s_waitcnt vmcnt(12)
    v_max3_u32 v28, v230, v231, v28
    v_add_f32 v64, v64, v76
    v_add_f32 v65, v65, v77
    v_mfma_f32_16x16x32_bf16 v[90:93], v[214:217], a[140:143], v[90:93]
    v_max3_u32 v28, v232, v233, v28
    v_mul_f32 v62, v62, v12
    v_mul_f32 v63, v63, v13
    v_mfma_f32_16x16x32_bf16 v[78:81], v[218:221], a[144:147], v[78:81]
    global_load_dwordx4 v[202:205], v31, s[66:67] offset:0 sc1
    s_waitcnt vmcnt(12)
    v_max3_u32 v28, v234, v235, v28
    v_mul_f32 v64, v64, v14
    v_mfma_f32_16x16x32_bf16 v[82:85], v[218:221], a[148:151], v[82:85]
    v_max3_u32 v28, v236, v237, v28
    v_mul_f32 v65, v65, v15
    v_cvt_pk_bf16_f32 v48, v62, v63
    v_mfma_f32_16x16x32_bf16 v[86:89], v[218:221], a[152:155], v[86:89]
    v_cvt_pk_bf16_f32 v49, v64, v65
    v_min_u32 v48, -2, v48
    v_mfma_f32_16x16x32_bf16 v[90:93], v[218:221], a[156:159], v[90:93]
    v_min_u32 v49, -2, v49
    v_cmp_eq_u32 vcc, -1, v28
    s_nop 0
    s_cbranch_vccnz Lz18_r
Lz18_ok:
    v_mfma_f32_16x16x32_bf16 v[94:97], v[222:225], a[32:35], v[94:97]
    global_load_dwordx4 v[206:209], v30, s[60:61] offset:1024 sc1
    v_mfma_f32_16x16x32_bf16 v[98:101], v[222:225], a[36:39], v[98:101]
    v_mfma_f32_16x16x32_bf16 v[102:105], v[222:225], a[40:43], v[102:105]
    v_mfma_f32_16x16x32_bf16 v[106:109], v[222:225], a[44:47], v[106:109]
    ds_write_b128 v20, v[82:85] offset:12288
    v_mfma_f32_16x16x32_bf16 v[94:97], v[226:229], a[48:51], v[94:97]
    global_load_dwordx4 v[210:213], v31, s[60:61] offset:1024 sc1
    v_mfma_f32_16x16x32_bf16 v[98:101], v[226:229], a[52:55], v[98:101]
    ds_write_b128 v21, v[86:89] offset:12288
    v_mfma_f32_16x16x32_bf16 v[102:105], v[226:229], a[56:59], v[102:105]
    s_waitcnt vmcnt(13)
    v_max_u32 v28, v238, v239
    v_mfma_f32_16x16x32_bf16 v[106:109], v[226:229], a[60:63], v[106:109]
    v_max3_u32 v28, v240, v241, v28
    v_mfma_f32_16x16x32_bf16 v[94:97], v[230:233], a[64:67], v[94:97]
    global_load_dwordx4 v[214:217], v30, s[62:63] offset:1024 sc1
    s_waitcnt vmcnt(13)
    v_max3_u32 v28, v242, v243, v28
    ds_write_b128 v22, v[90:93] offset:12288
    v_mfma_f32_16x16x32_bf16 v[98:101], v[230:233], a[68:71], v[98:101]
    v_max3_u32 v28, v244, v245, v28
    v_mfma_f32_16x16x32_bf16 v[102:105], v[230:233], a[72:75], v[102:105]
    s_waitcnt vmcnt(12)
    v_max3_u32 v28, v246, v247, v28
    s_waitcnt lgkmcnt(0)
    s_barrier
    v_mfma_f32_16x16x32_bf16 v[106:109], v[230:233], a[76:79], v[106:109]
    v_max3_u32 v28, v248, v249, v28
    v_mfma_f32_16x16x32_bf16 v[94:97], v[234:237], a[80:83], v[94:97]
    global_load_dwordx4 v[218:221], v31, s[62:63] offset:1024 sc1
    s_waitcnt vmcnt(12)
    v_max3_u32 v28, v250, v251, v28
    v_mfma_f32_16x16x32_bf16 v[98:101], v[234:237], a[84:87], v[98:101]
    v_max3_u32 v28, v252, v253, v28
    v_mfma_f32_16x16x32_bf16 v[102:105], v[234:237], a[88:91], v[102:105]
    v_mfma_f32_16x16x32_bf16 v[106:109], v[234:237], a[92:95], v[106:109]
    v_cmp_eq_u32 vcc, -1, v28
    s_nop 0
    s_cbranch_vccnz Lz19_r
Lz19_ok:
    v_mfma_f32_16x16x32_bf16 v[94:97], v[238:241], a[96:99], v[94:97]
    global_load_dwordx4 v[222:225], v30, s[64:65] offset:1024 sc1
    ds_read_b128 v[82:85], v23 offset:12288
    ds_read_b128 v[86:89], v23 offset:13312
    v_mfma_f32_16x16x32_bf16 v[98:101], v[238:241], a[100:103], v[98:101]
    ds_read_b128 v[90:93], v23 offset:14336
    v_lshlrev_b32 v12, 16, v50
    v_mfma_f32_16x16x32_bf16 v[102:105], v[238:241], a[104:107], v[102:105]
    v_and_b32 v13, 0xffff0000, v50
    v_lshlrev_b32 v14, 16, v51
    v_mfma_f32_16x16x32_bf16 v[106:109], v[238:241], a[108:111], v[106:109]
    v_and_b32 v15, 0xffff0000, v51
    v_mfma_f32_16x16x32_bf16 v[94:97], v[242:245], a[112:115], v[94:97]
    global_load_dwordx4 v[226:229], v31, s[64:65] offset:1024 sc1
    s_waitcnt lgkmcnt(2)
    v_add_f32 v78, v78, v82
    v_add_f32 v79, v79, v83
    v_mfma_f32_16x16x32_bf16 v[98:101], v[242:245], a[116:119], v[98:101]
    v_add_f32 v80, v80, v84
    v_add_f32 v81, v81, v85
    v_mfma_f32_16x16x32_bf16 v[102:105], v[242:245], a[120:123], v[102:105]
    s_waitcnt vmcnt(13)
    v_max_u32 v28, v174, v175
    s_waitcnt lgkmcnt(1)
    v_add_f32 v78, v78, v86
    v_mfma_f32_16x16x32_bf16 v[106:109], v[242:245], a[124:127], v[106:109]
    v_max3_u32 v28, v176, v177, v28
    v_add_f32 v79, v79, v87
    v_add_f32 v80, v80, v88
    v_mfma_f32_16x16x32_bf16 v[94:97], v[246:249], a[128:131], v[94:97]
    global_load_dwordx4 v[230:233], v30, s[66:67] offset:1024 sc1
    s_waitcnt vmcnt(13)
    v_max3_u32 v28, v178, v179, v28
    v_add_f32 v81, v81, v89
    s_waitcnt lgkmcnt(0)
    v_add_f32 v78, v78, v90
    v_mfma_f32_16x16x32_bf16 v[98:101], v[246:249], a[132:135], v[98:101]
    v_max3_u32 v28, v180, v181, v28
    v_add_f32 v79, v79, v91
    v_mfma_f32_16x16x32_bf16 v[102:105], v[246:249], a[136:139], v[102:105]
    s_waitcnt vmcnt(12)
    v_max3_u32 v28, v182, v183, v28
    v_add_f32 v80, v80, v92
    v_add_f32 v81, v81, v93
    v_mfma_f32_16x16x32_bf16 v[106:109], v[246:249], a[140:143], v[106:109]
    v_max3_u32 v28, v184, v185, v28
    v_mul_f32 v78, v78, v12
    v_mul_f32 v79, v79, v13
    v_mfma_f32_16x16x32_bf16 v[94:97], v[250:253], a[144:147], v[94:97]
    global_load_dwordx4 v[234:237], v31, s[66:67] offset:1024 sc1
    s_waitcnt vmcnt(12)
    v_max3_u32 v28, v186, v187, v28
    v_mul_f32 v80, v80, v14
    v_mfma_f32_16x16x32_bf16 v[98:101], v[250:253], a[148:151], v[98:101]
    v_max3_u32 v28, v188, v189, v28
    v_mul_f32 v81, v81, v15
    v_cvt_pk_bf16_f32 v50, v78, v79
    v_mfma_f32_16x16x32_bf16 v[102:105], v[250:253], a[152:155], v[102:105]
    v_cvt_pk_bf16_f32 v51, v80, v81
    v_min_u32 v50, -2, v50
    v_mfma_f32_16x16x32_bf16 v[106:109], v[250:253], a[156:159], v[106:109]
    v_min_u32 v51, -2, v51
    v_cmp_eq_u32 vcc, -1, v28
    s_nop 0
    s_cbranch_vccnz Lz20_r
Lz20_ok:
    v_mfma_f32_16x16x32_bf16 v[110:113], v[174:177], a[32:35], v[110:113]
    global_load_dwordx4 v[238:241], v30, s[60:61] offset:2048 sc1
    v_mfma_f32_16x16x32_bf16 v[114:117], v[174:177], a[36:39], v[114:117]
    v_mfma_f32_16x16x32_bf16 v[118:121], v[174:177], a[40:43], v[118:121]
    v_mfma_f32_16x16x32_bf16 v[122:125], v[174:177], a[44:47], v[122:125]
    ds_write_b128 v20, v[98:101] offset:0
    v_mfma_f32_16x16x32_bf16 v[110:113], v[178:181], a[48:51], v[110:113]
    global_load_dwordx4 v[242:245], v31, s[60:61] offset:2048 sc1
    v_mfma_f32_16x16x32_bf16 v[114:117], v[178:181], a[52:55], v[114:117]
    ds_write_b128 v21, v[102:105] offset:0
    v_mfma_f32_16x16x32_bf16 v[118:121], v[178:181], a[56:59], v[118:121]
    s_waitcnt vmcnt(13)
    v_max_u32 v28, v190, v191
    v_mfma_f32_16x16x32_bf16 v[122:125], v[178:181], a[60:63], v[122:125]
    v_max3_u32 v28, v192, v193, v28
    v_mfma_f32_16x16x32_bf16 v[110:113], v[182:185], a[64:67], v[110:113]
    global_load_dwordx4 v[246:249], v30, s[62:63] offset:2048 sc1
    s_waitcnt vmcnt(13)
    v_max3_u32 v28, v194, v195, v28
    ds_write_b128 v22, v[106:109] offset:0
    v_mfma_f32_16x16x32_bf16 v[114:117], v[182:185], a[68:71], v[114:117]
    v_max3_u32 v28, v196, v197, v28
    v_mfma_f32_16x16x32_bf16 v[118:121], v[182:185], a[72:75], v[118:121]
    s_waitcnt vmcnt(12)
    v_max3_u32 v28, v198, v199, v28
    s_waitcnt lgkmcnt(0)
    s_barrier
    v_mfma_f32_16x16x32_bf16 v[122:125], v[182:185], a[76:79], v[122:125]
    v_max3_u32 v28, v200, v201, v28
    v_mfma_f32_16x16x32_bf16 v[110:113], v[186:189], a[80:83], v[110:113]
    global_load_dwordx4 v[250:253], v31, s[62:63] offset:2048 sc1
    s_waitcnt vmcnt(12)
    v_max3_u32 v28, v202, v203, v28
    v_mfma_f32_16x16x32_bf16 v[114:117], v[186:189], a[84:87], v[114:117]
    v_max3_u32 v28, v204, v205, v28
    v_mfma_f32_16x16x32_bf16 v[118:121], v[186:189], a[88:91], v[118:121]
    v_mfma_f32_16x16x32_bf16 v[122:125], v[186:189], a[92:95], v[122:125]
    v_cmp_eq_u32 vcc, -1, v28
    s_nop 0
    s_cbranch_vccnz Lz21_r
Lz21_ok:
    v_mfma_f32_16x16x32_bf16 v[110:113], v[190:193], a[96:99], v[110:113]
    global_load_dwordx4 v[174:177], v30, s[64:65] offset:2048 sc1
    ds_read_b128 v[98:101], v23 offset:0
    ds_read_b128 v[102:105], v23 offset:1024
    v_mfma_f32_16x16x32_bf16 v[114:117], v[190:193], a[100:103], v[114:117]
    ds_read_b128 v[106:109], v23 offset:2048
    v_lshlrev_b32 v12, 16, v52
    v_mfma_f32_16x16x32_bf16 v[118:121], v[190:193], a[104:107], v[118:121]
    v_and_b32 v13, 0xffff0000, v52
    v_lshlrev_b32 v14, 16, v53
    v_mfma_f32_16x16x32_bf16 v[122:125], v[190:193], a[108:111], v[122:125]
    v_and_b32 v15, 0xffff0000, v53
    v_mfma_f32_16x16x32_bf16 v[110:113], v[194:197], a[112:115], v[110:113]
    global_load_dwordx4 v[178:181], v31, s[64:65] offset:2048 sc1
    s_waitcnt lgkmcnt(2)
    v_add_f32 v94, v94, v98
    v_add_f32 v95, v95, v99
    v_mfma_f32_16x16x32_bf16 v[114:117], v[194:197], a[116:119], v[114:117]
    v_add_f32 v96, v96, v100
    v_add_f32 v97, v97, v101
    v_mfma_f32_16x16x32_bf16 v[118:121], v[194:197], a[120:123], v[118:121]
    s_waitcnt vmcnt(13)
    v_max_u32 v28, v206, v207
    s_waitcnt lgkmcnt(1)
    v_add_f32 v94, v94, v102
    v_mfma_f32_16x16x32_bf16 v[122:125], v[194:197], a[124:127], v[122:125]
    v_max3_u32 v28, v208, v209, v28
    v_add_f32 v95, v95, v103
    v_add_f32 v96, v96, v104
    v_mfma_f32_16x16x32_bf16 v[110:113], v[198:201], a[128:131], v[110:113]
    global_load_dwordx4 v[182:185], v30, s[66:67] offset:2048 sc1
    s_waitcnt vmcnt(13)
    v_max3_u32 v28, v210, v211, v28
    v_add_f32 v97, v97, v105
    s_waitcnt lgkmcnt(0)
    v_add_f32 v94, v94, v106
    v_mfma_f32_16x16x32_bf16 v[114:117], v[198:201], a[132:135], v[114:117]
    v_max3_u32 v28, v212, v213, v28
    v_add_f32 v95, v95, v107
    v_mfma_f32_16x16x32_bf16 v[118:121], v[198:201], a[136:139], v[118:121]
    s_waitcnt vmcnt(12)
    v_max3_u32 v28, v214, v215, v28
    v_add_f32 v96, v96, v108
    v_add_f32 v97, v97, v109
    v_mfma_f32_16x16x32_bf16 v[122:125], v[198:201], a[140:143], v[122:125]
    v_max3_u32 v28, v216, v217, v28
    v_mul_f32 v94, v94, v12
    v_mul_f32 v95, v95, v13
    v_mfma_f32_16x16x32_bf16 v[110:113], v[202:205], a[144:147], v[110:113]
    global_load_dwordx4 v[186:189], v31, s[66:67] offset:2048 sc1
    s_waitcnt vmcnt(12)
    v_max3_u32 v28, v218, v219, v28
    v_mul_f32 v96, v96, v14
    v_mfma_f32_16x16x32_bf16 v[114:117], v[202:205], a[148:151], v[114:117]
    v_max3_u32 v28, v220, v221, v28
    v_mul_f32 v97, v97, v15
    v_cvt_pk_bf16_f32 v52, v94, v95
    v_mfma_f32_16x16x32_bf16 v[118:121], v[202:205], a[152:155], v[118:121]
    v_cvt_pk_bf16_f32 v53, v96, v97
    v_min_u32 v52, -2, v52
    v_mfma_f32_16x16x32_bf16 v[122:125], v[202:205], a[156:159], v[122:125]
    v_min_u32 v53, -2, v53
    v_cmp_eq_u32 vcc, -1, v28
    s_nop 0
    s_cbranch_vccnz Lz22_r
Lz22_ok:
    v_mfma_f32_16x16x32_bf16 v[126:129], v[206:209], a[32:35], v[126:129]
    global_load_dwordx4 v[190:193], v30, s[60:61] offset:3072 sc1
    v_mfma_f32_16x16x32_bf16 v[130:133], v[206:209], a[36:39], v[130:133]
    v_mfma_f32_16x16x32_bf16 v[134:137], v[206:209], a[40:43], v[134:137]
    v_mfma_f32_16x16x32_bf16 v[138:141], v[206:209], a[44:47], v[138:141]
    ds_write_b128 v20, v[114:117] offset:12288
    v_mfma_f32_16x16x32_bf16 v[126:129], v[210:213], a[48:51], v[126:129]
    global_load_dwordx4 v[194:197], v31, s[60:61] offset:3072 sc1
    v_mfma_f32_16x16x32_bf16 v[130:133], v[210:213], a[52:55], v[130:133]
    ds_write_b128 v21, v[118:121] offset:12288
    v_mfma_f32_16x16x32_bf16 v[134:137], v[210:213], a[56:59], v[134:137]
    s_waitcnt vmcnt(13)
    v_max_u32 v28, v222, v223
    v_mfma_f32_16x16x32_bf16 v[138:141], v[210:213], a[60:63], v[138:141]
    v_max3_u32 v28, v224, v225, v28
    v_mfma_f32_16x16x32_bf16 v[126:129], v[214:217], a[64:67], v[126:129]
    global_load_dwordx4 v[198:201], v30, s[62:63] offset:3072 sc1
    s_waitcnt vmcnt(13)
    v_max3_u32 v28, v226, v227, v28
    ds_write_b128 v22, v[122:125] offset:12288
    v_mfma_f32_16x16x32_bf16 v[130:133], v[214:217], a[68:71], v[130:133]
    v_max3_u32 v28, v228, v229, v28
    v_mfma_f32_16x16x32_bf16 v[134:137], v[214:217], a[72:75], v[134:137]
    s_waitcnt vmcnt(12)
    v_max3_u32 v28, v230, v231, v28
    s_waitcnt lgkmcnt(0)
    s_barrier
    v_mfma_f32_16x16x32_bf16 v[138:141], v[214:217], a[76:79], v[138:141]
    v_max3_u32 v28, v232, v233, v28
    v_mfma_f32_16x16x32_bf16 v[126:129], v[218:221], a[80:83], v[126:129]
    global_load_dwordx4 v[202:205], v31, s[62:63] offset:3072 sc1
    s_waitcnt vmcnt(12)
    v_max3_u32 v28, v234, v235, v28
    v_mfma_f32_16x16x32_bf16 v[130:133], v[218:221], a[84:87], v[130:133]
    v_max3_u32 v28, v236, v237, v28
    v_mfma_f32_16x16x32_bf16 v[134:137], v[218:221], a[88:91], v[134:137]
    v_mfma_f32_16x16x32_bf16 v[138:141], v[218:221], a[92:95], v[138:141]
    v_cmp_eq_u32 vcc, -1, v28
    s_nop 0
    s_cbranch_vccnz Lz23_r
Lz23_ok:
    v_mfma_f32_16x16x32_bf16 v[126:129], v[222:225], a[96:99], v[126:129]
    global_load_dwordx4 v[206:209], v30, s[64:65] offset:3072 sc1
    ds_read_b128 v[114:117], v23 offset:12288
    ds_read_b128 v[118:121], v23 offset:13312
    v_mfma_f32_16x16x32_bf16 v[130:133], v[222:225], a[100:103], v[130:133]
    ds_read_b128 v[122:125], v23 offset:14336
    v_lshlrev_b32 v12, 16, v54
    v_mfma_f32_16x16x32_bf16 v[134:137], v[222:225], a[104:107], v[134:137]
    v_and_b32 v13, 0xffff0000, v54
    v_lshlrev_b32 v14, 16, v55
    v_mfma_f32_16x16x32_bf16 v[138:141], v[222:225], a[108:111], v[138:141]
    v_and_b32 v15, 0xffff0000, v55
    v_mfma_f32_16x16x32_bf16 v[126:129], v[226:229], a[112:115], v[126:129]
    global_load_dwordx4 v[210:213], v31, s[64:65] offset:3072 sc1
    s_waitcnt lgkmcnt(2)
    v_add_f32 v110, v110, v114
    v_add_f32 v111, v111, v115
    v_mfma_f32_16x16x32_bf16 v[130:133], v[226:229], a[116:119], v[130:133]
    v_add_f32 v112, v112, v116
    v_add_f32 v113, v113, v117
    v_mfma_f32_16x16x32_bf16 v[134:137], v[226:229], a[120:123], v[134:137]
    s_waitcnt vmcnt(13)
    v_max_u32 v28, v238, v239
    s_waitcnt lgkmcnt(1)
    v_add_f32 v110, v110, v118
    v_mfma_f32_16x16x32_bf16 v[138:141], v[226:229], a[124:127], v[138:141]
    v_max3_u32 v28, v240, v241, v28
    v_add_f32 v111, v111, v119
    v_add_f32 v112, v112, v120
    v_mfma_f32_16x16x32_bf16 v[126:129], v[230:233], a[128:131], v[126:129]
    global_load_dwordx4 v[214:217], v30, s[66:67] offset:3072 sc1
    s_waitcnt vmcnt(13)
    v_max3_u32 v28, v242, v243, v28
    v_add_f32 v113, v113, v121
    s_waitcnt lgkmcnt(0)
    v_add_f32 v110, v110, v122
    v_mfma_f32_16x16x32_bf16 v[130:133], v[230:233], a[132:135], v[130:133]
    v_max3_u32 v28, v244, v245, v28
    v_add_f32 v111, v111, v123
    v_mfma_f32_16x16x32_bf16 v[134:137], v[230:233], a[136:139], v[134:137]
    s_waitcnt vmcnt(12)
    v_max3_u32 v28, v246, v247, v28
    v_add_f32 v112, v112, v124
    v_add_f32 v113, v113, v125
    v_mfma_f32_16x16x32_bf16 v[138:141], v[230:233], a[140:143], v[138:141]
    v_max3_u32 v28, v248, v249, v28
    v_mul_f32 v110, v110, v12
    v_mul_f32 v111, v111, v13
    v_mfma_f32_16x16x32_bf16 v[126:129], v[234:237], a[144:147], v[126:129]
    global_load_dwordx4 v[218:221], v31, s[66:67] offset:3072 sc1
    s_waitcnt vmcnt(12)
    v_max3_u32 v28, v250, v251, v28
    v_mul_f32 v112, v112, v14
    v_mfma_f32_16x16x32_bf16 v[130:133], v[234:237], a[148:151], v[130:133]
    v_max3_u32 v28, v252, v253, v28
    v_mul_f32 v113, v113, v15
    v_cvt_pk_bf16_f32 v54, v110, v111
    v_mfma_f32_16x16x32_bf16 v[134:137], v[234:237], a[152:155], v[134:137]
    v_cvt_pk_bf16_f32 v55, v112, v113
    v_min_u32 v54, -2, v54
    v_mfma_f32_16x16x32_bf16 v[138:141], v[234:237], a[156:159], v[138:141]
    v_min_u32 v55, -2, v55
    v_cmp_eq_u32 vcc, -1, v28
    s_nop 0
    s_cbranch_vccnz Lz24_r
Lz24_ok:
    v_mfma_f32_16x16x32_bf16 v[142:145], v[238:241], a[32:35], v[142:145]
    global_store_dwordx4 v24, v[48:51], s[38:39] offset:0 sc1
    v_mfma_f32_16x16x32_bf16 v[146:149], v[238:241], a[36:39], v[146:149]
    v_mfma_f32_16x16x32_bf16 v[150:153], v[238:241], a[40:43], v[150:153]
    global_store_dwordx4 v24, v[52:55], s[38:39] offset:1024 sc1
    v_mfma_f32_16x16x32_bf16 v[154:157], v[238:241], a[44:47], v[154:157]
    ds_write_b128 v20, v[130:133] offset:0
    v_mfma_f32_16x16x32_bf16 v[142:145], v[242:245], a[48:51], v[142:145]
    v_mfma_f32_16x16x32_bf16 v[146:149], v[242:245], a[52:55], v[146:149]
    global_load_lds_dwordx4 v4, s[92:93] offset:2048 sc1
    ds_write_b128 v21, v[134:137] offset:0
    v_mfma_f32_16x16x32_bf16 v[150:153], v[242:245], a[56:59], v[150:153]
    s_waitcnt vmcnt(14)
    v_max_u32 v28, v174, v175
    v_mfma_f32_16x16x32_bf16 v[154:157], v[242:245], a[60:63], v[154:157]
    v_max3_u32 v28, v176, v177, v28
    v_mfma_f32_16x16x32_bf16 v[142:145], v[246:249], a[64:67], v[142:145]
    global_load_lds_dwordx4 v4, s[92:93] offset:3072 sc1
    s_waitcnt vmcnt(14)
    v_max3_u32 v28, v178, v179, v28
    ds_write_b128 v22, v[138:141] offset:0
    v_mfma_f32_16x16x32_bf16 v[146:149], v[246:249], a[68:71], v[146:149]
    v_max3_u32 v28, v180, v181, v28
    v_mfma_f32_16x16x32_bf16 v[150:153], v[246:249], a[72:75], v[150:153]
    s_add_u32 m0, s95, 20480
    s_add_u32 s92, s92, 4096
    s_addc_u32 s93, s93, 0
    global_load_lds_dwordx4 v4, s[92:93] offset:0 sc1
    s_waitcnt vmcnt(14)
    v_max3_u32 v28, v182, v183, v28
    s_waitcnt lgkmcnt(0)
    s_barrier
    v_mfma_f32_16x16x32_bf16 v[154:157], v[246:249], a[76:79], v[154:157]
    v_max3_u32 v28, v184, v185, v28
    v_mfma_f32_16x16x32_bf16 v[142:145], v[250:253], a[80:83], v[142:145]
    s_waitcnt vmcnt(13)
    v_max3_u32 v28, v186, v187, v28
    v_mfma_f32_16x16x32_bf16 v[146:149], v[250:253], a[84:87], v[146:149]
    global_load_lds_dwordx4 v4, s[92:93] offset:1024 sc1
    v_max3_u32 v28, v188, v189, v28
    v_mfma_f32_16x16x32_bf16 v[150:153], v[250:253], a[88:91], v[150:153]
    v_mfma_f32_16x16x32_bf16 v[154:157], v[250:253], a[92:95], v[154:157]
    v_cmp_eq_u32 vcc, -1, v28
    s_nop 0
    s_cbranch_vccnz Lz25_r
Lz25_ok:
    v_mfma_f32_16x16x32_bf16 v[142:145], v[174:177], a[96:99], v[142:145]
    global_load_lds_dwordx4 v4, s[92:93] offset:2048 sc1
    ds_read_b128 v[130:133], v23 offset:0
    ds_read_b128 v[134:137], v23 offset:1024
    v_mfma_f32_16x16x32_bf16 v[146:149], v[174:177], a[100:103], v[146:149]
    ds_read_b128 v[138:141], v23 offset:2048
    v_lshlrev_b32 v12, 16, v56
    v_mfma_f32_16x16x32_bf16 v[150:153], v[174:177], a[104:107], v[150:153]
    v_and_b32 v13, 0xffff0000, v56
    v_lshlrev_b32 v14, 16, v57
    v_mfma_f32_16x16x32_bf16 v[154:157], v[174:177], a[108:111], v[154:157]
    v_and_b32 v15, 0xffff0000, v57
    v_mfma_f32_16x16x32_bf16 v[142:145], v[178:181], a[112:115], v[142:145]
    global_load_lds_dwordx4 v4, s[92:93] offset:3072 sc1
    s_waitcnt lgkmcnt(2)
    v_add_f32 v126, v126, v130
    v_add_f32 v127, v127, v131
    v_mfma_f32_16x16x32_bf16 v[146:149], v[178:181], a[116:119], v[146:149]
    v_add_f32 v128, v128, v132
    v_add_f32 v129, v129, v133
    v_mfma_f32_16x16x32_bf16 v[150:153], v[178:181], a[120:123], v[150:153]
    s_waitcnt vmcnt(15)
    v_max_u32 v28, v190, v191
    s_waitcnt lgkmcnt(1)
    v_add_f32 v126, v126, v134
    v_mfma_f32_16x16x32_bf16 v[154:157], v[178:181], a[124:127], v[154:157]
    v_max3_u32 v28, v192, v193, v28
    v_add_f32 v127, v127, v135
    v_add_f32 v128, v128, v136
    v_mfma_f32_16x16x32_bf16 v[142:145], v[182:185], a[128:131], v[142:145]
    s_add_u32 m0, s95, 24576
    s_add_u32 s92, s92, 4096
    s_addc_u32 s93, s93, 0
    global_load_lds_dwordx4 v4, s[92:93] offset:0 sc1
    s_waitcnt vmcnt(15)
    v_max3_u32 v28, v194, v195, v28
    v_add_f32 v129, v129, v137
    s_waitcnt lgkmcnt(0)
    v_add_f32 v126, v126, v138
    v_mfma_f32_16x16x32_bf16 v[146:149], v[182:185], a[132:135], v[146:149]
    v_max3_u32 v28, v196, v197, v28
    v_add_f32 v127, v127, v139
    v_mfma_f32_16x16x32_bf16 v[150:153], v[182:185], a[136:139], v[150:153]
    s_waitcnt vmcnt(14)
    v_max3_u32 v28, v198, v199, v28
    v_add_f32 v128, v128, v140
    v_add_f32 v129, v129, v141
    v_mfma_f32_16x16x32_bf16 v[154:157], v[182:185], a[140:143], v[154:157]
    v_max3_u32 v28, v200, v201, v28
    v_mul_f32 v126, v126, v12
    v_mul_f32 v127, v127, v13
    v_mfma_f32_16x16x32_bf16 v[142:145], v[186:189], a[144:147], v[142:145]
    global_load_lds_dwordx4 v4, s[92:93] offset:1024 sc1
    s_waitcnt vmcnt(14)
    v_max3_u32 v28, v202, v203, v28
    v_mul_f32 v128, v128, v14
    v_mfma_f32_16x16x32_bf16 v[146:149], v[186:189], a[148:151], v[146:149]
    v_max3_u32 v28, v204, v205, v28
    v_mul_f32 v129, v129, v15
    v_cvt_pk_bf16_f32 v56, v126, v127
    v_mfma_f32_16x16x32_bf16 v[150:153], v[186:189], a[152:155], v[150:153]
    v_cvt_pk_bf16_f32 v57, v128, v129
    v_min_u32 v56, -2, v56
    v_mfma_f32_16x16x32_bf16 v[154:157], v[186:189], a[156:159], v[154:157]
    v_min_u32 v57, -2, v57
    v_cmp_eq_u32 vcc, -1, v28
    s_nop 0
    s_cbranch_vccnz Lz26_r
Lz26_ok:
    v_mfma_f32_16x16x32_bf16 v[158:161], v[190:193], a[32:35], v[158:161]
    global_load_lds_dwordx4 v4, s[92:93] offset:2048 sc1
    v_mfma_f32_16x16x32_bf16 v[162:165], v[190:193], a[36:39], v[162:165]
    v_mfma_f32_16x16x32_bf16 v[166:169], v[190:193], a[40:43], v[166:169]
    v_mfma_f32_16x16x32_bf16 v[170:173], v[190:193], a[44:47], v[170:173]
    ds_write_b128 v20, v[146:149] offset:12288
    v_mfma_f32_16x16x32_bf16 v[158:161], v[194:197], a[48:51], v[158:161]
    global_load_lds_dwordx4 v4, s[92:93] offset:3072 sc1
    v_mfma_f32_16x16x32_bf16 v[162:165], v[194:197], a[52:55], v[162:165]
    ds_write_b128 v21, v[150:153] offset:12288
    v_mfma_f32_16x16x32_bf16 v[166:169], v[194:197], a[56:59], v[166:169]
    s_waitcnt vmcnt(15)
    v_max_u32 v28, v206, v207
    v_mfma_f32_16x16x32_bf16 v[170:173], v[194:197], a[60:63], v[170:173]
    v_max3_u32 v28, v208, v209, v28
    v_mfma_f32_16x16x32_bf16 v[158:161], v[198:201], a[64:67], v[158:161]
    s_add_u32 m0, s95, 28672
    s_add_u32 s92, s92, 4096
    s_addc_u32 s93, s93, 0
    global_load_lds_dwordx4 v4, s[92:93] offset:0 sc1
    s_waitcnt vmcnt(15)
    v_max3_u32 v28, v210, v211, v28
    ds_write_b128 v22, v[154:157] offset:12288
    v_mfma_f32_16x16x32_bf16 v[162:165], v[198:201], a[68:71], v[162:165]
    v_max3_u32 v28, v212, v213, v28
    v_mfma_f32_16x16x32_bf16 v[166:169], v[198:201], a[72:75], v[166:169]
    s_waitcnt vmcnt(14)
    v_max3_u32 v28, v214, v215, v28
    s_waitcnt lgkmcnt(0)
    s_barrier
    v_mfma_f32_16x16x32_bf16 v[170:173], v[198:201], a[76:79], v[170:173]
    v_max3_u32 v28, v216, v217, v28
    v_mfma_f32_16x16x32_bf16 v[158:161], v[202:205], a[80:83], v[158:161]
    global_load_lds_dwordx4 v4, s[92:93] offset:1024 sc1
    s_waitcnt vmcnt(14)
    v_max3_u32 v28, v218, v219, v28
    v_mfma_f32_16x16x32_bf16 v[162:165], v[202:205], a[84:87], v[162:165]
    v_max3_u32 v28, v220, v221, v28
    v_mfma_f32_16x16x32_bf16 v[166:169], v[202:205], a[88:91], v[166:169]
    v_mfma_f32_16x16x32_bf16 v[170:173], v[202:205], a[92:95], v[170:173]
    v_cmp_eq_u32 vcc, -1, v28
    s_nop 0
    s_cbranch_vccnz Lz27_r
Lz27_ok:
    v_mfma_f32_16x16x32_bf16 v[158:161], v[206:209], a[96:99], v[158:161]
    global_load_lds_dwordx4 v4, s[92:93] offset:2048 sc1
    ds_read_b128 v[146:149], v23 offset:12288
    ds_read_b128 v[150:153], v23 offset:13312
    v_mfma_f32_16x16x32_bf16 v[162:165], v[206:209], a[100:103], v[162:165]
    ds_read_b128 v[154:157], v23 offset:14336
    v_lshlrev_b32 v12, 16, v58
    v_mfma_f32_16x16x32_bf16 v[166:169], v[206:209], a[104:107], v[166:169]
    v_and_b32 v13, 0xffff0000, v58
    v_lshlrev_b32 v14, 16, v59
    v_mfma_f32_16x16x32_bf16 v[170:173], v[206:209], a[108:111], v[170:173]
    v_and_b32 v15, 0xffff0000, v59
    v_mfma_f32_16x16x32_bf16 v[158:161], v[210:213], a[112:115], v[158:161]
    global_load_lds_dwordx4 v4, s[92:93] offset:3072 sc1
    s_waitcnt lgkmcnt(2)
    v_add_f32 v142, v142, v146
    v_add_f32 v143, v143, v147
    v_mfma_f32_16x16x32_bf16 v[162:165], v[210:213], a[116:119], v[162:165]
    v_add_f32 v144, v144, v148
    v_add_f32 v145, v145, v149
    v_mfma_f32_16x16x32_bf16 v[166:169], v[210:213], a[120:123], v[166:169]
    s_waitcnt lgkmcnt(1)
    v_add_f32 v142, v142, v150
    v_mfma_f32_16x16x32_bf16 v[170:173], v[210:213], a[124:127], v[170:173]
    v_add_f32 v143, v143, v151
    v_add_f32 v144, v144, v152
    v_mfma_f32_16x16x32_bf16 v[158:161], v[214:217], a[128:131], v[158:161]
    s_add_u32 m0, s95, 32768
    s_add_u32 s92, s92, 4096
    s_addc_u32 s93, s93, 0
    global_load_lds_dwordx4 v4, s[92:93] offset:0 sc1
    v_add_f32 v145, v145, v153
    s_waitcnt lgkmcnt(0)
    v_add_f32 v142, v142, v154
    v_mfma_f32_16x16x32_bf16 v[162:165], v[214:217], a[132:135], v[162:165]
    v_add_f32 v143, v143, v155
    v_mfma_f32_16x16x32_bf16 v[166:169], v[214:217], a[136:139], v[166:169]
    v_add_f32 v144, v144, v156
    v_add_f32 v145, v145, v157
    v_mfma_f32_16x16x32_bf16 v[170:173], v[214:217], a[140:143], v[170:173]
    v_mul_f32 v142, v142, v12
    v_mul_f32 v143, v143, v13
    v_mfma_f32_16x16x32_bf16 v[158:161], v[218:221], a[144:147], v[158:161]
    global_load_lds_dwordx4 v4, s[92:93] offset:1024 sc1
    v_mul_f32 v144, v144, v14
    v_mfma_f32_16x16x32_bf16 v[162:165], v[218:221], a[148:151], v[162:165]
    v_mul_f32 v145, v145, v15
    v_cvt_pk_bf16_f32 v58, v142, v143
    v_mfma_f32_16x16x32_bf16 v[166:169], v[218:221], a[152:155], v[166:169]
    v_cvt_pk_bf16_f32 v59, v144, v145
    v_min_u32 v58, -2, v58
    v_mfma_f32_16x16x32_bf16 v[170:173], v[218:221], a[156:159], v[170:173]
    v_min_u32 v59, -2, v59
    global_store_dwordx4 v24, v[56:59], s[38:39] offset:2048 sc1
    ds_write_b128 v20, v[162:165] offset:0
    s_nop 1
    ds_write_b128 v21, v[166:169] offset:0
    s_nop 1
    ds_write_b128 v22, v[170:173] offset:0
    s_waitcnt lgkmcnt(0)
    s_barrier
    ds_read_b128 v[162:165], v23 offset:0
    ds_read_b128 v[166:169], v23 offset:1024
    ds_read_b128 v[170:173], v23 offset:2048
    v_lshlrev_b32 v12, 16, v60
    v_and_b32 v13, 0xffff0000, v60
    v_lshlrev_b32 v14, 16, v61
    v_and_b32 v15, 0xffff0000, v61
    s_waitcnt lgkmcnt(2)
    v_pk_add_f32 v[158:159], v[158:159], v[162:163] op_sel:[0,0] op_sel_hi:[1,1]
    v_pk_add_f32 v[160:161], v[160:161], v[164:165] op_sel:[0,0] op_sel_hi:[1,1]
    s_waitcnt lgkmcnt(1)
    v_pk_add_f32 v[158:159], v[158:159], v[166:167] op_sel:[0,0] op_sel_hi:[1,1]
    v_pk_add_f32 v[160:161], v[160:161], v[168:169] op_sel:[0,0] op_sel_hi:[1,1]
    s_waitcnt lgkmcnt(0)
    v_pk_add_f32 v[158:159], v[158:159], v[170:171] op_sel:[0,0] op_sel_hi:[1,1]
    v_pk_add_f32 v[160:161], v[160:161], v[172:173] op_sel:[0,0] op_sel_hi:[1,1]
    v_pk_mul_f32 v[158:159], v[158:159], v[12:13] op_sel:[0,0] op_sel_hi:[1,1]
    v_pk_mul_f32 v[160:161], v[160:161], v[14:15] op_sel:[0,0] op_sel_hi:[1,1]
    v_cvt_pk_bf16_f32 v60, v158, v159
    v_cvt_pk_bf16_f32 v61, v160, v161
    v_min_u32 v60, -2, v60
    v_min_u32 v61, -2, v61
    global_store_dwordx2 v25, v[60:61], s[38:39] sc1
    v_mov_b32 v30, v4
    v_add_u32 v31, 61440, v4
    v_add_u32 v20, 122880, v4
    s_mul_i32 s5, s41, 320
    s_add_u32 s5, s5, 12800
    v_lshl_add_u32 v28, v3, 5, s5
    v_lshl_add_u32 v29, v3, 4, s5
    global_load_dwordx4 v[218:221], v28, s[38:39] offset:0 sc1
    global_load_dwordx4 v[222:225], v28, s[38:39] offset:16 sc1
    global_load_dwordx4 v[226:229], v28, s[38:39] offset:128 sc1
    global_load_dwordx4 v[230:233], v28, s[38:39] offset:144 sc1
    global_load_dwordx4 v[234:237], v29, s[38:39] offset:256 sc1
    s_add_u32 s5, s5, 15360
    v_lshl_add_u32 v28, v3, 5, s5
    v_lshl_add_u32 v29, v3, 4, s5
    global_load_dwordx4 v[238:241], v28, s[38:39] offset:0 sc1
    global_load_dwordx4 v[242:245], v28, s[38:39] offset:16 sc1
    global_load_dwordx4 v[246:249], v28, s[38:39] offset:128 sc1
    global_load_dwordx4 v[250:253], v28, s[38:39] offset:144 sc1
    global_load_dwordx4 v[12:15], v29, s[38:39] offset:256 sc1
    s_add_u32 s5, s5, 15360
    global_load_dwordx4 v[62:65], v6, s[38:39] offset:-4096 sc1
    global_load_dwordx4 v[66:69], v6, s[38:39] offset:0 sc1
    global_load_dwordx4 v[70:73], v6, s[38:39] offset:3072 sc1
    global_load_dwordx4 v[74:77], v7, s[38:39] offset:-1024 sc1
    global_load_dwordx4 v[78:81], v7, s[38:39] offset:2048 sc1
    global_load_dwordx4 v[82:85], v26, s[38:39] offset:-2048 sc1
    global_load_dwordx4 v[86:89], v26, s[38:39] offset:1024 sc1
    global_load_dwordx4 v[90:93], v27, s[38:39] offset:-3072 sc1
    global_load_dwordx4 v[94:97], v6, s[38:39] offset:-3072 sc1
    global_load_dwordx4 v[98:101], v6, s[38:39] offset:1024 sc1
    global_load_dwordx4 v[102:105], v7, s[38:39] offset:-4096 sc1
    global_load_dwordx4 v[106:109], v7, s[38:39] offset:0 sc1
    global_load_dwordx4 v[110:113], v7, s[38:39] offset:3072 sc1
    global_load_dwordx4 v[114:117], v26, s[38:39] offset:-1024 sc1
    global_load_dwordx4 v[118:121], v26, s[38:39] offset:2048 sc1
    global_load_dwordx4 v[122:125], v27, s[38:39] offset:-2048 sc1
    s_waitcnt vmcnt(28)
    s_barrier
    ds_read_b128 v[194:197], v30 offset:0
    ds_read_b128 v[198:201], v30 offset:1024
    ds_read_b128 v[202:205], v30 offset:2048
    ds_read_b128 v[206:209], v30 offset:3072
    ds_read_b128 v[210:213], v30 offset:4096
    s_waitcnt vmcnt(15)
    v_max_u32 v28, v62, v63
    v_max3_u32 v28, v64, v65, v28
    s_waitcnt vmcnt(14)
    v_max3_u32 v28, v66, v67, v28
    v_max3_u32 v28, v68, v69, v28
    s_waitcnt vmcnt(13)
    v_max3_u32 v28, v70, v71, v28
    v_max3_u32 v28, v72, v73, v28
    s_waitcnt vmcnt(12)
    v_max3_u32 v28, v74, v75, v28
    v_max3_u32 v28, v76, v77, v28
    s_waitcnt vmcnt(11)
    v_max3_u32 v28, v78, v79, v28
    v_max3_u32 v28, v80, v81, v28
    s_waitcnt vmcnt(10)
    v_max3_u32 v28, v82, v83, v28
    v_max3_u32 v28, v84, v85, v28
    s_waitcnt vmcnt(9)
    v_max3_u32 v28, v86, v87, v28
    v_max3_u32 v28, v88, v89, v28
    s_waitcnt vmcnt(8)
    v_max3_u32 v28, v90, v91, v28
    v_max3_u32 v28, v92, v93, v28
    v_cmp_eq_u32 vcc, -1, v28
    s_nop 0
    s_cbranch_vccnz Lp0_r
Lp0_ok:
    s_waitcnt lgkmcnt(4)
    v_mfma_f32_16x16x32_bf16 v[174:177], v[194:197], v[62:65], 0
    ds_read_b128 v[214:217], v30 offset:20480
    s_waitcnt lgkmcnt(4)
    v_mfma_f32_16x16x32_bf16 v[178:181], v[198:201], v[62:65], 0
    ds_read_b128 v[194:197], v30 offset:21504
    s_waitcnt lgkmcnt(4)
    v_mfma_f32_16x16x32_bf16 v[182:185], v[202:205], v[62:65], 0
    ds_read_b128 v[198:201], v30 offset:22528
    s_waitcnt lgkmcnt(4)
    v_mfma_f32_16x16x32_bf16 v[186:189], v[206:209], v[62:65], 0
    ds_read_b128 v[202:205], v30 offset:23552
    s_waitcnt lgkmcnt(4)
    v_mfma_f32_16x16x32_bf16 v[190:193], v[210:213], v[62:65], 0
    ds_read_b128 v[206:209], v30 offset:24576
    s_waitcnt lgkmcnt(4)
    v_mfma_f32_16x16x32_bf16 v[174:177], v[214:217], v[66:69], v[174:177]
    ds_read_b128 v[210:213], v30 offset:35840
    s_waitcnt lgkmcnt(4)
    v_mfma_f32_16x16x32_bf16 v[178:181], v[194:197], v[66:69], v[178:181]
    ds_read_b128 v[214:217], v30 offset:36864
    s_waitcnt lgkmcnt(4)
    v_mfma_f32_16x16x32_bf16 v[182:185], v[198:201], v[66:69], v[182:185]
    ds_read_b128 v[194:197], v30 offset:37888
    s_waitcnt lgkmcnt(4)
    v_mfma_f32_16x16x32_bf16 v[186:189], v[202:205], v[66:69], v[186:189]
    ds_read_b128 v[198:201], v30 offset:38912
    s_waitcnt lgkmcnt(4)
    v_mfma_f32_16x16x32_bf16 v[190:193], v[206:209], v[66:69], v[190:193]
    ds_read_b128 v[202:205], v30 offset:39936
    s_waitcnt lgkmcnt(4)
    v_mfma_f32_16x16x32_bf16 v[174:177], v[210:213], v[70:73], v[174:177]
    ds_read_b128 v[206:209], v30 offset:56320
    s_waitcnt lgkmcnt(4)
    v_mfma_f32_16x16x32_bf16 v[178:181], v[214:217], v[70:73], v[178:181]
    ds_read_b128 v[210:213], v30 offset:57344
    s_waitcnt lgkmcnt(4)
    v_mfma_f32_16x16x32_bf16 v[182:185], v[194:197], v[70:73], v[182:185]
    ds_read_b128 v[214:217], v30 offset:58368
    s_waitcnt lgkmcnt(4)
    v_mfma_f32_16x16x32_bf16 v[186:189], v[198:201], v[70:73], v[186:189]
    ds_read_b128 v[194:197], v30 offset:59392
    s_waitcnt lgkmcnt(4)
    v_mfma_f32_16x16x32_bf16 v[190:193], v[202:205], v[70:73], v[190:193]
    ds_read_b128 v[198:201], v30 offset:60416
    s_waitcnt lgkmcnt(4)
    v_mfma_f32_16x16x32_bf16 v[174:177], v[206:209], v[74:77], v[174:177]
    ds_read_b128 v[202:205], v31 offset:10240
    s_waitcnt lgkmcnt(4)
    v_mfma_f32_16x16x32_bf16 v[178:181], v[210:213], v[74:77], v[178:181]
    ds_read_b128 v[206:209], v31 offset:11264
    s_waitcnt lgkmcnt(4)
    v_mfma_f32_16x16x32_bf16 v[182:185], v[214:217], v[74:77], v[182:185]
    ds_read_b128 v[210:213], v31 offset:12288
    s_waitcnt lgkmcnt(4)
    v_mfma_f32_16x16x32_bf16 v[186:189], v[194:197], v[74:77], v[186:189]
    ds_read_b128 v[214:217], v31 offset:13312
    s_waitcnt lgkmcnt(4)
    v_mfma_f32_16x16x32_bf16 v[190:193], v[198:201], v[74:77], v[190:193]
    ds_read_b128 v[194:197], v31 offset:14336
    s_waitcnt lgkmcnt(4)
    v_mfma_f32_16x16x32_bf16 v[174:177], v[202:205], v[78:81], v[174:177]
    ds_read_b128 v[198:201], v31 offset:30720
    s_waitcnt lgkmcnt(4)
    v_mfma_f32_16x16x32_bf16 v[178:181], v[206:209], v[78:81], v[178:181]
    ds_read_b128 v[202:205], v31 offset:31744
    s_waitcnt lgkmcnt(4)
    v_mfma_f32_16x16x32_bf16 v[182:185], v[210:213], v[78:81], v[182:185]
    ds_read_b128 v[206:209], v31 offset:32768
    s_waitcnt lgkmcnt(4)
    v_mfma_f32_16x16x32_bf16 v[186:189], v[214:217], v[78:81], v[186:189]
    ds_read_b128 v[210:213], v31 offset:33792
    s_waitcnt lgkmcnt(4)
    v_mfma_f32_16x16x32_bf16 v[190:193], v[194:197], v[78:81], v[190:193]
    global_load_dwordx4 v[126:129], v6, s[38:39] offset:-2048 sc1
    ds_read_b128 v[214:217], v31 offset:34816
    s_waitcnt lgkmcnt(4)
    v_mfma_f32_16x16x32_bf16 v[174:177], v[198:201], v[82:85], v[174:177]
    ds_read_b128 v[194:197], v31 offset:46080
    s_waitcnt lgkmcnt(4)
    v_mfma_f32_16x16x32_bf16 v[178:181], v[202:205], v[82:85], v[178:181]
    global_load_dwordx4 v[130:133], v6, s[38:39] offset:2048 sc1
    ds_read_b128 v[198:201], v31 offset:47104
    s_waitcnt lgkmcnt(4)
    v_mfma_f32_16x16x32_bf16 v[182:185], v[206:209], v[82:85], v[182:185]
    ds_read_b128 v[202:205], v31 offset:48128
    s_waitcnt lgkmcnt(4)
    v_mfma_f32_16x16x32_bf16 v[186:189], v[210:213], v[82:85], v[186:189]
    global_load_dwordx4 v[134:137], v7, s[38:39] offset:-3072 sc1
    ds_read_b128 v[206:209], v31 offset:49152
    s_waitcnt lgkmcnt(4)
    v_mfma_f32_16x16x32_bf16 v[190:193], v[214:217], v[82:85], v[190:193]
    ds_read_b128 v[210:213], v31 offset:50176
    s_waitcnt lgkmcnt(4)
    v_mfma_f32_16x16x32_bf16 v[174:177], v[194:197], v[86:89], v[174:177]
    global_load_dwordx4 v[138:141], v7, s[38:39] offset:1024 sc1
    ds_read_b128 v[214:217], v20 offset:5120
    s_waitcnt lgkmcnt(4)
    v_mfma_f32_16x16x32_bf16 v[178:181], v[198:201], v[86:89], v[178:181]
    ds_read_b128 v[194:197], v20 offset:6144
    s_waitcnt lgkmcnt(4)
    v_mfma_f32_16x16x32_bf16 v[182:185], v[202:205], v[86:89], v[182:185]
    ds_read_b128 v[198:201], v20 offset:7168
    s_waitcnt lgkmcnt(4)
    v_mfma_f32_16x16x32_bf16 v[186:189], v[206:209], v[86:89], v[186:189]
    global_load_dwordx4 v[142:145], v26, s[38:39] offset:-4096 sc1
    ds_read_b128 v[202:205], v20 offset:8192
    s_waitcnt lgkmcnt(4)
    v_mfma_f32_16x16x32_bf16 v[190:193], v[210:213], v[86:89], v[190:193]
    ds_read_b128 v[206:209], v20 offset:9216
    s_waitcnt lgkmcnt(4)
    v_mfma_f32_16x16x32_bf16 v[174:177], v[214:217], v[90:93], v[174:177]
    global_load_dwordx4 v[146:149], v26, s[38:39] offset:0 sc1
    ds_read_b128 v[210:213], v30 offset:5120
    s_waitcnt lgkmcnt(4)
    v_mfma_f32_16x16x32_bf16 v[178:181], v[194:197], v[90:93], v[178:181]
    ds_read_b128 v[214:217], v30 offset:6144
    s_waitcnt lgkmcnt(4)
    v_mfma_f32_16x16x32_bf16 v[182:185], v[198:201], v[90:93], v[182:185]
    global_load_dwordx4 v[150:153], v26, s[38:39] offset:3072 sc1
    ds_read_b128 v[194:197], v30 offset:7168
    s_waitcnt lgkmcnt(4)
    v_mfma_f32_16x16x32_bf16 v[186:189], v[202:205], v[90:93], v[186:189]
    ds_read_b128 v[198:201], v30 offset:8192
    s_waitcnt lgkmcnt(4)
    v_mfma_f32_16x16x32_bf16 v[190:193], v[206:209], v[90:93], v[190:193]
    ds_read_b128 v[202:205], v30 offset:9216
    s_waitcnt vmcnt(14)
    v_max_u32 v28, v94, v95
    v_max3_u32 v28, v96, v97, v28
    s_waitcnt vmcnt(13)
    v_max3_u32 v28, v98, v99, v28
    v_max3_u32 v28, v100, v101, v28
    s_waitcnt vmcnt(12)
    v_max3_u32 v28, v102, v103, v28
    v_max3_u32 v28, v104, v105, v28
    s_waitcnt vmcnt(11)
    v_max3_u32 v28, v106, v107, v28
    v_max3_u32 v28, v108, v109, v28
    s_waitcnt vmcnt(10)
    v_max3_u32 v28, v110, v111, v28
    v_max3_u32 v28, v112, v113, v28
    s_waitcnt vmcnt(9)
    v_max3_u32 v28, v114, v115, v28
    v_max3_u32 v28, v116, v117, v28
    s_waitcnt vmcnt(8)
    v_max3_u32 v28, v118, v119, v28
    v_max3_u32 v28, v120, v121, v28
    s_waitcnt vmcnt(7)
    v_max3_u32 v28, v122, v123, v28
    v_max3_u32 v28, v124, v125, v28
    v_cmp_eq_u32 vcc, -1, v28
    s_nop 0
    s_cbranch_vccnz Lp1_r
Lp1_ok:
    s_waitcnt lgkmcnt(4)
    v_mfma_f32_16x16x32_bf16 v[174:177], v[210:213], v[94:97], v[174:177]
    ds_read_b128 v[206:209], v30 offset:25600
    s_waitcnt lgkmcnt(4)
    v_mfma_f32_16x16x32_bf16 v[178:181], v[214:217], v[94:97], v[178:181]
    ds_read_b128 v[210:213], v30 offset:26624
    s_waitcnt lgkmcnt(4)
    v_mfma_f32_16x16x32_bf16 v[182:185], v[194:197], v[94:97], v[182:185]
    ds_read_b128 v[214:217], v30 offset:27648
    s_waitcnt lgkmcnt(4)
    v_mfma_f32_16x16x32_bf16 v[186:189], v[198:201], v[94:97], v[186:189]
    ds_read_b128 v[194:197], v30 offset:28672
    s_waitcnt lgkmcnt(4)
    v_mfma_f32_16x16x32_bf16 v[190:193], v[202:205], v[94:97], v[190:193]
    ds_read_b128 v[198:201], v30 offset:29696
    s_waitcnt lgkmcnt(4)
    v_mfma_f32_16x16x32_bf16 v[174:177], v[206:209], v[98:101], v[174:177]
    ds_read_b128 v[202:205], v30 offset:40960
    s_waitcnt lgkmcnt(4)
    v_mfma_f32_16x16x32_bf16 v[178:181], v[210:213], v[98:101], v[178:181]
    ds_read_b128 v[206:209], v30 offset:41984
    s_waitcnt lgkmcnt(4)
    v_mfma_f32_16x16x32_bf16 v[182:185], v[214:217], v[98:101], v[182:185]
    ds_read_b128 v[210:213], v30 offset:43008
    s_waitcnt lgkmcnt(4)
    v_mfma_f32_16x16x32_bf16 v[186:189], v[194:197], v[98:101], v[186:189]
    ds_read_b128 v[214:217], v30 offset:44032
    s_waitcnt lgkmcnt(4)
    v_mfma_f32_16x16x32_bf16 v[190:193], v[198:201], v[98:101], v[190:193]
    ds_read_b128 v[194:197], v30 offset:45056
    s_waitcnt lgkmcnt(4)
    v_mfma_f32_16x16x32_bf16 v[174:177], v[202:205], v[102:105], v[174:177]
    ds_read_b128 v[198:201], v31 offset:0
    s_waitcnt lgkmcnt(4)
    v_mfma_f32_16x16x32_bf16 v[178:181], v[206:209], v[102:105], v[178:181]
    ds_read_b128 v[202:205], v31 offset:1024
    s_waitcnt lgkmcnt(4)
    v_mfma_f32_16x16x32_bf16 v[182:185], v[210:213], v[102:105], v[182:185]
    ds_read_b128 v[206:209], v31 offset:2048
    s_waitcnt lgkmcnt(4)
    v_mfma_f32_16x16x32_bf16 v[186:189], v[214:217], v[102:105], v[186:189]
    ds_read_b128 v[210:213], v31 offset:3072
    s_waitcnt lgkmcnt(4)
    v_mfma_f32_16x16x32_bf16 v[190:193], v[194:197], v[102:105], v[190:193]
    ds_read_b128 v[214:217], v31 offset:4096
    s_waitcnt lgkmcnt(4)
    v_mfma_f32_16x16x32_bf16 v[174:177], v[198:201], v[106:109], v[174:177]
    ds_read_b128 v[194:197], v31 offset:15360
    s_waitcnt lgkmcnt(4)
    v_mfma_f32_16x16x32_bf16 v[178:181], v[202:205], v[106:109], v[178:181]
    ds_read_b128 v[198:201], v31 offset:16384
    s_waitcnt lgkmcnt(4)
    v_mfma_f32_16x16x32_bf16 v[182:185], v[206:209], v[106:109], v[182:185]
    ds_read_b128 v[202:205], v31 offset:17408
    s_waitcnt lgkmcnt(4)
    v_mfma_f32_16x16x32_bf16 v[186:189], v[210:213], v[106:109], v[186:189]
    ds_read_b128 v[206:209], v31 offset:18432
    s_waitcnt lgkmcnt(4)
    v_mfma_f32_16x16x32_bf16 v[190:193], v[214:217], v[106:109], v[190:193]
    ds_read_b128 v[210:213], v31 offset:19456
    s_waitcnt lgkmcnt(4)
    v_mfma_f32_16x16x32_bf16 v[174:177], v[194:197], v[110:113], v[174:177]
    ds_read_b128 v[214:217], v31 offset:35840
    s_waitcnt lgkmcnt(4)
    v_mfma_f32_16x16x32_bf16 v[178:181], v[198:201], v[110:113], v[178:181]
    ds_read_b128 v[194:197], v31 offset:36864
    s_waitcnt lgkmcnt(4)
    v_mfma_f32_16x16x32_bf16 v[182:185], v[202:205], v[110:113], v[182:185]
    ds_read_b128 v[198:201], v31 offset:37888
    s_waitcnt lgkmcnt(4)
    v_mfma_f32_16x16x32_bf16 v[186:189], v[206:209], v[110:113], v[186:189]
    ds_read_b128 v[202:205], v31 offset:38912
    s_waitcnt lgkmcnt(4)
    v_mfma_f32_16x16x32_bf16 v[190:193], v[210:213], v[110:113], v[190:193]
    global_load_dwordx4 v[158:161], v6, s[38:39] offset:-1024 sc1
    ds_read_b128 v[206:209], v31 offset:39936
    s_waitcnt lgkmcnt(4)
    v_mfma_f32_16x16x32_bf16 v[174:177], v[214:217], v[114:117], v[174:177]
    ds_read_b128 v[210:213], v31 offset:51200
    s_waitcnt lgkmcnt(4)
    v_mfma_f32_16x16x32_bf16 v[178:181], v[194:197], v[114:117], v[178:181]
    ds_read_b128 v[214:217], v31 offset:52224
    s_waitcnt lgkmcnt(4)
    v_mfma_f32_16x16x32_bf16 v[182:185], v[198:201], v[114:117], v[182:185]
    ds_read_b128 v[194:197], v31 offset:53248
    s_waitcnt lgkmcnt(4)
    v_mfma_f32_16x16x32_bf16 v[186:189], v[202:205], v[114:117], v[186:189]
    global_load_dwordx4 v[162:165], v7, s[38:39] offset:-2048 sc1
    ds_read_b128 v[198:201], v31 offset:54272
    s_waitcnt lgkmcnt(4)
    v_mfma_f32_16x16x32_bf16 v[190:193], v[206:209], v[114:117], v[190:193]
    ds_read_b128 v[202:205], v31 offset:55296
    s_waitcnt lgkmcnt(4)
    v_mfma_f32_16x16x32_bf16 v[174:177], v[210:213], v[118:121], v[174:177]
    ds_read_b128 v[206:209], v20 offset:10240
    s_waitcnt lgkmcnt(4)
    v_mfma_f32_16x16x32_bf16 v[178:181], v[214:217], v[118:121], v[178:181]
    ds_read_b128 v[210:213], v20 offset:11264
    s_waitcnt lgkmcnt(4)
    v_mfma_f32_16x16x32_bf16 v[182:185], v[194:197], v[118:121], v[182:185]
    global_load_dwordx4 v[166:169], v26, s[38:39] offset:-3072 sc1
    ds_read_b128 v[214:217], v20 offset:12288
    s_waitcnt lgkmcnt(4)
    v_mfma_f32_16x16x32_bf16 v[186:189], v[198:201], v[118:121], v[186:189]
    ds_read_b128 v[194:197], v20 offset:13312
    s_waitcnt lgkmcnt(4)
    v_mfma_f32_16x16x32_bf16 v[190:193], v[202:205], v[118:121], v[190:193]
    ds_read_b128 v[198:201], v20 offset:14336
    s_waitcnt lgkmcnt(4)
    v_mfma_f32_16x16x32_bf16 v[174:177], v[206:209], v[122:125], v[174:177]
    ds_read_b128 v[202:205], v30 offset:10240
    s_waitcnt lgkmcnt(4)
    v_mfma_f32_16x16x32_bf16 v[178:181], v[210:213], v[122:125], v[178:181]
    global_load_dwordx4 v[170:173], v27, s[38:39] offset:-4096 sc1
    ds_read_b128 v[206:209], v30 offset:11264
    s_waitcnt lgkmcnt(4)
    v_mfma_f32_16x16x32_bf16 v[182:185], v[214:217], v[122:125], v[182:185]
    ds_read_b128 v[210:213], v30 offset:12288
    s_waitcnt lgkmcnt(4)
    v_mfma_f32_16x16x32_bf16 v[186:189], v[194:197], v[122:125], v[186:189]
    ds_read_b128 v[214:217], v30 offset:13312
    s_waitcnt lgkmcnt(4)
    v_mfma_f32_16x16x32_bf16 v[190:193], v[198:201], v[122:125], v[190:193]
    ds_read_b128 v[194:197], v30 offset:14336
    v_add_f32 v218, v218, v238
    v_add_f32 v219, v219, v239
    v_add_f32 v220, v220, v240
    v_add_f32 v221, v221, v241
    v_cvt_pk_bf16_f32 v218, v218, v218
    v_lshlrev_b32 v218, 16, v218
    v_cvt_pk_bf16_f32 v219, v219, v219
    v_lshlrev_b32 v219, 16, v219
    v_cvt_pk_bf16_f32 v220, v220, v220
    v_lshlrev_b32 v220, 16, v220
    v_cvt_pk_bf16_f32 v221, v221, v221
    v_lshlrev_b32 v221, 16, v221
    v_add_f32 v222, v222, v242
    v_add_f32 v223, v223, v243
    v_add_f32 v224, v224, v244
    v_add_f32 v225, v225, v245
    v_cvt_pk_bf16_f32 v222, v222, v222
    v_lshlrev_b32 v222, 16, v222
    v_cvt_pk_bf16_f32 v223, v223, v223
    v_lshlrev_b32 v223, 16, v223
    v_cvt_pk_bf16_f32 v224, v224, v224
    v_lshlrev_b32 v224, 16, v224
    v_cvt_pk_bf16_f32 v225, v225, v225
    v_lshlrev_b32 v225, 16, v225
    v_add_f32 v226, v226, v246
    v_add_f32 v227, v227, v247
    v_add_f32 v228, v228, v248
    v_add_f32 v229, v229, v249
    v_cvt_pk_bf16_f32 v226, v226, v226
    v_lshlrev_b32 v226, 16, v226
    v_cvt_pk_bf16_f32 v227, v227, v227
    v_lshlrev_b32 v227, 16, v227
    v_cvt_pk_bf16_f32 v228, v228, v228
    v_lshlrev_b32 v228, 16, v228
    v_cvt_pk_bf16_f32 v229, v229, v229
    v_lshlrev_b32 v229, 16, v229
    v_add_f32 v230, v230, v250
    v_add_f32 v231, v231, v251
    v_add_f32 v232, v232, v252
    v_add_f32 v233, v233, v253
    v_cvt_pk_bf16_f32 v230, v230, v230
    v_lshlrev_b32 v230, 16, v230
    v_cvt_pk_bf16_f32 v231, v231, v231
    v_lshlrev_b32 v231, 16, v231
    v_cvt_pk_bf16_f32 v232, v232, v232
    v_lshlrev_b32 v232, 16, v232
    v_cvt_pk_bf16_f32 v233, v233, v233
    v_lshlrev_b32 v233, 16, v233
    v_add_f32 v234, v234, v12
    v_add_f32 v235, v235, v13
    v_add_f32 v236, v236, v14
    v_add_f32 v237, v237, v15
    v_cvt_pk_bf16_f32 v234, v234, v234
    v_lshlrev_b32 v234, 16, v234
    v_cvt_pk_bf16_f32 v235, v235, v235
    v_lshlrev_b32 v235, 16, v235
    v_cvt_pk_bf16_f32 v236, v236, v236
    v_lshlrev_b32 v236, 16, v236
    v_cvt_pk_bf16_f32 v237, v237, v237
    v_lshlrev_b32 v237, 16, v237
    s_waitcnt vmcnt(10)
    v_max_u32 v28, v126, v127
    v_max3_u32 v28, v128, v129, v28
    s_waitcnt vmcnt(9)
    v_max3_u32 v28, v130, v131, v28
    v_max3_u32 v28, v132, v133, v28
    s_waitcnt vmcnt(8)
    v_max3_u32 v28, v134, v135, v28
    v_max3_u32 v28, v136, v137, v28
    s_waitcnt vmcnt(7)
    v_max3_u32 v28, v138, v139, v28
    v_max3_u32 v28, v140, v141, v28
    s_waitcnt vmcnt(6)
    v_max3_u32 v28, v142, v143, v28
    v_max3_u32 v28, v144, v145, v28
    s_waitcnt vmcnt(5)
    v_max3_u32 v28, v146, v147, v28
    v_max3_u32 v28, v148, v149, v28
    s_waitcnt vmcnt(4)
    v_max3_u32 v28, v150, v151, v28
    v_max3_u32 v28, v152, v153, v28
    v_cmp_eq_u32 vcc, -1, v28
    s_nop 0
    s_cbranch_vccnz Lp2_r
Lp2_ok:
    s_waitcnt lgkmcnt(4)
    v_mfma_f32_16x16x32_bf16 v[174:177], v[202:205], v[126:129], v[174:177]
    ds_read_b128 v[198:201], v30 offset:30720
    s_waitcnt lgkmcnt(4)
    v_mfma_f32_16x16x32_bf16 v[178:181], v[206:209], v[126:129], v[178:181]
    ds_read_b128 v[202:205], v30 offset:31744
    s_waitcnt lgkmcnt(4)
    v_mfma_f32_16x16x32_bf16 v[182:185], v[210:213], v[126:129], v[182:185]
    ds_read_b128 v[206:209], v30 offset:32768
    s_waitcnt lgkmcnt(4)
    v_mfma_f32_16x16x32_bf16 v[186:189], v[214:217], v[126:129], v[186:189]
    ds_read_b128 v[210:213], v30 offset:33792
    s_waitcnt lgkmcnt(4)
    v_mfma_f32_16x16x32_bf16 v[190:193], v[194:197], v[126:129], v[190:193]
    ds_read_b128 v[214:217], v30 offset:34816
    s_waitcnt lgkmcnt(4)
    v_mfma_f32_16x16x32_bf16 v[174:177], v[198:201], v[130:133], v[174:177]
    ds_read_b128 v[194:197], v30 offset:46080
    s_waitcnt lgkmcnt(4)
    v_mfma_f32_16x16x32_bf16 v[178:181], v[202:205], v[130:133], v[178:181]
    ds_read_b128 v[198:201], v30 offset:47104
    s_waitcnt lgkmcnt(4)
    v_mfma_f32_16x16x32_bf16 v[182:185], v[206:209], v[130:133], v[182:185]
    ds_read_b128 v[202:205], v30 offset:48128
    s_waitcnt lgkmcnt(4)
    v_mfma_f32_16x16x32_bf16 v[186:189], v[210:213], v[130:133], v[186:189]
    ds_read_b128 v[206:209], v30 offset:49152
    s_waitcnt lgkmcnt(4)
    v_mfma_f32_16x16x32_bf16 v[190:193], v[214:217], v[130:133], v[190:193]
    ds_read_b128 v[210:213], v30 offset:50176
    s_waitcnt lgkmcnt(4)
    v_mfma_f32_16x16x32_bf16 v[174:177], v[194:197], v[134:137], v[174:177]
    ds_read_b128 v[214:217], v31 offset:5120
    s_waitcnt lgkmcnt(4)
    v_mfma_f32_16x16x32_bf16 v[178:181], v[198:201], v[134:137], v[178:181]
    ds_read_b128 v[194:197], v31 offset:6144
    s_waitcnt lgkmcnt(4)
    v_mfma_f32_16x16x32_bf16 v[182:185], v[202:205], v[134:137], v[182:185]
    ds_read_b128 v[198:201], v31 offset:7168
    s_waitcnt lgkmcnt(4)
    v_mfma_f32_16x16x32_bf16 v[186:189], v[206:209], v[134:137], v[186:189]
    ds_read_b128 v[202:205], v31 offset:8192
    s_waitcnt lgkmcnt(4)
    v_mfma_f32_16x16x32_bf16 v[190:193], v[210:213], v[134:137], v[190:193]
    ds_read_b128 v[206:209], v31 offset:9216
    s_waitcnt lgkmcnt(4)
    v_mfma_f32_16x16x32_bf16 v[174:177], v[214:217], v[138:141], v[174:177]
    ds_read_b128 v[210:213], v31 offset:20480
    s_waitcnt lgkmcnt(4)
    v_mfma_f32_16x16x32_bf16 v[178:181], v[194:197], v[138:141], v[178:181]
    ds_read_b128 v[214:217], v31 offset:21504
    s_waitcnt lgkmcnt(4)
    v_mfma_f32_16x16x32_bf16 v[182:185], v[198:201], v[138:141], v[182:185]
    ds_read_b128 v[194:197], v31 offset:22528
    s_waitcnt lgkmcnt(4)
    v_mfma_f32_16x16x32_bf16 v[186:189], v[202:205], v[138:141], v[186:189]
    ds_read_b128 v[198:201], v31 offset:23552
    s_waitcnt lgkmcnt(4)
    v_mfma_f32_16x16x32_bf16 v[190:193], v[206:209], v[138:141], v[190:193]
    ds_read_b128 v[202:205], v31 offset:24576
    s_waitcnt lgkmcnt(4)
    v_mfma_f32_16x16x32_bf16 v[174:177], v[210:213], v[142:145], v[174:177]
    ds_read_b128 v[206:209], v31 offset:40960
    s_waitcnt lgkmcnt(4)
    v_mfma_f32_16x16x32_bf16 v[178:181], v[214:217], v[142:145], v[178:181]
    ds_read_b128 v[210:213], v31 offset:41984
    s_waitcnt lgkmcnt(4)
    v_mfma_f32_16x16x32_bf16 v[182:185], v[194:197], v[142:145], v[182:185]
    ds_read_b128 v[214:217], v31 offset:43008
    s_waitcnt lgkmcnt(4)
    v_mfma_f32_16x16x32_bf16 v[186:189], v[198:201], v[142:145], v[186:189]
    ds_read_b128 v[194:197], v31 offset:44032
    s_waitcnt lgkmcnt(4)
    v_mfma_f32_16x16x32_bf16 v[190:193], v[202:205], v[142:145], v[190:193]
    ds_read_b128 v[198:201], v31 offset:45056
    s_waitcnt lgkmcnt(4)
    v_mfma_f32_16x16x32_bf16 v[174:177], v[206:209], v[146:149], v[174:177]
    ds_read_b128 v[202:205], v31 offset:56320
    s_waitcnt lgkmcnt(4)
    v_mfma_f32_16x16x32_bf16 v[178:181], v[210:213], v[146:149], v[178:181]
    ds_read_b128 v[206:209], v31 offset:57344
    s_waitcnt lgkmcnt(4)
    v_mfma_f32_16x16x32_bf16 v[182:185], v[214:217], v[146:149], v[182:185]
    ds_read_b128 v[210:213], v31 offset:58368
    s_waitcnt lgkmcnt(4)
    v_mfma_f32_16x16x32_bf16 v[186:189], v[194:197], v[146:149], v[186:189]
    ds_read_b128 v[214:217], v31 offset:59392
    s_waitcnt lgkmcnt(4)
    v_mfma_f32_16x16x32_bf16 v[190:193], v[198:201], v[146:149], v[190:193]
    ds_read_b128 v[194:197], v31 offset:60416
    s_waitcnt lgkmcnt(4)
    v_mfma_f32_16x16x32_bf16 v[174:177], v[202:205], v[150:153], v[174:177]
    ds_read_b128 v[198:201], v30 offset:15360
    s_waitcnt lgkmcnt(4)
    v_mfma_f32_16x16x32_bf16 v[178:181], v[206:209], v[150:153], v[178:181]
    ds_read_b128 v[202:205], v30 offset:16384
    s_waitcnt lgkmcnt(4)
    v_mfma_f32_16x16x32_bf16 v[182:185], v[210:213], v[150:153], v[182:185]
    ds_read_b128 v[206:209], v30 offset:17408
    s_waitcnt lgkmcnt(4)
    v_mfma_f32_16x16x32_bf16 v[186:189], v[214:217], v[150:153], v[186:189]
    ds_read_b128 v[210:213], v30 offset:18432
    s_waitcnt lgkmcnt(4)
    v_mfma_f32_16x16x32_bf16 v[190:193], v[194:197], v[150:153], v[190:193]
    ds_read_b128 v[214:217], v30 offset:19456
    s_waitcnt vmcnt(3)
    v_max_u32 v28, v158, v159
    v_max3_u32 v28, v160, v161, v28
    s_waitcnt vmcnt(2)
    v_max3_u32 v28, v162, v163, v28
    v_max3_u32 v28, v164, v165, v28
    s_waitcnt vmcnt(1)
    v_max3_u32 v28, v166, v167, v28
    v_max3_u32 v28, v168, v169, v28
    s_waitcnt vmcnt(0)
    v_max3_u32 v28, v170, v171, v28
    v_max3_u32 v28, v172, v173, v28
    v_cmp_eq_u32 vcc, -1, v28
    s_nop 0
    s_cbranch_vccnz Lp3_r
Lp3_ok:
    s_waitcnt lgkmcnt(4)
    v_mfma_f32_16x16x32_bf16 v[174:177], v[198:201], v[158:161], v[174:177]
    ds_read_b128 v[194:197], v30 offset:51200
    s_waitcnt lgkmcnt(4)
    v_mfma_f32_16x16x32_bf16 v[178:181], v[202:205], v[158:161], v[178:181]
    ds_read_b128 v[198:201], v30 offset:52224
    s_waitcnt lgkmcnt(4)
    v_mfma_f32_16x16x32_bf16 v[182:185], v[206:209], v[158:161], v[182:185]
    ds_read_b128 v[202:205], v30 offset:53248
    s_waitcnt lgkmcnt(4)
    v_mfma_f32_16x16x32_bf16 v[186:189], v[210:213], v[158:161], v[186:189]
    ds_read_b128 v[206:209], v30 offset:54272
    s_waitcnt lgkmcnt(4)
    v_mfma_f32_16x16x32_bf16 v[190:193], v[214:217], v[158:161], v[190:193]
    ds_read_b128 v[210:213], v30 offset:55296
    s_waitcnt lgkmcnt(4)
    v_mfma_f32_16x16x32_bf16 v[174:177], v[194:197], v[162:165], v[174:177]
    ds_read_b128 v[214:217], v31 offset:25600
    s_waitcnt lgkmcnt(4)
    v_mfma_f32_16x16x32_bf16 v[178:181], v[198:201], v[162:165], v[178:181]
    ds_read_b128 v[194:197], v31 offset:26624
    s_waitcnt lgkmcnt(4)
    v_mfma_f32_16x16x32_bf16 v[182:185], v[202:205], v[162:165], v[182:185]
    ds_read_b128 v[198:201], v31 offset:27648
    s_waitcnt lgkmcnt(4)
    v_mfma_f32_16x16x32_bf16 v[186:189], v[206:209], v[162:165], v[186:189]
    ds_read_b128 v[202:205], v31 offset:28672
    s_waitcnt lgkmcnt(4)
    v_mfma_f32_16x16x32_bf16 v[190:193], v[210:213], v[162:165], v[190:193]
    ds_read_b128 v[206:209], v31 offset:29696
    s_waitcnt lgkmcnt(4)
    v_mfma_f32_16x16x32_bf16 v[174:177], v[214:217], v[166:169], v[174:177]
    ds_read_b128 v[210:213], v20 offset:0
    s_waitcnt lgkmcnt(4)
    v_mfma_f32_16x16x32_bf16 v[178:181], v[194:197], v[166:169], v[178:181]
    ds_read_b128 v[214:217], v20 offset:1024
    s_waitcnt lgkmcnt(4)
    v_mfma_f32_16x16x32_bf16 v[182:185], v[198:201], v[166:169], v[182:185]
    ds_read_b128 v[194:197], v20 offset:2048
    s_waitcnt lgkmcnt(4)
    v_mfma_f32_16x16x32_bf16 v[186:189], v[202:205], v[166:169], v[186:189]
    ds_read_b128 v[198:201], v20 offset:3072
    s_waitcnt lgkmcnt(4)
    v_mfma_f32_16x16x32_bf16 v[190:193], v[206:209], v[166:169], v[190:193]
    ds_read_b128 v[202:205], v20 offset:4096
    s_waitcnt lgkmcnt(4)
    v_mfma_f32_16x16x32_bf16 v[174:177], v[210:213], v[170:173], v[174:177]
    s_waitcnt lgkmcnt(3)
    v_mfma_f32_16x16x32_bf16 v[178:181], v[214:217], v[170:173], v[178:181]
    s_waitcnt lgkmcnt(2)
    v_mfma_f32_16x16x32_bf16 v[182:185], v[194:197], v[170:173], v[182:185]
    s_waitcnt lgkmcnt(1)
    v_mfma_f32_16x16x32_bf16 v[186:189], v[198:201], v[170:173], v[186:189]
    s_waitcnt lgkmcnt(0)
    v_mfma_f32_16x16x32_bf16 v[190:193], v[202:205], v[170:173], v[190:193]
    v_lshlrev_b32 v62, 16, v36
    v_and_b32 v63, 0xffff0000, v36
    v_lshlrev_b32 v64, 16, v37
    v_and_b32 v65, 0xffff0000, v37
    v_lshlrev_b32 v66, 16, v38
    v_and_b32 v67, 0xffff0000, v38
    v_lshlrev_b32 v68, 16, v39
    v_and_b32 v69, 0xffff0000, v39
    v_lshlrev_b32 v70, 16, v40
    v_and_b32 v71, 0xffff0000, v40
    v_lshlrev_b32 v72, 16, v41
    v_and_b32 v73, 0xffff0000, v41
    v_lshlrev_b32 v74, 16, v42
    v_and_b32 v75, 0xffff0000, v42
    v_lshlrev_b32 v76, 16, v43
    v_and_b32 v77, 0xffff0000, v43
    v_lshlrev_b32 v78, 16, v44
    v_and_b32 v79, 0xffff0000, v44
    v_lshlrev_b32 v80, 16, v45
    v_and_b32 v81, 0xffff0000, v45
    v_add_u32 v28, s90, v5
    v_mul_u32_u24 v28, 1280, v28
    s_mul_i32 s4, s41, 160
    v_add_u32 v28, s4, v28
    v_lshl_add_u32 v29, v3, 4, v28
    v_lshl_add_u32 v28, v3, 3, v28
    v_fmac_f32 v62, v174, v218
    v_fmac_f32 v63, v178, v219
    v_fmac_f32 v64, v175, v220
    v_fmac_f32 v65, v179, v221
    v_fmac_f32 v66, v176, v222
    v_fmac_f32 v67, v180, v223
    v_fmac_f32 v68, v177, v224
    v_fmac_f32 v69, v181, v225
    v_cvt_pk_bf16_f32 v94, v62, v63
    v_cvt_pk_bf16_f32 v95, v64, v65
    v_cvt_pk_bf16_f32 v96, v66, v67
    v_cvt_pk_bf16_f32 v97, v68, v69
    global_store_dwordx4 v29, v[94:97], s[34:35] offset:0
    v_fmac_f32 v70, v182, v226
    v_fmac_f32 v71, v186, v227
    v_fmac_f32 v72, v183, v228
    v_fmac_f32 v73, v187, v229
    v_fmac_f32 v74, v184, v230
    v_fmac_f32 v75, v188, v231
    v_fmac_f32 v76, v185, v232
    v_fmac_f32 v77, v189, v233
    v_cvt_pk_bf16_f32 v98, v70, v71
    v_cvt_pk_bf16_f32 v99, v72, v73
    v_cvt_pk_bf16_f32 v100, v74, v75
    v_cvt_pk_bf16_f32 v101, v76, v77
    global_store_dwordx4 v29, v[98:101], s[34:35] offset:64
    v_fmac_f32 v78, v190, v234
    v_fmac_f32 v79, v191, v235
    v_fmac_f32 v80, v192, v236
    v_fmac_f32 v81, v193, v237
    v_cvt_pk_bf16_f32 v102, v78, v79
    v_cvt_pk_bf16_f32 v103, v80, v81
    global_store_dwordx2 v28, v[102:103], s[34:35] offset:128
Ldone_main_kernel:
Lend_main_kernel:
    s_endpgm
Lspare:
    s_and_b32 s4, s2, 7
    s_lshr_b32 s5, s2, 3
    s_sub_u32 s5, s5, 20
    s_mul_i32 s4, s4, 160
    s_lshr_b32 s4, s4, 7
    s_bfe_u32 s6, s5, 0x10001
    s_add_u32 s4, s4, s6
    s_lshl_b32 s4, s4, 7
    s_bitcmp1_b32 s5, 0
    s_cselect_b64 s[6:7], s[12:13], s[10:11]
    s_lshr_b32 s5, s5, 2
    v_mad_u32_u24 v250, v0, 3, s5
    v_min_u32 v250, 2047, v250
    v_mul_u32_u24 v250, 1280, v250
    v_add_u32 v250, s4, v250
    global_load_dword v250, v250, s[6:7] nt
    s_add_u32 s5, s5, 768
    v_mad_u32_u24 v251, v0, 3, s5
    v_min_u32 v251, 2047, v251
    v_mul_u32_u24 v251, 1280, v251
    v_add_u32 v251, s4, v251
    global_load_dword v251, v251, s[6:7] nt
    s_add_u32 s5, s5, 768
    v_mad_u32_u24 v252, v0, 3, s5
    v_min_u32 v252, 2047, v252
    v_mul_u32_u24 v252, 1280, v252
    v_add_u32 v252, s4, v252
    global_load_dword v252, v252, s[6:7] nt
    s_add_u32 s5, s5, 768
    s_sub_u32 s42, s2, 160
    s_cmp_ge_u32 s42, 54
    s_cbranch_scc1 Lrole_main_kernel_0
    v_and_b32 v2, 15, v1
    v_lshrrev_b32 v3, 4, v1
    s_mul_i32 s4, s3, 552960
    s_lshl_b32 s5, s42, 6
    s_add_u32 s4, s4, s5
    s_add_u32 s4, s4, 3456
    v_mul_u32_u24 v4, 27648, v3
    v_lshl_add_u32 v4, v2, 2, v4
    v_add_u32 v4, s4, v4
    global_load_dword v8, v4, s[22:23] offset:-3456 nt
    global_load_dword v9, v4, s[22:23] offset:0 nt
    global_load_dword v10, v4, s[22:23] offset:3456 nt
    v_add_u32 v4, 10368, v4
    global_load_dword v11, v4, s[22:23] offset:-3456 nt
    global_load_dword v12, v4, s[22:23] offset:0 nt
    global_load_dword v13, v4, s[22:23] offset:3456 nt
    v_add_u32 v4, 10368, v4
    global_load_dword v14, v4, s[22:23] offset:-3456 nt
    global_load_dword v15, v4, s[22:23] offset:0 nt
    v_add_u32 v4, 89856, v4
    global_load_dword v16, v4, s[22:23] offset:-3456 nt
    global_load_dword v17, v4, s[22:23] offset:0 nt
    global_load_dword v18, v4, s[22:23] offset:3456 nt
    v_add_u32 v4, 10368, v4
    global_load_dword v19, v4, s[22:23] offset:-3456 nt
    global_load_dword v20, v4, s[22:23] offset:0 nt
    global_load_dword v21, v4, s[22:23] offset:3456 nt
    v_add_u32 v4, 10368, v4
    global_load_dword v22, v4, s[22:23] offset:-3456 nt
    global_load_dword v23, v4, s[22:23] offset:0 nt
    v_add_u32 v4, 89856, v4
    global_load_dword v24, v4, s[22:23] offset:-3456 nt
    global_load_dword v25, v4, s[22:23] offset:0 nt
    global_load_dword v26, v4, s[22:23] offset:3456 nt
    v_add_u32 v4, 10368, v4
    global_load_dword v27, v4, s[22:23] offset:-3456 nt
    global_load_dword v28, v4, s[22:23] offset:0 nt
    global_load_dword v29, v4, s[22:23] offset:3456 nt
    v_add_u32 v4, 10368, v4
    global_load_dword v30, v4, s[22:23] offset:-3456 nt
    global_load_dword v31, v4, s[22:23] offset:0 nt
    v_add_u32 v4, 89856, v4
    global_load_dword v32, v4, s[22:23] offset:-3456 nt
    global_load_dword v33, v4, s[22:23] offset:0 nt
    global_load_dword v34, v4, s[22:23] offset:3456 nt
    v_add_u32 v4, 10368, v4
    global_load_dword v35, v4, s[22:23] offset:-3456 nt
    global_load_dword v36, v4, s[22:23] offset:0 nt
    global_load_dword v37, v4, s[22:23] offset:3456 nt
    v_add_u32 v4, 10368, v4
    global_load_dword v38, v4, s[22:23] offset:-3456 nt
    global_load_dword v39, v4, s[22:23] offset:0 nt
    v_add_u32 v4, 89856, v4
    global_load_dword v40, v4, s[22:23] offset:-3456 nt
    global_load_dword v41, v4, s[22:23] offset:0 nt
    global_load_dword v42, v4, s[22:23] offset:3456 nt
    v_add_u32 v4, 10368, v4
    global_load_dword v43, v4, s[22:23] offset:-3456 nt
    global_load_dword v44, v4, s[22:23] offset:0 nt
    global_load_dword v45, v4, s[22:23] offset:3456 nt
    v_add_u32 v4, 10368, v4
    global_load_dword v46, v4, s[22:23] offset:-3456 nt
    global_load_dword v47, v4, s[22:23] offset:0 nt
    v_min_u32 v48, 39, v1
    s_mul_i32 s5, s3, 640
    v_lshl_add_u32 v48, v48, 4, s5
    v_add_u32 v60, 10240, v48
    global_load_dwordx4 v[52:55], v60, s[38:39]
    v_add_u32 v60, 25600, v48
    global_load_dwordx4 v[56:59], v60, s[38:39]
    v_add_u32 v72, 7680, v48
    global_load_dwordx4 v[64:67], v72, s[38:39]
    v_add_u32 v72, 23040, v48
    global_load_dwordx4 v[68:71], v72, s[38:39]
    s_waitcnt vmcnt(2)
    v_add_f32 v52, v52, v56
    v_add_f32 v53, v53, v57
    v_add_f32 v54, v54, v58
    v_add_f32 v55, v55, v59
    v_cvt_pk_bf16_f32 v52, v52, v52
    v_lshlrev_b32 v52, 16, v52
    v_cvt_pk_bf16_f32 v53, v53, v53
    v_lshlrev_b32 v53, 16, v53
    v_cvt_pk_bf16_f32 v54, v54, v54
    v_lshlrev_b32 v54, 16, v54
    v_cvt_pk_bf16_f32 v55, v55, v55
    v_lshlrev_b32 v55, 16, v55
    v_add_f32 v52, 1.0, v52
    v_add_f32 v53, 1.0, v53
    v_add_f32 v54, 1.0, v54
    v_add_f32 v55, 1.0, v55
    v_cvt_pk_bf16_f32 v52, v52, v52
    v_lshlrev_b32 v52, 16, v52
    v_cvt_pk_bf16_f32 v53, v53, v53
    v_lshlrev_b32 v53, 16, v53
    v_cvt_pk_bf16_f32 v54, v54, v54
    v_lshlrev_b32 v54, 16, v54
    v_cvt_pk_bf16_f32 v55, v55, v55
    v_lshlrev_b32 v55, 16, v55
    s_waitcnt vmcnt(0)
    v_add_f32 v64, v64, v68
    v_add_f32 v65, v65, v69
    v_add_f32 v66, v66, v70
    v_add_f32 v67, v67, v71
    v_cvt_pk_bf16_f32 v64, v64, v64
    v_lshlrev_b32 v64, 16, v64
    v_cvt_pk_bf16_f32 v65, v65, v65
    v_lshlrev_b32 v65, 16, v65
    v_cvt_pk_bf16_f32 v66, v66, v66
    v_lshlrev_b32 v66, 16, v66
    v_cvt_pk_bf16_f32 v67, v67, v67
    v_lshlrev_b32 v67, 16, v67
    ds_write_b128 v48, v[52:55]
    ds_write_b128 v48, v[64:67] offset:2560
    v_lshl_add_u32 v73, v3, 5, s5
    s_cmp_ge_u32 s42, 27
    s_cselect_b32 s6, -54, 56
    s_lshl_b32 s7, s42, 1
    s_add_u32 s6, s6, s7
    s_mul_i32 s4, s6, 20480
    s_mul_i32 s5, s3, 5120
    s_add_u32 s4, s4, s5
    s_add_u32 s4, s4, 7342080
    v_lshl_add_u32 v74, v1, 4, s4
    v_add_u32 v75, 20480, v74
    s_mov_b32 s7, 0x3f803f80
    v_mov_b32 v76, 0
    v_mov_b32 v77, 0
    v_mov_b32 v78, 0
    v_mov_b32 v79, 0
    ds_read_b128 v[80:83], v73 offset:0
    ds_read_b128 v[88:91], v73 offset:2560
    ds_read_b128 v[84:87], v73 offset:16
    ds_read_b128 v[92:95], v73 offset:2576
    v_lshlrev_b32 v112, 16, v8
    v_and_b32 v113, 0xffff0000, v8
    v_lshlrev_b32 v114, 16, v9
    v_and_b32 v115, 0xffff0000, v9
    v_lshlrev_b32 v116, 16, v10
    v_and_b32 v117, 0xffff0000, v10
    v_lshlrev_b32 v118, 16, v11
    v_and_b32 v119, 0xffff0000, v11
    v_lshlrev_b32 v120, 16, v12
    v_and_b32 v121, 0xffff0000, v12
    v_lshlrev_b32 v122, 16, v13
    v_and_b32 v123, 0xffff0000, v13
    v_lshlrev_b32 v124, 16, v14
    v_and_b32 v125, 0xffff0000, v14
    v_lshlrev_b32 v126, 16, v15
    v_and_b32 v127, 0xffff0000, v15
    s_waitcnt lgkmcnt(3)
    v_pk_mul_f32 v[128:129], v[80:81], v[112:113] op_sel:[0,0] op_sel_hi:[0,1]
    v_pk_mul_f32 v[130:131], v[80:81], v[114:115] op_sel:[1,0] op_sel_hi:[1,1]
    v_pk_mul_f32 v[132:133], v[82:83], v[116:117] op_sel:[0,0] op_sel_hi:[0,1]
    v_pk_mul_f32 v[134:135], v[82:83], v[118:119] op_sel:[1,0] op_sel_hi:[1,1]
    s_waitcnt lgkmcnt(1)
    v_pk_mul_f32 v[136:137], v[84:85], v[120:121] op_sel:[0,0] op_sel_hi:[0,1]
    v_pk_mul_f32 v[138:139], v[84:85], v[122:123] op_sel:[1,0] op_sel_hi:[1,1]
    v_pk_mul_f32 v[140:141], v[86:87], v[124:125] op_sel:[0,0] op_sel_hi:[0,1]
    v_pk_mul_f32 v[142:143], v[86:87], v[126:127] op_sel:[1,0] op_sel_hi:[1,1]
    v_cvt_pk_bf16_f32 v144, v128, v130
    v_cvt_pk_bf16_f32 v145, v132, v134
    v_cvt_pk_bf16_f32 v146, v136, v138
    v_cvt_pk_bf16_f32 v147, v140, v142
    v_cvt_pk_bf16_f32 v148, v129, v131
    v_cvt_pk_bf16_f32 v149, v133, v135
    v_cvt_pk_bf16_f32 v150, v137, v139
    v_cvt_pk_bf16_f32 v151, v141, v143
    global_store_dwordx4 v74, v[144:147], s[38:39] offset:-2048 sc1
    global_store_dwordx4 v75, v[148:151], s[38:39] offset:-2048 sc1
    v_pk_fma_f32 v[78:79], v[88:89], v[112:113], v[78:79] op_sel:[0,0,0] op_sel_hi:[0,1,1]
    v_pk_fma_f32 v[78:79], v[88:89], v[114:115], v[78:79] op_sel:[1,0,0] op_sel_hi:[1,1,1]
    v_pk_fma_f32 v[78:79], v[90:91], v[116:117], v[78:79] op_sel:[0,0,0] op_sel_hi:[0,1,1]
    v_pk_fma_f32 v[78:79], v[90:91], v[118:119], v[78:79] op_sel:[1,0,0] op_sel_hi:[1,1,1]
    s_waitcnt lgkmcnt(0)
    v_pk_fma_f32 v[78:79], v[92:93], v[120:121], v[78:79] op_sel:[0,0,0] op_sel_hi:[0,1,1]
    v_pk_fma_f32 v[78:79], v[92:93], v[122:123], v[78:79] op_sel:[1,0,0] op_sel_hi:[1,1,1]
    v_pk_fma_f32 v[78:79], v[94:95], v[124:125], v[78:79] op_sel:[0,0,0] op_sel_hi:[0,1,1]
    v_pk_fma_f32 v[78:79], v[94:95], v[126:127], v[78:79] op_sel:[1,0,0] op_sel_hi:[1,1,1]
    v_dot2_f32_bf16 v76, v144, s7, v76
    v_dot2_f32_bf16 v77, v148, s7, v77
    v_dot2_f32_bf16 v76, v145, s7, v76
    v_dot2_f32_bf16 v77, v149, s7, v77
    v_dot2_f32_bf16 v76, v146, s7, v76
    v_dot2_f32_bf16 v77, v150, s7, v77
    v_dot2_f32_bf16 v76, v147, s7, v76
    v_dot2_f32_bf16 v77, v151, s7, v77
    ds_read_b128 v[96:99], v73 offset:128
    ds_read_b128 v[104:107], v73 offset:2688
    ds_read_b128 v[100:103], v73 offset:144
    ds_read_b128 v[108:111], v73 offset:2704
    v_lshlrev_b32 v112, 16, v16
    v_and_b32 v113, 0xffff0000, v16
    v_lshlrev_b32 v114, 16, v17
    v_and_b32 v115, 0xffff0000, v17
    v_lshlrev_b32 v116, 16, v18
    v_and_b32 v117, 0xffff0000, v18
    v_lshlrev_b32 v118, 16, v19
    v_and_b32 v119, 0xffff0000, v19
    v_lshlrev_b32 v120, 16, v20
    v_and_b32 v121, 0xffff0000, v20
    v_lshlrev_b32 v122, 16, v21
    v_and_b32 v123, 0xffff0000, v21
    v_lshlrev_b32 v124, 16, v22
    v_and_b32 v125, 0xffff0000, v22
    v_lshlrev_b32 v126, 16, v23
    v_and_b32 v127, 0xffff0000, v23
    s_waitcnt lgkmcnt(3)
    v_pk_mul_f32 v[128:129], v[96:97], v[112:113] op_sel:[0,0] op_sel_hi:[0,1]
    v_pk_mul_f32 v[130:131], v[96:97], v[114:115] op_sel:[1,0] op_sel_hi:[1,1]
    v_pk_mul_f32 v[132:133], v[98:99], v[116:117] op_sel:[0,0] op_sel_hi:[0,1]
    v_pk_mul_f32 v[134:135], v[98:99], v[118:119] op_sel:[1,0] op_sel_hi:[1,1]
    s_waitcnt lgkmcnt(1)
    v_pk_mul_f32 v[136:137], v[100:101], v[120:121] op_sel:[0,0] op_sel_hi:[0,1]
    v_pk_mul_f32 v[138:139], v[100:101], v[122:123] op_sel:[1,0] op_sel_hi:[1,1]
    v_pk_mul_f32 v[140:141], v[102:103], v[124:125] op_sel:[0,0] op_sel_hi:[0,1]
    v_pk_mul_f32 v[142:143], v[102:103], v[126:127] op_sel:[1,0] op_sel_hi:[1,1]
    v_cvt_pk_bf16_f32 v152, v128, v130
    v_cvt_pk_bf16_f32 v153, v132, v134
    v_cvt_pk_bf16_f32 v154, v136, v138
    v_cvt_pk_bf16_f32 v155, v140, v142
    v_cvt_pk_bf16_f32 v156, v129, v131
    v_cvt_pk_bf16_f32 v157, v133, v135
    v_cvt_pk_bf16_f32 v158, v137, v139
    v_cvt_pk_bf16_f32 v159, v141, v143
    global_store_dwordx4 v74, v[152:155], s[38:39] offset:-1024 sc1
    global_store_dwordx4 v75, v[156:159], s[38:39] offset:-1024 sc1
    v_pk_fma_f32 v[78:79], v[104:105], v[112:113], v[78:79] op_sel:[0,0,0] op_sel_hi:[0,1,1]
    v_pk_fma_f32 v[78:79], v[104:105], v[114:115], v[78:79] op_sel:[1,0,0] op_sel_hi:[1,1,1]
    v_pk_fma_f32 v[78:79], v[106:107], v[116:117], v[78:79] op_sel:[0,0,0] op_sel_hi:[0,1,1]
    v_pk_fma_f32 v[78:79], v[106:107], v[118:119], v[78:79] op_sel:[1,0,0] op_sel_hi:[1,1,1]
    s_waitcnt lgkmcnt(0)
    v_pk_fma_f32 v[78:79], v[108:109], v[120:121], v[78:79] op_sel:[0,0,0] op_sel_hi:[0,1,1]
    v_pk_fma_f32 v[78:79], v[108:109], v[122:123], v[78:79] op_sel:[1,0,0] op_sel_hi:[1,1,1]
    v_pk_fma_f32 v[78:79], v[110:111], v[124:125], v[78:79] op_sel:[0,0,0] op_sel_hi:[0,1,1]
    v_pk_fma_f32 v[78:79], v[110:111], v[126:127], v[78:79] op_sel:[1,0,0] op_sel_hi:[1,1,1]
    v_dot2_f32_bf16 v76, v152, s7, v76
    v_dot2_f32_bf16 v77, v156, s7, v77
    v_dot2_f32_bf16 v76, v153, s7, v76
    v_dot2_f32_bf16 v77, v157, s7, v77
    v_dot2_f32_bf16 v76, v154, s7, v76
    v_dot2_f32_bf16 v77, v158, s7, v77
    v_dot2_f32_bf16 v76, v155, s7, v76
    v_dot2_f32_bf16 v77, v159, s7, v77
    ds_read_b128 v[80:83], v73 offset:256
    ds_read_b128 v[88:91], v73 offset:2816
    ds_read_b128 v[84:87], v73 offset:272
    ds_read_b128 v[92:95], v73 offset:2832
    v_lshlrev_b32 v112, 16, v24
    v_and_b32 v113, 0xffff0000, v24
    v_lshlrev_b32 v114, 16, v25
    v_and_b32 v115, 0xffff0000, v25
    v_lshlrev_b32 v116, 16, v26
    v_and_b32 v117, 0xffff0000, v26
    v_lshlrev_b32 v118, 16, v27
    v_and_b32 v119, 0xffff0000, v27
    v_lshlrev_b32 v120, 16, v28
    v_and_b32 v121, 0xffff0000, v28
    v_lshlrev_b32 v122, 16, v29
    v_and_b32 v123, 0xffff0000, v29
    v_lshlrev_b32 v124, 16, v30
    v_and_b32 v125, 0xffff0000, v30
    v_lshlrev_b32 v126, 16, v31
    v_and_b32 v127, 0xffff0000, v31
    s_waitcnt lgkmcnt(3)
    v_pk_mul_f32 v[128:129], v[80:81], v[112:113] op_sel:[0,0] op_sel_hi:[0,1]
    v_pk_mul_f32 v[130:131], v[80:81], v[114:115] op_sel:[1,0] op_sel_hi:[1,1]
    v_pk_mul_f32 v[132:133], v[82:83], v[116:117] op_sel:[0,0] op_sel_hi:[0,1]
    v_pk_mul_f32 v[134:135], v[82:83], v[118:119] op_sel:[1,0] op_sel_hi:[1,1]
    s_waitcnt lgkmcnt(1)
    v_pk_mul_f32 v[136:137], v[84:85], v[120:121] op_sel:[0,0] op_sel_hi:[0,1]
    v_pk_mul_f32 v[138:139], v[84:85], v[122:123] op_sel:[1,0] op_sel_hi:[1,1]
    v_pk_mul_f32 v[140:141], v[86:87], v[124:125] op_sel:[0,0] op_sel_hi:[0,1]
    v_pk_mul_f32 v[142:143], v[86:87], v[126:127] op_sel:[1,0] op_sel_hi:[1,1]
    v_cvt_pk_bf16_f32 v144, v128, v130
    v_cvt_pk_bf16_f32 v145, v132, v134
    v_cvt_pk_bf16_f32 v146, v136, v138
    v_cvt_pk_bf16_f32 v147, v140, v142
    v_cvt_pk_bf16_f32 v148, v129, v131
    v_cvt_pk_bf16_f32 v149, v133, v135
    v_cvt_pk_bf16_f32 v150, v137, v139
    v_cvt_pk_bf16_f32 v151, v141, v143
    global_store_dwordx4 v74, v[144:147], s[38:39] offset:0 sc1
    global_store_dwordx4 v75, v[148:151], s[38:39] offset:0 sc1
    v_pk_fma_f32 v[78:79], v[88:89], v[112:113], v[78:79] op_sel:[0,0,0] op_sel_hi:[0,1,1]
    v_pk_fma_f32 v[78:79], v[88:89], v[114:115], v[78:79] op_sel:[1,0,0] op_sel_hi:[1,1,1]
    v_pk_fma_f32 v[78:79], v[90:91], v[116:117], v[78:79] op_sel:[0,0,0] op_sel_hi:[0,1,1]
    v_pk_fma_f32 v[78:79], v[90:91], v[118:119], v[78:79] op_sel:[1,0,0] op_sel_hi:[1,1,1]
    s_waitcnt lgkmcnt(0)
    v_pk_fma_f32 v[78:79], v[92:93], v[120:121], v[78:79] op_sel:[0,0,0] op_sel_hi:[0,1,1]
    v_pk_fma_f32 v[78:79], v[92:93], v[122:123], v[78:79] op_sel:[1,0,0] op_sel_hi:[1,1,1]
    v_pk_fma_f32 v[78:79], v[94:95], v[124:125], v[78:79] op_sel:[0,0,0] op_sel_hi:[0,1,1]
    v_pk_fma_f32 v[78:79], v[94:95], v[126:127], v[78:79] op_sel:[1,0,0] op_sel_hi:[1,1,1]
    v_dot2_f32_bf16 v76, v144, s7, v76
    v_dot2_f32_bf16 v77, v148, s7, v77
    v_dot2_f32_bf16 v76, v145, s7, v76
    v_dot2_f32_bf16 v77, v149, s7, v77
    v_dot2_f32_bf16 v76, v146, s7, v76
    v_dot2_f32_bf16 v77, v150, s7, v77
    v_dot2_f32_bf16 v76, v147, s7, v76
    v_dot2_f32_bf16 v77, v151, s7, v77
    ds_read_b128 v[96:99], v73 offset:384
    ds_read_b128 v[104:107], v73 offset:2944
    ds_read_b128 v[100:103], v73 offset:400
    ds_read_b128 v[108:111], v73 offset:2960
    v_lshlrev_b32 v112, 16, v32
    v_and_b32 v113, 0xffff0000, v32
    v_lshlrev_b32 v114, 16, v33
    v_and_b32 v115, 0xffff0000, v33
    v_lshlrev_b32 v116, 16, v34
    v_and_b32 v117, 0xffff0000, v34
    v_lshlrev_b32 v118, 16, v35
    v_and_b32 v119, 0xffff0000, v35
    v_lshlrev_b32 v120, 16, v36
    v_and_b32 v121, 0xffff0000, v36
    v_lshlrev_b32 v122, 16, v37
    v_and_b32 v123, 0xffff0000, v37
    v_lshlrev_b32 v124, 16, v38
    v_and_b32 v125, 0xffff0000, v38
    v_lshlrev_b32 v126, 16, v39
    v_and_b32 v127, 0xffff0000, v39
    s_waitcnt lgkmcnt(3)
    v_pk_mul_f32 v[128:129], v[96:97], v[112:113] op_sel:[0,0] op_sel_hi:[0,1]
    v_pk_mul_f32 v[130:131], v[96:97], v[114:115] op_sel:[1,0] op_sel_hi:[1,1]
    v_pk_mul_f32 v[132:133], v[98:99], v[116:117] op_sel:[0,0] op_sel_hi:[0,1]
    v_pk_mul_f32 v[134:135], v[98:99], v[118:119] op_sel:[1,0] op_sel_hi:[1,1]
    s_waitcnt lgkmcnt(1)
    v_pk_mul_f32 v[136:137], v[100:101], v[120:121] op_sel:[0,0] op_sel_hi:[0,1]
    v_pk_mul_f32 v[138:139], v[100:101], v[122:123] op_sel:[1,0] op_sel_hi:[1,1]
    v_pk_mul_f32 v[140:141], v[102:103], v[124:125] op_sel:[0,0] op_sel_hi:[0,1]
    v_pk_mul_f32 v[142:143], v[102:103], v[126:127] op_sel:[1,0] op_sel_hi:[1,1]
    v_cvt_pk_bf16_f32 v152, v128, v130
    v_cvt_pk_bf16_f32 v153, v132, v134
    v_cvt_pk_bf16_f32 v154, v136, v138
    v_cvt_pk_bf16_f32 v155, v140, v142
    v_cvt_pk_bf16_f32 v156, v129, v131
    v_cvt_pk_bf16_f32 v157, v133, v135
    v_cvt_pk_bf16_f32 v158, v137, v139
    v_cvt_pk_bf16_f32 v159, v141, v143
    global_store_dwordx4 v74, v[152:155], s[38:39] offset:1024 sc1
    global_store_dwordx4 v75, v[156:159], s[38:39] offset:1024 sc1
    v_pk_fma_f32 v[78:79], v[104:105], v[112:113], v[78:79] op_sel:[0,0,0] op_sel_hi:[0,1,1]
    v_pk_fma_f32 v[78:79], v[104:105], v[114:115], v[78:79] op_sel:[1,0,0] op_sel_hi:[1,1,1]
    v_pk_fma_f32 v[78:79], v[106:107], v[116:117], v[78:79] op_sel:[0,0,0] op_sel_hi:[0,1,1]
    v_pk_fma_f32 v[78:79], v[106:107], v[118:119], v[78:79] op_sel:[1,0,0] op_sel_hi:[1,1,1]
    s_waitcnt lgkmcnt(0)
    v_pk_fma_f32 v[78:79], v[108:109], v[120:121], v[78:79] op_sel:[0,0,0] op_sel_hi:[0,1,1]
    v_pk_fma_f32 v[78:79], v[108:109], v[122:123], v[78:79] op_sel:[1,0,0] op_sel_hi:[1,1,1]
    v_pk_fma_f32 v[78:79], v[110:111], v[124:125], v[78:79] op_sel:[0,0,0] op_sel_hi:[0,1,1]
    v_pk_fma_f32 v[78:79], v[110:111], v[126:127], v[78:79] op_sel:[1,0,0] op_sel_hi:[1,1,1]
    v_dot2_f32_bf16 v76, v152, s7, v76
    v_dot2_f32_bf16 v77, v156, s7, v77
    v_dot2_f32_bf16 v76, v153, s7, v76
    v_dot2_f32_bf16 v77, v157, s7, v77
    v_dot2_f32_bf16 v76, v154, s7, v76
    v_dot2_f32_bf16 v77, v158, s7, v77
    v_dot2_f32_bf16 v76, v155, s7, v76
    v_dot2_f32_bf16 v77, v159, s7, v77
    ds_read_b128 v[80:83], v73 offset:512
    ds_read_b128 v[88:91], v73 offset:3072
    ds_read_b128 v[84:87], v73 offset:528
    ds_read_b128 v[92:95], v73 offset:3088
    v_lshlrev_b32 v112, 16, v40
    v_and_b32 v113, 0xffff0000, v40
    v_lshlrev_b32 v114, 16, v41
    v_and_b32 v115, 0xffff0000, v41
    v_lshlrev_b32 v116, 16, v42
    v_and_b32 v117, 0xffff0000, v42
    v_lshlrev_b32 v118, 16, v43
    v_and_b32 v119, 0xffff0000, v43
    v_lshlrev_b32 v120, 16, v44
    v_and_b32 v121, 0xffff0000, v44
    v_lshlrev_b32 v122, 16, v45
    v_and_b32 v123, 0xffff0000, v45
    v_lshlrev_b32 v124, 16, v46
    v_and_b32 v125, 0xffff0000, v46
    v_lshlrev_b32 v126, 16, v47
    v_and_b32 v127, 0xffff0000, v47
    s_waitcnt lgkmcnt(3)
    v_pk_mul_f32 v[128:129], v[80:81], v[112:113] op_sel:[0,0] op_sel_hi:[0,1]
    v_pk_mul_f32 v[130:131], v[80:81], v[114:115] op_sel:[1,0] op_sel_hi:[1,1]
    v_pk_mul_f32 v[132:133], v[82:83], v[116:117] op_sel:[0,0] op_sel_hi:[0,1]
    v_pk_mul_f32 v[134:135], v[82:83], v[118:119] op_sel:[1,0] op_sel_hi:[1,1]
    s_waitcnt lgkmcnt(1)
    v_pk_mul_f32 v[136:137], v[84:85], v[120:121] op_sel:[0,0] op_sel_hi:[0,1]
    v_pk_mul_f32 v[138:139], v[84:85], v[122:123] op_sel:[1,0] op_sel_hi:[1,1]
    v_pk_mul_f32 v[140:141], v[86:87], v[124:125] op_sel:[0,0] op_sel_hi:[0,1]
    v_pk_mul_f32 v[142:143], v[86:87], v[126:127] op_sel:[1,0] op_sel_hi:[1,1]
    v_cvt_pk_bf16_f32 v144, v128, v130
    v_cvt_pk_bf16_f32 v145, v132, v134
    v_cvt_pk_bf16_f32 v146, v136, v138
    v_cvt_pk_bf16_f32 v147, v140, v142
    v_cvt_pk_bf16_f32 v148, v129, v131
    v_cvt_pk_bf16_f32 v149, v133, v135
    v_cvt_pk_bf16_f32 v150, v137, v139
    v_cvt_pk_bf16_f32 v151, v141, v143
    global_store_dwordx4 v74, v[144:147], s[38:39] offset:2048 sc1
    global_store_dwordx4 v75, v[148:151], s[38:39] offset:2048 sc1
    v_pk_fma_f32 v[78:79], v[88:89], v[112:113], v[78:79] op_sel:[0,0,0] op_sel_hi:[0,1,1]
    v_pk_fma_f32 v[78:79], v[88:89], v[114:115], v[78:79] op_sel:[1,0,0] op_sel_hi:[1,1,1]
    v_pk_fma_f32 v[78:79], v[90:91], v[116:117], v[78:79] op_sel:[0,0,0] op_sel_hi:[0,1,1]
    v_pk_fma_f32 v[78:79], v[90:91], v[118:119], v[78:79] op_sel:[1,0,0] op_sel_hi:[1,1,1]
    s_waitcnt lgkmcnt(0)
    v_pk_fma_f32 v[78:79], v[92:93], v[120:121], v[78:79] op_sel:[0,0,0] op_sel_hi:[0,1,1]
    v_pk_fma_f32 v[78:79], v[92:93], v[122:123], v[78:79] op_sel:[1,0,0] op_sel_hi:[1,1,1]
    v_pk_fma_f32 v[78:79], v[94:95], v[124:125], v[78:79] op_sel:[0,0,0] op_sel_hi:[0,1,1]
    v_pk_fma_f32 v[78:79], v[94:95], v[126:127], v[78:79] op_sel:[1,0,0] op_sel_hi:[1,1,1]
    v_dot2_f32_bf16 v76, v144, s7, v76
    v_dot2_f32_bf16 v77, v148, s7, v77
    v_dot2_f32_bf16 v76, v145, s7, v76
    v_dot2_f32_bf16 v77, v149, s7, v77
    v_dot2_f32_bf16 v76, v146, s7, v76
    v_dot2_f32_bf16 v77, v150, s7, v77
    v_dot2_f32_bf16 v76, v147, s7, v76
    v_dot2_f32_bf16 v77, v151, s7, v77
    s_nop 2
    v_permlane32_swap_b32 v76, v77
    v_permlane32_swap_b32 v78, v79
    v_add_f32 v76, v76, v77
    v_add_f32 v78, v78, v79
    s_nop 1
    v_permlane16_swap_b32 v76, v78
    v_add_f32 v76, v76, v78
    v_lshlrev_b32 v73, 2, v0
    ds_write_b32 v73, v76 offset:5120
    s_waitcnt vmcnt(0) lgkmcnt(0)
    s_barrier
    v_lshlrev_b32 v73, 2, v1
    ds_read_b32 v112, v73 offset:5120
    ds_read_b32 v113, v73 offset:5376
    ds_read_b32 v114, v73 offset:5632
    ds_read_b32 v115, v73 offset:5888
    s_lshl_b32 s6, s6, 7
    s_add_u32 s6, s6, 49152
    v_add_u32 v73, s6, v73
    s_waitcnt lgkmcnt(2)
    v_add_f32 v112, v112, v113
    s_waitcnt lgkmcnt(0)
    v_add_f32 v114, v114, v115
    v_add_f32 v112, v112, v114
    v_min_u32 v112, -2, v112
    s_cmp_lg_u32 s3, 0
    s_cbranch_scc1 Lwp_skip_57936_422
    global_store_dword v73, v112, s[38:39] sc1
Lwp_skip_57936_422:
    s_branch Lspare_done
Lrole_main_kernel_0:
    s_sub_u32 s42, s42, 54
Lspare_done:
    s_waitcnt lgkmcnt(0)
    s_barrier
    v_and_b32 v2, 15, v1
    v_lshrrev_b32 v3, 4, v1
    v_lshlrev_b32 v4, 4, v1
    v_lshrrev_b32 v6, 2, v2
    v_and_b32 v5, 3, v2
    v_lshl_add_u32 v5, v6, 3, v5
    s_and_b32 s4, s41, 1
    s_lshl_b32 s5, s3, 1
    s_add_u32 s5, s5, s4
    s_cmp_eq_u32 s5, 7
    s_cselect_b32 s5, 0, s5
    s_mul_i32 s96, s41, 7
    s_add_u32 s96, s96, s5
    s_add_u32 s97, s96, 1
    s_cmp_eq_u32 s3, 3
    s_cselect_b32 s97, 55, s97
    s_cselect_b32 s5, 0, -1
    s_mul_i32 s4, s96, 20480
    s_add_u32 s4, s4, 7344128
    v_add_u32 v6, s4, v4
    s_mul_i32 s4, s97, 20480
    s_add_u32 s4, s4, 7344128
    v_and_b32 v7, s5, v4
    v_add_u32 v7, s4, v7
    s_lshr_b32 s5, s2, 3
    s_sub_u32 s5, s5, 20
    s_lshl_b32 s5, s5, 2
    s_add_u32 s5, s5, s3
    s_cmp_ge_u32 s5, 28
    s_cselect_b32 s6, 20, 28
    s_cselect_b32 s7, 8, 4
    s_cselect_b32 s4, -28, 0
    s_cselect_b32 s94, 0, 0xa0
    s_add_u32 s5, s5, s4
    s_add_u32 s5, s5, s94
    v_lshlrev_b32 v28, 7, v1
Lwt:
    s_min_u32 s4, s5, 255
    s_lshr_b32 s94, s4, 6
    s_lshl_b32 s94, s94, 3
    s_and_b32 s95, s2, 6
    s_add_u32 s94, s94, s95
    s_lshl_b32 s94, s94, 18
    s_and_b32 s4, s4, 63
    s_lshl_b32 s4, s4, 13
    s_add_u32 s4, s4, s94
    v_add_u32 v29, s4, v28
    global_load_dword v30, v29, s[24:25] nt
    s_add_u32 s5, s5, s6
    s_sub_u32 s7, s7, 1
    s_cmp_lg_u32 s7, 0
    s_cbranch_scc1 Lwt
Lsu:
    s_lshl_b32 s4, s96, 7
    s_add_u32 s4, s4, 49152
    v_lshl_add_u32 v28, v2, 2, s4
    global_load_dword v8, v28, s[38:39] sc1
    global_load_dword v9, v28, s[38:39] offset:64 sc1
    s_add_u32 s4, s4, 7168
    v_lshl_add_u32 v28, v3, 4, s4
    global_load_dwordx4 v[12:15], v28, s[38:39] sc1
    global_load_dwordx4 v[16:19], v28, s[38:39] offset:64 sc1
    s_lshl_b32 s4, s97, 7
    s_add_u32 s4, s4, 49152
    v_lshl_add_u32 v28, v2, 2, s4
    global_load_dword v10, v28, s[38:39] sc1
    global_load_dword v11, v28, s[38:39] offset:64 sc1
    s_add_u32 s4, s4, 7168
    v_lshl_add_u32 v28, v3, 4, s4
    global_load_dwordx4 v[20:23], v28, s[38:39] sc1
    global_load_dwordx4 v[24:27], v28, s[38:39] offset:64 sc1
    s_waitcnt vmcnt(0)
    v_max_u32 v29, v8, v9
    v_max3_u32 v29, v10, v11, v29
    v_max3_u32 v29, v12, v13, v29
    v_max3_u32 v29, v14, v15, v29
    v_max3_u32 v29, v16, v17, v29
    v_max3_u32 v29, v18, v19, v29
    v_max3_u32 v29, v20, v21, v29
    v_max3_u32 v29, v22, v23, v29
    v_max3_u32 v29, v24, v25, v29
    v_max3_u32 v29, v26, v27, v29
    v_cmp_eq_u32 vcc, -1, v29
    s_add_u32 s100, s100, 1
    s_cmp_ge_u32 s100, 262144
    s_cbranch_scc1 Lsu_x
    s_cbranch_vccnz Lsu
Lsu_x:
    s_sub_u32 s5, s43, 5
    v_mad_u32_u24 v28, v1, 3, s5
    v_min_u32 v28, 159, v28
    v_lshlrev_b32 v28, 7, v28
    s_mul_i32 s4, s96, 20480
    s_add_u32 s4, s4, 7340032
    v_add_u32 v29, s4, v28
    global_load_dword v30, v29, s[38:39] sc1
    s_mul_i32 s4, s97, 20480
    s_add_u32 s4, s4, 7340032
    v_add_u32 v29, s4, v28
    global_load_dword v31, v29, s[38:39] sc1
    s_mul_i32 s4, s96, 20480
    s_add_u32 s4, s4, 8486912
    v_add_u32 v29, s4, v28
    global_load_dword v32, v29, s[38:39] sc1
    s_mul_i32 s4, s97, 20480
    s_add_u32 s4, s4, 8486912
    v_add_u32 v29, s4, v28
    global_load_dword v33, v29, s[38:39] sc1
    s_mul_i32 s4, s41, 138240
    s_add_u32 s4, s4, 10485760
    v_mad_u32_u24 v28, v0, 3, s5
    v_min_u32 v28, 1079, v28
    v_lshl_add_u32 v28, v28, 7, s4
    global_load_dword v34, v28, s[38:39] sc1
    s_add_u32 s5, s5, 768
    v_mad_u32_u24 v28, v0, 3, s5
    v_min_u32 v28, 1079, v28
    v_lshl_add_u32 v28, v28, 7, s4
    global_load_dword v35, v28, s[38:39] sc1
    s_add_u32 s5, s5, 768
    s_waitcnt vmcnt(0)
    global_load_dwordx4 a[96:99], v6, s[38:39] offset:-4096 sc1
    global_load_dwordx4 a[100:103], v7, s[38:39] offset:-4096 sc1
    global_load_dwordx4 a[104:107], v6, s[38:39] offset:-3072 sc1
    global_load_dwordx4 a[108:111], v7, s[38:39] offset:-3072 sc1
    global_load_dwordx4 a[112:115], v6, s[38:39] offset:-2048 sc1
    global_load_dwordx4 a[116:119], v7, s[38:39] offset:-2048 sc1
    global_load_dwordx4 a[120:123], v6, s[38:39] offset:-1024 sc1
    global_load_dwordx4 a[124:127], v7, s[38:39] offset:-1024 sc1
    global_load_dwordx4 a[128:131], v6, s[38:39] offset:0 sc1
    global_load_dwordx4 a[132:135], v7, s[38:39] offset:0 sc1
    global_load_dwordx4 a[136:139], v6, s[38:39] offset:1024 sc1
    global_load_dwordx4 a[140:143], v7, s[38:39] offset:1024 sc1
    global_load_dwordx4 a[144:147], v6, s[38:39] offset:2048 sc1
    global_load_dwordx4 a[148:151], v7, s[38:39] offset:2048 sc1
    global_load_dwordx4 a[152:155], v6, s[38:39] offset:3072 sc1
    global_load_dwordx4 a[156:159], v7, s[38:39] offset:3072 sc1
    v_add_u32 v6, 8192, v6
    v_add_u32 v7, 8192, v7
    s_branch Ljoin
Lcu_r:
    s_nop 7
Lcu_p:
    s_lshl_b32 s4, s96, 7
    s_add_u32 s4, s4, 49152
    v_lshl_add_u32 v30, v2, 2, s4
    global_load_dword v8, v30, s[38:39] sc1
    global_load_dword v9, v30, s[38:39] offset:64 sc1
    s_add_u32 s4, s4, 7168
    v_lshl_add_u32 v30, v3, 4, s4
    global_load_dwordx4 v[12:15], v30, s[38:39] sc1
    global_load_dwordx4 v[16:19], v30, s[38:39] offset:64 sc1
    s_lshl_b32 s4, s97, 7
    s_add_u32 s4, s4, 49152
    v_lshl_add_u32 v30, v2, 2, s4
    global_load_dword v10, v30, s[38:39] sc1
    global_load_dword v11, v30, s[38:39] offset:64 sc1
    s_add_u32 s4, s4, 7168
    v_lshl_add_u32 v30, v3, 4, s4
    global_load_dwordx4 v[20:23], v30, s[38:39] sc1
    global_load_dwordx4 v[24:27], v30, s[38:39] offset:64 sc1
    s_waitcnt vmcnt(0)
    v_max_u32 v28, v8, v9
    v_max3_u32 v28, v10, v11, v28
    v_max3_u32 v28, v12, v13, v28
    v_max3_u32 v28, v14, v15, v28
    v_max3_u32 v28, v16, v17, v28
    v_max3_u32 v28, v18, v19, v28
    v_max3_u32 v28, v20, v21, v28
    v_max3_u32 v28, v22, v23, v28
    v_max3_u32 v28, v24, v25, v28
    v_max3_u32 v28, v26, v27, v28
    v_cmp_eq_u32 vcc, -1, v28
    s_add_u32 s100, s100, 1
    s_cmp_ge_u32 s100, 262144
    s_cbranch_scc1 Lcu_p_x
    s_cbranch_vccnz Lcu_p
Lcu_p_x:
    s_nop 1
    s_branch Lcu_ok
Ls3_r:
    s_nop 7
Ls3_p:
    global_load_dwordx2 v[124:125], v169, s[38:39] offset:0 sc1
    global_load_dwordx2 v[126:127], v169, s[38:39] offset:512 sc1
    global_load_dwordx2 v[128:129], v169, s[38:39] offset:1024 sc1
    global_load_dwordx2 v[130:131], v169, s[38:39] offset:1536 sc1
    global_load_dwordx2 v[132:133], v169, s[38:39] offset:2048 sc1
    global_load_dwordx2 v[134:135], v169, s[38:39] offset:2560 sc1
    global_load_dwordx2 v[136:137], v169, s[38:39] offset:3072 sc1
    global_load_dwordx2 v[138:139], v169, s[38:39] offset:3584 sc1
    s_waitcnt vmcnt(0)
    v_max_u32 v28, v124, v125
    v_max3_u32 v28, v126, v127, v28
    v_max3_u32 v28, v128, v129, v28
    v_max3_u32 v28, v130, v131, v28
    v_max3_u32 v28, v132, v133, v28
    v_max3_u32 v28, v134, v135, v28
    v_max3_u32 v28, v136, v137, v28
    v_max3_u32 v28, v138, v139, v28
    v_cmp_eq_u32 vcc, -1, v28
    s_add_u32 s100, s100, 1
    s_cmp_ge_u32 s100, 262144
    s_cbranch_scc1 Ls3_p_x
    s_cbranch_vccnz Ls3_p
Ls3_p_x:
    s_nop 1
    s_branch Ls3_ok
Lz0_r:
    s_nop 7
Lz0_p:
    global_load_dwordx4 v[174:177], v30, s[52:53] offset:-3072 sc1
    global_load_dwordx4 v[178:181], v30, s[52:53] offset:-2048 sc1
    global_load_dwordx4 v[182:185], v30, s[52:53] offset:-1024 sc1
    global_load_dwordx4 v[186:189], v30, s[52:53] offset:0 sc1
    s_waitcnt vmcnt(0)
    v_max_u32 v28, v174, v175
    v_max3_u32 v28, v176, v177, v28
    v_max3_u32 v28, v178, v179, v28
    v_max3_u32 v28, v180, v181, v28
    v_max3_u32 v28, v182, v183, v28
    v_max3_u32 v28, v184, v185, v28
    v_max3_u32 v28, v186, v187, v28
    v_max3_u32 v28, v188, v189, v28
    v_cmp_eq_u32 vcc, -1, v28
    s_add_u32 s100, s100, 1
    s_cmp_ge_u32 s100, 262144
    s_cbranch_scc1 Lz0_p_x
    s_cbranch_vccnz Lz0_p
Lz0_p_x:
    s_nop 1
    s_branch Lz0_ok
Lz1_r:
    s_nop 7
Lz1_p:
    global_load_dwordx4 v[190:193], v30, s[52:53] offset:1024 sc1
    global_load_dwordx4 v[194:197], v30, s[52:53] offset:2048 sc1
    global_load_dwordx4 v[198:201], v30, s[52:53] offset:3072 sc1
    global_load_dwordx4 v[202:205], v31, s[52:53] offset:-3072 sc1
    s_waitcnt vmcnt(0)
    v_max_u32 v28, v190, v191
    v_max3_u32 v28, v192, v193, v28
    v_max3_u32 v28, v194, v195, v28
    v_max3_u32 v28, v196, v197, v28
    v_max3_u32 v28, v198, v199, v28
    v_max3_u32 v28, v200, v201, v28
    v_max3_u32 v28, v202, v203, v28
    v_max3_u32 v28, v204, v205, v28
    v_cmp_eq_u32 vcc, -1, v28
    s_add_u32 s100, s100, 1
    s_cmp_ge_u32 s100, 262144
    s_cbranch_scc1 Lz1_p_x
    s_cbranch_vccnz Lz1_p
Lz1_p_x:
    s_nop 1
    s_branch Lz1_ok
Lz2_r:
    s_nop 7
Lz2_p:
    global_load_dwordx4 v[206:209], v31, s[52:53] offset:-2048 sc1
    global_load_dwordx4 v[210:213], v31, s[52:53] offset:-1024 sc1
    global_load_dwordx4 v[214:217], v31, s[52:53] offset:0 sc1
    global_load_dwordx4 v[218:221], v31, s[52:53] offset:1024 sc1
    s_waitcnt vmcnt(0)
    v_max_u32 v28, v206, v207
    v_max3_u32 v28, v208, v209, v28
    v_max3_u32 v28, v210, v211, v28
    v_max3_u32 v28, v212, v213, v28
    v_max3_u32 v28, v214, v215, v28
    v_max3_u32 v28, v216, v217, v28
    v_max3_u32 v28, v218, v219, v28
    v_max3_u32 v28, v220, v221, v28
    v_cmp_eq_u32 vcc, -1, v28
    s_add_u32 s100, s100, 1
    s_cmp_ge_u32 s100, 262144
    s_cbranch_scc1 Lz2_p_x
    s_cbranch_vccnz Lz2_p
Lz2_p_x:
    s_nop 1
    s_branch Lz2_ok
Lz3_r:
    s_nop 7
Lz3_p:
    global_load_dwordx4 v[222:225], v31, s[52:53] offset:2048 sc1
    global_load_dwordx4 v[226:229], v31, s[52:53] offset:3072 sc1
    global_load_dwordx4 v[230:233], v30, s[54:55] offset:-3072 sc1
    global_load_dwordx4 v[234:237], v30, s[54:55] offset:-2048 sc1
    s_waitcnt vmcnt(0)
    v_max_u32 v28, v222, v223
    v_max3_u32 v28, v224, v225, v28
    v_max3_u32 v28, v226, v227, v28
    v_max3_u32 v28, v228, v229, v28
    v_max3_u32 v28, v230, v231, v28
    v_max3_u32 v28, v232, v233, v28
    v_max3_u32 v28, v234, v235, v28
    v_max3_u32 v28, v236, v237, v28
    v_cmp_eq_u32 vcc, -1, v28
    s_add_u32 s100, s100, 1
    s_cmp_ge_u32 s100, 262144
    s_cbranch_scc1 Lz3_p_x
    s_cbranch_vccnz Lz3_p
Lz3_p_x:
    s_nop 1
    s_branch Lz3_ok
Lz4_r:
    s_nop 7
Lz4_p:
    global_load_dwordx4 v[238:241], v30, s[54:55] offset:-1024 sc1
    global_load_dwordx4 v[242:245], v30, s[54:55] offset:0 sc1
    global_load_dwordx4 v[246:249], v30, s[54:55] offset:1024 sc1
    global_load_dwordx4 v[250:253], v30, s[54:55] offset:2048 sc1
    s_waitcnt vmcnt(0)
    v_max_u32 v28, v238, v239
    v_max3_u32 v28, v240, v241, v28
    v_max3_u32 v28, v242, v243, v28
    v_max3_u32 v28, v244, v245, v28
    v_max3_u32 v28, v246, v247, v28
    v_max3_u32 v28, v248, v249, v28
    v_max3_u32 v28, v250, v251, v28
    v_max3_u32 v28, v252, v253, v28
    v_cmp_eq_u32 vcc, -1, v28
    s_add_u32 s100, s100, 1
    s_cmp_ge_u32 s100, 262144
    s_cbranch_scc1 Lz4_p_x
    s_cbranch_vccnz Lz4_p
Lz4_p_x:
    s_nop 1
    s_branch Lz4_ok
Lz5_r:
    s_nop 7
Lz5_p:
    global_load_dwordx4 v[174:177], v30, s[54:55] offset:3072 sc1
    global_load_dwordx4 v[178:181], v31, s[54:55] offset:-3072 sc1
    global_load_dwordx4 v[182:185], v31, s[54:55] offset:-2048 sc1
    global_load_dwordx4 v[186:189], v31, s[54:55] offset:-1024 sc1
    s_waitcnt vmcnt(0)
    v_max_u32 v28, v174, v175
    v_max3_u32 v28, v176, v177, v28
    v_max3_u32 v28, v178, v179, v28
    v_max3_u32 v28, v180, v181, v28
    v_max3_u32 v28, v182, v183, v28
    v_max3_u32 v28, v184, v185, v28
    v_max3_u32 v28, v186, v187, v28
    v_max3_u32 v28, v188, v189, v28
    v_cmp_eq_u32 vcc, -1, v28
    s_add_u32 s100, s100, 1
    s_cmp_ge_u32 s100, 262144
    s_cbranch_scc1 Lz5_p_x
    s_cbranch_vccnz Lz5_p
Lz5_p_x:
    s_nop 1
    s_branch Lz5_ok
Lz6_r:
    s_nop 7
Lz6_p:
    global_load_dwordx4 v[190:193], v31, s[54:55] offset:0 sc1
    global_load_dwordx4 v[194:197], v31, s[54:55] offset:1024 sc1
    global_load_dwordx4 v[198:201], v31, s[54:55] offset:2048 sc1
    global_load_dwordx4 v[202:205], v31, s[54:55] offset:3072 sc1
    s_waitcnt vmcnt(0)
    v_max_u32 v28, v190, v191
    v_max3_u32 v28, v192, v193, v28
    v_max3_u32 v28, v194, v195, v28
    v_max3_u32 v28, v196, v197, v28
    v_max3_u32 v28, v198, v199, v28
    v_max3_u32 v28, v200, v201, v28
    v_max3_u32 v28, v202, v203, v28
    v_max3_u32 v28, v204, v205, v28
    v_cmp_eq_u32 vcc, -1, v28
    s_add_u32 s100, s100, 1
    s_cmp_ge_u32 s100, 262144
    s_cbranch_scc1 Lz6_p_x
    s_cbranch_vccnz Lz6_p
Lz6_p_x:
    s_nop 1
    s_branch Lz6_ok
Lz7_r:
    s_nop 7
Lz7_p:
    global_load_dwordx4 v[206:209], v30, s[56:57] offset:-3072 sc1
    global_load_dwordx4 v[210:213], v30, s[56:57] offset:-2048 sc1
    global_load_dwordx4 v[214:217], v30, s[56:57] offset:-1024 sc1
    global_load_dwordx4 v[218:221], v30, s[56:57] offset:0 sc1
    s_waitcnt vmcnt(0)
    v_max_u32 v28, v206, v207
    v_max3_u32 v28, v208, v209, v28
    v_max3_u32 v28, v210, v211, v28
    v_max3_u32 v28, v212, v213, v28
    v_max3_u32 v28, v214, v215, v28
    v_max3_u32 v28, v216, v217, v28
    v_max3_u32 v28, v218, v219, v28
    v_max3_u32 v28, v220, v221, v28
    v_cmp_eq_u32 vcc, -1, v28
    s_add_u32 s100, s100, 1
    s_cmp_ge_u32 s100, 262144
    s_cbranch_scc1 Lz7_p_x
    s_cbranch_vccnz Lz7_p
Lz7_p_x:
    s_nop 1
    s_branch Lz7_ok
Lz8_r:
    s_nop 7
Lz8_p:
    global_load_dwordx4 v[222:225], v30, s[56:57] offset:1024 sc1
    global_load_dwordx4 v[226:229], v30, s[56:57] offset:2048 sc1
    global_load_dwordx4 v[230:233], v30, s[56:57] offset:3072 sc1
    global_load_dwordx4 v[234:237], v31, s[56:57] offset:-3072 sc1
    s_waitcnt vmcnt(0)
    v_max_u32 v28, v222, v223
    v_max3_u32 v28, v224, v225, v28
    v_max3_u32 v28, v226, v227, v28
    v_max3_u32 v28, v228, v229, v28
    v_max3_u32 v28, v230, v231, v28
    v_max3_u32 v28, v232, v233, v28
    v_max3_u32 v28, v234, v235, v28
    v_max3_u32 v28, v236, v237, v28
    v_cmp_eq_u32 vcc, -1, v28
    s_add_u32 s100, s100, 1
    s_cmp_ge_u32 s100, 262144
    s_cbranch_scc1 Lz8_p_x
    s_cbranch_vccnz Lz8_p
Lz8_p_x:
    s_nop 1
    s_branch Lz8_ok
Lz9_r:
    s_nop 7
Lz9_p:
    global_load_dwordx4 v[238:241], v31, s[56:57] offset:-2048 sc1
    global_load_dwordx4 v[242:245], v31, s[56:57] offset:-1024 sc1
    global_load_dwordx4 v[246:249], v31, s[56:57] offset:0 sc1
    global_load_dwordx4 v[250:253], v31, s[56:57] offset:1024 sc1
    s_waitcnt vmcnt(0)
    v_max_u32 v28, v238, v239
    v_max3_u32 v28, v240, v241, v28
    v_max3_u32 v28, v242, v243, v28
    v_max3_u32 v28, v244, v245, v28
    v_max3_u32 v28, v246, v247, v28
    v_max3_u32 v28, v248, v249, v28
    v_max3_u32 v28, v250, v251, v28
    v_max3_u32 v28, v252, v253, v28
    v_cmp_eq_u32 vcc, -1, v28
    s_add_u32 s100, s100, 1
    s_cmp_ge_u32 s100, 262144
    s_cbranch_scc1 Lz9_p_x
    s_cbranch_vccnz Lz9_p
Lz9_p_x:
    s_nop 1
    s_branch Lz9_ok
Lz10_r:
    s_nop 7
Lz10_p:
    global_load_dwordx4 v[174:177], v31, s[56:57] offset:2048 sc1
    global_load_dwordx4 v[178:181], v31, s[56:57] offset:3072 sc1
    global_load_dwordx4 v[182:185], v30, s[58:59] offset:-3072 sc1
    global_load_dwordx4 v[186:189], v30, s[58:59] offset:-2048 sc1
    s_waitcnt vmcnt(0)
    v_max_u32 v28, v174, v175
    v_max3_u32 v28, v176, v177, v28
    v_max3_u32 v28, v178, v179, v28
    v_max3_u32 v28, v180, v181, v28
    v_max3_u32 v28, v182, v183, v28
    v_max3_u32 v28, v184, v185, v28
    v_max3_u32 v28, v186, v187, v28
    v_max3_u32 v28, v188, v189, v28
    v_cmp_eq_u32 vcc, -1, v28
    s_add_u32 s100, s100, 1
    s_cmp_ge_u32 s100, 262144
    s_cbranch_scc1 Lz10_p_x
    s_cbranch_vccnz Lz10_p
Lz10_p_x:
    s_nop 1
    s_branch Lz10_ok
Lz11_r:
    s_nop 7
Lz11_p:
    global_load_dwordx4 v[190:193], v30, s[58:59] offset:-1024 sc1
    global_load_dwordx4 v[194:197], v30, s[58:59] offset:0 sc1
    global_load_dwordx4 v[198:201], v30, s[58:59] offset:1024 sc1
    global_load_dwordx4 v[202:205], v30, s[58:59] offset:2048 sc1
    s_waitcnt vmcnt(0)
    v_max_u32 v28, v190, v191
    v_max3_u32 v28, v192, v193, v28
    v_max3_u32 v28, v194, v195, v28
    v_max3_u32 v28, v196, v197, v28
    v_max3_u32 v28, v198, v199, v28
    v_max3_u32 v28, v200, v201, v28
    v_max3_u32 v28, v202, v203, v28
    v_max3_u32 v28, v204, v205, v28
    v_cmp_eq_u32 vcc, -1, v28
    s_add_u32 s100, s100, 1
    s_cmp_ge_u32 s100, 262144
    s_cbranch_scc1 Lz11_p_x
    s_cbranch_vccnz Lz11_p
Lz11_p_x:
    s_nop 1
    s_branch Lz11_ok
Lz12_r:
    s_nop 7
Lz12_p:
    global_load_dwordx4 v[206:209], v30, s[58:59] offset:3072 sc1
    global_load_dwordx4 v[210:213], v31, s[58:59] offset:-3072 sc1
    global_load_dwordx4 v[214:217], v31, s[58:59] offset:-2048 sc1
    global_load_dwordx4 v[218:221], v31, s[58:59] offset:-1024 sc1
    s_waitcnt vmcnt(0)
    v_max_u32 v28, v206, v207
    v_max3_u32 v28, v208, v209, v28
    v_max3_u32 v28, v210, v211, v28
    v_max3_u32 v28, v212, v213, v28
    v_max3_u32 v28, v214, v215, v28
    v_max3_u32 v28, v216, v217, v28
    v_max3_u32 v28, v218, v219, v28
    v_max3_u32 v28, v220, v221, v28
    v_cmp_eq_u32 vcc, -1, v28
    s_add_u32 s100, s100, 1
    s_cmp_ge_u32 s100, 262144
    s_cbranch_scc1 Lz12_p_x
    s_cbranch_vccnz Lz12_p
Lz12_p_x:
    s_nop 1
    s_branch Lz12_ok
Lz13_r:
    s_nop 7
Lz13_p:
    global_load_dwordx4 v[222:225], v31, s[58:59] offset:0 sc1
    global_load_dwordx4 v[226:229], v31, s[58:59] offset:1024 sc1
    global_load_dwordx4 v[230:233], v31, s[58:59] offset:2048 sc1
    global_load_dwordx4 v[234:237], v31, s[58:59] offset:3072 sc1
    s_waitcnt vmcnt(0)
    v_max_u32 v28, v222, v223
    v_max3_u32 v28, v224, v225, v28
    v_max3_u32 v28, v226, v227, v28
    v_max3_u32 v28, v228, v229, v28
    v_max3_u32 v28, v230, v231, v28
    v_max3_u32 v28, v232, v233, v28
    v_max3_u32 v28, v234, v235, v28
    v_max3_u32 v28, v236, v237, v28
    v_cmp_eq_u32 vcc, -1, v28
    s_add_u32 s100, s100, 1
    s_cmp_ge_u32 s100, 262144
    s_cbranch_scc1 Lz13_p_x
    s_cbranch_vccnz Lz13_p
Lz13_p_x:
    s_nop 1
    s_branch Lz13_ok
Lz14_r:
    s_nop 7
Lz14_p:
    global_load_dwordx4 v[238:241], v30, s[60:61] offset:-3072 sc1
    global_load_dwordx4 v[242:245], v31, s[60:61] offset:-3072 sc1
    global_load_dwordx4 v[246:249], v30, s[62:63] offset:-3072 sc1
    global_load_dwordx4 v[250:253], v31, s[62:63] offset:-3072 sc1
    s_waitcnt vmcnt(0)
    v_max_u32 v28, v238, v239
    v_max3_u32 v28, v240, v241, v28
    v_max3_u32 v28, v242, v243, v28
    v_max3_u32 v28, v244, v245, v28
    v_max3_u32 v28, v246, v247, v28
    v_max3_u32 v28, v248, v249, v28
    v_max3_u32 v28, v250, v251, v28
    v_max3_u32 v28, v252, v253, v28
    v_cmp_eq_u32 vcc, -1, v28
    s_add_u32 s100, s100, 1
    s_cmp_ge_u32 s100, 262144
    s_cbranch_scc1 Lz14_p_x
    s_cbranch_vccnz Lz14_p
Lz14_p_x:
    s_nop 1
    s_branch Lz14_ok
Lz15_r:
    s_nop 7
Lz15_p:
    global_load_dwordx4 v[174:177], v30, s[64:65] offset:-3072 sc1
    global_load_dwordx4 v[178:181], v31, s[64:65] offset:-3072 sc1
    global_load_dwordx4 v[182:185], v30, s[66:67] offset:-3072 sc1
    global_load_dwordx4 v[186:189], v31, s[66:67] offset:-3072 sc1
    s_waitcnt vmcnt(0)
    v_max_u32 v28, v174, v175
    v_max3_u32 v28, v176, v177, v28
    v_max3_u32 v28, v178, v179, v28
    v_max3_u32 v28, v180, v181, v28
    v_max3_u32 v28, v182, v183, v28
    v_max3_u32 v28, v184, v185, v28
    v_max3_u32 v28, v186, v187, v28
    v_max3_u32 v28, v188, v189, v28
    v_cmp_eq_u32 vcc, -1, v28
    s_add_u32 s100, s100, 1
    s_cmp_ge_u32 s100, 262144
    s_cbranch_scc1 Lz15_p_x
    s_cbranch_vccnz Lz15_p
Lz15_p_x:
    s_nop 1
    s_branch Lz15_ok
Lz16_r:
    s_nop 7
Lz16_p:
    global_load_dwordx4 v[190:193], v30, s[60:61] offset:-2048 sc1
    global_load_dwordx4 v[194:197], v31, s[60:61] offset:-2048 sc1
    global_load_dwordx4 v[198:201], v30, s[62:63] offset:-2048 sc1
    global_load_dwordx4 v[202:205], v31, s[62:63] offset:-2048 sc1
    s_waitcnt vmcnt(0)
    v_max_u32 v28, v190, v191
    v_max3_u32 v28, v192, v193, v28
    v_max3_u32 v28, v194, v195, v28
    v_max3_u32 v28, v196, v197, v28
    v_max3_u32 v28, v198, v199, v28
    v_max3_u32 v28, v200, v201, v28
    v_max3_u32 v28, v202, v203, v28
    v_max3_u32 v28, v204, v205, v28
    v_cmp_eq_u32 vcc, -1, v28
    s_add_u32 s100, s100, 1
    s_cmp_ge_u32 s100, 262144
    s_cbranch_scc1 Lz16_p_x
    s_cbranch_vccnz Lz16_p
Lz16_p_x:
    s_nop 1
    s_branch Lz16_ok
Lz17_r:
    s_nop 7
Lz17_p:
    global_load_dwordx4 v[206:209], v30, s[64:65] offset:-2048 sc1
    global_load_dwordx4 v[210:213], v31, s[64:65] offset:-2048 sc1
    global_load_dwordx4 v[214:217], v30, s[66:67] offset:-2048 sc1
    global_load_dwordx4 v[218:221], v31, s[66:67] offset:-2048 sc1
    s_waitcnt vmcnt(0)
    v_max_u32 v28, v206, v207
    v_max3_u32 v28, v208, v209, v28
    v_max3_u32 v28, v210, v211, v28
    v_max3_u32 v28, v212, v213, v28
    v_max3_u32 v28, v214, v215, v28
    v_max3_u32 v28, v216, v217, v28
    v_max3_u32 v28, v218, v219, v28
    v_max3_u32 v28, v220, v221, v28
    v_cmp_eq_u32 vcc, -1, v28
    s_add_u32 s100, s100, 1
    s_cmp_ge_u32 s100, 262144
    s_cbranch_scc1 Lz17_p_x
    s_cbranch_vccnz Lz17_p
Lz17_p_x:
    s_nop 1
    s_branch Lz17_ok
Lz18_r:
    s_nop 7
Lz18_p:
    global_load_dwordx4 v[222:225], v30, s[60:61] offset:-1024 sc1
    global_load_dwordx4 v[226:229], v31, s[60:61] offset:-1024 sc1
    global_load_dwordx4 v[230:233], v30, s[62:63] offset:-1024 sc1
    global_load_dwordx4 v[234:237], v31, s[62:63] offset:-1024 sc1
    s_waitcnt vmcnt(0)
    v_max_u32 v28, v222, v223
    v_max3_u32 v28, v224, v225, v28
    v_max3_u32 v28, v226, v227, v28
    v_max3_u32 v28, v228, v229, v28
    v_max3_u32 v28, v230, v231, v28
    v_max3_u32 v28, v232, v233, v28
    v_max3_u32 v28, v234, v235, v28
    v_max3_u32 v28, v236, v237, v28
    v_cmp_eq_u32 vcc, -1, v28
    s_add_u32 s100, s100, 1
    s_cmp_ge_u32 s100, 262144
    s_cbranch_scc1 Lz18_p_x
    s_cbranch_vccnz Lz18_p
Lz18_p_x:
    s_nop 1
    s_branch Lz18_ok
Lz19_r:
    s_nop 7
Lz19_p:
    global_load_dwordx4 v[238:241], v30, s[64:65] offset:-1024 sc1
    global_load_dwordx4 v[242:245], v31, s[64:65] offset:-1024 sc1
    global_load_dwordx4 v[246:249], v30, s[66:67] offset:-1024 sc1
    global_load_dwordx4 v[250:253], v31, s[66:67] offset:-1024 sc1
    s_waitcnt vmcnt(0)
    v_max_u32 v28, v238, v239
    v_max3_u32 v28, v240, v241, v28
    v_max3_u32 v28, v242, v243, v28
    v_max3_u32 v28, v244, v245, v28
    v_max3_u32 v28, v246, v247, v28
    v_max3_u32 v28, v248, v249, v28
    v_max3_u32 v28, v250, v251, v28
    v_max3_u32 v28, v252, v253, v28
    v_cmp_eq_u32 vcc, -1, v28
    s_add_u32 s100, s100, 1
    s_cmp_ge_u32 s100, 262144
    s_cbranch_scc1 Lz19_p_x
    s_cbranch_vccnz Lz19_p
Lz19_p_x:
    s_nop 1
    s_branch Lz19_ok
Lz20_r:
    s_nop 7
Lz20_p:
    global_load_dwordx4 v[174:177], v30, s[60:61] offset:0 sc1
    global_load_dwordx4 v[178:181], v31, s[60:61] offset:0 sc1
    global_load_dwordx4 v[182:185], v30, s[62:63] offset:0 sc1
    global_load_dwordx4 v[186:189], v31, s[62:63] offset:0 sc1
    s_waitcnt vmcnt(0)
    v_max_u32 v28, v174, v175
    v_max3_u32 v28, v176, v177, v28
    v_max3_u32 v28, v178, v179, v28
    v_max3_u32 v28, v180, v181, v28
    v_max3_u32 v28, v182, v183, v28
    v_max3_u32 v28, v184, v185, v28
    v_max3_u32 v28, v186, v187, v28
    v_max3_u32 v28, v188, v189, v28
    v_cmp_eq_u32 vcc, -1, v28
    s_add_u32 s100, s100, 1
    s_cmp_ge_u32 s100, 262144
    s_cbranch_scc1 Lz20_p_x
    s_cbranch_vccnz Lz20_p
Lz20_p_x:
    s_nop 1
    s_branch Lz20_ok
Lz21_r:
    s_nop 7
Lz21_p:
    global_load_dwordx4 v[190:193], v30, s[64:65] offset:0 sc1
    global_load_dwordx4 v[194:197], v31, s[64:65] offset:0 sc1
    global_load_dwordx4 v[198:201], v30, s[66:67] offset:0 sc1
    global_load_dwordx4 v[202:205], v31, s[66:67] offset:0 sc1
    s_waitcnt vmcnt(0)
    v_max_u32 v28, v190, v191
    v_max3_u32 v28, v192, v193, v28
    v_max3_u32 v28, v194, v195, v28
    v_max3_u32 v28, v196, v197, v28
    v_max3_u32 v28, v198, v199, v28
    v_max3_u32 v28, v200, v201, v28
    v_max3_u32 v28, v202, v203, v28
    v_max3_u32 v28, v204, v205, v28
    v_cmp_eq_u32 vcc, -1, v28
    s_add_u32 s100, s100, 1
    s_cmp_ge_u32 s100, 262144
    s_cbranch_scc1 Lz21_p_x
    s_cbranch_vccnz Lz21_p
Lz21_p_x:
    s_nop 1
    s_branch Lz21_ok
Lz22_r:
    s_nop 7
Lz22_p:
    global_load_dwordx4 v[206:209], v30, s[60:61] offset:1024 sc1
    global_load_dwordx4 v[210:213], v31, s[60:61] offset:1024 sc1
    global_load_dwordx4 v[214:217], v30, s[62:63] offset:1024 sc1
    global_load_dwordx4 v[218:221], v31, s[62:63] offset:1024 sc1
    s_waitcnt vmcnt(0)
    v_max_u32 v28, v206, v207
    v_max3_u32 v28, v208, v209, v28
    v_max3_u32 v28, v210, v211, v28
    v_max3_u32 v28, v212, v213, v28
    v_max3_u32 v28, v214, v215, v28
    v_max3_u32 v28, v216, v217, v28
    v_max3_u32 v28, v218, v219, v28
    v_max3_u32 v28, v220, v221, v28
    v_cmp_eq_u32 vcc, -1, v28
    s_add_u32 s100, s100, 1
    s_cmp_ge_u32 s100, 262144
    s_cbranch_scc1 Lz22_p_x
    s_cbranch_vccnz Lz22_p
Lz22_p_x:
    s_nop 1
    s_branch Lz22_ok
Lz23_r:
    s_nop 7
Lz23_p:
    global_load_dwordx4 v[222:225], v30, s[64:65] offset:1024 sc1
    global_load_dwordx4 v[226:229], v31, s[64:65] offset:1024 sc1
    global_load_dwordx4 v[230:233], v30, s[66:67] offset:1024 sc1
    global_load_dwordx4 v[234:237], v31, s[66:67] offset:1024 sc1
    s_waitcnt vmcnt(0)
    v_max_u32 v28, v222, v223
    v_max3_u32 v28, v224, v225, v28
    v_max3_u32 v28, v226, v227, v28
    v_max3_u32 v28, v228, v229, v28
    v_max3_u32 v28, v230, v231, v28
    v_max3_u32 v28, v232, v233, v28
    v_max3_u32 v28, v234, v235, v28
    v_max3_u32 v28, v236, v237, v28
    v_cmp_eq_u32 vcc, -1, v28
    s_add_u32 s100, s100, 1
    s_cmp_ge_u32 s100, 262144
    s_cbranch_scc1 Lz23_p_x
    s_cbranch_vccnz Lz23_p
Lz23_p_x:
    s_nop 1
    s_branch Lz23_ok
Lz24_r:
    s_nop 7
Lz24_p:
    global_load_dwordx4 v[238:241], v30, s[60:61] offset:2048 sc1
    global_load_dwordx4 v[242:245], v31, s[60:61] offset:2048 sc1
    global_load_dwordx4 v[246:249], v30, s[62:63] offset:2048 sc1
    global_load_dwordx4 v[250:253], v31, s[62:63] offset:2048 sc1
    s_waitcnt vmcnt(0)
    v_max_u32 v28, v238, v239
    v_max3_u32 v28, v240, v241, v28
    v_max3_u32 v28, v242, v243, v28
    v_max3_u32 v28, v244, v245, v28
    v_max3_u32 v28, v246, v247, v28
    v_max3_u32 v28, v248, v249, v28
    v_max3_u32 v28, v250, v251, v28
    v_max3_u32 v28, v252, v253, v28
    v_cmp_eq_u32 vcc, -1, v28
    s_add_u32 s100, s100, 1
    s_cmp_ge_u32 s100, 262144
    s_cbranch_scc1 Lz24_p_x
    s_cbranch_vccnz Lz24_p
Lz24_p_x:
    s_nop 1
    s_branch Lz24_ok
Lz25_r:
    s_nop 7
Lz25_p:
    global_load_dwordx4 v[174:177], v30, s[64:65] offset:2048 sc1
    global_load_dwordx4 v[178:181], v31, s[64:65] offset:2048 sc1
    global_load_dwordx4 v[182:185], v30, s[66:67] offset:2048 sc1
    global_load_dwordx4 v[186:189], v31, s[66:67] offset:2048 sc1
    s_waitcnt vmcnt(0)
    v_max_u32 v28, v174, v175
    v_max3_u32 v28, v176, v177, v28
    v_max3_u32 v28, v178, v179, v28
    v_max3_u32 v28, v180, v181, v28
    v_max3_u32 v28, v182, v183, v28
    v_max3_u32 v28, v184, v185, v28
    v_max3_u32 v28, v186, v187, v28
    v_max3_u32 v28, v188, v189, v28
    v_cmp_eq_u32 vcc, -1, v28
    s_add_u32 s100, s100, 1
    s_cmp_ge_u32 s100, 262144
    s_cbranch_scc1 Lz25_p_x
    s_cbranch_vccnz Lz25_p
Lz25_p_x:
    s_nop 1
    s_branch Lz25_ok
Lz26_r:
    s_nop 7
Lz26_p:
    global_load_dwordx4 v[190:193], v30, s[60:61] offset:3072 sc1
    global_load_dwordx4 v[194:197], v31, s[60:61] offset:3072 sc1
    global_load_dwordx4 v[198:201], v30, s[62:63] offset:3072 sc1
    global_load_dwordx4 v[202:205], v31, s[62:63] offset:3072 sc1
    s_waitcnt vmcnt(0)
    v_max_u32 v28, v190, v191
    v_max3_u32 v28, v192, v193, v28
    v_max3_u32 v28, v194, v195, v28
    v_max3_u32 v28, v196, v197, v28
    v_max3_u32 v28, v198, v199, v28
    v_max3_u32 v28, v200, v201, v28
    v_max3_u32 v28, v202, v203, v28
    v_max3_u32 v28, v204, v205, v28
    v_cmp_eq_u32 vcc, -1, v28
    s_add_u32 s100, s100, 1
    s_cmp_ge_u32 s100, 262144
    s_cbranch_scc1 Lz26_p_x
    s_cbranch_vccnz Lz26_p
Lz26_p_x:
    s_nop 1
    s_branch Lz26_ok
Lz27_r:
    s_nop 7
Lz27_p:
    global_load_dwordx4 v[206:209], v30, s[64:65] offset:3072 sc1
    global_load_dwordx4 v[210:213], v31, s[64:65] offset:3072 sc1
    global_load_dwordx4 v[214:217], v30, s[66:67] offset:3072 sc1
    global_load_dwordx4 v[218:221], v31, s[66:67] offset:3072 sc1
    s_waitcnt vmcnt(0)
    v_max_u32 v28, v206, v207
    v_max3_u32 v28, v208, v209, v28
    v_max3_u32 v28, v210, v211, v28
    v_max3_u32 v28, v212, v213, v28
    v_max3_u32 v28, v214, v215, v28
    v_max3_u32 v28, v216, v217, v28
    v_max3_u32 v28, v218, v219, v28
    v_max3_u32 v28, v220, v221, v28
    v_cmp_eq_u32 vcc, -1, v28
    s_add_u32 s100, s100, 1
    s_cmp_ge_u32 s100, 262144
    s_cbranch_scc1 Lz27_p_x
    s_cbranch_vccnz Lz27_p
Lz27_p_x:
    s_nop 1
    s_branch Lz27_ok
Lp0_r:
    s_nop 7
Lp0_p:
    global_load_dwordx4 v[62:65], v6, s[38:39] offset:-4096 sc1
    global_load_dwordx4 v[66:69], v6, s[38:39] offset:0 sc1
    global_load_dwordx4 v[70:73], v6, s[38:39] offset:3072 sc1
    global_load_dwordx4 v[74:77], v7, s[38:39] offset:-1024 sc1
    global_load_dwordx4 v[78:81], v7, s[38:39] offset:2048 sc1
    global_load_dwordx4 v[82:85], v26, s[38:39] offset:-2048 sc1
    global_load_dwordx4 v[86:89], v26, s[38:39] offset:1024 sc1
    global_load_dwordx4 v[90:93], v27, s[38:39] offset:-3072 sc1
    s_waitcnt vmcnt(0)
    v_max_u32 v28, v62, v63
    v_max3_u32 v28, v64, v65, v28
    v_max3_u32 v28, v66, v67, v28
    v_max3_u32 v28, v68, v69, v28
    v_max3_u32 v28, v70, v71, v28
    v_max3_u32 v28, v72, v73, v28
    v_max3_u32 v28, v74, v75, v28
    v_max3_u32 v28, v76, v77, v28
    v_max3_u32 v28, v78, v79, v28
    v_max3_u32 v28, v80, v81, v28
    v_max3_u32 v28, v82, v83, v28
    v_max3_u32 v28, v84, v85, v28
    v_max3_u32 v28, v86, v87, v28
    v_max3_u32 v28, v88, v89, v28
    v_max3_u32 v28, v90, v91, v28
    v_max3_u32 v28, v92, v93, v28
    v_cmp_eq_u32 vcc, -1, v28
    s_add_u32 s100, s100, 1
    s_cmp_ge_u32 s100, 262144
    s_cbranch_scc1 Lp0_p_x
    s_cbranch_vccnz Lp0_p
Lp0_p_x:
    s_nop 1
    s_branch Lp0_ok
Lp1_r:
    s_nop 7
Lp1_p:
    global_load_dwordx4 v[94:97], v6, s[38:39] offset:-3072 sc1
    global_load_dwordx4 v[98:101], v6, s[38:39] offset:1024 sc1
    global_load_dwordx4 v[102:105], v7, s[38:39] offset:-4096 sc1
    global_load_dwordx4 v[106:109], v7, s[38:39] offset:0 sc1
    global_load_dwordx4 v[110:113], v7, s[38:39] offset:3072 sc1
    global_load_dwordx4 v[114:117], v26, s[38:39] offset:-1024 sc1
    global_load_dwordx4 v[118:121], v26, s[38:39] offset:2048 sc1
    global_load_dwordx4 v[122:125], v27, s[38:39] offset:-2048 sc1
    s_waitcnt vmcnt(0)
    v_max_u32 v28, v94, v95
    v_max3_u32 v28, v96, v97, v28
    v_max3_u32 v28, v98, v99, v28
    v_max3_u32 v28, v100, v101, v28
    v_max3_u32 v28, v102, v103, v28
    v_max3_u32 v28, v104, v105, v28
    v_max3_u32 v28, v106, v107, v28
    v_max3_u32 v28, v108, v109, v28
    v_max3_u32 v28, v110, v111, v28
    v_max3_u32 v28, v112, v113, v28
    v_max3_u32 v28, v114, v115, v28
    v_max3_u32 v28, v116, v117, v28
    v_max3_u32 v28, v118, v119, v28
    v_max3_u32 v28, v120, v121, v28
    v_max3_u32 v28, v122, v123, v28
    v_max3_u32 v28, v124, v125, v28
    v_cmp_eq_u32 vcc, -1, v28
    s_add_u32 s100, s100, 1
    s_cmp_ge_u32 s100, 262144
    s_cbranch_scc1 Lp1_p_x
    s_cbranch_vccnz Lp1_p
Lp1_p_x:
    s_nop 1
    s_branch Lp1_ok
Lp2_r:
    s_nop 7
Lp2_p:
    global_load_dwordx4 v[126:129], v6, s[38:39] offset:-2048 sc1
    global_load_dwordx4 v[130:133], v6, s[38:39] offset:2048 sc1
    global_load_dwordx4 v[134:137], v7, s[38:39] offset:-3072 sc1
    global_load_dwordx4 v[138:141], v7, s[38:39] offset:1024 sc1
    global_load_dwordx4 v[142:145], v26, s[38:39] offset:-4096 sc1
    global_load_dwordx4 v[146:149], v26, s[38:39] offset:0 sc1
    global_load_dwordx4 v[150:153], v26, s[38:39] offset:3072 sc1
    s_waitcnt vmcnt(0)
    v_max_u32 v28, v126, v127
    v_max3_u32 v28, v128, v129, v28
    v_max3_u32 v28, v130, v131, v28
    v_max3_u32 v28, v132, v133, v28
    v_max3_u32 v28, v134, v135, v28
    v_max3_u32 v28, v136, v137, v28
    v_max3_u32 v28, v138, v139, v28
    v_max3_u32 v28, v140, v141, v28
    v_max3_u32 v28, v142, v143, v28
    v_max3_u32 v28, v144, v145, v28
    v_max3_u32 v28, v146, v147, v28
    v_max3_u32 v28, v148, v149, v28
    v_max3_u32 v28, v150, v151, v28
    v_max3_u32 v28, v152, v153, v28
    v_cmp_eq_u32 vcc, -1, v28
    s_add_u32 s100, s100, 1
    s_cmp_ge_u32 s100, 262144
    s_cbranch_scc1 Lp2_p_x
    s_cbranch_vccnz Lp2_p
Lp2_p_x:
    s_nop 1
    s_branch Lp2_ok
Lp3_r:
    s_nop 7
Lp3_p:
    global_load_dwordx4 v[158:161], v6, s[38:39] offset:-1024 sc1
    global_load_dwordx4 v[162:165], v7, s[38:39] offset:-2048 sc1
    global_load_dwordx4 v[166:169], v26, s[38:39] offset:-3072 sc1
    global_load_dwordx4 v[170:173], v27, s[38:39] offset:-4096 sc1
    s_waitcnt vmcnt(0)
    v_max_u32 v28, v158, v159
    v_max3_u32 v28, v160, v161, v28
    v_max3_u32 v28, v162, v163, v28
    v_max3_u32 v28, v164, v165, v28
    v_max3_u32 v28, v166, v167, v28
    v_max3_u32 v28, v168, v169, v28
    v_max3_u32 v28, v170, v171, v28
    v_max3_u32 v28, v172, v173, v28
    v_cmp_eq_u32 vcc, -1, v28
    s_add_u32 s100, s100, 1
    s_cmp_ge_u32 s100, 262144
    s_cbranch_scc1 Lp3_p_x
    s_cbranch_vccnz Lp3_p
Lp3_p_x:
    s_nop 1
    s_branch Lp3_ok
Lcode_end:
    s_endpgm
.section .rodata,"a"
.p2align 6
.amdhsa_kernel side_kernel
  .amdhsa_next_free_vgpr 512
  .amdhsa_next_free_sgpr 102
  .amdhsa_accum_offset 256
  .amdhsa_group_segment_fixed_size 0
  .amdhsa_kernarg_size 128
  .amdhsa_user_sgpr_count 2
  .amdhsa_user_sgpr_kernarg_segment_ptr 1
  .amdhsa_system_sgpr_workgroup_id_x 1
  .amdhsa_float_denorm_mode_32 3
.end_amdhsa_kernel
.p2align 6
.amdhsa_kernel main_kernel
  .amdhsa_next_free_vgpr 512
  .amdhsa_next_free_sgpr 102
  .amdhsa_accum_offset 256
  .amdhsa_group_segment_fixed_size 0
  .amdhsa_kernarg_size 128
  .amdhsa_user_sgpr_count 2
  .amdhsa_user_sgpr_kernarg_segment_ptr 1
  .amdhsa_system_sgpr_workgroup_id_x 1
  .amdhsa_float_denorm_mode_32 3
.end_amdhsa_kernel
```

```asm
; @launch grid=(256,1,1) block=(256,1,1) lds=163840
.amdgcn_target "amdgcn-amd-amdhsa--gfx950"
.text
.p2align 8
.globl adaLN_cond__ssm_conv_h3__mixer_gmlp__prompt_kernel
.type adaLN_cond__ssm_conv_h3__mixer_gmlp__prompt_kernel,@function
adaLN_cond__ssm_conv_h3__mixer_gmlp__prompt_kernel:
    s_cmp_ge_u32 s2, 256
    s_cbranch_scc1 Lend
    s_load_dwordx16 s[8:23], s[0:1], 0
    s_load_dwordx16 s[24:39], s[0:1], 64
    v_lshrrev_b32 v2, 6, v0
    v_and_b32 v1, 63, v0
    v_readfirstlane_b32 s3, v2
    s_getpc_b64 s[4:5]
Lpf_adaLN_cond__ssm_conv_h3__mixer_gmlp__prompt_kernel_8:
    s_add_u32 s4, s4, adaLN_cond__ssm_conv_h3__mixer_gmlp__prompt_kernel-Lpf_adaLN_cond__ssm_conv_h3__mixer_gmlp__prompt_kernel_8
    s_addc_u32 s5, s5, -1
    s_lshr_b32 s6, s2, 3
    s_and_b32 s6, s6, 31
    v_mul_u32_u24 v254, 32, v0
    v_add_lshl_u32 v254, v254, s6, 7
    v_min_u32 v254, (Lcode_end-adaLN_cond__ssm_conv_h3__mixer_gmlp__prompt_kernel-4), v254
    global_load_dword v254, v254, s[4:5]
    v_and_b32 v2, 15, v1
    v_lshrrev_b32 v3, 4, v1
    v_lshlrev_b32 v4, 4, v1
    v_lshrrev_b32 v6, 2, v2
    v_and_b32 v5, 3, v2
    v_lshl_add_u32 v5, v6, 3, v5
    s_mov_b32 s100, 0
    s_and_b32 s4, s2, 7
    s_lshr_b32 s5, s2, 3
    s_lshr_b32 s43, s5, 2
    s_lshr_b32 s6, s43, 1
    s_lshl_b32 s6, s6, 3
    s_and_b32 s7, s4, 6
    s_add_u32 s6, s6, s7
    s_and_b32 s7, s43, 1
    s_add_u32 s40, s6, s7
    s_and_b32 s6, s4, 1
    s_lshl_b32 s6, s6, 2
    s_and_b32 s7, s5, 3
    s_add_u32 s41, s6, s7
    s_mul_i32 s4, s4, 20
    s_add_u32 s42, s4, s5
    s_waitcnt lgkmcnt(0)
    s_cmp_ge_u32 s2, 160
    s_cbranch_scc0 Lconv
Lspare:
    s_sub_u32 s42, s2, 160
    s_cmp_lt_u32 s42, 54
    s_cbranch_scc0 Lsp_b
    s_and_b32 s5, s42, 0x34
    s_cbranch_scc1 Lsp_a2
    s_lshr_b32 s5, s42, 3
    s_lshl_b32 s5, s5, 2
    s_and_b32 s48, s42, 3
    s_add_u32 s48, s48, s5
    v_mov_b32 v8, -1
    v_mov_b32 v9, -1
    v_mov_b32 v10, -1
    v_mov_b32 v11, -1
    s_lshl_b32 s4, s48, 13
    s_add_u32 s4, s4, 36864
    v_lshl_add_u32 v6, v0, 4, s4
    global_store_dwordx4 v6, v[8:11], s[38:39] offset:-4096 sc1
    global_store_dwordx4 v6, v[8:11], s[38:39] offset:0 sc1
    s_lshl_b32 s4, s48, 8
    s_add_u32 s4, s4, 98304
    v_lshl_add_u32 v7, v1, 2, s4
    global_store_dword v7, v8, s[38:39] sc1
    s_lshl_b32 s4, s48, 2
    v_mov_b32 v6, s4
    s_waitcnt vmcnt(0)
    s_barrier
    s_cmp_lg_u32 s3, 0
    s_cbranch_scc1 Linit_skip
    global_store_dword v6, v8, s[36:37] sc1
Linit_skip:
    s_branch Lsp_a2
Lsp_b:
    s_sub_u32 s48, s42, 54
    s_add_u32 s49, s48, 42
    s_add_u32 s50, s48, 84
    s_cmp_ge_u32 s50, 120
    s_cselect_b32 s50, s49, s50
    s_cmp_eq_u32 s3, 1
    s_cselect_b32 s51, s49, s48
    s_cmp_eq_u32 s3, 2
    s_cselect_b32 s51, s50, s51
    s_lshr_b32 s4, s51, 1
    s_and_b32 s5, s51, 1
    s_cmp_lt_u32 s4, 50
    s_cselect_b32 s6, -20, 0
    s_cmp_lt_u32 s4, 20
    s_cselect_b32 s6, 30, s6
    s_add_u32 s4, s4, s6
    s_mul_i32 s6, s5, 15360
    s_lshl_b32 s7, s4, 8
    s_add_u32 s51, s6, s7
    v_lshl_add_u32 v164, v1, 2, s51
    v_mov_b32 v165, -1
    global_store_dword v164, v165, s[38:39] offset:0 sc1
    s_lshr_b32 s4, s48, 1
    s_and_b32 s5, s48, 1
    s_cmp_lt_u32 s4, 50
    s_cselect_b32 s6, -20, 0
    s_cmp_lt_u32 s4, 20
    s_cselect_b32 s6, 30, s6
    s_add_u32 s4, s4, s6
    s_mul_i32 s6, s5, 15360
    s_lshl_b32 s7, s4, 8
    s_add_u32 s44, s6, s7
    s_lshl_b32 s5, s5, 2
    s_add_u32 s5, s5, s3
    s_mul_i32 s5, s5, 80
    s_lshl_b32 s4, s4, 7
    s_mul_i32 s6, s5, 7680
    s_add_u32 s4, s4, s6
    v_min_u32 v28, 39, v1
    s_lshl_b32 s5, s5, 1
    v_lshl_add_u32 v28, v28, 2, s5
    global_load_dword v80, v28, s[30:31]
    v_lshrrev_b32 v29, 3, v1
    v_mul_u32_u24 v28, 15232, v29
    v_add3_u32 v28, v28, v4, s4
    global_load_dwordx4 v[40:43], v28, s[32:33] nt
    v_add_u32 v28, 7680, v28
    global_load_dwordx4 v[44:47], v28, s[32:33] nt
    v_add_u32 v28, 115200, v28
    global_load_dwordx4 v[48:51], v28, s[32:33] nt
    v_add_u32 v28, 7680, v28
    global_load_dwordx4 v[52:55], v28, s[32:33] nt
    v_add_u32 v28, 115200, v28
    global_load_dwordx4 v[56:59], v28, s[32:33] nt
    v_add_u32 v28, 7680, v28
    global_load_dwordx4 v[60:63], v28, s[32:33] nt
    v_add_u32 v28, 115200, v28
    global_load_dwordx4 v[64:67], v28, s[32:33] nt
    v_add_u32 v28, 7680, v28
    global_load_dwordx4 v[68:71], v28, s[32:33] nt
    v_add_u32 v28, 115200, v28
    global_load_dwordx4 v[72:75], v28, s[32:33] nt
    v_add_u32 v28, 7680, v28
    global_load_dwordx4 v[76:79], v28, s[32:33] nt
    s_lshl_b32 s4, s48, 2
    s_add_u32 s4, s4, 32
    v_mov_b32 v164, s4
    s_waitcnt vmcnt(10)
    s_barrier
    s_cmp_lg_u32 s3, 0
    s_cbranch_scc1 Lsb_skip
    global_store_dword v164, v165, s[36:37] sc1
Lsb_skip:
    s_lshr_b32 s4, s49, 1
    s_and_b32 s5, s49, 1
    s_cmp_lt_u32 s4, 50
    s_cselect_b32 s6, -20, 0
    s_cmp_lt_u32 s4, 20
    s_cselect_b32 s6, 30, s6
    s_add_u32 s4, s4, s6
    s_mul_i32 s6, s5, 15360
    s_lshl_b32 s7, s4, 8
    s_add_u32 s45, s6, s7
    s_lshl_b32 s5, s5, 2
    s_add_u32 s5, s5, s3
    s_mul_i32 s5, s5, 80
    s_lshl_b32 s4, s4, 7
    s_mul_i32 s6, s5, 7680
    s_add_u32 s4, s4, s6
    v_min_u32 v96, 39, v1
    s_lshl_b32 s5, s5, 1
    v_lshl_add_u32 v96, v96, 2, s5
    global_load_dword v148, v96, s[30:31]
    v_lshrrev_b32 v97, 3, v1
    v_mul_u32_u24 v96, 15232, v97
    v_add3_u32 v96, v96, v4, s4
    global_load_dwordx4 v[108:111], v96, s[32:33] nt
    v_add_u32 v96, 7680, v96
    global_load_dwordx4 v[112:115], v96, s[32:33] nt
    v_add_u32 v96, 115200, v96
    global_load_dwordx4 v[116:119], v96, s[32:33] nt
    v_add_u32 v96, 7680, v96
    global_load_dwordx4 v[120:123], v96, s[32:33] nt
    v_add_u32 v96, 115200, v96
    global_load_dwordx4 v[124:127], v96, s[32:33] nt
    v_add_u32 v96, 7680, v96
    global_load_dwordx4 v[128:131], v96, s[32:33] nt
    v_add_u32 v96, 115200, v96
    global_load_dwordx4 v[132:135], v96, s[32:33] nt
    v_add_u32 v96, 7680, v96
    global_load_dwordx4 v[136:139], v96, s[32:33] nt
    v_add_u32 v96, 115200, v96
    global_load_dwordx4 v[140:143], v96, s[32:33] nt
    v_add_u32 v96, 7680, v96
    global_load_dwordx4 v[144:147], v96, s[32:33] nt
    v_lshlrev_b32 v82, 16, v80
    v_and_b32 v83, 0xffff0000, v80
    v_lshlrev_b32 v29, 2, v29
    v_mul_f32 v84, 0xbfb8aa3b, v82
    v_mul_f32 v85, 0xbfb8aa3b, v83
    v_exp_f32 v84, v84
    v_exp_f32 v85, v85
    v_add_f32 v84, 1.0, v84
    v_add_f32 v85, 1.0, v85
    v_rcp_f32 v84, v84
    v_rcp_f32 v85, v85
    v_mul_f32 v82, v82, v84
    v_mul_f32 v83, v83, v85
    v_cvt_pk_bf16_f32 v80, v82, v83
    ds_bpermute_b32 v88, v29, v80 offset:0
    ds_bpermute_b32 v89, v29, v80 offset:32
    ds_bpermute_b32 v90, v29, v80 offset:64
    ds_bpermute_b32 v91, v29, v80 offset:96
    ds_bpermute_b32 v92, v29, v80 offset:128
    s_waitcnt lgkmcnt(4)
    v_lshlrev_b32 v30, 16, v88
    v_and_b32 v31, 0xffff0000, v88
    s_waitcnt lgkmcnt(3)
    v_lshlrev_b32 v32, 16, v89
    v_and_b32 v33, 0xffff0000, v89
    s_waitcnt lgkmcnt(2)
    v_lshlrev_b32 v34, 16, v90
    v_and_b32 v35, 0xffff0000, v90
    s_waitcnt lgkmcnt(1)
    v_lshlrev_b32 v36, 16, v91
    v_and_b32 v37, 0xffff0000, v91
    s_waitcnt lgkmcnt(0)
    v_lshlrev_b32 v38, 16, v92
    v_and_b32 v39, 0xffff0000, v92
    s_waitcnt vmcnt(20)
    v_lshlrev_b32 v80, 16, v40
    v_and_b32 v81, 0xffff0000, v40
    v_lshlrev_b32 v82, 16, v41
    v_and_b32 v83, 0xffff0000, v41
    v_lshlrev_b32 v84, 16, v42
    v_and_b32 v85, 0xffff0000, v42
    v_lshlrev_b32 v86, 16, v43
    v_and_b32 v87, 0xffff0000, v43
    v_pk_mul_f32 v[88:89], v[30:31], v[80:81] op_sel:[0,0] op_sel_hi:[0,1]
    v_pk_mul_f32 v[90:91], v[30:31], v[82:83] op_sel:[0,0] op_sel_hi:[0,1]
    v_pk_mul_f32 v[92:93], v[30:31], v[84:85] op_sel:[0,0] op_sel_hi:[0,1]
    v_pk_mul_f32 v[94:95], v[30:31], v[86:87] op_sel:[0,0] op_sel_hi:[0,1]
    s_waitcnt vmcnt(19)
    v_lshlrev_b32 v80, 16, v44
    v_and_b32 v81, 0xffff0000, v44
    v_lshlrev_b32 v82, 16, v45
    v_and_b32 v83, 0xffff0000, v45
    v_lshlrev_b32 v84, 16, v46
    v_and_b32 v85, 0xffff0000, v46
    v_lshlrev_b32 v86, 16, v47
    v_and_b32 v87, 0xffff0000, v47
    v_pk_fma_f32 v[88:89], v[30:31], v[80:81], v[88:89] op_sel:[1,0,0] op_sel_hi:[1,1,1]
    v_pk_fma_f32 v[90:91], v[30:31], v[82:83], v[90:91] op_sel:[1,0,0] op_sel_hi:[1,1,1]
    v_pk_fma_f32 v[92:93], v[30:31], v[84:85], v[92:93] op_sel:[1,0,0] op_sel_hi:[1,1,1]
    v_pk_fma_f32 v[94:95], v[30:31], v[86:87], v[94:95] op_sel:[1,0,0] op_sel_hi:[1,1,1]
    s_waitcnt vmcnt(18)
    v_lshlrev_b32 v80, 16, v48
    v_and_b32 v81, 0xffff0000, v48
    v_lshlrev_b32 v82, 16, v49
    v_and_b32 v83, 0xffff0000, v49
    v_lshlrev_b32 v84, 16, v50
    v_and_b32 v85, 0xffff0000, v50
    v_lshlrev_b32 v86, 16, v51
    v_and_b32 v87, 0xffff0000, v51
    v_pk_fma_f32 v[88:89], v[32:33], v[80:81], v[88:89] op_sel:[0,0,0] op_sel_hi:[0,1,1]
    v_pk_fma_f32 v[90:91], v[32:33], v[82:83], v[90:91] op_sel:[0,0,0] op_sel_hi:[0,1,1]
    v_pk_fma_f32 v[92:93], v[32:33], v[84:85], v[92:93] op_sel:[0,0,0] op_sel_hi:[0,1,1]
    v_pk_fma_f32 v[94:95], v[32:33], v[86:87], v[94:95] op_sel:[0,0,0] op_sel_hi:[0,1,1]
    s_waitcnt vmcnt(17)
    v_lshlrev_b32 v80, 16, v52
    v_and_b32 v81, 0xffff0000, v52
    v_lshlrev_b32 v82, 16, v53
    v_and_b32 v83, 0xffff0000, v53
    v_lshlrev_b32 v84, 16, v54
    v_and_b32 v85, 0xffff0000, v54
    v_lshlrev_b32 v86, 16, v55
    v_and_b32 v87, 0xffff0000, v55
    v_pk_fma_f32 v[88:89], v[32:33], v[80:81], v[88:89] op_sel:[1,0,0] op_sel_hi:[1,1,1]
    v_pk_fma_f32 v[90:91], v[32:33], v[82:83], v[90:91] op_sel:[1,0,0] op_sel_hi:[1,1,1]
    v_pk_fma_f32 v[92:93], v[32:33], v[84:85], v[92:93] op_sel:[1,0,0] op_sel_hi:[1,1,1]
    v_pk_fma_f32 v[94:95], v[32:33], v[86:87], v[94:95] op_sel:[1,0,0] op_sel_hi:[1,1,1]
    s_waitcnt vmcnt(16)
    v_lshlrev_b32 v80, 16, v56
    v_and_b32 v81, 0xffff0000, v56
    v_lshlrev_b32 v82, 16, v57
    v_and_b32 v83, 0xffff0000, v57
    v_lshlrev_b32 v84, 16, v58
    v_and_b32 v85, 0xffff0000, v58
    v_lshlrev_b32 v86, 16, v59
    v_and_b32 v87, 0xffff0000, v59
    v_pk_fma_f32 v[88:89], v[34:35], v[80:81], v[88:89] op_sel:[0,0,0] op_sel_hi:[0,1,1]
    v_pk_fma_f32 v[90:91], v[34:35], v[82:83], v[90:91] op_sel:[0,0,0] op_sel_hi:[0,1,1]
    v_pk_fma_f32 v[92:93], v[34:35], v[84:85], v[92:93] op_sel:[0,0,0] op_sel_hi:[0,1,1]
    v_pk_fma_f32 v[94:95], v[34:35], v[86:87], v[94:95] op_sel:[0,0,0] op_sel_hi:[0,1,1]
    s_waitcnt vmcnt(15)
    v_lshlrev_b32 v80, 16, v60
    v_and_b32 v81, 0xffff0000, v60
    v_lshlrev_b32 v82, 16, v61
    v_and_b32 v83, 0xffff0000, v61
    v_lshlrev_b32 v84, 16, v62
    v_and_b32 v85, 0xffff0000, v62
    v_lshlrev_b32 v86, 16, v63
    v_and_b32 v87, 0xffff0000, v63
    v_pk_fma_f32 v[88:89], v[34:35], v[80:81], v[88:89] op_sel:[1,0,0] op_sel_hi:[1,1,1]
    v_pk_fma_f32 v[90:91], v[34:35], v[82:83], v[90:91] op_sel:[1,0,0] op_sel_hi:[1,1,1]
    v_pk_fma_f32 v[92:93], v[34:35], v[84:85], v[92:93] op_sel:[1,0,0] op_sel_hi:[1,1,1]
    v_pk_fma_f32 v[94:95], v[34:35], v[86:87], v[94:95] op_sel:[1,0,0] op_sel_hi:[1,1,1]
    s_waitcnt vmcnt(14)
    v_lshlrev_b32 v80, 16, v64
    v_and_b32 v81, 0xffff0000, v64
    v_lshlrev_b32 v82, 16, v65
    v_and_b32 v83, 0xffff0000, v65
    v_lshlrev_b32 v84, 16, v66
    v_and_b32 v85, 0xffff0000, v66
    v_lshlrev_b32 v86, 16, v67
    v_and_b32 v87, 0xffff0000, v67
    v_pk_fma_f32 v[88:89], v[36:37], v[80:81], v[88:89] op_sel:[0,0,0] op_sel_hi:[0,1,1]
    v_pk_fma_f32 v[90:91], v[36:37], v[82:83], v[90:91] op_sel:[0,0,0] op_sel_hi:[0,1,1]
    v_pk_fma_f32 v[92:93], v[36:37], v[84:85], v[92:93] op_sel:[0,0,0] op_sel_hi:[0,1,1]
    v_pk_fma_f32 v[94:95], v[36:37], v[86:87], v[94:95] op_sel:[0,0,0] op_sel_hi:[0,1,1]
    s_waitcnt vmcnt(13)
    v_lshlrev_b32 v80, 16, v68
    v_and_b32 v81, 0xffff0000, v68
    v_lshlrev_b32 v82, 16, v69
    v_and_b32 v83, 0xffff0000, v69
    v_lshlrev_b32 v84, 16, v70
    v_and_b32 v85, 0xffff0000, v70
    v_lshlrev_b32 v86, 16, v71
    v_and_b32 v87, 0xffff0000, v71
    v_pk_fma_f32 v[88:89], v[36:37], v[80:81], v[88:89] op_sel:[1,0,0] op_sel_hi:[1,1,1]
    v_pk_fma_f32 v[90:91], v[36:37], v[82:83], v[90:91] op_sel:[1,0,0] op_sel_hi:[1,1,1]
    v_pk_fma_f32 v[92:93], v[36:37], v[84:85], v[92:93] op_sel:[1,0,0] op_sel_hi:[1,1,1]
    v_pk_fma_f32 v[94:95], v[36:37], v[86:87], v[94:95] op_sel:[1,0,0] op_sel_hi:[1,1,1]
    s_waitcnt vmcnt(12)
    v_lshlrev_b32 v80, 16, v72
    v_and_b32 v81, 0xffff0000, v72
    v_lshlrev_b32 v82, 16, v73
    v_and_b32 v83, 0xffff0000, v73
    v_lshlrev_b32 v84, 16, v74
    v_and_b32 v85, 0xffff0000, v74
    v_lshlrev_b32 v86, 16, v75
    v_and_b32 v87, 0xffff0000, v75
    v_pk_fma_f32 v[88:89], v[38:39], v[80:81], v[88:89] op_sel:[0,0,0] op_sel_hi:[0,1,1]
    v_pk_fma_f32 v[90:91], v[38:39], v[82:83], v[90:91] op_sel:[0,0,0] op_sel_hi:[0,1,1]
    v_pk_fma_f32 v[92:93], v[38:39], v[84:85], v[92:93] op_sel:[0,0,0] op_sel_hi:[0,1,1]
    v_pk_fma_f32 v[94:95], v[38:39], v[86:87], v[94:95] op_sel:[0,0,0] op_sel_hi:[0,1,1]
    s_waitcnt vmcnt(11)
    v_lshlrev_b32 v80, 16, v76
    v_and_b32 v81, 0xffff0000, v76
    v_lshlrev_b32 v82, 16, v77
    v_and_b32 v83, 0xffff0000, v77
    v_lshlrev_b32 v84, 16, v78
    v_and_b32 v85, 0xffff0000, v78
    v_lshlrev_b32 v86, 16, v79
    v_and_b32 v87, 0xffff0000, v79
    v_pk_fma_f32 v[88:89], v[38:39], v[80:81], v[88:89] op_sel:[1,0,0] op_sel_hi:[1,1,1]
    v_pk_fma_f32 v[90:91], v[38:39], v[82:83], v[90:91] op_sel:[1,0,0] op_sel_hi:[1,1,1]
    v_pk_fma_f32 v[92:93], v[38:39], v[84:85], v[92:93] op_sel:[1,0,0] op_sel_hi:[1,1,1]
    v_pk_fma_f32 v[94:95], v[38:39], v[86:87], v[94:95] op_sel:[1,0,0] op_sel_hi:[1,1,1]
    s_nop 0
    v_permlane32_swap_b32 v88, v92
    v_permlane32_swap_b32 v89, v93
    v_permlane32_swap_b32 v90, v94
    v_permlane32_swap_b32 v91, v95
    v_add_f32 v88, v88, v92
    v_add_f32 v89, v89, v93
    v_add_f32 v90, v90, v94
    v_add_f32 v91, v91, v95
    s_nop 0
    v_permlane16_swap_b32 v88, v90
    v_permlane16_swap_b32 v89, v91
    v_add_f32 v88, v88, v90
    v_add_f32 v89, v89, v91
    v_and_b32 v81, 7, v1
    v_lshrrev_b32 v82, 3, v1
    v_add_f32_dpp v80, v88, v88 row_ror:8 row_mask:0xf bank_mask:0x3
    s_nop 1
    v_add_f32_dpp v80, v89, v89 row_ror:8 row_mask:0xf bank_mask:0xc
    v_lshl_add_u32 v81, v81, 3, v82
    s_lshl_b32 s7, s3, 8
    s_add_u32 s7, s7, 122880
    v_lshl_add_u32 v81, v81, 2, s7
    ds_write_b32 v81, v80
    s_waitcnt lgkmcnt(0)
    s_barrier
    v_lshlrev_b32 v81, 2, v1
    v_add_u32 v82, 122880, v81
    ds_read_b32 v88, v82 offset:0
    ds_read_b32 v89, v82 offset:256
    ds_read_b32 v90, v82 offset:512
    ds_read_b32 v91, v82 offset:768
    v_add_u32 v81, s44, v81
    s_waitcnt lgkmcnt(2)
    v_add_f32 v88, v88, v89
    s_waitcnt lgkmcnt(0)
    v_add_f32 v90, v90, v91
    v_add_f32 v88, v88, v90
    v_min_u32 v88, -2, v88
    s_cmp_lg_u32 s3, 0
    s_cbranch_scc1 Lmod_skip_s1
    global_store_dword v81, v88, s[38:39] offset:0 sc1
Lmod_skip_s1:
    s_waitcnt vmcnt(10)
    v_lshlrev_b32 v150, 16, v148
    v_and_b32 v151, 0xffff0000, v148
    v_lshlrev_b32 v97, 2, v97
    v_mul_f32 v152, 0xbfb8aa3b, v150
    v_mul_f32 v153, 0xbfb8aa3b, v151
    v_exp_f32 v152, v152
    v_exp_f32 v153, v153
    v_add_f32 v152, 1.0, v152
    v_add_f32 v153, 1.0, v153
    v_rcp_f32 v152, v152
    v_rcp_f32 v153, v153
    v_mul_f32 v150, v150, v152
    v_mul_f32 v151, v151, v153
    v_cvt_pk_bf16_f32 v148, v150, v151
    ds_bpermute_b32 v156, v97, v148 offset:0
    ds_bpermute_b32 v157, v97, v148 offset:32
    ds_bpermute_b32 v158, v97, v148 offset:64
    ds_bpermute_b32 v159, v97, v148 offset:96
    ds_bpermute_b32 v160, v97, v148 offset:128
    s_waitcnt lgkmcnt(4)
    v_lshlrev_b32 v98, 16, v156
    v_and_b32 v99, 0xffff0000, v156
    s_waitcnt lgkmcnt(3)
    v_lshlrev_b32 v100, 16, v157
    v_and_b32 v101, 0xffff0000, v157
    s_waitcnt lgkmcnt(2)
    v_lshlrev_b32 v102, 16, v158
    v_and_b32 v103, 0xffff0000, v158
    s_waitcnt lgkmcnt(1)
    v_lshlrev_b32 v104, 16, v159
    v_and_b32 v105, 0xffff0000, v159
    s_waitcnt lgkmcnt(0)
    v_lshlrev_b32 v106, 16, v160
    v_and_b32 v107, 0xffff0000, v160
    s_waitcnt vmcnt(9)
    v_lshlrev_b32 v148, 16, v108
    v_and_b32 v149, 0xffff0000, v108
    v_lshlrev_b32 v150, 16, v109
    v_and_b32 v151, 0xffff0000, v109
    v_lshlrev_b32 v152, 16, v110
    v_and_b32 v153, 0xffff0000, v110
    v_lshlrev_b32 v154, 16, v111
    v_and_b32 v155, 0xffff0000, v111
    v_pk_mul_f32 v[156:157], v[98:99], v[148:149] op_sel:[0,0] op_sel_hi:[0,1]
    v_pk_mul_f32 v[158:159], v[98:99], v[150:151] op_sel:[0,0] op_sel_hi:[0,1]
    v_pk_mul_f32 v[160:161], v[98:99], v[152:153] op_sel:[0,0] op_sel_hi:[0,1]
    v_pk_mul_f32 v[162:163], v[98:99], v[154:155] op_sel:[0,0] op_sel_hi:[0,1]
    s_waitcnt vmcnt(8)
    v_lshlrev_b32 v148, 16, v112
    v_and_b32 v149, 0xffff0000, v112
    v_lshlrev_b32 v150, 16, v113
    v_and_b32 v151, 0xffff0000, v113
    v_lshlrev_b32 v152, 16, v114
    v_and_b32 v153, 0xffff0000, v114
    v_lshlrev_b32 v154, 16, v115
    v_and_b32 v155, 0xffff0000, v115
    v_pk_fma_f32 v[156:157], v[98:99], v[148:149], v[156:157] op_sel:[1,0,0] op_sel_hi:[1,1,1]
    v_pk_fma_f32 v[158:159], v[98:99], v[150:151], v[158:159] op_sel:[1,0,0] op_sel_hi:[1,1,1]
    v_pk_fma_f32 v[160:161], v[98:99], v[152:153], v[160:161] op_sel:[1,0,0] op_sel_hi:[1,1,1]
    v_pk_fma_f32 v[162:163], v[98:99], v[154:155], v[162:163] op_sel:[1,0,0] op_sel_hi:[1,1,1]
    s_waitcnt vmcnt(7)
    v_lshlrev_b32 v148, 16, v116
    v_and_b32 v149, 0xffff0000, v116
    v_lshlrev_b32 v150, 16, v117
    v_and_b32 v151, 0xffff0000, v117
    v_lshlrev_b32 v152, 16, v118
    v_and_b32 v153, 0xffff0000, v118
    v_lshlrev_b32 v154, 16, v119
    v_and_b32 v155, 0xffff0000, v119
    v_pk_fma_f32 v[156:157], v[100:101], v[148:149], v[156:157] op_sel:[0,0,0] op_sel_hi:[0,1,1]
    v_pk_fma_f32 v[158:159], v[100:101], v[150:151], v[158:159] op_sel:[0,0,0] op_sel_hi:[0,1,1]
    v_pk_fma_f32 v[160:161], v[100:101], v[152:153], v[160:161] op_sel:[0,0,0] op_sel_hi:[0,1,1]
    v_pk_fma_f32 v[162:163], v[100:101], v[154:155], v[162:163] op_sel:[0,0,0] op_sel_hi:[0,1,1]
    s_waitcnt vmcnt(6)
    v_lshlrev_b32 v148, 16, v120
    v_and_b32 v149, 0xffff0000, v120
    v_lshlrev_b32 v150, 16, v121
    v_and_b32 v151, 0xffff0000, v121
    v_lshlrev_b32 v152, 16, v122
    v_and_b32 v153, 0xffff0000, v122
    v_lshlrev_b32 v154, 16, v123
    v_and_b32 v155, 0xffff0000, v123
    v_pk_fma_f32 v[156:157], v[100:101], v[148:149], v[156:157] op_sel:[1,0,0] op_sel_hi:[1,1,1]
    v_pk_fma_f32 v[158:159], v[100:101], v[150:151], v[158:159] op_sel:[1,0,0] op_sel_hi:[1,1,1]
    v_pk_fma_f32 v[160:161], v[100:101], v[152:153], v[160:161] op_sel:[1,0,0] op_sel_hi:[1,1,1]
    v_pk_fma_f32 v[162:163], v[100:101], v[154:155], v[162:163] op_sel:[1,0,0] op_sel_hi:[1,1,1]
    s_waitcnt vmcnt(5)
    v_lshlrev_b32 v148, 16, v124
    v_and_b32 v149, 0xffff0000, v124
    v_lshlrev_b32 v150, 16, v125
    v_and_b32 v151, 0xffff0000, v125
    v_lshlrev_b32 v152, 16, v126
    v_and_b32 v153, 0xffff0000, v126
    v_lshlrev_b32 v154, 16, v127
    v_and_b32 v155, 0xffff0000, v127
    v_pk_fma_f32 v[156:157], v[102:103], v[148:149], v[156:157] op_sel:[0,0,0] op_sel_hi:[0,1,1]
    v_pk_fma_f32 v[158:159], v[102:103], v[150:151], v[158:159] op_sel:[0,0,0] op_sel_hi:[0,1,1]
    v_pk_fma_f32 v[160:161], v[102:103], v[152:153], v[160:161] op_sel:[0,0,0] op_sel_hi:[0,1,1]
    v_pk_fma_f32 v[162:163], v[102:103], v[154:155], v[162:163] op_sel:[0,0,0] op_sel_hi:[0,1,1]
    s_waitcnt vmcnt(4)
    v_lshlrev_b32 v148, 16, v128
    v_and_b32 v149, 0xffff0000, v128
    v_lshlrev_b32 v150, 16, v129
    v_and_b32 v151, 0xffff0000, v129
    v_lshlrev_b32 v152, 16, v130
    v_and_b32 v153, 0xffff0000, v130
    v_lshlrev_b32 v154, 16, v131
    v_and_b32 v155, 0xffff0000, v131
    v_pk_fma_f32 v[156:157], v[102:103], v[148:149], v[156:157] op_sel:[1,0,0] op_sel_hi:[1,1,1]
    v_pk_fma_f32 v[158:159], v[102:103], v[150:151], v[158:159] op_sel:[1,0,0] op_sel_hi:[1,1,1]
    v_pk_fma_f32 v[160:161], v[102:103], v[152:153], v[160:161] op_sel:[1,0,0] op_sel_hi:[1,1,1]
    v_pk_fma_f32 v[162:163], v[102:103], v[154:155], v[162:163] op_sel:[1,0,0] op_sel_hi:[1,1,1]
    s_waitcnt vmcnt(3)
    v_lshlrev_b32 v148, 16, v132
    v_and_b32 v149, 0xffff0000, v132
    v_lshlrev_b32 v150, 16, v133
    v_and_b32 v151, 0xffff0000, v133
    v_lshlrev_b32 v152, 16, v134
    v_and_b32 v153, 0xffff0000, v134
    v_lshlrev_b32 v154, 16, v135
    v_and_b32 v155, 0xffff0000, v135
    v_pk_fma_f32 v[156:157], v[104:105], v[148:149], v[156:157] op_sel:[0,0,0] op_sel_hi:[0,1,1]
    v_pk_fma_f32 v[158:159], v[104:105], v[150:151], v[158:159] op_sel:[0,0,0] op_sel_hi:[0,1,1]
    v_pk_fma_f32 v[160:161], v[104:105], v[152:153], v[160:161] op_sel:[0,0,0] op_sel_hi:[0,1,1]
    v_pk_fma_f32 v[162:163], v[104:105], v[154:155], v[162:163] op_sel:[0,0,0] op_sel_hi:[0,1,1]
    s_waitcnt vmcnt(2)
    v_lshlrev_b32 v148, 16, v136
    v_and_b32 v149, 0xffff0000, v136
    v_lshlrev_b32 v150, 16, v137
    v_and_b32 v151, 0xffff0000, v137
    v_lshlrev_b32 v152, 16, v138
    v_and_b32 v153, 0xffff0000, v138
    v_lshlrev_b32 v154, 16, v139
    v_and_b32 v155, 0xffff0000, v139
    v_pk_fma_f32 v[156:157], v[104:105], v[148:149], v[156:157] op_sel:[1,0,0] op_sel_hi:[1,1,1]
    v_pk_fma_f32 v[158:159], v[104:105], v[150:151], v[158:159] op_sel:[1,0,0] op_sel_hi:[1,1,1]
    v_pk_fma_f32 v[160:161], v[104:105], v[152:153], v[160:161] op_sel:[1,0,0] op_sel_hi:[1,1,1]
    v_pk_fma_f32 v[162:163], v[104:105], v[154:155], v[162:163] op_sel:[1,0,0] op_sel_hi:[1,1,1]
    s_waitcnt vmcnt(1)
    v_lshlrev_b32 v148, 16, v140
    v_and_b32 v149, 0xffff0000, v140
    v_lshlrev_b32 v150, 16, v141
    v_and_b32 v151, 0xffff0000, v141
    v_lshlrev_b32 v152, 16, v142
    v_and_b32 v153, 0xffff0000, v142
    v_lshlrev_b32 v154, 16, v143
    v_and_b32 v155, 0xffff0000, v143
    v_pk_fma_f32 v[156:157], v[106:107], v[148:149], v[156:157] op_sel:[0,0,0] op_sel_hi:[0,1,1]
    v_pk_fma_f32 v[158:159], v[106:107], v[150:151], v[158:159] op_sel:[0,0,0] op_sel_hi:[0,1,1]
    v_pk_fma_f32 v[160:161], v[106:107], v[152:153], v[160:161] op_sel:[0,0,0] op_sel_hi:[0,1,1]
    v_pk_fma_f32 v[162:163], v[106:107], v[154:155], v[162:163] op_sel:[0,0,0] op_sel_hi:[0,1,1]
    s_waitcnt vmcnt(0)
    v_lshlrev_b32 v148, 16, v144
    v_and_b32 v149, 0xffff0000, v144
    v_lshlrev_b32 v150, 16, v145
    v_and_b32 v151, 0xffff0000, v145
    v_lshlrev_b32 v152, 16, v146
    v_and_b32 v153, 0xffff0000, v146
    v_lshlrev_b32 v154, 16, v147
    v_and_b32 v155, 0xffff0000, v147
    v_pk_fma_f32 v[156:157], v[106:107], v[148:149], v[156:157] op_sel:[1,0,0] op_sel_hi:[1,1,1]
    v_pk_fma_f32 v[158:159], v[106:107], v[150:151], v[158:159] op_sel:[1,0,0] op_sel_hi:[1,1,1]
    v_pk_fma_f32 v[160:161], v[106:107], v[152:153], v[160:161] op_sel:[1,0,0] op_sel_hi:[1,1,1]
    v_pk_fma_f32 v[162:163], v[106:107], v[154:155], v[162:163] op_sel:[1,0,0] op_sel_hi:[1,1,1]
    s_nop 0
    v_permlane32_swap_b32 v156, v160
    v_permlane32_swap_b32 v157, v161
    v_permlane32_swap_b32 v158, v162
    v_permlane32_swap_b32 v159, v163
    v_add_f32 v156, v156, v160
    v_add_f32 v157, v157, v161
    v_add_f32 v158, v158, v162
    v_add_f32 v159, v159, v163
    s_nop 0
    v_permlane16_swap_b32 v156, v158
    v_permlane16_swap_b32 v157, v159
    v_add_f32 v156, v156, v158
    v_add_f32 v157, v157, v159
    v_and_b32 v149, 7, v1
    v_lshrrev_b32 v150, 3, v1
    v_add_f32_dpp v148, v156, v156 row_ror:8 row_mask:0xf bank_mask:0x3
    s_nop 1
    v_add_f32_dpp v148, v157, v157 row_ror:8 row_mask:0xf bank_mask:0xc
    v_lshl_add_u32 v149, v149, 3, v150
    s_lshl_b32 s7, s3, 8
    s_add_u32 s7, s7, 123904
    v_lshl_add_u32 v149, v149, 2, s7
    ds_write_b32 v149, v148
    s_waitcnt lgkmcnt(0)
    s_barrier
    v_lshlrev_b32 v149, 2, v1
    v_add_u32 v150, 123904, v149
    ds_read_b32 v156, v150 offset:0
    ds_read_b32 v157, v150 offset:256
    ds_read_b32 v158, v150 offset:512
    ds_read_b32 v159, v150 offset:768
    v_add_u32 v149, s45, v149
    s_waitcnt lgkmcnt(2)
    v_add_f32 v156, v156, v157
    s_waitcnt lgkmcnt(0)
    v_add_f32 v158, v158, v159
    v_add_f32 v156, v156, v158
    v_min_u32 v156, -2, v156
    s_cmp_lg_u32 s3, 0
    s_cbranch_scc1 Lmod_skip_s2
    global_store_dword v149, v156, s[38:39] offset:0 sc1
Lmod_skip_s2:
    v_min_u32 v164, 49, v1
    v_lshlrev_b32 v164, 2, v164
Lbic:
    global_load_dword v165, v164, s[36:37] sc1
    s_waitcnt vmcnt(0)
    v_cmp_eq_u32 vcc, 0, v165
    s_add_u32 s100, s100, 1
    s_cmp_ge_u32 s100, 262144
    s_cbranch_scc1 Lbic_x
    s_cbranch_vccnz Lbic
Lbic_x:
    s_cmp_ge_u32 s48, 27
    s_cbranch_scc1 Lsp_c
    s_mul_i32 s4, s48, 40960
    s_mul_i32 s5, s3, 10240
    s_add_u32 s4, s4, s5
    v_lshl_add_u32 v30, v1, 4, s4
    s_add_u32 m0, s5, 0
    s_nop 0
    global_load_lds_dwordx4 v30, s[28:29] offset:0 nt
    global_load_lds_dwordx4 v30, s[28:29] offset:1024 nt
    global_load_lds_dwordx4 v30, s[28:29] offset:2048 nt
    global_load_lds_dwordx4 v30, s[28:29] offset:3072 nt
    s_add_u32 m0, s5, 4096
    v_add_u32 v30, 4096, v30
    global_load_lds_dwordx4 v30, s[28:29] offset:0 nt
    global_load_lds_dwordx4 v30, s[28:29] offset:1024 nt
    global_load_lds_dwordx4 v30, s[28:29] offset:2048 nt
    global_load_lds_dwordx4 v30, s[28:29] offset:3072 nt
    s_add_u32 m0, s5, 8192
    v_add_u32 v30, 4096, v30
    global_load_lds_dwordx4 v30, s[28:29] offset:0 nt
    global_load_lds_dwordx4 v30, s[28:29] offset:1024 nt
    v_and_b32 v33, 15, v1
    v_lshrrev_b32 v34, 4, v1
    v_mul_u32_u24 v34, 10240, v34
    s_mul_i32 s5, s3, 320
    s_add_u32 s5, s5, 0
    v_add_u32 v34, s5, v34
    v_lshl_add_u32 v31, v33, 2, v34
    v_lshl_add_u32 v32, v33, 1, v34
    s_mul_i32 s5, s3, 276480
    s_mul_i32 s6, s48, 5120
    s_add_u32 s5, s5, s6
    s_add_u32 s5, s5, 10487808
    v_lshl_add_u32 v30, v1, 4, s5
    s_mov_b32 s6, 0x5040100
    s_mov_b32 s7, 0x7060302
    s_waitcnt vmcnt(0)
    s_barrier
    ds_read_b32 v36, v31 offset:0
    ds_read_b32 v37, v31 offset:2560
    ds_read_b32 v38, v31 offset:5120
    ds_read_b32 v39, v31 offset:7680
    ds_read_b32 v40, v31 offset:1280
    ds_read_b32 v41, v31 offset:3840
    ds_read_b32 v42, v31 offset:6400
    ds_read_b32 v43, v31 offset:8960
    ds_read_b32 v44, v31 offset:64
    ds_read_b32 v45, v31 offset:2624
    ds_read_b32 v46, v31 offset:5184
    ds_read_b32 v47, v31 offset:7744
    ds_read_b32 v48, v31 offset:1344
    ds_read_b32 v49, v31 offset:3904
    ds_read_b32 v50, v31 offset:6464
    ds_read_b32 v51, v31 offset:9024
    ds_read_u16 v52, v32 offset:128
    ds_read_u16 v53, v32 offset:2688
    ds_read_u16 v54, v32 offset:5248
    ds_read_u16 v55, v32 offset:7808
    ds_read_u16 v56, v32 offset:1408
    ds_read_u16 v57, v32 offset:3968
    ds_read_u16 v58, v32 offset:6528
    ds_read_u16 v59, v32 offset:9088
    s_waitcnt lgkmcnt(15)
    v_perm_b32 v60, v37, v36, s6
    v_perm_b32 v61, v39, v38, s6
    v_perm_b32 v62, v41, v40, s6
    v_perm_b32 v63, v43, v42, s6
    v_perm_b32 v64, v37, v36, s7
    v_perm_b32 v65, v39, v38, s7
    v_perm_b32 v66, v41, v40, s7
    v_perm_b32 v67, v43, v42, s7
    s_waitcnt lgkmcnt(14)
    v_perm_b32 v68, v45, v44, s6
    s_waitcnt lgkmcnt(12)
    v_perm_b32 v69, v47, v46, s6
    s_waitcnt lgkmcnt(10)
    v_perm_b32 v70, v49, v48, s6
    s_waitcnt lgkmcnt(8)
    v_perm_b32 v71, v51, v50, s6
    v_perm_b32 v72, v45, v44, s7
    v_perm_b32 v73, v47, v46, s7
    v_perm_b32 v74, v49, v48, s7
    v_perm_b32 v75, v51, v50, s7
    s_waitcnt lgkmcnt(6)
    v_perm_b32 v76, v53, v52, s6
    s_waitcnt lgkmcnt(4)
    v_perm_b32 v77, v55, v54, s6
    s_waitcnt lgkmcnt(2)
    v_perm_b32 v78, v57, v56, s6
    s_waitcnt lgkmcnt(0)
    v_perm_b32 v79, v59, v58, s6
    global_store_dwordx4 v30, v[60:63], s[38:39] offset:-2048 sc1
    global_store_dwordx4 v30, v[64:67], s[38:39] offset:-1024 sc1
    global_store_dwordx4 v30, v[68:71], s[38:39] offset:0 sc1
    global_store_dwordx4 v30, v[72:75], s[38:39] offset:1024 sc1
    global_store_dwordx4 v30, v[76:79], s[38:39] offset:2048 sc1
    v_add_u32 v30, 138240, v30
    ds_read_b32 v80, v31 offset:160
    ds_read_b32 v81, v31 offset:2720
    ds_read_b32 v82, v31 offset:5280
    ds_read_b32 v83, v31 offset:7840
    ds_read_b32 v84, v31 offset:1440
    ds_read_b32 v85, v31 offset:4000
    ds_read_b32 v86, v31 offset:6560
    ds_read_b32 v87, v31 offset:9120
    ds_read_b32 v88, v31 offset:224
    ds_read_b32 v89, v31 offset:2784
    ds_read_b32 v90, v31 offset:5344
    ds_read_b32 v91, v31 offset:7904
    ds_read_b32 v92, v31 offset:1504
    ds_read_b32 v93, v31 offset:4064
    ds_read_b32 v94, v31 offset:6624
    ds_read_b32 v95, v31 offset:9184
    ds_read_u16 v96, v32 offset:288
    ds_read_u16 v97, v32 offset:2848
    ds_read_u16 v98, v32 offset:5408
    ds_read_u16 v99, v32 offset:7968
    ds_read_u16 v100, v32 offset:1568
    ds_read_u16 v101, v32 offset:4128
    ds_read_u16 v102, v32 offset:6688
    ds_read_u16 v103, v32 offset:9248
    s_waitcnt lgkmcnt(15)
    v_perm_b32 v104, v81, v80, s6
    v_perm_b32 v105, v83, v82, s6
    v_perm_b32 v106, v85, v84, s6
    v_perm_b32 v107, v87, v86, s6
    v_perm_b32 v108, v81, v80, s7
    v_perm_b32 v109, v83, v82, s7
    v_perm_b32 v110, v85, v84, s7
    v_perm_b32 v111, v87, v86, s7
    s_waitcnt lgkmcnt(14)
    v_perm_b32 v112, v89, v88, s6
    s_waitcnt lgkmcnt(12)
    v_perm_b32 v113, v91, v90, s6
    s_waitcnt lgkmcnt(10)
    v_perm_b32 v114, v93, v92, s6
    s_waitcnt lgkmcnt(8)
    v_perm_b32 v115, v95, v94, s6
    v_perm_b32 v116, v89, v88, s7
    v_perm_b32 v117, v91, v90, s7
    v_perm_b32 v118, v93, v92, s7
    v_perm_b32 v119, v95, v94, s7
    s_waitcnt lgkmcnt(6)
    v_perm_b32 v120, v97, v96, s6
    s_waitcnt lgkmcnt(4)
    v_perm_b32 v121, v99, v98, s6
    s_waitcnt lgkmcnt(2)
    v_perm_b32 v122, v101, v100, s6
    s_waitcnt lgkmcnt(0)
    v_perm_b32 v123, v103, v102, s6
    global_store_dwordx4 v30, v[104:107], s[38:39] offset:-2048 sc1
    global_store_dwordx4 v30, v[108:111], s[38:39] offset:-1024 sc1
    global_store_dwordx4 v30, v[112:115], s[38:39] offset:0 sc1
    global_store_dwordx4 v30, v[116:119], s[38:39] offset:1024 sc1
    global_store_dwordx4 v30, v[120:123], s[38:39] offset:2048 sc1
    s_lshl_b32 s4, s48, 2
    s_add_u32 s4, s4, 98304
    v_mov_b32 v28, s4
    s_waitcnt vmcnt(0) lgkmcnt(0)
    s_barrier
    s_cmp_lg_u32 s3, 0
    s_cbranch_scc1 Lsp_c
    global_store_dword v28, v28, s[38:39] sc1
    s_branch Lsp_c
Lsp_a2:
    s_and_b32 s4, s42, 1
    s_lshl_b32 s4, s4, 1
    s_and_b32 s5, s3, 1
    s_add_u32 s44, s4, s5
    s_and_b32 s4, s42, -2
    s_lshr_b32 s5, s3, 1
    s_add_u32 s45, s4, s5
    s_and_b32 s4, s42, 1
    s_lshl_b32 s4, s4, 2
    s_add_u32 s4, s4, s3
    s_mul_i32 s4, s4, 276480
    s_lshr_b32 s5, s42, 1
    s_lshl_b32 s5, s5, 7
    s_add_u32 s4, s4, s5
    v_lshrrev_b32 v28, 3, v1
    v_mul_u32_u24 v28, 3328, v28
    v_add3_u32 v28, v28, v4, s4
    s_mul_i32 s5, s3, 10240
    s_add_u32 m0, s5, 0
    s_nop 0
    global_load_lds_dwordx4 v28, s[22:23] nt
    v_add_u32 v28, 27648, v28
    s_add_u32 m0, s5, 1024
    s_nop 0
    global_load_lds_dwordx4 v28, s[22:23] nt
    v_add_u32 v28, 27648, v28
    s_add_u32 m0, s5, 2048
    s_nop 0
    global_load_lds_dwordx4 v28, s[22:23] nt
    v_add_u32 v28, 27648, v28
    s_add_u32 m0, s5, 3072
    s_nop 0
    global_load_lds_dwordx4 v28, s[22:23] nt
    v_add_u32 v28, 27648, v28
    s_add_u32 m0, s5, 4096
    s_nop 0
    global_load_lds_dwordx4 v28, s[22:23] nt
    v_add_u32 v28, 27648, v28
    s_add_u32 m0, s5, 5120
    s_nop 0
    global_load_lds_dwordx4 v28, s[22:23] nt
    v_add_u32 v28, 27648, v28
    s_add_u32 m0, s5, 6144
    s_nop 0
    global_load_lds_dwordx4 v28, s[22:23] nt
    v_add_u32 v28, 27648, v28
    s_add_u32 m0, s5, 7168
    s_nop 0
    global_load_lds_dwordx4 v28, s[22:23] nt
    v_add_u32 v28, 27648, v28
    s_add_u32 m0, s5, 8192
    s_nop 0
    global_load_lds_dwordx4 v28, s[22:23] nt
    v_add_u32 v28, 27648, v28
    s_add_u32 m0, s5, 9216
    s_nop 0
    global_load_lds_dwordx4 v28, s[22:23] nt
    v_add_u32 v28, 27648, v28
    v_min_u32 v72, 624, v4
    s_mul_i32 s5, s44, 640
    s_add_u32 s5, s5, 7680
    v_add_u32 v73, s5, v72
    s_mul_i32 s5, s3, 1280
    s_add_u32 s5, s5, 124928
    v_add_u32 v72, s5, v72
    v_lshl_add_u32 v74, v3, 5, s5
    s_cmp_ge_u32 s45, 27
    s_cselect_b32 s6, -54, 56
    s_lshl_b32 s7, s45, 1
    s_add_u32 s46, s6, s7
    s_mul_i32 s4, s46, 20480
    s_mul_i32 s5, s44, 5120
    s_add_u32 s4, s4, s5
    s_add_u32 s4, s4, 7342080
    v_add_u32 v75, s4, v4
    v_add_u32 v76, 20480, v75
    s_and_b32 s4, s3, 1
    s_mul_i32 s4, s4, 20480
    s_lshr_b32 s5, s3, 1
    s_lshl_b32 s5, s5, 6
    s_add_u32 s4, s4, s5
    v_lshl_add_u32 v28, v3, 10, s4
    v_lshl_add_u32 v28, v2, 2, v28
    s_cmp_lt_u32 s42, 18
    s_cbranch_scc1 Lwp_n1
    s_add_u32 s48, s42, 66
    s_lshr_b32 s4, s48, 1
    s_and_b32 s5, s48, 1
    s_cmp_lt_u32 s4, 50
    s_cselect_b32 s6, -20, 0
    s_cmp_lt_u32 s4, 20
    s_cselect_b32 s6, 30, s6
    s_add_u32 s4, s4, s6
    s_mul_i32 s6, s5, 15360
    s_lshl_b32 s7, s4, 8
    s_add_u32 s47, s6, s7
    s_lshl_b32 s5, s5, 2
    s_add_u32 s5, s5, s3
    s_mul_i32 s5, s5, 80
    s_lshl_b32 s4, s4, 7
    s_mul_i32 s6, s5, 7680
    s_add_u32 s4, s4, s6
    v_min_u32 v78, 39, v1
    s_lshl_b32 s5, s5, 1
    v_lshl_add_u32 v78, v78, 2, s5
    global_load_dword v132, v78, s[30:31]
    v_lshrrev_b32 v79, 3, v1
    v_mul_u32_u24 v78, 15232, v79
    v_add3_u32 v78, v78, v4, s4
    global_load_dwordx4 v[92:95], v78, s[32:33] nt
    v_add_u32 v78, 7680, v78
    global_load_dwordx4 v[96:99], v78, s[32:33] nt
    v_add_u32 v78, 115200, v78
    global_load_dwordx4 v[100:103], v78, s[32:33] nt
    v_add_u32 v78, 7680, v78
    global_load_dwordx4 v[104:107], v78, s[32:33] nt
    v_add_u32 v78, 115200, v78
    global_load_dwordx4 v[108:111], v78, s[32:33] nt
    v_add_u32 v78, 7680, v78
    global_load_dwordx4 v[112:115], v78, s[32:33] nt
    v_add_u32 v78, 115200, v78
    global_load_dwordx4 v[116:119], v78, s[32:33] nt
    v_add_u32 v78, 7680, v78
    global_load_dwordx4 v[120:123], v78, s[32:33] nt
    v_add_u32 v78, 115200, v78
    global_load_dwordx4 v[124:127], v78, s[32:33] nt
    v_add_u32 v78, 7680, v78
    global_load_dwordx4 v[128:131], v78, s[32:33] nt
    s_waitcnt vmcnt(11)
    s_branch Lwp_n2
Lwp_n1:
    s_waitcnt vmcnt(0)
Lwp_n2:
    s_barrier
    ds_read_b32 v32, v28 offset:0
    ds_read_b32 v33, v28 offset:128
    ds_read_b32 v34, v28 offset:256
    ds_read_b32 v35, v28 offset:384
    ds_read_b32 v36, v28 offset:512
    ds_read_b32 v37, v28 offset:640
    ds_read_b32 v38, v28 offset:768
    ds_read_b32 v39, v28 offset:896
    ds_read_b32 v40, v28 offset:4096
    ds_read_b32 v41, v28 offset:4224
    ds_read_b32 v42, v28 offset:4352
    ds_read_b32 v43, v28 offset:4480
    ds_read_b32 v44, v28 offset:4608
    ds_read_b32 v45, v28 offset:4736
    ds_read_b32 v46, v28 offset:4864
    ds_read_b32 v47, v28 offset:4992
    ds_read_b32 v48, v28 offset:8192
    ds_read_b32 v49, v28 offset:8320
    ds_read_b32 v50, v28 offset:8448
    ds_read_b32 v51, v28 offset:8576
    ds_read_b32 v52, v28 offset:8704
    ds_read_b32 v53, v28 offset:8832
    ds_read_b32 v54, v28 offset:8960
    ds_read_b32 v55, v28 offset:9088
    ds_read_b32 v56, v28 offset:12288
    ds_read_b32 v57, v28 offset:12416
    ds_read_b32 v58, v28 offset:12544
    ds_read_b32 v59, v28 offset:12672
    ds_read_b32 v60, v28 offset:12800
    ds_read_b32 v61, v28 offset:12928
    ds_read_b32 v62, v28 offset:13056
    ds_read_b32 v63, v28 offset:13184
    ds_read_b32 v64, v28 offset:16384
    ds_read_b32 v65, v28 offset:16512
    ds_read_b32 v66, v28 offset:16640
    ds_read_b32 v67, v28 offset:16768
    ds_read_b32 v68, v28 offset:16896
    ds_read_b32 v69, v28 offset:17024
    ds_read_b32 v70, v28 offset:17152
    ds_read_b32 v71, v28 offset:17280
    s_waitcnt lgkmcnt(15)
    v_lshlrev_b32 v152, 16, v32
    v_and_b32 v153, 0xffff0000, v32
    v_lshlrev_b32 v154, 16, v33
    v_and_b32 v155, 0xffff0000, v33
    v_lshlrev_b32 v156, 16, v34
    v_and_b32 v157, 0xffff0000, v34
    v_lshlrev_b32 v158, 16, v35
    v_and_b32 v159, 0xffff0000, v35
    v_lshlrev_b32 v160, 16, v36
    v_and_b32 v161, 0xffff0000, v36
    v_lshlrev_b32 v162, 16, v37
    v_and_b32 v163, 0xffff0000, v37
    v_lshlrev_b32 v164, 16, v38
    v_and_b32 v165, 0xffff0000, v38
    v_lshlrev_b32 v166, 16, v39
    v_and_b32 v167, 0xffff0000, v39
    v_lshlrev_b32 v168, 16, v40
    v_and_b32 v169, 0xffff0000, v40
    v_lshlrev_b32 v170, 16, v41
    v_and_b32 v171, 0xffff0000, v41
    v_lshlrev_b32 v172, 16, v42
    v_and_b32 v173, 0xffff0000, v42
    v_lshlrev_b32 v174, 16, v43
    v_and_b32 v175, 0xffff0000, v43
    v_lshlrev_b32 v176, 16, v44
    v_and_b32 v177, 0xffff0000, v44
    v_lshlrev_b32 v178, 16, v45
    v_and_b32 v179, 0xffff0000, v45
    v_lshlrev_b32 v180, 16, v46
    v_and_b32 v181, 0xffff0000, v46
    v_lshlrev_b32 v182, 16, v47
    v_and_b32 v183, 0xffff0000, v47
    v_lshlrev_b32 v184, 16, v48
    v_and_b32 v185, 0xffff0000, v48
    v_lshlrev_b32 v186, 16, v49
    v_and_b32 v187, 0xffff0000, v49
    v_lshlrev_b32 v188, 16, v50
    v_and_b32 v189, 0xffff0000, v50
    v_lshlrev_b32 v190, 16, v51
    v_and_b32 v191, 0xffff0000, v51
    v_lshlrev_b32 v192, 16, v52
    v_and_b32 v193, 0xffff0000, v52
    v_lshlrev_b32 v194, 16, v53
    v_and_b32 v195, 0xffff0000, v53
    v_lshlrev_b32 v196, 16, v54
    v_and_b32 v197, 0xffff0000, v54
    v_lshlrev_b32 v198, 16, v55
    v_and_b32 v199, 0xffff0000, v55
    v_lshlrev_b32 v200, 16, v56
    v_and_b32 v201, 0xffff0000, v56
    s_waitcnt lgkmcnt(14)
    v_lshlrev_b32 v202, 16, v57
    v_and_b32 v203, 0xffff0000, v57
    s_waitcnt lgkmcnt(13)
    v_lshlrev_b32 v204, 16, v58
    v_and_b32 v205, 0xffff0000, v58
    s_waitcnt lgkmcnt(12)
    v_lshlrev_b32 v206, 16, v59
    v_and_b32 v207, 0xffff0000, v59
    s_waitcnt lgkmcnt(11)
    v_lshlrev_b32 v208, 16, v60
    v_and_b32 v209, 0xffff0000, v60
    s_waitcnt lgkmcnt(10)
    v_lshlrev_b32 v210, 16, v61
    v_and_b32 v211, 0xffff0000, v61
    s_waitcnt lgkmcnt(9)
    v_lshlrev_b32 v212, 16, v62
    v_and_b32 v213, 0xffff0000, v62
    s_waitcnt lgkmcnt(8)
    v_lshlrev_b32 v214, 16, v63
    v_and_b32 v215, 0xffff0000, v63
    s_waitcnt lgkmcnt(7)
    v_lshlrev_b32 v216, 16, v64
    v_and_b32 v217, 0xffff0000, v64
    s_waitcnt lgkmcnt(6)
    v_lshlrev_b32 v218, 16, v65
    v_and_b32 v219, 0xffff0000, v65
    s_waitcnt lgkmcnt(5)
    v_lshlrev_b32 v220, 16, v66
    v_and_b32 v221, 0xffff0000, v66
    s_waitcnt lgkmcnt(4)
    v_lshlrev_b32 v222, 16, v67
    v_and_b32 v223, 0xffff0000, v67
    s_waitcnt lgkmcnt(3)
    v_lshlrev_b32 v224, 16, v68
    v_and_b32 v225, 0xffff0000, v68
    s_waitcnt lgkmcnt(2)
    v_lshlrev_b32 v226, 16, v69
    v_and_b32 v227, 0xffff0000, v69
    s_waitcnt lgkmcnt(1)
    v_lshlrev_b32 v228, 16, v70
    v_and_b32 v229, 0xffff0000, v70
    s_waitcnt lgkmcnt(0)
    v_lshlrev_b32 v230, 16, v71
    v_and_b32 v231, 0xffff0000, v71
    v_min_u32 v32, 49, v1
    v_lshlrev_b32 v32, 2, v32
Lwic:
    global_load_dword v33, v32, s[36:37] sc1
    s_waitcnt vmcnt(0)
    v_cmp_eq_u32 vcc, 0, v33
    s_add_u32 s100, s100, 1
    s_cmp_ge_u32 s100, 262144
    s_cbranch_scc1 Lwic_x
    s_cbranch_vccnz Lwic
Lwic_x:
    s_cmp_lt_u32 s42, 18
    s_cbranch_scc1 Lwp_n3
    v_lshlrev_b32 v134, 16, v132
    v_and_b32 v135, 0xffff0000, v132
    v_lshlrev_b32 v79, 2, v79
    v_mul_f32 v136, 0xbfb8aa3b, v134
    v_mul_f32 v137, 0xbfb8aa3b, v135
    v_exp_f32 v136, v136
    v_exp_f32 v137, v137
    v_add_f32 v136, 1.0, v136
    v_add_f32 v137, 1.0, v137
    v_rcp_f32 v136, v136
    v_rcp_f32 v137, v137
    v_mul_f32 v134, v134, v136
    v_mul_f32 v135, v135, v137
    v_cvt_pk_bf16_f32 v132, v134, v135
    ds_bpermute_b32 v140, v79, v132 offset:0
    ds_bpermute_b32 v141, v79, v132 offset:32
    ds_bpermute_b32 v142, v79, v132 offset:64
    ds_bpermute_b32 v143, v79, v132 offset:96
    ds_bpermute_b32 v144, v79, v132 offset:128
    s_waitcnt lgkmcnt(4)
    v_lshlrev_b32 v80, 16, v140
    v_and_b32 v81, 0xffff0000, v140
    s_waitcnt lgkmcnt(3)
    v_lshlrev_b32 v82, 16, v141
    v_and_b32 v83, 0xffff0000, v141
    s_waitcnt lgkmcnt(2)
    v_lshlrev_b32 v84, 16, v142
    v_and_b32 v85, 0xffff0000, v142
    s_waitcnt lgkmcnt(1)
    v_lshlrev_b32 v86, 16, v143
    v_and_b32 v87, 0xffff0000, v143
    s_waitcnt lgkmcnt(0)
    v_lshlrev_b32 v88, 16, v144
    v_and_b32 v89, 0xffff0000, v144
    v_lshlrev_b32 v132, 16, v92
    v_and_b32 v133, 0xffff0000, v92
    v_lshlrev_b32 v134, 16, v93
    v_and_b32 v135, 0xffff0000, v93
    v_lshlrev_b32 v136, 16, v94
    v_and_b32 v137, 0xffff0000, v94
    v_lshlrev_b32 v138, 16, v95
    v_and_b32 v139, 0xffff0000, v95
    v_pk_mul_f32 v[140:141], v[80:81], v[132:133] op_sel:[0,0] op_sel_hi:[0,1]
    v_pk_mul_f32 v[142:143], v[80:81], v[134:135] op_sel:[0,0] op_sel_hi:[0,1]
    v_pk_mul_f32 v[144:145], v[80:81], v[136:137] op_sel:[0,0] op_sel_hi:[0,1]
    v_pk_mul_f32 v[146:147], v[80:81], v[138:139] op_sel:[0,0] op_sel_hi:[0,1]
    v_lshlrev_b32 v132, 16, v96
    v_and_b32 v133, 0xffff0000, v96
    v_lshlrev_b32 v134, 16, v97
    v_and_b32 v135, 0xffff0000, v97
    v_lshlrev_b32 v136, 16, v98
    v_and_b32 v137, 0xffff0000, v98
    v_lshlrev_b32 v138, 16, v99
    v_and_b32 v139, 0xffff0000, v99
    v_pk_fma_f32 v[140:141], v[80:81], v[132:133], v[140:141] op_sel:[1,0,0] op_sel_hi:[1,1,1]
    v_pk_fma_f32 v[142:143], v[80:81], v[134:135], v[142:143] op_sel:[1,0,0] op_sel_hi:[1,1,1]
    v_pk_fma_f32 v[144:145], v[80:81], v[136:137], v[144:145] op_sel:[1,0,0] op_sel_hi:[1,1,1]
    v_pk_fma_f32 v[146:147], v[80:81], v[138:139], v[146:147] op_sel:[1,0,0] op_sel_hi:[1,1,1]
    v_lshlrev_b32 v132, 16, v100
    v_and_b32 v133, 0xffff0000, v100
    v_lshlrev_b32 v134, 16, v101
    v_and_b32 v135, 0xffff0000, v101
    v_lshlrev_b32 v136, 16, v102
    v_and_b32 v137, 0xffff0000, v102
    v_lshlrev_b32 v138, 16, v103
    v_and_b32 v139, 0xffff0000, v103
    v_pk_fma_f32 v[140:141], v[82:83], v[132:133], v[140:141] op_sel:[0,0,0] op_sel_hi:[0,1,1]
    v_pk_fma_f32 v[142:143], v[82:83], v[134:135], v[142:143] op_sel:[0,0,0] op_sel_hi:[0,1,1]
    v_pk_fma_f32 v[144:145], v[82:83], v[136:137], v[144:145] op_sel:[0,0,0] op_sel_hi:[0,1,1]
    v_pk_fma_f32 v[146:147], v[82:83], v[138:139], v[146:147] op_sel:[0,0,0] op_sel_hi:[0,1,1]
    v_lshlrev_b32 v132, 16, v104
    v_and_b32 v133, 0xffff0000, v104
    v_lshlrev_b32 v134, 16, v105
    v_and_b32 v135, 0xffff0000, v105
    v_lshlrev_b32 v136, 16, v106
    v_and_b32 v137, 0xffff0000, v106
    v_lshlrev_b32 v138, 16, v107
    v_and_b32 v139, 0xffff0000, v107
    v_pk_fma_f32 v[140:141], v[82:83], v[132:133], v[140:141] op_sel:[1,0,0] op_sel_hi:[1,1,1]
    v_pk_fma_f32 v[142:143], v[82:83], v[134:135], v[142:143] op_sel:[1,0,0] op_sel_hi:[1,1,1]
    v_pk_fma_f32 v[144:145], v[82:83], v[136:137], v[144:145] op_sel:[1,0,0] op_sel_hi:[1,1,1]
    v_pk_fma_f32 v[146:147], v[82:83], v[138:139], v[146:147] op_sel:[1,0,0] op_sel_hi:[1,1,1]
    v_lshlrev_b32 v132, 16, v108
    v_and_b32 v133, 0xffff0000, v108
    v_lshlrev_b32 v134, 16, v109
    v_and_b32 v135, 0xffff0000, v109
    v_lshlrev_b32 v136, 16, v110
    v_and_b32 v137, 0xffff0000, v110
    v_lshlrev_b32 v138, 16, v111
    v_and_b32 v139, 0xffff0000, v111
    v_pk_fma_f32 v[140:141], v[84:85], v[132:133], v[140:141] op_sel:[0,0,0] op_sel_hi:[0,1,1]
    v_pk_fma_f32 v[142:143], v[84:85], v[134:135], v[142:143] op_sel:[0,0,0] op_sel_hi:[0,1,1]
    v_pk_fma_f32 v[144:145], v[84:85], v[136:137], v[144:145] op_sel:[0,0,0] op_sel_hi:[0,1,1]
    v_pk_fma_f32 v[146:147], v[84:85], v[138:139], v[146:147] op_sel:[0,0,0] op_sel_hi:[0,1,1]
    v_lshlrev_b32 v132, 16, v112
    v_and_b32 v133, 0xffff0000, v112
    v_lshlrev_b32 v134, 16, v113
    v_and_b32 v135, 0xffff0000, v113
    v_lshlrev_b32 v136, 16, v114
    v_and_b32 v137, 0xffff0000, v114
    v_lshlrev_b32 v138, 16, v115
    v_and_b32 v139, 0xffff0000, v115
    v_pk_fma_f32 v[140:141], v[84:85], v[132:133], v[140:141] op_sel:[1,0,0] op_sel_hi:[1,1,1]
    v_pk_fma_f32 v[142:143], v[84:85], v[134:135], v[142:143] op_sel:[1,0,0] op_sel_hi:[1,1,1]
    v_pk_fma_f32 v[144:145], v[84:85], v[136:137], v[144:145] op_sel:[1,0,0] op_sel_hi:[1,1,1]
    v_pk_fma_f32 v[146:147], v[84:85], v[138:139], v[146:147] op_sel:[1,0,0] op_sel_hi:[1,1,1]
    v_lshlrev_b32 v132, 16, v116
    v_and_b32 v133, 0xffff0000, v116
    v_lshlrev_b32 v134, 16, v117
    v_and_b32 v135, 0xffff0000, v117
    v_lshlrev_b32 v136, 16, v118
    v_and_b32 v137, 0xffff0000, v118
    v_lshlrev_b32 v138, 16, v119
    v_and_b32 v139, 0xffff0000, v119
    v_pk_fma_f32 v[140:141], v[86:87], v[132:133], v[140:141] op_sel:[0,0,0] op_sel_hi:[0,1,1]
    v_pk_fma_f32 v[142:143], v[86:87], v[134:135], v[142:143] op_sel:[0,0,0] op_sel_hi:[0,1,1]
    v_pk_fma_f32 v[144:145], v[86:87], v[136:137], v[144:145] op_sel:[0,0,0] op_sel_hi:[0,1,1]
    v_pk_fma_f32 v[146:147], v[86:87], v[138:139], v[146:147] op_sel:[0,0,0] op_sel_hi:[0,1,1]
    v_lshlrev_b32 v132, 16, v120
    v_and_b32 v133, 0xffff0000, v120
    v_lshlrev_b32 v134, 16, v121
    v_and_b32 v135, 0xffff0000, v121
    v_lshlrev_b32 v136, 16, v122
    v_and_b32 v137, 0xffff0000, v122
    v_lshlrev_b32 v138, 16, v123
    v_and_b32 v139, 0xffff0000, v123
    v_pk_fma_f32 v[140:141], v[86:87], v[132:133], v[140:141] op_sel:[1,0,0] op_sel_hi:[1,1,1]
    v_pk_fma_f32 v[142:143], v[86:87], v[134:135], v[142:143] op_sel:[1,0,0] op_sel_hi:[1,1,1]
    v_pk_fma_f32 v[144:145], v[86:87], v[136:137], v[144:145] op_sel:[1,0,0] op_sel_hi:[1,1,1]
    v_pk_fma_f32 v[146:147], v[86:87], v[138:139], v[146:147] op_sel:[1,0,0] op_sel_hi:[1,1,1]
    v_lshlrev_b32 v132, 16, v124
    v_and_b32 v133, 0xffff0000, v124
    v_lshlrev_b32 v134, 16, v125
    v_and_b32 v135, 0xffff0000, v125
    v_lshlrev_b32 v136, 16, v126
    v_and_b32 v137, 0xffff0000, v126
    v_lshlrev_b32 v138, 16, v127
    v_and_b32 v139, 0xffff0000, v127
    v_pk_fma_f32 v[140:141], v[88:89], v[132:133], v[140:141] op_sel:[0,0,0] op_sel_hi:[0,1,1]
    v_pk_fma_f32 v[142:143], v[88:89], v[134:135], v[142:143] op_sel:[0,0,0] op_sel_hi:[0,1,1]
    v_pk_fma_f32 v[144:145], v[88:89], v[136:137], v[144:145] op_sel:[0,0,0] op_sel_hi:[0,1,1]
    v_pk_fma_f32 v[146:147], v[88:89], v[138:139], v[146:147] op_sel:[0,0,0] op_sel_hi:[0,1,1]
    v_lshlrev_b32 v132, 16, v128
    v_and_b32 v133, 0xffff0000, v128
    v_lshlrev_b32 v134, 16, v129
    v_and_b32 v135, 0xffff0000, v129
    v_lshlrev_b32 v136, 16, v130
    v_and_b32 v137, 0xffff0000, v130
    v_lshlrev_b32 v138, 16, v131
    v_and_b32 v139, 0xffff0000, v131
    v_pk_fma_f32 v[140:141], v[88:89], v[132:133], v[140:141] op_sel:[1,0,0] op_sel_hi:[1,1,1]
    v_pk_fma_f32 v[142:143], v[88:89], v[134:135], v[142:143] op_sel:[1,0,0] op_sel_hi:[1,1,1]
    v_pk_fma_f32 v[144:145], v[88:89], v[136:137], v[144:145] op_sel:[1,0,0] op_sel_hi:[1,1,1]
    v_pk_fma_f32 v[146:147], v[88:89], v[138:139], v[146:147] op_sel:[1,0,0] op_sel_hi:[1,1,1]
    s_nop 0
    v_permlane32_swap_b32 v140, v144
    v_permlane32_swap_b32 v141, v145
    v_permlane32_swap_b32 v142, v146
    v_permlane32_swap_b32 v143, v147
    v_add_f32 v140, v140, v144
    v_add_f32 v141, v141, v145
    v_add_f32 v142, v142, v146
    v_add_f32 v143, v143, v147
    s_nop 0
    v_permlane16_swap_b32 v140, v142
    v_permlane16_swap_b32 v141, v143
    v_add_f32 v140, v140, v142
    v_add_f32 v141, v141, v143
    v_and_b32 v133, 7, v1
    v_lshrrev_b32 v134, 3, v1
    v_add_f32_dpp v132, v140, v140 row_ror:8 row_mask:0xf bank_mask:0x3
    s_nop 1
    v_add_f32_dpp v132, v141, v141 row_ror:8 row_mask:0xf bank_mask:0xc
    v_lshl_add_u32 v133, v133, 3, v134
    s_lshl_b32 s7, s3, 8
    s_add_u32 s7, s7, 122880
    v_lshl_add_u32 v133, v133, 2, s7
    ds_write_b32 v133, v132
    s_waitcnt lgkmcnt(0)
    s_barrier
    v_lshlrev_b32 v133, 2, v1
    v_add_u32 v134, 122880, v133
    ds_read_b32 v140, v134 offset:0
    ds_read_b32 v141, v134 offset:256
    ds_read_b32 v142, v134 offset:512
    ds_read_b32 v143, v134 offset:768
    v_add_u32 v133, s47, v133
    s_waitcnt lgkmcnt(2)
    v_add_f32 v140, v140, v141
    s_waitcnt lgkmcnt(0)
    v_add_f32 v142, v142, v143
    v_add_f32 v140, v140, v142
    v_min_u32 v140, -2, v140
    s_cmp_lg_u32 s3, 0
    s_cbranch_scc1 Lmod_skip_w
    global_store_dword v133, v140, s[38:39] offset:0 sc1
Lmod_skip_w:
Lwp_n3:
Lwm:
    v_add_u32 v77, 0, v73
    global_load_dwordx4 v[80:83], v77, s[38:39] sc1
    global_load_dwordx4 v[84:87], v77, s[38:39] offset:2560 sc1
    v_add_u32 v77, 15360, v73
    global_load_dwordx4 v[88:91], v77, s[38:39] sc1
    global_load_dwordx4 v[92:95], v77, s[38:39] offset:2560 sc1
    s_waitcnt vmcnt(0)
    v_max_u32 v77, v80, v81
    v_max3_u32 v77, v82, v83, v77
    v_max3_u32 v77, v84, v85, v77
    v_max3_u32 v77, v86, v87, v77
    v_max3_u32 v77, v88, v89, v77
    v_max3_u32 v77, v90, v91, v77
    v_max3_u32 v77, v92, v93, v77
    v_max3_u32 v77, v94, v95, v77
    v_cmp_eq_u32 vcc, -1, v77
    s_add_u32 s100, s100, 1
    s_cmp_ge_u32 s100, 262144
    s_cbranch_scc1 Lwm_x
    s_cbranch_vccnz Lwm
Lwm_x:
    v_pk_add_f32 v[80:81], v[80:81], v[88:89] op_sel:[0,0] op_sel_hi:[1,1]
    v_pk_add_f32 v[82:83], v[82:83], v[90:91] op_sel:[0,0] op_sel_hi:[1,1]
    v_pk_add_f32 v[84:85], v[84:85], v[92:93] op_sel:[0,0] op_sel_hi:[1,1]
    v_pk_add_f32 v[86:87], v[86:87], v[94:95] op_sel:[0,0] op_sel_hi:[1,1]
    v_cvt_pk_bf16_f32 v80, v80, v80
    v_lshlrev_b32 v80, 16, v80
    v_cvt_pk_bf16_f32 v81, v81, v81
    v_lshlrev_b32 v81, 16, v81
    v_cvt_pk_bf16_f32 v82, v82, v82
    v_lshlrev_b32 v82, 16, v82
    v_cvt_pk_bf16_f32 v83, v83, v83
    v_lshlrev_b32 v83, 16, v83
    v_cvt_pk_bf16_f32 v84, v84, v84
    v_lshlrev_b32 v84, 16, v84
    v_cvt_pk_bf16_f32 v85, v85, v85
    v_lshlrev_b32 v85, 16, v85
    v_cvt_pk_bf16_f32 v86, v86, v86
    v_lshlrev_b32 v86, 16, v86
    v_cvt_pk_bf16_f32 v87, v87, v87
    v_lshlrev_b32 v87, 16, v87
    v_add_f32 v84, 1.0, v84
    v_add_f32 v85, 1.0, v85
    v_add_f32 v86, 1.0, v86
    v_add_f32 v87, 1.0, v87
    v_cvt_pk_bf16_f32 v84, v84, v84
    v_lshlrev_b32 v84, 16, v84
    v_cvt_pk_bf16_f32 v85, v85, v85
    v_lshlrev_b32 v85, 16, v85
    v_cvt_pk_bf16_f32 v86, v86, v86
    v_lshlrev_b32 v86, 16, v86
    v_cvt_pk_bf16_f32 v87, v87, v87
    v_lshlrev_b32 v87, 16, v87
    ds_write_b128 v72, v[84:87]
    ds_write_b128 v72, v[80:83] offset:640
    ds_read_b128 v[32:35], v74 offset:0
    ds_read_b128 v[36:39], v74 offset:16
    ds_read_b128 v[40:43], v74 offset:128
    ds_read_b128 v[44:47], v74 offset:144
    ds_read_b128 v[48:51], v74 offset:256
    ds_read_b128 v[52:55], v74 offset:272
    ds_read_b128 v[56:59], v74 offset:384
    ds_read_b128 v[60:63], v74 offset:400
    ds_read_b128 v[64:67], v74 offset:512
    ds_read_b128 v[68:71], v74 offset:528
    s_waitcnt lgkmcnt(9)
    v_pk_mul_f32 v[96:97], v[32:33], v[152:153] op_sel:[0,0] op_sel_hi:[0,1]
    v_pk_mul_f32 v[98:99], v[32:33], v[154:155] op_sel:[1,0] op_sel_hi:[1,1]
    v_pk_mul_f32 v[100:101], v[34:35], v[156:157] op_sel:[0,0] op_sel_hi:[0,1]
    v_pk_mul_f32 v[102:103], v[34:35], v[158:159] op_sel:[1,0] op_sel_hi:[1,1]
    s_waitcnt lgkmcnt(8)
    v_pk_mul_f32 v[104:105], v[36:37], v[160:161] op_sel:[0,0] op_sel_hi:[0,1]
    v_pk_mul_f32 v[106:107], v[36:37], v[162:163] op_sel:[1,0] op_sel_hi:[1,1]
    v_pk_mul_f32 v[108:109], v[38:39], v[164:165] op_sel:[0,0] op_sel_hi:[0,1]
    v_pk_mul_f32 v[110:111], v[38:39], v[166:167] op_sel:[1,0] op_sel_hi:[1,1]
    v_cvt_pk_bf16_f32 v112, v96, v98
    v_cvt_pk_bf16_f32 v113, v100, v102
    v_cvt_pk_bf16_f32 v114, v104, v106
    v_cvt_pk_bf16_f32 v115, v108, v110
    v_cvt_pk_bf16_f32 v116, v97, v99
    v_cvt_pk_bf16_f32 v117, v101, v103
    v_cvt_pk_bf16_f32 v118, v105, v107
    v_cvt_pk_bf16_f32 v119, v109, v111
    global_store_dwordx4 v75, v[112:115], s[38:39] offset:-2048 sc1
    global_store_dwordx4 v76, v[116:119], s[38:39] offset:-2048 sc1
    s_waitcnt lgkmcnt(7)
    v_pk_mul_f32 v[96:97], v[40:41], v[168:169] op_sel:[0,0] op_sel_hi:[0,1]
    v_pk_mul_f32 v[98:99], v[40:41], v[170:171] op_sel:[1,0] op_sel_hi:[1,1]
    v_pk_mul_f32 v[100:101], v[42:43], v[172:173] op_sel:[0,0] op_sel_hi:[0,1]
    v_pk_mul_f32 v[102:103], v[42:43], v[174:175] op_sel:[1,0] op_sel_hi:[1,1]
    s_waitcnt lgkmcnt(6)
    v_pk_mul_f32 v[104:105], v[44:45], v[176:177] op_sel:[0,0] op_sel_hi:[0,1]
    v_pk_mul_f32 v[106:107], v[44:45], v[178:179] op_sel:[1,0] op_sel_hi:[1,1]
    v_pk_mul_f32 v[108:109], v[46:47], v[180:181] op_sel:[0,0] op_sel_hi:[0,1]
    v_pk_mul_f32 v[110:111], v[46:47], v[182:183] op_sel:[1,0] op_sel_hi:[1,1]
    v_cvt_pk_bf16_f32 v120, v96, v98
    v_cvt_pk_bf16_f32 v121, v100, v102
    v_cvt_pk_bf16_f32 v122, v104, v106
    v_cvt_pk_bf16_f32 v123, v108, v110
    v_cvt_pk_bf16_f32 v124, v97, v99
    v_cvt_pk_bf16_f32 v125, v101, v103
    v_cvt_pk_bf16_f32 v126, v105, v107
    v_cvt_pk_bf16_f32 v127, v109, v111
    global_store_dwordx4 v75, v[120:123], s[38:39] offset:-1024 sc1
    global_store_dwordx4 v76, v[124:127], s[38:39] offset:-1024 sc1
    s_waitcnt lgkmcnt(5)
    v_pk_mul_f32 v[96:97], v[48:49], v[184:185] op_sel:[0,0] op_sel_hi:[0,1]
    v_pk_mul_f32 v[98:99], v[48:49], v[186:187] op_sel:[1,0] op_sel_hi:[1,1]
    v_pk_mul_f32 v[100:101], v[50:51], v[188:189] op_sel:[0,0] op_sel_hi:[0,1]
    v_pk_mul_f32 v[102:103], v[50:51], v[190:191] op_sel:[1,0] op_sel_hi:[1,1]
    s_waitcnt lgkmcnt(4)
    v_pk_mul_f32 v[104:105], v[52:53], v[192:193] op_sel:[0,0] op_sel_hi:[0,1]
    v_pk_mul_f32 v[106:107], v[52:53], v[194:195] op_sel:[1,0] op_sel_hi:[1,1]
    v_pk_mul_f32 v[108:109], v[54:55], v[196:197] op_sel:[0,0] op_sel_hi:[0,1]
    v_pk_mul_f32 v[110:111], v[54:55], v[198:199] op_sel:[1,0] op_sel_hi:[1,1]
    v_cvt_pk_bf16_f32 v128, v96, v98
    v_cvt_pk_bf16_f32 v129, v100, v102
    v_cvt_pk_bf16_f32 v130, v104, v106
    v_cvt_pk_bf16_f32 v131, v108, v110
    v_cvt_pk_bf16_f32 v132, v97, v99
    v_cvt_pk_bf16_f32 v133, v101, v103
    v_cvt_pk_bf16_f32 v134, v105, v107
    v_cvt_pk_bf16_f32 v135, v109, v111
    global_store_dwordx4 v75, v[128:131], s[38:39] offset:0 sc1
    global_store_dwordx4 v76, v[132:135], s[38:39] offset:0 sc1
    s_waitcnt lgkmcnt(3)
    v_pk_mul_f32 v[96:97], v[56:57], v[200:201] op_sel:[0,0] op_sel_hi:[0,1]
    v_pk_mul_f32 v[98:99], v[56:57], v[202:203] op_sel:[1,0] op_sel_hi:[1,1]
    v_pk_mul_f32 v[100:101], v[58:59], v[204:205] op_sel:[0,0] op_sel_hi:[0,1]
    v_pk_mul_f32 v[102:103], v[58:59], v[206:207] op_sel:[1,0] op_sel_hi:[1,1]
    s_waitcnt lgkmcnt(2)
    v_pk_mul_f32 v[104:105], v[60:61], v[208:209] op_sel:[0,0] op_sel_hi:[0,1]
    v_pk_mul_f32 v[106:107], v[60:61], v[210:211] op_sel:[1,0] op_sel_hi:[1,1]
    v_pk_mul_f32 v[108:109], v[62:63], v[212:213] op_sel:[0,0] op_sel_hi:[0,1]
    v_pk_mul_f32 v[110:111], v[62:63], v[214:215] op_sel:[1,0] op_sel_hi:[1,1]
    v_cvt_pk_bf16_f32 v136, v96, v98
    v_cvt_pk_bf16_f32 v137, v100, v102
    v_cvt_pk_bf16_f32 v138, v104, v106
    v_cvt_pk_bf16_f32 v139, v108, v110
    v_cvt_pk_bf16_f32 v140, v97, v99
    v_cvt_pk_bf16_f32 v141, v101, v103
    v_cvt_pk_bf16_f32 v142, v105, v107
    v_cvt_pk_bf16_f32 v143, v109, v111
    global_store_dwordx4 v75, v[136:139], s[38:39] offset:1024 sc1
    global_store_dwordx4 v76, v[140:143], s[38:39] offset:1024 sc1
    s_waitcnt lgkmcnt(1)
    v_pk_mul_f32 v[96:97], v[64:65], v[216:217] op_sel:[0,0] op_sel_hi:[0,1]
    v_pk_mul_f32 v[98:99], v[64:65], v[218:219] op_sel:[1,0] op_sel_hi:[1,1]
    v_pk_mul_f32 v[100:101], v[66:67], v[220:221] op_sel:[0,0] op_sel_hi:[0,1]
    v_pk_mul_f32 v[102:103], v[66:67], v[222:223] op_sel:[1,0] op_sel_hi:[1,1]
    s_waitcnt lgkmcnt(0)
    v_pk_mul_f32 v[104:105], v[68:69], v[224:225] op_sel:[0,0] op_sel_hi:[0,1]
    v_pk_mul_f32 v[106:107], v[68:69], v[226:227] op_sel:[1,0] op_sel_hi:[1,1]
    v_pk_mul_f32 v[108:109], v[70:71], v[228:229] op_sel:[0,0] op_sel_hi:[0,1]
    v_pk_mul_f32 v[110:111], v[70:71], v[230:231] op_sel:[1,0] op_sel_hi:[1,1]
    v_cvt_pk_bf16_f32 v144, v96, v98
    v_cvt_pk_bf16_f32 v145, v100, v102
    v_cvt_pk_bf16_f32 v146, v104, v106
    v_cvt_pk_bf16_f32 v147, v108, v110
    v_cvt_pk_bf16_f32 v148, v97, v99
    v_cvt_pk_bf16_f32 v149, v101, v103
    v_cvt_pk_bf16_f32 v150, v105, v107
    v_cvt_pk_bf16_f32 v151, v109, v111
    global_store_dwordx4 v75, v[144:147], s[38:39] offset:2048 sc1
    global_store_dwordx4 v76, v[148:151], s[38:39] offset:2048 sc1
    ds_read_b128 v[32:35], v74 offset:640
    ds_read_b128 v[36:39], v74 offset:656
    ds_read_b128 v[40:43], v74 offset:768
    ds_read_b128 v[44:47], v74 offset:784
    ds_read_b128 v[48:51], v74 offset:896
    ds_read_b128 v[52:55], v74 offset:912
    ds_read_b128 v[56:59], v74 offset:1024
    ds_read_b128 v[60:63], v74 offset:1040
    ds_read_b128 v[64:67], v74 offset:1152
    ds_read_b128 v[68:71], v74 offset:1168
    s_mov_b32 s7, 0x3f803f80
    v_mov_b32 v88, 0
    v_mov_b32 v89, 0
    v_mov_b32 v90, 0
    v_mov_b32 v91, 0
    v_mov_b32 v92, 0
    v_mov_b32 v93, 0
    v_mov_b32 v94, 0
    v_mov_b32 v95, 0
    v_dot2_f32_bf16 v88, v112, s7, v88
    v_dot2_f32_bf16 v89, v116, s7, v89
    v_dot2_f32_bf16 v88, v113, s7, v88
    v_dot2_f32_bf16 v89, v117, s7, v89
    v_dot2_f32_bf16 v88, v114, s7, v88
    v_dot2_f32_bf16 v89, v118, s7, v89
    v_dot2_f32_bf16 v88, v115, s7, v88
    v_dot2_f32_bf16 v89, v119, s7, v89
    v_dot2_f32_bf16 v88, v120, s7, v88
    v_dot2_f32_bf16 v89, v124, s7, v89
    v_dot2_f32_bf16 v88, v121, s7, v88
    v_dot2_f32_bf16 v89, v125, s7, v89
    v_dot2_f32_bf16 v88, v122, s7, v88
    v_dot2_f32_bf16 v89, v126, s7, v89
    v_dot2_f32_bf16 v88, v123, s7, v88
    v_dot2_f32_bf16 v89, v127, s7, v89
    v_dot2_f32_bf16 v88, v128, s7, v88
    v_dot2_f32_bf16 v89, v132, s7, v89
    v_dot2_f32_bf16 v88, v129, s7, v88
    v_dot2_f32_bf16 v89, v133, s7, v89
    v_dot2_f32_bf16 v88, v130, s7, v88
    v_dot2_f32_bf16 v89, v134, s7, v89
    v_dot2_f32_bf16 v88, v131, s7, v88
    v_dot2_f32_bf16 v89, v135, s7, v89
    v_dot2_f32_bf16 v88, v136, s7, v88
    v_dot2_f32_bf16 v89, v140, s7, v89
    v_dot2_f32_bf16 v88, v137, s7, v88
    v_dot2_f32_bf16 v89, v141, s7, v89
    v_dot2_f32_bf16 v88, v138, s7, v88
    v_dot2_f32_bf16 v89, v142, s7, v89
    v_dot2_f32_bf16 v88, v139, s7, v88
    v_dot2_f32_bf16 v89, v143, s7, v89
    v_dot2_f32_bf16 v88, v144, s7, v88
    v_dot2_f32_bf16 v89, v148, s7, v89
    v_dot2_f32_bf16 v88, v145, s7, v88
    v_dot2_f32_bf16 v89, v149, s7, v89
    v_dot2_f32_bf16 v88, v146, s7, v88
    v_dot2_f32_bf16 v89, v150, s7, v89
    v_dot2_f32_bf16 v88, v147, s7, v88
    v_dot2_f32_bf16 v89, v151, s7, v89
    s_waitcnt lgkmcnt(9)
    v_pk_fma_f32 v[90:91], v[32:33], v[152:153], v[90:91] op_sel:[0,0,0] op_sel_hi:[0,1,1]
    v_pk_fma_f32 v[92:93], v[32:33], v[154:155], v[92:93] op_sel:[1,0,0] op_sel_hi:[1,1,1]
    v_pk_fma_f32 v[94:95], v[34:35], v[156:157], v[94:95] op_sel:[0,0,0] op_sel_hi:[0,1,1]
    v_pk_fma_f32 v[90:91], v[34:35], v[158:159], v[90:91] op_sel:[1,0,0] op_sel_hi:[1,1,1]
    s_waitcnt lgkmcnt(8)
    v_pk_fma_f32 v[92:93], v[36:37], v[160:161], v[92:93] op_sel:[0,0,0] op_sel_hi:[0,1,1]
    v_pk_fma_f32 v[94:95], v[36:37], v[162:163], v[94:95] op_sel:[1,0,0] op_sel_hi:[1,1,1]
    v_pk_fma_f32 v[90:91], v[38:39], v[164:165], v[90:91] op_sel:[0,0,0] op_sel_hi:[0,1,1]
    v_pk_fma_f32 v[92:93], v[38:39], v[166:167], v[92:93] op_sel:[1,0,0] op_sel_hi:[1,1,1]
    s_waitcnt lgkmcnt(7)
    v_pk_fma_f32 v[94:95], v[40:41], v[168:169], v[94:95] op_sel:[0,0,0] op_sel_hi:[0,1,1]
    v_pk_fma_f32 v[90:91], v[40:41], v[170:171], v[90:91] op_sel:[1,0,0] op_sel_hi:[1,1,1]
    v_pk_fma_f32 v[92:93], v[42:43], v[172:173], v[92:93] op_sel:[0,0,0] op_sel_hi:[0,1,1]
    v_pk_fma_f32 v[94:95], v[42:43], v[174:175], v[94:95] op_sel:[1,0,0] op_sel_hi:[1,1,1]
    s_waitcnt lgkmcnt(6)
    v_pk_fma_f32 v[90:91], v[44:45], v[176:177], v[90:91] op_sel:[0,0,0] op_sel_hi:[0,1,1]
    v_pk_fma_f32 v[92:93], v[44:45], v[178:179], v[92:93] op_sel:[1,0,0] op_sel_hi:[1,1,1]
    v_pk_fma_f32 v[94:95], v[46:47], v[180:181], v[94:95] op_sel:[0,0,0] op_sel_hi:[0,1,1]
    v_pk_fma_f32 v[90:91], v[46:47], v[182:183], v[90:91] op_sel:[1,0,0] op_sel_hi:[1,1,1]
    s_waitcnt lgkmcnt(5)
    v_pk_fma_f32 v[92:93], v[48:49], v[184:185], v[92:93] op_sel:[0,0,0] op_sel_hi:[0,1,1]
    v_pk_fma_f32 v[94:95], v[48:49], v[186:187], v[94:95] op_sel:[1,0,0] op_sel_hi:[1,1,1]
    v_pk_fma_f32 v[90:91], v[50:51], v[188:189], v[90:91] op_sel:[0,0,0] op_sel_hi:[0,1,1]
    v_pk_fma_f32 v[92:93], v[50:51], v[190:191], v[92:93] op_sel:[1,0,0] op_sel_hi:[1,1,1]
    s_waitcnt lgkmcnt(4)
    v_pk_fma_f32 v[94:95], v[52:53], v[192:193], v[94:95] op_sel:[0,0,0] op_sel_hi:[0,1,1]
    v_pk_fma_f32 v[90:91], v[52:53], v[194:195], v[90:91] op_sel:[1,0,0] op_sel_hi:[1,1,1]
    v_pk_fma_f32 v[92:93], v[54:55], v[196:197], v[92:93] op_sel:[0,0,0] op_sel_hi:[0,1,1]
    v_pk_fma_f32 v[94:95], v[54:55], v[198:199], v[94:95] op_sel:[1,0,0] op_sel_hi:[1,1,1]
    s_waitcnt lgkmcnt(3)
    v_pk_fma_f32 v[90:91], v[56:57], v[200:201], v[90:91] op_sel:[0,0,0] op_sel_hi:[0,1,1]
    v_pk_fma_f32 v[92:93], v[56:57], v[202:203], v[92:93] op_sel:[1,0,0] op_sel_hi:[1,1,1]
    v_pk_fma_f32 v[94:95], v[58:59], v[204:205], v[94:95] op_sel:[0,0,0] op_sel_hi:[0,1,1]
    v_pk_fma_f32 v[90:91], v[58:59], v[206:207], v[90:91] op_sel:[1,0,0] op_sel_hi:[1,1,1]
    s_waitcnt lgkmcnt(2)
    v_pk_fma_f32 v[92:93], v[60:61], v[208:209], v[92:93] op_sel:[0,0,0] op_sel_hi:[0,1,1]
    v_pk_fma_f32 v[94:95], v[60:61], v[210:211], v[94:95] op_sel:[1,0,0] op_sel_hi:[1,1,1]
    v_pk_fma_f32 v[90:91], v[62:63], v[212:213], v[90:91] op_sel:[0,0,0] op_sel_hi:[0,1,1]
    v_pk_fma_f32 v[92:93], v[62:63], v[214:215], v[92:93] op_sel:[1,0,0] op_sel_hi:[1,1,1]
    s_waitcnt lgkmcnt(1)
    v_pk_fma_f32 v[94:95], v[64:65], v[216:217], v[94:95] op_sel:[0,0,0] op_sel_hi:[0,1,1]
    v_pk_fma_f32 v[90:91], v[64:65], v[218:219], v[90:91] op_sel:[1,0,0] op_sel_hi:[1,1,1]
    v_pk_fma_f32 v[92:93], v[66:67], v[220:221], v[92:93] op_sel:[0,0,0] op_sel_hi:[0,1,1]
    v_pk_fma_f32 v[94:95], v[66:67], v[222:223], v[94:95] op_sel:[1,0,0] op_sel_hi:[1,1,1]
    s_waitcnt lgkmcnt(0)
    v_pk_fma_f32 v[90:91], v[68:69], v[224:225], v[90:91] op_sel:[0,0,0] op_sel_hi:[0,1,1]
    v_pk_fma_f32 v[92:93], v[68:69], v[226:227], v[92:93] op_sel:[1,0,0] op_sel_hi:[1,1,1]
    v_pk_fma_f32 v[94:95], v[70:71], v[228:229], v[94:95] op_sel:[0,0,0] op_sel_hi:[0,1,1]
    v_pk_fma_f32 v[90:91], v[70:71], v[230:231], v[90:91] op_sel:[1,0,0] op_sel_hi:[1,1,1]
    v_pk_add_f32 v[90:91], v[90:91], v[92:93] op_sel:[0,0] op_sel_hi:[1,1]
    v_pk_add_f32 v[90:91], v[90:91], v[94:95] op_sel:[0,0] op_sel_hi:[1,1]
    v_permlane32_swap_b32 v88, v89
    s_nop 0
    v_permlane32_swap_b32 v90, v91
    v_add_f32 v88, v88, v89
    v_add_f32 v90, v90, v91
    s_nop 1
    v_permlane16_swap_b32 v88, v90
    v_add_f32 v88, v88, v90
    v_lshlrev_b32 v74, 2, v0
    v_add_u32 v74, 131072, v74
    ds_write_b32 v74, v88
    v_xor_b32 v74, 256, v74
    s_waitcnt vmcnt(0) lgkmcnt(0)
    s_barrier
    ds_read_b32 v89, v74
    s_lshl_b32 s6, s46, 7
    s_lshr_b32 s5, s44, 1
    s_mul_i32 s5, s5, 14336
    s_add_u32 s6, s6, s5
    s_add_u32 s6, s6, 49152
    v_lshl_add_u32 v74, v1, 2, s6
    s_waitcnt lgkmcnt(0)
    v_add_f32 v88, v88, v89
    v_min_u32 v88, -2, v88
    s_bitcmp1_b32 s3, 0
    s_cbranch_scc1 Lwp_skip
    global_store_dword v74, v88, s[38:39] sc1
Lwp_skip:
Lsp_c:
    s_and_b32 s4, s41, 1
    s_lshl_b32 s5, s3, 1
    s_add_u32 s5, s5, s4
    s_cmp_eq_u32 s5, 7
    s_cselect_b32 s5, 0, s5
    s_mul_i32 s96, s41, 7
    s_add_u32 s96, s96, s5
    s_add_u32 s97, s96, 1
    s_cmp_eq_u32 s3, 3
    s_cselect_b32 s97, 55, s97
    s_cselect_b32 s5, 0, -1
    v_and_b32 v7, s5, v4
    s_mul_i32 s4, s96, 20480
    s_add_u32 s5, s4, 7344128
    s_add_u32 s8, s38, s5
    s_addc_u32 s9, s39, 0
    s_add_u32 s5, s4, 7352320
    s_add_u32 s10, s38, s5
    s_addc_u32 s11, s39, 0
    s_add_u32 s5, s4, 7360512
    s_add_u32 s12, s38, s5
    s_addc_u32 s13, s39, 0
    s_mul_i32 s4, s97, 20480
    s_add_u32 s5, s4, 7344128
    s_add_u32 s14, s38, s5
    s_addc_u32 s15, s39, 0
    s_add_u32 s5, s4, 7352320
    s_add_u32 s16, s38, s5
    s_addc_u32 s17, s39, 0
    s_add_u32 s5, s4, 7360512
    s_add_u32 s18, s38, s5
    s_addc_u32 s19, s39, 0
Lsu:
    s_lshl_b32 s4, s96, 7
    s_add_u32 s4, s4, 49152
    v_lshl_add_u32 v28, v2, 2, s4
    global_load_dword v8, v28, s[38:39] sc1
    global_load_dword v9, v28, s[38:39] offset:64 sc1
    s_add_u32 s4, s4, 7168
    v_lshl_add_u32 v28, v3, 4, s4
    global_load_dwordx4 v[12:15], v28, s[38:39] sc1
    global_load_dwordx4 v[16:19], v28, s[38:39] offset:64 sc1
    s_lshl_b32 s4, s97, 7
    s_add_u32 s4, s4, 49152
    v_lshl_add_u32 v28, v2, 2, s4
    global_load_dword v10, v28, s[38:39] sc1
    global_load_dword v11, v28, s[38:39] offset:64 sc1
    s_add_u32 s4, s4, 7168
    v_lshl_add_u32 v28, v3, 4, s4
    global_load_dwordx4 v[20:23], v28, s[38:39] sc1
    global_load_dwordx4 v[24:27], v28, s[38:39] offset:64 sc1
    s_lshl_b32 s4, s96, 7
    s_add_u32 s4, s4, 63488
    v_lshl_add_u32 v28, v2, 2, s4
    global_load_dword v40, v28, s[38:39] sc1
    global_load_dword v41, v28, s[38:39] offset:64 sc1
    s_add_u32 s4, s4, 7168
    v_lshl_add_u32 v28, v3, 4, s4
    global_load_dwordx4 v[44:47], v28, s[38:39] sc1
    global_load_dwordx4 v[48:51], v28, s[38:39] offset:64 sc1
    s_lshl_b32 s4, s97, 7
    s_add_u32 s4, s4, 63488
    v_lshl_add_u32 v28, v2, 2, s4
    global_load_dword v42, v28, s[38:39] sc1
    global_load_dword v43, v28, s[38:39] offset:64 sc1
    s_add_u32 s4, s4, 7168
    v_lshl_add_u32 v28, v3, 4, s4
    global_load_dwordx4 v[52:55], v28, s[38:39] sc1
    global_load_dwordx4 v[56:59], v28, s[38:39] offset:64 sc1
    s_waitcnt vmcnt(0)
    v_max_u32 v29, v8, v9
    v_max3_u32 v29, v10, v11, v29
    v_max3_u32 v29, v12, v13, v29
    v_max3_u32 v29, v14, v15, v29
    v_max3_u32 v29, v16, v17, v29
    v_max3_u32 v29, v18, v19, v29
    v_max3_u32 v29, v20, v21, v29
    v_max3_u32 v29, v22, v23, v29
    v_max3_u32 v29, v24, v25, v29
    v_max3_u32 v29, v26, v27, v29
    v_max3_u32 v29, v40, v41, v29
    v_max3_u32 v29, v42, v43, v29
    v_max3_u32 v29, v44, v45, v29
    v_max3_u32 v29, v46, v47, v29
    v_max3_u32 v29, v48, v49, v29
    v_max3_u32 v29, v50, v51, v29
    v_max3_u32 v29, v52, v53, v29
    v_max3_u32 v29, v54, v55, v29
    v_max3_u32 v29, v56, v57, v29
    v_max3_u32 v29, v58, v59, v29
    v_cmp_eq_u32 vcc, -1, v29
    s_add_u32 s100, s100, 1
    s_cmp_ge_u32 s100, 262144
    s_cbranch_scc1 Lsu_x
    s_cbranch_vccnz Lsu
Lsu_x:
    s_sub_u32 s5, s43, 5
    v_mad_u32_u24 v28, v1, 3, s5
    v_min_u32 v28, 159, v28
    v_lshlrev_b32 v28, 7, v28
    v_add_f32 v8, v8, v40
    v_add_f32 v9, v9, v41
    v_add_f32 v10, v10, v42
    v_add_f32 v11, v11, v43
    v_add_f32 v12, v12, v44
    v_add_f32 v13, v13, v45
    v_add_f32 v14, v14, v46
    v_add_f32 v15, v15, v47
    v_add_f32 v16, v16, v48
    v_add_f32 v17, v17, v49
    v_add_f32 v18, v18, v50
    v_add_f32 v19, v19, v51
    v_add_f32 v20, v20, v52
    v_add_f32 v21, v21, v53
    v_add_f32 v22, v22, v54
    v_add_f32 v23, v23, v55
    v_add_f32 v24, v24, v56
    v_add_f32 v25, v25, v57
    v_add_f32 v26, v26, v58
    v_add_f32 v27, v27, v59
    global_load_dwordx4 a[128:131], v4, s[8:9] offset:0 sc1
    global_load_dwordx4 a[132:135], v7, s[14:15] offset:0 sc1
    global_load_dwordx4 a[136:139], v4, s[8:9] offset:1024 sc1
    global_load_dwordx4 a[140:143], v7, s[14:15] offset:1024 sc1
    global_load_dwordx4 a[144:147], v4, s[8:9] offset:2048 sc1
    global_load_dwordx4 a[148:151], v7, s[14:15] offset:2048 sc1
    global_load_dwordx4 a[152:155], v4, s[8:9] offset:3072 sc1
    global_load_dwordx4 a[156:159], v7, s[14:15] offset:3072 sc1
    global_load_dwordx4 a[160:163], v4, s[10:11] offset:-4096 sc1
    global_load_dwordx4 a[164:167], v7, s[16:17] offset:-4096 sc1
    global_load_dwordx4 a[168:171], v4, s[10:11] offset:-3072 sc1
    global_load_dwordx4 a[172:175], v7, s[16:17] offset:-3072 sc1
    global_load_dwordx4 a[176:179], v4, s[10:11] offset:-2048 sc1
    global_load_dwordx4 a[180:183], v7, s[16:17] offset:-2048 sc1
    global_load_dwordx4 a[184:187], v4, s[10:11] offset:-1024 sc1
    global_load_dwordx4 a[188:191], v7, s[16:17] offset:-1024 sc1
    global_load_dwordx4 a[192:195], v4, s[10:11] offset:0 sc1
    global_load_dwordx4 a[196:199], v7, s[16:17] offset:0 sc1
    global_load_dwordx4 a[200:203], v4, s[10:11] offset:1024 sc1
    global_load_dwordx4 a[204:207], v7, s[16:17] offset:1024 sc1
    global_load_dwordx4 a[208:211], v4, s[10:11] offset:2048 sc1
    global_load_dwordx4 a[212:215], v7, s[16:17] offset:2048 sc1
    global_load_dwordx4 a[216:219], v4, s[10:11] offset:3072 sc1
    global_load_dwordx4 a[220:223], v7, s[16:17] offset:3072 sc1
    global_load_dwordx4 a[224:227], v4, s[12:13] offset:-4096 sc1
    global_load_dwordx4 a[228:231], v7, s[18:19] offset:-4096 sc1
    global_load_dwordx4 a[232:235], v4, s[12:13] offset:-3072 sc1
    global_load_dwordx4 a[236:239], v7, s[18:19] offset:-3072 sc1
    global_load_dwordx4 a[240:243], v4, s[12:13] offset:-2048 sc1
    global_load_dwordx4 a[244:247], v7, s[18:19] offset:-2048 sc1
    global_load_dwordx4 a[248:251], v4, s[12:13] offset:-1024 sc1
    global_load_dwordx4 a[252:255], v7, s[18:19] offset:-1024 sc1
    s_mul_i32 s4, s96, 20480
    s_add_u32 s4, s4, 8486912
    v_add_u32 v29, s4, v28
    global_load_dword v32, v29, s[38:39] sc1
    s_mul_i32 s4, s97, 20480
    s_add_u32 s4, s4, 8486912
    v_add_u32 v29, s4, v28
    global_load_dword v33, v29, s[38:39] sc1
Lss:
    v_min_u32 v28, 624, v4
    v_add_u32 v28, 98560, v28
    global_load_dwordx4 v[40:43], v28, s[38:39] sc1
    s_waitcnt vmcnt(0)
    v_max_u32 v29, v40, v41
    v_max3_u32 v29, v42, v43, v29
    v_cmp_eq_u32 vcc, -1, v29
    s_add_u32 s100, s100, 1
    s_cmp_ge_u32 s100, 262144
    s_cbranch_scc1 Lss_x
    s_cbranch_vccnz Lss
Lss_x:
    s_barrier
    s_branch Ljoin
Lconv:
    s_and_b32 s4, s42, 15
    s_lshl_b32 s4, s4, 2
    s_add_u32 s4, s4, s3
    s_mul_i32 s4, s4, 40960
    s_lshr_b32 s5, s42, 4
    s_lshl_b32 s6, s5, 7
    s_add_u32 s4, s4, s6
    v_mul_u32_u24 v38, 10240, v3
    v_lshl_add_u32 v38, v2, 3, v38
    v_add_u32 v38, s4, v38
    v_add_u32 v39, 5120, v38
    global_load_dwordx2 v[48:49], v38, s[10:11] offset:0
    global_load_dwordx2 v[50:51], v38, s[10:11] offset:1280
    global_load_dwordx2 v[52:53], v38, s[10:11] offset:2560
    global_load_dwordx2 v[54:55], v38, s[10:11] offset:3840
    global_load_dwordx2 v[56:57], v39, s[10:11] offset:0
    global_load_dwordx2 v[58:59], v39, s[10:11] offset:1280
    global_load_dwordx2 v[60:61], v39, s[10:11] offset:2560
    global_load_dwordx2 v[62:63], v39, s[10:11] offset:3840
    v_max_u32 v40, 3840, v38
    global_load_dwordx2 v[42:43], v40, s[10:11] offset:-3840
    global_load_dwordx2 v[44:45], v40, s[10:11] offset:-2560
    global_load_dwordx2 v[46:47], v40, s[10:11] offset:-1280
    s_lshl_b32 s5, s5, 9
    v_lshl_add_u32 v40, v2, 5, s5
    global_load_dwordx4 v[80:83], v40, s[14:15] offset:0
    global_load_dwordx4 v[84:87], v40, s[14:15] offset:16
    global_load_dwordx2 v[64:65], v38, s[12:13] offset:0 nt
    global_load_dwordx2 v[66:67], v38, s[12:13] offset:1280 nt
    global_load_dwordx2 v[68:69], v38, s[12:13] offset:2560 nt
    global_load_dwordx2 v[70:71], v38, s[12:13] offset:3840 nt
    global_load_dwordx2 v[72:73], v39, s[12:13] offset:0 nt
    global_load_dwordx2 v[74:75], v39, s[12:13] offset:1280 nt
    global_load_dwordx2 v[76:77], v39, s[12:13] offset:2560 nt
    global_load_dwordx2 v[78:79], v39, s[12:13] offset:3840 nt
    s_lshl_b32 s7, s42, 3
    s_load_dwordx2 s[52:53], s[18:19], s7
    v_mov_b32 v148, 0
    v_mov_b32 v149, 0
    v_mov_b32 v150, 0
    v_mov_b32 v151, 0
    s_mul_i32 s5, s3, 8448
    v_and_b32 v28, 48, v4
    v_add_u32 v28, s5, v28
    ds_write_b128 v28, v[148:151] offset:0
    ds_write_b128 v28, v[148:151] offset:4224
    v_min_u32 v28, 448, v4
    s_mul_i32 s4, s3, 9280
    v_add_u32 v28, s4, v28
    ds_write_b128 v28, v[148:151] offset:37888
    ds_write_b128 v28, v[148:151] offset:42528
    v_add_u32 v31, s5, v4
    v_and_b32 v28, 1, v2
    v_lshrrev_b32 v29, 1, v2
    v_mul_u32_u24 v30, 4224, v28
    v_lshl_add_u32 v30, v29, 3, v30
    v_lshl_add_u32 v30, v3, 4, v30
    v_add_u32 v30, s5, v30
    v_mul_u32_u24 v32, 4640, v28
    v_lshlrev_b32 v29, 6, v29
    v_sub_u32 v32, v32, v29
    v_lshl_add_u32 v32, v3, 4, v32
    s_add_u32 s4, s4, 34256
    v_add_u32 v32, s4, v32
    v_lshl_add_u32 v34, v28, 2, v29
    v_lshl_add_u32 v34, v3, 4, v34
    s_mul_i32 s4, s3, 1056
    s_add_u32 s4, s4, 83200
    v_add_u32 v34, s4, v34
    v_lshlrev_b32 v28, 2, v0
    v_sub_u32 v33, 34824, v28
    v_add_u32 v35, 83200, v28
    s_lshl_b32 s4, s42, 14
    s_add_u32 s4, s4, 1052672
    v_lshl_add_u32 v36, v0, 4, s4
    v_lshrrev_b32 v28, 5, v0
    v_mul_u32_u24 v37, 81920, v28
    v_and_b32 v28, 31, v0
    v_lshl_add_u32 v37, v28, 4, v37
    s_lshl_b32 s4, s42, 9
    s_add_u32 s4, s4, 4194304
    v_add_u32 v37, s4, v37
    s_waitcnt lgkmcnt(0)
    s_lshl_b32 s56, s52, 16
    s_lshr_b32 s60, s56, 16
    s_and_b32 s57, s52, 0xffff0000
    s_lshr_b32 s61, s57, 16
    s_lshl_b32 s58, s53, 16
    s_lshr_b32 s62, s58, 16
    s_and_b32 s59, s53, 0xffff0000
    s_lshr_b32 s63, s59, 16
    v_and_b32 v203, 7, v1
    v_lshrrev_b32 v204, 3, v1
    s_lshl_b32 s4, s42, 2
    s_add_u32 s4, s4, s3
    s_lshl_b32 s47, s4, 12
    v_add_u32 v28, s47, v4
    s_mul_i32 s5, s3, 8448
    s_add_u32 m0, s5, 4288
    s_nop 0
    global_load_lds_dwordx4 v28, s[16:17] offset:0 nt
    global_load_lds_dwordx4 v28, s[16:17] offset:1024 nt
    global_load_lds_dwordx4 v28, s[16:17] offset:2048 nt
    global_load_lds_dwordx4 v28, s[16:17] offset:3072 nt
    s_waitcnt vmcnt(24)
    v_lshlrev_b32 v116, 16, v48
    v_and_b32 v117, 0xffff0000, v48
    v_lshlrev_b32 v118, 16, v49
    v_and_b32 v119, 0xffff0000, v49
    s_waitcnt vmcnt(23)
    v_lshlrev_b32 v120, 16, v50
    v_and_b32 v121, 0xffff0000, v50
    v_lshlrev_b32 v122, 16, v51
    v_and_b32 v123, 0xffff0000, v51
    s_waitcnt vmcnt(22)
    v_lshlrev_b32 v124, 16, v52
    v_and_b32 v125, 0xffff0000, v52
    v_lshlrev_b32 v126, 16, v53
    v_and_b32 v127, 0xffff0000, v53
    s_waitcnt vmcnt(21)
    v_lshlrev_b32 v128, 16, v54
    v_and_b32 v129, 0xffff0000, v54
    v_lshlrev_b32 v130, 16, v55
    v_and_b32 v131, 0xffff0000, v55
    s_waitcnt vmcnt(20)
    v_lshlrev_b32 v132, 16, v56
    v_and_b32 v133, 0xffff0000, v56
    v_lshlrev_b32 v134, 16, v57
    v_and_b32 v135, 0xffff0000, v57
    s_waitcnt vmcnt(19)
    v_lshlrev_b32 v136, 16, v58
    v_and_b32 v137, 0xffff0000, v58
    v_lshlrev_b32 v138, 16, v59
    v_and_b32 v139, 0xffff0000, v59
    s_waitcnt vmcnt(18)
    v_lshlrev_b32 v140, 16, v60
    v_and_b32 v141, 0xffff0000, v60
    v_lshlrev_b32 v142, 16, v61
    v_and_b32 v143, 0xffff0000, v61
    s_waitcnt vmcnt(17)
    v_lshlrev_b32 v144, 16, v62
    v_and_b32 v145, 0xffff0000, v62
    v_lshlrev_b32 v146, 16, v63
    v_and_b32 v147, 0xffff0000, v63
    s_lshl_b32 s4, s42, 2
    s_add_u32 s4, s4, s3
    s_mul_i32 s4, s4, 5120
    s_cmp_lt_u32 s42, 128
    s_cselect_b32 s5, -1, 0
    v_add_u32 v201, s4, v4
    v_and_b32 v201, s5, v201
    v_add_u32 v201, 2048, v201
    global_load_dwordx4 v[180:183], v201, s[8:9] offset:-2048 nt
    global_load_dwordx4 v[184:187], v201, s[8:9] offset:-1024 nt
    global_load_dwordx4 v[188:191], v201, s[8:9] offset:0 nt
    global_load_dwordx4 v[192:195], v201, s[8:9] offset:1024 nt
    global_load_dwordx4 v[196:199], v201, s[8:9] offset:2048 nt
    v_cmp_le_u32 vcc, 1280, v38
    s_waitcnt vmcnt(21)
    s_nop 0
    v_cndmask_b32 v42, 0, v42, vcc
    v_cndmask_b32 v43, 0, v43, vcc
    s_waitcnt vmcnt(20)
    v_cndmask_b32 v44, 0, v44, vcc
    v_cndmask_b32 v45, 0, v45, vcc
    s_waitcnt vmcnt(19)
    v_cndmask_b32 v46, 0, v46, vcc
    v_cndmask_b32 v47, 0, v47, vcc
    v_lshlrev_b32 v104, 16, v42
    v_and_b32 v105, 0xffff0000, v42
    v_lshlrev_b32 v106, 16, v43
    v_and_b32 v107, 0xffff0000, v43
    v_lshlrev_b32 v108, 16, v44
    v_and_b32 v109, 0xffff0000, v44
    v_lshlrev_b32 v110, 16, v45
    v_and_b32 v111, 0xffff0000, v45
    v_lshlrev_b32 v112, 16, v46
    v_and_b32 v113, 0xffff0000, v46
    v_lshlrev_b32 v114, 16, v47
    v_and_b32 v115, 0xffff0000, v47
    s_waitcnt vmcnt(18)
    v_lshlrev_b32 v88, 16, v80
    v_and_b32 v92, 0xffff0000, v80
    v_lshlrev_b32 v96, 16, v81
    v_and_b32 v100, 0xffff0000, v81
    v_lshlrev_b32 v89, 16, v82
    v_and_b32 v93, 0xffff0000, v82
    v_lshlrev_b32 v97, 16, v83
    v_and_b32 v101, 0xffff0000, v83
    s_waitcnt vmcnt(17)
    v_lshlrev_b32 v90, 16, v84
    v_and_b32 v94, 0xffff0000, v84
    v_lshlrev_b32 v98, 16, v85
    v_and_b32 v102, 0xffff0000, v85
    v_lshlrev_b32 v91, 16, v86
    v_and_b32 v95, 0xffff0000, v86
    v_lshlrev_b32 v99, 16, v87
    v_and_b32 v103, 0xffff0000, v87
    v_pk_mul_f32 v[148:149], v[116:117], v[88:89] op_sel:[0,0] op_sel_hi:[1,1]
    v_pk_mul_f32 v[150:151], v[118:119], v[90:91] op_sel:[0,0] op_sel_hi:[1,1]
    v_pk_mul_f32 v[152:153], v[120:121], v[88:89] op_sel:[0,0] op_sel_hi:[1,1]
    v_pk_mul_f32 v[154:155], v[122:123], v[90:91] op_sel:[0,0] op_sel_hi:[1,1]
    v_pk_mul_f32 v[156:157], v[124:125], v[88:89] op_sel:[0,0] op_sel_hi:[1,1]
    v_pk_mul_f32 v[158:159], v[126:127], v[90:91] op_sel:[0,0] op_sel_hi:[1,1]
    v_pk_mul_f32 v[160:161], v[128:129], v[88:89] op_sel:[0,0] op_sel_hi:[1,1]
    v_pk_mul_f32 v[162:163], v[130:131], v[90:91] op_sel:[0,0] op_sel_hi:[1,1]
    v_pk_mul_f32 v[164:165], v[132:133], v[88:89] op_sel:[0,0] op_sel_hi:[1,1]
    v_pk_mul_f32 v[166:167], v[134:135], v[90:91] op_sel:[0,0] op_sel_hi:[1,1]
    v_pk_mul_f32 v[168:169], v[136:137], v[88:89] op_sel:[0,0] op_sel_hi:[1,1]
    v_pk_mul_f32 v[170:171], v[138:139], v[90:91] op_sel:[0,0] op_sel_hi:[1,1]
    v_pk_mul_f32 v[172:173], v[140:141], v[88:89] op_sel:[0,0] op_sel_hi:[1,1]
    v_pk_mul_f32 v[174:175], v[142:143], v[90:91] op_sel:[0,0] op_sel_hi:[1,1]
    v_pk_mul_f32 v[176:177], v[144:145], v[88:89] op_sel:[0,0] op_sel_hi:[1,1]
    v_pk_mul_f32 v[178:179], v[146:147], v[90:91] op_sel:[0,0] op_sel_hi:[1,1]
    v_pk_fma_f32 v[148:149], v[112:113], v[92:93], v[148:149] op_sel:[0,0,0] op_sel_hi:[1,1,1]
    v_pk_fma_f32 v[150:151], v[114:115], v[94:95], v[150:151] op_sel:[0,0,0] op_sel_hi:[1,1,1]
    v_pk_fma_f32 v[152:153], v[116:117], v[92:93], v[152:153] op_sel:[0,0,0] op_sel_hi:[1,1,1]
    v_pk_fma_f32 v[154:155], v[118:119], v[94:95], v[154:155] op_sel:[0,0,0] op_sel_hi:[1,1,1]
    v_pk_fma_f32 v[156:157], v[120:121], v[92:93], v[156:157] op_sel:[0,0,0] op_sel_hi:[1,1,1]
    v_pk_fma_f32 v[158:159], v[122:123], v[94:95], v[158:159] op_sel:[0,0,0] op_sel_hi:[1,1,1]
    v_pk_fma_f32 v[160:161], v[124:125], v[92:93], v[160:161] op_sel:[0,0,0] op_sel_hi:[1,1,1]
    v_pk_fma_f32 v[162:163], v[126:127], v[94:95], v[162:163] op_sel:[0,0,0] op_sel_hi:[1,1,1]
    v_pk_fma_f32 v[164:165], v[128:129], v[92:93], v[164:165] op_sel:[0,0,0] op_sel_hi:[1,1,1]
    v_pk_fma_f32 v[166:167], v[130:131], v[94:95], v[166:167] op_sel:[0,0,0] op_sel_hi:[1,1,1]
    v_pk_fma_f32 v[168:169], v[132:133], v[92:93], v[168:169] op_sel:[0,0,0] op_sel_hi:[1,1,1]
    v_pk_fma_f32 v[170:171], v[134:135], v[94:95], v[170:171] op_sel:[0,0,0] op_sel_hi:[1,1,1]
    v_pk_fma_f32 v[172:173], v[136:137], v[92:93], v[172:173] op_sel:[0,0,0] op_sel_hi:[1,1,1]
    v_pk_fma_f32 v[174:175], v[138:139], v[94:95], v[174:175] op_sel:[0,0,0] op_sel_hi:[1,1,1]
    v_pk_fma_f32 v[176:177], v[140:141], v[92:93], v[176:177] op_sel:[0,0,0] op_sel_hi:[1,1,1]
    v_pk_fma_f32 v[178:179], v[142:143], v[94:95], v[178:179] op_sel:[0,0,0] op_sel_hi:[1,1,1]
    v_pk_fma_f32 v[148:149], v[108:109], v[96:97], v[148:149] op_sel:[0,0,0] op_sel_hi:[1,1,1]
    v_pk_fma_f32 v[150:151], v[110:111], v[98:99], v[150:151] op_sel:[0,0,0] op_sel_hi:[1,1,1]
    v_pk_fma_f32 v[152:153], v[112:113], v[96:97], v[152:153] op_sel:[0,0,0] op_sel_hi:[1,1,1]
    v_pk_fma_f32 v[154:155], v[114:115], v[98:99], v[154:155] op_sel:[0,0,0] op_sel_hi:[1,1,1]
    v_pk_fma_f32 v[156:157], v[116:117], v[96:97], v[156:157] op_sel:[0,0,0] op_sel_hi:[1,1,1]
    v_pk_fma_f32 v[158:159], v[118:119], v[98:99], v[158:159] op_sel:[0,0,0] op_sel_hi:[1,1,1]
    v_pk_fma_f32 v[160:161], v[120:121], v[96:97], v[160:161] op_sel:[0,0,0] op_sel_hi:[1,1,1]
    v_pk_fma_f32 v[162:163], v[122:123], v[98:99], v[162:163] op_sel:[0,0,0] op_sel_hi:[1,1,1]
    v_pk_fma_f32 v[164:165], v[124:125], v[96:97], v[164:165] op_sel:[0,0,0] op_sel_hi:[1,1,1]
    v_pk_fma_f32 v[166:167], v[126:127], v[98:99], v[166:167] op_sel:[0,0,0] op_sel_hi:[1,1,1]
    v_pk_fma_f32 v[168:169], v[128:129], v[96:97], v[168:169] op_sel:[0,0,0] op_sel_hi:[1,1,1]
    v_pk_fma_f32 v[170:171], v[130:131], v[98:99], v[170:171] op_sel:[0,0,0] op_sel_hi:[1,1,1]
    v_pk_fma_f32 v[172:173], v[132:133], v[96:97], v[172:173] op_sel:[0,0,0] op_sel_hi:[1,1,1]
    v_pk_fma_f32 v[174:175], v[134:135], v[98:99], v[174:175] op_sel:[0,0,0] op_sel_hi:[1,1,1]
    v_pk_fma_f32 v[176:177], v[136:137], v[96:97], v[176:177] op_sel:[0,0,0] op_sel_hi:[1,1,1]
    v_pk_fma_f32 v[178:179], v[138:139], v[98:99], v[178:179] op_sel:[0,0,0] op_sel_hi:[1,1,1]
    v_pk_fma_f32 v[148:149], v[104:105], v[100:101], v[148:149] op_sel:[0,0,0] op_sel_hi:[1,1,1]
    v_pk_fma_f32 v[150:151], v[106:107], v[102:103], v[150:151] op_sel:[0,0,0] op_sel_hi:[1,1,1]
    v_pk_fma_f32 v[152:153], v[108:109], v[100:101], v[152:153] op_sel:[0,0,0] op_sel_hi:[1,1,1]
    v_pk_fma_f32 v[154:155], v[110:111], v[102:103], v[154:155] op_sel:[0,0,0] op_sel_hi:[1,1,1]
    v_pk_fma_f32 v[156:157], v[112:113], v[100:101], v[156:157] op_sel:[0,0,0] op_sel_hi:[1,1,1]
    v_pk_fma_f32 v[158:159], v[114:115], v[102:103], v[158:159] op_sel:[0,0,0] op_sel_hi:[1,1,1]
    v_pk_fma_f32 v[160:161], v[116:117], v[100:101], v[160:161] op_sel:[0,0,0] op_sel_hi:[1,1,1]
    v_pk_fma_f32 v[162:163], v[118:119], v[102:103], v[162:163] op_sel:[0,0,0] op_sel_hi:[1,1,1]
    v_pk_fma_f32 v[164:165], v[120:121], v[100:101], v[164:165] op_sel:[0,0,0] op_sel_hi:[1,1,1]
    v_pk_fma_f32 v[166:167], v[122:123], v[102:103], v[166:167] op_sel:[0,0,0] op_sel_hi:[1,1,1]
    v_pk_fma_f32 v[168:169], v[124:125], v[100:101], v[168:169] op_sel:[0,0,0] op_sel_hi:[1,1,1]
    v_pk_fma_f32 v[170:171], v[126:127], v[102:103], v[170:171] op_sel:[0,0,0] op_sel_hi:[1,1,1]
    v_pk_fma_f32 v[172:173], v[128:129], v[100:101], v[172:173] op_sel:[0,0,0] op_sel_hi:[1,1,1]
    v_pk_fma_f32 v[174:175], v[130:131], v[102:103], v[174:175] op_sel:[0,0,0] op_sel_hi:[1,1,1]
    v_pk_fma_f32 v[176:177], v[132:133], v[100:101], v[176:177] op_sel:[0,0,0] op_sel_hi:[1,1,1]
    v_pk_fma_f32 v[178:179], v[134:135], v[102:103], v[178:179] op_sel:[0,0,0] op_sel_hi:[1,1,1]
    s_lshl_b32 s4, s3, 6
    s_sub_u32 s4, 104688, s4
    v_mul_u32_u24 v40, 272, v2
    v_add_u32 v40, s4, v40
    v_lshlrev_b32 v39, 4, v3
    v_sub_u32 v40, v40, v39
    s_waitcnt vmcnt(16)
    v_lshlrev_b32 v104, 16, v64
    v_and_b32 v105, 0xffff0000, v64
    v_lshlrev_b32 v106, 16, v65
    v_and_b32 v107, 0xffff0000, v65
    v_pk_mul_f32 v[148:149], v[148:149], v[104:105] op_sel:[0,0] op_sel_hi:[1,1]
    v_pk_mul_f32 v[150:151], v[150:151], v[106:107] op_sel:[0,0] op_sel_hi:[1,1]
    s_waitcnt vmcnt(15)
    v_lshlrev_b32 v108, 16, v66
    v_and_b32 v109, 0xffff0000, v66
    v_lshlrev_b32 v110, 16, v67
    v_and_b32 v111, 0xffff0000, v67
    v_pk_mul_f32 v[152:153], v[152:153], v[108:109] op_sel:[0,0] op_sel_hi:[1,1]
    v_pk_mul_f32 v[154:155], v[154:155], v[110:111] op_sel:[0,0] op_sel_hi:[1,1]
    s_waitcnt vmcnt(14)
    v_lshlrev_b32 v112, 16, v68
    v_and_b32 v113, 0xffff0000, v68
    v_lshlrev_b32 v114, 16, v69
    v_and_b32 v115, 0xffff0000, v69
    v_pk_mul_f32 v[156:157], v[156:157], v[112:113] op_sel:[0,0] op_sel_hi:[1,1]
    v_pk_mul_f32 v[158:159], v[158:159], v[114:115] op_sel:[0,0] op_sel_hi:[1,1]
    s_waitcnt vmcnt(13)
    v_lshlrev_b32 v116, 16, v70
    v_and_b32 v117, 0xffff0000, v70
    v_lshlrev_b32 v118, 16, v71
    v_and_b32 v119, 0xffff0000, v71
    v_pk_mul_f32 v[160:161], v[160:161], v[116:117] op_sel:[0,0] op_sel_hi:[1,1]
    v_pk_mul_f32 v[162:163], v[162:163], v[118:119] op_sel:[0,0] op_sel_hi:[1,1]
    s_waitcnt vmcnt(12)
    v_lshlrev_b32 v120, 16, v72
    v_and_b32 v121, 0xffff0000, v72
    v_lshlrev_b32 v122, 16, v73
    v_and_b32 v123, 0xffff0000, v73
    v_pk_mul_f32 v[164:165], v[164:165], v[120:121] op_sel:[0,0] op_sel_hi:[1,1]
    v_pk_mul_f32 v[166:167], v[166:167], v[122:123] op_sel:[0,0] op_sel_hi:[1,1]
    s_waitcnt vmcnt(11)
    v_lshlrev_b32 v124, 16, v74
    v_and_b32 v125, 0xffff0000, v74
    v_lshlrev_b32 v126, 16, v75
    v_and_b32 v127, 0xffff0000, v75
    v_pk_mul_f32 v[168:169], v[168:169], v[124:125] op_sel:[0,0] op_sel_hi:[1,1]
    v_pk_mul_f32 v[170:171], v[170:171], v[126:127] op_sel:[0,0] op_sel_hi:[1,1]
    s_waitcnt vmcnt(10)
    v_lshlrev_b32 v128, 16, v76
    v_and_b32 v129, 0xffff0000, v76
    v_lshlrev_b32 v130, 16, v77
    v_and_b32 v131, 0xffff0000, v77
    v_pk_mul_f32 v[172:173], v[172:173], v[128:129] op_sel:[0,0] op_sel_hi:[1,1]
    v_pk_mul_f32 v[174:175], v[174:175], v[130:131] op_sel:[0,0] op_sel_hi:[1,1]
    s_waitcnt vmcnt(9)
    v_lshlrev_b32 v132, 16, v78
    v_and_b32 v133, 0xffff0000, v78
    v_lshlrev_b32 v134, 16, v79
    v_and_b32 v135, 0xffff0000, v79
    v_pk_mul_f32 v[176:177], v[176:177], v[132:133] op_sel:[0,0] op_sel_hi:[1,1]
    v_pk_mul_f32 v[178:179], v[178:179], v[134:135] op_sel:[0,0] op_sel_hi:[1,1]
    v_cvt_pk_bf16_f32 v88, v176, v172
    v_cvt_pk_bf16_f32 v89, v168, v164
    v_cvt_pk_bf16_f32 v90, v160, v156
    v_cvt_pk_bf16_f32 v91, v152, v148
    ds_write_b128 v40, v[88:91] offset:0
    v_cvt_pk_bf16_f32 v92, v177, v173
    v_cvt_pk_bf16_f32 v93, v169, v165
    v_cvt_pk_bf16_f32 v94, v161, v157
    v_cvt_pk_bf16_f32 v95, v153, v149
    ds_write_b128 v40, v[92:95] offset:4352
    v_cvt_pk_bf16_f32 v96, v178, v174
    v_cvt_pk_bf16_f32 v97, v170, v166
    v_cvt_pk_bf16_f32 v98, v162, v158
    v_cvt_pk_bf16_f32 v99, v154, v150
    ds_write_b128 v40, v[96:99] offset:8704
    v_cvt_pk_bf16_f32 v100, v179, v175
    v_cvt_pk_bf16_f32 v101, v171, v167
    v_cvt_pk_bf16_f32 v102, v163, v159
    v_cvt_pk_bf16_f32 v103, v155, v151
    ds_write_b128 v40, v[100:103] offset:13056
    s_waitcnt lgkmcnt(0)
    s_barrier
    s_mul_i32 s4, s3, 4352
    s_add_u32 s4, s4, 104448
    v_mul_u32_u24 v40, 272, v3
    v_lshl_add_u32 v40, v2, 4, v40
    v_add_u32 v40, s4, v40
    ds_read_b128 v[148:151], v40 offset:0
    ds_read_b128 v[152:155], v40 offset:1088
    ds_read_b128 v[156:159], v40 offset:2176
    ds_read_b128 v[160:163], v40 offset:3264
    s_lshr_b32 s4, s42, 4
    s_lshl_b32 s4, s4, 6
    s_add_u32 s4, s4, s3
    s_lshl_b32 s4, s4, 12
    s_and_b32 s5, s42, 15
    s_lshl_b32 s5, s5, 8
    s_sub_u32 s4, s4, s5
    s_add_u32 s4, s4, 20975360
    v_lshl_add_u32 v38, v3, 14, s4
    v_lshl_add_u32 v38, v2, 4, v38
    s_waitcnt lgkmcnt(3)
    global_store_dwordx4 v38, v[148:151], s[38:39] sc1
    v_add_u32 v38, 65536, v38
    s_waitcnt lgkmcnt(2)
    global_store_dwordx4 v38, v[152:155], s[38:39] sc1
    v_add_u32 v38, 65536, v38
    s_waitcnt lgkmcnt(1)
    global_store_dwordx4 v38, v[156:159], s[38:39] sc1
    v_add_u32 v38, 65536, v38
    s_waitcnt lgkmcnt(0)
    global_store_dwordx4 v38, v[160:163], s[38:39] sc1
    v_min_u32 v212, 7, v1
    v_lshlrev_b32 v212, 2, v212
    global_load_dword v213, v212, s[36:37] sc1
    s_waitcnt vmcnt(10)
    ds_read_b128 v[74:77], v31 offset:4288
    ds_read_b32 v73, v31 offset:4284
    ds_read_b128 v[82:85], v31 offset:5312
    ds_read_b32 v81, v31 offset:5308
    ds_read_b128 v[90:93], v31 offset:6336
    ds_read_b32 v89, v31 offset:6332
    ds_read_b128 v[98:101], v31 offset:7360
    ds_read_b32 v97, v31 offset:7356
    s_waitcnt lgkmcnt(6)
    v_alignbit_b32 v104, v74, v73, 16
    v_alignbit_b32 v105, v75, v74, 16
    v_alignbit_b32 v106, v76, v75, 16
    v_alignbit_b32 v107, v77, v76, 16
    ds_write_b128 v31, v[104:107] offset:64
    s_waitcnt lgkmcnt(5)
    v_alignbit_b32 v108, v82, v81, 16
    v_alignbit_b32 v109, v83, v82, 16
    v_alignbit_b32 v110, v84, v83, 16
    v_alignbit_b32 v111, v85, v84, 16
    ds_write_b128 v31, v[108:111] offset:1088
    s_waitcnt lgkmcnt(4)
    v_alignbit_b32 v112, v90, v89, 16
    v_alignbit_b32 v113, v91, v90, 16
    v_alignbit_b32 v114, v92, v91, 16
    v_alignbit_b32 v115, v93, v92, 16
    ds_write_b128 v31, v[112:115] offset:2112
    s_waitcnt lgkmcnt(3)
    v_alignbit_b32 v116, v98, v97, 16
    v_alignbit_b32 v117, v99, v98, 16
    v_alignbit_b32 v118, v100, v99, 16
    v_alignbit_b32 v119, v101, v100, 16
    ds_write_b128 v31, v[116:119] offset:3136
    ds_read_b64 a[0:1], v30 offset:8
    ds_read_b64 a[2:3], v30 offset:16
    ds_read_b64 a[4:5], v30 offset:72
    ds_read_b64 a[6:7], v30 offset:80
    ds_read_b64 a[8:9], v30 offset:136
    ds_read_b64 a[10:11], v30 offset:144
    ds_read_b64 a[12:13], v30 offset:200
    ds_read_b64 a[14:15], v30 offset:208
    ds_read_b64 a[16:17], v30 offset:264
    ds_read_b64 a[18:19], v30 offset:272
    ds_read_b64 a[20:21], v30 offset:328
    ds_read_b64 a[22:23], v30 offset:336
    ds_read_b64 a[24:25], v30 offset:392
    ds_read_b64 a[26:27], v30 offset:400
    ds_read_b64 a[28:29], v30 offset:456
    ds_read_b64 a[30:31], v30 offset:464
    ds_read_b64 a[32:33], v30 offset:520
    ds_read_b64 a[34:35], v30 offset:528
    ds_read_b64 a[36:37], v30 offset:584
    ds_read_b64 a[38:39], v30 offset:592
    ds_read_b64 a[40:41], v30 offset:648
    ds_read_b64 a[42:43], v30 offset:656
    ds_read_b64 a[44:45], v30 offset:712
    ds_read_b64 a[46:47], v30 offset:720
    ds_read_b64 a[48:49], v30 offset:776
    ds_read_b64 a[50:51], v30 offset:784
    ds_read_b64 a[52:53], v30 offset:840
    ds_read_b64 a[54:55], v30 offset:848
    ds_read_b64 a[56:57], v30 offset:904
    ds_read_b64 a[58:59], v30 offset:912
    ds_read_b64 a[60:61], v30 offset:968
    ds_read_b64 a[62:63], v30 offset:976
    ds_read_b64 a[64:65], v30 offset:1032
    ds_read_b64 a[66:67], v30 offset:1040
    ds_read_b64 a[68:69], v30 offset:1096
    ds_read_b64 a[70:71], v30 offset:1104
    ds_read_b64 a[72:73], v30 offset:1160
    ds_read_b64 a[74:75], v30 offset:1168
    ds_read_b64 a[76:77], v30 offset:1224
    ds_read_b64 a[78:79], v30 offset:1232
    ds_read_b64 a[80:81], v30 offset:1288
    ds_read_b64 a[82:83], v30 offset:1296
    ds_read_b64 a[84:85], v30 offset:1352
    ds_read_b64 a[86:87], v30 offset:1360
    ds_read_b64 a[88:89], v30 offset:1416
    ds_read_b64 a[90:91], v30 offset:1424
    ds_read_b64 a[92:93], v30 offset:1480
    ds_read_b64 a[94:95], v30 offset:1488
    s_mul_i32 s5, s3, 5152
    s_add_u32 s5, s5, 122880
    v_add_u32 v201, s5, v4
    v_lshrrev_b32 v202, 5, v1
    v_lshl_add_u32 v202, v202, 4, v201
    s_waitcnt vmcnt(9)
    ds_write_b128 v201, v[180:183] offset:0
    s_waitcnt vmcnt(8)
    ds_write_b128 v201, v[184:187] offset:1024
    s_waitcnt vmcnt(7)
    ds_write_b128 v202, v[188:191] offset:2048
    s_waitcnt vmcnt(6)
    ds_write_b128 v201, v[192:195] offset:3088
    s_waitcnt vmcnt(5)
    ds_write_b128 v201, v[196:199] offset:4112
    s_lshl_b32 s4, s42, 7
    s_add_u32 s4, s4, 77824
    v_mov_b32 v28, s4
    v_mov_b32 v29, 0
    s_waitcnt vmcnt(0)
    v_cmp_eq_u32 vcc, 0, v213
    s_nop 0
    s_cbranch_vccnz Lic_r
Lic_ok:
    s_waitcnt lgkmcnt(0)
    s_barrier
    s_cmp_lg_u32 s3, 0
    s_cbranch_scc1 Lkf_skip
    global_store_dword v28, v29, s[38:39] sc1
Lkf_skip:
    s_cmp_ge_u32 s42, 128
    s_cbranch_scc1 Lc_m3
    v_mul_u32_u24 v201, 2576, v203
    v_lshl_add_u32 v201, v204, 3, v201
    s_mul_i32 s5, s3, 320
    s_add_u32 s5, s5, 122880
    v_add_u32 v201, s5, v201
    ds_read2_b64 v[180:183], v201 offset0:0 offset1:160
    ds_read2_b64 v[184:187], v201 offset0:8 offset1:168
    ds_read2_b64 v[188:191], v201 offset0:16 offset1:176
    ds_read2_b64 v[192:195], v201 offset0:24 offset1:184
    ds_read2_b64 v[196:199], v201 offset0:32 offset1:192
    s_mul_i32 s5, s3, 655360
    s_lshl_b32 s6, s42, 7
    s_add_u32 s5, s5, s6
    s_add_u32 s5, s5, 1048576
    v_lshl_add_u32 v200, v204, 14, s5
    v_lshl_add_u32 v200, v203, 4, v200
    s_mov_b32 s7, 0x3f803f80
    v_mov_b32 v208, 0
    v_mov_b32 v209, 0
    v_mov_b32 v210, 0
    v_mov_b32 v211, 0
    s_waitcnt lgkmcnt(4)
    global_store_dwordx4 v200, v[180:183], s[38:39] sc1
    v_add_u32 v200, 131072, v200
    s_waitcnt lgkmcnt(3)
    global_store_dwordx4 v200, v[184:187], s[38:39] sc1
    v_add_u32 v200, 131072, v200
    s_waitcnt lgkmcnt(2)
    global_store_dwordx4 v200, v[188:191], s[38:39] sc1
    v_add_u32 v200, 131072, v200
    s_waitcnt lgkmcnt(1)
    global_store_dwordx4 v200, v[192:195], s[38:39] sc1
    v_add_u32 v200, 131072, v200
    s_waitcnt lgkmcnt(0)
    global_store_dwordx4 v200, v[196:199], s[38:39] sc1
    v_dot2_f32_bf16 v208, v180, s7, v208
    v_dot2_f32_bf16 v209, v180, v180, v209
    v_dot2_f32_bf16 v210, v182, s7, v210
    v_dot2_f32_bf16 v211, v182, v182, v211
    v_dot2_f32_bf16 v208, v181, s7, v208
    v_dot2_f32_bf16 v209, v181, v181, v209
    v_dot2_f32_bf16 v210, v183, s7, v210
    v_dot2_f32_bf16 v211, v183, v183, v211
    v_dot2_f32_bf16 v208, v184, s7, v208
    v_dot2_f32_bf16 v209, v184, v184, v209
    v_dot2_f32_bf16 v210, v186, s7, v210
    v_dot2_f32_bf16 v211, v186, v186, v211
    v_dot2_f32_bf16 v208, v185, s7, v208
    v_dot2_f32_bf16 v209, v185, v185, v209
    v_dot2_f32_bf16 v210, v187, s7, v210
    v_dot2_f32_bf16 v211, v187, v187, v211
    v_dot2_f32_bf16 v208, v188, s7, v208
    v_dot2_f32_bf16 v209, v188, v188, v209
    v_dot2_f32_bf16 v210, v190, s7, v210
    v_dot2_f32_bf16 v211, v190, v190, v211
    v_dot2_f32_bf16 v208, v189, s7, v208
    v_dot2_f32_bf16 v209, v189, v189, v209
    v_dot2_f32_bf16 v210, v191, s7, v210
    v_dot2_f32_bf16 v211, v191, v191, v211
    v_dot2_f32_bf16 v208, v192, s7, v208
    v_dot2_f32_bf16 v209, v192, v192, v209
    v_dot2_f32_bf16 v210, v194, s7, v210
    v_dot2_f32_bf16 v211, v194, v194, v211
    v_dot2_f32_bf16 v208, v193, s7, v208
    v_dot2_f32_bf16 v209, v193, v193, v209
    v_dot2_f32_bf16 v210, v195, s7, v210
    v_dot2_f32_bf16 v211, v195, v195, v211
    v_dot2_f32_bf16 v208, v196, s7, v208
    v_dot2_f32_bf16 v209, v196, v196, v209
    v_dot2_f32_bf16 v210, v198, s7, v210
    v_dot2_f32_bf16 v211, v198, v198, v211
    v_dot2_f32_bf16 v208, v197, s7, v208
    v_dot2_f32_bf16 v209, v197, v197, v209
    v_dot2_f32_bf16 v210, v199, s7, v210
    v_dot2_f32_bf16 v211, v199, v199, v211
    s_nop 1
    v_permlane32_swap_b32 v208, v210
    v_permlane32_swap_b32 v209, v211
    v_add_f32 v208, v208, v210
    v_add_f32 v209, v209, v211
    s_nop 1
    v_permlane16_swap_b32 v208, v209
    v_add_f32 v208, v208, v209
    v_lshlrev_b32 v201, 4, v203
    v_lshl_add_u32 v201, v3, 2, v201
    v_add_f32_dpp v208, v208, v208 row_ror:8 row_mask:0xf bank_mask:0xf
    s_lshl_b32 s5, s3, 7
    s_add_u32 s5, s5, 143616
    v_add_u32 v201, s5, v201
    ds_write_b32 v201, v208
Lc_j3:
    s_and_b32 s4, s42, -16
    s_lshl_b32 s4, s4, 7
    s_add_u32 s4, s4, 77824
    v_lshl_add_u32 v29, v2, 7, s4
    ds_read_b64 a[96:97], v30 offset:1544
    ds_read_b64 a[98:99], v30 offset:1552
    ds_read_b64 a[100:101], v30 offset:1608
    ds_read_b64 a[102:103], v30 offset:1616
    ds_read_b64 a[104:105], v30 offset:1672
    ds_read_b64 a[106:107], v30 offset:1680
    ds_read_b64 a[108:109], v30 offset:1736
    ds_read_b64 a[110:111], v30 offset:1744
    ds_read_b64 a[112:113], v30 offset:1800
    ds_read_b64 a[114:115], v30 offset:1808
    ds_read_b64 a[116:117], v30 offset:1864
    ds_read_b64 a[118:119], v30 offset:1872
    ds_read_b64 a[120:121], v30 offset:1928
    ds_read_b64 a[122:123], v30 offset:1936
    ds_read_b64 a[124:125], v30 offset:1992
    ds_read_b64 a[126:127], v30 offset:2000
    ds_read_b64 a[128:129], v30 offset:2056
    ds_read_b64 a[130:131], v30 offset:2064
    ds_read_b64 a[132:133], v30 offset:2120
    ds_read_b64 a[134:135], v30 offset:2128
    ds_read_b64 a[136:137], v30 offset:2184
    ds_read_b64 a[138:139], v30 offset:2192
    ds_read_b64 a[140:141], v30 offset:2248
    ds_read_b64 a[142:143], v30 offset:2256
    ds_read_b64 a[144:145], v30 offset:2312
    ds_read_b64 a[146:147], v30 offset:2320
    ds_read_b64 a[148:149], v30 offset:2376
    ds_read_b64 a[150:151], v30 offset:2384
    ds_read_b64 a[152:153], v30 offset:2440
    ds_read_b64 a[154:155], v30 offset:2448
    ds_read_b64 a[156:157], v30 offset:2504
    ds_read_b64 a[158:159], v30 offset:2512
    ds_read_b64 a[160:161], v30 offset:2568
    ds_read_b64 a[162:163], v30 offset:2576
    ds_read_b64 a[164:165], v30 offset:2632
    ds_read_b64 a[166:167], v30 offset:2640
    ds_read_b64 a[168:169], v30 offset:2696
    ds_read_b64 a[170:171], v30 offset:2704
    ds_read_b64 a[172:173], v30 offset:2760
    ds_read_b64 a[174:175], v30 offset:2768
    global_load_dword v40, v29, s[38:39] sc1
    v_min_u32 v41, 49, v1
    v_lshlrev_b32 v41, 2, v41
    global_load_dword v42, v41, s[36:37] sc1
    ds_read_b64 a[176:177], v30 offset:2824
    ds_read_b64 a[178:179], v30 offset:2832
    ds_read_b64 a[180:181], v30 offset:2888
    ds_read_b64 a[182:183], v30 offset:2896
    ds_read_b64 a[184:185], v30 offset:2952
    ds_read_b64 a[186:187], v30 offset:2960
    ds_read_b64 a[188:189], v30 offset:3016
    ds_read_b64 a[190:191], v30 offset:3024
    ds_read_b64 a[192:193], v30 offset:3080
    ds_read_b64 a[194:195], v30 offset:3088
    ds_read_b64 a[196:197], v30 offset:3144
    ds_read_b64 a[198:199], v30 offset:3152
    ds_read_b64 a[200:201], v30 offset:3208
    ds_read_b64 a[202:203], v30 offset:3216
    ds_read_b64 a[204:205], v30 offset:3272
    ds_read_b64 a[206:207], v30 offset:3280
    ds_read_b64 a[208:209], v30 offset:3336
    ds_read_b64 a[210:211], v30 offset:3344
    ds_read_b64 a[212:213], v30 offset:3400
    ds_read_b64 a[214:215], v30 offset:3408
    ds_read_b64 a[216:217], v30 offset:3464
    ds_read_b64 a[218:219], v30 offset:3472
    ds_read_b64 a[220:221], v30 offset:3528
    ds_read_b64 a[222:223], v30 offset:3536
    ds_read_b64 a[224:225], v30 offset:3592
    ds_read_b64 a[226:227], v30 offset:3600
    ds_read_b64 a[228:229], v30 offset:3656
    ds_read_b64 a[230:231], v30 offset:3664
    ds_read_b64 a[232:233], v30 offset:3720
    ds_read_b64 a[234:235], v30 offset:3728
    ds_read_b64 a[236:237], v30 offset:3784
    ds_read_b64 a[238:239], v30 offset:3792
    ds_read_b64 a[240:241], v30 offset:3848
    ds_read_b64 a[242:243], v30 offset:3856
    ds_read_b64 a[244:245], v30 offset:3912
    ds_read_b64 a[246:247], v30 offset:3920
    ds_read_b64 a[248:249], v30 offset:3976
    ds_read_b64 a[250:251], v30 offset:3984
    ds_read_b64 a[252:253], v30 offset:4040
    ds_read_b64 a[254:255], v30 offset:4048
    s_and_b32 s4, s41, 1
    s_lshl_b32 s5, s3, 1
    s_add_u32 s5, s5, s4
    s_cmp_eq_u32 s5, 7
    s_cselect_b32 s5, 0, s5
    s_mul_i32 s96, s41, 7
    s_add_u32 s96, s96, s5
    s_add_u32 s97, s96, 1
    s_cmp_eq_u32 s3, 3
    s_cselect_b32 s97, 55, s97
    s_cselect_b32 s5, 0, -1
    v_and_b32 v7, s5, v4
    s_mul_i32 s4, s96, 20480
    s_add_u32 s5, s4, 7344128
    s_add_u32 s8, s38, s5
    s_addc_u32 s9, s39, 0
    s_add_u32 s5, s4, 7352320
    s_add_u32 s10, s38, s5
    s_addc_u32 s11, s39, 0
    s_add_u32 s5, s4, 7360512
    s_add_u32 s12, s38, s5
    s_addc_u32 s13, s39, 0
    s_mul_i32 s4, s97, 20480
    s_add_u32 s5, s4, 7344128
    s_add_u32 s14, s38, s5
    s_addc_u32 s15, s39, 0
    s_add_u32 s5, s4, 7352320
    s_add_u32 s16, s38, s5
    s_addc_u32 s17, s39, 0
    s_add_u32 s5, s4, 7360512
    s_add_u32 s18, s38, s5
    s_addc_u32 s19, s39, 0
    s_waitcnt vmcnt(0) lgkmcnt(0)
    s_barrier
    s_cmp_ge_u32 s42, 128
    s_cbranch_scc1 Lc_j5
    s_cmp_lg_u32 s3, 0
    s_cbranch_scc1 Lc_j5
    v_lshlrev_b32 v201, 3, v2
    v_add_u32 v202, 143616, v201
    ds_read_b64 v[212:213], v202 offset:0
    ds_read_b64 v[214:215], v202 offset:128
    ds_read_b64 v[216:217], v202 offset:256
    ds_read_b64 v[218:219], v202 offset:384
    s_waitcnt lgkmcnt(2)
    v_pk_add_f32 v[212:213], v[212:213], v[214:215] op_sel:[0,0] op_sel_hi:[1,1]
    s_waitcnt lgkmcnt(0)
    v_pk_add_f32 v[216:217], v[216:217], v[218:219] op_sel:[0,0] op_sel_hi:[1,1]
    v_pk_add_f32 v[212:213], v[212:213], v[216:217] op_sel:[0,0] op_sel_hi:[1,1]
    v_mul_f32 v212, 0x3acccccd, v212
    v_mul_f32 v213, 0x3acccccd, v213
    v_fma_f32 v213, -v212, v212, v213
    v_max_f32 v213, 0, v213
    v_add_f32 v213, 0x3727c5ac, v213
    v_rsq_f32 v214, v213
    s_nop 0
    v_mul_f32_e64 v213, -v212, v214
    v_mov_b32 v212, v214
    v_min_u32 v212, -2, v212
    v_min_u32 v213, -2, v213
    s_lshl_b32 s5, s42, 7
    s_add_u32 s5, s5, 32768
    v_add_u32 v201, s5, v201
    global_store_dwordx2 v201, v[212:213], s[38:39] sc1
Lc_j5:
    v_cmp_eq_u32 vcc, 0, v42
    s_nop 0
    s_cbranch_vccnz Lic2_r
Lic2_ok:
    v_cmp_eq_u32 vcc, -1, v40
    s_nop 0
    s_cbranch_vccnz Lkf_r
Lkf_ok:
    s_add_u32 s4, s47, 20971520
    v_add_u32 v28, s4, v4
    s_mul_i32 s5, s3, 9280
    s_add_u32 m0, s5, 33804
    s_nop 0
    global_load_lds_dwordx4 v28, s[38:39] offset:3072 sc1
    s_add_u32 m0, s5, 38448
    s_nop 0
    global_load_lds_dwordx4 v28, s[38:39] offset:3072 sc1
    s_add_u32 m0, s5, 33804
    s_nop 0
    global_load_lds_dwordx4 v28, s[38:39] offset:2048 sc1
    s_add_u32 m0, s5, 38448
    s_nop 0
    global_load_lds_dwordx4 v28, s[38:39] offset:2048 sc1
    s_add_u32 m0, s5, 33804
    s_nop 0
    global_load_lds_dwordx4 v28, s[38:39] offset:1024 sc1
    s_add_u32 m0, s5, 38448
    s_nop 0
    global_load_lds_dwordx4 v28, s[38:39] offset:1024 sc1
    s_add_u32 m0, s5, 33804
    s_nop 0
    global_load_lds_dwordx4 v28, s[38:39] offset:0 sc1
    s_add_u32 m0, s5, 38448
    s_nop 0
    global_load_lds_dwordx4 v28, s[38:39] offset:0 sc1
    s_waitcnt vmcnt(6)
    ds_read_b128 v[72:75], v32 offset:3584
    ds_read_b128 v[76:79], v32 offset:3648
    ds_read_b128 v[80:83], v32 offset:3712
    ds_read_b128 v[84:87], v32 offset:3776
    ds_read_b128 v[88:91], v32 offset:3840
    ds_read_b128 v[92:95], v32 offset:3904
    ds_read_b128 v[96:99], v32 offset:3968
    ds_read_b128 v[100:103], v32 offset:4032
    s_waitcnt lgkmcnt(7)
    v_mfma_f32_16x16x32_bf16 v[40:43], a[0:3], v[72:75], 0
    ds_read_b128 v[104:107], v32 offset:3072
    v_mov_b32 v156, -1
    v_mfma_f32_16x16x32_bf16 v[44:47], a[32:35], v[72:75], 0
    ds_read_b128 v[108:111], v32 offset:3136
    v_mov_b32 v157, -1
    s_waitcnt lgkmcnt(8)
    v_mfma_f32_16x16x32_bf16 v[40:43], a[4:7], v[76:79], v[40:43]
    ds_read_b128 v[112:115], v32 offset:3200
    v_mfma_f32_16x16x32_bf16 v[44:47], a[36:39], v[76:79], v[44:47]
    ds_read_b128 v[116:119], v32 offset:3264
    v_mov_b32 v158, -1
    s_waitcnt lgkmcnt(9)
    v_mfma_f32_16x16x32_bf16 v[40:43], a[8:11], v[80:83], v[40:43]
    ds_read_b128 v[120:123], v32 offset:3328
    v_mfma_f32_16x16x32_bf16 v[44:47], a[40:43], v[80:83], v[44:47]
    ds_read_b128 v[124:127], v32 offset:3392
    v_mov_b32 v159, -1
    s_waitcnt lgkmcnt(10)
    v_mfma_f32_16x16x32_bf16 v[40:43], a[12:15], v[84:87], v[40:43]
    ds_read_b128 v[128:131], v32 offset:3456
    v_mfma_f32_16x16x32_bf16 v[44:47], a[44:47], v[84:87], v[44:47]
    ds_read_b128 v[132:135], v32 offset:3520
    v_add_u32 v236, 0, v37
    s_waitcnt lgkmcnt(11)
    v_mfma_f32_16x16x32_bf16 v[40:43], a[16:19], v[88:91], v[40:43]
    v_mfma_f32_16x16x32_bf16 v[44:47], a[48:51], v[88:91], v[44:47]
    global_store_dwordx4 v236, v[156:159], s[38:39] sc1
    s_waitcnt lgkmcnt(10)
    v_mfma_f32_16x16x32_bf16 v[40:43], a[20:23], v[92:95], v[40:43]
    v_mfma_f32_16x16x32_bf16 v[44:47], a[52:55], v[92:95], v[44:47]
    v_add_u32 v236, 655360, v37
    s_waitcnt lgkmcnt(9)
    v_mfma_f32_16x16x32_bf16 v[40:43], a[24:27], v[96:99], v[40:43]
    v_mfma_f32_16x16x32_bf16 v[44:47], a[56:59], v[96:99], v[44:47]
    global_store_dwordx4 v236, v[156:159], s[38:39] sc1
    s_waitcnt lgkmcnt(8)
    v_mfma_f32_16x16x32_bf16 v[40:43], a[28:31], v[100:103], v[40:43]
    v_mfma_f32_16x16x32_bf16 v[44:47], a[60:63], v[100:103], v[44:47]
    v_add_u32 v236, 1310720, v37
    s_waitcnt lgkmcnt(7)
    v_mfma_f32_16x16x32_bf16 v[44:47], a[0:3], v[104:107], v[44:47]
    s_waitcnt lgkmcnt(6)
    v_mfma_f32_16x16x32_bf16 v[44:47], a[4:7], v[108:111], v[44:47]
    global_store_dwordx4 v236, v[156:159], s[38:39] sc1
    s_waitcnt lgkmcnt(5)
    v_mfma_f32_16x16x32_bf16 v[44:47], a[8:11], v[112:115], v[44:47]
    s_waitcnt lgkmcnt(4)
    v_mfma_f32_16x16x32_bf16 v[44:47], a[12:15], v[116:119], v[44:47]
    v_add_u32 v236, 1966080, v37
    s_waitcnt lgkmcnt(3)
    v_mfma_f32_16x16x32_bf16 v[44:47], a[16:19], v[120:123], v[44:47]
    s_waitcnt lgkmcnt(2)
    v_mfma_f32_16x16x32_bf16 v[44:47], a[20:23], v[124:127], v[44:47]
    global_store_dwordx4 v236, v[156:159], s[38:39] sc1
    s_waitcnt lgkmcnt(1)
    v_mfma_f32_16x16x32_bf16 v[44:47], a[24:27], v[128:131], v[44:47]
    s_waitcnt lgkmcnt(0)
    v_mfma_f32_16x16x32_bf16 v[44:47], a[28:31], v[132:135], v[44:47]
    s_mul_i32 s4, s42, 24576
    s_min_u32 s4, s4, 3776512
    s_add_u32 s4, s4, 12455936
    v_lshl_add_u32 v236, v0, 4, s4
    v_mfma_f32_16x16x32_bf16 v[48:51], a[64:67], v[72:75], 0
    v_mfma_f32_16x16x32_bf16 v[52:55], a[96:99], v[72:75], 0
    global_store_dwordx4 v236, v[156:159], s[38:39] offset:-4096 sc1
    v_mfma_f32_16x16x32_bf16 v[56:59], a[128:131], v[72:75], 0
    v_mfma_f32_16x16x32_bf16 v[60:63], a[160:163], v[72:75], 0
    global_store_dwordx4 v236, v[156:159], s[38:39] offset:0 sc1
    v_mfma_f32_16x16x32_bf16 v[64:67], a[192:195], v[72:75], 0
    v_mfma_f32_16x16x32_bf16 v[68:71], a[224:227], v[72:75], 0
    v_add_u32 v236, 8192, v236
    v_mfma_f32_16x16x32_bf16 v[48:51], a[68:71], v[76:79], v[48:51]
    v_mfma_f32_16x16x32_bf16 v[52:55], a[100:103], v[76:79], v[52:55]
    global_store_dwordx4 v236, v[156:159], s[38:39] offset:-4096 sc1
    v_mfma_f32_16x16x32_bf16 v[56:59], a[132:135], v[76:79], v[56:59]
    v_mfma_f32_16x16x32_bf16 v[60:63], a[164:167], v[76:79], v[60:63]
    global_store_dwordx4 v236, v[156:159], s[38:39] offset:0 sc1
    v_mfma_f32_16x16x32_bf16 v[64:67], a[196:199], v[76:79], v[64:67]
    v_mfma_f32_16x16x32_bf16 v[68:71], a[228:231], v[76:79], v[68:71]
    v_add_u32 v236, 8192, v236
    v_mfma_f32_16x16x32_bf16 v[48:51], a[72:75], v[80:83], v[48:51]
    v_mfma_f32_16x16x32_bf16 v[52:55], a[104:107], v[80:83], v[52:55]
    global_store_dwordx4 v236, v[156:159], s[38:39] offset:-4096 sc1
    v_mfma_f32_16x16x32_bf16 v[56:59], a[136:139], v[80:83], v[56:59]
    v_mfma_f32_16x16x32_bf16 v[60:63], a[168:171], v[80:83], v[60:63]
    global_store_dwordx4 v236, v[156:159], s[38:39] offset:0 sc1
    v_mfma_f32_16x16x32_bf16 v[64:67], a[200:203], v[80:83], v[64:67]
    v_mfma_f32_16x16x32_bf16 v[68:71], a[232:235], v[80:83], v[68:71]
    v_add_u32 v236, 8192, v236
    v_mfma_f32_16x16x32_bf16 v[48:51], a[76:79], v[84:87], v[48:51]
    v_mfma_f32_16x16x32_bf16 v[52:55], a[108:111], v[84:87], v[52:55]
    v_mfma_f32_16x16x32_bf16 v[56:59], a[140:143], v[84:87], v[56:59]
    v_lshlrev_b32 v28, 4, v0
    v_mfma_f32_16x16x32_bf16 v[60:63], a[172:175], v[84:87], v[60:63]
    v_add_u32 v28, 36864, v28
    v_mfma_f32_16x16x32_bf16 v[64:67], a[204:207], v[84:87], v[64:67]
    global_load_dwordx4 v[200:203], v28, s[38:39] offset:-4096 sc1
    v_mfma_f32_16x16x32_bf16 v[68:71], a[236:239], v[84:87], v[68:71]
    global_load_dwordx4 v[204:207], v28, s[38:39] offset:0 sc1
    v_mfma_f32_16x16x32_bf16 v[48:51], a[80:83], v[88:91], v[48:51]
    v_add_u32 v28, 8192, v28
    v_mfma_f32_16x16x32_bf16 v[52:55], a[112:115], v[88:91], v[52:55]
    global_load_dwordx4 v[208:211], v28, s[38:39] offset:-4096 sc1
    v_mfma_f32_16x16x32_bf16 v[56:59], a[144:147], v[88:91], v[56:59]
    global_load_dwordx4 v[212:215], v28, s[38:39] offset:0 sc1
    v_mfma_f32_16x16x32_bf16 v[60:63], a[176:179], v[88:91], v[60:63]
    v_min_u32 v28, 11, v1
    v_mfma_f32_16x16x32_bf16 v[64:67], a[208:211], v[88:91], v[64:67]
    v_lshrrev_b32 v29, 2, v28
    v_mfma_f32_16x16x32_bf16 v[68:71], a[240:243], v[88:91], v[68:71]
    v_mul_u32_u24 v29, 2544, v29
    v_mfma_f32_16x16x32_bf16 v[48:51], a[84:87], v[92:95], v[48:51]
    v_lshl_add_u32 v28, v28, 2, v29
    v_mfma_f32_16x16x32_bf16 v[52:55], a[116:119], v[92:95], v[52:55]
    s_lshl_b32 s4, s42, 4
    s_add_u32 s4, s4, 0
    v_add_u32 v28, s4, v28
    v_mfma_f32_16x16x32_bf16 v[56:59], a[148:151], v[92:95], v[56:59]
    global_load_dword v180, v28, s[38:39] sc1
    v_mfma_f32_16x16x32_bf16 v[60:63], a[180:183], v[92:95], v[60:63]
    v_add_u32 v28, 15360, v28
    v_mfma_f32_16x16x32_bf16 v[64:67], a[212:215], v[92:95], v[64:67]
    global_load_dword v181, v28, s[38:39] sc1
    v_mfma_f32_16x16x32_bf16 v[68:71], a[244:247], v[92:95], v[68:71]
    v_mfma_f32_16x16x32_bf16 v[48:51], a[88:91], v[96:99], v[48:51]
    v_mfma_f32_16x16x32_bf16 v[52:55], a[120:123], v[96:99], v[52:55]
    v_mfma_f32_16x16x32_bf16 v[56:59], a[152:155], v[96:99], v[56:59]
    v_mfma_f32_16x16x32_bf16 v[60:63], a[184:187], v[96:99], v[60:63]
    v_mfma_f32_16x16x32_bf16 v[64:67], a[216:219], v[96:99], v[64:67]
    v_mfma_f32_16x16x32_bf16 v[68:71], a[248:251], v[96:99], v[68:71]
    v_mfma_f32_16x16x32_bf16 v[48:51], a[92:95], v[100:103], v[48:51]
    v_mfma_f32_16x16x32_bf16 v[52:55], a[124:127], v[100:103], v[52:55]
    v_mfma_f32_16x16x32_bf16 v[56:59], a[156:159], v[100:103], v[56:59]
    v_mfma_f32_16x16x32_bf16 v[60:63], a[188:191], v[100:103], v[60:63]
    v_mfma_f32_16x16x32_bf16 v[64:67], a[220:223], v[100:103], v[64:67]
    v_mfma_f32_16x16x32_bf16 v[68:71], a[252:255], v[100:103], v[68:71]
    v_mfma_f32_16x16x32_bf16 v[48:51], a[32:35], v[104:107], v[48:51]
    v_mfma_f32_16x16x32_bf16 v[52:55], a[64:67], v[104:107], v[52:55]
    v_mfma_f32_16x16x32_bf16 v[56:59], a[96:99], v[104:107], v[56:59]
    v_mfma_f32_16x16x32_bf16 v[60:63], a[128:131], v[104:107], v[60:63]
    v_mfma_f32_16x16x32_bf16 v[64:67], a[160:163], v[104:107], v[64:67]
    v_mfma_f32_16x16x32_bf16 v[68:71], a[192:195], v[104:107], v[68:71]
    v_mfma_f32_16x16x32_bf16 v[48:51], a[36:39], v[108:111], v[48:51]
    v_mfma_f32_16x16x32_bf16 v[52:55], a[68:71], v[108:111], v[52:55]
    v_mfma_f32_16x16x32_bf16 v[56:59], a[100:103], v[108:111], v[56:59]
    v_mfma_f32_16x16x32_bf16 v[60:63], a[132:135], v[108:111], v[60:63]
    v_mfma_f32_16x16x32_bf16 v[64:67], a[164:167], v[108:111], v[64:67]
    v_mfma_f32_16x16x32_bf16 v[68:71], a[196:199], v[108:111], v[68:71]
    v_mfma_f32_16x16x32_bf16 v[48:51], a[40:43], v[112:115], v[48:51]
    v_mfma_f32_16x16x32_bf16 v[52:55], a[72:75], v[112:115], v[52:55]
    v_mfma_f32_16x16x32_bf16 v[56:59], a[104:107], v[112:115], v[56:59]
    v_mfma_f32_16x16x32_bf16 v[60:63], a[136:139], v[112:115], v[60:63]
    v_mfma_f32_16x16x32_bf16 v[64:67], a[168:171], v[112:115], v[64:67]
    v_mfma_f32_16x16x32_bf16 v[68:71], a[200:203], v[112:115], v[68:71]
    v_mfma_f32_16x16x32_bf16 v[48:51], a[44:47], v[116:119], v[48:51]
    v_mfma_f32_16x16x32_bf16 v[52:55], a[76:79], v[116:119], v[52:55]
    v_mfma_f32_16x16x32_bf16 v[56:59], a[108:111], v[116:119], v[56:59]
    s_waitcnt vmcnt(5)
    v_max_u32 v236, v201, v203
    s_waitcnt vmcnt(4)
    v_max3_u32 v236, v205, v207, v236
    v_mfma_f32_16x16x32_bf16 v[60:63], a[140:143], v[116:119], v[60:63]
    s_waitcnt vmcnt(3)
    v_max3_u32 v236, v209, v211, v236
    v_mfma_f32_16x16x32_bf16 v[64:67], a[172:175], v[116:119], v[64:67]
    s_waitcnt vmcnt(2)
    v_max3_u32 v236, v213, v215, v236
    v_mfma_f32_16x16x32_bf16 v[68:71], a[204:207], v[116:119], v[68:71]
    s_waitcnt vmcnt(0)
    v_max3_u32 v236, v180, v181, v236
    v_mfma_f32_16x16x32_bf16 v[48:51], a[48:51], v[120:123], v[48:51]
    v_cmp_eq_u32 vcc, -1, v236
    v_mfma_f32_16x16x32_bf16 v[52:55], a[80:83], v[120:123], v[52:55]
    s_cbranch_vccnz Lax_r
Lax_ok:
    global_load_dwordx4 v[184:187], v36, s[38:39] offset:-4096 sc1
    v_mfma_f32_16x16x32_bf16 v[56:59], a[112:115], v[120:123], v[56:59]
    global_load_dwordx4 v[188:191], v36, s[38:39] offset:0 sc1
    v_mfma_f32_16x16x32_bf16 v[60:63], a[144:147], v[120:123], v[60:63]
    v_add_u32 v36, 8192, v36
    v_mfma_f32_16x16x32_bf16 v[64:67], a[176:179], v[120:123], v[64:67]
    v_cvt_pk_bf16_f32 v136, v40, v41
    v_cvt_pk_bf16_f32 v137, v42, v43
    global_load_dwordx4 v[192:195], v36, s[38:39] offset:-4096 sc1
    v_mfma_f32_16x16x32_bf16 v[68:71], a[208:211], v[120:123], v[68:71]
    ds_write2_b32 v34, v136, v137 offset0:0 offset1:2
    global_load_dwordx4 v[196:199], v36, s[38:39] offset:0 sc1
    v_mfma_f32_16x16x32_bf16 v[48:51], a[52:55], v[124:127], v[48:51]
    v_cvt_pk_bf16_f32 v138, v44, v45
    v_add_f32 v180, v180, v181
    v_mfma_f32_16x16x32_bf16 v[52:55], a[84:87], v[124:127], v[52:55]
    v_cvt_pk_bf16_f32 v139, v46, v47
    v_cvt_pk_bf16_f32 v180, v180, v180
    v_lshlrev_b32 v180, 16, v180
    v_mfma_f32_16x16x32_bf16 v[56:59], a[116:119], v[124:127], v[56:59]
    ds_write2_b32 v34, v138, v139 offset0:128 offset1:130
    v_mov_b32 v29, 1.0
    v_mfma_f32_16x16x32_bf16 v[60:63], a[148:151], v[124:127], v[60:63]
    v_add_u32 v34, 4224, v34
    v_add_f32_dpp v180, v180, v29 quad_perm:[0,1,2,3] row_mask:0xf bank_mask:0x2
    v_mfma_f32_16x16x32_bf16 v[64:67], a[180:183], v[124:127], v[64:67]
    s_waitcnt lgkmcnt(0)
    s_barrier
    v_cvt_pk_bf16_f32 v180, v180, v180
    v_mfma_f32_16x16x32_bf16 v[68:71], a[212:215], v[124:127], v[68:71]
    s_lshl_b32 s6, s42, 2
    s_add_u32 s6, s6, 98560
    v_mov_b32 v136, s6
    s_cmp_lg_u32 s3, 0
    s_cbranch_scc1 Lxf_skip
    global_store_dword v136, v136, s[38:39] sc1
Lxf_skip:
    v_lshlrev_b32 v180, 16, v180
    v_mfma_f32_16x16x32_bf16 v[48:51], a[56:59], v[128:131], v[48:51]
    s_nop 0
    v_mul_f32_dpp v181, v180, v180 row_shl:8 row_mask:0xf bank_mask:0x1
    s_nop 1
    v_mul_f32_dpp v181, v180, v180 row_shl:4 row_mask:0xf bank_mask:0x2
    ds_read_b128 v[72:75], v32 offset:2560
    v_mfma_f32_16x16x32_bf16 v[52:55], a[88:91], v[128:131], v[52:55]
    v_readlane_b32 s68, v181, 0
    ds_read_b128 v[76:79], v32 offset:2624
    v_mfma_f32_16x16x32_bf16 v[56:59], a[120:123], v[128:131], v[56:59]
    v_readlane_b32 s69, v181, 1
    ds_read_b128 v[80:83], v32 offset:2688
    v_mfma_f32_16x16x32_bf16 v[60:63], a[152:155], v[128:131], v[60:63]
    v_readlane_b32 s70, v181, 2
    ds_read_b128 v[84:87], v32 offset:2752
    v_mfma_f32_16x16x32_bf16 v[64:67], a[184:187], v[128:131], v[64:67]
    v_readlane_b32 s71, v181, 3
    ds_read_b128 v[88:91], v32 offset:2816
    v_mfma_f32_16x16x32_bf16 v[68:71], a[216:219], v[128:131], v[68:71]
    v_readlane_b32 s64, v181, 4
    ds_read_b128 v[92:95], v32 offset:2880
    v_mfma_f32_16x16x32_bf16 v[48:51], a[60:63], v[132:135], v[48:51]
    v_readlane_b32 s65, v181, 5
    v_readlane_b32 s66, v181, 6
    ds_read_b128 v[96:99], v32 offset:2944
    v_mfma_f32_16x16x32_bf16 v[52:55], a[92:95], v[132:135], v[52:55]
    v_readlane_b32 s67, v181, 7
    ds_read_b128 v[100:103], v32 offset:3008
    v_mfma_f32_16x16x32_bf16 v[56:59], a[124:127], v[132:135], v[56:59]
    v_mov_b32 v176, s68
    v_mfma_f32_16x16x32_bf16 v[60:63], a[156:159], v[132:135], v[60:63]
    v_mov_b32 v177, s69
    v_mfma_f32_16x16x32_bf16 v[64:67], a[188:191], v[132:135], v[64:67]
    v_mov_b32 v178, s70
    v_mfma_f32_16x16x32_bf16 v[68:71], a[220:223], v[132:135], v[68:71]
    v_mov_b32 v179, s71
    s_waitcnt lgkmcnt(7)
    v_mfma_f32_16x16x32_bf16 v[48:51], a[0:3], v[72:75], v[48:51]
    ds_read_b128 v[104:107], v32 offset:2048
    s_lshl_b32 s4, s96, 7
    s_add_u32 s4, s4, 49152
    v_lshl_add_u32 v28, v2, 2, s4
    global_load_dword v8, v28, s[38:39] sc1
    v_mfma_f32_16x16x32_bf16 v[52:55], a[32:35], v[72:75], v[52:55]
    ds_read_b128 v[108:111], v32 offset:2112
    global_load_dword v9, v28, s[38:39] offset:64 sc1
    s_waitcnt lgkmcnt(8)
    v_mfma_f32_16x16x32_bf16 v[48:51], a[4:7], v[76:79], v[48:51]
    ds_read_b128 v[112:115], v32 offset:2176
    s_add_u32 s4, s4, 7168
    v_lshl_add_u32 v28, v3, 4, s4
    v_mfma_f32_16x16x32_bf16 v[52:55], a[36:39], v[76:79], v[52:55]
    ds_read_b128 v[116:119], v32 offset:2240
    global_load_dwordx4 v[12:15], v28, s[38:39] sc1
    s_waitcnt lgkmcnt(9)
    v_mfma_f32_16x16x32_bf16 v[48:51], a[8:11], v[80:83], v[48:51]
    ds_read_b128 v[120:123], v32 offset:2304
    global_load_dwordx4 v[16:19], v28, s[38:39] offset:64 sc1
    v_mfma_f32_16x16x32_bf16 v[52:55], a[40:43], v[80:83], v[52:55]
    ds_read_b128 v[124:127], v32 offset:2368
    s_lshl_b32 s4, s97, 7
    s_add_u32 s4, s4, 49152
    v_lshl_add_u32 v28, v2, 2, s4
    s_waitcnt lgkmcnt(10)
    v_mfma_f32_16x16x32_bf16 v[48:51], a[12:15], v[84:87], v[48:51]
    ds_read_b128 v[128:131], v32 offset:2432
    global_load_dword v10, v28, s[38:39] sc1
    v_mfma_f32_16x16x32_bf16 v[52:55], a[44:47], v[84:87], v[52:55]
    ds_read_b128 v[132:135], v32 offset:2496
    global_load_dword v11, v28, s[38:39] offset:64 sc1
    s_add_u32 s4, s4, 7168
    v_lshl_add_u32 v28, v3, 4, s4
    s_waitcnt lgkmcnt(11)
    v_mfma_f32_16x16x32_bf16 v[48:51], a[16:19], v[88:91], v[48:51]
    global_load_dwordx4 v[20:23], v28, s[38:39] sc1
    v_mfma_f32_16x16x32_bf16 v[52:55], a[48:51], v[88:91], v[52:55]
    global_load_dwordx4 v[24:27], v28, s[38:39] offset:64 sc1
    s_waitcnt lgkmcnt(10)
    v_mfma_f32_16x16x32_bf16 v[48:51], a[20:23], v[92:95], v[48:51]
    s_lshl_b32 s4, s96, 7
    s_add_u32 s4, s4, 63488
    v_lshl_add_u32 v28, v2, 2, s4
    v_mfma_f32_16x16x32_bf16 v[52:55], a[52:55], v[92:95], v[52:55]
    global_load_dword v216, v28, s[38:39] sc1
    s_waitcnt lgkmcnt(9)
    v_mfma_f32_16x16x32_bf16 v[48:51], a[24:27], v[96:99], v[48:51]
    global_load_dword v217, v28, s[38:39] offset:64 sc1
    v_mfma_f32_16x16x32_bf16 v[52:55], a[56:59], v[96:99], v[52:55]
    s_add_u32 s4, s4, 7168
    v_lshl_add_u32 v28, v3, 4, s4
    s_waitcnt lgkmcnt(8)
    v_mfma_f32_16x16x32_bf16 v[48:51], a[28:31], v[100:103], v[48:51]
    global_load_dwordx4 v[220:223], v28, s[38:39] sc1
    global_load_dwordx4 v[224:227], v28, s[38:39] offset:64 sc1
    v_mfma_f32_16x16x32_bf16 v[52:55], a[60:63], v[100:103], v[52:55]
    s_lshl_b32 s4, s97, 7
    s_add_u32 s4, s4, 63488
    v_lshl_add_u32 v28, v2, 2, s4
    s_waitcnt lgkmcnt(7)
    v_mfma_f32_16x16x32_bf16 v[52:55], a[0:3], v[104:107], v[52:55]
    global_load_dword v218, v28, s[38:39] sc1
    s_waitcnt lgkmcnt(6)
    v_mfma_f32_16x16x32_bf16 v[52:55], a[4:7], v[108:111], v[52:55]
    global_load_dword v219, v28, s[38:39] offset:64 sc1
    s_waitcnt lgkmcnt(5)
    v_mfma_f32_16x16x32_bf16 v[52:55], a[8:11], v[112:115], v[52:55]
    s_add_u32 s4, s4, 7168
    v_lshl_add_u32 v28, v3, 4, s4
    s_waitcnt lgkmcnt(4)
    v_mfma_f32_16x16x32_bf16 v[52:55], a[12:15], v[116:119], v[52:55]
    global_load_dwordx4 v[228:231], v28, s[38:39] sc1
    s_waitcnt lgkmcnt(3)
    v_mfma_f32_16x16x32_bf16 v[52:55], a[16:19], v[120:123], v[52:55]
    global_load_dwordx4 v[232:235], v28, s[38:39] offset:64 sc1
    s_waitcnt lgkmcnt(2)
    v_mfma_f32_16x16x32_bf16 v[52:55], a[20:23], v[124:127], v[52:55]
    s_waitcnt lgkmcnt(1)
    v_mfma_f32_16x16x32_bf16 v[52:55], a[24:27], v[128:131], v[52:55]
    ds_read_b32 v148, v35 offset:0
    ds_read_b32 v149, v35 offset:1056
    s_waitcnt lgkmcnt(2)
    v_mfma_f32_16x16x32_bf16 v[52:55], a[28:31], v[132:135], v[52:55]
    ds_read_b32 v150, v35 offset:2112
    ds_read_b32 v151, v35 offset:3168
    v_mfma_f32_16x16x32_bf16 v[56:59], a[64:67], v[72:75], v[56:59]
    ds_read_b32 v152, v33 offset:3072
    ds_read_b32 v153, v33 offset:12352
    v_mfma_f32_16x16x32_bf16 v[60:63], a[96:99], v[72:75], v[60:63]
    ds_read_b32 v154, v33 offset:21632
    ds_read_b32 v155, v33 offset:30912
    v_mfma_f32_16x16x32_bf16 v[64:67], a[128:131], v[72:75], v[64:67]
    s_waitcnt vmcnt(19)
    v_lshlrev_b32 v156, 16, v184
    v_and_b32 v157, 0xffff0000, v184
    v_mfma_f32_16x16x32_bf16 v[68:71], a[160:163], v[72:75], v[68:71]
    v_lshlrev_b32 v158, 16, v185
    v_and_b32 v159, 0xffff0000, v185
    v_mfma_f32_16x16x32_bf16 v[56:59], a[68:71], v[76:79], v[56:59]
    v_cvt_pk_bf16_f32 v136, v48, v49
    v_lshlrev_b32 v160, 16, v186
    v_and_b32 v161, 0xffff0000, v186
    v_mfma_f32_16x16x32_bf16 v[60:63], a[100:103], v[76:79], v[60:63]
    v_cvt_pk_bf16_f32 v137, v50, v51
    v_lshlrev_b32 v162, 16, v187
    v_and_b32 v163, 0xffff0000, v187
    v_mfma_f32_16x16x32_bf16 v[64:67], a[132:135], v[76:79], v[64:67]
    ds_write2_b32 v34, v136, v137 offset0:0 offset1:2
    v_fma_f32 v164, v156, v200, v201
    v_fma_f32 v165, v157, v200, v201
    v_mfma_f32_16x16x32_bf16 v[68:71], a[164:167], v[76:79], v[68:71]
    v_cvt_pk_bf16_f32 v138, v52, v53
    v_fma_f32 v166, v158, v200, v201
    v_mfma_f32_16x16x32_bf16 v[56:59], a[72:75], v[80:83], v[56:59]
    v_cvt_pk_bf16_f32 v139, v54, v55
    v_fma_f32 v167, v159, v200, v201
    v_fma_f32 v168, v160, v202, v203
    v_mfma_f32_16x16x32_bf16 v[60:63], a[104:107], v[80:83], v[60:63]
    ds_write2_b32 v34, v138, v139 offset0:128 offset1:130
    v_fma_f32 v169, v161, v202, v203
    v_fma_f32 v170, v162, v202, v203
    v_mfma_f32_16x16x32_bf16 v[64:67], a[136:139], v[80:83], v[64:67]
    v_add_u32 v34, 4224, v34
    v_fma_f32 v171, v163, v202, v203
    v_fma_f32 v164, v164, s64, v176
    v_mfma_f32_16x16x32_bf16 v[68:71], a[168:171], v[80:83], v[68:71]
    s_waitcnt lgkmcnt(0)
    s_barrier
    v_fma_f32 v165, v165, s65, v177
    v_fma_f32 v166, v166, s66, v178
    v_mfma_f32_16x16x32_bf16 v[56:59], a[76:79], v[84:87], v[56:59]
    v_fma_f32 v167, v167, s67, v179
    v_fma_f32 v168, v168, s64, v176
    v_mfma_f32_16x16x32_bf16 v[60:63], a[108:111], v[84:87], v[60:63]
    v_fma_f32 v169, v169, s65, v177
    v_fma_f32 v170, v170, s66, v178
    v_mfma_f32_16x16x32_bf16 v[64:67], a[140:143], v[84:87], v[64:67]
    v_fma_f32 v171, v171, s67, v179
    v_lshlrev_b32 v140, 16, v148
    v_mfma_f32_16x16x32_bf16 v[68:71], a[172:175], v[84:87], v[68:71]
    v_and_b32 v144, 0xffff0000, v148
    v_lshlrev_b32 v141, 16, v149
    v_mfma_f32_16x16x32_bf16 v[56:59], a[80:83], v[88:91], v[56:59]
    v_and_b32 v145, 0xffff0000, v149
    v_lshlrev_b32 v142, 16, v150
    v_mfma_f32_16x16x32_bf16 v[60:63], a[112:115], v[88:91], v[60:63]
    v_and_b32 v146, 0xffff0000, v150
    v_mfma_f32_16x16x32_bf16 v[64:67], a[144:147], v[88:91], v[64:67]
    v_lshlrev_b32 v143, 16, v151
    v_and_b32 v147, 0xffff0000, v151
    v_mfma_f32_16x16x32_bf16 v[68:71], a[176:179], v[88:91], v[68:71]
    v_and_b32 v172, 0xffff0000, v152
    v_and_b32 v173, 0xffff0000, v153
    v_mfma_f32_16x16x32_bf16 v[56:59], a[84:87], v[92:95], v[56:59]
    v_and_b32 v174, 0xffff0000, v154
    v_and_b32 v175, 0xffff0000, v155
    v_mfma_f32_16x16x32_bf16 v[60:63], a[116:119], v[92:95], v[60:63]
    v_fmac_f32 v140, s56, v172
    v_fmac_f32 v141, s57, v173
    v_mfma_f32_16x16x32_bf16 v[64:67], a[148:151], v[92:95], v[64:67]
    v_fmac_f32 v142, s58, v174
    v_fmac_f32 v143, s59, v175
    v_mfma_f32_16x16x32_bf16 v[68:71], a[180:183], v[92:95], v[68:71]
    v_lshlrev_b32 v172, 16, v152
    v_lshlrev_b32 v173, 16, v153
    v_mfma_f32_16x16x32_bf16 v[56:59], a[88:91], v[96:99], v[56:59]
    v_lshlrev_b32 v174, 16, v154
    v_lshlrev_b32 v175, 16, v155
    v_mfma_f32_16x16x32_bf16 v[60:63], a[120:123], v[96:99], v[60:63]
    v_fmac_f32 v144, s56, v172
    v_fmac_f32 v145, s57, v173
    v_mfma_f32_16x16x32_bf16 v[64:67], a[152:155], v[96:99], v[64:67]
    v_fmac_f32 v146, s58, v174
    v_fmac_f32 v147, s59, v175
    v_mfma_f32_16x16x32_bf16 v[68:71], a[184:187], v[96:99], v[68:71]
    v_fma_f32 v156, v164, v140, v156
    v_mfma_f32_16x16x32_bf16 v[56:59], a[92:95], v[100:103], v[56:59]
    v_fma_f32 v157, v165, v141, v157
    v_fma_f32 v158, v166, v142, v158
    v_mfma_f32_16x16x32_bf16 v[60:63], a[124:127], v[100:103], v[60:63]
    v_fma_f32 v159, v167, v143, v159
    v_fma_f32 v160, v168, v144, v160
    v_mfma_f32_16x16x32_bf16 v[64:67], a[156:159], v[100:103], v[64:67]
    v_fma_f32 v161, v169, v145, v161
    v_fma_f32 v162, v170, v146, v162
    v_mfma_f32_16x16x32_bf16 v[68:71], a[188:191], v[100:103], v[68:71]
    v_fma_f32 v163, v171, v147, v163
    v_cvt_pk_bf16_f32 v184, v156, v157
    v_mfma_f32_16x16x32_bf16 v[56:59], a[32:35], v[104:107], v[56:59]
    v_cvt_pk_bf16_f32 v185, v158, v159
    v_cvt_pk_bf16_f32 v186, v160, v161
    s_waitcnt vmcnt(14)
    v_max_u32 v236, v8, v9
    s_waitcnt vmcnt(10)
    v_max3_u32 v236, v10, v11, v236
    v_mfma_f32_16x16x32_bf16 v[60:63], a[64:67], v[104:107], v[60:63]
    v_cvt_pk_bf16_f32 v187, v162, v163
    v_min_u32 v184, -2, v184
    v_max3_u32 v236, v12, v13, v236
    v_mfma_f32_16x16x32_bf16 v[64:67], a[96:99], v[104:107], v[64:67]
    v_min_u32 v185, -2, v185
    v_min_u32 v186, -2, v186
    v_max3_u32 v236, v14, v15, v236
    v_mfma_f32_16x16x32_bf16 v[68:71], a[128:131], v[104:107], v[68:71]
    v_min_u32 v187, -2, v187
    global_store_dwordx4 v37, v[184:187], s[38:39] sc1
    v_max3_u32 v236, v16, v17, v236
    v_mfma_f32_16x16x32_bf16 v[56:59], a[36:39], v[108:111], v[56:59]
    v_add_u32 v37, 655360, v37
    v_max3_u32 v236, v18, v19, v236
    v_mfma_f32_16x16x32_bf16 v[60:63], a[68:71], v[108:111], v[60:63]
    s_waitcnt vmcnt(10)
    v_max3_u32 v236, v20, v21, v236
    v_max3_u32 v236, v22, v23, v236
    v_mfma_f32_16x16x32_bf16 v[64:67], a[100:103], v[108:111], v[64:67]
    s_waitcnt vmcnt(9)
    v_max3_u32 v236, v24, v25, v236
    v_mfma_f32_16x16x32_bf16 v[68:71], a[132:135], v[108:111], v[68:71]
    v_max3_u32 v236, v26, v27, v236
    v_mfma_f32_16x16x32_bf16 v[56:59], a[40:43], v[112:115], v[56:59]
    s_waitcnt vmcnt(7)
    v_max3_u32 v236, v216, v217, v236
    v_mfma_f32_16x16x32_bf16 v[60:63], a[72:75], v[112:115], v[60:63]
    s_waitcnt vmcnt(3)
    v_max3_u32 v236, v218, v219, v236
    v_mfma_f32_16x16x32_bf16 v[64:67], a[104:107], v[112:115], v[64:67]
    v_max3_u32 v236, v220, v221, v236
    v_max3_u32 v236, v222, v223, v236
    v_mfma_f32_16x16x32_bf16 v[68:71], a[136:139], v[112:115], v[68:71]
    v_max3_u32 v236, v224, v225, v236
    v_mfma_f32_16x16x32_bf16 v[56:59], a[44:47], v[116:119], v[56:59]
    v_max3_u32 v236, v226, v227, v236
    v_mfma_f32_16x16x32_bf16 v[60:63], a[76:79], v[116:119], v[60:63]
    s_waitcnt vmcnt(2)
    v_max3_u32 v236, v228, v229, v236
    v_mfma_f32_16x16x32_bf16 v[64:67], a[108:111], v[116:119], v[64:67]
    v_max3_u32 v236, v230, v231, v236
    v_mfma_f32_16x16x32_bf16 v[68:71], a[140:143], v[116:119], v[68:71]
    s_waitcnt vmcnt(1)
    v_max3_u32 v236, v232, v233, v236
    v_mfma_f32_16x16x32_bf16 v[56:59], a[48:51], v[120:123], v[56:59]
    v_max3_u32 v236, v234, v235, v236
    v_cmp_eq_u32 vcc, -1, v236
    v_mfma_f32_16x16x32_bf16 v[60:63], a[80:83], v[120:123], v[60:63]
    s_cbranch_vccnz Lcu_r
Lcu_ok:
    v_mfma_f32_16x16x32_bf16 v[64:67], a[112:115], v[120:123], v[64:67]
    global_load_dwordx4 a[192:195], v4, s[10:11] offset:0 sc1
    v_mfma_f32_16x16x32_bf16 v[68:71], a[144:147], v[120:123], v[68:71]
    global_load_dwordx4 a[196:199], v7, s[16:17] offset:0 sc1
    v_mfma_f32_16x16x32_bf16 v[56:59], a[52:55], v[124:127], v[56:59]
    global_load_dwordx4 a[200:203], v4, s[10:11] offset:1024 sc1
    ds_read_b128 v[72:75], v32 offset:1536
    v_mfma_f32_16x16x32_bf16 v[60:63], a[84:87], v[124:127], v[60:63]
    global_load_dwordx4 a[204:207], v7, s[16:17] offset:1024 sc1
    global_load_dwordx4 a[208:211], v4, s[10:11] offset:2048 sc1
    ds_read_b128 v[76:79], v32 offset:1600
    v_mfma_f32_16x16x32_bf16 v[64:67], a[116:119], v[124:127], v[64:67]
    global_load_dwordx4 a[212:215], v7, s[16:17] offset:2048 sc1
    ds_read_b128 v[80:83], v32 offset:1664
    v_mfma_f32_16x16x32_bf16 v[68:71], a[148:151], v[124:127], v[68:71]
    global_load_dwordx4 a[216:219], v4, s[10:11] offset:3072 sc1
    ds_read_b128 v[84:87], v32 offset:1728
    v_mfma_f32_16x16x32_bf16 v[56:59], a[56:59], v[128:131], v[56:59]
    global_load_dwordx4 a[220:223], v7, s[16:17] offset:3072 sc1
    ds_read_b128 v[88:91], v32 offset:1792
    v_mfma_f32_16x16x32_bf16 v[60:63], a[88:91], v[128:131], v[60:63]
    global_load_dwordx4 a[224:227], v4, s[12:13] offset:-4096 sc1
    ds_read_b128 v[92:95], v32 offset:1856
    v_mfma_f32_16x16x32_bf16 v[64:67], a[120:123], v[128:131], v[64:67]
    global_load_dwordx4 a[228:231], v7, s[18:19] offset:-4096 sc1
    global_load_dwordx4 a[232:235], v4, s[12:13] offset:-3072 sc1
    ds_read_b128 v[96:99], v32 offset:1920
    v_mfma_f32_16x16x32_bf16 v[68:71], a[152:155], v[128:131], v[68:71]
    global_load_dwordx4 a[236:239], v7, s[18:19] offset:-3072 sc1
    ds_read_b128 v[100:103], v32 offset:1984
    v_mfma_f32_16x16x32_bf16 v[56:59], a[60:63], v[132:135], v[56:59]
    global_load_dwordx4 a[240:243], v4, s[12:13] offset:-2048 sc1
    v_mfma_f32_16x16x32_bf16 v[60:63], a[92:95], v[132:135], v[60:63]
    global_load_dwordx4 a[244:247], v7, s[18:19] offset:-2048 sc1
    v_mfma_f32_16x16x32_bf16 v[64:67], a[124:127], v[132:135], v[64:67]
    global_load_dwordx4 a[248:251], v4, s[12:13] offset:-1024 sc1
    v_mfma_f32_16x16x32_bf16 v[68:71], a[156:159], v[132:135], v[68:71]
    global_load_dwordx4 a[252:255], v7, s[18:19] offset:-1024 sc1
    s_waitcnt lgkmcnt(7)
    v_mfma_f32_16x16x32_bf16 v[56:59], a[0:3], v[72:75], v[56:59]
    ds_read_b128 v[104:107], v32 offset:1024
    ds_read_b32 v148, v35 offset:4224
    ds_read_b32 v149, v35 offset:5280
    v_mfma_f32_16x16x32_bf16 v[60:63], a[32:35], v[72:75], v[60:63]
    ds_read_b128 v[108:111], v32 offset:1088
    ds_read_b32 v150, v35 offset:6336
    ds_read_b32 v151, v35 offset:7392
    s_waitcnt lgkmcnt(12)
    v_mfma_f32_16x16x32_bf16 v[56:59], a[4:7], v[76:79], v[56:59]
    ds_read_b128 v[112:115], v32 offset:1152
    ds_read_b32 v152, v33 offset:2048
    v_mfma_f32_16x16x32_bf16 v[60:63], a[36:39], v[76:79], v[60:63]
    ds_read_b128 v[116:119], v32 offset:1216
    ds_read_b32 v153, v33 offset:11328
    ds_read_b32 v154, v33 offset:20608
    s_waitcnt lgkmcnt(15)
    v_mfma_f32_16x16x32_bf16 v[56:59], a[8:11], v[80:83], v[56:59]
    ds_read_b128 v[120:123], v32 offset:1280
    ds_read_b32 v155, v33 offset:29888
    v_lshlrev_b32 v156, 16, v188
    v_mfma_f32_16x16x32_bf16 v[60:63], a[40:43], v[80:83], v[60:63]
    ds_read_b128 v[124:127], v32 offset:1344
    v_and_b32 v157, 0xffff0000, v188
    v_mfma_f32_16x16x32_bf16 v[56:59], a[12:15], v[84:87], v[56:59]
    ds_read_b128 v[128:131], v32 offset:1408
    v_lshlrev_b32 v158, 16, v189
    v_and_b32 v159, 0xffff0000, v189
    v_mfma_f32_16x16x32_bf16 v[60:63], a[44:47], v[84:87], v[60:63]
    ds_read_b128 v[132:135], v32 offset:1472
    v_lshlrev_b32 v160, 16, v190
    v_and_b32 v161, 0xffff0000, v190
    s_waitcnt lgkmcnt(15)
    v_mfma_f32_16x16x32_bf16 v[56:59], a[16:19], v[88:91], v[56:59]
    v_lshlrev_b32 v162, 16, v191
    v_mfma_f32_16x16x32_bf16 v[60:63], a[48:51], v[88:91], v[60:63]
    v_and_b32 v163, 0xffff0000, v191
    v_fma_f32 v164, v156, v204, v205
    v_mfma_f32_16x16x32_bf16 v[56:59], a[20:23], v[92:95], v[56:59]
    v_fma_f32 v165, v157, v204, v205
    v_fma_f32 v166, v158, v204, v205
    v_mfma_f32_16x16x32_bf16 v[60:63], a[52:55], v[92:95], v[60:63]
    v_fma_f32 v167, v159, v204, v205
    v_mfma_f32_16x16x32_bf16 v[56:59], a[24:27], v[96:99], v[56:59]
    v_fma_f32 v168, v160, v206, v207
    v_fma_f32 v169, v161, v206, v207
    v_mfma_f32_16x16x32_bf16 v[60:63], a[56:59], v[96:99], v[60:63]
    v_fma_f32 v170, v162, v206, v207
    v_fma_f32 v171, v163, v206, v207
    v_mfma_f32_16x16x32_bf16 v[56:59], a[28:31], v[100:103], v[56:59]
    v_fma_f32 v164, v164, s64, v176
    v_mfma_f32_16x16x32_bf16 v[60:63], a[60:63], v[100:103], v[60:63]
    v_fma_f32 v165, v165, s65, v177
    v_fma_f32 v166, v166, s66, v178
    v_mfma_f32_16x16x32_bf16 v[60:63], a[0:3], v[104:107], v[60:63]
    v_fma_f32 v167, v167, s67, v179
    s_waitcnt lgkmcnt(12)
    v_mfma_f32_16x16x32_bf16 v[60:63], a[4:7], v[108:111], v[60:63]
    v_fma_f32 v168, v168, s64, v176
    v_fma_f32 v169, v169, s65, v177
    s_waitcnt lgkmcnt(9)
    v_mfma_f32_16x16x32_bf16 v[60:63], a[8:11], v[112:115], v[60:63]
    v_fma_f32 v170, v170, s66, v178
    v_fma_f32 v171, v171, s67, v179
    s_waitcnt lgkmcnt(7)
    v_mfma_f32_16x16x32_bf16 v[60:63], a[12:15], v[116:119], v[60:63]
    v_lshlrev_b32 v140, 16, v148
    s_waitcnt lgkmcnt(4)
    v_mfma_f32_16x16x32_bf16 v[60:63], a[16:19], v[120:123], v[60:63]
    v_and_b32 v144, 0xffff0000, v148
    v_lshlrev_b32 v141, 16, v149
    global_load_dwordx4 a[160:163], v4, s[10:11] offset:-4096 sc1
    s_waitcnt lgkmcnt(2)
    v_mfma_f32_16x16x32_bf16 v[60:63], a[20:23], v[124:127], v[60:63]
    v_and_b32 v145, 0xffff0000, v149
    v_lshlrev_b32 v142, 16, v150
    s_waitcnt lgkmcnt(1)
    v_mfma_f32_16x16x32_bf16 v[60:63], a[24:27], v[128:131], v[60:63]
    v_and_b32 v146, 0xffff0000, v150
    s_waitcnt lgkmcnt(0)
    v_mfma_f32_16x16x32_bf16 v[60:63], a[28:31], v[132:135], v[60:63]
    v_lshlrev_b32 v143, 16, v151
    v_and_b32 v147, 0xffff0000, v151
    v_mfma_f32_16x16x32_bf16 v[64:67], a[64:67], v[72:75], v[64:67]
    v_and_b32 v172, 0xffff0000, v152
    v_and_b32 v173, 0xffff0000, v153
    global_load_dwordx4 a[164:167], v7, s[16:17] offset:-4096 sc1
    v_mfma_f32_16x16x32_bf16 v[68:71], a[96:99], v[72:75], v[68:71]
    v_and_b32 v174, 0xffff0000, v154
    v_mfma_f32_16x16x32_bf16 v[64:67], a[68:71], v[76:79], v[64:67]
    v_and_b32 v175, 0xffff0000, v155
    v_fmac_f32 v140, s56, v172
    v_mfma_f32_16x16x32_bf16 v[68:71], a[100:103], v[76:79], v[68:71]
    v_fmac_f32 v141, s57, v173
    v_fmac_f32 v142, s58, v174
    v_mfma_f32_16x16x32_bf16 v[64:67], a[72:75], v[80:83], v[64:67]
    v_fmac_f32 v143, s59, v175
    v_cvt_pk_bf16_f32 v136, v56, v57
    v_mfma_f32_16x16x32_bf16 v[68:71], a[104:107], v[80:83], v[68:71]
    v_lshlrev_b32 v172, 16, v152
    v_lshlrev_b32 v173, 16, v153
    v_cvt_pk_bf16_f32 v137, v58, v59
    global_load_dwordx4 a[168:171], v4, s[10:11] offset:-3072 sc1
    v_mfma_f32_16x16x32_bf16 v[64:67], a[76:79], v[84:87], v[64:67]
    v_lshlrev_b32 v174, 16, v154
    ds_write2_b32 v34, v136, v137 offset0:0 offset1:2
    v_mfma_f32_16x16x32_bf16 v[68:71], a[108:111], v[84:87], v[68:71]
    v_lshlrev_b32 v175, 16, v155
    v_fmac_f32 v144, s56, v172
    v_cvt_pk_bf16_f32 v138, v60, v61
    v_mfma_f32_16x16x32_bf16 v[64:67], a[80:83], v[88:91], v[64:67]
    v_fmac_f32 v145, s57, v173
    v_fmac_f32 v146, s58, v174
    v_cvt_pk_bf16_f32 v139, v62, v63
    v_mfma_f32_16x16x32_bf16 v[68:71], a[112:115], v[88:91], v[68:71]
    v_fmac_f32 v147, s59, v175
    ds_write2_b32 v34, v138, v139 offset0:128 offset1:130
    global_load_dwordx4 a[172:175], v7, s[16:17] offset:-3072 sc1
    v_mfma_f32_16x16x32_bf16 v[64:67], a[84:87], v[92:95], v[64:67]
    v_fma_f32 v156, v164, v140, v156
    v_fma_f32 v157, v165, v141, v157
    v_add_u32 v34, 4224, v34
    v_mfma_f32_16x16x32_bf16 v[68:71], a[116:119], v[92:95], v[68:71]
    v_fma_f32 v158, v166, v142, v158
    v_fma_f32 v159, v167, v143, v159
    s_waitcnt lgkmcnt(0)
    s_barrier
    v_mfma_f32_16x16x32_bf16 v[64:67], a[88:91], v[96:99], v[64:67]
    v_fma_f32 v160, v168, v144, v160
    v_mfma_f32_16x16x32_bf16 v[68:71], a[120:123], v[96:99], v[68:71]
    v_fma_f32 v161, v169, v145, v161
    v_fma_f32 v162, v170, v146, v162
    v_mfma_f32_16x16x32_bf16 v[64:67], a[92:95], v[100:103], v[64:67]
    v_fma_f32 v163, v171, v147, v163
    v_cvt_pk_bf16_f32 v188, v156, v157
    global_load_dwordx4 a[176:179], v4, s[10:11] offset:-2048 sc1
    v_mfma_f32_16x16x32_bf16 v[68:71], a[124:127], v[100:103], v[68:71]
    v_cvt_pk_bf16_f32 v189, v158, v159
    v_mfma_f32_16x16x32_bf16 v[64:67], a[32:35], v[104:107], v[64:67]
    v_cvt_pk_bf16_f32 v190, v160, v161
    v_cvt_pk_bf16_f32 v191, v162, v163
    v_mfma_f32_16x16x32_bf16 v[68:71], a[64:67], v[104:107], v[68:71]
    v_min_u32 v188, -2, v188
    v_min_u32 v189, -2, v189
    v_mfma_f32_16x16x32_bf16 v[64:67], a[36:39], v[108:111], v[64:67]
    v_min_u32 v190, -2, v190
    global_load_dwordx4 a[180:183], v7, s[16:17] offset:-2048 sc1
    v_mfma_f32_16x16x32_bf16 v[68:71], a[68:71], v[108:111], v[68:71]
    v_min_u32 v191, -2, v191
    global_store_dwordx4 v37, v[188:191], s[38:39] sc1
    v_mfma_f32_16x16x32_bf16 v[64:67], a[40:43], v[112:115], v[64:67]
    v_add_u32 v37, 655360, v37
    ds_read_b128 v[72:75], v32 offset:512
    v_mfma_f32_16x16x32_bf16 v[68:71], a[72:75], v[112:115], v[68:71]
    ds_read_b128 v[76:79], v32 offset:576
    v_mfma_f32_16x16x32_bf16 v[64:67], a[44:47], v[116:119], v[64:67]
    ds_read_b128 v[80:83], v32 offset:640
    v_mfma_f32_16x16x32_bf16 v[68:71], a[76:79], v[116:119], v[68:71]
    global_load_dwordx4 a[184:187], v4, s[10:11] offset:-1024 sc1
    ds_read_b128 v[84:87], v32 offset:704
    v_mfma_f32_16x16x32_bf16 v[64:67], a[48:51], v[120:123], v[64:67]
    ds_read_b128 v[88:91], v32 offset:768
    v_mfma_f32_16x16x32_bf16 v[68:71], a[80:83], v[120:123], v[68:71]
    ds_read_b128 v[92:95], v32 offset:832
    v_mfma_f32_16x16x32_bf16 v[64:67], a[52:55], v[124:127], v[64:67]
    ds_read_b128 v[96:99], v32 offset:896
    v_mfma_f32_16x16x32_bf16 v[68:71], a[84:87], v[124:127], v[68:71]
    global_load_dwordx4 a[188:191], v7, s[16:17] offset:-1024 sc1
    ds_read_b128 v[100:103], v32 offset:960
    v_mfma_f32_16x16x32_bf16 v[64:67], a[56:59], v[128:131], v[64:67]
    v_mfma_f32_16x16x32_bf16 v[68:71], a[88:91], v[128:131], v[68:71]
    v_mfma_f32_16x16x32_bf16 v[64:67], a[60:63], v[132:135], v[64:67]
    v_mfma_f32_16x16x32_bf16 v[68:71], a[92:95], v[132:135], v[68:71]
    v_min_u32 v29, 624, v4
    v_add_u32 v29, 98560, v29
    global_load_dwordx4 v[200:203], v29, s[38:39] sc1
    global_load_dwordx4 a[128:131], v4, s[8:9] offset:0 sc1
    ds_read_b128 v[104:107], v32 offset:0
    ds_read_b128 v[108:111], v32 offset:64
    ds_read_b128 v[112:115], v32 offset:128
    ds_read_b128 v[116:119], v32 offset:192
    ds_read_b128 v[120:123], v32 offset:256
    ds_read_b128 v[124:127], v32 offset:320
    ds_read_b128 v[128:131], v32 offset:384
    ds_read_b128 v[132:135], v32 offset:448
    ds_read_b32 v148, v35 offset:8448
    ds_read_b32 v149, v35 offset:9504
    ds_read_b32 v150, v35 offset:10560
    global_load_dwordx4 a[132:135], v7, s[14:15] offset:0 sc1
    ds_read_b32 v151, v35 offset:11616
    ds_read_b32 v152, v33 offset:1024
    ds_read_b32 v153, v33 offset:10304
    ds_read_b32 v154, v33 offset:19584
    ds_read_b32 v155, v33 offset:28864
    v_lshlrev_b32 v156, 16, v192
    v_and_b32 v157, 0xffff0000, v192
    v_lshlrev_b32 v158, 16, v193
    v_and_b32 v159, 0xffff0000, v193
    v_lshlrev_b32 v160, 16, v194
    v_and_b32 v161, 0xffff0000, v194
    global_load_dwordx4 a[136:139], v4, s[8:9] offset:1024 sc1
    v_lshlrev_b32 v162, 16, v195
    v_and_b32 v163, 0xffff0000, v195
    v_pk_fma_f32 v[164:165], v[208:209], v[156:157], v[208:209] op_sel:[0,0,1] op_sel_hi:[0,1,1]
    v_pk_fma_f32 v[166:167], v[208:209], v[158:159], v[208:209] op_sel:[0,0,1] op_sel_hi:[0,1,1]
    v_pk_fma_f32 v[168:169], v[210:211], v[160:161], v[210:211] op_sel:[0,0,1] op_sel_hi:[0,1,1]
    v_pk_fma_f32 v[170:171], v[210:211], v[162:163], v[210:211] op_sel:[0,0,1] op_sel_hi:[0,1,1]
    v_pk_fma_f32 v[164:165], v[164:165], s[64:65], v[176:177] op_sel:[0,0,0] op_sel_hi:[1,1,1]
    v_pk_fma_f32 v[166:167], v[166:167], s[66:67], v[178:179] op_sel:[0,0,0] op_sel_hi:[1,1,1]
    v_pk_fma_f32 v[168:169], v[168:169], s[64:65], v[176:177] op_sel:[0,0,0] op_sel_hi:[1,1,1]
    v_pk_fma_f32 v[170:171], v[170:171], s[66:67], v[178:179] op_sel:[0,0,0] op_sel_hi:[1,1,1]
    s_waitcnt lgkmcnt(7)
    v_lshlrev_b32 v140, 16, v148
    global_load_dwordx4 a[140:143], v7, s[14:15] offset:1024 sc1
    v_and_b32 v144, 0xffff0000, v148
    s_waitcnt lgkmcnt(6)
    v_lshlrev_b32 v141, 16, v149
    v_and_b32 v145, 0xffff0000, v149
    s_waitcnt lgkmcnt(5)
    v_lshlrev_b32 v142, 16, v150
    v_and_b32 v146, 0xffff0000, v150
    s_waitcnt lgkmcnt(4)
    v_lshlrev_b32 v143, 16, v151
    v_and_b32 v147, 0xffff0000, v151
    s_waitcnt lgkmcnt(3)
    v_dot2_f32_bf16 v140, v152, s56, v140
    s_waitcnt lgkmcnt(2)
    v_dot2_f32_bf16 v141, v153, s57, v141
    s_waitcnt lgkmcnt(1)
    v_dot2_f32_bf16 v142, v154, s58, v142
    s_waitcnt lgkmcnt(0)
    v_dot2_f32_bf16 v143, v155, s59, v143
    global_load_dwordx4 a[144:147], v4, s[8:9] offset:2048 sc1
    v_dot2_f32_bf16 v144, v152, s60, v144
    v_dot2_f32_bf16 v145, v153, s61, v145
    v_dot2_f32_bf16 v146, v154, s62, v146
    v_dot2_f32_bf16 v147, v155, s63, v147
    v_pk_fma_f32 v[156:157], v[164:165], v[140:141], v[156:157] op_sel:[0,0,0] op_sel_hi:[1,1,1]
    v_pk_fma_f32 v[158:159], v[166:167], v[142:143], v[158:159] op_sel:[0,0,0] op_sel_hi:[1,1,1]
    v_pk_fma_f32 v[160:161], v[168:169], v[144:145], v[160:161] op_sel:[0,0,0] op_sel_hi:[1,1,1]
    v_pk_fma_f32 v[162:163], v[170:171], v[146:147], v[162:163] op_sel:[0,0,0] op_sel_hi:[1,1,1]
    v_cvt_pk_bf16_f32 v192, v156, v157
    v_cvt_pk_bf16_f32 v193, v158, v159
    v_cvt_pk_bf16_f32 v194, v160, v161
    global_load_dwordx4 a[148:151], v7, s[14:15] offset:2048 sc1
    v_cvt_pk_bf16_f32 v195, v162, v163
    v_min_u32 v192, -2, v192
    v_min_u32 v193, -2, v193
    v_min_u32 v194, -2, v194
    v_min_u32 v195, -2, v195
    global_store_dwordx4 v37, v[192:195], s[38:39] sc1
    v_add_u32 v37, 655360, v37
    v_mfma_f32_16x16x32_bf16 v[64:67], a[0:3], v[72:75], v[64:67]
    v_mfma_f32_16x16x32_bf16 v[68:71], a[32:35], v[72:75], v[68:71]
    v_mfma_f32_16x16x32_bf16 v[64:67], a[4:7], v[76:79], v[64:67]
    v_mfma_f32_16x16x32_bf16 v[68:71], a[36:39], v[76:79], v[68:71]
    global_load_dwordx4 a[152:155], v4, s[8:9] offset:3072 sc1
    v_mfma_f32_16x16x32_bf16 v[64:67], a[8:11], v[80:83], v[64:67]
    v_mfma_f32_16x16x32_bf16 v[68:71], a[40:43], v[80:83], v[68:71]
    v_mfma_f32_16x16x32_bf16 v[64:67], a[12:15], v[84:87], v[64:67]
    v_mfma_f32_16x16x32_bf16 v[68:71], a[44:47], v[84:87], v[68:71]
    v_mfma_f32_16x16x32_bf16 v[64:67], a[16:19], v[88:91], v[64:67]
    v_mfma_f32_16x16x32_bf16 v[68:71], a[48:51], v[88:91], v[68:71]
    v_mfma_f32_16x16x32_bf16 v[64:67], a[20:23], v[92:95], v[64:67]
    v_mfma_f32_16x16x32_bf16 v[68:71], a[52:55], v[92:95], v[68:71]
    v_mfma_f32_16x16x32_bf16 v[64:67], a[24:27], v[96:99], v[64:67]
    v_mfma_f32_16x16x32_bf16 v[68:71], a[56:59], v[96:99], v[68:71]
    v_mfma_f32_16x16x32_bf16 v[64:67], a[28:31], v[100:103], v[64:67]
    global_load_dwordx4 a[156:159], v7, s[14:15] offset:3072 sc1
    v_mfma_f32_16x16x32_bf16 v[68:71], a[60:63], v[100:103], v[68:71]
    v_mfma_f32_16x16x32_bf16 v[68:71], a[0:3], v[104:107], v[68:71]
    v_mfma_f32_16x16x32_bf16 v[68:71], a[4:7], v[108:111], v[68:71]
    v_mfma_f32_16x16x32_bf16 v[68:71], a[8:11], v[112:115], v[68:71]
    v_mfma_f32_16x16x32_bf16 v[68:71], a[12:15], v[116:119], v[68:71]
    v_mfma_f32_16x16x32_bf16 v[68:71], a[16:19], v[120:123], v[68:71]
    v_mfma_f32_16x16x32_bf16 v[68:71], a[20:23], v[124:127], v[68:71]
    v_mfma_f32_16x16x32_bf16 v[68:71], a[24:27], v[128:131], v[68:71]
    v_mfma_f32_16x16x32_bf16 v[68:71], a[28:31], v[132:135], v[68:71]
    v_cvt_pk_bf16_f32 v136, v64, v65
    v_cvt_pk_bf16_f32 v137, v66, v67
    ds_write2_b32 v34, v136, v137 offset0:0 offset1:2
    s_nop 4
    v_cvt_pk_bf16_f32 v138, v68, v69
    v_cvt_pk_bf16_f32 v139, v70, v71
    ds_write2_b32 v34, v138, v139 offset0:128 offset1:130
    s_waitcnt lgkmcnt(0)
    s_barrier
    ds_read_b32 v148, v35 offset:12672
    ds_read_b32 v149, v35 offset:13728
    ds_read_b32 v150, v35 offset:14784
    ds_read_b32 v151, v35 offset:15840
    ds_read_b32 v152, v33 offset:0
    ds_read_b32 v153, v33 offset:9280
    ds_read_b32 v154, v33 offset:18560
    ds_read_b32 v155, v33 offset:27840
    v_lshlrev_b32 v156, 16, v196
    v_and_b32 v157, 0xffff0000, v196
    v_lshlrev_b32 v158, 16, v197
    v_and_b32 v159, 0xffff0000, v197
    v_lshlrev_b32 v160, 16, v198
    v_and_b32 v161, 0xffff0000, v198
    v_lshlrev_b32 v162, 16, v199
    v_and_b32 v163, 0xffff0000, v199
    v_pk_fma_f32 v[164:165], v[212:213], v[156:157], v[212:213] op_sel:[0,0,1] op_sel_hi:[0,1,1]
    v_pk_fma_f32 v[166:167], v[212:213], v[158:159], v[212:213] op_sel:[0,0,1] op_sel_hi:[0,1,1]
    v_pk_fma_f32 v[168:169], v[214:215], v[160:161], v[214:215] op_sel:[0,0,1] op_sel_hi:[0,1,1]
    v_pk_fma_f32 v[170:171], v[214:215], v[162:163], v[214:215] op_sel:[0,0,1] op_sel_hi:[0,1,1]
    v_pk_fma_f32 v[164:165], v[164:165], s[64:65], v[176:177] op_sel:[0,0,0] op_sel_hi:[1,1,1]
    v_pk_fma_f32 v[166:167], v[166:167], s[66:67], v[178:179] op_sel:[0,0,0] op_sel_hi:[1,1,1]
    v_pk_fma_f32 v[168:169], v[168:169], s[64:65], v[176:177] op_sel:[0,0,0] op_sel_hi:[1,1,1]
    v_pk_fma_f32 v[170:171], v[170:171], s[66:67], v[178:179] op_sel:[0,0,0] op_sel_hi:[1,1,1]
    s_waitcnt lgkmcnt(7)
    v_lshlrev_b32 v140, 16, v148
    v_and_b32 v144, 0xffff0000, v148
    s_waitcnt lgkmcnt(6)
    v_lshlrev_b32 v141, 16, v149
    v_and_b32 v145, 0xffff0000, v149
    s_waitcnt lgkmcnt(5)
    v_lshlrev_b32 v142, 16, v150
    v_and_b32 v146, 0xffff0000, v150
    s_waitcnt lgkmcnt(4)
    v_lshlrev_b32 v143, 16, v151
    v_and_b32 v147, 0xffff0000, v151
    s_waitcnt lgkmcnt(3)
    v_dot2_f32_bf16 v140, v152, s56, v140
    s_waitcnt lgkmcnt(2)
    v_dot2_f32_bf16 v141, v153, s57, v141
    s_waitcnt lgkmcnt(1)
    v_dot2_f32_bf16 v142, v154, s58, v142
    s_waitcnt lgkmcnt(0)
    v_dot2_f32_bf16 v143, v155, s59, v143
    v_dot2_f32_bf16 v144, v152, s60, v144
    v_dot2_f32_bf16 v145, v153, s61, v145
    v_dot2_f32_bf16 v146, v154, s62, v146
    v_dot2_f32_bf16 v147, v155, s63, v147
    v_pk_fma_f32 v[156:157], v[164:165], v[140:141], v[156:157] op_sel:[0,0,0] op_sel_hi:[1,1,1]
    v_pk_fma_f32 v[158:159], v[166:167], v[142:143], v[158:159] op_sel:[0,0,0] op_sel_hi:[1,1,1]
    v_pk_fma_f32 v[160:161], v[168:169], v[144:145], v[160:161] op_sel:[0,0,0] op_sel_hi:[1,1,1]
    v_pk_fma_f32 v[162:163], v[170:171], v[146:147], v[162:163] op_sel:[0,0,0] op_sel_hi:[1,1,1]
    v_cvt_pk_bf16_f32 v196, v156, v157
    v_cvt_pk_bf16_f32 v197, v158, v159
    v_cvt_pk_bf16_f32 v198, v160, v161
    v_cvt_pk_bf16_f32 v199, v162, v163
    v_min_u32 v196, -2, v196
    v_min_u32 v197, -2, v197
    v_min_u32 v198, -2, v198
    v_min_u32 v199, -2, v199
    global_store_dwordx4 v37, v[196:199], s[38:39] sc1
    v_add_f32 v8, v8, v216
    v_add_f32 v9, v9, v217
    v_add_f32 v10, v10, v218
    v_add_f32 v11, v11, v219
    v_add_f32 v12, v12, v220
    v_add_f32 v13, v13, v221
    v_add_f32 v14, v14, v222
    v_add_f32 v15, v15, v223
    v_add_f32 v16, v16, v224
    v_add_f32 v17, v17, v225
    v_add_f32 v18, v18, v226
    v_add_f32 v19, v19, v227
    v_add_f32 v20, v20, v228
    v_add_f32 v21, v21, v229
    v_add_f32 v22, v22, v230
    v_add_f32 v23, v23, v231
    v_add_f32 v24, v24, v232
    v_add_f32 v25, v25, v233
    v_add_f32 v26, v26, v234
    v_add_f32 v27, v27, v235
    s_waitcnt vmcnt(10)
    v_max_u32 v236, v200, v201
    v_max3_u32 v236, v202, v203, v236
    v_cmp_eq_u32 vcc, -1, v236
    s_nop 0
    s_cbranch_vccnz Lxf_r
Lxf_ok:
Ljoin:
    global_load_dwordx4 a[96:99], v4, s[8:9] offset:-4096 sc1
    s_mul_i32 s4, s43, 43
    s_lshr_b32 s4, s4, 7
    s_mul_i32 s4, s4, 3
    s_sub_u32 s4, s43, s4
    s_lshl_b32 s5, s3, 1
    s_add_u32 s6, s5, 0
    s_and_b32 s6, s6, 7
    s_lshl_b32 s7, s4, 3
    s_add_u32 s44, s6, s7
    s_add_u32 s6, s5, 1
    s_and_b32 s6, s6, 7
    s_lshl_b32 s7, s4, 3
    s_add_u32 s45, s6, s7
    global_load_dwordx4 a[100:103], v7, s[14:15] offset:-4096 sc1
    s_add_u32 s4, s4, 1
    s_cmp_eq_u32 s4, 3
    s_cselect_b32 s4, 0, s4
    s_add_u32 s6, s5, 0
    s_and_b32 s6, s6, 7
    s_lshl_b32 s7, s4, 3
    s_add_u32 s46, s6, s7
    s_add_u32 s6, s5, 1
    s_and_b32 s6, s6, 7
    s_lshl_b32 s7, s4, 3
    s_add_u32 s47, s6, s7
    s_add_u32 s4, s4, 1
    s_cmp_eq_u32 s4, 3
    global_load_dwordx4 a[104:107], v4, s[8:9] offset:-3072 sc1
    s_cselect_b32 s4, 0, s4
    s_add_u32 s6, s5, 0
    s_and_b32 s6, s6, 7
    s_lshl_b32 s7, s4, 3
    s_add_u32 s48, s6, s7
    s_add_u32 s6, s5, 1
    s_and_b32 s6, s6, 7
    s_lshl_b32 s7, s4, 3
    s_add_u32 s49, s6, s7
    s_mov_b32 s4, 3
    s_add_u32 s6, s5, 0
    s_and_b32 s6, s6, 7
    s_lshl_b32 s7, s4, 3
    s_add_u32 s50, s6, s7
    global_load_dwordx4 a[108:111], v7, s[14:15] offset:-3072 sc1
    s_add_u32 s6, s5, 1
    s_and_b32 s6, s6, 7
    s_lshl_b32 s7, s4, 3
    s_add_u32 s51, s6, s7
    s_mul_i32 s4, s41, 458752
    s_add_u32 s4, s4, 12582912
    s_lshl_b32 s5, s40, 18
    s_mul_i32 s6, s44, 14336
    s_add_u32 s6, s6, s4
    s_add_u32 s52, s38, s6
    s_addc_u32 s53, s39, 0
    s_lshl_b32 s6, s44, 7
    s_add_u32 s6, s6, s5
    global_load_dwordx4 a[112:115], v4, s[8:9] offset:-2048 sc1
    s_add_u32 s68, s24, s6
    s_addc_u32 s69, s25, 0
    s_mul_i32 s6, s45, 14336
    s_add_u32 s6, s6, s4
    s_add_u32 s54, s38, s6
    s_addc_u32 s55, s39, 0
    s_lshl_b32 s6, s45, 7
    s_add_u32 s6, s6, s5
    s_add_u32 s70, s24, s6
    s_addc_u32 s71, s25, 0
    s_mul_i32 s6, s46, 14336
    s_add_u32 s6, s6, s4
    s_add_u32 s56, s38, s6
    global_load_dwordx4 a[116:119], v7, s[14:15] offset:-2048 sc1
    s_addc_u32 s57, s39, 0
    s_lshl_b32 s6, s46, 7
    s_add_u32 s6, s6, s5
    s_add_u32 s72, s24, s6
    s_addc_u32 s73, s25, 0
    s_mul_i32 s6, s47, 14336
    s_add_u32 s6, s6, s4
    s_add_u32 s58, s38, s6
    s_addc_u32 s59, s39, 0
    s_lshl_b32 s6, s47, 7
    s_add_u32 s6, s6, s5
    s_add_u32 s74, s24, s6
    s_addc_u32 s75, s25, 0
    s_mul_i32 s6, s48, 14336
    global_load_dwordx4 a[120:123], v4, s[8:9] offset:-1024 sc1
    s_add_u32 s6, s6, s4
    s_add_u32 s60, s38, s6
    s_addc_u32 s61, s39, 0
    s_lshl_b32 s6, s48, 7
    s_add_u32 s6, s6, s5
    s_add_u32 s76, s24, s6
    s_addc_u32 s77, s25, 0
    s_mul_i32 s6, s49, 14336
    s_add_u32 s6, s6, s4
    s_add_u32 s62, s38, s6
    s_addc_u32 s63, s39, 0
    s_lshl_b32 s6, s49, 7
    s_add_u32 s6, s6, s5
    global_load_dwordx4 a[124:127], v7, s[14:15] offset:-1024 sc1
    s_add_u32 s78, s24, s6
    s_addc_u32 s79, s25, 0
    s_mul_i32 s6, s50, 14336
    s_add_u32 s6, s6, s4
    s_add_u32 s64, s38, s6
    s_addc_u32 s65, s39, 0
    s_lshl_b32 s6, s50, 7
    s_add_u32 s6, s6, s5
    s_add_u32 s80, s24, s6
    s_addc_u32 s81, s25, 0
    s_mul_i32 s6, s51, 14336
    s_add_u32 s6, s6, s4
    s_add_u32 s66, s38, s6
    s_addc_u32 s67, s39, 0
    s_lshl_b32 s6, s51, 7
    s_add_u32 s6, s6, s5
    s_add_u32 s82, s24, s6
    s_addc_u32 s83, s25, 0
    s_mov_b32 s84, 0xc0135761
    s_mov_b32 s85, 0xbdd2d3e8
    s_cmp_eq_u32 s3, 3
    s_cselect_b64 s[86:87], 0, -1
    s_lshl_b32 s88, s3, 9
    s_lshl_b32 s89, s3, 14
    s_add_u32 s89, s89, 83200
    v_lshlrev_b32 v30, 3, v1
    v_and_b32 v28, 7, v1
    v_lshl_add_u32 v28, v3, 3, v28
    v_bfe_u32 v29, v1, 3, 1
    v_lshlrev_b32 v66, 9, v29
    v_lshl_add_u32 v66, v28, 4, v66
    s_mul_i32 s4, s3, 20480
    s_mul_i32 s5, s40, 81920
    s_add_u32 s4, s4, s5
    s_add_u32 s4, s4, 4194304
    v_add_u32 v66, s4, v66
    v_lshl_add_u32 v70, v28, 1, v29
    v_lshrrev_b32 v28, 5, v1
    v_bfe_u32 v68, v1, 1, 1
    v_lshl_add_u32 v28, v28, 1, v68
    v_mul_u32_u24 v68, 1040, v28
    v_lshl_add_u32 v68, v29, 3, v68
    v_bfe_u32 v28, v1, 2, 1
    v_lshl_add_u32 v68, v28, 6, v68
    v_bfe_u32 v28, v1, 4, 1
    v_lshl_add_u32 v68, v28, 7, v68
    v_bfe_u32 v28, v1, 0, 1
    v_lshl_add_u32 v68, v28, 5, v68
    s_mul_i32 s5, s3, 20800
    v_add_u32 v68, s5, v68
    v_min_u32 v28, 39, v1
    v_lshl_add_u32 v72, v28, 9, s4
    v_lshrrev_b32 v28, 3, v1
    v_lshlrev_b32 v28, 12, v28
    v_bfe_u32 v29, v1, 4, 1
    v_xor_b32 v29, v29, v1
    v_and_b32 v29, 7, v29
    v_xor_b32 v76, 0, v29
    v_lshl_add_u32 v76, v76, 4, v28
    v_add_u32 v80, 131072, v76
    v_xor_b32 v77, 2, v29
    v_lshl_add_u32 v77, v77, 4, v28
    v_add_u32 v77, 32768, v77
    v_add_u32 v81, 131072, v77
    v_xor_b32 v78, 4, v29
    v_lshl_add_u32 v78, v78, 4, v28
    v_add_u32 v78, 65536, v78
    v_add_u32 v82, 131072, v78
    v_xor_b32 v79, 6, v29
    v_lshl_add_u32 v79, v79, 4, v28
    v_add_u32 v79, 98304, v79
    v_add_u32 v83, 131072, v79
    v_lshrrev_b32 v29, 1, v2
    v_xor_b32 v29, v29, v3
    v_lshlrev_b32 v29, 4, v29
    v_lshl_add_u32 v29, v5, 7, v29
    s_xor_b32 s4, s3, 0
    s_lshr_b32 s5, s4, 1
    s_lshl_b32 s5, s5, 12
    s_and_b32 s4, s4, 1
    s_lshl_b32 s4, s4, 9
    s_add_u32 s4, s4, s5
    s_add_u32 s4, s4, s89
    v_add_u32 v84, s4, v29
    v_xor_b32 v85, 64, v84
    s_xor_b32 s4, s3, 1
    s_lshr_b32 s5, s4, 1
    s_lshl_b32 s5, s5, 12
    s_and_b32 s4, s4, 1
    s_lshl_b32 s4, s4, 9
    s_add_u32 s4, s4, s5
    s_add_u32 s4, s4, s89
    v_add_u32 v86, s4, v29
    v_xor_b32 v87, 64, v86
    s_xor_b32 s4, s3, 2
    s_lshr_b32 s5, s4, 1
    s_lshl_b32 s5, s5, 12
    s_and_b32 s4, s4, 1
    s_lshl_b32 s4, s4, 9
    s_add_u32 s4, s4, s5
    s_add_u32 s4, s4, s89
    v_add_u32 v88, s4, v29
    v_xor_b32 v89, 64, v88
    s_xor_b32 s4, s3, 3
    s_lshr_b32 s5, s4, 1
    s_lshl_b32 s5, s5, 12
    s_and_b32 s4, s4, 1
    s_lshl_b32 s4, s4, 9
    s_add_u32 s4, s4, s5
    s_add_u32 s4, s4, s89
    v_add_u32 v90, s4, v29
    v_xor_b32 v91, 64, v90
    s_lshr_b32 s5, s3, 1
    s_lshl_b32 s5, s5, 5
    s_and_b32 s4, s3, 1
    s_lshl_b32 s4, s4, 2
    s_add_u32 s4, s4, s5
    s_lshl_b32 s5, s40, 6
    s_add_u32 s90, s4, s5
    v_add_lshl_u32 v28, v5, s90, 1
    global_load_ushort v32, v28, s[26:27]
    s_add_u32 s8, s8, 1146880
    s_addc_u32 s9, s9, 0
    s_add_u32 s10, s10, 1146880
    s_addc_u32 s11, s11, 0
    s_add_u32 s12, s12, 1146880
    s_addc_u32 s13, s13, 0
    s_add_u32 s14, s14, 1146880
    s_addc_u32 s15, s15, 0
    s_add_u32 s16, s16, 1146880
    s_addc_u32 s17, s17, 0
    s_add_u32 s18, s18, 1146880
    s_addc_u32 s19, s19, 0
    s_cmp_lt_u32 s43, 5
    s_cbranch_scc1 Lx_first
Lx_redo:
    Lxp:
    global_load_dword v71, v72, s[38:39] offset:508 sc1
    s_waitcnt vmcnt(0)
    v_mov_b32 v28, v71
    v_cmp_eq_u32 vcc, -1, v28
    s_add_u32 s100, s100, 1
    s_cmp_ge_u32 s100, 262144
    s_cbranch_scc1 Lxp_x
    s_cbranch_vccnz Lxp
Lxp_x:
Lx_first:
    s_mov_b32 s7, 0x3f803f80
    v_add_u32 v67, 4096, v66
    global_load_dwordx4 v[92:95], v67, s[38:39] offset:-4096 sc1
    global_load_dwordx4 v[96:99], v67, s[38:39] offset:-3072 sc1
    global_load_dwordx4 v[100:103], v67, s[38:39] offset:-2048 sc1
    global_load_dwordx4 v[104:107], v67, s[38:39] offset:-1024 sc1
    global_load_dwordx4 v[108:111], v67, s[38:39] offset:0 sc1
    global_load_dwordx4 v[112:115], v67, s[38:39] offset:1024 sc1
    global_load_dwordx4 v[116:119], v67, s[38:39] offset:2048 sc1
    global_load_dwordx4 v[120:123], v67, s[38:39] offset:3072 sc1
    v_add_u32 v67, 8192, v67
    global_load_dwordx4 v[124:127], v67, s[38:39] offset:-4096 sc1
    global_load_dwordx4 v[128:131], v67, s[38:39] offset:-3072 sc1
    v_mov_b32 v62, 0
    v_mov_b32 v63, 0
    v_mov_b32 v64, 0
    v_mov_b32 v65, 0
    v_mov_b32 v71, 0
    global_load_dwordx4 v[132:135], v67, s[38:39] offset:-2048 sc1
    v_add_u32 v69, 0, v68
    s_waitcnt vmcnt(10)
    ds_write2_b64 v69, v[92:93], v[94:95] offset0:0 offset1:2
    v_dot2_f32_bf16 v62, v92, s7, v62
    v_dot2_f32_bf16 v63, v92, v92, v63
    v_dot2_f32_bf16 v64, v94, s7, v64
    v_dot2_f32_bf16 v65, v94, v94, v65
    v_dot2_f32_bf16 v62, v93, s7, v62
    v_dot2_f32_bf16 v63, v93, v93, v63
    v_dot2_f32_bf16 v64, v95, s7, v64
    v_dot2_f32_bf16 v65, v95, v95, v65
    global_load_dwordx4 v[136:139], v67, s[38:39] offset:-1024 sc1
    s_waitcnt vmcnt(10)
    ds_write2_b64 v69, v[96:97], v[98:99] offset0:32 offset1:34
    v_max3_u32 v71, v95, v99, v71
    v_dot2_f32_bf16 v62, v96, s7, v62
    v_dot2_f32_bf16 v63, v96, v96, v63
    v_dot2_f32_bf16 v64, v98, s7, v64
    v_dot2_f32_bf16 v65, v98, v98, v65
    v_dot2_f32_bf16 v62, v97, s7, v62
    v_dot2_f32_bf16 v63, v97, v97, v63
    v_dot2_f32_bf16 v64, v99, s7, v64
    v_dot2_f32_bf16 v65, v99, v99, v65
    global_load_dwordx4 v[140:143], v67, s[38:39] offset:0 sc1
    s_waitcnt vmcnt(10)
    ds_write2_b64 v69, v[100:101], v[102:103] offset0:64 offset1:66
    v_dot2_f32_bf16 v62, v100, s7, v62
    v_dot2_f32_bf16 v63, v100, v100, v63
    v_dot2_f32_bf16 v64, v102, s7, v64
    v_dot2_f32_bf16 v65, v102, v102, v65
    v_dot2_f32_bf16 v62, v101, s7, v62
    v_dot2_f32_bf16 v63, v101, v101, v63
    v_dot2_f32_bf16 v64, v103, s7, v64
    v_dot2_f32_bf16 v65, v103, v103, v65
    global_load_dwordx4 v[144:147], v67, s[38:39] offset:1024 sc1
    s_waitcnt vmcnt(10)
    ds_write2_b64 v69, v[104:105], v[106:107] offset0:96 offset1:98
    v_max3_u32 v71, v103, v107, v71
    v_dot2_f32_bf16 v62, v104, s7, v62
    v_dot2_f32_bf16 v63, v104, v104, v63
    v_dot2_f32_bf16 v64, v106, s7, v64
    v_dot2_f32_bf16 v65, v106, v106, v65
    v_dot2_f32_bf16 v62, v105, s7, v62
    v_dot2_f32_bf16 v63, v105, v105, v63
    v_dot2_f32_bf16 v64, v107, s7, v64
    v_dot2_f32_bf16 v65, v107, v107, v65
    global_load_dwordx4 v[148:151], v67, s[38:39] offset:2048 sc1
    v_add_u32 v69, 4160, v68
    s_waitcnt vmcnt(10)
    ds_write2_b64 v69, v[108:109], v[110:111] offset0:0 offset1:2
    v_dot2_f32_bf16 v62, v108, s7, v62
    v_dot2_f32_bf16 v63, v108, v108, v63
    v_dot2_f32_bf16 v64, v110, s7, v64
    v_dot2_f32_bf16 v65, v110, v110, v65
    v_dot2_f32_bf16 v62, v109, s7, v62
    v_dot2_f32_bf16 v63, v109, v109, v63
    v_dot2_f32_bf16 v64, v111, s7, v64
    v_dot2_f32_bf16 v65, v111, v111, v65
    global_load_dwordx4 v[152:155], v67, s[38:39] offset:3072 sc1
    v_add_u32 v67, 8192, v67
    s_waitcnt vmcnt(10)
    ds_write2_b64 v69, v[112:113], v[114:115] offset0:32 offset1:34
    v_max3_u32 v71, v111, v115, v71
    v_dot2_f32_bf16 v62, v112, s7, v62
    v_dot2_f32_bf16 v63, v112, v112, v63
    v_dot2_f32_bf16 v64, v114, s7, v64
    v_dot2_f32_bf16 v65, v114, v114, v65
    v_dot2_f32_bf16 v62, v113, s7, v62
    v_dot2_f32_bf16 v63, v113, v113, v63
    v_dot2_f32_bf16 v64, v115, s7, v64
    v_dot2_f32_bf16 v65, v115, v115, v65
    global_load_dwordx4 v[156:159], v67, s[38:39] offset:-4096 sc1
    s_waitcnt vmcnt(10)
    ds_write2_b64 v69, v[116:117], v[118:119] offset0:64 offset1:66
    v_dot2_f32_bf16 v62, v116, s7, v62
    v_dot2_f32_bf16 v63, v116, v116, v63
    v_dot2_f32_bf16 v64, v118, s7, v64
    v_dot2_f32_bf16 v65, v118, v118, v65
    v_dot2_f32_bf16 v62, v117, s7, v62
    v_dot2_f32_bf16 v63, v117, v117, v63
    v_dot2_f32_bf16 v64, v119, s7, v64
    v_dot2_f32_bf16 v65, v119, v119, v65
    global_load_dwordx4 v[160:163], v67, s[38:39] offset:-3072 sc1
    s_waitcnt vmcnt(10)
    ds_write2_b64 v69, v[120:121], v[122:123] offset0:96 offset1:98
    v_max3_u32 v71, v119, v123, v71
    v_dot2_f32_bf16 v62, v120, s7, v62
    v_dot2_f32_bf16 v63, v120, v120, v63
    v_dot2_f32_bf16 v64, v122, s7, v64
    v_dot2_f32_bf16 v65, v122, v122, v65
    v_dot2_f32_bf16 v62, v121, s7, v62
    v_dot2_f32_bf16 v63, v121, v121, v63
    v_dot2_f32_bf16 v64, v123, s7, v64
    v_dot2_f32_bf16 v65, v123, v123, v65
    global_load_dwordx4 v[164:167], v67, s[38:39] offset:-2048 sc1
    v_add_u32 v69, 8320, v68
    s_waitcnt vmcnt(10)
    ds_write2_b64 v69, v[124:125], v[126:127] offset0:0 offset1:2
    v_dot2_f32_bf16 v62, v124, s7, v62
    v_dot2_f32_bf16 v63, v124, v124, v63
    v_dot2_f32_bf16 v64, v126, s7, v64
    v_dot2_f32_bf16 v65, v126, v126, v65
    v_dot2_f32_bf16 v62, v125, s7, v62
    v_dot2_f32_bf16 v63, v125, v125, v63
    v_dot2_f32_bf16 v64, v127, s7, v64
    v_dot2_f32_bf16 v65, v127, v127, v65
    global_load_dwordx4 v[168:171], v67, s[38:39] offset:-1024 sc1
    s_waitcnt vmcnt(10)
    ds_write2_b64 v69, v[128:129], v[130:131] offset0:32 offset1:34
    v_max3_u32 v71, v127, v131, v71
    v_dot2_f32_bf16 v62, v128, s7, v62
    v_dot2_f32_bf16 v63, v128, v128, v63
    v_dot2_f32_bf16 v64, v130, s7, v64
    v_dot2_f32_bf16 v65, v130, v130, v65
    v_dot2_f32_bf16 v62, v129, s7, v62
    v_dot2_f32_bf16 v63, v129, v129, v63
    v_dot2_f32_bf16 v64, v131, s7, v64
    v_dot2_f32_bf16 v65, v131, v131, v65
    s_waitcnt vmcnt(9)
    ds_write2_b64 v69, v[132:133], v[134:135] offset0:64 offset1:66
    v_dot2_f32_bf16 v62, v132, s7, v62
    v_dot2_f32_bf16 v63, v132, v132, v63
    v_dot2_f32_bf16 v64, v134, s7, v64
    v_dot2_f32_bf16 v65, v134, v134, v65
    v_dot2_f32_bf16 v62, v133, s7, v62
    v_dot2_f32_bf16 v63, v133, v133, v63
    v_dot2_f32_bf16 v64, v135, s7, v64
    v_dot2_f32_bf16 v65, v135, v135, v65
    s_waitcnt vmcnt(8)
    ds_write2_b64 v69, v[136:137], v[138:139] offset0:96 offset1:98
    v_max3_u32 v71, v135, v139, v71
    v_dot2_f32_bf16 v62, v136, s7, v62
    v_dot2_f32_bf16 v63, v136, v136, v63
    v_dot2_f32_bf16 v64, v138, s7, v64
    v_dot2_f32_bf16 v65, v138, v138, v65
    v_dot2_f32_bf16 v62, v137, s7, v62
    v_dot2_f32_bf16 v63, v137, v137, v63
    v_dot2_f32_bf16 v64, v139, s7, v64
    v_dot2_f32_bf16 v65, v139, v139, v65
    v_add_u32 v69, 12480, v68
    s_waitcnt vmcnt(7)
    ds_write2_b64 v69, v[140:141], v[142:143] offset0:0 offset1:2
    v_dot2_f32_bf16 v62, v140, s7, v62
    v_dot2_f32_bf16 v63, v140, v140, v63
    v_dot2_f32_bf16 v64, v142, s7, v64
    v_dot2_f32_bf16 v65, v142, v142, v65
    v_dot2_f32_bf16 v62, v141, s7, v62
    v_dot2_f32_bf16 v63, v141, v141, v63
    v_dot2_f32_bf16 v64, v143, s7, v64
    v_dot2_f32_bf16 v65, v143, v143, v65
    s_waitcnt vmcnt(6)
    ds_write2_b64 v69, v[144:145], v[146:147] offset0:32 offset1:34
    v_max3_u32 v71, v143, v147, v71
    v_dot2_f32_bf16 v62, v144, s7, v62
    v_dot2_f32_bf16 v63, v144, v144, v63
    v_dot2_f32_bf16 v64, v146, s7, v64
    v_dot2_f32_bf16 v65, v146, v146, v65
    v_dot2_f32_bf16 v62, v145, s7, v62
    v_dot2_f32_bf16 v63, v145, v145, v63
    v_dot2_f32_bf16 v64, v147, s7, v64
    v_dot2_f32_bf16 v65, v147, v147, v65
    s_waitcnt vmcnt(5)
    ds_write2_b64 v69, v[148:149], v[150:151] offset0:64 offset1:66
    v_dot2_f32_bf16 v62, v148, s7, v62
    v_dot2_f32_bf16 v63, v148, v148, v63
    v_dot2_f32_bf16 v64, v150, s7, v64
    v_dot2_f32_bf16 v65, v150, v150, v65
    v_dot2_f32_bf16 v62, v149, s7, v62
    v_dot2_f32_bf16 v63, v149, v149, v63
    v_dot2_f32_bf16 v64, v151, s7, v64
    v_dot2_f32_bf16 v65, v151, v151, v65
    s_waitcnt vmcnt(4)
    ds_write2_b64 v69, v[152:153], v[154:155] offset0:96 offset1:98
    v_max3_u32 v71, v151, v155, v71
    v_dot2_f32_bf16 v62, v152, s7, v62
    v_dot2_f32_bf16 v63, v152, v152, v63
    v_dot2_f32_bf16 v64, v154, s7, v64
    v_dot2_f32_bf16 v65, v154, v154, v65
    v_dot2_f32_bf16 v62, v153, s7, v62
    v_dot2_f32_bf16 v63, v153, v153, v63
    v_dot2_f32_bf16 v64, v155, s7, v64
    v_dot2_f32_bf16 v65, v155, v155, v65
    v_add_u32 v69, 16640, v68
    s_waitcnt vmcnt(3)
    ds_write2_b64 v69, v[156:157], v[158:159] offset0:0 offset1:2
    v_dot2_f32_bf16 v62, v156, s7, v62
    v_dot2_f32_bf16 v63, v156, v156, v63
    v_dot2_f32_bf16 v64, v158, s7, v64
    v_dot2_f32_bf16 v65, v158, v158, v65
    v_dot2_f32_bf16 v62, v157, s7, v62
    v_dot2_f32_bf16 v63, v157, v157, v63
    v_dot2_f32_bf16 v64, v159, s7, v64
    v_dot2_f32_bf16 v65, v159, v159, v65
    s_waitcnt vmcnt(2)
    ds_write2_b64 v69, v[160:161], v[162:163] offset0:32 offset1:34
    v_max3_u32 v71, v159, v163, v71
    v_dot2_f32_bf16 v62, v160, s7, v62
    v_dot2_f32_bf16 v63, v160, v160, v63
    v_dot2_f32_bf16 v64, v162, s7, v64
    v_dot2_f32_bf16 v65, v162, v162, v65
    v_dot2_f32_bf16 v62, v161, s7, v62
    v_dot2_f32_bf16 v63, v161, v161, v63
    v_dot2_f32_bf16 v64, v163, s7, v64
    v_dot2_f32_bf16 v65, v163, v163, v65
    s_waitcnt vmcnt(1)
    ds_write2_b64 v69, v[164:165], v[166:167] offset0:64 offset1:66
    v_dot2_f32_bf16 v62, v164, s7, v62
    v_dot2_f32_bf16 v63, v164, v164, v63
    v_dot2_f32_bf16 v64, v166, s7, v64
    v_dot2_f32_bf16 v65, v166, v166, v65
    v_dot2_f32_bf16 v62, v165, s7, v62
    v_dot2_f32_bf16 v63, v165, v165, v63
    v_dot2_f32_bf16 v64, v167, s7, v64
    v_dot2_f32_bf16 v65, v167, v167, v65
    s_waitcnt vmcnt(0)
    ds_write2_b64 v69, v[168:169], v[170:171] offset0:96 offset1:98
    v_max3_u32 v71, v167, v171, v71
    v_dot2_f32_bf16 v62, v168, s7, v62
    v_dot2_f32_bf16 v63, v168, v168, v63
    v_dot2_f32_bf16 v64, v170, s7, v64
    v_dot2_f32_bf16 v65, v170, v170, v65
    v_dot2_f32_bf16 v62, v169, s7, v62
    v_dot2_f32_bf16 v63, v169, v169, v63
    v_dot2_f32_bf16 v64, v171, s7, v64
    v_dot2_f32_bf16 v65, v171, v171, v65
    v_cmp_eq_u32 vcc, -1, v71
    s_cmp_ge_u32 s100, 262144
    s_cbranch_scc1 Lx_go
    s_cbranch_vccnz Lx_redo
Lx_go:
    v_add_f32_dpp v172, v62, v62 row_ror:8 row_mask:0xf bank_mask:0x3
    s_nop 1
    v_add_f32_dpp v172, v64, v64 row_ror:8 row_mask:0xf bank_mask:0xc
    v_add_f32_dpp v173, v63, v63 row_ror:8 row_mask:0xf bank_mask:0x3
    s_nop 1
    v_add_f32_dpp v173, v65, v65 row_ror:8 row_mask:0xf bank_mask:0xc
    s_add_u32 s4, s88, 148736
    v_lshl_add_u32 v28, v70, 3, s4
    ds_write_b64 v28, v[172:173]
    s_waitcnt lgkmcnt(0)
    s_barrier
    v_mov_b32 v167, v4
    v_add_u32 v168, 41600, v4
    ds_read_b128 v[48:51], v167 offset:0
    ds_read_b128 v[52:55], v167 offset:1040
    ds_read_b128 v[56:59], v167 offset:2080
    ds_read_b128 v[60:63], v167 offset:3120
    ds_read_b128 v[64:67], v167 offset:4160
    s_waitcnt lgkmcnt(4)
    v_mfma_f32_16x16x32_bf16 v[180:183], v[48:51], a[96:99], 0
    global_load_dwordx4 a[0:3], v4, s[8:9] offset:-4096 sc1
    ds_read_b128 v[68:71], v167 offset:5200
    v_mfma_f32_16x16x32_bf16 v[196:199], v[48:51], a[100:103], 0
    s_waitcnt lgkmcnt(4)
    v_mfma_f32_16x16x32_bf16 v[184:187], v[52:55], a[96:99], 0
    ds_read_b128 v[48:51], v167 offset:6240
    v_mfma_f32_16x16x32_bf16 v[200:203], v[52:55], a[100:103], 0
    s_waitcnt lgkmcnt(4)
    v_mfma_f32_16x16x32_bf16 v[188:191], v[56:59], a[96:99], 0
    v_add_u32 v28, 148736, v30
    ds_read_b128 v[52:55], v167 offset:7280
    v_mfma_f32_16x16x32_bf16 v[204:207], v[56:59], a[100:103], 0
    ds_read_b64 v[172:173], v28 offset:0
    global_load_dwordx4 a[4:7], v7, s[14:15] offset:-4096 sc1
    s_waitcnt lgkmcnt(5)
    v_mfma_f32_16x16x32_bf16 v[192:195], v[60:63], a[96:99], 0
    ds_read_b128 v[56:59], v167 offset:8320
    v_mfma_f32_16x16x32_bf16 v[208:211], v[60:63], a[100:103], 0
    ds_read_b64 v[174:175], v28 offset:512
    s_waitcnt lgkmcnt(6)
    v_mfma_f32_16x16x32_bf16 v[180:183], v[64:67], a[104:107], v[180:183]
    ds_read_b128 v[60:63], v167 offset:9360
    v_mfma_f32_16x16x32_bf16 v[196:199], v[64:67], a[108:111], v[196:199]
    ds_read_b64 v[176:177], v28 offset:1024
    s_waitcnt lgkmcnt(7)
    v_mfma_f32_16x16x32_bf16 v[184:187], v[68:71], a[104:107], v[184:187]
    ds_read_b128 v[64:67], v167 offset:10400
    v_mfma_f32_16x16x32_bf16 v[200:203], v[68:71], a[108:111], v[200:203]
    ds_read_b64 v[178:179], v28 offset:1536
    global_load_dwordx4 a[8:11], v4, s[8:9] offset:-3072 sc1
    s_waitcnt lgkmcnt(8)
    v_mfma_f32_16x16x32_bf16 v[188:191], v[48:51], a[104:107], v[188:191]
    ds_read_b128 v[68:71], v167 offset:11440
    v_mfma_f32_16x16x32_bf16 v[204:207], v[48:51], a[108:111], v[204:207]
    s_add_u32 s4, s88, 150784
    v_lshl_add_u32 v164, v1, 2, s4
    s_waitcnt lgkmcnt(8)
    v_mfma_f32_16x16x32_bf16 v[192:195], v[52:55], a[104:107], v[192:195]
    ds_read_b128 v[48:51], v167 offset:12480
    v_mfma_f32_16x16x32_bf16 v[208:211], v[52:55], a[108:111], v[208:211]
    v_lshl_add_u32 v165, v3, 5, s4
    s_waitcnt lgkmcnt(7)
    v_mfma_f32_16x16x32_bf16 v[180:183], v[56:59], a[112:115], v[180:183]
    ds_read_b128 v[52:55], v167 offset:13520
    v_mfma_f32_16x16x32_bf16 v[196:199], v[56:59], a[116:119], v[196:199]
    v_lshl_add_u32 v166, v5, 2, s4
    global_load_dwordx4 a[12:15], v7, s[14:15] offset:-3072 sc1
    s_waitcnt lgkmcnt(6)
    v_mfma_f32_16x16x32_bf16 v[184:187], v[60:63], a[112:115], v[184:187]
    ds_read_b128 v[56:59], v167 offset:14560
    v_mfma_f32_16x16x32_bf16 v[200:203], v[60:63], a[116:119], v[200:203]
    v_add_f32 v172, v172, v174
    s_waitcnt lgkmcnt(5)
    v_mfma_f32_16x16x32_bf16 v[188:191], v[64:67], a[112:115], v[188:191]
    ds_read_b128 v[60:63], v167 offset:15600
    v_mfma_f32_16x16x32_bf16 v[204:207], v[64:67], a[116:119], v[204:207]
    v_add_f32 v173, v173, v175
    s_waitcnt lgkmcnt(4)
    v_mfma_f32_16x16x32_bf16 v[192:195], v[68:71], a[112:115], v[192:195]
    global_load_dwordx4 a[16:19], v4, s[8:9] offset:-2048 sc1
    ds_read_b128 v[64:67], v167 offset:16640
    v_mfma_f32_16x16x32_bf16 v[208:211], v[68:71], a[116:119], v[208:211]
    v_add_f32 v176, v176, v178
    s_waitcnt lgkmcnt(4)
    v_mfma_f32_16x16x32_bf16 v[180:183], v[48:51], a[120:123], v[180:183]
    ds_read_b128 v[68:71], v167 offset:17680
    v_mfma_f32_16x16x32_bf16 v[196:199], v[48:51], a[124:127], v[196:199]
    v_add_f32 v177, v177, v179
    s_waitcnt lgkmcnt(4)
    v_mfma_f32_16x16x32_bf16 v[184:187], v[52:55], a[120:123], v[184:187]
    ds_read_b128 v[48:51], v167 offset:18720
    v_mfma_f32_16x16x32_bf16 v[200:203], v[52:55], a[124:127], v[200:203]
    v_add_f32 v172, v172, v176
    s_waitcnt lgkmcnt(4)
    v_mfma_f32_16x16x32_bf16 v[188:191], v[56:59], a[120:123], v[188:191]
    global_load_dwordx4 a[20:23], v7, s[14:15] offset:-2048 sc1
    ds_read_b128 v[52:55], v167 offset:19760
    v_mfma_f32_16x16x32_bf16 v[204:207], v[56:59], a[124:127], v[204:207]
    v_add_f32 v173, v173, v177
    s_waitcnt lgkmcnt(4)
    v_mfma_f32_16x16x32_bf16 v[192:195], v[60:63], a[120:123], v[192:195]
    ds_read_b128 v[56:59], v167 offset:20800
    v_mfma_f32_16x16x32_bf16 v[208:211], v[60:63], a[124:127], v[208:211]
    v_mul_f32 v172, 0x3acccccd, v172
    s_waitcnt lgkmcnt(4)
    v_mfma_f32_16x16x32_bf16 v[180:183], v[64:67], a[128:131], v[180:183]
    ds_read_b128 v[60:63], v167 offset:21840
    v_mfma_f32_16x16x32_bf16 v[196:199], v[64:67], a[132:135], v[196:199]
    v_mul_f32 v173, 0x3acccccd, v173
    s_waitcnt lgkmcnt(4)
    v_mfma_f32_16x16x32_bf16 v[184:187], v[68:71], a[128:131], v[184:187]
    global_load_dwordx4 a[24:27], v4, s[8:9] offset:-1024 sc1
    ds_read_b128 v[64:67], v167 offset:22880
    v_mfma_f32_16x16x32_bf16 v[200:203], v[68:71], a[132:135], v[200:203]
    v_fma_f32 v173, -v172, v172, v173
    s_waitcnt lgkmcnt(4)
    v_mfma_f32_16x16x32_bf16 v[188:191], v[48:51], a[128:131], v[188:191]
    ds_read_b128 v[68:71], v167 offset:23920
    v_mfma_f32_16x16x32_bf16 v[204:207], v[48:51], a[132:135], v[204:207]
    v_max_f32 v173, 0, v173
    s_waitcnt lgkmcnt(4)
    v_mfma_f32_16x16x32_bf16 v[192:195], v[52:55], a[128:131], v[192:195]
    ds_read_b128 v[48:51], v167 offset:24960
    v_mfma_f32_16x16x32_bf16 v[208:211], v[52:55], a[132:135], v[208:211]
    v_add_f32 v173, 0x3727c5ac, v173
    s_waitcnt lgkmcnt(4)
    v_mfma_f32_16x16x32_bf16 v[180:183], v[56:59], a[136:139], v[180:183]
    global_load_dwordx4 a[28:31], v7, s[14:15] offset:-1024 sc1
    ds_read_b128 v[52:55], v167 offset:26000
    v_mfma_f32_16x16x32_bf16 v[196:199], v[56:59], a[140:143], v[196:199]
    v_rsq_f32 v174, v173
    s_waitcnt lgkmcnt(4)
    v_mfma_f32_16x16x32_bf16 v[184:187], v[60:63], a[136:139], v[184:187]
    ds_read_b128 v[56:59], v167 offset:27040
    v_mfma_f32_16x16x32_bf16 v[200:203], v[60:63], a[140:143], v[200:203]
    v_mul_f32_e64 v173, -v172, v174
    s_waitcnt lgkmcnt(4)
    v_mfma_f32_16x16x32_bf16 v[188:191], v[64:67], a[136:139], v[188:191]
    ds_read_b128 v[60:63], v167 offset:28080
    v_mfma_f32_16x16x32_bf16 v[204:207], v[64:67], a[140:143], v[204:207]
    v_mov_b32 v172, v174
    global_load_dwordx4 a[32:35], v4, s[8:9] offset:0 sc1
    s_waitcnt lgkmcnt(4)
    v_mfma_f32_16x16x32_bf16 v[192:195], v[68:71], a[136:139], v[192:195]
    ds_read_b128 v[64:67], v167 offset:29120
    v_mfma_f32_16x16x32_bf16 v[208:211], v[68:71], a[140:143], v[208:211]
    ds_write2st64_b32 v164, v172, v173 offset0:0 offset1:1
    s_waitcnt lgkmcnt(5)
    v_mfma_f32_16x16x32_bf16 v[180:183], v[48:51], a[144:147], v[180:183]
    ds_read_b128 v[68:71], v167 offset:30160
    v_mfma_f32_16x16x32_bf16 v[196:199], v[48:51], a[148:151], v[196:199]
    ds_read_b128 v[92:95], v165 offset:0
    s_waitcnt lgkmcnt(6)
    v_mfma_f32_16x16x32_bf16 v[184:187], v[52:55], a[144:147], v[184:187]
    ds_read_b128 v[48:51], v167 offset:31200
    v_mfma_f32_16x16x32_bf16 v[200:203], v[52:55], a[148:151], v[200:203]
    ds_read_b128 v[96:99], v165 offset:16
    global_load_dwordx4 a[36:39], v7, s[14:15] offset:0 sc1
    s_waitcnt lgkmcnt(7)
    v_mfma_f32_16x16x32_bf16 v[188:191], v[56:59], a[144:147], v[188:191]
    ds_read_b128 v[52:55], v167 offset:32240
    v_mfma_f32_16x16x32_bf16 v[204:207], v[56:59], a[148:151], v[204:207]
    ds_read_b128 v[100:103], v165 offset:128
    s_waitcnt lgkmcnt(8)
    v_mfma_f32_16x16x32_bf16 v[192:195], v[60:63], a[144:147], v[192:195]
    ds_read_b128 v[104:107], v165 offset:144
    ds_read_b128 v[56:59], v167 offset:33280
    v_mfma_f32_16x16x32_bf16 v[208:211], v[60:63], a[148:151], v[208:211]
    s_waitcnt lgkmcnt(9)
    v_mfma_f32_16x16x32_bf16 v[180:183], v[64:67], a[152:155], v[180:183]
    ds_read_b128 v[108:111], v165 offset:256
    ds_read_b128 v[60:63], v167 offset:34320
    v_mfma_f32_16x16x32_bf16 v[196:199], v[64:67], a[156:159], v[196:199]
    global_load_dwordx4 a[40:43], v4, s[8:9] offset:1024 sc1
    s_waitcnt lgkmcnt(9)
    v_mfma_f32_16x16x32_bf16 v[184:187], v[68:71], a[152:155], v[184:187]
    ds_read_b128 v[112:115], v165 offset:272
    ds_read_b128 v[64:67], v167 offset:35360
    v_mfma_f32_16x16x32_bf16 v[200:203], v[68:71], a[156:159], v[200:203]
    s_waitcnt lgkmcnt(9)
    v_mfma_f32_16x16x32_bf16 v[188:191], v[48:51], a[152:155], v[188:191]
    ds_read_b128 v[116:119], v165 offset:384
    ds_read_b128 v[68:71], v167 offset:36400
    v_mfma_f32_16x16x32_bf16 v[204:207], v[48:51], a[156:159], v[204:207]
    s_waitcnt lgkmcnt(9)
    v_mfma_f32_16x16x32_bf16 v[192:195], v[52:55], a[152:155], v[192:195]
    ds_read_b128 v[120:123], v165 offset:400
    global_load_dwordx4 a[44:47], v7, s[14:15] offset:1024 sc1
    ds_read_b128 v[48:51], v167 offset:37440
    v_mfma_f32_16x16x32_bf16 v[208:211], v[52:55], a[156:159], v[208:211]
    s_waitcnt lgkmcnt(8)
    v_mfma_f32_16x16x32_bf16 v[180:183], v[56:59], a[160:163], v[180:183]
    ds_read_b32 v156, v166 offset:0
    ds_read_b128 v[52:55], v167 offset:38480
    v_mfma_f32_16x16x32_bf16 v[196:199], v[56:59], a[164:167], v[196:199]
    s_waitcnt lgkmcnt(8)
    v_mfma_f32_16x16x32_bf16 v[184:187], v[60:63], a[160:163], v[184:187]
    ds_read_b32 v157, v166 offset:256
    ds_read_b128 v[56:59], v167 offset:39520
    v_mfma_f32_16x16x32_bf16 v[200:203], v[60:63], a[164:167], v[200:203]
    s_waitcnt lgkmcnt(8)
    v_mfma_f32_16x16x32_bf16 v[188:191], v[64:67], a[160:163], v[188:191]
    ds_read_b32 v158, v166 offset:16
    global_load_dwordx4 a[48:51], v4, s[8:9] offset:2048 sc1
    ds_read_b128 v[60:63], v167 offset:40560
    v_mfma_f32_16x16x32_bf16 v[204:207], v[64:67], a[164:167], v[204:207]
    s_waitcnt lgkmcnt(8)
    v_mfma_f32_16x16x32_bf16 v[192:195], v[68:71], a[160:163], v[192:195]
    ds_read_b32 v159, v166 offset:272
    ds_read_b128 v[64:67], v168 offset:0
    v_mfma_f32_16x16x32_bf16 v[208:211], v[68:71], a[164:167], v[208:211]
    s_waitcnt lgkmcnt(8)
    v_mfma_f32_16x16x32_bf16 v[180:183], v[48:51], a[168:171], v[180:183]
    ds_read_b32 v160, v166 offset:128
    ds_read_b128 v[68:71], v168 offset:1040
    v_mfma_f32_16x16x32_bf16 v[196:199], v[48:51], a[172:175], v[196:199]
    s_waitcnt lgkmcnt(8)
    v_mfma_f32_16x16x32_bf16 v[184:187], v[52:55], a[168:171], v[184:187]
    ds_read_b32 v161, v166 offset:384
    global_load_dwordx4 a[52:55], v7, s[14:15] offset:2048 sc1
    ds_read_b128 v[48:51], v168 offset:2080
    v_mfma_f32_16x16x32_bf16 v[200:203], v[52:55], a[172:175], v[200:203]
    s_waitcnt lgkmcnt(8)
    v_mfma_f32_16x16x32_bf16 v[188:191], v[56:59], a[168:171], v[188:191]
    ds_read_b32 v162, v166 offset:144
    ds_read_b128 v[52:55], v168 offset:3120
    v_mfma_f32_16x16x32_bf16 v[204:207], v[56:59], a[172:175], v[204:207]
    s_waitcnt lgkmcnt(8)
    v_mfma_f32_16x16x32_bf16 v[192:195], v[60:63], a[168:171], v[192:195]
    ds_read_b32 v163, v166 offset:400
    ds_read_b128 v[56:59], v168 offset:4160
    v_mfma_f32_16x16x32_bf16 v[208:211], v[60:63], a[172:175], v[208:211]
    s_waitcnt lgkmcnt(8)
    v_mfma_f32_16x16x32_bf16 v[180:183], v[64:67], a[176:179], v[180:183]
    v_fma_f32 v124, v108, v8, v9
    global_load_dwordx4 a[56:59], v4, s[8:9] offset:3072 sc1
    ds_read_b128 v[60:63], v168 offset:5200
    v_mfma_f32_16x16x32_bf16 v[196:199], v[64:67], a[180:183], v[196:199]
    s_waitcnt lgkmcnt(7)
    v_mfma_f32_16x16x32_bf16 v[184:187], v[68:71], a[176:179], v[184:187]
    v_fma_f32 v125, v109, v8, v9
    ds_read_b128 v[64:67], v168 offset:6240
    v_mfma_f32_16x16x32_bf16 v[200:203], v[68:71], a[180:183], v[200:203]
    s_waitcnt lgkmcnt(6)
    v_mfma_f32_16x16x32_bf16 v[188:191], v[48:51], a[176:179], v[188:191]
    v_fma_f32 v126, v110, v8, v9
    ds_read_b128 v[68:71], v168 offset:7280
    v_mfma_f32_16x16x32_bf16 v[204:207], v[48:51], a[180:183], v[204:207]
    global_load_dwordx4 a[60:63], v7, s[14:15] offset:3072 sc1
    s_waitcnt lgkmcnt(5)
    v_mfma_f32_16x16x32_bf16 v[192:195], v[52:55], a[176:179], v[192:195]
    v_fma_f32 v127, v111, v8, v9
    ds_read_b128 v[48:51], v168 offset:8320
    v_mfma_f32_16x16x32_bf16 v[208:211], v[52:55], a[180:183], v[208:211]
    s_waitcnt lgkmcnt(4)
    v_mfma_f32_16x16x32_bf16 v[180:183], v[56:59], a[184:187], v[180:183]
    v_fma_f32 v128, v112, v8, v9
    ds_read_b128 v[52:55], v168 offset:9360
    v_mfma_f32_16x16x32_bf16 v[196:199], v[56:59], a[188:191], v[196:199]
    s_waitcnt lgkmcnt(4)
    v_mfma_f32_16x16x32_bf16 v[184:187], v[60:63], a[184:187], v[184:187]
    v_fma_f32 v129, v113, v8, v9
    ds_read_b128 v[56:59], v168 offset:10400
    v_mfma_f32_16x16x32_bf16 v[200:203], v[60:63], a[188:191], v[200:203]
    global_load_dwordx4 a[64:67], v4, s[10:11] offset:-4096 sc1
    s_waitcnt lgkmcnt(4)
    v_mfma_f32_16x16x32_bf16 v[188:191], v[64:67], a[184:187], v[188:191]
    v_fma_f32 v130, v114, v8, v9
    ds_read_b128 v[60:63], v168 offset:11440
    v_mfma_f32_16x16x32_bf16 v[204:207], v[64:67], a[188:191], v[204:207]
    s_waitcnt lgkmcnt(4)
    v_mfma_f32_16x16x32_bf16 v[192:195], v[68:71], a[184:187], v[192:195]
    v_fma_f32 v131, v115, v8, v9
    ds_read_b128 v[64:67], v168 offset:12480
    v_mfma_f32_16x16x32_bf16 v[208:211], v[68:71], a[188:191], v[208:211]
    s_waitcnt lgkmcnt(4)
    v_mfma_f32_16x16x32_bf16 v[180:183], v[48:51], a[192:195], v[180:183]
    v_fma_f32 v132, v116, v8, v9
    ds_read_b128 v[68:71], v168 offset:13520
    v_mfma_f32_16x16x32_bf16 v[196:199], v[48:51], a[196:199], v[196:199]
    global_load_dwordx4 a[68:71], v7, s[16:17] offset:-4096 sc1
    s_waitcnt lgkmcnt(4)
    v_mfma_f32_16x16x32_bf16 v[184:187], v[52:55], a[192:195], v[184:187]
    v_fma_f32 v133, v117, v8, v9
    ds_read_b128 v[48:51], v168 offset:14560
    v_mfma_f32_16x16x32_bf16 v[200:203], v[52:55], a[196:199], v[200:203]
    s_waitcnt lgkmcnt(4)
    v_mfma_f32_16x16x32_bf16 v[188:191], v[56:59], a[192:195], v[188:191]
    v_fma_f32 v134, v118, v8, v9
    ds_read_b128 v[52:55], v168 offset:15600
    v_mfma_f32_16x16x32_bf16 v[204:207], v[56:59], a[196:199], v[204:207]
    s_waitcnt lgkmcnt(4)
    v_mfma_f32_16x16x32_bf16 v[192:195], v[60:63], a[192:195], v[192:195]
    v_fma_f32 v135, v119, v8, v9
    global_load_dwordx4 a[72:75], v4, s[10:11] offset:-3072 sc1
    ds_read_b128 v[56:59], v168 offset:16640
    v_mfma_f32_16x16x32_bf16 v[208:211], v[60:63], a[196:199], v[208:211]
    v_fma_f32 v136, v120, v8, v9
    s_waitcnt lgkmcnt(4)
    v_mfma_f32_16x16x32_bf16 v[180:183], v[64:67], a[200:203], v[180:183]
    ds_read_b128 v[60:63], v168 offset:17680
    v_mfma_f32_16x16x32_bf16 v[196:199], v[64:67], a[204:207], v[196:199]
    v_fma_f32 v137, v121, v8, v9
    s_waitcnt lgkmcnt(4)
    v_mfma_f32_16x16x32_bf16 v[184:187], v[68:71], a[200:203], v[184:187]
    ds_read_b128 v[64:67], v168 offset:18720
    v_mfma_f32_16x16x32_bf16 v[200:203], v[68:71], a[204:207], v[200:203]
    v_fma_f32 v138, v122, v8, v9
    s_waitcnt lgkmcnt(4)
    v_mfma_f32_16x16x32_bf16 v[188:191], v[48:51], a[200:203], v[188:191]
    global_load_dwordx4 a[76:79], v7, s[16:17] offset:-3072 sc1
    ds_read_b128 v[68:71], v168 offset:19760
    v_mfma_f32_16x16x32_bf16 v[204:207], v[48:51], a[204:207], v[204:207]
    v_fma_f32 v139, v123, v8, v9
    s_waitcnt lgkmcnt(4)
    v_mfma_f32_16x16x32_bf16 v[192:195], v[52:55], a[200:203], v[192:195]
    ds_read_b128 v[48:51], v168 offset:20800
    v_mfma_f32_16x16x32_bf16 v[208:211], v[52:55], a[204:207], v[208:211]
    v_fma_f32 v140, v108, v10, v11
    s_waitcnt lgkmcnt(4)
    v_mfma_f32_16x16x32_bf16 v[180:183], v[56:59], a[208:211], v[180:183]
    ds_read_b128 v[52:55], v168 offset:21840
    v_mfma_f32_16x16x32_bf16 v[196:199], v[56:59], a[212:215], v[196:199]
    v_fma_f32 v141, v109, v10, v11
    s_waitcnt lgkmcnt(4)
    v_mfma_f32_16x16x32_bf16 v[184:187], v[60:63], a[208:211], v[184:187]
    global_load_dwordx4 a[80:83], v4, s[10:11] offset:-2048 sc1
    ds_read_b128 v[56:59], v168 offset:22880
    v_mfma_f32_16x16x32_bf16 v[200:203], v[60:63], a[212:215], v[200:203]
    v_fma_f32 v142, v110, v10, v11
    s_waitcnt lgkmcnt(4)
    v_mfma_f32_16x16x32_bf16 v[188:191], v[64:67], a[208:211], v[188:191]
    ds_read_b128 v[60:63], v168 offset:23920
    v_mfma_f32_16x16x32_bf16 v[204:207], v[64:67], a[212:215], v[204:207]
    v_fma_f32 v143, v111, v10, v11
    s_waitcnt lgkmcnt(4)
    v_mfma_f32_16x16x32_bf16 v[192:195], v[68:71], a[208:211], v[192:195]
    ds_read_b128 v[64:67], v168 offset:24960
    v_mfma_f32_16x16x32_bf16 v[208:211], v[68:71], a[212:215], v[208:211]
    v_fma_f32 v144, v112, v10, v11
    s_waitcnt lgkmcnt(4)
    v_mfma_f32_16x16x32_bf16 v[180:183], v[48:51], a[216:219], v[180:183]
    global_load_dwordx4 a[84:87], v7, s[16:17] offset:-2048 sc1
    ds_read_b128 v[68:71], v168 offset:26000
    v_mfma_f32_16x16x32_bf16 v[196:199], v[48:51], a[220:223], v[196:199]
    v_fma_f32 v145, v113, v10, v11
    s_waitcnt lgkmcnt(4)
    v_mfma_f32_16x16x32_bf16 v[184:187], v[52:55], a[216:219], v[184:187]
    ds_read_b128 v[48:51], v168 offset:27040
    v_mfma_f32_16x16x32_bf16 v[200:203], v[52:55], a[220:223], v[200:203]
    v_fma_f32 v146, v114, v10, v11
    s_waitcnt lgkmcnt(4)
    v_mfma_f32_16x16x32_bf16 v[188:191], v[56:59], a[216:219], v[188:191]
    ds_read_b128 v[52:55], v168 offset:28080
    v_mfma_f32_16x16x32_bf16 v[204:207], v[56:59], a[220:223], v[204:207]
    v_fma_f32 v147, v115, v10, v11
    global_load_dwordx4 a[88:91], v4, s[10:11] offset:-1024 sc1
    s_waitcnt lgkmcnt(4)
    v_mfma_f32_16x16x32_bf16 v[192:195], v[60:63], a[216:219], v[192:195]
    ds_read_b128 v[56:59], v168 offset:29120
    v_mfma_f32_16x16x32_bf16 v[208:211], v[60:63], a[220:223], v[208:211]
    v_fma_f32 v148, v116, v10, v11
    s_waitcnt lgkmcnt(4)
    v_mfma_f32_16x16x32_bf16 v[180:183], v[64:67], a[224:227], v[180:183]
    ds_read_b128 v[60:63], v168 offset:30160
    v_mfma_f32_16x16x32_bf16 v[196:199], v[64:67], a[228:231], v[196:199]
    v_fma_f32 v149, v117, v10, v11
    s_waitcnt lgkmcnt(4)
    v_mfma_f32_16x16x32_bf16 v[184:187], v[68:71], a[224:227], v[184:187]
    ds_read_b128 v[64:67], v168 offset:31200
    v_mfma_f32_16x16x32_bf16 v[200:203], v[68:71], a[228:231], v[200:203]
    v_fma_f32 v150, v118, v10, v11
    global_load_dwordx4 a[92:95], v7, s[16:17] offset:-1024 sc1
    s_waitcnt lgkmcnt(4)
    v_mfma_f32_16x16x32_bf16 v[188:191], v[48:51], a[224:227], v[188:191]
    ds_read_b128 v[68:71], v168 offset:32240
    v_mfma_f32_16x16x32_bf16 v[204:207], v[48:51], a[228:231], v[204:207]
    v_fma_f32 v151, v119, v10, v11
    s_waitcnt lgkmcnt(4)
    v_mfma_f32_16x16x32_bf16 v[192:195], v[52:55], a[224:227], v[192:195]
    ds_read_b128 v[48:51], v168 offset:33280
    v_mfma_f32_16x16x32_bf16 v[208:211], v[52:55], a[228:231], v[208:211]
    v_fma_f32 v152, v120, v10, v11
    s_waitcnt lgkmcnt(4)
    v_mfma_f32_16x16x32_bf16 v[180:183], v[56:59], a[232:235], v[180:183]
    ds_read_b128 v[52:55], v168 offset:34320
    v_mfma_f32_16x16x32_bf16 v[196:199], v[56:59], a[236:239], v[196:199]
    v_fma_f32 v153, v121, v10, v11
    global_load_dwordx4 a[96:99], v4, s[10:11] offset:0 sc1
    s_waitcnt lgkmcnt(4)
    v_mfma_f32_16x16x32_bf16 v[184:187], v[60:63], a[232:235], v[184:187]
    ds_read_b128 v[56:59], v168 offset:35360
    v_mfma_f32_16x16x32_bf16 v[200:203], v[60:63], a[236:239], v[200:203]
    v_fma_f32 v154, v122, v10, v11
    s_waitcnt lgkmcnt(4)
    v_mfma_f32_16x16x32_bf16 v[188:191], v[64:67], a[232:235], v[188:191]
    ds_read_b128 v[60:63], v168 offset:36400
    v_mfma_f32_16x16x32_bf16 v[204:207], v[64:67], a[236:239], v[204:207]
    v_fma_f32 v155, v123, v10, v11
    s_waitcnt lgkmcnt(4)
    v_mfma_f32_16x16x32_bf16 v[192:195], v[68:71], a[232:235], v[192:195]
    global_load_dwordx4 a[100:103], v7, s[16:17] offset:0 sc1
    ds_read_b128 v[64:67], v168 offset:37440
    v_mfma_f32_16x16x32_bf16 v[208:211], v[68:71], a[236:239], v[208:211]
    v_lshlrev_b32 v32, 16, v32
    s_waitcnt lgkmcnt(4)
    v_mfma_f32_16x16x32_bf16 v[180:183], v[48:51], a[240:243], v[180:183]
    ds_read_b128 v[68:71], v168 offset:38480
    v_mfma_f32_16x16x32_bf16 v[196:199], v[48:51], a[244:247], v[196:199]
    v_mov_b32 v33, v32
    s_waitcnt lgkmcnt(4)
    v_mfma_f32_16x16x32_bf16 v[184:187], v[52:55], a[240:243], v[184:187]
    ds_read_b128 v[48:51], v168 offset:39520
    v_mfma_f32_16x16x32_bf16 v[200:203], v[52:55], a[244:247], v[200:203]
    v_mov_b32 v34, v32
    s_waitcnt lgkmcnt(4)
    v_mfma_f32_16x16x32_bf16 v[188:191], v[56:59], a[240:243], v[188:191]
    global_load_dwordx4 a[104:107], v4, s[10:11] offset:1024 sc1
    ds_read_b128 v[52:55], v168 offset:40560
    v_mfma_f32_16x16x32_bf16 v[204:207], v[56:59], a[244:247], v[204:207]
    v_mov_b32 v35, v32
    s_waitcnt lgkmcnt(4)
    v_mfma_f32_16x16x32_bf16 v[192:195], v[60:63], a[240:243], v[192:195]
    v_mfma_f32_16x16x32_bf16 v[208:211], v[60:63], a[244:247], v[208:211]
    s_waitcnt lgkmcnt(3)
    v_mfma_f32_16x16x32_bf16 v[180:183], v[64:67], a[248:251], v[180:183]
    v_mfma_f32_16x16x32_bf16 v[196:199], v[64:67], a[252:255], v[196:199]
    s_waitcnt lgkmcnt(2)
    v_mfma_f32_16x16x32_bf16 v[184:187], v[68:71], a[248:251], v[184:187]
    global_load_dwordx4 a[108:111], v7, s[16:17] offset:1024 sc1
    v_mfma_f32_16x16x32_bf16 v[200:203], v[68:71], a[252:255], v[200:203]
    s_waitcnt lgkmcnt(1)
    v_mfma_f32_16x16x32_bf16 v[188:191], v[48:51], a[248:251], v[188:191]
    v_mfma_f32_16x16x32_bf16 v[204:207], v[48:51], a[252:255], v[204:207]
    s_waitcnt lgkmcnt(0)
    v_mfma_f32_16x16x32_bf16 v[192:195], v[52:55], a[248:251], v[192:195]
    v_mfma_f32_16x16x32_bf16 v[208:211], v[52:55], a[252:255], v[208:211]
    global_load_dwordx4 a[112:115], v4, s[10:11] offset:2048 sc1
    v_pk_fma_f32 v[180:181], v[180:181], v[92:93], v[124:125] op_sel:[0,0,0] op_sel_hi:[1,1,1]
    v_pk_fma_f32 v[182:183], v[182:183], v[94:95], v[126:127] op_sel:[0,0,0] op_sel_hi:[1,1,1]
    v_pk_fma_f32 v[184:185], v[184:185], v[96:97], v[128:129] op_sel:[0,0,0] op_sel_hi:[1,1,1]
    v_pk_fma_f32 v[186:187], v[186:187], v[98:99], v[130:131] op_sel:[0,0,0] op_sel_hi:[1,1,1]
    v_pk_fma_f32 v[188:189], v[188:189], v[100:101], v[132:133] op_sel:[0,0,0] op_sel_hi:[1,1,1]
    v_pk_fma_f32 v[190:191], v[190:191], v[102:103], v[134:135] op_sel:[0,0,0] op_sel_hi:[1,1,1]
    v_pk_fma_f32 v[192:193], v[192:193], v[104:105], v[136:137] op_sel:[0,0,0] op_sel_hi:[1,1,1]
    v_pk_fma_f32 v[194:195], v[194:195], v[106:107], v[138:139] op_sel:[0,0,0] op_sel_hi:[1,1,1]
    global_load_dwordx4 a[116:119], v7, s[16:17] offset:2048 sc1
    v_pk_fma_f32 v[196:197], v[196:197], v[92:93], v[140:141] op_sel:[0,0,0] op_sel_hi:[1,1,1]
    v_pk_fma_f32 v[198:199], v[198:199], v[94:95], v[142:143] op_sel:[0,0,0] op_sel_hi:[1,1,1]
    v_pk_fma_f32 v[200:201], v[200:201], v[96:97], v[144:145] op_sel:[0,0,0] op_sel_hi:[1,1,1]
    v_pk_fma_f32 v[202:203], v[202:203], v[98:99], v[146:147] op_sel:[0,0,0] op_sel_hi:[1,1,1]
    v_pk_fma_f32 v[204:205], v[204:205], v[100:101], v[148:149] op_sel:[0,0,0] op_sel_hi:[1,1,1]
    v_pk_fma_f32 v[206:207], v[206:207], v[102:103], v[150:151] op_sel:[0,0,0] op_sel_hi:[1,1,1]
    v_pk_fma_f32 v[208:209], v[208:209], v[104:105], v[152:153] op_sel:[0,0,0] op_sel_hi:[1,1,1]
    v_pk_fma_f32 v[210:211], v[210:211], v[106:107], v[154:155] op_sel:[0,0,0] op_sel_hi:[1,1,1]
    global_load_dwordx4 a[120:123], v4, s[10:11] offset:3072 sc1
    v_pk_mul_f32 v[124:125], v[180:181], v[180:181] op_sel:[0,0] op_sel_hi:[1,1]
    v_pk_mul_f32 v[126:127], v[182:183], v[182:183] op_sel:[0,0] op_sel_hi:[1,1]
    v_pk_mul_f32 v[128:129], v[184:185], v[184:185] op_sel:[0,0] op_sel_hi:[1,1]
    v_pk_mul_f32 v[130:131], v[186:187], v[186:187] op_sel:[0,0] op_sel_hi:[1,1]
    v_pk_mul_f32 v[132:133], v[188:189], v[188:189] op_sel:[0,0] op_sel_hi:[1,1]
    v_pk_mul_f32 v[134:135], v[190:191], v[190:191] op_sel:[0,0] op_sel_hi:[1,1]
    v_pk_mul_f32 v[136:137], v[192:193], v[192:193] op_sel:[0,0] op_sel_hi:[1,1]
    v_pk_mul_f32 v[138:139], v[194:195], v[194:195] op_sel:[0,0] op_sel_hi:[1,1]
    global_load_dwordx4 a[124:127], v7, s[16:17] offset:3072 sc1
    v_pk_mul_f32 v[140:141], v[196:197], v[196:197] op_sel:[0,0] op_sel_hi:[1,1]
    v_pk_mul_f32 v[142:143], v[198:199], v[198:199] op_sel:[0,0] op_sel_hi:[1,1]
    v_pk_mul_f32 v[144:145], v[200:201], v[200:201] op_sel:[0,0] op_sel_hi:[1,1]
    v_pk_mul_f32 v[146:147], v[202:203], v[202:203] op_sel:[0,0] op_sel_hi:[1,1]
    v_pk_mul_f32 v[148:149], v[204:205], v[204:205] op_sel:[0,0] op_sel_hi:[1,1]
    v_pk_mul_f32 v[150:151], v[206:207], v[206:207] op_sel:[0,0] op_sel_hi:[1,1]
    v_pk_mul_f32 v[152:153], v[208:209], v[208:209] op_sel:[0,0] op_sel_hi:[1,1]
    v_pk_mul_f32 v[154:155], v[210:211], v[210:211] op_sel:[0,0] op_sel_hi:[1,1]
    global_load_dwordx4 a[128:131], v4, s[12:13] offset:-4096 sc1
    v_pk_fma_f32 v[124:125], v[124:125], s[84:85], s[84:85] op_sel:[0,1,0] op_sel_hi:[1,1,0]
    v_pk_fma_f32 v[126:127], v[126:127], s[84:85], s[84:85] op_sel:[0,1,0] op_sel_hi:[1,1,0]
    v_pk_fma_f32 v[128:129], v[128:129], s[84:85], s[84:85] op_sel:[0,1,0] op_sel_hi:[1,1,0]
    v_pk_fma_f32 v[130:131], v[130:131], s[84:85], s[84:85] op_sel:[0,1,0] op_sel_hi:[1,1,0]
    v_pk_fma_f32 v[132:133], v[132:133], s[84:85], s[84:85] op_sel:[0,1,0] op_sel_hi:[1,1,0]
    v_pk_fma_f32 v[134:135], v[134:135], s[84:85], s[84:85] op_sel:[0,1,0] op_sel_hi:[1,1,0]
    v_pk_fma_f32 v[136:137], v[136:137], s[84:85], s[84:85] op_sel:[0,1,0] op_sel_hi:[1,1,0]
    v_pk_fma_f32 v[138:139], v[138:139], s[84:85], s[84:85] op_sel:[0,1,0] op_sel_hi:[1,1,0]
    global_load_dwordx4 a[132:135], v7, s[18:19] offset:-4096 sc1
    v_pk_fma_f32 v[140:141], v[140:141], s[84:85], s[84:85] op_sel:[0,1,0] op_sel_hi:[1,1,0]
    v_pk_fma_f32 v[142:143], v[142:143], s[84:85], s[84:85] op_sel:[0,1,0] op_sel_hi:[1,1,0]
    v_pk_fma_f32 v[144:145], v[144:145], s[84:85], s[84:85] op_sel:[0,1,0] op_sel_hi:[1,1,0]
    v_pk_fma_f32 v[146:147], v[146:147], s[84:85], s[84:85] op_sel:[0,1,0] op_sel_hi:[1,1,0]
    v_pk_fma_f32 v[148:149], v[148:149], s[84:85], s[84:85] op_sel:[0,1,0] op_sel_hi:[1,1,0]
    v_pk_fma_f32 v[150:151], v[150:151], s[84:85], s[84:85] op_sel:[0,1,0] op_sel_hi:[1,1,0]
    v_pk_fma_f32 v[152:153], v[152:153], s[84:85], s[84:85] op_sel:[0,1,0] op_sel_hi:[1,1,0]
    v_pk_fma_f32 v[154:155], v[154:155], s[84:85], s[84:85] op_sel:[0,1,0] op_sel_hi:[1,1,0]
    v_pk_mul_f32 v[124:125], v[124:125], v[180:181] op_sel:[0,0] op_sel_hi:[1,1]
    global_load_dwordx4 a[136:139], v4, s[12:13] offset:-3072 sc1
    v_pk_mul_f32 v[126:127], v[126:127], v[182:183] op_sel:[0,0] op_sel_hi:[1,1]
    v_pk_mul_f32 v[128:129], v[128:129], v[184:185] op_sel:[0,0] op_sel_hi:[1,1]
    v_pk_mul_f32 v[130:131], v[130:131], v[186:187] op_sel:[0,0] op_sel_hi:[1,1]
    v_pk_mul_f32 v[132:133], v[132:133], v[188:189] op_sel:[0,0] op_sel_hi:[1,1]
    v_pk_mul_f32 v[134:135], v[134:135], v[190:191] op_sel:[0,0] op_sel_hi:[1,1]
    v_pk_mul_f32 v[136:137], v[136:137], v[192:193] op_sel:[0,0] op_sel_hi:[1,1]
    v_pk_mul_f32 v[138:139], v[138:139], v[194:195] op_sel:[0,0] op_sel_hi:[1,1]
    v_pk_mul_f32 v[140:141], v[140:141], v[196:197] op_sel:[0,0] op_sel_hi:[1,1]
    global_load_dwordx4 a[140:143], v7, s[18:19] offset:-3072 sc1
    v_pk_mul_f32 v[142:143], v[142:143], v[198:199] op_sel:[0,0] op_sel_hi:[1,1]
    v_pk_mul_f32 v[144:145], v[144:145], v[200:201] op_sel:[0,0] op_sel_hi:[1,1]
    v_pk_mul_f32 v[146:147], v[146:147], v[202:203] op_sel:[0,0] op_sel_hi:[1,1]
    v_pk_mul_f32 v[148:149], v[148:149], v[204:205] op_sel:[0,0] op_sel_hi:[1,1]
    v_pk_mul_f32 v[150:151], v[150:151], v[206:207] op_sel:[0,0] op_sel_hi:[1,1]
    v_pk_mul_f32 v[152:153], v[152:153], v[208:209] op_sel:[0,0] op_sel_hi:[1,1]
    v_pk_mul_f32 v[154:155], v[154:155], v[210:211] op_sel:[0,0] op_sel_hi:[1,1]
    v_exp_f32 v124, v124
    global_load_dwordx4 a[144:147], v4, s[12:13] offset:-2048 sc1
    v_exp_f32 v125, v125
    v_exp_f32 v126, v126
    v_exp_f32 v127, v127
    v_exp_f32 v128, v128
    v_exp_f32 v129, v129
    v_exp_f32 v130, v130
    v_exp_f32 v131, v131
    v_exp_f32 v132, v132
    global_load_dwordx4 a[148:151], v7, s[18:19] offset:-2048 sc1
    v_exp_f32 v133, v133
    v_exp_f32 v134, v134
    v_exp_f32 v135, v135
    v_exp_f32 v136, v136
    v_exp_f32 v137, v137
    v_exp_f32 v138, v138
    v_exp_f32 v139, v139
    v_exp_f32 v140, v140
    global_load_dwordx4 a[152:155], v4, s[12:13] offset:-1024 sc1
    v_exp_f32 v141, v141
    v_exp_f32 v142, v142
    v_exp_f32 v143, v143
    v_exp_f32 v144, v144
    v_exp_f32 v145, v145
    v_exp_f32 v146, v146
    v_exp_f32 v147, v147
    v_exp_f32 v148, v148
    global_load_dwordx4 a[156:159], v7, s[18:19] offset:-1024 sc1
    v_exp_f32 v149, v149
    v_exp_f32 v150, v150
    v_exp_f32 v151, v151
    v_exp_f32 v152, v152
    v_exp_f32 v153, v153
    v_exp_f32 v154, v154
    v_exp_f32 v155, v155
    v_pk_add_f32 v[124:125], v[124:125], 1.0 op_sel:[0,0] op_sel_hi:[1,0]
    v_pk_add_f32 v[126:127], v[126:127], 1.0 op_sel:[0,0] op_sel_hi:[1,0]
    s_add_u32 m0, s89, 0
    s_nop 0
    global_load_lds_dwordx4 v76, s[68:69]
    v_pk_add_f32 v[128:129], v[128:129], 1.0 op_sel:[0,0] op_sel_hi:[1,0]
    v_pk_add_f32 v[130:131], v[130:131], 1.0 op_sel:[0,0] op_sel_hi:[1,0]
    v_pk_add_f32 v[132:133], v[132:133], 1.0 op_sel:[0,0] op_sel_hi:[1,0]
    v_pk_add_f32 v[134:135], v[134:135], 1.0 op_sel:[0,0] op_sel_hi:[1,0]
    v_pk_add_f32 v[136:137], v[136:137], 1.0 op_sel:[0,0] op_sel_hi:[1,0]
    v_pk_add_f32 v[138:139], v[138:139], 1.0 op_sel:[0,0] op_sel_hi:[1,0]
    v_pk_add_f32 v[140:141], v[140:141], 1.0 op_sel:[0,0] op_sel_hi:[1,0]
    v_pk_add_f32 v[142:143], v[142:143], 1.0 op_sel:[0,0] op_sel_hi:[1,0]
    s_add_u32 m0, s89, 1024
    s_nop 0
    global_load_lds_dwordx4 v77, s[68:69]
    v_pk_add_f32 v[144:145], v[144:145], 1.0 op_sel:[0,0] op_sel_hi:[1,0]
    v_pk_add_f32 v[146:147], v[146:147], 1.0 op_sel:[0,0] op_sel_hi:[1,0]
    v_pk_add_f32 v[148:149], v[148:149], 1.0 op_sel:[0,0] op_sel_hi:[1,0]
    v_pk_add_f32 v[150:151], v[150:151], 1.0 op_sel:[0,0] op_sel_hi:[1,0]
    v_pk_add_f32 v[152:153], v[152:153], 1.0 op_sel:[0,0] op_sel_hi:[1,0]
    v_pk_add_f32 v[154:155], v[154:155], 1.0 op_sel:[0,0] op_sel_hi:[1,0]
    v_rcp_f32 v124, v124
    v_rcp_f32 v125, v125
    s_add_u32 m0, s89, 2048
    s_nop 0
    global_load_lds_dwordx4 v78, s[68:69]
    v_rcp_f32 v126, v126
    v_rcp_f32 v127, v127
    v_rcp_f32 v128, v128
    v_rcp_f32 v129, v129
    v_rcp_f32 v130, v130
    v_rcp_f32 v131, v131
    v_rcp_f32 v132, v132
    v_rcp_f32 v133, v133
    s_add_u32 m0, s89, 3072
    s_nop 0
    global_load_lds_dwordx4 v79, s[68:69]
    v_rcp_f32 v134, v134
    v_rcp_f32 v135, v135
    v_rcp_f32 v136, v136
    v_rcp_f32 v137, v137
    v_rcp_f32 v138, v138
    v_rcp_f32 v139, v139
    v_rcp_f32 v140, v140
    v_rcp_f32 v141, v141
    s_add_u32 m0, s89, 4096
    s_nop 0
    global_load_lds_dwordx4 v80, s[68:69]
    v_rcp_f32 v142, v142
    v_rcp_f32 v143, v143
    v_rcp_f32 v144, v144
    v_rcp_f32 v145, v145
    v_rcp_f32 v146, v146
    v_rcp_f32 v147, v147
    v_rcp_f32 v148, v148
    v_rcp_f32 v149, v149
    v_rcp_f32 v150, v150
    s_add_u32 m0, s89, 5120
    s_nop 0
    global_load_lds_dwordx4 v81, s[68:69]
    v_rcp_f32 v151, v151
    v_rcp_f32 v152, v152
    v_rcp_f32 v153, v153
    v_rcp_f32 v154, v154
    v_rcp_f32 v155, v155
    v_pk_mul_f32 v[180:181], v[180:181], v[124:125] op_sel:[0,0] op_sel_hi:[1,1]
    v_pk_mul_f32 v[182:183], v[182:183], v[126:127] op_sel:[0,0] op_sel_hi:[1,1]
    v_pk_mul_f32 v[184:185], v[184:185], v[128:129] op_sel:[0,0] op_sel_hi:[1,1]
    s_add_u32 m0, s89, 6144
    s_nop 0
    global_load_lds_dwordx4 v82, s[68:69]
    v_pk_mul_f32 v[186:187], v[186:187], v[130:131] op_sel:[0,0] op_sel_hi:[1,1]
    v_pk_mul_f32 v[188:189], v[188:189], v[132:133] op_sel:[0,0] op_sel_hi:[1,1]
    v_pk_mul_f32 v[190:191], v[190:191], v[134:135] op_sel:[0,0] op_sel_hi:[1,1]
    v_pk_mul_f32 v[192:193], v[192:193], v[136:137] op_sel:[0,0] op_sel_hi:[1,1]
    v_pk_mul_f32 v[194:195], v[194:195], v[138:139] op_sel:[0,0] op_sel_hi:[1,1]
    v_pk_mul_f32 v[196:197], v[196:197], v[140:141] op_sel:[0,0] op_sel_hi:[1,1]
    v_pk_mul_f32 v[198:199], v[198:199], v[142:143] op_sel:[0,0] op_sel_hi:[1,1]
    v_pk_mul_f32 v[200:201], v[200:201], v[144:145] op_sel:[0,0] op_sel_hi:[1,1]
    s_add_u32 m0, s89, 7168
    s_nop 0
    global_load_lds_dwordx4 v83, s[68:69]
    v_pk_mul_f32 v[202:203], v[202:203], v[146:147] op_sel:[0,0] op_sel_hi:[1,1]
    v_pk_mul_f32 v[204:205], v[204:205], v[148:149] op_sel:[0,0] op_sel_hi:[1,1]
    v_pk_mul_f32 v[206:207], v[206:207], v[150:151] op_sel:[0,0] op_sel_hi:[1,1]
    v_pk_mul_f32 v[208:209], v[208:209], v[152:153] op_sel:[0,0] op_sel_hi:[1,1]
    v_pk_mul_f32 v[210:211], v[210:211], v[154:155] op_sel:[0,0] op_sel_hi:[1,1]
    v_pk_add_f32 v[124:125], v[180:181], v[196:197] op_sel:[0,0] op_sel_hi:[1,1]
    v_pk_mul_f32 v[140:141], v[180:181], v[180:181] op_sel:[0,0] op_sel_hi:[1,1]
    v_pk_add_f32 v[126:127], v[182:183], v[198:199] op_sel:[0,0] op_sel_hi:[1,1]
    s_add_u32 m0, s89, 8192
    s_nop 0
    global_load_lds_dwordx4 v76, s[70:71]
    v_pk_mul_f32 v[142:143], v[182:183], v[182:183] op_sel:[0,0] op_sel_hi:[1,1]
    v_pk_add_f32 v[128:129], v[184:185], v[200:201] op_sel:[0,0] op_sel_hi:[1,1]
    v_pk_mul_f32 v[144:145], v[184:185], v[184:185] op_sel:[0,0] op_sel_hi:[1,1]
    v_pk_add_f32 v[130:131], v[186:187], v[202:203] op_sel:[0,0] op_sel_hi:[1,1]
    v_pk_mul_f32 v[146:147], v[186:187], v[186:187] op_sel:[0,0] op_sel_hi:[1,1]
    v_pk_add_f32 v[132:133], v[188:189], v[204:205] op_sel:[0,0] op_sel_hi:[1,1]
    v_pk_mul_f32 v[148:149], v[188:189], v[188:189] op_sel:[0,0] op_sel_hi:[1,1]
    v_pk_add_f32 v[134:135], v[190:191], v[206:207] op_sel:[0,0] op_sel_hi:[1,1]
    s_add_u32 m0, s89, 9216
    s_nop 0
    global_load_lds_dwordx4 v77, s[70:71]
    v_pk_mul_f32 v[150:151], v[190:191], v[190:191] op_sel:[0,0] op_sel_hi:[1,1]
    v_pk_add_f32 v[136:137], v[192:193], v[208:209] op_sel:[0,0] op_sel_hi:[1,1]
    v_pk_mul_f32 v[152:153], v[192:193], v[192:193] op_sel:[0,0] op_sel_hi:[1,1]
    v_pk_add_f32 v[138:139], v[194:195], v[210:211] op_sel:[0,0] op_sel_hi:[1,1]
    v_pk_mul_f32 v[154:155], v[194:195], v[194:195] op_sel:[0,0] op_sel_hi:[1,1]
    v_pk_fma_f32 v[140:141], v[196:197], v[196:197], v[140:141] op_sel:[0,0,0] op_sel_hi:[1,1,1]
    v_pk_fma_f32 v[142:143], v[198:199], v[198:199], v[142:143] op_sel:[0,0,0] op_sel_hi:[1,1,1]
    v_pk_fma_f32 v[144:145], v[200:201], v[200:201], v[144:145] op_sel:[0,0,0] op_sel_hi:[1,1,1]
    s_add_u32 m0, s89, 10240
    s_nop 0
    global_load_lds_dwordx4 v78, s[70:71]
    v_pk_fma_f32 v[146:147], v[202:203], v[202:203], v[146:147] op_sel:[0,0,0] op_sel_hi:[1,1,1]
    v_pk_fma_f32 v[148:149], v[204:205], v[204:205], v[148:149] op_sel:[0,0,0] op_sel_hi:[1,1,1]
    v_pk_fma_f32 v[150:151], v[206:207], v[206:207], v[150:151] op_sel:[0,0,0] op_sel_hi:[1,1,1]
    v_pk_fma_f32 v[152:153], v[208:209], v[208:209], v[152:153] op_sel:[0,0,0] op_sel_hi:[1,1,1]
    v_pk_fma_f32 v[154:155], v[210:211], v[210:211], v[154:155] op_sel:[0,0,0] op_sel_hi:[1,1,1]
    v_add_f32_dpp v92, v124, v124 row_ror:8 row_mask:0xf bank_mask:0x3
    v_add_f32_dpp v93, v125, v125 row_ror:8 row_mask:0xf bank_mask:0x3
    v_add_f32_dpp v94, v126, v126 row_ror:8 row_mask:0xf bank_mask:0x3
    v_add_f32_dpp v95, v127, v127 row_ror:8 row_mask:0xf bank_mask:0x3
    s_add_u32 m0, s89, 11264
    s_nop 0
    global_load_lds_dwordx4 v79, s[70:71]
    v_add_f32_dpp v96, v128, v128 row_ror:8 row_mask:0xf bank_mask:0x3
    v_add_f32_dpp v97, v129, v129 row_ror:8 row_mask:0xf bank_mask:0x3
    v_add_f32_dpp v98, v130, v130 row_ror:8 row_mask:0xf bank_mask:0x3
    v_add_f32_dpp v99, v131, v131 row_ror:8 row_mask:0xf bank_mask:0x3
    v_add_f32_dpp v100, v132, v132 row_ror:8 row_mask:0xf bank_mask:0x3
    v_add_f32_dpp v101, v133, v133 row_ror:8 row_mask:0xf bank_mask:0x3
    v_add_f32_dpp v102, v134, v134 row_ror:8 row_mask:0xf bank_mask:0x3
    v_add_f32_dpp v103, v135, v135 row_ror:8 row_mask:0xf bank_mask:0x3
    s_add_u32 m0, s89, 12288
    s_nop 0
    global_load_lds_dwordx4 v80, s[70:71]
    v_add_f32_dpp v104, v136, v136 row_ror:8 row_mask:0xf bank_mask:0x3
    v_add_f32_dpp v105, v137, v137 row_ror:8 row_mask:0xf bank_mask:0x3
    v_add_f32_dpp v106, v138, v138 row_ror:8 row_mask:0xf bank_mask:0x3
    v_add_f32_dpp v107, v139, v139 row_ror:8 row_mask:0xf bank_mask:0x3
    v_add_f32_dpp v92, v140, v140 row_ror:8 row_mask:0xf bank_mask:0xc
    v_add_f32_dpp v93, v141, v141 row_ror:8 row_mask:0xf bank_mask:0xc
    v_add_f32_dpp v94, v142, v142 row_ror:8 row_mask:0xf bank_mask:0xc
    v_add_f32_dpp v95, v143, v143 row_ror:8 row_mask:0xf bank_mask:0xc
    s_add_u32 m0, s89, 13312
    s_nop 0
    global_load_lds_dwordx4 v81, s[70:71]
    v_add_f32_dpp v96, v144, v144 row_ror:8 row_mask:0xf bank_mask:0xc
    v_add_f32_dpp v97, v145, v145 row_ror:8 row_mask:0xf bank_mask:0xc
    v_add_f32_dpp v98, v146, v146 row_ror:8 row_mask:0xf bank_mask:0xc
    v_add_f32_dpp v99, v147, v147 row_ror:8 row_mask:0xf bank_mask:0xc
    v_add_f32_dpp v100, v148, v148 row_ror:8 row_mask:0xf bank_mask:0xc
    v_add_f32_dpp v101, v149, v149 row_ror:8 row_mask:0xf bank_mask:0xc
    v_add_f32_dpp v102, v150, v150 row_ror:8 row_mask:0xf bank_mask:0xc
    v_add_f32_dpp v103, v151, v151 row_ror:8 row_mask:0xf bank_mask:0xc
    s_add_u32 m0, s89, 14336
    s_nop 0
    global_load_lds_dwordx4 v82, s[70:71]
    v_add_f32_dpp v104, v152, v152 row_ror:8 row_mask:0xf bank_mask:0xc
    v_add_f32_dpp v105, v153, v153 row_ror:8 row_mask:0xf bank_mask:0xc
    v_add_f32_dpp v106, v154, v154 row_ror:8 row_mask:0xf bank_mask:0xc
    v_add_f32_dpp v107, v155, v155 row_ror:8 row_mask:0xf bank_mask:0xc
    v_add_f32_dpp v124, v92, v92 row_half_mirror row_mask:0xf bank_mask:0x5
    v_add_f32_dpp v125, v93, v93 row_half_mirror row_mask:0xf bank_mask:0x5
    v_add_f32_dpp v126, v94, v94 row_half_mirror row_mask:0xf bank_mask:0x5
    v_add_f32_dpp v127, v95, v95 row_half_mirror row_mask:0xf bank_mask:0x5
    s_add_u32 m0, s89, 15360
    s_nop 0
    global_load_lds_dwordx4 v83, s[70:71]
    v_add_f32_dpp v128, v96, v96 row_half_mirror row_mask:0xf bank_mask:0x5
    v_add_f32_dpp v129, v97, v97 row_half_mirror row_mask:0xf bank_mask:0x5
    v_add_f32_dpp v130, v98, v98 row_half_mirror row_mask:0xf bank_mask:0x5
    v_add_f32_dpp v131, v99, v99 row_half_mirror row_mask:0xf bank_mask:0x5
    v_add_f32_dpp v124, v100, v100 row_half_mirror row_mask:0xf bank_mask:0xa
    v_add_f32_dpp v125, v101, v101 row_half_mirror row_mask:0xf bank_mask:0xa
    v_add_f32_dpp v126, v102, v102 row_half_mirror row_mask:0xf bank_mask:0xa
    v_add_f32_dpp v127, v103, v103 row_half_mirror row_mask:0xf bank_mask:0xa
    v_add_f32_dpp v128, v104, v104 row_half_mirror row_mask:0xf bank_mask:0xa
    v_add_f32_dpp v129, v105, v105 row_half_mirror row_mask:0xf bank_mask:0xa
    v_add_f32_dpp v130, v106, v106 row_half_mirror row_mask:0xf bank_mask:0xa
    v_add_f32_dpp v131, v107, v107 row_half_mirror row_mask:0xf bank_mask:0xa
    v_add_f32_dpp v124, v124, v124 quad_perm:[1,0,3,2] row_mask:0xf bank_mask:0xf
    v_add_f32_dpp v125, v125, v125 quad_perm:[1,0,3,2] row_mask:0xf bank_mask:0xf
    v_add_f32_dpp v126, v126, v126 quad_perm:[1,0,3,2] row_mask:0xf bank_mask:0xf
    v_add_f32_dpp v127, v127, v127 quad_perm:[1,0,3,2] row_mask:0xf bank_mask:0xf
    v_add_f32_dpp v128, v128, v128 quad_perm:[1,0,3,2] row_mask:0xf bank_mask:0xf
    v_add_f32_dpp v129, v129, v129 quad_perm:[1,0,3,2] row_mask:0xf bank_mask:0xf
    v_add_f32_dpp v130, v130, v130 quad_perm:[1,0,3,2] row_mask:0xf bank_mask:0xf
    v_add_f32_dpp v131, v131, v131 quad_perm:[1,0,3,2] row_mask:0xf bank_mask:0xf
    v_add_f32_dpp v124, v124, v124 quad_perm:[2,3,0,1] row_mask:0xf bank_mask:0xf
    v_add_f32_dpp v125, v125, v125 quad_perm:[2,3,0,1] row_mask:0xf bank_mask:0xf
    v_add_f32_dpp v126, v126, v126 quad_perm:[2,3,0,1] row_mask:0xf bank_mask:0xf
    v_add_f32_dpp v127, v127, v127 quad_perm:[2,3,0,1] row_mask:0xf bank_mask:0xf
    v_add_f32_dpp v128, v128, v128 quad_perm:[2,3,0,1] row_mask:0xf bank_mask:0xf
    v_add_f32_dpp v129, v129, v129 quad_perm:[2,3,0,1] row_mask:0xf bank_mask:0xf
    v_add_f32_dpp v130, v130, v130 quad_perm:[2,3,0,1] row_mask:0xf bank_mask:0xf
    v_add_f32_dpp v131, v131, v131 quad_perm:[2,3,0,1] row_mask:0xf bank_mask:0xf
    v_lshrrev_b32 v28, 2, v2
    v_lshlrev_b32 v28, 7, v28
    v_lshl_add_u32 v28, v3, 5, v28
    s_add_u32 s4, s88, 150784
    v_add_u32 v28, s4, v28
    ds_write_b128 v28, v[124:127]
    ds_write_b128 v28, v[128:131] offset:16
    s_waitcnt lgkmcnt(0)
    s_barrier
    v_lshlrev_b32 v28, 2, v1
    v_add_u32 v28, 150784, v28
    ds_read2st64_b32 v[172:173], v28 offset0:0 offset1:1
    ds_read2st64_b32 v[174:175], v28 offset0:2 offset1:3
    ds_read2st64_b32 v[176:177], v28 offset0:4 offset1:5
    ds_read2st64_b32 v[178:179], v28 offset0:6 offset1:7
    s_lshl_b32 s4, s40, 12
    s_add_u32 s4, s4, 12451840
    v_add_u32 v169, s4, v30
    s_lshl_b32 s4, s41, 9
    v_add_u32 v28, s4, v169
    s_add_u32 s4, s88, 148736
    v_lshl_add_u32 v164, v1, 2, s4
    v_lshl_add_u32 v165, v3, 5, s4
    s_waitcnt lgkmcnt(2)
    v_pk_add_f32 v[172:173], v[172:173], v[174:175] op_sel:[0,0] op_sel_hi:[1,1]
    s_waitcnt lgkmcnt(0)
    v_pk_add_f32 v[176:177], v[176:177], v[178:179] op_sel:[0,0] op_sel_hi:[1,1]
    v_pk_add_f32 v[172:173], v[172:173], v[176:177] op_sel:[0,0] op_sel_hi:[1,1]
    v_min_u32 v172, -2, v172
    v_min_u32 v173, -2, v173
    s_lshl_b32 s4, s3, 4
    s_lshl_b64 exec, 0xffff, s4
    global_store_dwordx2 v28, v[172:173], s[38:39] sc1
    s_mov_b64 exec, -1
    ds_read_b128 v[48:51], v167 offset:0
    ds_read_b128 v[52:55], v167 offset:1040
    ds_read_b128 v[56:59], v167 offset:2080
    ds_read_b128 v[60:63], v167 offset:3120
    ds_read_b128 v[64:67], v167 offset:4160
    s_waitcnt vmcnt(56) lgkmcnt(4)
    v_mfma_f32_16x16x32_bf16 v[212:215], a[0:3], v[48:51], 0
    s_waitcnt vmcnt(9)
    ds_read_b128 a[160:163], v84 offset:0
    ds_read_b128 a[164:167], v86 offset:0
    ds_read_b128 v[68:71], v167 offset:5200
    v_mfma_f32_16x16x32_bf16 v[228:231], a[4:7], v[48:51], 0
    ds_read_b128 a[168:171], v88 offset:0
    ds_read_b128 a[172:175], v90 offset:0
    s_waitcnt lgkmcnt(8)
    v_mfma_f32_16x16x32_bf16 v[216:219], a[0:3], v[52:55], 0
    ds_read_b128 a[176:179], v85 offset:0
    ds_read_b128 v[48:51], v167 offset:6240
    v_mfma_f32_16x16x32_bf16 v[232:235], a[4:7], v[52:55], 0
    ds_read_b128 a[180:183], v87 offset:0
    ds_read_b128 a[184:187], v89 offset:0
    s_waitcnt lgkmcnt(11)
    v_mfma_f32_16x16x32_bf16 v[220:223], a[0:3], v[56:59], 0
    ds_read_b128 a[188:191], v91 offset:0
    ds_read_b128 v[52:55], v167 offset:7280
    v_mfma_f32_16x16x32_bf16 v[236:239], a[4:7], v[56:59], 0
    s_waitcnt lgkmcnt(1)
    s_add_u32 m0, s89, 0
    s_nop 0
    global_load_lds_dwordx4 v76, s[72:73]
    s_add_u32 m0, s89, 1024
    s_nop 0
    global_load_lds_dwordx4 v77, s[72:73]
    v_mfma_f32_16x16x32_bf16 v[224:227], a[0:3], v[60:63], 0
    s_add_u32 m0, s89, 2048
    s_nop 0
    global_load_lds_dwordx4 v78, s[72:73]
    s_add_u32 m0, s89, 3072
    s_nop 0
    global_load_lds_dwordx4 v79, s[72:73]
    ds_read_b128 v[56:59], v167 offset:8320
    v_mfma_f32_16x16x32_bf16 v[240:243], a[4:7], v[60:63], 0
    s_add_u32 m0, s89, 4096
    s_nop 0
    global_load_lds_dwordx4 v80, s[72:73]
    v_mfma_f32_16x16x32_bf16 v[212:215], a[8:11], v[64:67], v[212:215]
    s_add_u32 m0, s89, 5120
    s_nop 0
    global_load_lds_dwordx4 v81, s[72:73]
    s_add_u32 m0, s89, 6144
    s_nop 0
    global_load_lds_dwordx4 v82, s[72:73]
    ds_read_b128 v[60:63], v167 offset:9360
    v_mfma_f32_16x16x32_bf16 v[228:231], a[12:15], v[64:67], v[228:231]
    s_add_u32 m0, s89, 7168
    s_nop 0
    global_load_lds_dwordx4 v83, s[72:73]
    v_mfma_f32_16x16x32_bf16 v[216:219], a[8:11], v[68:71], v[216:219]
    s_waitcnt vmcnt(9)
    ds_read_b128 a[192:195], v84 offset:8192
    ds_read_b128 v[64:67], v167 offset:10400
    v_mfma_f32_16x16x32_bf16 v[232:235], a[12:15], v[68:71], v[232:235]
    ds_read_b128 a[196:199], v86 offset:8192
    v_mfma_f32_16x16x32_bf16 v[220:223], a[8:11], v[48:51], v[220:223]
    ds_read_b128 v[68:71], v167 offset:11440
    v_mfma_f32_16x16x32_bf16 v[236:239], a[12:15], v[48:51], v[236:239]
    ds_read_b128 a[200:203], v88 offset:8192
    s_waitcnt lgkmcnt(7)
    v_mfma_f32_16x16x32_bf16 v[224:227], a[8:11], v[52:55], v[224:227]
    ds_read_b128 v[48:51], v167 offset:12480
    v_mfma_f32_16x16x32_bf16 v[240:243], a[12:15], v[52:55], v[240:243]
    ds_read_b128 a[204:207], v90 offset:8192
    s_waitcnt lgkmcnt(8)
    v_mfma_f32_16x16x32_bf16 v[212:215], a[16:19], v[56:59], v[212:215]
    ds_read_b128 v[52:55], v167 offset:13520
    v_mfma_f32_16x16x32_bf16 v[228:231], a[20:23], v[56:59], v[228:231]
    ds_read_b128 a[208:211], v85 offset:8192
    s_waitcnt lgkmcnt(9)
    v_mfma_f32_16x16x32_bf16 v[216:219], a[16:19], v[60:63], v[216:219]
    ds_read_b128 v[56:59], v167 offset:14560
    v_mfma_f32_16x16x32_bf16 v[232:235], a[20:23], v[60:63], v[232:235]
    ds_read_b128 a[212:215], v87 offset:8192
    s_waitcnt lgkmcnt(9)
    v_mfma_f32_16x16x32_bf16 v[220:223], a[16:19], v[64:67], v[220:223]
    s_mul_i32 s5, s41, 10
    s_mul_i32 s6, s3, 1040
    v_add_u32 v28, s5, v3
    ds_read_b128 v[60:63], v167 offset:15600
    v_mfma_f32_16x16x32_bf16 v[236:239], a[20:23], v[64:67], v[236:239]
    ds_read_b128 a[216:219], v89 offset:8192
    s_waitcnt lgkmcnt(9)
    v_mfma_f32_16x16x32_bf16 v[224:227], a[16:19], v[68:71], v[224:227]
    ds_read_b128 v[64:67], v167 offset:16640
    v_mfma_f32_16x16x32_bf16 v[240:243], a[20:23], v[68:71], v[240:243]
    ds_read_b128 a[220:223], v91 offset:8192
    s_waitcnt lgkmcnt(9)
    v_mfma_f32_16x16x32_bf16 v[212:215], a[24:27], v[48:51], v[212:215]
    s_add_u32 s5, s5, 4
    v_lshrrev_b32 v29, 2, v28
    ds_read_b128 v[68:71], v167 offset:17680
    v_mfma_f32_16x16x32_bf16 v[228:231], a[28:31], v[48:51], v[228:231]
    s_waitcnt lgkmcnt(1)
    s_add_u32 m0, s89, 8192
    s_nop 0
    global_load_lds_dwordx4 v76, s[74:75]
    v_mfma_f32_16x16x32_bf16 v[216:219], a[24:27], v[52:55], v[216:219]
    s_add_u32 m0, s89, 9216
    s_nop 0
    global_load_lds_dwordx4 v77, s[74:75]
    ds_read_b128 v[48:51], v167 offset:18720
    v_mfma_f32_16x16x32_bf16 v[232:235], a[28:31], v[52:55], v[232:235]
    v_mfma_f32_16x16x32_bf16 v[220:223], a[24:27], v[56:59], v[220:223]
    s_add_u32 m0, s89, 10240
    s_nop 0
    global_load_lds_dwordx4 v78, s[74:75]
    v_mul_u32_u24 v29, 4160, v29
    ds_read_b128 v[52:55], v167 offset:19760
    v_mfma_f32_16x16x32_bf16 v[236:239], a[28:31], v[56:59], v[236:239]
    v_mfma_f32_16x16x32_bf16 v[224:227], a[24:27], v[60:63], v[224:227]
    s_add_u32 m0, s89, 11264
    s_nop 0
    global_load_lds_dwordx4 v79, s[74:75]
    ds_read_b128 v[56:59], v167 offset:20800
    v_mfma_f32_16x16x32_bf16 v[240:243], a[28:31], v[60:63], v[240:243]
    v_mfma_f32_16x16x32_bf16 v[212:215], a[32:35], v[64:67], v[212:215]
    s_add_u32 m0, s89, 12288
    s_nop 0
    global_load_lds_dwordx4 v80, s[74:75]
    v_and_b32 v28, 3, v28
    ds_read_b128 v[60:63], v167 offset:21840
    v_mfma_f32_16x16x32_bf16 v[228:231], a[36:39], v[64:67], v[228:231]
    s_waitcnt lgkmcnt(4)
    v_mfma_f32_16x16x32_bf16 v[216:219], a[32:35], v[68:71], v[216:219]
    s_add_u32 m0, s89, 13312
    s_nop 0
    global_load_lds_dwordx4 v81, s[74:75]
    ds_read_b128 v[64:67], v167 offset:22880
    v_mfma_f32_16x16x32_bf16 v[232:235], a[36:39], v[68:71], v[232:235]
    s_waitcnt lgkmcnt(4)
    v_mfma_f32_16x16x32_bf16 v[220:223], a[32:35], v[48:51], v[220:223]
    s_add_u32 m0, s89, 14336
    s_nop 0
    global_load_lds_dwordx4 v82, s[74:75]
    v_lshl_add_u32 v29, v28, 8, v29
    ds_read_b128 v[68:71], v167 offset:23920
    v_mfma_f32_16x16x32_bf16 v[236:239], a[36:39], v[48:51], v[236:239]
    s_waitcnt lgkmcnt(4)
    v_mfma_f32_16x16x32_bf16 v[224:227], a[32:35], v[52:55], v[224:227]
    s_add_u32 m0, s89, 15360
    s_nop 0
    global_load_lds_dwordx4 v83, s[74:75]
    ds_read_b128 v[48:51], v167 offset:24960
    v_mfma_f32_16x16x32_bf16 v[240:243], a[36:39], v[52:55], v[240:243]
    s_waitcnt lgkmcnt(4)
    v_mfma_f32_16x16x32_bf16 v[212:215], a[40:43], v[56:59], v[212:215]
    s_waitcnt vmcnt(8)
    ds_read_b128 a[224:227], v84 offset:0
    v_lshl_add_u32 v29, v2, 4, v29
    ds_read_b128 v[52:55], v167 offset:26000
    v_mfma_f32_16x16x32_bf16 v[228:231], a[44:47], v[56:59], v[228:231]
    ds_read_b128 a[228:231], v86 offset:0
    s_waitcnt lgkmcnt(6)
    v_mfma_f32_16x16x32_bf16 v[216:219], a[40:43], v[60:63], v[216:219]
    ds_read_b128 a[232:235], v88 offset:0
    ds_read_b128 v[56:59], v167 offset:27040
    v_mfma_f32_16x16x32_bf16 v[232:235], a[44:47], v[60:63], v[232:235]
    s_waitcnt lgkmcnt(7)
    v_mfma_f32_16x16x32_bf16 v[220:223], a[40:43], v[64:67], v[220:223]
    ds_read_b128 a[236:239], v90 offset:0
    v_add_u32 v29, s6, v29
    ds_read_b128 v[60:63], v167 offset:28080
    v_mfma_f32_16x16x32_bf16 v[236:239], a[44:47], v[64:67], v[236:239]
    ds_read_b128 a[240:243], v85 offset:0
    s_waitcnt lgkmcnt(9)
    v_mfma_f32_16x16x32_bf16 v[224:227], a[40:43], v[68:71], v[224:227]
    ds_read_b128 a[244:247], v87 offset:0
    ds_read_b128 v[64:67], v167 offset:29120
    v_mfma_f32_16x16x32_bf16 v[240:243], a[44:47], v[68:71], v[240:243]
    s_waitcnt lgkmcnt(10)
    v_mfma_f32_16x16x32_bf16 v[212:215], a[48:51], v[48:51], v[212:215]
    ds_read_b128 a[248:251], v89 offset:0
    ds_read_b128 v[36:39], v29 offset:0
    ds_read_b128 v[68:71], v167 offset:30160
    v_mfma_f32_16x16x32_bf16 v[228:231], a[52:55], v[48:51], v[228:231]
    ds_read_b128 a[252:255], v91 offset:0
    s_waitcnt lgkmcnt(12)
    v_mfma_f32_16x16x32_bf16 v[216:219], a[48:51], v[52:55], v[216:219]
    ds_read_b128 v[48:51], v167 offset:31200
    v_mfma_f32_16x16x32_bf16 v[232:235], a[52:55], v[52:55], v[232:235]
    s_waitcnt lgkmcnt(1)
    s_add_u32 m0, s89, 0
    s_nop 0
    global_load_lds_dwordx4 v76, s[76:77]
    v_mfma_f32_16x16x32_bf16 v[220:223], a[48:51], v[56:59], v[220:223]
    s_add_u32 m0, s89, 1024
    s_nop 0
    global_load_lds_dwordx4 v77, s[76:77]
    v_add_u32 v28, s5, v3
    ds_read_b128 v[52:55], v167 offset:32240
    v_mfma_f32_16x16x32_bf16 v[236:239], a[52:55], v[56:59], v[236:239]
    s_add_u32 m0, s89, 2048
    s_nop 0
    global_load_lds_dwordx4 v78, s[76:77]
    v_mfma_f32_16x16x32_bf16 v[224:227], a[48:51], v[60:63], v[224:227]
    ds_read_b128 v[56:59], v167 offset:33280
    v_mfma_f32_16x16x32_bf16 v[240:243], a[52:55], v[60:63], v[240:243]
    s_add_u32 m0, s89, 3072
    s_nop 0
    global_load_lds_dwordx4 v79, s[76:77]
    v_mfma_f32_16x16x32_bf16 v[212:215], a[56:59], v[64:67], v[212:215]
    s_add_u32 m0, s89, 4096
    s_nop 0
    global_load_lds_dwordx4 v80, s[76:77]
    ds_read_b128 v[60:63], v167 offset:34320
    v_mfma_f32_16x16x32_bf16 v[228:231], a[60:63], v[64:67], v[228:231]
    s_add_u32 m0, s89, 5120
    s_nop 0
    global_load_lds_dwordx4 v81, s[76:77]
    s_add_u32 s5, s5, 4
    v_lshrrev_b32 v29, 2, v28
    v_mfma_f32_16x16x32_bf16 v[216:219], a[56:59], v[68:71], v[216:219]
    ds_read_b128 v[64:67], v167 offset:35360
    v_mfma_f32_16x16x32_bf16 v[232:235], a[60:63], v[68:71], v[232:235]
    s_add_u32 m0, s89, 6144
    s_nop 0
    global_load_lds_dwordx4 v82, s[76:77]
    s_waitcnt lgkmcnt(4)
    v_mfma_f32_16x16x32_bf16 v[220:223], a[56:59], v[48:51], v[220:223]
    s_add_u32 m0, s89, 7168
    s_nop 0
    global_load_lds_dwordx4 v83, s[76:77]
    ds_read_b128 v[68:71], v167 offset:36400
    v_mfma_f32_16x16x32_bf16 v[236:239], a[60:63], v[48:51], v[236:239]
    v_mul_u32_u24 v29, 4160, v29
    s_waitcnt lgkmcnt(4)
    v_mfma_f32_16x16x32_bf16 v[224:227], a[56:59], v[52:55], v[224:227]
    s_waitcnt vmcnt(8)
    ds_read_b128 a[0:3], v84 offset:8192
    ds_read_b128 v[48:51], v167 offset:37440
    v_mfma_f32_16x16x32_bf16 v[240:243], a[60:63], v[52:55], v[240:243]
    ds_read_b128 a[4:7], v86 offset:8192
    s_waitcnt lgkmcnt(6)
    v_mfma_f32_16x16x32_bf16 v[212:215], a[64:67], v[56:59], v[212:215]
    ds_read_b128 a[8:11], v88 offset:8192
    ds_read_b128 v[52:55], v167 offset:38480
    v_mfma_f32_16x16x32_bf16 v[228:231], a[68:71], v[56:59], v[228:231]
    v_and_b32 v28, 3, v28
    s_waitcnt lgkmcnt(7)
    v_mfma_f32_16x16x32_bf16 v[216:219], a[64:67], v[60:63], v[216:219]
    ds_read_b128 a[12:15], v90 offset:8192
    ds_read_b128 v[56:59], v167 offset:39520
    v_mfma_f32_16x16x32_bf16 v[232:235], a[68:71], v[60:63], v[232:235]
    ds_read_b128 a[16:19], v85 offset:8192
    s_waitcnt lgkmcnt(9)
    v_mfma_f32_16x16x32_bf16 v[220:223], a[64:67], v[64:67], v[220:223]
    ds_read_b128 a[20:23], v87 offset:8192
    ds_read_b128 v[60:63], v167 offset:40560
    v_mfma_f32_16x16x32_bf16 v[236:239], a[68:71], v[64:67], v[236:239]
    v_lshl_add_u32 v29, v28, 8, v29
    s_waitcnt lgkmcnt(10)
    v_mfma_f32_16x16x32_bf16 v[224:227], a[64:67], v[68:71], v[224:227]
    ds_read_b128 a[24:27], v89 offset:8192
    ds_read_b128 v[64:67], v168 offset:0
    v_mfma_f32_16x16x32_bf16 v[240:243], a[68:71], v[68:71], v[240:243]
    ds_read_b128 a[28:31], v91 offset:8192
    s_waitcnt lgkmcnt(11)
    v_mfma_f32_16x16x32_bf16 v[212:215], a[72:75], v[48:51], v[212:215]
    ds_read_b128 v[68:71], v168 offset:1040
    v_mfma_f32_16x16x32_bf16 v[228:231], a[76:79], v[48:51], v[228:231]
    s_waitcnt lgkmcnt(1)
    s_add_u32 m0, s89, 8192
    s_nop 0
    global_load_lds_dwordx4 v76, s[78:79]
    v_lshl_add_u32 v29, v2, 4, v29
    v_mfma_f32_16x16x32_bf16 v[216:219], a[72:75], v[52:55], v[216:219]
    s_add_u32 m0, s89, 9216
    s_nop 0
    global_load_lds_dwordx4 v77, s[78:79]
    ds_read_b128 v[48:51], v168 offset:2080
    v_mfma_f32_16x16x32_bf16 v[232:235], a[76:79], v[52:55], v[232:235]
    s_add_u32 m0, s89, 10240
    s_nop 0
    global_load_lds_dwordx4 v78, s[78:79]
    v_mfma_f32_16x16x32_bf16 v[220:223], a[72:75], v[56:59], v[220:223]
    ds_read_b128 v[52:55], v168 offset:3120
    v_mfma_f32_16x16x32_bf16 v[236:239], a[76:79], v[56:59], v[236:239]
    s_add_u32 m0, s89, 11264
    s_nop 0
    global_load_lds_dwordx4 v79, s[78:79]
    v_add_u32 v29, s6, v29
    v_mfma_f32_16x16x32_bf16 v[224:227], a[72:75], v[60:63], v[224:227]
    s_add_u32 m0, s89, 12288
    s_nop 0
    global_load_lds_dwordx4 v80, s[78:79]
    ds_read_b128 v[56:59], v168 offset:4160
    v_mfma_f32_16x16x32_bf16 v[240:243], a[76:79], v[60:63], v[240:243]
    s_add_u32 m0, s89, 13312
    s_nop 0
    global_load_lds_dwordx4 v81, s[78:79]
    v_mfma_f32_16x16x32_bf16 v[212:215], a[80:83], v[64:67], v[212:215]
    ds_read_b128 v[60:63], v168 offset:5200
    v_mfma_f32_16x16x32_bf16 v[228:231], a[84:87], v[64:67], v[228:231]
    s_add_u32 m0, s89, 14336
    s_nop 0
    global_load_lds_dwordx4 v82, s[78:79]
    ds_read_b128 v[40:43], v29 offset:0
    s_waitcnt lgkmcnt(5)
    v_mfma_f32_16x16x32_bf16 v[216:219], a[80:83], v[68:71], v[216:219]
    s_add_u32 m0, s89, 15360
    s_nop 0
    global_load_lds_dwordx4 v83, s[78:79]
    ds_read_b128 v[64:67], v168 offset:6240
    v_mfma_f32_16x16x32_bf16 v[232:235], a[84:87], v[68:71], v[232:235]
    s_waitcnt lgkmcnt(5)
    v_mfma_f32_16x16x32_bf16 v[220:223], a[80:83], v[48:51], v[220:223]
    s_waitcnt vmcnt(8)
    ds_read_b128 a[32:35], v84 offset:0
    ds_read_b128 v[68:71], v168 offset:7280
    v_mfma_f32_16x16x32_bf16 v[236:239], a[84:87], v[48:51], v[236:239]
    ds_read_b128 a[36:39], v86 offset:0
    v_lshrrev_b32 v28, 1, v3
    s_waitcnt lgkmcnt(7)
    v_mfma_f32_16x16x32_bf16 v[224:227], a[80:83], v[52:55], v[224:227]
    ds_read_b128 a[40:43], v88 offset:0
    ds_read_b128 v[48:51], v168 offset:8320
    v_mfma_f32_16x16x32_bf16 v[240:243], a[84:87], v[52:55], v[240:243]
    s_waitcnt lgkmcnt(8)
    v_mfma_f32_16x16x32_bf16 v[212:215], a[88:91], v[56:59], v[212:215]
    ds_read_b128 a[44:47], v90 offset:0
    ds_read_b128 v[52:55], v168 offset:9360
    v_mfma_f32_16x16x32_bf16 v[228:231], a[92:95], v[56:59], v[228:231]
    ds_read_b128 a[48:51], v85 offset:0
    v_add_u32 v28, s5, v28
    s_waitcnt lgkmcnt(10)
    v_mfma_f32_16x16x32_bf16 v[216:219], a[88:91], v[60:63], v[216:219]
    ds_read_b128 a[52:55], v87 offset:0
    ds_read_b128 v[56:59], v168 offset:10400
    v_mfma_f32_16x16x32_bf16 v[232:235], a[92:95], v[60:63], v[232:235]
    s_waitcnt lgkmcnt(10)
    v_mfma_f32_16x16x32_bf16 v[220:223], a[88:91], v[64:67], v[220:223]
    ds_read_b128 a[56:59], v89 offset:0
    ds_read_b128 v[60:63], v168 offset:11440
    v_mfma_f32_16x16x32_bf16 v[236:239], a[92:95], v[64:67], v[236:239]
    ds_read_b128 a[60:63], v91 offset:0
    s_waitcnt lgkmcnt(11)
    v_mfma_f32_16x16x32_bf16 v[224:227], a[88:91], v[68:71], v[224:227]
    s_add_u32 s5, s5, 4
    v_lshrrev_b32 v29, 2, v28
    ds_read_b128 v[64:67], v168 offset:12480
    v_mfma_f32_16x16x32_bf16 v[240:243], a[92:95], v[68:71], v[240:243]
    s_waitcnt lgkmcnt(1)
    s_add_u32 m0, s89, 0
    s_nop 0
    global_load_lds_dwordx4 v76, s[80:81]
    v_mfma_f32_16x16x32_bf16 v[212:215], a[96:99], v[48:51], v[212:215]
    s_add_u32 m0, s89, 1024
    s_nop 0
    global_load_lds_dwordx4 v77, s[80:81]
    ds_read_b128 v[68:71], v168 offset:13520
    v_mfma_f32_16x16x32_bf16 v[228:231], a[100:103], v[48:51], v[228:231]
    s_add_u32 m0, s89, 2048
    s_nop 0
    global_load_lds_dwordx4 v78, s[80:81]
    v_mfma_f32_16x16x32_bf16 v[216:219], a[96:99], v[52:55], v[216:219]
    v_mul_u32_u24 v29, 4160, v29
    ds_read_b128 v[48:51], v168 offset:14560
    v_mfma_f32_16x16x32_bf16 v[232:235], a[100:103], v[52:55], v[232:235]
    s_add_u32 m0, s89, 3072
    s_nop 0
    global_load_lds_dwordx4 v79, s[80:81]
    v_mfma_f32_16x16x32_bf16 v[220:223], a[96:99], v[56:59], v[220:223]
    s_add_u32 m0, s89, 4096
    s_nop 0
    global_load_lds_dwordx4 v80, s[80:81]
    ds_read_b128 v[52:55], v168 offset:15600
    v_mfma_f32_16x16x32_bf16 v[236:239], a[100:103], v[56:59], v[236:239]
    s_add_u32 m0, s89, 5120
    s_nop 0
    global_load_lds_dwordx4 v81, s[80:81]
    v_mfma_f32_16x16x32_bf16 v[224:227], a[96:99], v[60:63], v[224:227]
    v_and_b32 v28, 3, v28
    ds_read_b128 v[56:59], v168 offset:16640
    v_mfma_f32_16x16x32_bf16 v[240:243], a[100:103], v[60:63], v[240:243]
    s_add_u32 m0, s89, 6144
    s_nop 0
    global_load_lds_dwordx4 v82, s[80:81]
    s_waitcnt lgkmcnt(4)
    v_mfma_f32_16x16x32_bf16 v[212:215], a[104:107], v[64:67], v[212:215]
    s_add_u32 m0, s89, 7168
    s_nop 0
    global_load_lds_dwordx4 v83, s[80:81]
    ds_read_b128 v[60:63], v168 offset:17680
    v_mfma_f32_16x16x32_bf16 v[228:231], a[108:111], v[64:67], v[228:231]
    s_waitcnt lgkmcnt(4)
    v_mfma_f32_16x16x32_bf16 v[216:219], a[104:107], v[68:71], v[216:219]
    s_waitcnt vmcnt(8)
    ds_read_b128 a[64:67], v84 offset:8192
    v_lshl_add_u32 v29, v28, 8, v29
    ds_read_b128 v[64:67], v168 offset:18720
    v_mfma_f32_16x16x32_bf16 v[232:235], a[108:111], v[68:71], v[232:235]
    ds_read_b128 a[68:71], v86 offset:8192
    s_waitcnt lgkmcnt(6)
    v_mfma_f32_16x16x32_bf16 v[220:223], a[104:107], v[48:51], v[220:223]
    ds_read_b128 v[68:71], v168 offset:19760
    v_mfma_f32_16x16x32_bf16 v[236:239], a[108:111], v[48:51], v[236:239]
    ds_read_b128 a[72:75], v88 offset:8192
    s_waitcnt lgkmcnt(7)
    v_mfma_f32_16x16x32_bf16 v[224:227], a[104:107], v[52:55], v[224:227]
    v_lshl_add_u32 v29, v2, 4, v29
    ds_read_b128 v[48:51], v168 offset:20800
    v_mfma_f32_16x16x32_bf16 v[240:243], a[108:111], v[52:55], v[240:243]
    ds_read_b128 a[76:79], v90 offset:8192
    s_waitcnt lgkmcnt(8)
    v_mfma_f32_16x16x32_bf16 v[212:215], a[112:115], v[56:59], v[212:215]
    ds_read_b128 v[52:55], v168 offset:21840
    v_mfma_f32_16x16x32_bf16 v[228:231], a[116:119], v[56:59], v[228:231]
    ds_read_b128 a[80:83], v85 offset:8192
    s_waitcnt lgkmcnt(9)
    v_mfma_f32_16x16x32_bf16 v[216:219], a[112:115], v[60:63], v[216:219]
    ds_read_b128 a[84:87], v87 offset:8192
    v_add_u32 v29, s6, v29
    ds_read_b128 v[56:59], v168 offset:22880
    v_mfma_f32_16x16x32_bf16 v[232:235], a[116:119], v[60:63], v[232:235]
    s_waitcnt lgkmcnt(9)
    v_mfma_f32_16x16x32_bf16 v[220:223], a[112:115], v[64:67], v[220:223]
    ds_read_b128 a[88:91], v89 offset:8192
    ds_read_b128 v[60:63], v168 offset:23920
    v_mfma_f32_16x16x32_bf16 v[236:239], a[116:119], v[64:67], v[236:239]
    s_waitcnt lgkmcnt(9)
    v_mfma_f32_16x16x32_bf16 v[224:227], a[112:115], v[68:71], v[224:227]
    ds_read_b128 a[92:95], v91 offset:8192
    v_and_b32 v28, 1, v3
    ds_read_b128 v[64:67], v168 offset:24960
    v_mfma_f32_16x16x32_bf16 v[240:243], a[116:119], v[68:71], v[240:243]
    s_waitcnt lgkmcnt(9)
    v_mfma_f32_16x16x32_bf16 v[212:215], a[120:123], v[48:51], v[212:215]
    s_waitcnt lgkmcnt(1)
    s_add_u32 m0, s89, 8192
    s_nop 0
    global_load_lds_dwordx4 v76, s[82:83]
    ds_read_b128 v[68:71], v168 offset:26000
    v_mfma_f32_16x16x32_bf16 v[228:231], a[124:127], v[48:51], v[228:231]
    s_add_u32 m0, s89, 9216
    s_nop 0
    global_load_lds_dwordx4 v77, s[82:83]
    v_mfma_f32_16x16x32_bf16 v[216:219], a[120:123], v[52:55], v[216:219]
    v_lshl_add_u32 v29, v28, 3, v29
    ds_read_b128 v[48:51], v168 offset:27040
    v_mfma_f32_16x16x32_bf16 v[232:235], a[124:127], v[52:55], v[232:235]
    s_add_u32 m0, s89, 10240
    s_nop 0
    global_load_lds_dwordx4 v78, s[82:83]
    v_mfma_f32_16x16x32_bf16 v[220:223], a[120:123], v[56:59], v[220:223]
    ds_read_b128 v[52:55], v168 offset:28080
    v_mfma_f32_16x16x32_bf16 v[236:239], a[124:127], v[56:59], v[236:239]
    s_add_u32 m0, s89, 11264
    s_nop 0
    global_load_lds_dwordx4 v79, s[82:83]
    v_mfma_f32_16x16x32_bf16 v[224:227], a[120:123], v[60:63], v[224:227]
    ds_read_b64 v[44:45], v29 offset:0
    ds_read_b128 v[56:59], v168 offset:29120
    v_mfma_f32_16x16x32_bf16 v[240:243], a[124:127], v[60:63], v[240:243]
    s_add_u32 m0, s89, 12288
    s_nop 0
    global_load_lds_dwordx4 v80, s[82:83]
    s_waitcnt lgkmcnt(5)
    v_mfma_f32_16x16x32_bf16 v[212:215], a[128:131], v[64:67], v[212:215]
    s_add_u32 m0, s89, 13312
    s_nop 0
    global_load_lds_dwordx4 v81, s[82:83]
    ds_read_b128 v[60:63], v168 offset:30160
    v_mfma_f32_16x16x32_bf16 v[228:231], a[132:135], v[64:67], v[228:231]
    s_waitcnt lgkmcnt(5)
    v_mfma_f32_16x16x32_bf16 v[216:219], a[128:131], v[68:71], v[216:219]
    s_add_u32 m0, s89, 14336
    s_nop 0
    global_load_lds_dwordx4 v82, s[82:83]
    ds_read_b128 v[64:67], v168 offset:31200
    v_mfma_f32_16x16x32_bf16 v[232:235], a[132:135], v[68:71], v[232:235]
    s_waitcnt lgkmcnt(5)
    v_mfma_f32_16x16x32_bf16 v[220:223], a[128:131], v[48:51], v[220:223]
    s_add_u32 m0, s89, 15360
    s_nop 0
    global_load_lds_dwordx4 v83, s[82:83]
    ds_read_b128 v[68:71], v168 offset:32240
    v_mfma_f32_16x16x32_bf16 v[236:239], a[132:135], v[48:51], v[236:239]
    s_waitcnt lgkmcnt(5)
    v_mfma_f32_16x16x32_bf16 v[224:227], a[128:131], v[52:55], v[224:227]
    s_waitcnt vmcnt(8)
    ds_read_b128 a[96:99], v84 offset:0
    ds_read_b128 v[48:51], v168 offset:33280
    v_mfma_f32_16x16x32_bf16 v[240:243], a[132:135], v[52:55], v[240:243]
    s_waitcnt lgkmcnt(5)
    v_mfma_f32_16x16x32_bf16 v[212:215], a[136:139], v[56:59], v[212:215]
    ds_read_b128 a[100:103], v86 offset:0
    ds_read_b128 v[52:55], v168 offset:34320
    v_mfma_f32_16x16x32_bf16 v[228:231], a[140:143], v[56:59], v[228:231]
    s_waitcnt lgkmcnt(6)
    v_mfma_f32_16x16x32_bf16 v[216:219], a[136:139], v[60:63], v[216:219]
    ds_read_b128 a[104:107], v88 offset:0
    ds_read_b128 v[56:59], v168 offset:35360
    v_mfma_f32_16x16x32_bf16 v[232:235], a[140:143], v[60:63], v[232:235]
    s_waitcnt lgkmcnt(7)
    v_mfma_f32_16x16x32_bf16 v[220:223], a[136:139], v[64:67], v[220:223]
    ds_read_b128 a[108:111], v90 offset:0
    global_load_dwordx2 v[124:125], v169, s[38:39] offset:0 sc1
    global_load_dwordx2 v[126:127], v169, s[38:39] offset:512 sc1
    ds_read_b128 v[60:63], v168 offset:36400
    v_mfma_f32_16x16x32_bf16 v[236:239], a[140:143], v[64:67], v[236:239]
    global_load_dwordx2 v[128:129], v169, s[38:39] offset:1024 sc1
    s_waitcnt lgkmcnt(8)
    v_mfma_f32_16x16x32_bf16 v[224:227], a[136:139], v[68:71], v[224:227]
    ds_read_b128 a[112:115], v85 offset:0
    global_load_dwordx2 v[130:131], v169, s[38:39] offset:1536 sc1
    ds_read_b128 v[64:67], v168 offset:37440
    v_mfma_f32_16x16x32_bf16 v[240:243], a[140:143], v[68:71], v[240:243]
    global_load_dwordx2 v[132:133], v169, s[38:39] offset:2048 sc1
    s_waitcnt lgkmcnt(8)
    v_mfma_f32_16x16x32_bf16 v[212:215], a[144:147], v[48:51], v[212:215]
    ds_read_b128 a[116:119], v87 offset:0
    global_load_dwordx2 v[134:135], v169, s[38:39] offset:2560 sc1
    ds_read_b128 v[68:71], v168 offset:38480
    v_mfma_f32_16x16x32_bf16 v[228:231], a[148:151], v[48:51], v[228:231]
    global_load_dwordx2 v[136:137], v169, s[38:39] offset:3072 sc1
    s_waitcnt lgkmcnt(8)
    v_mfma_f32_16x16x32_bf16 v[216:219], a[144:147], v[52:55], v[216:219]
    ds_read_b128 a[120:123], v89 offset:0
    global_load_dwordx2 v[138:139], v169, s[38:39] offset:3584 sc1
    ds_read_b128 v[48:51], v168 offset:39520
    v_mfma_f32_16x16x32_bf16 v[232:235], a[148:151], v[52:55], v[232:235]
    v_min_u32 v141, 26, v1
    s_waitcnt lgkmcnt(8)
    v_mfma_f32_16x16x32_bf16 v[220:223], a[144:147], v[56:59], v[220:223]
    ds_read_b128 a[124:127], v91 offset:0
    v_lshlrev_b32 v141, 2, v141
    ds_read_b128 v[52:55], v168 offset:40560
    v_mfma_f32_16x16x32_bf16 v[236:239], a[148:151], v[56:59], v[236:239]
    v_add_u32 v141, 98304, v141
    s_waitcnt lgkmcnt(8)
    v_mfma_f32_16x16x32_bf16 v[224:227], a[144:147], v[60:63], v[224:227]
    global_load_dword v140, v141, s[38:39] sc1
    v_mfma_f32_16x16x32_bf16 v[240:243], a[148:151], v[60:63], v[240:243]
    s_waitcnt lgkmcnt(6)
    v_mfma_f32_16x16x32_bf16 v[212:215], a[152:155], v[64:67], v[212:215]
    v_mfma_f32_16x16x32_bf16 v[228:231], a[156:159], v[64:67], v[228:231]
    s_waitcnt lgkmcnt(4)
    v_mfma_f32_16x16x32_bf16 v[216:219], a[152:155], v[68:71], v[216:219]
    v_mfma_f32_16x16x32_bf16 v[232:235], a[156:159], v[68:71], v[232:235]
    s_waitcnt lgkmcnt(2)
    v_mfma_f32_16x16x32_bf16 v[220:223], a[152:155], v[48:51], v[220:223]
    v_mfma_f32_16x16x32_bf16 v[236:239], a[156:159], v[48:51], v[236:239]
    s_waitcnt lgkmcnt(0)
    v_mfma_f32_16x16x32_bf16 v[224:227], a[152:155], v[52:55], v[224:227]
    v_mfma_f32_16x16x32_bf16 v[240:243], a[156:159], v[52:55], v[240:243]
    s_waitcnt vmcnt(6)
    v_max3_u32 v28, v125, v127, v129
    s_waitcnt vmcnt(4)
    v_max3_u32 v28, v131, v133, v28
    s_waitcnt vmcnt(2)
    v_max3_u32 v28, v135, v137, v28
    s_waitcnt vmcnt(0)
    v_max3_u32 v28, v139, v140, v28
    v_cmp_eq_u32 vcc, -1, v28
    s_nop 0
    s_cbranch_vccnz Ls3_r
Ls3_ok:
    v_pk_add_f32 v[124:125], v[124:125], v[126:127] op_sel:[0,0] op_sel_hi:[1,1]
    v_pk_add_f32 v[128:129], v[128:129], v[130:131] op_sel:[0,0] op_sel_hi:[1,1]
    v_pk_add_f32 v[132:133], v[132:133], v[134:135] op_sel:[0,0] op_sel_hi:[1,1]
    v_pk_add_f32 v[136:137], v[136:137], v[138:139] op_sel:[0,0] op_sel_hi:[1,1]
    v_pk_add_f32 v[124:125], v[124:125], v[128:129] op_sel:[0,0] op_sel_hi:[1,1]
    v_pk_add_f32 v[132:133], v[132:133], v[136:137] op_sel:[0,0] op_sel_hi:[1,1]
    v_pk_add_f32 v[124:125], v[124:125], v[132:133] op_sel:[0,0] op_sel_hi:[1,1]
    v_mul_f32 v124, 0x3a97b426, v124
    v_mul_f32 v125, 0x3a97b426, v125
    v_fma_f32 v125, -v124, v124, v125
    v_max_f32 v125, 0, v125
    v_add_f32 v125, 0x3727c5ac, v125
    v_rsq_f32 v126, v125
    s_nop 0
    v_mul_f32_e64 v125, -v124, v126
    v_mov_b32 v124, v126
    ds_write2st64_b32 v164, v124, v125 offset0:0 offset1:1
    ds_read_b128 v[92:95], v165 offset:0
    ds_read_b128 v[96:99], v165 offset:16
    ds_read_b128 v[100:103], v165 offset:128
    ds_read_b128 v[104:107], v165 offset:144
    ds_read_b128 v[108:111], v165 offset:256
    ds_read_b128 v[112:115], v165 offset:272
    ds_read_b128 v[116:119], v165 offset:384
    ds_read_b128 v[120:123], v165 offset:400
    ds_read_b128 a[128:131], v84 offset:8192
    ds_read_b128 a[132:135], v86 offset:8192
    ds_read_b128 a[136:139], v88 offset:8192
    ds_read_b128 a[140:143], v90 offset:8192
    ds_read_b128 a[144:147], v85 offset:8192
    ds_read_b128 a[148:151], v87 offset:8192
    ds_read_b128 a[152:155], v89 offset:8192
    ds_read_b128 a[156:159], v91 offset:8192
    s_lshl_b32 s4, s41, 6
    s_lshl_b32 s5, s40, 1
    s_add_u32 s4, s4, s5
    s_mul_i32 s4, s4, 7168
    s_lshl_b32 s5, s3, 11
    s_add_u32 s4, s4, s5
    s_add_u32 s4, s4, 12582912
    v_add_u32 v28, s4, v4
    v_add_u32 v29, 7168, v28
    s_waitcnt lgkmcnt(11)
    v_pk_fma_f32 v[180:181], v[180:181], v[92:93], v[108:109] op_sel:[0,0,0] op_sel_hi:[1,1,1]
    v_pk_fma_f32 v[182:183], v[182:183], v[94:95], v[110:111] op_sel:[0,0,0] op_sel_hi:[1,1,1]
    s_waitcnt lgkmcnt(10)
    v_pk_fma_f32 v[184:185], v[184:185], v[96:97], v[112:113] op_sel:[0,0,0] op_sel_hi:[1,1,1]
    v_pk_fma_f32 v[186:187], v[186:187], v[98:99], v[114:115] op_sel:[0,0,0] op_sel_hi:[1,1,1]
    v_cvt_pk_bf16_f32 v124, v180, v181
    v_cvt_pk_bf16_f32 v125, v182, v183
    v_cvt_pk_bf16_f32 v126, v184, v185
    v_cvt_pk_bf16_f32 v127, v186, v187
    v_min_u32 v124, -2, v124
    v_min_u32 v125, -2, v125
    v_min_u32 v126, -2, v126
    v_min_u32 v127, -2, v127
    global_store_dwordx4 v28, v[124:127], s[38:39] offset:0 sc1
    s_waitcnt lgkmcnt(9)
    v_pk_fma_f32 v[188:189], v[188:189], v[100:101], v[116:117] op_sel:[0,0,0] op_sel_hi:[1,1,1]
    v_pk_fma_f32 v[190:191], v[190:191], v[102:103], v[118:119] op_sel:[0,0,0] op_sel_hi:[1,1,1]
    s_waitcnt lgkmcnt(8)
    v_pk_fma_f32 v[192:193], v[192:193], v[104:105], v[120:121] op_sel:[0,0,0] op_sel_hi:[1,1,1]
    v_pk_fma_f32 v[194:195], v[194:195], v[106:107], v[122:123] op_sel:[0,0,0] op_sel_hi:[1,1,1]
    v_cvt_pk_bf16_f32 v128, v188, v189
    v_cvt_pk_bf16_f32 v129, v190, v191
    v_cvt_pk_bf16_f32 v130, v192, v193
    v_cvt_pk_bf16_f32 v131, v194, v195
    v_min_u32 v128, -2, v128
    v_min_u32 v129, -2, v129
    v_min_u32 v130, -2, v130
    v_min_u32 v131, -2, v131
    global_store_dwordx4 v29, v[128:131], s[38:39] offset:0 sc1
    v_pk_fma_f32 v[196:197], v[196:197], v[92:93], v[108:109] op_sel:[0,0,0] op_sel_hi:[1,1,1]
    v_pk_fma_f32 v[198:199], v[198:199], v[94:95], v[110:111] op_sel:[0,0,0] op_sel_hi:[1,1,1]
    v_pk_fma_f32 v[200:201], v[200:201], v[96:97], v[112:113] op_sel:[0,0,0] op_sel_hi:[1,1,1]
    v_pk_fma_f32 v[202:203], v[202:203], v[98:99], v[114:115] op_sel:[0,0,0] op_sel_hi:[1,1,1]
    v_cvt_pk_bf16_f32 v132, v196, v197
    v_cvt_pk_bf16_f32 v133, v198, v199
    v_cvt_pk_bf16_f32 v134, v200, v201
    v_cvt_pk_bf16_f32 v135, v202, v203
    v_min_u32 v132, -2, v132
    v_min_u32 v133, -2, v133
    v_min_u32 v134, -2, v134
    v_min_u32 v135, -2, v135
    s_mov_b64 exec, s[86:87]
    global_store_dwordx4 v28, v[132:135], s[38:39] offset:1024 sc1
    s_mov_b64 exec, -1
    v_pk_fma_f32 v[204:205], v[204:205], v[100:101], v[116:117] op_sel:[0,0,0] op_sel_hi:[1,1,1]
    v_pk_fma_f32 v[206:207], v[206:207], v[102:103], v[118:119] op_sel:[0,0,0] op_sel_hi:[1,1,1]
    v_pk_fma_f32 v[208:209], v[208:209], v[104:105], v[120:121] op_sel:[0,0,0] op_sel_hi:[1,1,1]
    v_pk_fma_f32 v[210:211], v[210:211], v[106:107], v[122:123] op_sel:[0,0,0] op_sel_hi:[1,1,1]
    v_cvt_pk_bf16_f32 v136, v204, v205
    v_cvt_pk_bf16_f32 v137, v206, v207
    v_cvt_pk_bf16_f32 v138, v208, v209
    v_cvt_pk_bf16_f32 v139, v210, v211
    v_min_u32 v136, -2, v136
    v_min_u32 v137, -2, v137
    v_min_u32 v138, -2, v138
    v_min_u32 v139, -2, v139
    s_mov_b64 exec, s[86:87]
    global_store_dwordx4 v29, v[136:139], s[38:39] offset:1024 sc1
    s_mov_b64 exec, -1
    v_mov_b32 v92, -1
    v_mov_b32 v93, -1
    v_mov_b32 v94, -1
    v_mov_b32 v95, -1
    s_lshl_b32 s4, s40, 2
    s_add_u32 s4, s4, s3
    s_mul_i32 s4, s4, 28
    s_mul_i32 s5, s41, 7
    s_lshr_b32 s5, s5, 1
    s_add_u32 s4, s4, s5
    s_lshl_b32 s4, s4, 10
    s_add_u32 s4, s4, 16252928
    v_add_u32 v28, s4, v4
    global_store_dwordx4 v28, v[92:95], s[38:39] offset:0 sc1
    global_store_dwordx4 v28, v[92:95], s[38:39] offset:1024 sc1
    global_store_dwordx4 v28, v[92:95], s[38:39] offset:2048 sc1
    global_store_dwordx4 v28, v[92:95], s[38:39] offset:3072 sc1
    s_waitcnt lgkmcnt(0)
    s_barrier
    s_mul_i32 s5, s41, 138240
    s_add_u32 s5, s5, 10485760
    s_add_u32 s92, s38, s5
    s_addc_u32 s93, s39, 0
    s_mul_i32 s95, s3, 34816
    s_min_u32 s95, s95, 103424
    s_add_u32 s92, s92, s95
    s_addc_u32 s93, s93, 0
    s_add_u32 m0, s95, 0
    s_nop 0
    global_load_lds_dwordx4 v4, s[92:93] offset:0 sc1
    v_pk_fma_f32 v[180:181], v[156:157], v[12:13], v[16:17] op_sel:[1,0,0] op_sel_hi:[1,1,1]
    v_pk_fma_f32 v[182:183], v[156:157], v[14:15], v[18:19] op_sel:[1,0,0] op_sel_hi:[1,1,1]
    v_pk_fma_f32 v[184:185], v[158:159], v[12:13], v[16:17] op_sel:[1,0,0] op_sel_hi:[1,1,1]
    v_pk_fma_f32 v[186:187], v[158:159], v[14:15], v[18:19] op_sel:[1,0,0] op_sel_hi:[1,1,1]
    v_pk_fma_f32 v[188:189], v[160:161], v[12:13], v[16:17] op_sel:[1,0,0] op_sel_hi:[1,1,1]
    v_pk_fma_f32 v[190:191], v[160:161], v[14:15], v[18:19] op_sel:[1,0,0] op_sel_hi:[1,1,1]
    v_pk_fma_f32 v[192:193], v[162:163], v[12:13], v[16:17] op_sel:[1,0,0] op_sel_hi:[1,1,1]
    v_pk_fma_f32 v[194:195], v[162:163], v[14:15], v[18:19] op_sel:[1,0,0] op_sel_hi:[1,1,1]
    v_pk_fma_f32 v[212:213], v[156:157], v[212:213], v[180:181] op_sel:[0,0,0] op_sel_hi:[0,1,1]
    v_pk_fma_f32 v[214:215], v[156:157], v[214:215], v[182:183] op_sel:[0,0,0] op_sel_hi:[0,1,1]
    v_pk_fma_f32 v[216:217], v[158:159], v[216:217], v[184:185] op_sel:[0,0,0] op_sel_hi:[0,1,1]
    v_pk_fma_f32 v[218:219], v[158:159], v[218:219], v[186:187] op_sel:[0,0,0] op_sel_hi:[0,1,1]
    v_pk_fma_f32 v[220:221], v[160:161], v[220:221], v[188:189] op_sel:[0,0,0] op_sel_hi:[0,1,1]
    v_pk_fma_f32 v[222:223], v[160:161], v[222:223], v[190:191] op_sel:[0,0,0] op_sel_hi:[0,1,1]
    global_load_lds_dwordx4 v4, s[92:93] offset:1024 sc1
    v_pk_fma_f32 v[224:225], v[162:163], v[224:225], v[192:193] op_sel:[0,0,0] op_sel_hi:[0,1,1]
    v_pk_fma_f32 v[226:227], v[162:163], v[226:227], v[194:195] op_sel:[0,0,0] op_sel_hi:[0,1,1]
    v_pk_fma_f32 v[180:181], v[156:157], v[20:21], v[24:25] op_sel:[1,0,0] op_sel_hi:[1,1,1]
    v_pk_fma_f32 v[182:183], v[156:157], v[22:23], v[26:27] op_sel:[1,0,0] op_sel_hi:[1,1,1]
    v_pk_fma_f32 v[184:185], v[158:159], v[20:21], v[24:25] op_sel:[1,0,0] op_sel_hi:[1,1,1]
    v_pk_fma_f32 v[186:187], v[158:159], v[22:23], v[26:27] op_sel:[1,0,0] op_sel_hi:[1,1,1]
    v_pk_fma_f32 v[188:189], v[160:161], v[20:21], v[24:25] op_sel:[1,0,0] op_sel_hi:[1,1,1]
    v_pk_fma_f32 v[190:191], v[160:161], v[22:23], v[26:27] op_sel:[1,0,0] op_sel_hi:[1,1,1]
    v_pk_fma_f32 v[192:193], v[162:163], v[20:21], v[24:25] op_sel:[1,0,0] op_sel_hi:[1,1,1]
    v_pk_fma_f32 v[194:195], v[162:163], v[22:23], v[26:27] op_sel:[1,0,0] op_sel_hi:[1,1,1]
    v_pk_fma_f32 v[228:229], v[156:157], v[228:229], v[180:181] op_sel:[0,0,0] op_sel_hi:[0,1,1]
    v_pk_fma_f32 v[230:231], v[156:157], v[230:231], v[182:183] op_sel:[0,0,0] op_sel_hi:[0,1,1]
    v_pk_fma_f32 v[232:233], v[158:159], v[232:233], v[184:185] op_sel:[0,0,0] op_sel_hi:[0,1,1]
    v_pk_fma_f32 v[234:235], v[158:159], v[234:235], v[186:187] op_sel:[0,0,0] op_sel_hi:[0,1,1]
    v_pk_fma_f32 v[236:237], v[160:161], v[236:237], v[188:189] op_sel:[0,0,0] op_sel_hi:[0,1,1]
    global_load_lds_dwordx4 v4, s[92:93] offset:2048 sc1
    v_pk_fma_f32 v[238:239], v[160:161], v[238:239], v[190:191] op_sel:[0,0,0] op_sel_hi:[0,1,1]
    v_pk_fma_f32 v[240:241], v[162:163], v[240:241], v[192:193] op_sel:[0,0,0] op_sel_hi:[0,1,1]
    v_pk_fma_f32 v[242:243], v[162:163], v[242:243], v[194:195] op_sel:[0,0,0] op_sel_hi:[0,1,1]
    v_pk_mul_f32 v[180:181], v[212:213], v[212:213] op_sel:[0,0] op_sel_hi:[1,1]
    v_pk_mul_f32 v[182:183], v[214:215], v[214:215] op_sel:[0,0] op_sel_hi:[1,1]
    v_pk_mul_f32 v[184:185], v[216:217], v[216:217] op_sel:[0,0] op_sel_hi:[1,1]
    v_pk_mul_f32 v[186:187], v[218:219], v[218:219] op_sel:[0,0] op_sel_hi:[1,1]
    v_pk_mul_f32 v[188:189], v[220:221], v[220:221] op_sel:[0,0] op_sel_hi:[1,1]
    v_pk_mul_f32 v[190:191], v[222:223], v[222:223] op_sel:[0,0] op_sel_hi:[1,1]
    v_pk_mul_f32 v[192:193], v[224:225], v[224:225] op_sel:[0,0] op_sel_hi:[1,1]
    v_pk_mul_f32 v[194:195], v[226:227], v[226:227] op_sel:[0,0] op_sel_hi:[1,1]
    v_pk_mul_f32 v[196:197], v[228:229], v[228:229] op_sel:[0,0] op_sel_hi:[1,1]
    v_pk_mul_f32 v[198:199], v[230:231], v[230:231] op_sel:[0,0] op_sel_hi:[1,1]
    v_pk_mul_f32 v[200:201], v[232:233], v[232:233] op_sel:[0,0] op_sel_hi:[1,1]
    global_load_lds_dwordx4 v4, s[92:93] offset:3072 sc1
    v_pk_mul_f32 v[202:203], v[234:235], v[234:235] op_sel:[0,0] op_sel_hi:[1,1]
    v_pk_mul_f32 v[204:205], v[236:237], v[236:237] op_sel:[0,0] op_sel_hi:[1,1]
    v_pk_mul_f32 v[206:207], v[238:239], v[238:239] op_sel:[0,0] op_sel_hi:[1,1]
    v_pk_mul_f32 v[208:209], v[240:241], v[240:241] op_sel:[0,0] op_sel_hi:[1,1]
    v_pk_mul_f32 v[210:211], v[242:243], v[242:243] op_sel:[0,0] op_sel_hi:[1,1]
    v_pk_fma_f32 v[180:181], v[180:181], s[84:85], s[84:85] op_sel:[0,1,0] op_sel_hi:[1,1,0]
    v_pk_fma_f32 v[182:183], v[182:183], s[84:85], s[84:85] op_sel:[0,1,0] op_sel_hi:[1,1,0]
    v_pk_fma_f32 v[184:185], v[184:185], s[84:85], s[84:85] op_sel:[0,1,0] op_sel_hi:[1,1,0]
    v_pk_fma_f32 v[186:187], v[186:187], s[84:85], s[84:85] op_sel:[0,1,0] op_sel_hi:[1,1,0]
    v_pk_fma_f32 v[188:189], v[188:189], s[84:85], s[84:85] op_sel:[0,1,0] op_sel_hi:[1,1,0]
    v_pk_fma_f32 v[190:191], v[190:191], s[84:85], s[84:85] op_sel:[0,1,0] op_sel_hi:[1,1,0]
    v_pk_fma_f32 v[192:193], v[192:193], s[84:85], s[84:85] op_sel:[0,1,0] op_sel_hi:[1,1,0]
    v_pk_fma_f32 v[194:195], v[194:195], s[84:85], s[84:85] op_sel:[0,1,0] op_sel_hi:[1,1,0]
    v_pk_fma_f32 v[196:197], v[196:197], s[84:85], s[84:85] op_sel:[0,1,0] op_sel_hi:[1,1,0]
    v_pk_fma_f32 v[198:199], v[198:199], s[84:85], s[84:85] op_sel:[0,1,0] op_sel_hi:[1,1,0]
    s_add_u32 m0, s95, 4096
    s_add_u32 s92, s92, 4096
    s_addc_u32 s93, s93, 0
    global_load_lds_dwordx4 v4, s[92:93] offset:0 sc1
    v_pk_fma_f32 v[200:201], v[200:201], s[84:85], s[84:85] op_sel:[0,1,0] op_sel_hi:[1,1,0]
    v_pk_fma_f32 v[202:203], v[202:203], s[84:85], s[84:85] op_sel:[0,1,0] op_sel_hi:[1,1,0]
    v_pk_fma_f32 v[204:205], v[204:205], s[84:85], s[84:85] op_sel:[0,1,0] op_sel_hi:[1,1,0]
    v_pk_fma_f32 v[206:207], v[206:207], s[84:85], s[84:85] op_sel:[0,1,0] op_sel_hi:[1,1,0]
    v_pk_fma_f32 v[208:209], v[208:209], s[84:85], s[84:85] op_sel:[0,1,0] op_sel_hi:[1,1,0]
    v_pk_fma_f32 v[210:211], v[210:211], s[84:85], s[84:85] op_sel:[0,1,0] op_sel_hi:[1,1,0]
    v_pk_mul_f32 v[180:181], v[180:181], v[212:213] op_sel:[0,0] op_sel_hi:[1,1]
    v_pk_mul_f32 v[182:183], v[182:183], v[214:215] op_sel:[0,0] op_sel_hi:[1,1]
    v_pk_mul_f32 v[184:185], v[184:185], v[216:217] op_sel:[0,0] op_sel_hi:[1,1]
    v_pk_mul_f32 v[186:187], v[186:187], v[218:219] op_sel:[0,0] op_sel_hi:[1,1]
    v_pk_mul_f32 v[188:189], v[188:189], v[220:221] op_sel:[0,0] op_sel_hi:[1,1]
    v_pk_mul_f32 v[190:191], v[190:191], v[222:223] op_sel:[0,0] op_sel_hi:[1,1]
    v_pk_mul_f32 v[192:193], v[192:193], v[224:225] op_sel:[0,0] op_sel_hi:[1,1]
    v_pk_mul_f32 v[194:195], v[194:195], v[226:227] op_sel:[0,0] op_sel_hi:[1,1]
    global_load_lds_dwordx4 v4, s[92:93] offset:1024 sc1
    v_pk_mul_f32 v[196:197], v[196:197], v[228:229] op_sel:[0,0] op_sel_hi:[1,1]
    v_pk_mul_f32 v[198:199], v[198:199], v[230:231] op_sel:[0,0] op_sel_hi:[1,1]
    v_pk_mul_f32 v[200:201], v[200:201], v[232:233] op_sel:[0,0] op_sel_hi:[1,1]
    v_pk_mul_f32 v[202:203], v[202:203], v[234:235] op_sel:[0,0] op_sel_hi:[1,1]
    v_pk_mul_f32 v[204:205], v[204:205], v[236:237] op_sel:[0,0] op_sel_hi:[1,1]
    v_pk_mul_f32 v[206:207], v[206:207], v[238:239] op_sel:[0,0] op_sel_hi:[1,1]
    v_pk_mul_f32 v[208:209], v[208:209], v[240:241] op_sel:[0,0] op_sel_hi:[1,1]
    v_pk_mul_f32 v[210:211], v[210:211], v[242:243] op_sel:[0,0] op_sel_hi:[1,1]
    v_exp_f32 v180, v180
    v_exp_f32 v181, v181
    v_exp_f32 v182, v182
    v_exp_f32 v183, v183
    v_exp_f32 v184, v184
    v_exp_f32 v185, v185
    v_exp_f32 v186, v186
    global_load_lds_dwordx4 v4, s[92:93] offset:2048 sc1
    v_exp_f32 v187, v187
    v_exp_f32 v188, v188
    v_exp_f32 v189, v189
    v_exp_f32 v190, v190
    v_exp_f32 v191, v191
    v_exp_f32 v192, v192
    v_exp_f32 v193, v193
    v_exp_f32 v194, v194
    v_exp_f32 v195, v195
    v_exp_f32 v196, v196
    v_exp_f32 v197, v197
    v_exp_f32 v198, v198
    v_exp_f32 v199, v199
    v_exp_f32 v200, v200
    global_load_lds_dwordx4 v4, s[92:93] offset:3072 sc1
    v_exp_f32 v201, v201
    v_exp_f32 v202, v202
    v_exp_f32 v203, v203
    v_exp_f32 v204, v204
    v_exp_f32 v205, v205
    v_exp_f32 v206, v206
    v_exp_f32 v207, v207
    v_exp_f32 v208, v208
    v_exp_f32 v209, v209
    v_exp_f32 v210, v210
    v_exp_f32 v211, v211
    v_pk_add_f32 v[180:181], v[180:181], 1.0 op_sel:[0,0] op_sel_hi:[1,0]
    v_pk_add_f32 v[182:183], v[182:183], 1.0 op_sel:[0,0] op_sel_hi:[1,0]
    v_pk_add_f32 v[184:185], v[184:185], 1.0 op_sel:[0,0] op_sel_hi:[1,0]
    v_pk_add_f32 v[186:187], v[186:187], 1.0 op_sel:[0,0] op_sel_hi:[1,0]
    s_add_u32 m0, s95, 8192
    s_add_u32 s92, s92, 4096
    s_addc_u32 s93, s93, 0
    global_load_lds_dwordx4 v4, s[92:93] offset:0 sc1
    v_pk_add_f32 v[188:189], v[188:189], 1.0 op_sel:[0,0] op_sel_hi:[1,0]
    v_pk_add_f32 v[190:191], v[190:191], 1.0 op_sel:[0,0] op_sel_hi:[1,0]
    v_pk_add_f32 v[192:193], v[192:193], 1.0 op_sel:[0,0] op_sel_hi:[1,0]
    v_pk_add_f32 v[194:195], v[194:195], 1.0 op_sel:[0,0] op_sel_hi:[1,0]
    v_pk_add_f32 v[196:197], v[196:197], 1.0 op_sel:[0,0] op_sel_hi:[1,0]
    v_pk_add_f32 v[198:199], v[198:199], 1.0 op_sel:[0,0] op_sel_hi:[1,0]
    v_pk_add_f32 v[200:201], v[200:201], 1.0 op_sel:[0,0] op_sel_hi:[1,0]
    v_pk_add_f32 v[202:203], v[202:203], 1.0 op_sel:[0,0] op_sel_hi:[1,0]
    v_pk_add_f32 v[204:205], v[204:205], 1.0 op_sel:[0,0] op_sel_hi:[1,0]
    v_pk_add_f32 v[206:207], v[206:207], 1.0 op_sel:[0,0] op_sel_hi:[1,0]
    v_pk_add_f32 v[208:209], v[208:209], 1.0 op_sel:[0,0] op_sel_hi:[1,0]
    v_pk_add_f32 v[210:211], v[210:211], 1.0 op_sel:[0,0] op_sel_hi:[1,0]
    v_rcp_f32 v180, v180
    v_rcp_f32 v181, v181
    global_load_lds_dwordx4 v4, s[92:93] offset:1024 sc1
    v_rcp_f32 v182, v182
    v_rcp_f32 v183, v183
    v_rcp_f32 v184, v184
    v_rcp_f32 v185, v185
    v_rcp_f32 v186, v186
    v_rcp_f32 v187, v187
    v_rcp_f32 v188, v188
    v_rcp_f32 v189, v189
    v_rcp_f32 v190, v190
    v_rcp_f32 v191, v191
    v_rcp_f32 v192, v192
    v_rcp_f32 v193, v193
    v_rcp_f32 v194, v194
    v_rcp_f32 v195, v195
    v_rcp_f32 v196, v196
    global_load_lds_dwordx4 v4, s[92:93] offset:2048 sc1
    v_rcp_f32 v197, v197
    v_rcp_f32 v198, v198
    v_rcp_f32 v199, v199
    v_rcp_f32 v200, v200
    v_rcp_f32 v201, v201
    v_rcp_f32 v202, v202
    v_rcp_f32 v203, v203
    v_rcp_f32 v204, v204
    v_rcp_f32 v205, v205
    v_rcp_f32 v206, v206
    v_rcp_f32 v207, v207
    v_rcp_f32 v208, v208
    v_rcp_f32 v209, v209
    v_rcp_f32 v210, v210
    global_load_lds_dwordx4 v4, s[92:93] offset:3072 sc1
    v_rcp_f32 v211, v211
    v_pk_mul_f32 v[212:213], v[212:213], v[180:181] op_sel:[0,0] op_sel_hi:[1,1]
    v_pk_mul_f32 v[214:215], v[214:215], v[182:183] op_sel:[0,0] op_sel_hi:[1,1]
    v_pk_mul_f32 v[216:217], v[216:217], v[184:185] op_sel:[0,0] op_sel_hi:[1,1]
    v_pk_mul_f32 v[218:219], v[218:219], v[186:187] op_sel:[0,0] op_sel_hi:[1,1]
    v_pk_mul_f32 v[220:221], v[220:221], v[188:189] op_sel:[0,0] op_sel_hi:[1,1]
    v_pk_mul_f32 v[222:223], v[222:223], v[190:191] op_sel:[0,0] op_sel_hi:[1,1]
    v_pk_mul_f32 v[224:225], v[224:225], v[192:193] op_sel:[0,0] op_sel_hi:[1,1]
    v_pk_mul_f32 v[226:227], v[226:227], v[194:195] op_sel:[0,0] op_sel_hi:[1,1]
    v_pk_mul_f32 v[228:229], v[228:229], v[196:197] op_sel:[0,0] op_sel_hi:[1,1]
    v_pk_mul_f32 v[230:231], v[230:231], v[198:199] op_sel:[0,0] op_sel_hi:[1,1]
    v_pk_mul_f32 v[232:233], v[232:233], v[200:201] op_sel:[0,0] op_sel_hi:[1,1]
    v_pk_mul_f32 v[234:235], v[234:235], v[202:203] op_sel:[0,0] op_sel_hi:[1,1]
    v_pk_mul_f32 v[236:237], v[236:237], v[204:205] op_sel:[0,0] op_sel_hi:[1,1]
    v_pk_mul_f32 v[238:239], v[238:239], v[206:207] op_sel:[0,0] op_sel_hi:[1,1]
    s_add_u32 m0, s95, 12288
    s_add_u32 s92, s92, 4096
    s_addc_u32 s93, s93, 0
    global_load_lds_dwordx4 v4, s[92:93] offset:0 sc1
    v_pk_mul_f32 v[240:241], v[240:241], v[208:209] op_sel:[0,0] op_sel_hi:[1,1]
    v_pk_mul_f32 v[242:243], v[242:243], v[210:211] op_sel:[0,0] op_sel_hi:[1,1]
    v_cvt_pk_bf16_f32 v180, v212, v213
    v_cvt_pk_bf16_f32 v181, v214, v215
    v_cvt_pk_bf16_f32 v182, v216, v217
    v_cvt_pk_bf16_f32 v183, v218, v219
    v_cvt_pk_bf16_f32 v184, v220, v221
    v_cvt_pk_bf16_f32 v185, v222, v223
    v_cvt_pk_bf16_f32 v186, v224, v225
    v_cvt_pk_bf16_f32 v187, v226, v227
    v_cvt_pk_bf16_f32 v188, v228, v229
    v_cvt_pk_bf16_f32 v189, v230, v231
    v_cvt_pk_bf16_f32 v190, v232, v233
    v_cvt_pk_bf16_f32 v191, v234, v235
    global_load_lds_dwordx4 v4, s[92:93] offset:1024 sc1
    v_cvt_pk_bf16_f32 v192, v236, v237
    v_cvt_pk_bf16_f32 v193, v238, v239
    v_cvt_pk_bf16_f32 v194, v240, v241
    v_cvt_pk_bf16_f32 v195, v242, v243
    s_lshl_b32 s4, s3, 10
    s_add_u32 s4, s4, 138240
    v_add_u32 v28, s4, v30
    ds_write_b64 v28, v[180:181] offset:0
    ds_write_b64 v28, v[182:183] offset:4096
    ds_write_b64 v28, v[184:185] offset:8192
    ds_write_b64 v28, v[186:187] offset:12288
    ds_write_b64 v28, v[188:189] offset:512
    ds_write_b64 v28, v[190:191] offset:4608
    ds_write_b64 v28, v[192:193] offset:8704
    ds_write_b64 v28, v[194:195] offset:12800
    s_waitcnt lgkmcnt(0)
    s_barrier
    s_lshl_b32 s4, s3, 12
    s_add_u32 s4, s4, 138240
    v_add_u32 v28, s4, v30
    ds_read_b64 v[48:49], v28 offset:0
    ds_read_b64 v[50:51], v28 offset:512
    ds_read_b64 v[52:53], v28 offset:1024
    ds_read_b64 v[54:55], v28 offset:1536
    ds_read_b64 v[56:57], v28 offset:2048
    ds_read_b64 v[58:59], v28 offset:2560
    ds_read_b64 v[60:61], v28 offset:3072
    global_load_lds_dwordx4 v4, s[92:93] offset:2048 sc1
    global_load_lds_dwordx4 v4, s[92:93] offset:3072 sc1
    s_add_u32 m0, s95, 16384
    s_add_u32 s92, s92, 4096
    s_addc_u32 s93, s93, 0
    global_load_lds_dwordx4 v4, s[92:93] offset:0 sc1
    global_load_lds_dwordx4 v4, s[92:93] offset:1024 sc1
    v_add_u32 v30, 3072, v4
    v_add_u32 v31, 10240, v4
    s_xor_b32 s4, s3, 1
    s_mul_i32 s4, s4, 3072
    s_add_u32 s4, s4, 138240
    v_add_u32 v20, s4, v4
    s_xor_b32 s4, s3, 2
    s_mul_i32 s4, s4, 3072
    s_add_u32 s4, s4, 139264
    v_add_u32 v21, s4, v4
    s_xor_b32 s4, s3, 3
    s_mul_i32 s4, s4, 3072
    s_add_u32 s4, s4, 140288
    v_add_u32 v22, s4, v4
    s_mul_i32 s4, s3, 3072
    s_add_u32 s4, s4, 138240
    v_add_u32 v23, s4, v4
    s_lshl_b32 s4, s40, 2
    s_add_u32 s4, s4, s3
    s_mul_i32 s4, s4, 28672
    s_add_u32 s91, s4, 16252928
    s_mul_i32 s5, s41, 7
    s_add_u32 s5, s5, 1
    s_lshr_b32 s5, s5, 1
    s_lshl_b32 s5, s5, 10
    s_add_u32 s4, s91, s5
    v_add_u32 v24, s4, v4
    s_movk_i32 s5, 3072
    s_bitcmp1_b32 s41, 0
    s_cselect_b32 s5, -1016, s5
    v_add_u32 v25, s5, v24
    v_min_u32 v29, 13, v1
    v_lshlrev_b32 v29, 10, v29
    s_add_u32 s4, s91, 4096
    v_add_u32 v6, s4, v4
    v_add_u32 v7, 8192, v6
    v_add_u32 v26, 16384, v6
    v_add_u32 v27, 24576, v6
    s_waitcnt lgkmcnt(0)
    s_barrier
Lzp:
    global_load_dword v62, v29, s[52:53] offset:1020 sc1
    global_load_dword v63, v29, s[54:55] offset:1020 sc1
    global_load_dwordx4 v[174:177], v30, s[52:53] offset:-3072 sc1
    global_load_dwordx4 v[178:181], v30, s[52:53] offset:-2048 sc1
    global_load_dwordx4 v[182:185], v30, s[52:53] offset:-1024 sc1
    global_load_dwordx4 v[186:189], v30, s[52:53] offset:0 sc1
    global_load_dwordx4 v[190:193], v30, s[52:53] offset:1024 sc1
    global_load_dwordx4 v[194:197], v30, s[52:53] offset:2048 sc1
    global_load_dwordx4 v[198:201], v30, s[52:53] offset:3072 sc1
    global_load_dwordx4 v[202:205], v31, s[52:53] offset:-3072 sc1
    s_waitcnt vmcnt(0)
    v_max_u32 v28, v62, v63
    v_max3_u32 v28, v177, v181, v28
    v_max3_u32 v28, v185, v189, v28
    v_cmp_eq_u32 vcc, -1, v28
    s_add_u32 s100, s100, 1
    s_cmp_ge_u32 s100, 262144
    s_cbranch_scc1 Lzp_x
    s_cbranch_vccnz Lzp
Lzp_x:
    global_load_dwordx4 v[206:209], v31, s[52:53] offset:-2048 sc1
    global_load_dwordx4 v[210:213], v31, s[52:53] offset:-1024 sc1
    global_load_dwordx4 v[214:217], v31, s[52:53] offset:0 sc1
    global_load_dwordx4 v[218:221], v31, s[52:53] offset:1024 sc1
    global_load_dwordx4 v[222:225], v31, s[52:53] offset:2048 sc1
    global_load_dwordx4 v[226:229], v31, s[52:53] offset:3072 sc1
    global_load_dwordx4 v[230:233], v30, s[54:55] offset:-3072 sc1
    global_load_dwordx4 v[234:237], v30, s[54:55] offset:-2048 sc1
    v_mfma_f32_16x16x32_bf16 v[62:65], v[174:177], a[160:163], v[32:35]
    global_load_dwordx4 v[238:241], v30, s[54:55] offset:-1024 sc1
    v_mfma_f32_16x16x32_bf16 v[66:69], v[174:177], a[164:167], 0
    v_mfma_f32_16x16x32_bf16 v[70:73], v[174:177], a[168:171], 0
    v_mfma_f32_16x16x32_bf16 v[74:77], v[174:177], a[172:175], 0
    v_mfma_f32_16x16x32_bf16 v[78:81], v[178:181], a[160:163], v[32:35]
    global_load_dwordx4 v[242:245], v30, s[54:55] offset:0 sc1
    v_mfma_f32_16x16x32_bf16 v[82:85], v[178:181], a[164:167], 0
    v_mfma_f32_16x16x32_bf16 v[86:89], v[178:181], a[168:171], 0
    v_mfma_f32_16x16x32_bf16 v[90:93], v[178:181], a[172:175], 0
    v_mfma_f32_16x16x32_bf16 v[94:97], v[182:185], a[160:163], v[32:35]
    global_load_dwordx4 v[246:249], v30, s[54:55] offset:1024 sc1
    v_mfma_f32_16x16x32_bf16 v[98:101], v[182:185], a[164:167], 0
    v_mfma_f32_16x16x32_bf16 v[102:105], v[182:185], a[168:171], 0
    v_mfma_f32_16x16x32_bf16 v[106:109], v[182:185], a[172:175], 0
    v_max_u32 v28, v193, v197
    v_mfma_f32_16x16x32_bf16 v[110:113], v[186:189], a[160:163], v[32:35]
    global_load_dwordx4 v[250:253], v30, s[54:55] offset:2048 sc1
    v_max3_u32 v28, v201, v205, v28
    v_mfma_f32_16x16x32_bf16 v[114:117], v[186:189], a[164:167], 0
    v_cmp_eq_u32 vcc, -1, v28
    v_mfma_f32_16x16x32_bf16 v[118:121], v[186:189], a[168:171], 0
    v_mfma_f32_16x16x32_bf16 v[122:125], v[186:189], a[172:175], 0
    s_cbranch_vccnz Lz1_r
Lz1_ok:
    v_mfma_f32_16x16x32_bf16 v[126:129], v[190:193], a[160:163], v[32:35]
    global_load_dwordx4 v[174:177], v30, s[54:55] offset:3072 sc1
    v_mfma_f32_16x16x32_bf16 v[130:133], v[190:193], a[164:167], 0
    v_mfma_f32_16x16x32_bf16 v[134:137], v[190:193], a[168:171], 0
    v_mfma_f32_16x16x32_bf16 v[138:141], v[190:193], a[172:175], 0
    v_mfma_f32_16x16x32_bf16 v[142:145], v[194:197], a[160:163], v[32:35]
    global_load_dwordx4 v[178:181], v31, s[54:55] offset:-3072 sc1
    v_mfma_f32_16x16x32_bf16 v[146:149], v[194:197], a[164:167], 0
    v_mfma_f32_16x16x32_bf16 v[150:153], v[194:197], a[168:171], 0
    v_mfma_f32_16x16x32_bf16 v[154:157], v[194:197], a[172:175], 0
    v_mfma_f32_16x16x32_bf16 v[158:161], v[198:201], a[160:163], v[32:35]
    global_load_dwordx4 v[182:185], v31, s[54:55] offset:-2048 sc1
    v_mfma_f32_16x16x32_bf16 v[162:165], v[198:201], a[164:167], 0
    v_mfma_f32_16x16x32_bf16 v[166:169], v[198:201], a[168:171], 0
    v_mfma_f32_16x16x32_bf16 v[170:173], v[198:201], a[172:175], 0
    s_waitcnt vmcnt(13)
    v_max_u32 v28, v209, v213
    v_mfma_f32_16x16x32_bf16 v[62:65], v[202:205], a[176:179], v[62:65]
    global_load_dwordx4 v[186:189], v31, s[54:55] offset:-1024 sc1
    s_waitcnt vmcnt(12)
    v_max3_u32 v28, v217, v221, v28
    v_mfma_f32_16x16x32_bf16 v[66:69], v[202:205], a[180:183], v[66:69]
    v_cmp_eq_u32 vcc, -1, v28
    v_mfma_f32_16x16x32_bf16 v[70:73], v[202:205], a[184:187], v[70:73]
    v_mfma_f32_16x16x32_bf16 v[74:77], v[202:205], a[188:191], v[74:77]
    s_cbranch_vccnz Lz2_r
Lz2_ok:
    v_mfma_f32_16x16x32_bf16 v[78:81], v[206:209], a[176:179], v[78:81]
    global_load_dwordx4 v[190:193], v31, s[54:55] offset:0 sc1
    v_mfma_f32_16x16x32_bf16 v[82:85], v[206:209], a[180:183], v[82:85]
    v_mfma_f32_16x16x32_bf16 v[86:89], v[206:209], a[184:187], v[86:89]
    v_mfma_f32_16x16x32_bf16 v[90:93], v[206:209], a[188:191], v[90:93]
    v_mfma_f32_16x16x32_bf16 v[94:97], v[210:213], a[176:179], v[94:97]
    global_load_dwordx4 v[194:197], v31, s[54:55] offset:1024 sc1
    v_mfma_f32_16x16x32_bf16 v[98:101], v[210:213], a[180:183], v[98:101]
    v_mfma_f32_16x16x32_bf16 v[102:105], v[210:213], a[184:187], v[102:105]
    v_mfma_f32_16x16x32_bf16 v[106:109], v[210:213], a[188:191], v[106:109]
    v_mfma_f32_16x16x32_bf16 v[110:113], v[214:217], a[176:179], v[110:113]
    global_load_dwordx4 v[198:201], v31, s[54:55] offset:2048 sc1
    v_mfma_f32_16x16x32_bf16 v[114:117], v[214:217], a[180:183], v[114:117]
    v_mfma_f32_16x16x32_bf16 v[118:121], v[214:217], a[184:187], v[118:121]
    v_mfma_f32_16x16x32_bf16 v[122:125], v[214:217], a[188:191], v[122:125]
    s_waitcnt vmcnt(13)
    v_max_u32 v28, v225, v229
    v_mfma_f32_16x16x32_bf16 v[126:129], v[218:221], a[176:179], v[126:129]
    global_load_dwordx4 v[202:205], v31, s[54:55] offset:3072 sc1
    s_waitcnt vmcnt(12)
    v_max3_u32 v28, v233, v237, v28
    v_mfma_f32_16x16x32_bf16 v[130:133], v[218:221], a[180:183], v[130:133]
    v_cmp_eq_u32 vcc, -1, v28
    v_mfma_f32_16x16x32_bf16 v[134:137], v[218:221], a[184:187], v[134:137]
    v_mfma_f32_16x16x32_bf16 v[138:141], v[218:221], a[188:191], v[138:141]
    s_cbranch_vccnz Lz3_r
Lz3_ok:
    v_mfma_f32_16x16x32_bf16 v[142:145], v[222:225], a[176:179], v[142:145]
    global_load_dwordx4 v[206:209], v30, s[56:57] offset:-3072 sc1
    s_barrier
    v_mfma_f32_16x16x32_bf16 v[146:149], v[222:225], a[180:183], v[146:149]
    s_lshl_b32 s4, s40, 5
    s_add_u32 s4, s4, 99328
    v_and_b32 v8, 7, v1
    v_mfma_f32_16x16x32_bf16 v[150:153], v[222:225], a[184:187], v[150:153]
    v_lshl_add_u32 v8, v8, 2, s4
    v_mfma_f32_16x16x32_bf16 v[154:157], v[222:225], a[188:191], v[154:157]
    s_lshl_b32 s5, s41, 2
    s_add_u32 s4, s4, s5
    v_mov_b32 v9, s4
    v_mfma_f32_16x16x32_bf16 v[158:161], v[226:229], a[176:179], v[158:161]
    global_load_dwordx4 v[210:213], v31, s[56:57] offset:-3072 sc1
    v_mfma_f32_16x16x32_bf16 v[162:165], v[226:229], a[180:183], v[162:165]
    s_cmp_lg_u32 s3, 0
    s_cbranch_scc1 Lpf_skip
    global_store_dword v9, v9, s[38:39] sc1
Lpf_skip:
    v_min_u32 v29, 27, v1
    v_mfma_f32_16x16x32_bf16 v[166:169], v[226:229], a[184:187], v[166:169]
    s_mul_i32 s4, s43, 28
    v_add_lshl_u32 v29, v29, s4, 7
    v_mfma_f32_16x16x32_bf16 v[170:173], v[226:229], a[188:191], v[170:173]
    global_load_dword v29, v29, s[64:65] sc1
    v_mfma_f32_16x16x32_bf16 v[62:65], v[230:233], a[192:195], v[62:65]
    global_load_dwordx4 v[214:217], v30, s[58:59] offset:-3072 sc1
    v_mfma_f32_16x16x32_bf16 v[66:69], v[230:233], a[196:199], v[66:69]
    v_mfma_f32_16x16x32_bf16 v[70:73], v[230:233], a[200:203], v[70:73]
    v_mfma_f32_16x16x32_bf16 v[74:77], v[230:233], a[204:207], v[74:77]
    s_waitcnt vmcnt(14)
    v_max_u32 v28, v241, v245
    v_mfma_f32_16x16x32_bf16 v[78:81], v[234:237], a[192:195], v[78:81]
    global_load_dwordx4 v[218:221], v31, s[58:59] offset:-3072 sc1
    s_waitcnt vmcnt(13)
    v_max3_u32 v28, v249, v253, v28
    v_mfma_f32_16x16x32_bf16 v[82:85], v[234:237], a[196:199], v[82:85]
    v_cmp_eq_u32 vcc, -1, v28
    v_mfma_f32_16x16x32_bf16 v[86:89], v[234:237], a[200:203], v[86:89]
    v_mfma_f32_16x16x32_bf16 v[90:93], v[234:237], a[204:207], v[90:93]
    s_cbranch_vccnz Lz4_r
Lz4_ok:
    v_mfma_f32_16x16x32_bf16 v[94:97], v[238:241], a[192:195], v[94:97]
    global_load_dwordx4 v[222:225], v30, s[60:61] offset:-3072 sc1
    v_mfma_f32_16x16x32_bf16 v[98:101], v[238:241], a[196:199], v[98:101]
    v_mfma_f32_16x16x32_bf16 v[102:105], v[238:241], a[200:203], v[102:105]
    v_mfma_f32_16x16x32_bf16 v[106:109], v[238:241], a[204:207], v[106:109]
    v_mfma_f32_16x16x32_bf16 v[110:113], v[242:245], a[192:195], v[110:113]
    global_load_dwordx4 v[226:229], v31, s[60:61] offset:-3072 sc1
    v_mfma_f32_16x16x32_bf16 v[114:117], v[242:245], a[196:199], v[114:117]
    v_mfma_f32_16x16x32_bf16 v[118:121], v[242:245], a[200:203], v[118:121]
    v_mfma_f32_16x16x32_bf16 v[122:125], v[242:245], a[204:207], v[122:125]
    v_mfma_f32_16x16x32_bf16 v[126:129], v[246:249], a[192:195], v[126:129]
    global_load_dwordx4 v[230:233], v30, s[62:63] offset:-3072 sc1
    v_mfma_f32_16x16x32_bf16 v[130:133], v[246:249], a[196:199], v[130:133]
    v_mfma_f32_16x16x32_bf16 v[134:137], v[246:249], a[200:203], v[134:137]
    v_mfma_f32_16x16x32_bf16 v[138:141], v[246:249], a[204:207], v[138:141]
    s_waitcnt vmcnt(14)
    v_max_u32 v28, v177, v181
    v_mfma_f32_16x16x32_bf16 v[142:145], v[250:253], a[192:195], v[142:145]
    global_load_dwordx4 v[234:237], v31, s[62:63] offset:-3072 sc1
    s_waitcnt vmcnt(13)
    v_max3_u32 v28, v185, v189, v28
    v_mfma_f32_16x16x32_bf16 v[146:149], v[250:253], a[196:199], v[146:149]
    v_cmp_eq_u32 vcc, -1, v28
    v_mfma_f32_16x16x32_bf16 v[150:153], v[250:253], a[200:203], v[150:153]
    v_mfma_f32_16x16x32_bf16 v[154:157], v[250:253], a[204:207], v[154:157]
    s_cbranch_vccnz Lz5_r
Lz5_ok:
    v_mfma_f32_16x16x32_bf16 v[158:161], v[174:177], a[192:195], v[158:161]
    global_load_dwordx4 v[238:241], v30, s[64:65] offset:-3072 sc1
    v_mfma_f32_16x16x32_bf16 v[162:165], v[174:177], a[196:199], v[162:165]
    v_mfma_f32_16x16x32_bf16 v[166:169], v[174:177], a[200:203], v[166:169]
    v_mfma_f32_16x16x32_bf16 v[170:173], v[174:177], a[204:207], v[170:173]
    v_mfma_f32_16x16x32_bf16 v[62:65], v[178:181], a[208:211], v[62:65]
    global_load_dwordx4 v[242:245], v31, s[64:65] offset:-3072 sc1
    v_mfma_f32_16x16x32_bf16 v[66:69], v[178:181], a[212:215], v[66:69]
    v_mfma_f32_16x16x32_bf16 v[70:73], v[178:181], a[216:219], v[70:73]
    v_mfma_f32_16x16x32_bf16 v[74:77], v[178:181], a[220:223], v[74:77]
    v_mfma_f32_16x16x32_bf16 v[78:81], v[182:185], a[208:211], v[78:81]
    global_load_dwordx4 v[246:249], v30, s[66:67] offset:-3072 sc1
    v_mfma_f32_16x16x32_bf16 v[82:85], v[182:185], a[212:215], v[82:85]
    v_mfma_f32_16x16x32_bf16 v[86:89], v[182:185], a[216:219], v[86:89]
    v_mfma_f32_16x16x32_bf16 v[90:93], v[182:185], a[220:223], v[90:93]
    s_waitcnt vmcnt(14)
    v_max_u32 v28, v193, v197
    v_mfma_f32_16x16x32_bf16 v[94:97], v[186:189], a[208:211], v[94:97]
    global_load_dwordx4 v[250:253], v31, s[66:67] offset:-3072 sc1
    s_waitcnt vmcnt(13)
    v_max3_u32 v28, v201, v205, v28
    v_mfma_f32_16x16x32_bf16 v[98:101], v[186:189], a[212:215], v[98:101]
    v_cmp_eq_u32 vcc, -1, v28
    v_mfma_f32_16x16x32_bf16 v[102:105], v[186:189], a[216:219], v[102:105]
    v_mfma_f32_16x16x32_bf16 v[106:109], v[186:189], a[220:223], v[106:109]
    s_cbranch_vccnz Lz6_r
Lz6_ok:
    v_mfma_f32_16x16x32_bf16 v[110:113], v[190:193], a[208:211], v[110:113]
    global_load_dwordx4 v[174:177], v30, s[56:57] offset:-2048 sc1
    v_mfma_f32_16x16x32_bf16 v[114:117], v[190:193], a[212:215], v[114:117]
    v_mfma_f32_16x16x32_bf16 v[118:121], v[190:193], a[216:219], v[118:121]
    v_mfma_f32_16x16x32_bf16 v[122:125], v[190:193], a[220:223], v[122:125]
    v_mfma_f32_16x16x32_bf16 v[126:129], v[194:197], a[208:211], v[126:129]
    global_load_dwordx4 v[178:181], v31, s[56:57] offset:-2048 sc1
    v_mfma_f32_16x16x32_bf16 v[130:133], v[194:197], a[212:215], v[130:133]
    v_mfma_f32_16x16x32_bf16 v[134:137], v[194:197], a[216:219], v[134:137]
    v_mfma_f32_16x16x32_bf16 v[138:141], v[194:197], a[220:223], v[138:141]
    v_mfma_f32_16x16x32_bf16 v[142:145], v[198:201], a[208:211], v[142:145]
    global_load_dwordx4 v[182:185], v30, s[58:59] offset:-2048 sc1
    v_mfma_f32_16x16x32_bf16 v[146:149], v[198:201], a[212:215], v[146:149]
    v_mfma_f32_16x16x32_bf16 v[150:153], v[198:201], a[216:219], v[150:153]
    v_mfma_f32_16x16x32_bf16 v[154:157], v[198:201], a[220:223], v[154:157]
    s_waitcnt vmcnt(14)
    v_max_u32 v28, v209, v213
    v_mfma_f32_16x16x32_bf16 v[158:161], v[202:205], a[208:211], v[158:161]
    global_load_dwordx4 v[186:189], v31, s[58:59] offset:-2048 sc1
    s_waitcnt vmcnt(12)
    v_max3_u32 v28, v217, v221, v28
    v_mfma_f32_16x16x32_bf16 v[162:165], v[202:205], a[212:215], v[162:165]
    v_cmp_eq_u32 vcc, -1, v28
    v_mfma_f32_16x16x32_bf16 v[166:169], v[202:205], a[216:219], v[166:169]
    v_mfma_f32_16x16x32_bf16 v[170:173], v[202:205], a[220:223], v[170:173]
    s_cbranch_vccnz Lz7_r
Lz7_ok:
    v_mfma_f32_16x16x32_bf16 v[62:65], v[206:209], a[224:227], v[62:65]
    global_load_dwordx4 v[190:193], v30, s[60:61] offset:-2048 sc1
    v_mfma_f32_16x16x32_bf16 v[66:69], v[206:209], a[228:231], v[66:69]
    v_mfma_f32_16x16x32_bf16 v[70:73], v[206:209], a[232:235], v[70:73]
    v_mfma_f32_16x16x32_bf16 v[74:77], v[206:209], a[236:239], v[74:77]
    v_mfma_f32_16x16x32_bf16 v[62:65], v[210:213], a[240:243], v[62:65]
    global_load_dwordx4 v[194:197], v31, s[60:61] offset:-2048 sc1
    v_mfma_f32_16x16x32_bf16 v[66:69], v[210:213], a[244:247], v[66:69]
    v_mfma_f32_16x16x32_bf16 v[70:73], v[210:213], a[248:251], v[70:73]
    v_mfma_f32_16x16x32_bf16 v[74:77], v[210:213], a[252:255], v[74:77]
    v_mfma_f32_16x16x32_bf16 v[62:65], v[214:217], a[0:3], v[62:65]
    global_load_dwordx4 v[198:201], v30, s[62:63] offset:-2048 sc1
    v_mfma_f32_16x16x32_bf16 v[66:69], v[214:217], a[4:7], v[66:69]
    v_mfma_f32_16x16x32_bf16 v[70:73], v[214:217], a[8:11], v[70:73]
    v_mfma_f32_16x16x32_bf16 v[74:77], v[214:217], a[12:15], v[74:77]
    s_waitcnt vmcnt(13)
    v_max_u32 v28, v225, v229
    v_mfma_f32_16x16x32_bf16 v[62:65], v[218:221], a[16:19], v[62:65]
    global_load_dwordx4 v[202:205], v31, s[62:63] offset:-2048 sc1
    s_waitcnt vmcnt(12)
    v_max3_u32 v28, v233, v237, v28
    v_mfma_f32_16x16x32_bf16 v[66:69], v[218:221], a[20:23], v[66:69]
    v_cmp_eq_u32 vcc, -1, v28
    v_mfma_f32_16x16x32_bf16 v[70:73], v[218:221], a[24:27], v[70:73]
    v_mfma_f32_16x16x32_bf16 v[74:77], v[218:221], a[28:31], v[74:77]
    s_cbranch_vccnz Lz8_r
Lz8_ok:
    v_mfma_f32_16x16x32_bf16 v[62:65], v[222:225], a[32:35], v[62:65]
    global_load_dwordx4 v[206:209], v30, s[64:65] offset:-2048 sc1
    v_mfma_f32_16x16x32_bf16 v[66:69], v[222:225], a[36:39], v[66:69]
    v_mfma_f32_16x16x32_bf16 v[70:73], v[222:225], a[40:43], v[70:73]
    v_mfma_f32_16x16x32_bf16 v[74:77], v[222:225], a[44:47], v[74:77]
    v_mfma_f32_16x16x32_bf16 v[62:65], v[226:229], a[48:51], v[62:65]
    global_load_dwordx4 v[210:213], v31, s[64:65] offset:-2048 sc1
    v_mfma_f32_16x16x32_bf16 v[66:69], v[226:229], a[52:55], v[66:69]
    v_mfma_f32_16x16x32_bf16 v[70:73], v[226:229], a[56:59], v[70:73]
    v_mfma_f32_16x16x32_bf16 v[74:77], v[226:229], a[60:63], v[74:77]
    v_mfma_f32_16x16x32_bf16 v[62:65], v[230:233], a[64:67], v[62:65]
    global_load_dwordx4 v[214:217], v30, s[66:67] offset:-2048 sc1
    v_mfma_f32_16x16x32_bf16 v[66:69], v[230:233], a[68:71], v[66:69]
    v_mfma_f32_16x16x32_bf16 v[70:73], v[230:233], a[72:75], v[70:73]
    v_mfma_f32_16x16x32_bf16 v[74:77], v[230:233], a[76:79], v[74:77]
    s_waitcnt vmcnt(13)
    v_max_u32 v28, v241, v245
    v_mfma_f32_16x16x32_bf16 v[62:65], v[234:237], a[80:83], v[62:65]
    global_load_dwordx4 v[218:221], v31, s[66:67] offset:-2048 sc1
    s_waitcnt vmcnt(12)
    v_max3_u32 v28, v249, v253, v28
    v_mfma_f32_16x16x32_bf16 v[66:69], v[234:237], a[84:87], v[66:69]
    v_cmp_eq_u32 vcc, -1, v28
    v_mfma_f32_16x16x32_bf16 v[70:73], v[234:237], a[88:91], v[70:73]
    v_mfma_f32_16x16x32_bf16 v[74:77], v[234:237], a[92:95], v[74:77]
    s_cbranch_vccnz Lz9_r
Lz9_ok:
    v_mfma_f32_16x16x32_bf16 v[62:65], v[238:241], a[96:99], v[62:65]
    global_load_dwordx4 v[222:225], v30, s[56:57] offset:-1024 sc1
    v_mfma_f32_16x16x32_bf16 v[66:69], v[238:241], a[100:103], v[66:69]
    v_mfma_f32_16x16x32_bf16 v[70:73], v[238:241], a[104:107], v[70:73]
    v_mfma_f32_16x16x32_bf16 v[74:77], v[238:241], a[108:111], v[74:77]
    v_mfma_f32_16x16x32_bf16 v[62:65], v[242:245], a[112:115], v[62:65]
    global_load_dwordx4 v[226:229], v31, s[56:57] offset:-1024 sc1
    v_mfma_f32_16x16x32_bf16 v[66:69], v[242:245], a[116:119], v[66:69]
    v_mfma_f32_16x16x32_bf16 v[70:73], v[242:245], a[120:123], v[70:73]
    v_mfma_f32_16x16x32_bf16 v[74:77], v[242:245], a[124:127], v[74:77]
    v_mfma_f32_16x16x32_bf16 v[62:65], v[246:249], a[128:131], v[62:65]
    global_load_dwordx4 v[230:233], v30, s[58:59] offset:-1024 sc1
    v_mfma_f32_16x16x32_bf16 v[66:69], v[246:249], a[132:135], v[66:69]
    v_mfma_f32_16x16x32_bf16 v[70:73], v[246:249], a[136:139], v[70:73]
    v_mfma_f32_16x16x32_bf16 v[74:77], v[246:249], a[140:143], v[74:77]
    s_waitcnt vmcnt(13)
    v_max_u32 v28, v177, v181
    v_mfma_f32_16x16x32_bf16 v[62:65], v[250:253], a[144:147], v[62:65]
    global_load_dwordx4 v[234:237], v31, s[58:59] offset:-1024 sc1
    s_waitcnt vmcnt(12)
    v_max3_u32 v28, v185, v189, v28
    v_mfma_f32_16x16x32_bf16 v[66:69], v[250:253], a[148:151], v[66:69]
    v_cmp_eq_u32 vcc, -1, v28
    v_mfma_f32_16x16x32_bf16 v[70:73], v[250:253], a[152:155], v[70:73]
    v_mfma_f32_16x16x32_bf16 v[74:77], v[250:253], a[156:159], v[74:77]
    s_cbranch_vccnz Lz10_r
Lz10_ok:
    v_mfma_f32_16x16x32_bf16 v[78:81], v[174:177], a[224:227], v[78:81]
    global_load_dwordx4 v[238:241], v30, s[60:61] offset:-1024 sc1
    v_mfma_f32_16x16x32_bf16 v[82:85], v[174:177], a[228:231], v[82:85]
    v_mfma_f32_16x16x32_bf16 v[86:89], v[174:177], a[232:235], v[86:89]
    v_mfma_f32_16x16x32_bf16 v[90:93], v[174:177], a[236:239], v[90:93]
    ds_write_b128 v20, v[66:69] offset:0
    v_mfma_f32_16x16x32_bf16 v[78:81], v[178:181], a[240:243], v[78:81]
    global_load_dwordx4 v[242:245], v31, s[60:61] offset:-1024 sc1
    v_mfma_f32_16x16x32_bf16 v[82:85], v[178:181], a[244:247], v[82:85]
    v_mfma_f32_16x16x32_bf16 v[86:89], v[178:181], a[248:251], v[86:89]
    ds_write_b128 v21, v[70:73] offset:0
    v_mfma_f32_16x16x32_bf16 v[90:93], v[178:181], a[252:255], v[90:93]
    v_mfma_f32_16x16x32_bf16 v[78:81], v[182:185], a[0:3], v[78:81]
    global_load_dwordx4 v[246:249], v30, s[62:63] offset:-1024 sc1
    v_mfma_f32_16x16x32_bf16 v[82:85], v[182:185], a[4:7], v[82:85]
    ds_write_b128 v22, v[74:77] offset:0
    v_mfma_f32_16x16x32_bf16 v[86:89], v[182:185], a[8:11], v[86:89]
    v_mfma_f32_16x16x32_bf16 v[90:93], v[182:185], a[12:15], v[90:93]
    s_waitcnt vmcnt(13)
    v_max_u32 v28, v193, v197
    v_mfma_f32_16x16x32_bf16 v[78:81], v[186:189], a[16:19], v[78:81]
    global_load_dwordx4 v[250:253], v31, s[62:63] offset:-1024 sc1
    s_waitcnt vmcnt(12)
    v_max3_u32 v28, v201, v205, v28
    s_waitcnt lgkmcnt(0)
    s_barrier
    v_mfma_f32_16x16x32_bf16 v[82:85], v[186:189], a[20:23], v[82:85]
    v_cmp_eq_u32 vcc, -1, v28
    v_mfma_f32_16x16x32_bf16 v[86:89], v[186:189], a[24:27], v[86:89]
    v_mfma_f32_16x16x32_bf16 v[90:93], v[186:189], a[28:31], v[90:93]
    s_cbranch_vccnz Lz11_r
Lz11_ok:
    v_mfma_f32_16x16x32_bf16 v[78:81], v[190:193], a[32:35], v[78:81]
    global_load_dwordx4 v[174:177], v30, s[64:65] offset:-1024 sc1
    ds_read_b128 v[66:69], v23 offset:0
    v_mfma_f32_16x16x32_bf16 v[82:85], v[190:193], a[36:39], v[82:85]
    ds_read_b128 v[70:73], v23 offset:1024
    v_mfma_f32_16x16x32_bf16 v[86:89], v[190:193], a[40:43], v[86:89]
    ds_read_b128 v[74:77], v23 offset:2048
    v_mfma_f32_16x16x32_bf16 v[90:93], v[190:193], a[44:47], v[90:93]
    v_lshlrev_b32 v12, 16, v48
    v_mfma_f32_16x16x32_bf16 v[78:81], v[194:197], a[48:51], v[78:81]
    global_load_dwordx4 v[178:181], v31, s[64:65] offset:-1024 sc1
    v_and_b32 v13, 0xffff0000, v48
    v_mfma_f32_16x16x32_bf16 v[82:85], v[194:197], a[52:55], v[82:85]
    v_lshlrev_b32 v14, 16, v49
    v_mfma_f32_16x16x32_bf16 v[86:89], v[194:197], a[56:59], v[86:89]
    v_and_b32 v15, 0xffff0000, v49
    v_mfma_f32_16x16x32_bf16 v[90:93], v[194:197], a[60:63], v[90:93]
    v_mfma_f32_16x16x32_bf16 v[78:81], v[198:201], a[64:67], v[78:81]
    global_load_dwordx4 v[182:185], v30, s[66:67] offset:-1024 sc1
    s_waitcnt lgkmcnt(2)
    v_add_f32 v62, v62, v66
    v_mfma_f32_16x16x32_bf16 v[82:85], v[198:201], a[68:71], v[82:85]
    v_add_f32 v63, v63, v67
    v_mfma_f32_16x16x32_bf16 v[86:89], v[198:201], a[72:75], v[86:89]
    v_add_f32 v64, v64, v68
    v_mfma_f32_16x16x32_bf16 v[90:93], v[198:201], a[76:79], v[90:93]
    s_waitcnt vmcnt(13)
    v_max_u32 v28, v209, v213
    v_add_f32 v65, v65, v69
    v_mfma_f32_16x16x32_bf16 v[78:81], v[202:205], a[80:83], v[78:81]
    global_load_dwordx4 v[186:189], v31, s[66:67] offset:-1024 sc1
    s_waitcnt vmcnt(12)
    v_max3_u32 v28, v217, v221, v28
    s_waitcnt lgkmcnt(1)
    v_add_f32 v62, v62, v70
    v_mfma_f32_16x16x32_bf16 v[82:85], v[202:205], a[84:87], v[82:85]
    v_cmp_eq_u32 vcc, -1, v28
    v_add_f32 v63, v63, v71
    v_mfma_f32_16x16x32_bf16 v[86:89], v[202:205], a[88:91], v[86:89]
    v_add_f32 v64, v64, v72
    v_mfma_f32_16x16x32_bf16 v[90:93], v[202:205], a[92:95], v[90:93]
    s_cbranch_vccnz Lz12_r
Lz12_ok:
    v_mfma_f32_16x16x32_bf16 v[78:81], v[206:209], a[96:99], v[78:81]
    global_load_dwordx4 v[190:193], v30, s[56:57] offset:0 sc1
    v_add_f32 v65, v65, v73
    v_mfma_f32_16x16x32_bf16 v[82:85], v[206:209], a[100:103], v[82:85]
    s_waitcnt lgkmcnt(0)
    v_add_f32 v62, v62, v74
    v_mfma_f32_16x16x32_bf16 v[86:89], v[206:209], a[104:107], v[86:89]
    v_add_f32 v63, v63, v75
    v_mfma_f32_16x16x32_bf16 v[90:93], v[206:209], a[108:111], v[90:93]
    v_add_f32 v64, v64, v76
    v_mfma_f32_16x16x32_bf16 v[78:81], v[210:213], a[112:115], v[78:81]
    global_load_dwordx4 v[194:197], v31, s[56:57] offset:0 sc1
    v_add_f32 v65, v65, v77
    v_mfma_f32_16x16x32_bf16 v[82:85], v[210:213], a[116:119], v[82:85]
    v_mfma_f32_16x16x32_bf16 v[86:89], v[210:213], a[120:123], v[86:89]
    v_mul_f32 v62, v62, v12
    v_mfma_f32_16x16x32_bf16 v[90:93], v[210:213], a[124:127], v[90:93]
    v_mul_f32 v63, v63, v13
    v_mfma_f32_16x16x32_bf16 v[78:81], v[214:217], a[128:131], v[78:81]
    global_load_dwordx4 v[198:201], v30, s[58:59] offset:0 sc1
    v_mul_f32 v64, v64, v14
    v_mfma_f32_16x16x32_bf16 v[82:85], v[214:217], a[132:135], v[82:85]
    v_mul_f32 v65, v65, v15
    v_mfma_f32_16x16x32_bf16 v[86:89], v[214:217], a[136:139], v[86:89]
    v_mfma_f32_16x16x32_bf16 v[90:93], v[214:217], a[140:143], v[90:93]
    s_waitcnt vmcnt(13)
    v_max_u32 v28, v225, v229
    v_cvt_pk_bf16_f32 v48, v62, v63
    v_mfma_f32_16x16x32_bf16 v[78:81], v[218:221], a[144:147], v[78:81]
    global_load_dwordx4 v[202:205], v31, s[58:59] offset:0 sc1
    s_waitcnt vmcnt(12)
    v_max3_u32 v28, v233, v237, v28
    v_cvt_pk_bf16_f32 v49, v64, v65
    v_mfma_f32_16x16x32_bf16 v[82:85], v[218:221], a[148:151], v[82:85]
    v_cmp_eq_u32 vcc, -1, v28
    v_min_u32 v48, -2, v48
    v_mfma_f32_16x16x32_bf16 v[86:89], v[218:221], a[152:155], v[86:89]
    v_min_u32 v49, -2, v49
    v_mfma_f32_16x16x32_bf16 v[90:93], v[218:221], a[156:159], v[90:93]
    s_cbranch_vccnz Lz13_r
Lz13_ok:
    v_mfma_f32_16x16x32_bf16 v[94:97], v[222:225], a[224:227], v[94:97]
    global_load_dwordx4 v[206:209], v30, s[60:61] offset:0 sc1
    v_mfma_f32_16x16x32_bf16 v[98:101], v[222:225], a[228:231], v[98:101]
    v_mfma_f32_16x16x32_bf16 v[102:105], v[222:225], a[232:235], v[102:105]
    v_mfma_f32_16x16x32_bf16 v[106:109], v[222:225], a[236:239], v[106:109]
    ds_write_b128 v20, v[82:85] offset:12288
    v_mfma_f32_16x16x32_bf16 v[94:97], v[226:229], a[240:243], v[94:97]
    global_load_dwordx4 v[210:213], v31, s[60:61] offset:0 sc1
    v_mfma_f32_16x16x32_bf16 v[98:101], v[226:229], a[244:247], v[98:101]
    v_mfma_f32_16x16x32_bf16 v[102:105], v[226:229], a[248:251], v[102:105]
    ds_write_b128 v21, v[86:89] offset:12288
    v_mfma_f32_16x16x32_bf16 v[106:109], v[226:229], a[252:255], v[106:109]
    v_mfma_f32_16x16x32_bf16 v[94:97], v[230:233], a[0:3], v[94:97]
    global_load_dwordx4 v[214:217], v30, s[62:63] offset:0 sc1
    v_mfma_f32_16x16x32_bf16 v[98:101], v[230:233], a[4:7], v[98:101]
    ds_write_b128 v22, v[90:93] offset:12288
    v_mfma_f32_16x16x32_bf16 v[102:105], v[230:233], a[8:11], v[102:105]
    v_mfma_f32_16x16x32_bf16 v[106:109], v[230:233], a[12:15], v[106:109]
    s_waitcnt vmcnt(13)
    v_max_u32 v28, v241, v245
    v_mfma_f32_16x16x32_bf16 v[94:97], v[234:237], a[16:19], v[94:97]
    global_load_dwordx4 v[218:221], v31, s[62:63] offset:0 sc1
    s_waitcnt vmcnt(12)
    v_max3_u32 v28, v249, v253, v28
    s_waitcnt lgkmcnt(0)
    s_barrier
    v_mfma_f32_16x16x32_bf16 v[98:101], v[234:237], a[20:23], v[98:101]
    v_cmp_eq_u32 vcc, -1, v28
    v_mfma_f32_16x16x32_bf16 v[102:105], v[234:237], a[24:27], v[102:105]
    v_mfma_f32_16x16x32_bf16 v[106:109], v[234:237], a[28:31], v[106:109]
    s_cbranch_vccnz Lz14_r
Lz14_ok:
    v_mfma_f32_16x16x32_bf16 v[94:97], v[238:241], a[32:35], v[94:97]
    global_load_dwordx4 v[222:225], v30, s[64:65] offset:0 sc1
    ds_read_b128 v[82:85], v23 offset:12288
    v_mfma_f32_16x16x32_bf16 v[98:101], v[238:241], a[36:39], v[98:101]
    ds_read_b128 v[86:89], v23 offset:13312
    v_mfma_f32_16x16x32_bf16 v[102:105], v[238:241], a[40:43], v[102:105]
    ds_read_b128 v[90:93], v23 offset:14336
    v_mfma_f32_16x16x32_bf16 v[106:109], v[238:241], a[44:47], v[106:109]
    v_lshlrev_b32 v12, 16, v50
    v_mfma_f32_16x16x32_bf16 v[94:97], v[242:245], a[48:51], v[94:97]
    global_load_dwordx4 v[226:229], v31, s[64:65] offset:0 sc1
    v_and_b32 v13, 0xffff0000, v50
    v_mfma_f32_16x16x32_bf16 v[98:101], v[242:245], a[52:55], v[98:101]
    v_lshlrev_b32 v14, 16, v51
    v_mfma_f32_16x16x32_bf16 v[102:105], v[242:245], a[56:59], v[102:105]
    v_and_b32 v15, 0xffff0000, v51
    v_mfma_f32_16x16x32_bf16 v[106:109], v[242:245], a[60:63], v[106:109]
    v_mfma_f32_16x16x32_bf16 v[94:97], v[246:249], a[64:67], v[94:97]
    global_load_dwordx4 v[230:233], v30, s[66:67] offset:0 sc1
    s_waitcnt lgkmcnt(2)
    v_add_f32 v78, v78, v82
    v_mfma_f32_16x16x32_bf16 v[98:101], v[246:249], a[68:71], v[98:101]
    v_add_f32 v79, v79, v83
    v_mfma_f32_16x16x32_bf16 v[102:105], v[246:249], a[72:75], v[102:105]
    v_add_f32 v80, v80, v84
    v_mfma_f32_16x16x32_bf16 v[106:109], v[246:249], a[76:79], v[106:109]
    s_waitcnt vmcnt(13)
    v_max_u32 v28, v177, v181
    v_add_f32 v81, v81, v85
    v_mfma_f32_16x16x32_bf16 v[94:97], v[250:253], a[80:83], v[94:97]
    global_load_dwordx4 v[234:237], v31, s[66:67] offset:0 sc1
    s_waitcnt vmcnt(12)
    v_max3_u32 v28, v185, v189, v28
    s_waitcnt lgkmcnt(1)
    v_add_f32 v78, v78, v86
    v_mfma_f32_16x16x32_bf16 v[98:101], v[250:253], a[84:87], v[98:101]
    v_cmp_eq_u32 vcc, -1, v28
    v_add_f32 v79, v79, v87
    v_mfma_f32_16x16x32_bf16 v[102:105], v[250:253], a[88:91], v[102:105]
    v_add_f32 v80, v80, v88
    v_mfma_f32_16x16x32_bf16 v[106:109], v[250:253], a[92:95], v[106:109]
    s_cbranch_vccnz Lz15_r
Lz15_ok:
    v_mfma_f32_16x16x32_bf16 v[94:97], v[174:177], a[96:99], v[94:97]
    global_load_dwordx4 v[238:241], v30, s[56:57] offset:1024 sc1
    v_add_f32 v81, v81, v89
    v_mfma_f32_16x16x32_bf16 v[98:101], v[174:177], a[100:103], v[98:101]
    s_waitcnt lgkmcnt(0)
    v_add_f32 v78, v78, v90
    v_mfma_f32_16x16x32_bf16 v[102:105], v[174:177], a[104:107], v[102:105]
    v_add_f32 v79, v79, v91
    v_mfma_f32_16x16x32_bf16 v[106:109], v[174:177], a[108:111], v[106:109]
    v_add_f32 v80, v80, v92
    v_mfma_f32_16x16x32_bf16 v[94:97], v[178:181], a[112:115], v[94:97]
    global_load_dwordx4 v[242:245], v31, s[56:57] offset:1024 sc1
    v_add_f32 v81, v81, v93
    v_mfma_f32_16x16x32_bf16 v[98:101], v[178:181], a[116:119], v[98:101]
    v_mfma_f32_16x16x32_bf16 v[102:105], v[178:181], a[120:123], v[102:105]
    v_mul_f32 v78, v78, v12
    v_mfma_f32_16x16x32_bf16 v[106:109], v[178:181], a[124:127], v[106:109]
    v_mul_f32 v79, v79, v13
    v_mfma_f32_16x16x32_bf16 v[94:97], v[182:185], a[128:131], v[94:97]
    global_load_dwordx4 v[246:249], v30, s[58:59] offset:1024 sc1
    v_mul_f32 v80, v80, v14
    v_mfma_f32_16x16x32_bf16 v[98:101], v[182:185], a[132:135], v[98:101]
    v_mul_f32 v81, v81, v15
    v_mfma_f32_16x16x32_bf16 v[102:105], v[182:185], a[136:139], v[102:105]
    v_mfma_f32_16x16x32_bf16 v[106:109], v[182:185], a[140:143], v[106:109]
    s_waitcnt vmcnt(13)
    v_max_u32 v28, v193, v197
    v_cvt_pk_bf16_f32 v50, v78, v79
    v_mfma_f32_16x16x32_bf16 v[94:97], v[186:189], a[144:147], v[94:97]
    global_load_dwordx4 v[250:253], v31, s[58:59] offset:1024 sc1
    s_waitcnt vmcnt(12)
    v_max3_u32 v28, v201, v205, v28
    v_cvt_pk_bf16_f32 v51, v80, v81
    v_mfma_f32_16x16x32_bf16 v[98:101], v[186:189], a[148:151], v[98:101]
    v_cmp_eq_u32 vcc, -1, v28
    v_min_u32 v50, -2, v50
    v_mfma_f32_16x16x32_bf16 v[102:105], v[186:189], a[152:155], v[102:105]
    v_min_u32 v51, -2, v51
    v_mfma_f32_16x16x32_bf16 v[106:109], v[186:189], a[156:159], v[106:109]
    s_cbranch_vccnz Lz16_r
Lz16_ok:
    v_mfma_f32_16x16x32_bf16 v[110:113], v[190:193], a[224:227], v[110:113]
    global_load_dwordx4 v[174:177], v30, s[60:61] offset:1024 sc1
    v_mfma_f32_16x16x32_bf16 v[114:117], v[190:193], a[228:231], v[114:117]
    v_mfma_f32_16x16x32_bf16 v[118:121], v[190:193], a[232:235], v[118:121]
    v_mfma_f32_16x16x32_bf16 v[122:125], v[190:193], a[236:239], v[122:125]
    ds_write_b128 v20, v[98:101] offset:0
    v_mfma_f32_16x16x32_bf16 v[110:113], v[194:197], a[240:243], v[110:113]
    global_load_dwordx4 v[178:181], v31, s[60:61] offset:1024 sc1
    v_mfma_f32_16x16x32_bf16 v[114:117], v[194:197], a[244:247], v[114:117]
    v_mfma_f32_16x16x32_bf16 v[118:121], v[194:197], a[248:251], v[118:121]
    ds_write_b128 v21, v[102:105] offset:0
    v_mfma_f32_16x16x32_bf16 v[122:125], v[194:197], a[252:255], v[122:125]
    v_mfma_f32_16x16x32_bf16 v[110:113], v[198:201], a[0:3], v[110:113]
    global_load_dwordx4 v[182:185], v30, s[62:63] offset:1024 sc1
    v_mfma_f32_16x16x32_bf16 v[114:117], v[198:201], a[4:7], v[114:117]
    ds_write_b128 v22, v[106:109] offset:0
    v_mfma_f32_16x16x32_bf16 v[118:121], v[198:201], a[8:11], v[118:121]
    v_mfma_f32_16x16x32_bf16 v[122:125], v[198:201], a[12:15], v[122:125]
    s_waitcnt vmcnt(13)
    v_max_u32 v28, v209, v213
    v_mfma_f32_16x16x32_bf16 v[110:113], v[202:205], a[16:19], v[110:113]
    global_load_dwordx4 v[186:189], v31, s[62:63] offset:1024 sc1
    s_waitcnt vmcnt(12)
    v_max3_u32 v28, v217, v221, v28
    s_waitcnt lgkmcnt(0)
    s_barrier
    v_mfma_f32_16x16x32_bf16 v[114:117], v[202:205], a[20:23], v[114:117]
    v_cmp_eq_u32 vcc, -1, v28
    v_mfma_f32_16x16x32_bf16 v[118:121], v[202:205], a[24:27], v[118:121]
    v_mfma_f32_16x16x32_bf16 v[122:125], v[202:205], a[28:31], v[122:125]
    s_cbranch_vccnz Lz17_r
Lz17_ok:
    v_mfma_f32_16x16x32_bf16 v[110:113], v[206:209], a[32:35], v[110:113]
    global_load_dwordx4 v[190:193], v30, s[64:65] offset:1024 sc1
    ds_read_b128 v[98:101], v23 offset:0
    v_mfma_f32_16x16x32_bf16 v[114:117], v[206:209], a[36:39], v[114:117]
    ds_read_b128 v[102:105], v23 offset:1024
    v_mfma_f32_16x16x32_bf16 v[118:121], v[206:209], a[40:43], v[118:121]
    ds_read_b128 v[106:109], v23 offset:2048
    v_mfma_f32_16x16x32_bf16 v[122:125], v[206:209], a[44:47], v[122:125]
    v_lshlrev_b32 v12, 16, v52
    v_mfma_f32_16x16x32_bf16 v[110:113], v[210:213], a[48:51], v[110:113]
    global_load_dwordx4 v[194:197], v31, s[64:65] offset:1024 sc1
    v_and_b32 v13, 0xffff0000, v52
    v_mfma_f32_16x16x32_bf16 v[114:117], v[210:213], a[52:55], v[114:117]
    v_lshlrev_b32 v14, 16, v53
    v_mfma_f32_16x16x32_bf16 v[118:121], v[210:213], a[56:59], v[118:121]
    v_and_b32 v15, 0xffff0000, v53
    v_mfma_f32_16x16x32_bf16 v[122:125], v[210:213], a[60:63], v[122:125]
    v_mfma_f32_16x16x32_bf16 v[110:113], v[214:217], a[64:67], v[110:113]
    global_load_dwordx4 v[198:201], v30, s[66:67] offset:1024 sc1
    s_waitcnt lgkmcnt(2)
    v_add_f32 v94, v94, v98
    v_mfma_f32_16x16x32_bf16 v[114:117], v[214:217], a[68:71], v[114:117]
    v_add_f32 v95, v95, v99
    v_mfma_f32_16x16x32_bf16 v[118:121], v[214:217], a[72:75], v[118:121]
    v_add_f32 v96, v96, v100
    v_mfma_f32_16x16x32_bf16 v[122:125], v[214:217], a[76:79], v[122:125]
    s_waitcnt vmcnt(13)
    v_max_u32 v28, v225, v229
    v_add_f32 v97, v97, v101
    v_mfma_f32_16x16x32_bf16 v[110:113], v[218:221], a[80:83], v[110:113]
    global_load_dwordx4 v[202:205], v31, s[66:67] offset:1024 sc1
    s_waitcnt vmcnt(12)
    v_max3_u32 v28, v233, v237, v28
    s_waitcnt lgkmcnt(1)
    v_add_f32 v94, v94, v102
    v_mfma_f32_16x16x32_bf16 v[114:117], v[218:221], a[84:87], v[114:117]
    v_cmp_eq_u32 vcc, -1, v28
    v_add_f32 v95, v95, v103
    v_mfma_f32_16x16x32_bf16 v[118:121], v[218:221], a[88:91], v[118:121]
    v_add_f32 v96, v96, v104
    v_mfma_f32_16x16x32_bf16 v[122:125], v[218:221], a[92:95], v[122:125]
    s_cbranch_vccnz Lz18_r
Lz18_ok:
    v_mfma_f32_16x16x32_bf16 v[110:113], v[222:225], a[96:99], v[110:113]
    global_load_dwordx4 v[206:209], v30, s[56:57] offset:2048 sc1
    v_add_f32 v97, v97, v105
    v_mfma_f32_16x16x32_bf16 v[114:117], v[222:225], a[100:103], v[114:117]
    s_waitcnt lgkmcnt(0)
    v_add_f32 v94, v94, v106
    v_mfma_f32_16x16x32_bf16 v[118:121], v[222:225], a[104:107], v[118:121]
    v_add_f32 v95, v95, v107
    v_mfma_f32_16x16x32_bf16 v[122:125], v[222:225], a[108:111], v[122:125]
    v_add_f32 v96, v96, v108
    v_mfma_f32_16x16x32_bf16 v[110:113], v[226:229], a[112:115], v[110:113]
    global_load_dwordx4 v[210:213], v31, s[56:57] offset:2048 sc1
    v_add_f32 v97, v97, v109
    v_mfma_f32_16x16x32_bf16 v[114:117], v[226:229], a[116:119], v[114:117]
    v_mfma_f32_16x16x32_bf16 v[118:121], v[226:229], a[120:123], v[118:121]
    v_mul_f32 v94, v94, v12
    v_mfma_f32_16x16x32_bf16 v[122:125], v[226:229], a[124:127], v[122:125]
    v_mul_f32 v95, v95, v13
    v_mfma_f32_16x16x32_bf16 v[110:113], v[230:233], a[128:131], v[110:113]
    global_load_dwordx4 v[214:217], v30, s[58:59] offset:2048 sc1
    v_mul_f32 v96, v96, v14
    v_mfma_f32_16x16x32_bf16 v[114:117], v[230:233], a[132:135], v[114:117]
    v_mul_f32 v97, v97, v15
    v_mfma_f32_16x16x32_bf16 v[118:121], v[230:233], a[136:139], v[118:121]
    v_mfma_f32_16x16x32_bf16 v[122:125], v[230:233], a[140:143], v[122:125]
    s_waitcnt vmcnt(13)
    v_max_u32 v28, v241, v245
    v_cvt_pk_bf16_f32 v52, v94, v95
    v_mfma_f32_16x16x32_bf16 v[110:113], v[234:237], a[144:147], v[110:113]
    global_load_dwordx4 v[218:221], v31, s[58:59] offset:2048 sc1
    s_waitcnt vmcnt(12)
    v_max3_u32 v28, v249, v253, v28
    v_cvt_pk_bf16_f32 v53, v96, v97
    v_mfma_f32_16x16x32_bf16 v[114:117], v[234:237], a[148:151], v[114:117]
    v_cmp_eq_u32 vcc, -1, v28
    v_min_u32 v52, -2, v52
    v_mfma_f32_16x16x32_bf16 v[118:121], v[234:237], a[152:155], v[118:121]
    v_min_u32 v53, -2, v53
    v_mfma_f32_16x16x32_bf16 v[122:125], v[234:237], a[156:159], v[122:125]
    s_cbranch_vccnz Lz19_r
Lz19_ok:
    v_mfma_f32_16x16x32_bf16 v[126:129], v[238:241], a[224:227], v[126:129]
    global_load_dwordx4 v[222:225], v30, s[60:61] offset:2048 sc1
    v_mfma_f32_16x16x32_bf16 v[130:133], v[238:241], a[228:231], v[130:133]
    v_mfma_f32_16x16x32_bf16 v[134:137], v[238:241], a[232:235], v[134:137]
    v_mfma_f32_16x16x32_bf16 v[138:141], v[238:241], a[236:239], v[138:141]
    ds_write_b128 v20, v[114:117] offset:12288
    v_mfma_f32_16x16x32_bf16 v[126:129], v[242:245], a[240:243], v[126:129]
    global_load_dwordx4 v[226:229], v31, s[60:61] offset:2048 sc1
    v_mfma_f32_16x16x32_bf16 v[130:133], v[242:245], a[244:247], v[130:133]
    v_mfma_f32_16x16x32_bf16 v[134:137], v[242:245], a[248:251], v[134:137]
    ds_write_b128 v21, v[118:121] offset:12288
    v_mfma_f32_16x16x32_bf16 v[138:141], v[242:245], a[252:255], v[138:141]
    v_mfma_f32_16x16x32_bf16 v[126:129], v[246:249], a[0:3], v[126:129]
    global_load_dwordx4 v[230:233], v30, s[62:63] offset:2048 sc1
    v_mfma_f32_16x16x32_bf16 v[130:133], v[246:249], a[4:7], v[130:133]
    ds_write_b128 v22, v[122:125] offset:12288
    v_mfma_f32_16x16x32_bf16 v[134:137], v[246:249], a[8:11], v[134:137]
    v_mfma_f32_16x16x32_bf16 v[138:141], v[246:249], a[12:15], v[138:141]
    s_waitcnt vmcnt(13)
    v_max_u32 v28, v177, v181
    v_mfma_f32_16x16x32_bf16 v[126:129], v[250:253], a[16:19], v[126:129]
    global_load_dwordx4 v[234:237], v31, s[62:63] offset:2048 sc1
    s_waitcnt vmcnt(12)
    v_max3_u32 v28, v185, v189, v28
    s_waitcnt lgkmcnt(0)
    s_barrier
    v_mfma_f32_16x16x32_bf16 v[130:133], v[250:253], a[20:23], v[130:133]
    v_cmp_eq_u32 vcc, -1, v28
    v_mfma_f32_16x16x32_bf16 v[134:137], v[250:253], a[24:27], v[134:137]
    v_mfma_f32_16x16x32_bf16 v[138:141], v[250:253], a[28:31], v[138:141]
    s_cbranch_vccnz Lz20_r
Lz20_ok:
    v_mfma_f32_16x16x32_bf16 v[126:129], v[174:177], a[32:35], v[126:129]
    global_load_dwordx4 v[238:241], v30, s[64:65] offset:2048 sc1
    global_load_dword v9, v8, s[38:39] sc1
    ds_read_b128 v[114:117], v23 offset:12288
    v_mfma_f32_16x16x32_bf16 v[130:133], v[174:177], a[36:39], v[130:133]
    ds_read_b128 v[118:121], v23 offset:13312
    v_mfma_f32_16x16x32_bf16 v[134:137], v[174:177], a[40:43], v[134:137]
    ds_read_b128 v[122:125], v23 offset:14336
    v_mfma_f32_16x16x32_bf16 v[138:141], v[174:177], a[44:47], v[138:141]
    v_lshlrev_b32 v12, 16, v54
    v_mfma_f32_16x16x32_bf16 v[126:129], v[178:181], a[48:51], v[126:129]
    global_load_dwordx4 v[242:245], v31, s[64:65] offset:2048 sc1
    v_and_b32 v13, 0xffff0000, v54
    v_mfma_f32_16x16x32_bf16 v[130:133], v[178:181], a[52:55], v[130:133]
    v_lshlrev_b32 v14, 16, v55
    v_mfma_f32_16x16x32_bf16 v[134:137], v[178:181], a[56:59], v[134:137]
    v_and_b32 v15, 0xffff0000, v55
    v_mfma_f32_16x16x32_bf16 v[138:141], v[178:181], a[60:63], v[138:141]
    v_mfma_f32_16x16x32_bf16 v[126:129], v[182:185], a[64:67], v[126:129]
    global_load_dwordx4 v[246:249], v30, s[66:67] offset:2048 sc1
    s_waitcnt lgkmcnt(2)
    v_add_f32 v110, v110, v114
    v_mfma_f32_16x16x32_bf16 v[130:133], v[182:185], a[68:71], v[130:133]
    v_add_f32 v111, v111, v115
    v_mfma_f32_16x16x32_bf16 v[134:137], v[182:185], a[72:75], v[134:137]
    v_add_f32 v112, v112, v116
    v_mfma_f32_16x16x32_bf16 v[138:141], v[182:185], a[76:79], v[138:141]
    s_waitcnt vmcnt(14)
    v_max_u32 v28, v193, v197
    v_add_f32 v113, v113, v117
    v_mfma_f32_16x16x32_bf16 v[126:129], v[186:189], a[80:83], v[126:129]
    global_load_dwordx4 v[250:253], v31, s[66:67] offset:2048 sc1
    s_waitcnt vmcnt(13)
    v_max3_u32 v28, v201, v205, v28
    s_waitcnt lgkmcnt(1)
    v_add_f32 v110, v110, v118
    v_mfma_f32_16x16x32_bf16 v[130:133], v[186:189], a[84:87], v[130:133]
    v_cmp_eq_u32 vcc, -1, v28
    v_add_f32 v111, v111, v119
    v_mfma_f32_16x16x32_bf16 v[134:137], v[186:189], a[88:91], v[134:137]
    v_add_f32 v112, v112, v120
    v_mfma_f32_16x16x32_bf16 v[138:141], v[186:189], a[92:95], v[138:141]
    s_cbranch_vccnz Lz21_r
Lz21_ok:
    v_mfma_f32_16x16x32_bf16 v[126:129], v[190:193], a[96:99], v[126:129]
    global_load_dwordx4 v[174:177], v30, s[56:57] offset:3072 sc1
    v_add_f32 v113, v113, v121
    v_mfma_f32_16x16x32_bf16 v[130:133], v[190:193], a[100:103], v[130:133]
    s_waitcnt lgkmcnt(0)
    v_add_f32 v110, v110, v122
    v_mfma_f32_16x16x32_bf16 v[134:137], v[190:193], a[104:107], v[134:137]
    v_add_f32 v111, v111, v123
    v_mfma_f32_16x16x32_bf16 v[138:141], v[190:193], a[108:111], v[138:141]
    v_add_f32 v112, v112, v124
    v_mfma_f32_16x16x32_bf16 v[126:129], v[194:197], a[112:115], v[126:129]
    global_load_dwordx4 v[178:181], v31, s[56:57] offset:3072 sc1
    v_add_f32 v113, v113, v125
    v_mfma_f32_16x16x32_bf16 v[130:133], v[194:197], a[116:119], v[130:133]
    v_mfma_f32_16x16x32_bf16 v[134:137], v[194:197], a[120:123], v[134:137]
    v_mul_f32 v110, v110, v12
    v_mfma_f32_16x16x32_bf16 v[138:141], v[194:197], a[124:127], v[138:141]
    v_mul_f32 v111, v111, v13
    v_mfma_f32_16x16x32_bf16 v[126:129], v[198:201], a[128:131], v[126:129]
    global_load_dwordx4 v[182:185], v30, s[58:59] offset:3072 sc1
    v_mul_f32 v112, v112, v14
    v_mfma_f32_16x16x32_bf16 v[130:133], v[198:201], a[132:135], v[130:133]
    v_mul_f32 v113, v113, v15
    v_mfma_f32_16x16x32_bf16 v[134:137], v[198:201], a[136:139], v[134:137]
    v_mfma_f32_16x16x32_bf16 v[138:141], v[198:201], a[140:143], v[138:141]
    s_waitcnt vmcnt(14)
    v_max_u32 v28, v209, v213
    v_cvt_pk_bf16_f32 v54, v110, v111
    v_mfma_f32_16x16x32_bf16 v[126:129], v[202:205], a[144:147], v[126:129]
    global_load_dwordx4 v[186:189], v31, s[58:59] offset:3072 sc1
    s_waitcnt vmcnt(13)
    v_max3_u32 v28, v217, v221, v28
    v_cvt_pk_bf16_f32 v55, v112, v113
    v_mfma_f32_16x16x32_bf16 v[130:133], v[202:205], a[148:151], v[130:133]
    v_cmp_eq_u32 vcc, -1, v28
    v_min_u32 v54, -2, v54
    v_mfma_f32_16x16x32_bf16 v[134:137], v[202:205], a[152:155], v[134:137]
    v_min_u32 v55, -2, v55
    v_mfma_f32_16x16x32_bf16 v[138:141], v[202:205], a[156:159], v[138:141]
    s_cbranch_vccnz Lz22_r
Lz22_ok:
    v_mfma_f32_16x16x32_bf16 v[142:145], v[206:209], a[224:227], v[142:145]
    global_load_dwordx4 v[190:193], v30, s[60:61] offset:3072 sc1
    v_mfma_f32_16x16x32_bf16 v[146:149], v[206:209], a[228:231], v[146:149]
    v_mfma_f32_16x16x32_bf16 v[150:153], v[206:209], a[232:235], v[150:153]
    v_mfma_f32_16x16x32_bf16 v[154:157], v[206:209], a[236:239], v[154:157]
    ds_write_b128 v20, v[130:133] offset:0
    v_mfma_f32_16x16x32_bf16 v[142:145], v[210:213], a[240:243], v[142:145]
    global_load_dwordx4 v[194:197], v31, s[60:61] offset:3072 sc1
    v_mfma_f32_16x16x32_bf16 v[146:149], v[210:213], a[244:247], v[146:149]
    v_mfma_f32_16x16x32_bf16 v[150:153], v[210:213], a[248:251], v[150:153]
    ds_write_b128 v21, v[134:137] offset:0
    v_mfma_f32_16x16x32_bf16 v[154:157], v[210:213], a[252:255], v[154:157]
    v_mfma_f32_16x16x32_bf16 v[142:145], v[214:217], a[0:3], v[142:145]
    global_load_dwordx4 v[198:201], v30, s[62:63] offset:3072 sc1
    v_mfma_f32_16x16x32_bf16 v[146:149], v[214:217], a[4:7], v[146:149]
    ds_write_b128 v22, v[138:141] offset:0
    v_mfma_f32_16x16x32_bf16 v[150:153], v[214:217], a[8:11], v[150:153]
    v_mfma_f32_16x16x32_bf16 v[154:157], v[214:217], a[12:15], v[154:157]
    s_waitcnt vmcnt(14)
    v_max_u32 v28, v225, v229
    v_mfma_f32_16x16x32_bf16 v[142:145], v[218:221], a[16:19], v[142:145]
    global_load_dwordx4 v[202:205], v31, s[62:63] offset:3072 sc1
    s_waitcnt vmcnt(13)
    v_max3_u32 v28, v233, v237, v28
    s_waitcnt lgkmcnt(0)
    s_barrier
    v_mfma_f32_16x16x32_bf16 v[146:149], v[218:221], a[20:23], v[146:149]
    v_cmp_eq_u32 vcc, -1, v28
    v_mfma_f32_16x16x32_bf16 v[150:153], v[218:221], a[24:27], v[150:153]
    v_mfma_f32_16x16x32_bf16 v[154:157], v[218:221], a[28:31], v[154:157]
    s_cbranch_vccnz Lz23_r
Lz23_ok:
    v_mfma_f32_16x16x32_bf16 v[142:145], v[222:225], a[32:35], v[142:145]
    global_load_dwordx4 v[206:209], v30, s[64:65] offset:3072 sc1
    ds_read_b128 v[130:133], v23 offset:0
    v_mfma_f32_16x16x32_bf16 v[146:149], v[222:225], a[36:39], v[146:149]
    ds_read_b128 v[134:137], v23 offset:1024
    v_mfma_f32_16x16x32_bf16 v[150:153], v[222:225], a[40:43], v[150:153]
    ds_read_b128 v[138:141], v23 offset:2048
    v_mfma_f32_16x16x32_bf16 v[154:157], v[222:225], a[44:47], v[154:157]
    v_lshlrev_b32 v12, 16, v56
    v_mfma_f32_16x16x32_bf16 v[142:145], v[226:229], a[48:51], v[142:145]
    global_load_dwordx4 v[210:213], v31, s[64:65] offset:3072 sc1
    v_and_b32 v13, 0xffff0000, v56
    v_mfma_f32_16x16x32_bf16 v[146:149], v[226:229], a[52:55], v[146:149]
    v_lshlrev_b32 v14, 16, v57
    v_mfma_f32_16x16x32_bf16 v[150:153], v[226:229], a[56:59], v[150:153]
    v_and_b32 v15, 0xffff0000, v57
    v_mfma_f32_16x16x32_bf16 v[154:157], v[226:229], a[60:63], v[154:157]
    v_mfma_f32_16x16x32_bf16 v[142:145], v[230:233], a[64:67], v[142:145]
    global_load_dwordx4 v[214:217], v30, s[66:67] offset:3072 sc1
    s_waitcnt lgkmcnt(2)
    v_add_f32 v126, v126, v130
    v_mfma_f32_16x16x32_bf16 v[146:149], v[230:233], a[68:71], v[146:149]
    v_add_f32 v127, v127, v131
    v_mfma_f32_16x16x32_bf16 v[150:153], v[230:233], a[72:75], v[150:153]
    v_add_f32 v128, v128, v132
    v_mfma_f32_16x16x32_bf16 v[154:157], v[230:233], a[76:79], v[154:157]
    s_waitcnt vmcnt(13)
    v_max_u32 v28, v241, v245
    v_add_f32 v129, v129, v133
    v_mfma_f32_16x16x32_bf16 v[142:145], v[234:237], a[80:83], v[142:145]
    global_load_dwordx4 v[218:221], v31, s[66:67] offset:3072 sc1
    s_waitcnt vmcnt(12)
    v_max3_u32 v28, v249, v253, v28
    s_waitcnt lgkmcnt(1)
    v_add_f32 v126, v126, v134
    v_mfma_f32_16x16x32_bf16 v[146:149], v[234:237], a[84:87], v[146:149]
    v_cmp_eq_u32 vcc, -1, v28
    v_add_f32 v127, v127, v135
    v_mfma_f32_16x16x32_bf16 v[150:153], v[234:237], a[88:91], v[150:153]
    v_add_f32 v128, v128, v136
    v_mfma_f32_16x16x32_bf16 v[154:157], v[234:237], a[92:95], v[154:157]
    s_cbranch_vccnz Lz24_r
Lz24_ok:
    v_cmp_eq_u32 vcc, -1, v9
    s_nop 0
    s_cbranch_vccnz Lpf_r
Lpf_ok:
    v_mfma_f32_16x16x32_bf16 v[142:145], v[238:241], a[96:99], v[142:145]
    global_store_dwordx4 v24, v[48:51], s[38:39] offset:0 sc1
    v_add_f32 v129, v129, v137
    v_mfma_f32_16x16x32_bf16 v[146:149], v[238:241], a[100:103], v[146:149]
    s_waitcnt lgkmcnt(0)
    v_add_f32 v126, v126, v138
    v_mfma_f32_16x16x32_bf16 v[150:153], v[238:241], a[104:107], v[150:153]
    global_store_dwordx4 v24, v[52:55], s[38:39] offset:1024 sc1
    v_add_f32 v127, v127, v139
    v_mfma_f32_16x16x32_bf16 v[154:157], v[238:241], a[108:111], v[154:157]
    v_add_f32 v128, v128, v140
    v_mfma_f32_16x16x32_bf16 v[142:145], v[242:245], a[112:115], v[142:145]
    v_add_f32 v129, v129, v141
    v_mfma_f32_16x16x32_bf16 v[146:149], v[242:245], a[116:119], v[146:149]
    global_load_lds_dwordx4 v4, s[92:93] offset:2048 sc1
    v_mfma_f32_16x16x32_bf16 v[150:153], v[242:245], a[120:123], v[150:153]
    v_mul_f32 v126, v126, v12
    v_mfma_f32_16x16x32_bf16 v[154:157], v[242:245], a[124:127], v[154:157]
    v_mul_f32 v127, v127, v13
    v_mfma_f32_16x16x32_bf16 v[142:145], v[246:249], a[128:131], v[142:145]
    global_load_lds_dwordx4 v4, s[92:93] offset:3072 sc1
    v_mul_f32 v128, v128, v14
    v_mfma_f32_16x16x32_bf16 v[146:149], v[246:249], a[132:135], v[146:149]
    v_mul_f32 v129, v129, v15
    v_mfma_f32_16x16x32_bf16 v[150:153], v[246:249], a[136:139], v[150:153]
    s_add_u32 m0, s95, 20480
    s_add_u32 s92, s92, 4096
    s_addc_u32 s93, s93, 0
    global_load_lds_dwordx4 v4, s[92:93] offset:0 sc1
    v_mfma_f32_16x16x32_bf16 v[154:157], v[246:249], a[140:143], v[154:157]
    s_waitcnt vmcnt(15)
    v_max_u32 v28, v177, v181
    v_cvt_pk_bf16_f32 v56, v126, v127
    v_mfma_f32_16x16x32_bf16 v[142:145], v[250:253], a[144:147], v[142:145]
    s_waitcnt vmcnt(13)
    v_max3_u32 v28, v185, v189, v28
    v_cvt_pk_bf16_f32 v57, v128, v129
    v_mfma_f32_16x16x32_bf16 v[146:149], v[250:253], a[148:151], v[146:149]
    global_load_lds_dwordx4 v4, s[92:93] offset:1024 sc1
    v_cmp_eq_u32 vcc, -1, v28
    v_min_u32 v56, -2, v56
    v_mfma_f32_16x16x32_bf16 v[150:153], v[250:253], a[152:155], v[150:153]
    v_min_u32 v57, -2, v57
    v_mfma_f32_16x16x32_bf16 v[154:157], v[250:253], a[156:159], v[154:157]
    s_cbranch_vccnz Lz25_r
Lz25_ok:
    v_mfma_f32_16x16x32_bf16 v[158:161], v[174:177], a[224:227], v[158:161]
    global_load_lds_dwordx4 v4, s[92:93] offset:2048 sc1
    v_mfma_f32_16x16x32_bf16 v[162:165], v[174:177], a[228:231], v[162:165]
    v_mfma_f32_16x16x32_bf16 v[166:169], v[174:177], a[232:235], v[166:169]
    v_mfma_f32_16x16x32_bf16 v[170:173], v[174:177], a[236:239], v[170:173]
    ds_write_b128 v20, v[146:149] offset:12288
    v_mfma_f32_16x16x32_bf16 v[158:161], v[178:181], a[240:243], v[158:161]
    global_load_lds_dwordx4 v4, s[92:93] offset:3072 sc1
    v_mfma_f32_16x16x32_bf16 v[162:165], v[178:181], a[244:247], v[162:165]
    v_mfma_f32_16x16x32_bf16 v[166:169], v[178:181], a[248:251], v[166:169]
    ds_write_b128 v21, v[150:153] offset:12288
    v_mfma_f32_16x16x32_bf16 v[170:173], v[178:181], a[252:255], v[170:173]
    v_mfma_f32_16x16x32_bf16 v[158:161], v[182:185], a[0:3], v[158:161]
    s_add_u32 m0, s95, 24576
    s_add_u32 s92, s92, 4096
    s_addc_u32 s93, s93, 0
    global_load_lds_dwordx4 v4, s[92:93] offset:0 sc1
    v_mfma_f32_16x16x32_bf16 v[162:165], v[182:185], a[4:7], v[162:165]
    ds_write_b128 v22, v[154:157] offset:12288
    v_mfma_f32_16x16x32_bf16 v[166:169], v[182:185], a[8:11], v[166:169]
    v_mfma_f32_16x16x32_bf16 v[170:173], v[182:185], a[12:15], v[170:173]
    s_waitcnt vmcnt(15)
    v_max_u32 v28, v193, v197
    v_mfma_f32_16x16x32_bf16 v[158:161], v[186:189], a[16:19], v[158:161]
    global_load_lds_dwordx4 v4, s[92:93] offset:1024 sc1
    s_waitcnt vmcnt(14)
    v_max3_u32 v28, v201, v205, v28
    s_waitcnt lgkmcnt(0)
    s_barrier
    v_mfma_f32_16x16x32_bf16 v[162:165], v[186:189], a[20:23], v[162:165]
    v_cmp_eq_u32 vcc, -1, v28
    v_mfma_f32_16x16x32_bf16 v[166:169], v[186:189], a[24:27], v[166:169]
    v_mfma_f32_16x16x32_bf16 v[170:173], v[186:189], a[28:31], v[170:173]
    s_cbranch_vccnz Lz26_r
Lz26_ok:
    v_mfma_f32_16x16x32_bf16 v[158:161], v[190:193], a[32:35], v[158:161]
    global_load_lds_dwordx4 v4, s[92:93] offset:2048 sc1
    ds_read_b128 v[146:149], v23 offset:12288
    v_mfma_f32_16x16x32_bf16 v[162:165], v[190:193], a[36:39], v[162:165]
    ds_read_b128 v[150:153], v23 offset:13312
    v_mfma_f32_16x16x32_bf16 v[166:169], v[190:193], a[40:43], v[166:169]
    ds_read_b128 v[154:157], v23 offset:14336
    v_mfma_f32_16x16x32_bf16 v[170:173], v[190:193], a[44:47], v[170:173]
    v_lshlrev_b32 v12, 16, v58
    v_mfma_f32_16x16x32_bf16 v[158:161], v[194:197], a[48:51], v[158:161]
    global_load_lds_dwordx4 v4, s[92:93] offset:3072 sc1
    v_and_b32 v13, 0xffff0000, v58
    v_mfma_f32_16x16x32_bf16 v[162:165], v[194:197], a[52:55], v[162:165]
    v_lshlrev_b32 v14, 16, v59
    v_mfma_f32_16x16x32_bf16 v[166:169], v[194:197], a[56:59], v[166:169]
    v_and_b32 v15, 0xffff0000, v59
    v_mfma_f32_16x16x32_bf16 v[170:173], v[194:197], a[60:63], v[170:173]
    v_mfma_f32_16x16x32_bf16 v[158:161], v[198:201], a[64:67], v[158:161]
    s_add_u32 m0, s95, 28672
    s_add_u32 s92, s92, 4096
    s_addc_u32 s93, s93, 0
    global_load_lds_dwordx4 v4, s[92:93] offset:0 sc1
    s_waitcnt lgkmcnt(2)
    v_add_f32 v142, v142, v146
    v_mfma_f32_16x16x32_bf16 v[162:165], v[198:201], a[68:71], v[162:165]
    v_add_f32 v143, v143, v147
    v_mfma_f32_16x16x32_bf16 v[166:169], v[198:201], a[72:75], v[166:169]
    v_add_f32 v144, v144, v148
    v_mfma_f32_16x16x32_bf16 v[170:173], v[198:201], a[76:79], v[170:173]
    s_waitcnt vmcnt(15)
    v_max_u32 v28, v209, v213
    v_add_f32 v145, v145, v149
    v_mfma_f32_16x16x32_bf16 v[158:161], v[202:205], a[80:83], v[158:161]
    global_load_lds_dwordx4 v4, s[92:93] offset:1024 sc1
    s_waitcnt vmcnt(14)
    v_max3_u32 v28, v217, v221, v28
    s_waitcnt lgkmcnt(1)
    v_add_f32 v142, v142, v150
    v_mfma_f32_16x16x32_bf16 v[162:165], v[202:205], a[84:87], v[162:165]
    v_cmp_eq_u32 vcc, -1, v28
    v_add_f32 v143, v143, v151
    v_mfma_f32_16x16x32_bf16 v[166:169], v[202:205], a[88:91], v[166:169]
    v_add_f32 v144, v144, v152
    v_mfma_f32_16x16x32_bf16 v[170:173], v[202:205], a[92:95], v[170:173]
    s_cbranch_vccnz Lz27_r
Lz27_ok:
    v_mfma_f32_16x16x32_bf16 v[158:161], v[206:209], a[96:99], v[158:161]
    global_load_lds_dwordx4 v4, s[92:93] offset:2048 sc1
    v_add_f32 v145, v145, v153
    v_mfma_f32_16x16x32_bf16 v[162:165], v[206:209], a[100:103], v[162:165]
    s_waitcnt lgkmcnt(0)
    v_add_f32 v142, v142, v154
    v_mfma_f32_16x16x32_bf16 v[166:169], v[206:209], a[104:107], v[166:169]
    v_add_f32 v143, v143, v155
    v_mfma_f32_16x16x32_bf16 v[170:173], v[206:209], a[108:111], v[170:173]
    v_add_f32 v144, v144, v156
    v_mfma_f32_16x16x32_bf16 v[158:161], v[210:213], a[112:115], v[158:161]
    global_load_lds_dwordx4 v4, s[92:93] offset:3072 sc1
    v_add_f32 v145, v145, v157
    v_mfma_f32_16x16x32_bf16 v[162:165], v[210:213], a[116:119], v[162:165]
    v_mfma_f32_16x16x32_bf16 v[166:169], v[210:213], a[120:123], v[166:169]
    v_mul_f32 v142, v142, v12
    v_mfma_f32_16x16x32_bf16 v[170:173], v[210:213], a[124:127], v[170:173]
    v_mul_f32 v143, v143, v13
    v_mfma_f32_16x16x32_bf16 v[158:161], v[214:217], a[128:131], v[158:161]
    s_add_u32 m0, s95, 32768
    s_add_u32 s92, s92, 4096
    s_addc_u32 s93, s93, 0
    global_load_lds_dwordx4 v4, s[92:93] offset:0 sc1
    v_mul_f32 v144, v144, v14
    v_mfma_f32_16x16x32_bf16 v[162:165], v[214:217], a[132:135], v[162:165]
    v_mul_f32 v145, v145, v15
    v_mfma_f32_16x16x32_bf16 v[166:169], v[214:217], a[136:139], v[166:169]
    v_mfma_f32_16x16x32_bf16 v[170:173], v[214:217], a[140:143], v[170:173]
    v_cvt_pk_bf16_f32 v58, v142, v143
    v_mfma_f32_16x16x32_bf16 v[158:161], v[218:221], a[144:147], v[158:161]
    global_load_lds_dwordx4 v4, s[92:93] offset:1024 sc1
    v_cvt_pk_bf16_f32 v59, v144, v145
    v_mfma_f32_16x16x32_bf16 v[162:165], v[218:221], a[148:151], v[162:165]
    v_min_u32 v58, -2, v58
    v_mfma_f32_16x16x32_bf16 v[166:169], v[218:221], a[152:155], v[166:169]
    v_min_u32 v59, -2, v59
    v_mfma_f32_16x16x32_bf16 v[170:173], v[218:221], a[156:159], v[170:173]
    global_store_dwordx4 v24, v[56:59], s[38:39] offset:2048 sc1
    s_nop 2
    ds_write_b128 v20, v[162:165] offset:0
    s_nop 0
    ds_write_b128 v21, v[166:169] offset:0
    s_nop 0
    ds_write_b128 v22, v[170:173] offset:0
    s_waitcnt lgkmcnt(0)
    s_barrier
    ds_read_b128 v[162:165], v23 offset:0
    ds_read_b128 v[166:169], v23 offset:1024
    ds_read_b128 v[170:173], v23 offset:2048
    v_lshlrev_b32 v12, 16, v60
    v_and_b32 v13, 0xffff0000, v60
    v_lshlrev_b32 v14, 16, v61
    v_and_b32 v15, 0xffff0000, v61
    s_waitcnt lgkmcnt(2)
    v_pk_add_f32 v[158:159], v[158:159], v[162:163] op_sel:[0,0] op_sel_hi:[1,1]
    v_pk_add_f32 v[160:161], v[160:161], v[164:165] op_sel:[0,0] op_sel_hi:[1,1]
    s_waitcnt lgkmcnt(1)
    v_pk_add_f32 v[158:159], v[158:159], v[166:167] op_sel:[0,0] op_sel_hi:[1,1]
    v_pk_add_f32 v[160:161], v[160:161], v[168:169] op_sel:[0,0] op_sel_hi:[1,1]
    s_waitcnt lgkmcnt(0)
    v_pk_add_f32 v[158:159], v[158:159], v[170:171] op_sel:[0,0] op_sel_hi:[1,1]
    v_pk_add_f32 v[160:161], v[160:161], v[172:173] op_sel:[0,0] op_sel_hi:[1,1]
    v_pk_mul_f32 v[158:159], v[158:159], v[12:13] op_sel:[0,0] op_sel_hi:[1,1]
    v_pk_mul_f32 v[160:161], v[160:161], v[14:15] op_sel:[0,0] op_sel_hi:[1,1]
    v_cvt_pk_bf16_f32 v60, v158, v159
    v_cvt_pk_bf16_f32 v61, v160, v161
    v_min_u32 v60, -2, v60
    v_min_u32 v61, -2, v61
    global_store_dwordx2 v25, v[60:61], s[38:39] sc1
    v_mov_b32 v30, v4
    v_add_u32 v31, 61440, v4
    v_add_u32 v20, 122880, v4
    s_mul_i32 s5, s41, 320
    s_add_u32 s5, s5, 12800
    v_lshl_add_u32 v28, v3, 5, s5
    v_lshl_add_u32 v29, v3, 4, s5
    global_load_dwordx4 v[218:221], v28, s[38:39] offset:0 sc1
    global_load_dwordx4 v[222:225], v28, s[38:39] offset:16 sc1
    global_load_dwordx4 v[226:229], v28, s[38:39] offset:128 sc1
    global_load_dwordx4 v[230:233], v28, s[38:39] offset:144 sc1
    global_load_dwordx4 v[234:237], v29, s[38:39] offset:256 sc1
    s_add_u32 s5, s5, 15360
    v_lshl_add_u32 v28, v3, 5, s5
    v_lshl_add_u32 v29, v3, 4, s5
    global_load_dwordx4 v[238:241], v28, s[38:39] offset:0 sc1
    global_load_dwordx4 v[242:245], v28, s[38:39] offset:16 sc1
    global_load_dwordx4 v[246:249], v28, s[38:39] offset:128 sc1
    global_load_dwordx4 v[250:253], v28, s[38:39] offset:144 sc1
    global_load_dwordx4 v[12:15], v29, s[38:39] offset:256 sc1
    s_add_u32 s5, s5, 15360
    global_load_dwordx4 v[62:65], v6, s[38:39] offset:-4096 sc1
    global_load_dwordx4 v[66:69], v6, s[38:39] offset:0 sc1
    global_load_dwordx4 v[70:73], v6, s[38:39] offset:3072 sc1
    global_load_dwordx4 v[74:77], v7, s[38:39] offset:-1024 sc1
    global_load_dwordx4 v[78:81], v7, s[38:39] offset:2048 sc1
    global_load_dwordx4 v[82:85], v26, s[38:39] offset:-2048 sc1
    global_load_dwordx4 v[86:89], v26, s[38:39] offset:1024 sc1
    global_load_dwordx4 v[90:93], v27, s[38:39] offset:-3072 sc1
    global_load_dwordx4 v[94:97], v6, s[38:39] offset:-3072 sc1
    global_load_dwordx4 v[98:101], v6, s[38:39] offset:1024 sc1
    global_load_dwordx4 v[102:105], v7, s[38:39] offset:-4096 sc1
    global_load_dwordx4 v[106:109], v7, s[38:39] offset:0 sc1
    global_load_dwordx4 v[110:113], v7, s[38:39] offset:3072 sc1
    global_load_dwordx4 v[114:117], v26, s[38:39] offset:-1024 sc1
    global_load_dwordx4 v[118:121], v26, s[38:39] offset:2048 sc1
    global_load_dwordx4 v[122:125], v27, s[38:39] offset:-2048 sc1
    s_waitcnt vmcnt(28)
    s_barrier
    ds_read_b128 v[194:197], v30 offset:0
    ds_read_b128 v[198:201], v30 offset:1024
    ds_read_b128 v[202:205], v30 offset:2048
    ds_read_b128 v[206:209], v30 offset:3072
    ds_read_b128 v[210:213], v30 offset:4096
    s_waitcnt vmcnt(25)
    v_max_u32 v28, v218, v219
    v_max3_u32 v28, v220, v221, v28
    s_waitcnt vmcnt(24)
    v_max3_u32 v28, v222, v223, v28
    v_max3_u32 v28, v224, v225, v28
    s_waitcnt vmcnt(23)
    v_max3_u32 v28, v226, v227, v28
    v_max3_u32 v28, v228, v229, v28
    s_waitcnt vmcnt(22)
    v_max3_u32 v28, v230, v231, v28
    v_max3_u32 v28, v232, v233, v28
    s_waitcnt vmcnt(21)
    v_max3_u32 v28, v234, v235, v28
    v_max3_u32 v28, v236, v237, v28
    s_waitcnt vmcnt(20)
    v_max3_u32 v28, v238, v239, v28
    v_max3_u32 v28, v240, v241, v28
    s_waitcnt vmcnt(19)
    v_max3_u32 v28, v242, v243, v28
    v_max3_u32 v28, v244, v245, v28
    s_waitcnt vmcnt(18)
    v_max3_u32 v28, v246, v247, v28
    v_max3_u32 v28, v248, v249, v28
    s_waitcnt vmcnt(17)
    v_max3_u32 v28, v250, v251, v28
    v_max3_u32 v28, v252, v253, v28
    s_waitcnt vmcnt(16)
    v_max3_u32 v28, v12, v13, v28
    v_max3_u32 v28, v14, v15, v28
    v_cmp_eq_u32 vcc, -1, v28
    s_nop 0
    s_cbranch_vccnz Lgb_r
Lgb_ok:
    s_waitcnt vmcnt(14)
    v_max_u32 v28, v65, v69
    s_waitcnt vmcnt(12)
    v_max3_u32 v28, v73, v77, v28
    s_waitcnt vmcnt(10)
    v_max3_u32 v28, v81, v85, v28
    s_waitcnt vmcnt(8)
    v_max3_u32 v28, v89, v93, v28
    v_cmp_eq_u32 vcc, -1, v28
    s_nop 0
    s_cbranch_vccnz Lp0_r
Lp0_ok:
    s_waitcnt lgkmcnt(4)
    v_mfma_f32_16x16x32_bf16 v[174:177], v[194:197], v[62:65], 0
    ds_read_b128 v[214:217], v30 offset:20480
    s_waitcnt lgkmcnt(4)
    v_mfma_f32_16x16x32_bf16 v[178:181], v[198:201], v[62:65], 0
    ds_read_b128 v[194:197], v30 offset:21504
    s_waitcnt lgkmcnt(4)
    v_mfma_f32_16x16x32_bf16 v[182:185], v[202:205], v[62:65], 0
    ds_read_b128 v[198:201], v30 offset:22528
    s_waitcnt lgkmcnt(4)
    v_mfma_f32_16x16x32_bf16 v[186:189], v[206:209], v[62:65], 0
    ds_read_b128 v[202:205], v30 offset:23552
    s_waitcnt lgkmcnt(4)
    v_mfma_f32_16x16x32_bf16 v[190:193], v[210:213], v[62:65], 0
    ds_read_b128 v[206:209], v30 offset:24576
    s_waitcnt lgkmcnt(4)
    v_mfma_f32_16x16x32_bf16 v[174:177], v[214:217], v[66:69], v[174:177]
    ds_read_b128 v[210:213], v30 offset:35840
    s_waitcnt lgkmcnt(4)
    v_mfma_f32_16x16x32_bf16 v[178:181], v[194:197], v[66:69], v[178:181]
    ds_read_b128 v[214:217], v30 offset:36864
    s_waitcnt lgkmcnt(4)
    v_mfma_f32_16x16x32_bf16 v[182:185], v[198:201], v[66:69], v[182:185]
    ds_read_b128 v[194:197], v30 offset:37888
    s_waitcnt lgkmcnt(4)
    v_mfma_f32_16x16x32_bf16 v[186:189], v[202:205], v[66:69], v[186:189]
    ds_read_b128 v[198:201], v30 offset:38912
    s_waitcnt lgkmcnt(4)
    v_mfma_f32_16x16x32_bf16 v[190:193], v[206:209], v[66:69], v[190:193]
    ds_read_b128 v[202:205], v30 offset:39936
    s_waitcnt lgkmcnt(4)
    v_mfma_f32_16x16x32_bf16 v[174:177], v[210:213], v[70:73], v[174:177]
    ds_read_b128 v[206:209], v30 offset:56320
    s_waitcnt lgkmcnt(4)
    v_mfma_f32_16x16x32_bf16 v[178:181], v[214:217], v[70:73], v[178:181]
    ds_read_b128 v[210:213], v30 offset:57344
    s_waitcnt lgkmcnt(4)
    v_mfma_f32_16x16x32_bf16 v[182:185], v[194:197], v[70:73], v[182:185]
    ds_read_b128 v[214:217], v30 offset:58368
    s_waitcnt lgkmcnt(4)
    v_mfma_f32_16x16x32_bf16 v[186:189], v[198:201], v[70:73], v[186:189]
    ds_read_b128 v[194:197], v30 offset:59392
    s_waitcnt lgkmcnt(4)
    v_mfma_f32_16x16x32_bf16 v[190:193], v[202:205], v[70:73], v[190:193]
    ds_read_b128 v[198:201], v30 offset:60416
    s_waitcnt lgkmcnt(4)
    v_mfma_f32_16x16x32_bf16 v[174:177], v[206:209], v[74:77], v[174:177]
    ds_read_b128 v[202:205], v31 offset:10240
    s_waitcnt lgkmcnt(4)
    v_mfma_f32_16x16x32_bf16 v[178:181], v[210:213], v[74:77], v[178:181]
    ds_read_b128 v[206:209], v31 offset:11264
    s_waitcnt lgkmcnt(4)
    v_mfma_f32_16x16x32_bf16 v[182:185], v[214:217], v[74:77], v[182:185]
    ds_read_b128 v[210:213], v31 offset:12288
    s_waitcnt lgkmcnt(4)
    v_mfma_f32_16x16x32_bf16 v[186:189], v[194:197], v[74:77], v[186:189]
    ds_read_b128 v[214:217], v31 offset:13312
    s_waitcnt lgkmcnt(4)
    v_mfma_f32_16x16x32_bf16 v[190:193], v[198:201], v[74:77], v[190:193]
    ds_read_b128 v[194:197], v31 offset:14336
    s_waitcnt lgkmcnt(4)
    v_mfma_f32_16x16x32_bf16 v[174:177], v[202:205], v[78:81], v[174:177]
    ds_read_b128 v[198:201], v31 offset:30720
    s_waitcnt lgkmcnt(4)
    v_mfma_f32_16x16x32_bf16 v[178:181], v[206:209], v[78:81], v[178:181]
    ds_read_b128 v[202:205], v31 offset:31744
    s_waitcnt lgkmcnt(4)
    v_mfma_f32_16x16x32_bf16 v[182:185], v[210:213], v[78:81], v[182:185]
    ds_read_b128 v[206:209], v31 offset:32768
    s_waitcnt lgkmcnt(4)
    v_mfma_f32_16x16x32_bf16 v[186:189], v[214:217], v[78:81], v[186:189]
    ds_read_b128 v[210:213], v31 offset:33792
    s_waitcnt lgkmcnt(4)
    v_mfma_f32_16x16x32_bf16 v[190:193], v[194:197], v[78:81], v[190:193]
    global_load_dwordx4 v[126:129], v6, s[38:39] offset:-2048 sc1
    ds_read_b128 v[214:217], v31 offset:34816
    s_waitcnt lgkmcnt(4)
    v_mfma_f32_16x16x32_bf16 v[174:177], v[198:201], v[82:85], v[174:177]
    ds_read_b128 v[194:197], v31 offset:46080
    s_waitcnt lgkmcnt(4)
    v_mfma_f32_16x16x32_bf16 v[178:181], v[202:205], v[82:85], v[178:181]
    global_load_dwordx4 v[130:133], v6, s[38:39] offset:2048 sc1
    ds_read_b128 v[198:201], v31 offset:47104
    s_waitcnt lgkmcnt(4)
    v_mfma_f32_16x16x32_bf16 v[182:185], v[206:209], v[82:85], v[182:185]
    ds_read_b128 v[202:205], v31 offset:48128
    s_waitcnt lgkmcnt(4)
    v_mfma_f32_16x16x32_bf16 v[186:189], v[210:213], v[82:85], v[186:189]
    global_load_dwordx4 v[134:137], v7, s[38:39] offset:-3072 sc1
    ds_read_b128 v[206:209], v31 offset:49152
    s_waitcnt lgkmcnt(4)
    v_mfma_f32_16x16x32_bf16 v[190:193], v[214:217], v[82:85], v[190:193]
    ds_read_b128 v[210:213], v31 offset:50176
    s_waitcnt lgkmcnt(4)
    v_mfma_f32_16x16x32_bf16 v[174:177], v[194:197], v[86:89], v[174:177]
    global_load_dwordx4 v[138:141], v7, s[38:39] offset:1024 sc1
    ds_read_b128 v[214:217], v20 offset:5120
    s_waitcnt lgkmcnt(4)
    v_mfma_f32_16x16x32_bf16 v[178:181], v[198:201], v[86:89], v[178:181]
    ds_read_b128 v[194:197], v20 offset:6144
    s_waitcnt lgkmcnt(4)
    v_mfma_f32_16x16x32_bf16 v[182:185], v[202:205], v[86:89], v[182:185]
    ds_read_b128 v[198:201], v20 offset:7168
    s_waitcnt lgkmcnt(4)
    v_mfma_f32_16x16x32_bf16 v[186:189], v[206:209], v[86:89], v[186:189]
    global_load_dwordx4 v[142:145], v26, s[38:39] offset:-4096 sc1
    ds_read_b128 v[202:205], v20 offset:8192
    s_waitcnt lgkmcnt(4)
    v_mfma_f32_16x16x32_bf16 v[190:193], v[210:213], v[86:89], v[190:193]
    ds_read_b128 v[206:209], v20 offset:9216
    s_waitcnt lgkmcnt(4)
    v_mfma_f32_16x16x32_bf16 v[174:177], v[214:217], v[90:93], v[174:177]
    global_load_dwordx4 v[146:149], v26, s[38:39] offset:0 sc1
    ds_read_b128 v[210:213], v30 offset:5120
    s_waitcnt lgkmcnt(4)
    v_mfma_f32_16x16x32_bf16 v[178:181], v[194:197], v[90:93], v[178:181]
    ds_read_b128 v[214:217], v30 offset:6144
    s_waitcnt lgkmcnt(4)
    v_mfma_f32_16x16x32_bf16 v[182:185], v[198:201], v[90:93], v[182:185]
    global_load_dwordx4 v[150:153], v26, s[38:39] offset:3072 sc1
    ds_read_b128 v[194:197], v30 offset:7168
    s_waitcnt lgkmcnt(4)
    v_mfma_f32_16x16x32_bf16 v[186:189], v[202:205], v[90:93], v[186:189]
    ds_read_b128 v[198:201], v30 offset:8192
    s_waitcnt lgkmcnt(4)
    v_mfma_f32_16x16x32_bf16 v[190:193], v[206:209], v[90:93], v[190:193]
    ds_read_b128 v[202:205], v30 offset:9216
    s_waitcnt vmcnt(13)
    v_max_u32 v28, v97, v101
    s_waitcnt vmcnt(11)
    v_max3_u32 v28, v105, v109, v28
    s_waitcnt vmcnt(9)
    v_max3_u32 v28, v113, v117, v28
    s_waitcnt vmcnt(7)
    v_max3_u32 v28, v121, v125, v28
    v_cmp_eq_u32 vcc, -1, v28
    s_nop 0
    s_cbranch_vccnz Lp1_r
Lp1_ok:
    s_waitcnt lgkmcnt(4)
    v_mfma_f32_16x16x32_bf16 v[174:177], v[210:213], v[94:97], v[174:177]
    ds_read_b128 v[206:209], v30 offset:25600
    s_waitcnt lgkmcnt(4)
    v_mfma_f32_16x16x32_bf16 v[178:181], v[214:217], v[94:97], v[178:181]
    ds_read_b128 v[210:213], v30 offset:26624
    s_waitcnt lgkmcnt(4)
    v_mfma_f32_16x16x32_bf16 v[182:185], v[194:197], v[94:97], v[182:185]
    ds_read_b128 v[214:217], v30 offset:27648
    s_waitcnt lgkmcnt(4)
    v_mfma_f32_16x16x32_bf16 v[186:189], v[198:201], v[94:97], v[186:189]
    ds_read_b128 v[194:197], v30 offset:28672
    s_waitcnt lgkmcnt(4)
    v_mfma_f32_16x16x32_bf16 v[190:193], v[202:205], v[94:97], v[190:193]
    ds_read_b128 v[198:201], v30 offset:29696
    s_waitcnt lgkmcnt(4)
    v_mfma_f32_16x16x32_bf16 v[174:177], v[206:209], v[98:101], v[174:177]
    ds_read_b128 v[202:205], v30 offset:40960
    s_waitcnt lgkmcnt(4)
    v_mfma_f32_16x16x32_bf16 v[178:181], v[210:213], v[98:101], v[178:181]
    ds_read_b128 v[206:209], v30 offset:41984
    s_waitcnt lgkmcnt(4)
    v_mfma_f32_16x16x32_bf16 v[182:185], v[214:217], v[98:101], v[182:185]
    ds_read_b128 v[210:213], v30 offset:43008
    s_waitcnt lgkmcnt(4)
    v_mfma_f32_16x16x32_bf16 v[186:189], v[194:197], v[98:101], v[186:189]
    ds_read_b128 v[214:217], v30 offset:44032
    s_waitcnt lgkmcnt(4)
    v_mfma_f32_16x16x32_bf16 v[190:193], v[198:201], v[98:101], v[190:193]
    ds_read_b128 v[194:197], v30 offset:45056
    s_waitcnt lgkmcnt(4)
    v_mfma_f32_16x16x32_bf16 v[174:177], v[202:205], v[102:105], v[174:177]
    ds_read_b128 v[198:201], v31 offset:0
    s_waitcnt lgkmcnt(4)
    v_mfma_f32_16x16x32_bf16 v[178:181], v[206:209], v[102:105], v[178:181]
    ds_read_b128 v[202:205], v31 offset:1024
    s_waitcnt lgkmcnt(4)
    v_mfma_f32_16x16x32_bf16 v[182:185], v[210:213], v[102:105], v[182:185]
    ds_read_b128 v[206:209], v31 offset:2048
    s_waitcnt lgkmcnt(4)
    v_mfma_f32_16x16x32_bf16 v[186:189], v[214:217], v[102:105], v[186:189]
    ds_read_b128 v[210:213], v31 offset:3072
    s_waitcnt lgkmcnt(4)
    v_mfma_f32_16x16x32_bf16 v[190:193], v[194:197], v[102:105], v[190:193]
    ds_read_b128 v[214:217], v31 offset:4096
    s_waitcnt lgkmcnt(4)
    v_mfma_f32_16x16x32_bf16 v[174:177], v[198:201], v[106:109], v[174:177]
    ds_read_b128 v[194:197], v31 offset:15360
    s_waitcnt lgkmcnt(4)
    v_mfma_f32_16x16x32_bf16 v[178:181], v[202:205], v[106:109], v[178:181]
    ds_read_b128 v[198:201], v31 offset:16384
    s_waitcnt lgkmcnt(4)
    v_mfma_f32_16x16x32_bf16 v[182:185], v[206:209], v[106:109], v[182:185]
    ds_read_b128 v[202:205], v31 offset:17408
    s_waitcnt lgkmcnt(4)
    v_mfma_f32_16x16x32_bf16 v[186:189], v[210:213], v[106:109], v[186:189]
    ds_read_b128 v[206:209], v31 offset:18432
    s_waitcnt lgkmcnt(4)
    v_mfma_f32_16x16x32_bf16 v[190:193], v[214:217], v[106:109], v[190:193]
    ds_read_b128 v[210:213], v31 offset:19456
    s_waitcnt lgkmcnt(4)
    v_mfma_f32_16x16x32_bf16 v[174:177], v[194:197], v[110:113], v[174:177]
    ds_read_b128 v[214:217], v31 offset:35840
    s_waitcnt lgkmcnt(4)
    v_mfma_f32_16x16x32_bf16 v[178:181], v[198:201], v[110:113], v[178:181]
    ds_read_b128 v[194:197], v31 offset:36864
    s_waitcnt lgkmcnt(4)
    v_mfma_f32_16x16x32_bf16 v[182:185], v[202:205], v[110:113], v[182:185]
    ds_read_b128 v[198:201], v31 offset:37888
    s_waitcnt lgkmcnt(4)
    v_mfma_f32_16x16x32_bf16 v[186:189], v[206:209], v[110:113], v[186:189]
    ds_read_b128 v[202:205], v31 offset:38912
    s_waitcnt lgkmcnt(4)
    v_mfma_f32_16x16x32_bf16 v[190:193], v[210:213], v[110:113], v[190:193]
    global_load_dwordx4 v[158:161], v6, s[38:39] offset:-1024 sc1
    ds_read_b128 v[206:209], v31 offset:39936
    s_waitcnt lgkmcnt(4)
    v_mfma_f32_16x16x32_bf16 v[174:177], v[214:217], v[114:117], v[174:177]
    ds_read_b128 v[210:213], v31 offset:51200
    s_waitcnt lgkmcnt(4)
    v_mfma_f32_16x16x32_bf16 v[178:181], v[194:197], v[114:117], v[178:181]
    ds_read_b128 v[214:217], v31 offset:52224
    s_waitcnt lgkmcnt(4)
    v_mfma_f32_16x16x32_bf16 v[182:185], v[198:201], v[114:117], v[182:185]
    ds_read_b128 v[194:197], v31 offset:53248
    s_waitcnt lgkmcnt(4)
    v_mfma_f32_16x16x32_bf16 v[186:189], v[202:205], v[114:117], v[186:189]
    global_load_dwordx4 v[162:165], v7, s[38:39] offset:-2048 sc1
    ds_read_b128 v[198:201], v31 offset:54272
    s_waitcnt lgkmcnt(4)
    v_mfma_f32_16x16x32_bf16 v[190:193], v[206:209], v[114:117], v[190:193]
    ds_read_b128 v[202:205], v31 offset:55296
    s_waitcnt lgkmcnt(4)
    v_mfma_f32_16x16x32_bf16 v[174:177], v[210:213], v[118:121], v[174:177]
    ds_read_b128 v[206:209], v20 offset:10240
    s_waitcnt lgkmcnt(4)
    v_mfma_f32_16x16x32_bf16 v[178:181], v[214:217], v[118:121], v[178:181]
    ds_read_b128 v[210:213], v20 offset:11264
    s_waitcnt lgkmcnt(4)
    v_mfma_f32_16x16x32_bf16 v[182:185], v[194:197], v[118:121], v[182:185]
    global_load_dwordx4 v[166:169], v26, s[38:39] offset:-3072 sc1
    ds_read_b128 v[214:217], v20 offset:12288
    s_waitcnt lgkmcnt(4)
    v_mfma_f32_16x16x32_bf16 v[186:189], v[198:201], v[118:121], v[186:189]
    ds_read_b128 v[194:197], v20 offset:13312
    s_waitcnt lgkmcnt(4)
    v_mfma_f32_16x16x32_bf16 v[190:193], v[202:205], v[118:121], v[190:193]
    ds_read_b128 v[198:201], v20 offset:14336
    s_waitcnt lgkmcnt(4)
    v_mfma_f32_16x16x32_bf16 v[174:177], v[206:209], v[122:125], v[174:177]
    ds_read_b128 v[202:205], v30 offset:10240
    s_waitcnt lgkmcnt(4)
    v_mfma_f32_16x16x32_bf16 v[178:181], v[210:213], v[122:125], v[178:181]
    global_load_dwordx4 v[170:173], v27, s[38:39] offset:-4096 sc1
    ds_read_b128 v[206:209], v30 offset:11264
    s_waitcnt lgkmcnt(4)
    v_mfma_f32_16x16x32_bf16 v[182:185], v[214:217], v[122:125], v[182:185]
    ds_read_b128 v[210:213], v30 offset:12288
    s_waitcnt lgkmcnt(4)
    v_mfma_f32_16x16x32_bf16 v[186:189], v[194:197], v[122:125], v[186:189]
    ds_read_b128 v[214:217], v30 offset:13312
    s_waitcnt lgkmcnt(4)
    v_mfma_f32_16x16x32_bf16 v[190:193], v[198:201], v[122:125], v[190:193]
    ds_read_b128 v[194:197], v30 offset:14336
    v_add_f32 v218, v218, v238
    v_add_f32 v219, v219, v239
    v_add_f32 v220, v220, v240
    v_add_f32 v221, v221, v241
    v_cvt_pk_bf16_f32 v218, v218, v218
    v_lshlrev_b32 v218, 16, v218
    v_cvt_pk_bf16_f32 v219, v219, v219
    v_lshlrev_b32 v219, 16, v219
    v_cvt_pk_bf16_f32 v220, v220, v220
    v_lshlrev_b32 v220, 16, v220
    v_cvt_pk_bf16_f32 v221, v221, v221
    v_lshlrev_b32 v221, 16, v221
    v_add_f32 v222, v222, v242
    v_add_f32 v223, v223, v243
    v_add_f32 v224, v224, v244
    v_add_f32 v225, v225, v245
    v_cvt_pk_bf16_f32 v222, v222, v222
    v_lshlrev_b32 v222, 16, v222
    v_cvt_pk_bf16_f32 v223, v223, v223
    v_lshlrev_b32 v223, 16, v223
    v_cvt_pk_bf16_f32 v224, v224, v224
    v_lshlrev_b32 v224, 16, v224
    v_cvt_pk_bf16_f32 v225, v225, v225
    v_lshlrev_b32 v225, 16, v225
    v_add_f32 v226, v226, v246
    v_add_f32 v227, v227, v247
    v_add_f32 v228, v228, v248
    v_add_f32 v229, v229, v249
    v_cvt_pk_bf16_f32 v226, v226, v226
    v_lshlrev_b32 v226, 16, v226
    v_cvt_pk_bf16_f32 v227, v227, v227
    v_lshlrev_b32 v227, 16, v227
    v_cvt_pk_bf16_f32 v228, v228, v228
    v_lshlrev_b32 v228, 16, v228
    v_cvt_pk_bf16_f32 v229, v229, v229
    v_lshlrev_b32 v229, 16, v229
    v_add_f32 v230, v230, v250
    v_add_f32 v231, v231, v251
    v_add_f32 v232, v232, v252
    v_add_f32 v233, v233, v253
    v_cvt_pk_bf16_f32 v230, v230, v230
    v_lshlrev_b32 v230, 16, v230
    v_cvt_pk_bf16_f32 v231, v231, v231
    v_lshlrev_b32 v231, 16, v231
    v_cvt_pk_bf16_f32 v232, v232, v232
    v_lshlrev_b32 v232, 16, v232
    v_cvt_pk_bf16_f32 v233, v233, v233
    v_lshlrev_b32 v233, 16, v233
    v_add_f32 v234, v234, v12
    v_add_f32 v235, v235, v13
    v_add_f32 v236, v236, v14
    v_add_f32 v237, v237, v15
    v_cvt_pk_bf16_f32 v234, v234, v234
    v_lshlrev_b32 v234, 16, v234
    v_cvt_pk_bf16_f32 v235, v235, v235
    v_lshlrev_b32 v235, 16, v235
    v_cvt_pk_bf16_f32 v236, v236, v236
    v_lshlrev_b32 v236, 16, v236
    v_cvt_pk_bf16_f32 v237, v237, v237
    v_lshlrev_b32 v237, 16, v237
    s_waitcnt vmcnt(8)
    v_max3_u32 v28, v129, v133, v137
    s_waitcnt vmcnt(6)
    v_max3_u32 v28, v141, v145, v28
    s_waitcnt vmcnt(4)
    v_max3_u32 v28, v149, v153, v28
    v_cmp_eq_u32 vcc, -1, v28
    s_nop 0
    s_cbranch_vccnz Lp2_r
Lp2_ok:
    s_waitcnt lgkmcnt(4)
    v_mfma_f32_16x16x32_bf16 v[174:177], v[202:205], v[126:129], v[174:177]
    ds_read_b128 v[198:201], v30 offset:30720
    s_waitcnt lgkmcnt(4)
    v_mfma_f32_16x16x32_bf16 v[178:181], v[206:209], v[126:129], v[178:181]
    ds_read_b128 v[202:205], v30 offset:31744
    s_waitcnt lgkmcnt(4)
    v_mfma_f32_16x16x32_bf16 v[182:185], v[210:213], v[126:129], v[182:185]
    ds_read_b128 v[206:209], v30 offset:32768
    s_waitcnt lgkmcnt(4)
    v_mfma_f32_16x16x32_bf16 v[186:189], v[214:217], v[126:129], v[186:189]
    ds_read_b128 v[210:213], v30 offset:33792
    s_waitcnt lgkmcnt(4)
    v_mfma_f32_16x16x32_bf16 v[190:193], v[194:197], v[126:129], v[190:193]
    ds_read_b128 v[214:217], v30 offset:34816
    s_waitcnt lgkmcnt(4)
    v_mfma_f32_16x16x32_bf16 v[174:177], v[198:201], v[130:133], v[174:177]
    ds_read_b128 v[194:197], v30 offset:46080
    s_waitcnt lgkmcnt(4)
    v_mfma_f32_16x16x32_bf16 v[178:181], v[202:205], v[130:133], v[178:181]
    ds_read_b128 v[198:201], v30 offset:47104
    s_waitcnt lgkmcnt(4)
    v_mfma_f32_16x16x32_bf16 v[182:185], v[206:209], v[130:133], v[182:185]
    ds_read_b128 v[202:205], v30 offset:48128
    s_waitcnt lgkmcnt(4)
    v_mfma_f32_16x16x32_bf16 v[186:189], v[210:213], v[130:133], v[186:189]
    ds_read_b128 v[206:209], v30 offset:49152
    s_waitcnt lgkmcnt(4)
    v_mfma_f32_16x16x32_bf16 v[190:193], v[214:217], v[130:133], v[190:193]
    ds_read_b128 v[210:213], v30 offset:50176
    s_waitcnt lgkmcnt(4)
    v_mfma_f32_16x16x32_bf16 v[174:177], v[194:197], v[134:137], v[174:177]
    ds_read_b128 v[214:217], v31 offset:5120
    s_waitcnt lgkmcnt(4)
    v_mfma_f32_16x16x32_bf16 v[178:181], v[198:201], v[134:137], v[178:181]
    ds_read_b128 v[194:197], v31 offset:6144
    s_waitcnt lgkmcnt(4)
    v_mfma_f32_16x16x32_bf16 v[182:185], v[202:205], v[134:137], v[182:185]
    ds_read_b128 v[198:201], v31 offset:7168
    s_waitcnt lgkmcnt(4)
    v_mfma_f32_16x16x32_bf16 v[186:189], v[206:209], v[134:137], v[186:189]
    ds_read_b128 v[202:205], v31 offset:8192
    s_waitcnt lgkmcnt(4)
    v_mfma_f32_16x16x32_bf16 v[190:193], v[210:213], v[134:137], v[190:193]
    ds_read_b128 v[206:209], v31 offset:9216
    s_waitcnt lgkmcnt(4)
    v_mfma_f32_16x16x32_bf16 v[174:177], v[214:217], v[138:141], v[174:177]
    ds_read_b128 v[210:213], v31 offset:20480
    s_waitcnt lgkmcnt(4)
    v_mfma_f32_16x16x32_bf16 v[178:181], v[194:197], v[138:141], v[178:181]
    ds_read_b128 v[214:217], v31 offset:21504
    s_waitcnt lgkmcnt(4)
    v_mfma_f32_16x16x32_bf16 v[182:185], v[198:201], v[138:141], v[182:185]
    ds_read_b128 v[194:197], v31 offset:22528
    s_waitcnt lgkmcnt(4)
    v_mfma_f32_16x16x32_bf16 v[186:189], v[202:205], v[138:141], v[186:189]
    ds_read_b128 v[198:201], v31 offset:23552
    s_waitcnt lgkmcnt(4)
    v_mfma_f32_16x16x32_bf16 v[190:193], v[206:209], v[138:141], v[190:193]
    ds_read_b128 v[202:205], v31 offset:24576
    s_waitcnt lgkmcnt(4)
    v_mfma_f32_16x16x32_bf16 v[174:177], v[210:213], v[142:145], v[174:177]
    ds_read_b128 v[206:209], v31 offset:40960
    s_waitcnt lgkmcnt(4)
    v_mfma_f32_16x16x32_bf16 v[178:181], v[214:217], v[142:145], v[178:181]
    ds_read_b128 v[210:213], v31 offset:41984
    s_waitcnt lgkmcnt(4)
    v_mfma_f32_16x16x32_bf16 v[182:185], v[194:197], v[142:145], v[182:185]
    ds_read_b128 v[214:217], v31 offset:43008
    s_waitcnt lgkmcnt(4)
    v_mfma_f32_16x16x32_bf16 v[186:189], v[198:201], v[142:145], v[186:189]
    ds_read_b128 v[194:197], v31 offset:44032
    s_waitcnt lgkmcnt(4)
    v_mfma_f32_16x16x32_bf16 v[190:193], v[202:205], v[142:145], v[190:193]
    ds_read_b128 v[198:201], v31 offset:45056
    s_waitcnt lgkmcnt(4)
    v_mfma_f32_16x16x32_bf16 v[174:177], v[206:209], v[146:149], v[174:177]
    ds_read_b128 v[202:205], v31 offset:56320
    s_waitcnt lgkmcnt(4)
    v_mfma_f32_16x16x32_bf16 v[178:181], v[210:213], v[146:149], v[178:181]
    ds_read_b128 v[206:209], v31 offset:57344
    s_waitcnt lgkmcnt(4)
    v_mfma_f32_16x16x32_bf16 v[182:185], v[214:217], v[146:149], v[182:185]
    ds_read_b128 v[210:213], v31 offset:58368
    s_waitcnt lgkmcnt(4)
    v_mfma_f32_16x16x32_bf16 v[186:189], v[194:197], v[146:149], v[186:189]
    ds_read_b128 v[214:217], v31 offset:59392
    s_waitcnt lgkmcnt(4)
    v_mfma_f32_16x16x32_bf16 v[190:193], v[198:201], v[146:149], v[190:193]
    ds_read_b128 v[194:197], v31 offset:60416
    s_waitcnt lgkmcnt(4)
    v_mfma_f32_16x16x32_bf16 v[174:177], v[202:205], v[150:153], v[174:177]
    ds_read_b128 v[198:201], v30 offset:15360
    s_waitcnt lgkmcnt(4)
    v_mfma_f32_16x16x32_bf16 v[178:181], v[206:209], v[150:153], v[178:181]
    ds_read_b128 v[202:205], v30 offset:16384
    s_waitcnt lgkmcnt(4)
    v_mfma_f32_16x16x32_bf16 v[182:185], v[210:213], v[150:153], v[182:185]
    ds_read_b128 v[206:209], v30 offset:17408
    s_waitcnt lgkmcnt(4)
    v_mfma_f32_16x16x32_bf16 v[186:189], v[214:217], v[150:153], v[186:189]
    ds_read_b128 v[210:213], v30 offset:18432
    s_waitcnt lgkmcnt(4)
    v_mfma_f32_16x16x32_bf16 v[190:193], v[194:197], v[150:153], v[190:193]
    ds_read_b128 v[214:217], v30 offset:19456
    s_waitcnt vmcnt(3)
    v_max_u32 v28, v159, v161
    s_waitcnt vmcnt(2)
    v_max3_u32 v28, v163, v165, v28
    s_waitcnt vmcnt(1)
    v_max3_u32 v28, v167, v169, v28
    s_waitcnt vmcnt(0)
    v_max3_u32 v28, v171, v173, v28
    v_cmp_eq_u32 vcc, -1, v28
    s_nop 0
    s_cbranch_vccnz Lp3_r
Lp3_ok:
    s_waitcnt lgkmcnt(4)
    v_mfma_f32_16x16x32_bf16 v[174:177], v[198:201], v[158:161], v[174:177]
    ds_read_b128 v[194:197], v30 offset:51200
    s_waitcnt lgkmcnt(4)
    v_mfma_f32_16x16x32_bf16 v[178:181], v[202:205], v[158:161], v[178:181]
    ds_read_b128 v[198:201], v30 offset:52224
    s_waitcnt lgkmcnt(4)
    v_mfma_f32_16x16x32_bf16 v[182:185], v[206:209], v[158:161], v[182:185]
    ds_read_b128 v[202:205], v30 offset:53248
    s_waitcnt lgkmcnt(4)
    v_mfma_f32_16x16x32_bf16 v[186:189], v[210:213], v[158:161], v[186:189]
    ds_read_b128 v[206:209], v30 offset:54272
    s_waitcnt lgkmcnt(4)
    v_mfma_f32_16x16x32_bf16 v[190:193], v[214:217], v[158:161], v[190:193]
    ds_read_b128 v[210:213], v30 offset:55296
    s_waitcnt lgkmcnt(4)
    v_mfma_f32_16x16x32_bf16 v[174:177], v[194:197], v[162:165], v[174:177]
    ds_read_b128 v[214:217], v31 offset:25600
    s_waitcnt lgkmcnt(4)
    v_mfma_f32_16x16x32_bf16 v[178:181], v[198:201], v[162:165], v[178:181]
    ds_read_b128 v[194:197], v31 offset:26624
    s_waitcnt lgkmcnt(4)
    v_mfma_f32_16x16x32_bf16 v[182:185], v[202:205], v[162:165], v[182:185]
    ds_read_b128 v[198:201], v31 offset:27648
    s_waitcnt lgkmcnt(4)
    v_mfma_f32_16x16x32_bf16 v[186:189], v[206:209], v[162:165], v[186:189]
    ds_read_b128 v[202:205], v31 offset:28672
    s_waitcnt lgkmcnt(4)
    v_mfma_f32_16x16x32_bf16 v[190:193], v[210:213], v[162:165], v[190:193]
    ds_read_b128 v[206:209], v31 offset:29696
    s_waitcnt lgkmcnt(4)
    v_mfma_f32_16x16x32_bf16 v[174:177], v[214:217], v[166:169], v[174:177]
    ds_read_b128 v[210:213], v20 offset:0
    s_waitcnt lgkmcnt(4)
    v_mfma_f32_16x16x32_bf16 v[178:181], v[194:197], v[166:169], v[178:181]
    ds_read_b128 v[214:217], v20 offset:1024
    s_waitcnt lgkmcnt(4)
    v_mfma_f32_16x16x32_bf16 v[182:185], v[198:201], v[166:169], v[182:185]
    ds_read_b128 v[194:197], v20 offset:2048
    s_waitcnt lgkmcnt(4)
    v_mfma_f32_16x16x32_bf16 v[186:189], v[202:205], v[166:169], v[186:189]
    ds_read_b128 v[198:201], v20 offset:3072
    s_waitcnt lgkmcnt(4)
    v_mfma_f32_16x16x32_bf16 v[190:193], v[206:209], v[166:169], v[190:193]
    ds_read_b128 v[202:205], v20 offset:4096
    s_waitcnt lgkmcnt(4)
    v_mfma_f32_16x16x32_bf16 v[174:177], v[210:213], v[170:173], v[174:177]
    s_waitcnt lgkmcnt(3)
    v_mfma_f32_16x16x32_bf16 v[178:181], v[214:217], v[170:173], v[178:181]
    s_waitcnt lgkmcnt(2)
    v_mfma_f32_16x16x32_bf16 v[182:185], v[194:197], v[170:173], v[182:185]
    s_waitcnt lgkmcnt(1)
    v_mfma_f32_16x16x32_bf16 v[186:189], v[198:201], v[170:173], v[186:189]
    s_waitcnt lgkmcnt(0)
    v_mfma_f32_16x16x32_bf16 v[190:193], v[202:205], v[170:173], v[190:193]
    v_lshlrev_b32 v62, 16, v36
    v_and_b32 v63, 0xffff0000, v36
    v_lshlrev_b32 v64, 16, v37
    v_and_b32 v65, 0xffff0000, v37
    v_lshlrev_b32 v66, 16, v38
    v_and_b32 v67, 0xffff0000, v38
    v_lshlrev_b32 v68, 16, v39
    v_and_b32 v69, 0xffff0000, v39
    v_lshlrev_b32 v70, 16, v40
    v_and_b32 v71, 0xffff0000, v40
    v_lshlrev_b32 v72, 16, v41
    v_and_b32 v73, 0xffff0000, v41
    v_lshlrev_b32 v74, 16, v42
    v_and_b32 v75, 0xffff0000, v42
    v_lshlrev_b32 v76, 16, v43
    v_and_b32 v77, 0xffff0000, v43
    v_lshlrev_b32 v78, 16, v44
    v_and_b32 v79, 0xffff0000, v44
    v_lshlrev_b32 v80, 16, v45
    v_and_b32 v81, 0xffff0000, v45
    v_add_u32 v28, s90, v5
    v_mul_u32_u24 v28, 1280, v28
    s_mul_i32 s4, s41, 160
    v_add_u32 v28, s4, v28
    v_lshl_add_u32 v29, v3, 4, v28
    v_lshl_add_u32 v28, v3, 3, v28
    v_fmac_f32 v62, v174, v218
    v_fmac_f32 v63, v178, v219
    v_fmac_f32 v64, v175, v220
    v_fmac_f32 v65, v179, v221
    v_fmac_f32 v66, v176, v222
    v_fmac_f32 v67, v180, v223
    v_fmac_f32 v68, v177, v224
    v_fmac_f32 v69, v181, v225
    v_cvt_pk_bf16_f32 v94, v62, v63
    v_cvt_pk_bf16_f32 v95, v64, v65
    v_cvt_pk_bf16_f32 v96, v66, v67
    v_cvt_pk_bf16_f32 v97, v68, v69
    global_store_dwordx4 v29, v[94:97], s[34:35] offset:0
    v_fmac_f32 v70, v182, v226
    v_fmac_f32 v71, v186, v227
    v_fmac_f32 v72, v183, v228
    v_fmac_f32 v73, v187, v229
    v_fmac_f32 v74, v184, v230
    v_fmac_f32 v75, v188, v231
    v_fmac_f32 v76, v185, v232
    v_fmac_f32 v77, v189, v233
    v_cvt_pk_bf16_f32 v98, v70, v71
    v_cvt_pk_bf16_f32 v99, v72, v73
    v_cvt_pk_bf16_f32 v100, v74, v75
    v_cvt_pk_bf16_f32 v101, v76, v77
    global_store_dwordx4 v29, v[98:101], s[34:35] offset:64
    v_fmac_f32 v78, v190, v234
    v_fmac_f32 v79, v191, v235
    v_fmac_f32 v80, v192, v236
    v_fmac_f32 v81, v193, v237
    v_cvt_pk_bf16_f32 v102, v78, v79
    v_cvt_pk_bf16_f32 v103, v80, v81
    global_store_dwordx2 v28, v[102:103], s[34:35] offset:128
Lflush:
Lend:
    s_endpgm
Lic_r:
    v_min_u32 v212, 7, v1
    v_lshlrev_b32 v212, 2, v212
Lic_p:
    global_load_dword v213, v212, s[36:37] sc1
    s_waitcnt vmcnt(0)
    v_cmp_eq_u32 vcc, 0, v213
    s_add_u32 s100, s100, 1
    s_cmp_ge_u32 s100, 262144
    s_cbranch_scc1 Lic_p_x
    s_cbranch_vccnz Lic_p
Lic_p_x:
    s_branch Lic_ok
Lc_m3:
    s_cmp_ge_u32 s42, 130
    s_cbranch_scc1 Lc_j3
    s_sub_u32 s46, s42, 128
    v_mov_b32 v148, 0
    v_mov_b32 v149, 0
    v_mov_b32 v150, 0
    v_mov_b32 v151, 0
    s_mul_i32 s4, s46, 1146880
    s_add_u32 s4, s4, 8445952
    v_lshl_add_u32 v152, v0, 4, s4
    global_store_dwordx4 v152, v[148:151], s[38:39] sc1
    v_add_u32 v152, 4096, v152
    global_store_dwordx4 v152, v[148:151], s[38:39] sc1
    v_add_u32 v152, 4096, v152
    global_store_dwordx4 v152, v[148:151], s[38:39] sc1
    v_add_u32 v152, 4096, v152
    global_store_dwordx4 v152, v[148:151], s[38:39] sc1
    v_add_u32 v152, 4096, v152
    global_store_dwordx4 v152, v[148:151], s[38:39] sc1
    v_add_u32 v152, 4096, v152
    global_store_dwordx4 v152, v[148:151], s[38:39] sc1
    v_add_u32 v152, 4096, v152
    global_store_dwordx4 v152, v[148:151], s[38:39] sc1
    v_add_u32 v152, 4096, v152
    global_store_dwordx4 v152, v[148:151], s[38:39] sc1
    v_add_u32 v152, 4096, v152
    global_store_dwordx4 v152, v[148:151], s[38:39] sc1
    v_add_u32 v152, 4096, v152
    global_store_dwordx4 v152, v[148:151], s[38:39] sc1
    v_add_u32 v152, 4096, v152
    s_mul_i32 s4, s46, 7168
    s_and_b32 s5, s3, 1
    s_mul_i32 s5, s5, 14336
    s_add_u32 s4, s4, s5
    s_add_u32 s4, s4, 56064
    v_lshl_add_u32 v152, v1, 2, s4
    s_waitcnt vmcnt(0) lgkmcnt(0)
    s_barrier
    global_store_dword v152, v148, s[38:39] sc1
    s_branch Lc_j3
Lic2_r:
    v_min_u32 v41, 49, v1
    v_lshlrev_b32 v41, 2, v41
Lic2_p:
    global_load_dword v42, v41, s[36:37] sc1
    s_waitcnt vmcnt(0)
    v_cmp_eq_u32 vcc, 0, v42
    s_add_u32 s100, s100, 1
    s_cmp_ge_u32 s100, 262144
    s_cbranch_scc1 Lic2_p_x
    s_cbranch_vccnz Lic2_p
Lic2_p_x:
    s_branch Lic2_ok
Lkf_r:
    s_nop 7
Lkf_p:
    global_load_dword v40, v29, s[38:39] sc1
    s_waitcnt vmcnt(0)
    v_mov_b32 v40, v40
    v_cmp_eq_u32 vcc, -1, v40
    s_add_u32 s100, s100, 1
    s_cmp_ge_u32 s100, 262144
    s_cbranch_scc1 Lkf_p_x
    s_cbranch_vccnz Lkf_p
Lkf_p_x:
    s_nop 1
    s_branch Lkf_ok
Lax_r:
    s_nop 7
Lax_p:
    v_lshlrev_b32 v28, 4, v0
    v_add_u32 v28, 36864, v28
    global_load_dwordx4 v[200:203], v28, s[38:39] offset:-4096 sc1
    global_load_dwordx4 v[204:207], v28, s[38:39] offset:0 sc1
    v_add_u32 v28, 8192, v28
    global_load_dwordx4 v[208:211], v28, s[38:39] offset:-4096 sc1
    global_load_dwordx4 v[212:215], v28, s[38:39] offset:0 sc1
    v_min_u32 v28, 11, v1
    v_lshrrev_b32 v29, 2, v28
    v_mul_u32_u24 v29, 2544, v29
    v_lshl_add_u32 v28, v28, 2, v29
    s_lshl_b32 s4, s42, 4
    s_add_u32 s4, s4, 0
    v_add_u32 v28, s4, v28
    global_load_dword v180, v28, s[38:39] sc1
    v_add_u32 v28, 15360, v28
    global_load_dword v181, v28, s[38:39] sc1
    s_waitcnt vmcnt(0)
    v_max_u32 v236, v201, v203
    v_max3_u32 v236, v205, v207, v236
    v_max3_u32 v236, v209, v211, v236
    v_max3_u32 v236, v213, v215, v236
    v_max3_u32 v236, v180, v181, v236
    v_cmp_eq_u32 vcc, -1, v236
    s_add_u32 s100, s100, 1
    s_cmp_ge_u32 s100, 262144
    s_cbranch_scc1 Lax_p_x
    s_cbranch_vccnz Lax_p
Lax_p_x:
    s_nop 1
    s_branch Lax_ok
Lcu_r:
    s_nop 7
Lcu_p:
    s_lshl_b32 s4, s96, 7
    s_add_u32 s4, s4, 49152
    v_lshl_add_u32 v28, v2, 2, s4
    global_load_dword v8, v28, s[38:39] sc1
    global_load_dword v9, v28, s[38:39] offset:64 sc1
    s_add_u32 s4, s4, 7168
    v_lshl_add_u32 v28, v3, 4, s4
    global_load_dwordx4 v[12:15], v28, s[38:39] sc1
    global_load_dwordx4 v[16:19], v28, s[38:39] offset:64 sc1
    s_lshl_b32 s4, s97, 7
    s_add_u32 s4, s4, 49152
    v_lshl_add_u32 v28, v2, 2, s4
    global_load_dword v10, v28, s[38:39] sc1
    global_load_dword v11, v28, s[38:39] offset:64 sc1
    s_add_u32 s4, s4, 7168
    v_lshl_add_u32 v28, v3, 4, s4
    global_load_dwordx4 v[20:23], v28, s[38:39] sc1
    global_load_dwordx4 v[24:27], v28, s[38:39] offset:64 sc1
    s_lshl_b32 s4, s96, 7
    s_add_u32 s4, s4, 63488
    v_lshl_add_u32 v28, v2, 2, s4
    global_load_dword v216, v28, s[38:39] sc1
    global_load_dword v217, v28, s[38:39] offset:64 sc1
    s_add_u32 s4, s4, 7168
    v_lshl_add_u32 v28, v3, 4, s4
    global_load_dwordx4 v[220:223], v28, s[38:39] sc1
    global_load_dwordx4 v[224:227], v28, s[38:39] offset:64 sc1
    s_lshl_b32 s4, s97, 7
    s_add_u32 s4, s4, 63488
    v_lshl_add_u32 v28, v2, 2, s4
    global_load_dword v218, v28, s[38:39] sc1
    global_load_dword v219, v28, s[38:39] offset:64 sc1
    s_add_u32 s4, s4, 7168
    v_lshl_add_u32 v28, v3, 4, s4
    global_load_dwordx4 v[228:231], v28, s[38:39] sc1
    global_load_dwordx4 v[232:235], v28, s[38:39] offset:64 sc1
    s_waitcnt vmcnt(0)
    v_max_u32 v236, v8, v9
    v_max3_u32 v236, v10, v11, v236
    v_max3_u32 v236, v12, v13, v236
    v_max3_u32 v236, v14, v15, v236
    v_max3_u32 v236, v16, v17, v236
    v_max3_u32 v236, v18, v19, v236
    v_max3_u32 v236, v20, v21, v236
    v_max3_u32 v236, v22, v23, v236
    v_max3_u32 v236, v24, v25, v236
    v_max3_u32 v236, v26, v27, v236
    v_max3_u32 v236, v216, v217, v236
    v_max3_u32 v236, v218, v219, v236
    v_max3_u32 v236, v220, v221, v236
    v_max3_u32 v236, v222, v223, v236
    v_max3_u32 v236, v224, v225, v236
    v_max3_u32 v236, v226, v227, v236
    v_max3_u32 v236, v228, v229, v236
    v_max3_u32 v236, v230, v231, v236
    v_max3_u32 v236, v232, v233, v236
    v_max3_u32 v236, v234, v235, v236
    v_cmp_eq_u32 vcc, -1, v236
    s_add_u32 s100, s100, 1
    s_cmp_ge_u32 s100, 262144
    s_cbranch_scc1 Lcu_p_x
    s_cbranch_vccnz Lcu_p
Lcu_p_x:
    s_nop 1
    s_branch Lcu_ok
Lxf_r:
    s_nop 7
Lxf_p:
    v_min_u32 v29, 624, v4
    v_add_u32 v29, 98560, v29
    global_load_dwordx4 v[200:203], v29, s[38:39] sc1
    s_waitcnt vmcnt(0)
    v_max_u32 v236, v200, v201
    v_max3_u32 v236, v202, v203, v236
    v_cmp_eq_u32 vcc, -1, v236
    s_add_u32 s100, s100, 1
    s_cmp_ge_u32 s100, 262144
    s_cbranch_scc1 Lxf_p_x
    s_cbranch_vccnz Lxf_p
Lxf_p_x:
    s_nop 1
    s_branch Lxf_ok
Ls3_r:
    s_nop 7
Ls3_p:
    global_load_dwordx2 v[124:125], v169, s[38:39] offset:0 sc1
    global_load_dwordx2 v[126:127], v169, s[38:39] offset:512 sc1
    global_load_dwordx2 v[128:129], v169, s[38:39] offset:1024 sc1
    global_load_dwordx2 v[130:131], v169, s[38:39] offset:1536 sc1
    global_load_dwordx2 v[132:133], v169, s[38:39] offset:2048 sc1
    global_load_dwordx2 v[134:135], v169, s[38:39] offset:2560 sc1
    global_load_dwordx2 v[136:137], v169, s[38:39] offset:3072 sc1
    global_load_dwordx2 v[138:139], v169, s[38:39] offset:3584 sc1
    v_min_u32 v141, 26, v1
    v_lshlrev_b32 v141, 2, v141
    v_add_u32 v141, 98304, v141
    global_load_dword v140, v141, s[38:39] sc1
    s_waitcnt vmcnt(0)
    v_max3_u32 v28, v125, v127, v129
    v_max3_u32 v28, v131, v133, v28
    v_max3_u32 v28, v135, v137, v28
    v_max3_u32 v28, v139, v140, v28
    v_cmp_eq_u32 vcc, -1, v28
    s_add_u32 s100, s100, 1
    s_cmp_ge_u32 s100, 262144
    s_cbranch_scc1 Ls3_p_x
    s_cbranch_vccnz Ls3_p
Ls3_p_x:
    s_nop 1
    s_branch Ls3_ok
Lz1_r:
    s_nop 7
Lz1_p:
    global_load_dwordx4 v[190:193], v30, s[52:53] offset:1024 sc1
    global_load_dwordx4 v[194:197], v30, s[52:53] offset:2048 sc1
    global_load_dwordx4 v[198:201], v30, s[52:53] offset:3072 sc1
    global_load_dwordx4 v[202:205], v31, s[52:53] offset:-3072 sc1
    s_waitcnt vmcnt(0)
    v_max_u32 v28, v193, v197
    v_max3_u32 v28, v201, v205, v28
    v_cmp_eq_u32 vcc, -1, v28
    s_add_u32 s100, s100, 1
    s_cmp_ge_u32 s100, 262144
    s_cbranch_scc1 Lz1_p_x
    s_cbranch_vccnz Lz1_p
Lz1_p_x:
    s_nop 1
    s_branch Lz1_ok
Lz2_r:
    s_nop 7
Lz2_p:
    global_load_dwordx4 v[206:209], v31, s[52:53] offset:-2048 sc1
    global_load_dwordx4 v[210:213], v31, s[52:53] offset:-1024 sc1
    global_load_dwordx4 v[214:217], v31, s[52:53] offset:0 sc1
    global_load_dwordx4 v[218:221], v31, s[52:53] offset:1024 sc1
    s_waitcnt vmcnt(0)
    v_max_u32 v28, v209, v213
    v_max3_u32 v28, v217, v221, v28
    v_cmp_eq_u32 vcc, -1, v28
    s_add_u32 s100, s100, 1
    s_cmp_ge_u32 s100, 262144
    s_cbranch_scc1 Lz2_p_x
    s_cbranch_vccnz Lz2_p
Lz2_p_x:
    s_nop 1
    s_branch Lz2_ok
Lz3_r:
    s_nop 7
Lz3_p:
    global_load_dwordx4 v[222:225], v31, s[52:53] offset:2048 sc1
    global_load_dwordx4 v[226:229], v31, s[52:53] offset:3072 sc1
    global_load_dwordx4 v[230:233], v30, s[54:55] offset:-3072 sc1
    global_load_dwordx4 v[234:237], v30, s[54:55] offset:-2048 sc1
    s_waitcnt vmcnt(0)
    v_max_u32 v28, v225, v229
    v_max3_u32 v28, v233, v237, v28
    v_cmp_eq_u32 vcc, -1, v28
    s_add_u32 s100, s100, 1
    s_cmp_ge_u32 s100, 262144
    s_cbranch_scc1 Lz3_p_x
    s_cbranch_vccnz Lz3_p
Lz3_p_x:
    s_nop 1
    s_branch Lz3_ok
Lz4_r:
    s_nop 7
Lz4_p:
    global_load_dwordx4 v[238:241], v30, s[54:55] offset:-1024 sc1
    global_load_dwordx4 v[242:245], v30, s[54:55] offset:0 sc1
    global_load_dwordx4 v[246:249], v30, s[54:55] offset:1024 sc1
    global_load_dwordx4 v[250:253], v30, s[54:55] offset:2048 sc1
    s_waitcnt vmcnt(0)
    v_max_u32 v28, v241, v245
    v_max3_u32 v28, v249, v253, v28
    v_cmp_eq_u32 vcc, -1, v28
    s_add_u32 s100, s100, 1
    s_cmp_ge_u32 s100, 262144
    s_cbranch_scc1 Lz4_p_x
    s_cbranch_vccnz Lz4_p
Lz4_p_x:
    s_nop 1
    s_branch Lz4_ok
Lz5_r:
    s_nop 7
Lz5_p:
    global_load_dwordx4 v[174:177], v30, s[54:55] offset:3072 sc1
    global_load_dwordx4 v[178:181], v31, s[54:55] offset:-3072 sc1
    global_load_dwordx4 v[182:185], v31, s[54:55] offset:-2048 sc1
    global_load_dwordx4 v[186:189], v31, s[54:55] offset:-1024 sc1
    s_waitcnt vmcnt(0)
    v_max_u32 v28, v177, v181
    v_max3_u32 v28, v185, v189, v28
    v_cmp_eq_u32 vcc, -1, v28
    s_add_u32 s100, s100, 1
    s_cmp_ge_u32 s100, 262144
    s_cbranch_scc1 Lz5_p_x
    s_cbranch_vccnz Lz5_p
Lz5_p_x:
    s_nop 1
    s_branch Lz5_ok
Lz6_r:
    s_nop 7
Lz6_p:
    global_load_dwordx4 v[190:193], v31, s[54:55] offset:0 sc1
    global_load_dwordx4 v[194:197], v31, s[54:55] offset:1024 sc1
    global_load_dwordx4 v[198:201], v31, s[54:55] offset:2048 sc1
    global_load_dwordx4 v[202:205], v31, s[54:55] offset:3072 sc1
    s_waitcnt vmcnt(0)
    v_max_u32 v28, v193, v197
    v_max3_u32 v28, v201, v205, v28
    v_cmp_eq_u32 vcc, -1, v28
    s_add_u32 s100, s100, 1
    s_cmp_ge_u32 s100, 262144
    s_cbranch_scc1 Lz6_p_x
    s_cbranch_vccnz Lz6_p
Lz6_p_x:
    s_nop 1
    s_branch Lz6_ok
Lz7_r:
    s_nop 7
Lz7_p:
    global_load_dwordx4 v[206:209], v30, s[56:57] offset:-3072 sc1
    global_load_dwordx4 v[210:213], v31, s[56:57] offset:-3072 sc1
    global_load_dwordx4 v[214:217], v30, s[58:59] offset:-3072 sc1
    global_load_dwordx4 v[218:221], v31, s[58:59] offset:-3072 sc1
    s_waitcnt vmcnt(0)
    v_max_u32 v28, v209, v213
    v_max3_u32 v28, v217, v221, v28
    v_cmp_eq_u32 vcc, -1, v28
    s_add_u32 s100, s100, 1
    s_cmp_ge_u32 s100, 262144
    s_cbranch_scc1 Lz7_p_x
    s_cbranch_vccnz Lz7_p
Lz7_p_x:
    s_nop 1
    s_branch Lz7_ok
Lz8_r:
    s_nop 7
Lz8_p:
    global_load_dwordx4 v[222:225], v30, s[60:61] offset:-3072 sc1
    global_load_dwordx4 v[226:229], v31, s[60:61] offset:-3072 sc1
    global_load_dwordx4 v[230:233], v30, s[62:63] offset:-3072 sc1
    global_load_dwordx4 v[234:237], v31, s[62:63] offset:-3072 sc1
    s_waitcnt vmcnt(0)
    v_max_u32 v28, v225, v229
    v_max3_u32 v28, v233, v237, v28
    v_cmp_eq_u32 vcc, -1, v28
    s_add_u32 s100, s100, 1
    s_cmp_ge_u32 s100, 262144
    s_cbranch_scc1 Lz8_p_x
    s_cbranch_vccnz Lz8_p
Lz8_p_x:
    s_nop 1
    s_branch Lz8_ok
Lz9_r:
    s_nop 7
Lz9_p:
    global_load_dwordx4 v[238:241], v30, s[64:65] offset:-3072 sc1
    global_load_dwordx4 v[242:245], v31, s[64:65] offset:-3072 sc1
    global_load_dwordx4 v[246:249], v30, s[66:67] offset:-3072 sc1
    global_load_dwordx4 v[250:253], v31, s[66:67] offset:-3072 sc1
    s_waitcnt vmcnt(0)
    v_max_u32 v28, v241, v245
    v_max3_u32 v28, v249, v253, v28
    v_cmp_eq_u32 vcc, -1, v28
    s_add_u32 s100, s100, 1
    s_cmp_ge_u32 s100, 262144
    s_cbranch_scc1 Lz9_p_x
    s_cbranch_vccnz Lz9_p
Lz9_p_x:
    s_nop 1
    s_branch Lz9_ok
Lz10_r:
    s_nop 7
Lz10_p:
    global_load_dwordx4 v[174:177], v30, s[56:57] offset:-2048 sc1
    global_load_dwordx4 v[178:181], v31, s[56:57] offset:-2048 sc1
    global_load_dwordx4 v[182:185], v30, s[58:59] offset:-2048 sc1
    global_load_dwordx4 v[186:189], v31, s[58:59] offset:-2048 sc1
    s_waitcnt vmcnt(0)
    v_max_u32 v28, v177, v181
    v_max3_u32 v28, v185, v189, v28
    v_cmp_eq_u32 vcc, -1, v28
    s_add_u32 s100, s100, 1
    s_cmp_ge_u32 s100, 262144
    s_cbranch_scc1 Lz10_p_x
    s_cbranch_vccnz Lz10_p
Lz10_p_x:
    s_nop 1
    s_branch Lz10_ok
Lz11_r:
    s_nop 7
Lz11_p:
    global_load_dwordx4 v[190:193], v30, s[60:61] offset:-2048 sc1
    global_load_dwordx4 v[194:197], v31, s[60:61] offset:-2048 sc1
    global_load_dwordx4 v[198:201], v30, s[62:63] offset:-2048 sc1
    global_load_dwordx4 v[202:205], v31, s[62:63] offset:-2048 sc1
    s_waitcnt vmcnt(0)
    v_max_u32 v28, v193, v197
    v_max3_u32 v28, v201, v205, v28
    v_cmp_eq_u32 vcc, -1, v28
    s_add_u32 s100, s100, 1
    s_cmp_ge_u32 s100, 262144
    s_cbranch_scc1 Lz11_p_x
    s_cbranch_vccnz Lz11_p
Lz11_p_x:
    s_nop 1
    s_branch Lz11_ok
Lz12_r:
    s_nop 7
Lz12_p:
    global_load_dwordx4 v[206:209], v30, s[64:65] offset:-2048 sc1
    global_load_dwordx4 v[210:213], v31, s[64:65] offset:-2048 sc1
    global_load_dwordx4 v[214:217], v30, s[66:67] offset:-2048 sc1
    global_load_dwordx4 v[218:221], v31, s[66:67] offset:-2048 sc1
    s_waitcnt vmcnt(0)
    v_max_u32 v28, v209, v213
    v_max3_u32 v28, v217, v221, v28
    v_cmp_eq_u32 vcc, -1, v28
    s_add_u32 s100, s100, 1
    s_cmp_ge_u32 s100, 262144
    s_cbranch_scc1 Lz12_p_x
    s_cbranch_vccnz Lz12_p
Lz12_p_x:
    s_nop 1
    s_branch Lz12_ok
Lz13_r:
    s_nop 7
Lz13_p:
    global_load_dwordx4 v[222:225], v30, s[56:57] offset:-1024 sc1
    global_load_dwordx4 v[226:229], v31, s[56:57] offset:-1024 sc1
    global_load_dwordx4 v[230:233], v30, s[58:59] offset:-1024 sc1
    global_load_dwordx4 v[234:237], v31, s[58:59] offset:-1024 sc1
    s_waitcnt vmcnt(0)
    v_max_u32 v28, v225, v229
    v_max3_u32 v28, v233, v237, v28
    v_cmp_eq_u32 vcc, -1, v28
    s_add_u32 s100, s100, 1
    s_cmp_ge_u32 s100, 262144
    s_cbranch_scc1 Lz13_p_x
    s_cbranch_vccnz Lz13_p
Lz13_p_x:
    s_nop 1
    s_branch Lz13_ok
Lz14_r:
    s_nop 7
Lz14_p:
    global_load_dwordx4 v[238:241], v30, s[60:61] offset:-1024 sc1
    global_load_dwordx4 v[242:245], v31, s[60:61] offset:-1024 sc1
    global_load_dwordx4 v[246:249], v30, s[62:63] offset:-1024 sc1
    global_load_dwordx4 v[250:253], v31, s[62:63] offset:-1024 sc1
    s_waitcnt vmcnt(0)
    v_max_u32 v28, v241, v245
    v_max3_u32 v28, v249, v253, v28
    v_cmp_eq_u32 vcc, -1, v28
    s_add_u32 s100, s100, 1
    s_cmp_ge_u32 s100, 262144
    s_cbranch_scc1 Lz14_p_x
    s_cbranch_vccnz Lz14_p
Lz14_p_x:
    s_nop 1
    s_branch Lz14_ok
Lz15_r:
    s_nop 7
Lz15_p:
    global_load_dwordx4 v[174:177], v30, s[64:65] offset:-1024 sc1
    global_load_dwordx4 v[178:181], v31, s[64:65] offset:-1024 sc1
    global_load_dwordx4 v[182:185], v30, s[66:67] offset:-1024 sc1
    global_load_dwordx4 v[186:189], v31, s[66:67] offset:-1024 sc1
    s_waitcnt vmcnt(0)
    v_max_u32 v28, v177, v181
    v_max3_u32 v28, v185, v189, v28
    v_cmp_eq_u32 vcc, -1, v28
    s_add_u32 s100, s100, 1
    s_cmp_ge_u32 s100, 262144
    s_cbranch_scc1 Lz15_p_x
    s_cbranch_vccnz Lz15_p
Lz15_p_x:
    s_nop 1
    s_branch Lz15_ok
Lz16_r:
    s_nop 7
Lz16_p:
    global_load_dwordx4 v[190:193], v30, s[56:57] offset:0 sc1
    global_load_dwordx4 v[194:197], v31, s[56:57] offset:0 sc1
    global_load_dwordx4 v[198:201], v30, s[58:59] offset:0 sc1
    global_load_dwordx4 v[202:205], v31, s[58:59] offset:0 sc1
    s_waitcnt vmcnt(0)
    v_max_u32 v28, v193, v197
    v_max3_u32 v28, v201, v205, v28
    v_cmp_eq_u32 vcc, -1, v28
    s_add_u32 s100, s100, 1
    s_cmp_ge_u32 s100, 262144
    s_cbranch_scc1 Lz16_p_x
    s_cbranch_vccnz Lz16_p
Lz16_p_x:
    s_nop 1
    s_branch Lz16_ok
Lz17_r:
    s_nop 7
Lz17_p:
    global_load_dwordx4 v[206:209], v30, s[60:61] offset:0 sc1
    global_load_dwordx4 v[210:213], v31, s[60:61] offset:0 sc1
    global_load_dwordx4 v[214:217], v30, s[62:63] offset:0 sc1
    global_load_dwordx4 v[218:221], v31, s[62:63] offset:0 sc1
    s_waitcnt vmcnt(0)
    v_max_u32 v28, v209, v213
    v_max3_u32 v28, v217, v221, v28
    v_cmp_eq_u32 vcc, -1, v28
    s_add_u32 s100, s100, 1
    s_cmp_ge_u32 s100, 262144
    s_cbranch_scc1 Lz17_p_x
    s_cbranch_vccnz Lz17_p
Lz17_p_x:
    s_nop 1
    s_branch Lz17_ok
Lz18_r:
    s_nop 7
Lz18_p:
    global_load_dwordx4 v[222:225], v30, s[64:65] offset:0 sc1
    global_load_dwordx4 v[226:229], v31, s[64:65] offset:0 sc1
    global_load_dwordx4 v[230:233], v30, s[66:67] offset:0 sc1
    global_load_dwordx4 v[234:237], v31, s[66:67] offset:0 sc1
    s_waitcnt vmcnt(0)
    v_max_u32 v28, v225, v229
    v_max3_u32 v28, v233, v237, v28
    v_cmp_eq_u32 vcc, -1, v28
    s_add_u32 s100, s100, 1
    s_cmp_ge_u32 s100, 262144
    s_cbranch_scc1 Lz18_p_x
    s_cbranch_vccnz Lz18_p
Lz18_p_x:
    s_nop 1
    s_branch Lz18_ok
Lz19_r:
    s_nop 7
Lz19_p:
    global_load_dwordx4 v[238:241], v30, s[56:57] offset:1024 sc1
    global_load_dwordx4 v[242:245], v31, s[56:57] offset:1024 sc1
    global_load_dwordx4 v[246:249], v30, s[58:59] offset:1024 sc1
    global_load_dwordx4 v[250:253], v31, s[58:59] offset:1024 sc1
    s_waitcnt vmcnt(0)
    v_max_u32 v28, v241, v245
    v_max3_u32 v28, v249, v253, v28
    v_cmp_eq_u32 vcc, -1, v28
    s_add_u32 s100, s100, 1
    s_cmp_ge_u32 s100, 262144
    s_cbranch_scc1 Lz19_p_x
    s_cbranch_vccnz Lz19_p
Lz19_p_x:
    s_nop 1
    s_branch Lz19_ok
Lz20_r:
    s_nop 7
Lz20_p:
    global_load_dwordx4 v[174:177], v30, s[60:61] offset:1024 sc1
    global_load_dwordx4 v[178:181], v31, s[60:61] offset:1024 sc1
    global_load_dwordx4 v[182:185], v30, s[62:63] offset:1024 sc1
    global_load_dwordx4 v[186:189], v31, s[62:63] offset:1024 sc1
    s_waitcnt vmcnt(0)
    v_max_u32 v28, v177, v181
    v_max3_u32 v28, v185, v189, v28
    v_cmp_eq_u32 vcc, -1, v28
    s_add_u32 s100, s100, 1
    s_cmp_ge_u32 s100, 262144
    s_cbranch_scc1 Lz20_p_x
    s_cbranch_vccnz Lz20_p
Lz20_p_x:
    s_nop 1
    s_branch Lz20_ok
Lz21_r:
    s_nop 7
Lz21_p:
    global_load_dwordx4 v[190:193], v30, s[64:65] offset:1024 sc1
    global_load_dwordx4 v[194:197], v31, s[64:65] offset:1024 sc1
    global_load_dwordx4 v[198:201], v30, s[66:67] offset:1024 sc1
    global_load_dwordx4 v[202:205], v31, s[66:67] offset:1024 sc1
    s_waitcnt vmcnt(0)
    v_max_u32 v28, v193, v197
    v_max3_u32 v28, v201, v205, v28
    v_cmp_eq_u32 vcc, -1, v28
    s_add_u32 s100, s100, 1
    s_cmp_ge_u32 s100, 262144
    s_cbranch_scc1 Lz21_p_x
    s_cbranch_vccnz Lz21_p
Lz21_p_x:
    s_nop 1
    s_branch Lz21_ok
Lz22_r:
    s_nop 7
Lz22_p:
    global_load_dwordx4 v[206:209], v30, s[56:57] offset:2048 sc1
    global_load_dwordx4 v[210:213], v31, s[56:57] offset:2048 sc1
    global_load_dwordx4 v[214:217], v30, s[58:59] offset:2048 sc1
    global_load_dwordx4 v[218:221], v31, s[58:59] offset:2048 sc1
    s_waitcnt vmcnt(0)
    v_max_u32 v28, v209, v213
    v_max3_u32 v28, v217, v221, v28
    v_cmp_eq_u32 vcc, -1, v28
    s_add_u32 s100, s100, 1
    s_cmp_ge_u32 s100, 262144
    s_cbranch_scc1 Lz22_p_x
    s_cbranch_vccnz Lz22_p
Lz22_p_x:
    s_nop 1
    s_branch Lz22_ok
Lz23_r:
    s_nop 7
Lz23_p:
    global_load_dwordx4 v[222:225], v30, s[60:61] offset:2048 sc1
    global_load_dwordx4 v[226:229], v31, s[60:61] offset:2048 sc1
    global_load_dwordx4 v[230:233], v30, s[62:63] offset:2048 sc1
    global_load_dwordx4 v[234:237], v31, s[62:63] offset:2048 sc1
    s_waitcnt vmcnt(0)
    v_max_u32 v28, v225, v229
    v_max3_u32 v28, v233, v237, v28
    v_cmp_eq_u32 vcc, -1, v28
    s_add_u32 s100, s100, 1
    s_cmp_ge_u32 s100, 262144
    s_cbranch_scc1 Lz23_p_x
    s_cbranch_vccnz Lz23_p
Lz23_p_x:
    s_nop 1
    s_branch Lz23_ok
Lz24_r:
    s_nop 7
Lz24_p:
    global_load_dwordx4 v[238:241], v30, s[64:65] offset:2048 sc1
    global_load_dwordx4 v[242:245], v31, s[64:65] offset:2048 sc1
    global_load_dwordx4 v[246:249], v30, s[66:67] offset:2048 sc1
    global_load_dwordx4 v[250:253], v31, s[66:67] offset:2048 sc1
    s_waitcnt vmcnt(0)
    v_max_u32 v28, v241, v245
    v_max3_u32 v28, v249, v253, v28
    v_cmp_eq_u32 vcc, -1, v28
    s_add_u32 s100, s100, 1
    s_cmp_ge_u32 s100, 262144
    s_cbranch_scc1 Lz24_p_x
    s_cbranch_vccnz Lz24_p
Lz24_p_x:
    s_nop 1
    s_branch Lz24_ok
Lpf_r:
    s_nop 7
Lpf_p:
    global_load_dword v9, v8, s[38:39] sc1
    s_waitcnt vmcnt(0)
    v_mov_b32 v9, v9
    v_cmp_eq_u32 vcc, -1, v9
    s_add_u32 s100, s100, 1
    s_cmp_ge_u32 s100, 262144
    s_cbranch_scc1 Lpf_p_x
    s_cbranch_vccnz Lpf_p
Lpf_p_x:
    s_nop 1
    s_branch Lpf_ok
Lz25_r:
    s_nop 7
Lz25_p:
    global_load_dwordx4 v[174:177], v30, s[56:57] offset:3072 sc1
    global_load_dwordx4 v[178:181], v31, s[56:57] offset:3072 sc1
    global_load_dwordx4 v[182:185], v30, s[58:59] offset:3072 sc1
    global_load_dwordx4 v[186:189], v31, s[58:59] offset:3072 sc1
    s_waitcnt vmcnt(0)
    v_max_u32 v28, v177, v181
    v_max3_u32 v28, v185, v189, v28
    v_cmp_eq_u32 vcc, -1, v28
    s_add_u32 s100, s100, 1
    s_cmp_ge_u32 s100, 262144
    s_cbranch_scc1 Lz25_p_x
    s_cbranch_vccnz Lz25_p
Lz25_p_x:
    s_nop 1
    s_branch Lz25_ok
Lz26_r:
    s_nop 7
Lz26_p:
    global_load_dwordx4 v[190:193], v30, s[60:61] offset:3072 sc1
    global_load_dwordx4 v[194:197], v31, s[60:61] offset:3072 sc1
    global_load_dwordx4 v[198:201], v30, s[62:63] offset:3072 sc1
    global_load_dwordx4 v[202:205], v31, s[62:63] offset:3072 sc1
    s_waitcnt vmcnt(0)
    v_max_u32 v28, v193, v197
    v_max3_u32 v28, v201, v205, v28
    v_cmp_eq_u32 vcc, -1, v28
    s_add_u32 s100, s100, 1
    s_cmp_ge_u32 s100, 262144
    s_cbranch_scc1 Lz26_p_x
    s_cbranch_vccnz Lz26_p
Lz26_p_x:
    s_nop 1
    s_branch Lz26_ok
Lz27_r:
    s_nop 7
Lz27_p:
    global_load_dwordx4 v[206:209], v30, s[64:65] offset:3072 sc1
    global_load_dwordx4 v[210:213], v31, s[64:65] offset:3072 sc1
    global_load_dwordx4 v[214:217], v30, s[66:67] offset:3072 sc1
    global_load_dwordx4 v[218:221], v31, s[66:67] offset:3072 sc1
    s_waitcnt vmcnt(0)
    v_max_u32 v28, v209, v213
    v_max3_u32 v28, v217, v221, v28
    v_cmp_eq_u32 vcc, -1, v28
    s_add_u32 s100, s100, 1
    s_cmp_ge_u32 s100, 262144
    s_cbranch_scc1 Lz27_p_x
    s_cbranch_vccnz Lz27_p
Lz27_p_x:
    s_nop 1
    s_branch Lz27_ok
Lgb_r:
    s_nop 7
Lgb_p:
    s_mul_i32 s5, s41, 320
    s_add_u32 s5, s5, 12800
    v_lshl_add_u32 v28, v3, 5, s5
    v_lshl_add_u32 v29, v3, 4, s5
    global_load_dwordx4 v[218:221], v28, s[38:39] offset:0 sc1
    global_load_dwordx4 v[222:225], v28, s[38:39] offset:16 sc1
    global_load_dwordx4 v[226:229], v28, s[38:39] offset:128 sc1
    global_load_dwordx4 v[230:233], v28, s[38:39] offset:144 sc1
    global_load_dwordx4 v[234:237], v29, s[38:39] offset:256 sc1
    s_add_u32 s5, s5, 15360
    v_lshl_add_u32 v28, v3, 5, s5
    v_lshl_add_u32 v29, v3, 4, s5
    global_load_dwordx4 v[238:241], v28, s[38:39] offset:0 sc1
    global_load_dwordx4 v[242:245], v28, s[38:39] offset:16 sc1
    global_load_dwordx4 v[246:249], v28, s[38:39] offset:128 sc1
    global_load_dwordx4 v[250:253], v28, s[38:39] offset:144 sc1
    global_load_dwordx4 v[12:15], v29, s[38:39] offset:256 sc1
    s_add_u32 s5, s5, 15360
    s_waitcnt vmcnt(0)
    v_max_u32 v28, v218, v219
    v_max3_u32 v28, v220, v221, v28
    v_max3_u32 v28, v222, v223, v28
    v_max3_u32 v28, v224, v225, v28
    v_max3_u32 v28, v226, v227, v28
    v_max3_u32 v28, v228, v229, v28
    v_max3_u32 v28, v230, v231, v28
    v_max3_u32 v28, v232, v233, v28
    v_max3_u32 v28, v234, v235, v28
    v_max3_u32 v28, v236, v237, v28
    v_max3_u32 v28, v238, v239, v28
    v_max3_u32 v28, v240, v241, v28
    v_max3_u32 v28, v242, v243, v28
    v_max3_u32 v28, v244, v245, v28
    v_max3_u32 v28, v246, v247, v28
    v_max3_u32 v28, v248, v249, v28
    v_max3_u32 v28, v250, v251, v28
    v_max3_u32 v28, v252, v253, v28
    v_max3_u32 v28, v12, v13, v28
    v_max3_u32 v28, v14, v15, v28
    v_cmp_eq_u32 vcc, -1, v28
    s_add_u32 s100, s100, 1
    s_cmp_ge_u32 s100, 262144
    s_cbranch_scc1 Lgb_p_x
    s_cbranch_vccnz Lgb_p
Lgb_p_x:
    s_nop 1
    s_branch Lgb_ok
Lp0_r:
    s_nop 7
Lp0_p:
    global_load_dwordx4 v[62:65], v6, s[38:39] offset:-4096 sc1
    global_load_dwordx4 v[66:69], v6, s[38:39] offset:0 sc1
    global_load_dwordx4 v[70:73], v6, s[38:39] offset:3072 sc1
    global_load_dwordx4 v[74:77], v7, s[38:39] offset:-1024 sc1
    global_load_dwordx4 v[78:81], v7, s[38:39] offset:2048 sc1
    global_load_dwordx4 v[82:85], v26, s[38:39] offset:-2048 sc1
    global_load_dwordx4 v[86:89], v26, s[38:39] offset:1024 sc1
    global_load_dwordx4 v[90:93], v27, s[38:39] offset:-3072 sc1
    s_waitcnt vmcnt(0)
    v_max_u32 v28, v65, v69
    v_max3_u32 v28, v73, v77, v28
    v_max3_u32 v28, v81, v85, v28
    v_max3_u32 v28, v89, v93, v28
    v_cmp_eq_u32 vcc, -1, v28
    s_add_u32 s100, s100, 1
    s_cmp_ge_u32 s100, 262144
    s_cbranch_scc1 Lp0_p_x
    s_cbranch_vccnz Lp0_p
Lp0_p_x:
    s_nop 1
    s_branch Lp0_ok
Lp1_r:
    s_nop 7
Lp1_p:
    global_load_dwordx4 v[94:97], v6, s[38:39] offset:-3072 sc1
    global_load_dwordx4 v[98:101], v6, s[38:39] offset:1024 sc1
    global_load_dwordx4 v[102:105], v7, s[38:39] offset:-4096 sc1
    global_load_dwordx4 v[106:109], v7, s[38:39] offset:0 sc1
    global_load_dwordx4 v[110:113], v7, s[38:39] offset:3072 sc1
    global_load_dwordx4 v[114:117], v26, s[38:39] offset:-1024 sc1
    global_load_dwordx4 v[118:121], v26, s[38:39] offset:2048 sc1
    global_load_dwordx4 v[122:125], v27, s[38:39] offset:-2048 sc1
    s_waitcnt vmcnt(0)
    v_max_u32 v28, v97, v101
    v_max3_u32 v28, v105, v109, v28
    v_max3_u32 v28, v113, v117, v28
    v_max3_u32 v28, v121, v125, v28
    v_cmp_eq_u32 vcc, -1, v28
    s_add_u32 s100, s100, 1
    s_cmp_ge_u32 s100, 262144
    s_cbranch_scc1 Lp1_p_x
    s_cbranch_vccnz Lp1_p
Lp1_p_x:
    s_nop 1
    s_branch Lp1_ok
Lp2_r:
    s_nop 7
Lp2_p:
    global_load_dwordx4 v[126:129], v6, s[38:39] offset:-2048 sc1
    global_load_dwordx4 v[130:133], v6, s[38:39] offset:2048 sc1
    global_load_dwordx4 v[134:137], v7, s[38:39] offset:-3072 sc1
    global_load_dwordx4 v[138:141], v7, s[38:39] offset:1024 sc1
    global_load_dwordx4 v[142:145], v26, s[38:39] offset:-4096 sc1
    global_load_dwordx4 v[146:149], v26, s[38:39] offset:0 sc1
    global_load_dwordx4 v[150:153], v26, s[38:39] offset:3072 sc1
    s_waitcnt vmcnt(0)
    v_max3_u32 v28, v129, v133, v137
    v_max3_u32 v28, v141, v145, v28
    v_max3_u32 v28, v149, v153, v28
    v_cmp_eq_u32 vcc, -1, v28
    s_add_u32 s100, s100, 1
    s_cmp_ge_u32 s100, 262144
    s_cbranch_scc1 Lp2_p_x
    s_cbranch_vccnz Lp2_p
Lp2_p_x:
    s_nop 1
    s_branch Lp2_ok
Lp3_r:
    s_nop 7
Lp3_p:
    global_load_dwordx4 v[158:161], v6, s[38:39] offset:-1024 sc1
    global_load_dwordx4 v[162:165], v7, s[38:39] offset:-2048 sc1
    global_load_dwordx4 v[166:169], v26, s[38:39] offset:-3072 sc1
    global_load_dwordx4 v[170:173], v27, s[38:39] offset:-4096 sc1
    s_waitcnt vmcnt(0)
    v_max_u32 v28, v159, v161
    v_max3_u32 v28, v163, v165, v28
    v_max3_u32 v28, v167, v169, v28
    v_max3_u32 v28, v171, v173, v28
    v_cmp_eq_u32 vcc, -1, v28
    s_add_u32 s100, s100, 1
    s_cmp_ge_u32 s100, 262144
    s_cbranch_scc1 Lp3_p_x
    s_cbranch_vccnz Lp3_p
Lp3_p_x:
    s_nop 1
    s_branch Lp3_ok
Lcode_end:
    s_endpgm
.section .rodata,"a"
.p2align 6
.amdhsa_kernel adaLN_cond__ssm_conv_h3__mixer_gmlp__prompt_kernel
  .amdhsa_next_free_vgpr 512
  .amdhsa_next_free_sgpr 102
  .amdhsa_accum_offset 256
  .amdhsa_group_segment_fixed_size 0
  .amdhsa_kernarg_size 128
  .amdhsa_user_sgpr_count 2
  .amdhsa_user_sgpr_kernarg_segment_ptr 1
  .amdhsa_system_sgpr_workgroup_id_x 1
  .amdhsa_float_denorm_mode_32 3
.end_amdhsa_kernel
```

```asm
; @launch grid=(256,1,1) block=(256,1,1) lds=163840
.amdgcn_target "amdgcn-amd-amdhsa--gfx950"
.text
.p2align 8
.globl adaLN_cond__ssm_conv_h3__mixer_gmlp__prompt_kernel
.type adaLN_cond__ssm_conv_h3__mixer_gmlp__prompt_kernel,@function
adaLN_cond__ssm_conv_h3__mixer_gmlp__prompt_kernel:
    s_cmp_ge_u32 s2, 256
    s_cbranch_scc1 Lend
    s_load_dwordx16 s[8:23], s[0:1], 0
    s_load_dwordx16 s[24:39], s[0:1], 64
    v_lshrrev_b32 v2, 6, v0
    v_and_b32 v1, 63, v0
    v_readfirstlane_b32 s3, v2
    s_getpc_b64 s[4:5]
Lpf_adaLN_cond__ssm_conv_h3__mixer_gmlp__prompt_kernel_8:
    s_add_u32 s4, s4, adaLN_cond__ssm_conv_h3__mixer_gmlp__prompt_kernel-Lpf_adaLN_cond__ssm_conv_h3__mixer_gmlp__prompt_kernel_8
    s_addc_u32 s5, s5, -1
    s_lshr_b32 s6, s2, 3
    s_and_b32 s6, s6, 31
    v_mul_u32_u24 v254, 32, v0
    v_add_lshl_u32 v254, v254, s6, 7
    v_min_u32 v254, (Lcode_end-adaLN_cond__ssm_conv_h3__mixer_gmlp__prompt_kernel-4), v254
    global_load_dword v254, v254, s[4:5]
    v_and_b32 v2, 15, v1
    v_lshrrev_b32 v3, 4, v1
    v_lshlrev_b32 v4, 4, v1
    v_lshrrev_b32 v6, 2, v2
    v_and_b32 v5, 3, v2
    v_lshl_add_u32 v5, v6, 3, v5
    s_mov_b32 s100, 0
    s_and_b32 s4, s2, 7
    s_lshr_b32 s5, s2, 3
    s_lshr_b32 s43, s5, 2
    s_lshr_b32 s6, s43, 1
    s_lshl_b32 s6, s6, 3
    s_and_b32 s7, s4, 6
    s_add_u32 s6, s6, s7
    s_and_b32 s7, s43, 1
    s_add_u32 s40, s6, s7
    s_and_b32 s6, s4, 1
    s_lshl_b32 s6, s6, 2
    s_and_b32 s7, s5, 3
    s_add_u32 s41, s6, s7
    s_mul_i32 s4, s4, 20
    s_add_u32 s42, s4, s5
    s_waitcnt lgkmcnt(0)
    s_cmp_ge_u32 s2, 160
    s_cbranch_scc0 Lconv
Lspare:
    s_sub_u32 s42, s2, 160
    s_cmp_lt_u32 s42, 54
    s_cbranch_scc0 Lsp_b
    s_and_b32 s5, s42, 0x34
    s_cbranch_scc1 Lsp_a2
    s_lshr_b32 s5, s42, 3
    s_lshl_b32 s5, s5, 2
    s_and_b32 s48, s42, 3
    s_add_u32 s48, s48, s5
    v_mov_b32 v8, -1
    v_mov_b32 v9, -1
    v_mov_b32 v10, -1
    v_mov_b32 v11, -1
    s_lshl_b32 s4, s48, 13
    s_add_u32 s4, s4, 36864
    v_lshl_add_u32 v6, v0, 4, s4
    global_store_dwordx4 v6, v[8:11], s[38:39] offset:-4096 sc1
    global_store_dwordx4 v6, v[8:11], s[38:39] offset:0 sc1
    s_lshl_b32 s4, s48, 8
    s_add_u32 s4, s4, 98304
    v_lshl_add_u32 v7, v1, 2, s4
    global_store_dword v7, v8, s[38:39] sc1
    s_lshl_b32 s4, s48, 2
    v_mov_b32 v6, s4
    s_waitcnt vmcnt(0)
    s_barrier
    s_cmp_lg_u32 s3, 0
    s_cbranch_scc1 Linit_skip
    global_store_dword v6, v8, s[36:37] sc1
Linit_skip:
    s_branch Lsp_a2
Lsp_b:
    s_sub_u32 s48, s42, 54
    s_add_u32 s49, s48, 42
    s_add_u32 s50, s48, 84
    s_cmp_ge_u32 s50, 120
    s_cselect_b32 s50, s49, s50
    s_cmp_eq_u32 s3, 1
    s_cselect_b32 s51, s49, s48
    s_cmp_eq_u32 s3, 2
    s_cselect_b32 s51, s50, s51
    s_lshr_b32 s4, s51, 1
    s_and_b32 s5, s51, 1
    s_cmp_lt_u32 s4, 50
    s_cselect_b32 s6, -20, 0
    s_cmp_lt_u32 s4, 20
    s_cselect_b32 s6, 30, s6
    s_add_u32 s4, s4, s6
    s_mul_i32 s6, s5, 15360
    s_lshl_b32 s7, s4, 8
    s_add_u32 s51, s6, s7
    v_lshl_add_u32 v164, v1, 2, s51
    v_mov_b32 v165, -1
    global_store_dword v164, v165, s[38:39] offset:0 sc1
    s_lshr_b32 s4, s48, 1
    s_and_b32 s5, s48, 1
    s_cmp_lt_u32 s4, 50
    s_cselect_b32 s6, -20, 0
    s_cmp_lt_u32 s4, 20
    s_cselect_b32 s6, 30, s6
    s_add_u32 s4, s4, s6
    s_mul_i32 s6, s5, 15360
    s_lshl_b32 s7, s4, 8
    s_add_u32 s44, s6, s7
    s_lshl_b32 s5, s5, 2
    s_add_u32 s5, s5, s3
    s_mul_i32 s5, s5, 80
    s_lshl_b32 s4, s4, 7
    s_mul_i32 s6, s5, 7680
    s_add_u32 s4, s4, s6
    v_min_u32 v28, 39, v1
    s_lshl_b32 s5, s5, 1
    v_lshl_add_u32 v28, v28, 2, s5
    global_load_dword v80, v28, s[30:31]
    v_lshrrev_b32 v29, 3, v1
    v_mul_u32_u24 v28, 15232, v29
    v_add3_u32 v28, v28, v4, s4
    global_load_dwordx4 v[40:43], v28, s[32:33] nt
    v_add_u32 v28, 7680, v28
    global_load_dwordx4 v[44:47], v28, s[32:33] nt
    v_add_u32 v28, 115200, v28
    global_load_dwordx4 v[48:51], v28, s[32:33] nt
    v_add_u32 v28, 7680, v28
    global_load_dwordx4 v[52:55], v28, s[32:33] nt
    v_add_u32 v28, 115200, v28
    global_load_dwordx4 v[56:59], v28, s[32:33] nt
    v_add_u32 v28, 7680, v28
    global_load_dwordx4 v[60:63], v28, s[32:33] nt
    v_add_u32 v28, 115200, v28
    global_load_dwordx4 v[64:67], v28, s[32:33] nt
    v_add_u32 v28, 7680, v28
    global_load_dwordx4 v[68:71], v28, s[32:33] nt
    v_add_u32 v28, 115200, v28
    global_load_dwordx4 v[72:75], v28, s[32:33] nt
    v_add_u32 v28, 7680, v28
    global_load_dwordx4 v[76:79], v28, s[32:33] nt
    s_lshl_b32 s4, s48, 2
    s_add_u32 s4, s4, 32
    v_mov_b32 v164, s4
    s_waitcnt vmcnt(10)
    s_barrier
    s_cmp_lg_u32 s3, 0
    s_cbranch_scc1 Lsb_skip
    global_store_dword v164, v165, s[36:37] sc1
Lsb_skip:
    s_lshr_b32 s4, s49, 1
    s_and_b32 s5, s49, 1
    s_cmp_lt_u32 s4, 50
    s_cselect_b32 s6, -20, 0
    s_cmp_lt_u32 s4, 20
    s_cselect_b32 s6, 30, s6
    s_add_u32 s4, s4, s6
    s_mul_i32 s6, s5, 15360
    s_lshl_b32 s7, s4, 8
    s_add_u32 s45, s6, s7
    s_lshl_b32 s5, s5, 2
    s_add_u32 s5, s5, s3
    s_mul_i32 s5, s5, 80
    s_lshl_b32 s4, s4, 7
    s_mul_i32 s6, s5, 7680
    s_add_u32 s4, s4, s6
    v_min_u32 v96, 39, v1
    s_lshl_b32 s5, s5, 1
    v_lshl_add_u32 v96, v96, 2, s5
    global_load_dword v148, v96, s[30:31]
    v_lshrrev_b32 v97, 3, v1
    v_mul_u32_u24 v96, 15232, v97
    v_add3_u32 v96, v96, v4, s4
    global_load_dwordx4 v[108:111], v96, s[32:33] nt
    v_add_u32 v96, 7680, v96
    global_load_dwordx4 v[112:115], v96, s[32:33] nt
    v_add_u32 v96, 115200, v96
    global_load_dwordx4 v[116:119], v96, s[32:33] nt
    v_add_u32 v96, 7680, v96
    global_load_dwordx4 v[120:123], v96, s[32:33] nt
    v_add_u32 v96, 115200, v96
    global_load_dwordx4 v[124:127], v96, s[32:33] nt
    v_add_u32 v96, 7680, v96
    global_load_dwordx4 v[128:131], v96, s[32:33] nt
    v_add_u32 v96, 115200, v96
    v_lshlrev_b32 v82, 16, v80
    v_and_b32 v83, 0xffff0000, v80
    v_lshlrev_b32 v29, 2, v29
    v_mul_f32 v84, 0xbfb8aa3b, v82
    v_mul_f32 v85, 0xbfb8aa3b, v83
    v_exp_f32 v84, v84
    v_exp_f32 v85, v85
    v_add_f32 v84, 1.0, v84
    v_add_f32 v85, 1.0, v85
    v_rcp_f32 v84, v84
    v_rcp_f32 v85, v85
    v_mul_f32 v82, v82, v84
    v_mul_f32 v83, v83, v85
    v_cvt_pk_bf16_f32 v80, v82, v83
    ds_bpermute_b32 v88, v29, v80 offset:0
    ds_bpermute_b32 v89, v29, v80 offset:32
    ds_bpermute_b32 v90, v29, v80 offset:64
    ds_bpermute_b32 v91, v29, v80 offset:96
    ds_bpermute_b32 v92, v29, v80 offset:128
    s_waitcnt lgkmcnt(4)
    v_lshlrev_b32 v30, 16, v88
    v_and_b32 v31, 0xffff0000, v88
    s_waitcnt lgkmcnt(3)
    v_lshlrev_b32 v32, 16, v89
    v_and_b32 v33, 0xffff0000, v89
    s_waitcnt lgkmcnt(2)
    v_lshlrev_b32 v34, 16, v90
    v_and_b32 v35, 0xffff0000, v90
    s_waitcnt lgkmcnt(1)
    v_lshlrev_b32 v36, 16, v91
    v_and_b32 v37, 0xffff0000, v91
    s_waitcnt lgkmcnt(0)
    v_lshlrev_b32 v38, 16, v92
    v_and_b32 v39, 0xffff0000, v92
    s_waitcnt vmcnt(16)
    v_lshlrev_b32 v80, 16, v40
    v_and_b32 v81, 0xffff0000, v40
    v_lshlrev_b32 v82, 16, v41
    v_and_b32 v83, 0xffff0000, v41
    v_lshlrev_b32 v84, 16, v42
    v_and_b32 v85, 0xffff0000, v42
    v_lshlrev_b32 v86, 16, v43
    v_and_b32 v87, 0xffff0000, v43
    v_pk_mul_f32 v[88:89], v[30:31], v[80:81] op_sel:[0,0] op_sel_hi:[0,1]
    v_pk_mul_f32 v[90:91], v[30:31], v[82:83] op_sel:[0,0] op_sel_hi:[0,1]
    v_pk_mul_f32 v[92:93], v[30:31], v[84:85] op_sel:[0,0] op_sel_hi:[0,1]
    v_pk_mul_f32 v[94:95], v[30:31], v[86:87] op_sel:[0,0] op_sel_hi:[0,1]
    s_waitcnt vmcnt(15)
    v_lshlrev_b32 v80, 16, v44
    v_and_b32 v81, 0xffff0000, v44
    v_lshlrev_b32 v82, 16, v45
    v_and_b32 v83, 0xffff0000, v45
    v_lshlrev_b32 v84, 16, v46
    v_and_b32 v85, 0xffff0000, v46
    v_lshlrev_b32 v86, 16, v47
    v_and_b32 v87, 0xffff0000, v47
    v_pk_fma_f32 v[88:89], v[30:31], v[80:81], v[88:89] op_sel:[1,0,0] op_sel_hi:[1,1,1]
    v_pk_fma_f32 v[90:91], v[30:31], v[82:83], v[90:91] op_sel:[1,0,0] op_sel_hi:[1,1,1]
    v_pk_fma_f32 v[92:93], v[30:31], v[84:85], v[92:93] op_sel:[1,0,0] op_sel_hi:[1,1,1]
    v_pk_fma_f32 v[94:95], v[30:31], v[86:87], v[94:95] op_sel:[1,0,0] op_sel_hi:[1,1,1]
    s_waitcnt vmcnt(14)
    v_lshlrev_b32 v80, 16, v48
    v_and_b32 v81, 0xffff0000, v48
    v_lshlrev_b32 v82, 16, v49
    v_and_b32 v83, 0xffff0000, v49
    v_lshlrev_b32 v84, 16, v50
    v_and_b32 v85, 0xffff0000, v50
    v_lshlrev_b32 v86, 16, v51
    v_and_b32 v87, 0xffff0000, v51
    v_pk_fma_f32 v[88:89], v[32:33], v[80:81], v[88:89] op_sel:[0,0,0] op_sel_hi:[0,1,1]
    v_pk_fma_f32 v[90:91], v[32:33], v[82:83], v[90:91] op_sel:[0,0,0] op_sel_hi:[0,1,1]
    v_pk_fma_f32 v[92:93], v[32:33], v[84:85], v[92:93] op_sel:[0,0,0] op_sel_hi:[0,1,1]
    v_pk_fma_f32 v[94:95], v[32:33], v[86:87], v[94:95] op_sel:[0,0,0] op_sel_hi:[0,1,1]
    s_waitcnt vmcnt(13)
    v_lshlrev_b32 v80, 16, v52
    v_and_b32 v81, 0xffff0000, v52
    v_lshlrev_b32 v82, 16, v53
    v_and_b32 v83, 0xffff0000, v53
    v_lshlrev_b32 v84, 16, v54
    v_and_b32 v85, 0xffff0000, v54
    v_lshlrev_b32 v86, 16, v55
    v_and_b32 v87, 0xffff0000, v55
    v_pk_fma_f32 v[88:89], v[32:33], v[80:81], v[88:89] op_sel:[1,0,0] op_sel_hi:[1,1,1]
    v_pk_fma_f32 v[90:91], v[32:33], v[82:83], v[90:91] op_sel:[1,0,0] op_sel_hi:[1,1,1]
    v_pk_fma_f32 v[92:93], v[32:33], v[84:85], v[92:93] op_sel:[1,0,0] op_sel_hi:[1,1,1]
    v_pk_fma_f32 v[94:95], v[32:33], v[86:87], v[94:95] op_sel:[1,0,0] op_sel_hi:[1,1,1]
    s_waitcnt vmcnt(12)
    v_lshlrev_b32 v80, 16, v56
    v_and_b32 v81, 0xffff0000, v56
    v_lshlrev_b32 v82, 16, v57
    v_and_b32 v83, 0xffff0000, v57
    v_lshlrev_b32 v84, 16, v58
    v_and_b32 v85, 0xffff0000, v58
    v_lshlrev_b32 v86, 16, v59
    v_and_b32 v87, 0xffff0000, v59
    v_pk_fma_f32 v[88:89], v[34:35], v[80:81], v[88:89] op_sel:[0,0,0] op_sel_hi:[0,1,1]
    v_pk_fma_f32 v[90:91], v[34:35], v[82:83], v[90:91] op_sel:[0,0,0] op_sel_hi:[0,1,1]
    v_pk_fma_f32 v[92:93], v[34:35], v[84:85], v[92:93] op_sel:[0,0,0] op_sel_hi:[0,1,1]
    v_pk_fma_f32 v[94:95], v[34:35], v[86:87], v[94:95] op_sel:[0,0,0] op_sel_hi:[0,1,1]
    s_waitcnt vmcnt(11)
    v_lshlrev_b32 v80, 16, v60
    v_and_b32 v81, 0xffff0000, v60
    v_lshlrev_b32 v82, 16, v61
    v_and_b32 v83, 0xffff0000, v61
    v_lshlrev_b32 v84, 16, v62
    v_and_b32 v85, 0xffff0000, v62
    v_lshlrev_b32 v86, 16, v63
    v_and_b32 v87, 0xffff0000, v63
    v_pk_fma_f32 v[88:89], v[34:35], v[80:81], v[88:89] op_sel:[1,0,0] op_sel_hi:[1,1,1]
    v_pk_fma_f32 v[90:91], v[34:35], v[82:83], v[90:91] op_sel:[1,0,0] op_sel_hi:[1,1,1]
    v_pk_fma_f32 v[92:93], v[34:35], v[84:85], v[92:93] op_sel:[1,0,0] op_sel_hi:[1,1,1]
    v_pk_fma_f32 v[94:95], v[34:35], v[86:87], v[94:95] op_sel:[1,0,0] op_sel_hi:[1,1,1]
    s_waitcnt vmcnt(10)
    v_lshlrev_b32 v80, 16, v64
    v_and_b32 v81, 0xffff0000, v64
    v_lshlrev_b32 v82, 16, v65
    v_and_b32 v83, 0xffff0000, v65
    v_lshlrev_b32 v84, 16, v66
    v_and_b32 v85, 0xffff0000, v66
    v_lshlrev_b32 v86, 16, v67
    v_and_b32 v87, 0xffff0000, v67
    v_pk_fma_f32 v[88:89], v[36:37], v[80:81], v[88:89] op_sel:[0,0,0] op_sel_hi:[0,1,1]
    v_pk_fma_f32 v[90:91], v[36:37], v[82:83], v[90:91] op_sel:[0,0,0] op_sel_hi:[0,1,1]
    v_pk_fma_f32 v[92:93], v[36:37], v[84:85], v[92:93] op_sel:[0,0,0] op_sel_hi:[0,1,1]
    v_pk_fma_f32 v[94:95], v[36:37], v[86:87], v[94:95] op_sel:[0,0,0] op_sel_hi:[0,1,1]
    s_waitcnt vmcnt(9)
    v_lshlrev_b32 v80, 16, v68
    v_and_b32 v81, 0xffff0000, v68
    v_lshlrev_b32 v82, 16, v69
    v_and_b32 v83, 0xffff0000, v69
    v_lshlrev_b32 v84, 16, v70
    v_and_b32 v85, 0xffff0000, v70
    v_lshlrev_b32 v86, 16, v71
    v_and_b32 v87, 0xffff0000, v71
    v_pk_fma_f32 v[88:89], v[36:37], v[80:81], v[88:89] op_sel:[1,0,0] op_sel_hi:[1,1,1]
    v_pk_fma_f32 v[90:91], v[36:37], v[82:83], v[90:91] op_sel:[1,0,0] op_sel_hi:[1,1,1]
    v_pk_fma_f32 v[92:93], v[36:37], v[84:85], v[92:93] op_sel:[1,0,0] op_sel_hi:[1,1,1]
    v_pk_fma_f32 v[94:95], v[36:37], v[86:87], v[94:95] op_sel:[1,0,0] op_sel_hi:[1,1,1]
    s_waitcnt vmcnt(8)
    v_lshlrev_b32 v80, 16, v72
    v_and_b32 v81, 0xffff0000, v72
    v_lshlrev_b32 v82, 16, v73
    v_and_b32 v83, 0xffff0000, v73
    v_lshlrev_b32 v84, 16, v74
    v_and_b32 v85, 0xffff0000, v74
    v_lshlrev_b32 v86, 16, v75
    v_and_b32 v87, 0xffff0000, v75
    v_pk_fma_f32 v[88:89], v[38:39], v[80:81], v[88:89] op_sel:[0,0,0] op_sel_hi:[0,1,1]
    v_pk_fma_f32 v[90:91], v[38:39], v[82:83], v[90:91] op_sel:[0,0,0] op_sel_hi:[0,1,1]
    v_pk_fma_f32 v[92:93], v[38:39], v[84:85], v[92:93] op_sel:[0,0,0] op_sel_hi:[0,1,1]
    v_pk_fma_f32 v[94:95], v[38:39], v[86:87], v[94:95] op_sel:[0,0,0] op_sel_hi:[0,1,1]
    s_waitcnt vmcnt(7)
    v_lshlrev_b32 v80, 16, v76
    v_and_b32 v81, 0xffff0000, v76
    v_lshlrev_b32 v82, 16, v77
    v_and_b32 v83, 0xffff0000, v77
    v_lshlrev_b32 v84, 16, v78
    v_and_b32 v85, 0xffff0000, v78
    v_lshlrev_b32 v86, 16, v79
    v_and_b32 v87, 0xffff0000, v79
    v_pk_fma_f32 v[88:89], v[38:39], v[80:81], v[88:89] op_sel:[1,0,0] op_sel_hi:[1,1,1]
    v_pk_fma_f32 v[90:91], v[38:39], v[82:83], v[90:91] op_sel:[1,0,0] op_sel_hi:[1,1,1]
    v_pk_fma_f32 v[92:93], v[38:39], v[84:85], v[92:93] op_sel:[1,0,0] op_sel_hi:[1,1,1]
    v_pk_fma_f32 v[94:95], v[38:39], v[86:87], v[94:95] op_sel:[1,0,0] op_sel_hi:[1,1,1]
    s_nop 0
    v_permlane32_swap_b32 v88, v92
    v_permlane32_swap_b32 v89, v93
    v_permlane32_swap_b32 v90, v94
    v_permlane32_swap_b32 v91, v95
    v_add_f32 v88, v88, v92
    v_add_f32 v89, v89, v93
    v_add_f32 v90, v90, v94
    v_add_f32 v91, v91, v95
    s_nop 0
    v_permlane16_swap_b32 v88, v90
    v_permlane16_swap_b32 v89, v91
    v_add_f32 v88, v88, v90
    v_add_f32 v89, v89, v91
    v_and_b32 v81, 7, v1
    v_lshrrev_b32 v82, 3, v1
    v_add_f32_dpp v80, v88, v88 row_ror:8 row_mask:0xf bank_mask:0x3
    s_nop 1
    v_add_f32_dpp v80, v89, v89 row_ror:8 row_mask:0xf bank_mask:0xc
    v_lshl_add_u32 v81, v81, 3, v82
    s_lshl_b32 s7, s3, 8
    s_add_u32 s7, s7, 122880
    v_lshl_add_u32 v81, v81, 2, s7
    ds_write_b32 v81, v80
    s_waitcnt lgkmcnt(0)
    s_barrier
    v_lshlrev_b32 v81, 2, v1
    v_add_u32 v82, 122880, v81
    ds_read_b32 v88, v82 offset:0
    ds_read_b32 v89, v82 offset:256
    ds_read_b32 v90, v82 offset:512
    ds_read_b32 v91, v82 offset:768
    v_add_u32 v81, s44, v81
    s_waitcnt lgkmcnt(2)
    v_add_f32 v88, v88, v89
    s_waitcnt lgkmcnt(0)
    v_add_f32 v90, v90, v91
    v_add_f32 v88, v88, v90
    v_min_u32 v88, -2, v88
    s_cmp_lg_u32 s3, 0
    s_cbranch_scc1 Lmod_skip_s1
    global_store_dword v81, v88, s[38:39] offset:0 sc1
Lmod_skip_s1:
    global_load_dwordx4 v[132:135], v96, s[32:33] nt
    v_add_u32 v96, 7680, v96
    global_load_dwordx4 v[136:139], v96, s[32:33] nt
    v_add_u32 v96, 115200, v96
    global_load_dwordx4 v[140:143], v96, s[32:33] nt
    v_add_u32 v96, 7680, v96
    global_load_dwordx4 v[144:147], v96, s[32:33] nt
    s_cmp_lt_u32 s50, 100
    s_cbranch_scc1 Lsb_n3
    s_lshr_b32 s4, s50, 1
    s_and_b32 s5, s50, 1
    s_cmp_lt_u32 s4, 50
    s_cselect_b32 s6, -20, 0
    s_cmp_lt_u32 s4, 20
    s_cselect_b32 s6, 30, s6
    s_add_u32 s4, s4, s6
    s_mul_i32 s6, s5, 15360
    s_lshl_b32 s7, s4, 8
    s_add_u32 s44, s6, s7
    s_lshl_b32 s5, s5, 2
    s_add_u32 s5, s5, s3
    s_mul_i32 s5, s5, 80
    s_lshl_b32 s4, s4, 7
    s_mul_i32 s6, s5, 7680
    s_add_u32 s4, s4, s6
    v_min_u32 v28, 39, v1
    s_lshl_b32 s5, s5, 1
    v_lshl_add_u32 v28, v28, 2, s5
    global_load_dword v80, v28, s[30:31]
    v_lshrrev_b32 v29, 3, v1
    v_mul_u32_u24 v28, 15232, v29
    v_add3_u32 v28, v28, v4, s4
    global_load_dwordx4 v[40:43], v28, s[32:33] nt
    v_add_u32 v28, 7680, v28
    global_load_dwordx4 v[44:47], v28, s[32:33] nt
    v_add_u32 v28, 115200, v28
    global_load_dwordx4 v[48:51], v28, s[32:33] nt
    v_add_u32 v28, 7680, v28
    global_load_dwordx4 v[52:55], v28, s[32:33] nt
    v_add_u32 v28, 115200, v28
    global_load_dwordx4 v[56:59], v28, s[32:33] nt
    v_add_u32 v28, 7680, v28
    global_load_dwordx4 v[60:63], v28, s[32:33] nt
    v_add_u32 v28, 115200, v28
    global_load_dwordx4 v[64:67], v28, s[32:33] nt
    v_add_u32 v28, 7680, v28
    global_load_dwordx4 v[68:71], v28, s[32:33] nt
    v_add_u32 v28, 115200, v28
    global_load_dwordx4 v[72:75], v28, s[32:33] nt
    v_add_u32 v28, 7680, v28
    global_load_dwordx4 v[76:79], v28, s[32:33] nt
    s_waitcnt vmcnt(11)
    s_branch Lsb_n4
Lsb_n3:
    s_waitcnt vmcnt(0)
Lsb_n4:
    v_lshlrev_b32 v150, 16, v148
    v_and_b32 v151, 0xffff0000, v148
    v_lshlrev_b32 v97, 2, v97
    v_mul_f32 v152, 0xbfb8aa3b, v150
    v_mul_f32 v153, 0xbfb8aa3b, v151
    v_exp_f32 v152, v152
    v_exp_f32 v153, v153
    v_add_f32 v152, 1.0, v152
    v_add_f32 v153, 1.0, v153
    v_rcp_f32 v152, v152
    v_rcp_f32 v153, v153
    v_mul_f32 v150, v150, v152
    v_mul_f32 v151, v151, v153
    v_cvt_pk_bf16_f32 v148, v150, v151
    ds_bpermute_b32 v156, v97, v148 offset:0
    ds_bpermute_b32 v157, v97, v148 offset:32
    ds_bpermute_b32 v158, v97, v148 offset:64
    ds_bpermute_b32 v159, v97, v148 offset:96
    ds_bpermute_b32 v160, v97, v148 offset:128
    s_waitcnt lgkmcnt(4)
    v_lshlrev_b32 v98, 16, v156
    v_and_b32 v99, 0xffff0000, v156
    s_waitcnt lgkmcnt(3)
    v_lshlrev_b32 v100, 16, v157
    v_and_b32 v101, 0xffff0000, v157
    s_waitcnt lgkmcnt(2)
    v_lshlrev_b32 v102, 16, v158
    v_and_b32 v103, 0xffff0000, v158
    s_waitcnt lgkmcnt(1)
    v_lshlrev_b32 v104, 16, v159
    v_and_b32 v105, 0xffff0000, v159
    s_waitcnt lgkmcnt(0)
    v_lshlrev_b32 v106, 16, v160
    v_and_b32 v107, 0xffff0000, v160
    v_lshlrev_b32 v148, 16, v108
    v_and_b32 v149, 0xffff0000, v108
    v_lshlrev_b32 v150, 16, v109
    v_and_b32 v151, 0xffff0000, v109
    v_lshlrev_b32 v152, 16, v110
    v_and_b32 v153, 0xffff0000, v110
    v_lshlrev_b32 v154, 16, v111
    v_and_b32 v155, 0xffff0000, v111
    v_pk_mul_f32 v[156:157], v[98:99], v[148:149] op_sel:[0,0] op_sel_hi:[0,1]
    v_pk_mul_f32 v[158:159], v[98:99], v[150:151] op_sel:[0,0] op_sel_hi:[0,1]
    v_pk_mul_f32 v[160:161], v[98:99], v[152:153] op_sel:[0,0] op_sel_hi:[0,1]
    v_pk_mul_f32 v[162:163], v[98:99], v[154:155] op_sel:[0,0] op_sel_hi:[0,1]
    v_lshlrev_b32 v148, 16, v112
    v_and_b32 v149, 0xffff0000, v112
    v_lshlrev_b32 v150, 16, v113
    v_and_b32 v151, 0xffff0000, v113
    v_lshlrev_b32 v152, 16, v114
    v_and_b32 v153, 0xffff0000, v114
    v_lshlrev_b32 v154, 16, v115
    v_and_b32 v155, 0xffff0000, v115
    v_pk_fma_f32 v[156:157], v[98:99], v[148:149], v[156:157] op_sel:[1,0,0] op_sel_hi:[1,1,1]
    v_pk_fma_f32 v[158:159], v[98:99], v[150:151], v[158:159] op_sel:[1,0,0] op_sel_hi:[1,1,1]
    v_pk_fma_f32 v[160:161], v[98:99], v[152:153], v[160:161] op_sel:[1,0,0] op_sel_hi:[1,1,1]
    v_pk_fma_f32 v[162:163], v[98:99], v[154:155], v[162:163] op_sel:[1,0,0] op_sel_hi:[1,1,1]
    v_lshlrev_b32 v148, 16, v116
    v_and_b32 v149, 0xffff0000, v116
    v_lshlrev_b32 v150, 16, v117
    v_and_b32 v151, 0xffff0000, v117
    v_lshlrev_b32 v152, 16, v118
    v_and_b32 v153, 0xffff0000, v118
    v_lshlrev_b32 v154, 16, v119
    v_and_b32 v155, 0xffff0000, v119
    v_pk_fma_f32 v[156:157], v[100:101], v[148:149], v[156:157] op_sel:[0,0,0] op_sel_hi:[0,1,1]
    v_pk_fma_f32 v[158:159], v[100:101], v[150:151], v[158:159] op_sel:[0,0,0] op_sel_hi:[0,1,1]
    v_pk_fma_f32 v[160:161], v[100:101], v[152:153], v[160:161] op_sel:[0,0,0] op_sel_hi:[0,1,1]
    v_pk_fma_f32 v[162:163], v[100:101], v[154:155], v[162:163] op_sel:[0,0,0] op_sel_hi:[0,1,1]
    v_lshlrev_b32 v148, 16, v120
    v_and_b32 v149, 0xffff0000, v120
    v_lshlrev_b32 v150, 16, v121
    v_and_b32 v151, 0xffff0000, v121
    v_lshlrev_b32 v152, 16, v122
    v_and_b32 v153, 0xffff0000, v122
    v_lshlrev_b32 v154, 16, v123
    v_and_b32 v155, 0xffff0000, v123
    v_pk_fma_f32 v[156:157], v[100:101], v[148:149], v[156:157] op_sel:[1,0,0] op_sel_hi:[1,1,1]
    v_pk_fma_f32 v[158:159], v[100:101], v[150:151], v[158:159] op_sel:[1,0,0] op_sel_hi:[1,1,1]
    v_pk_fma_f32 v[160:161], v[100:101], v[152:153], v[160:161] op_sel:[1,0,0] op_sel_hi:[1,1,1]
    v_pk_fma_f32 v[162:163], v[100:101], v[154:155], v[162:163] op_sel:[1,0,0] op_sel_hi:[1,1,1]
    v_lshlrev_b32 v148, 16, v124
    v_and_b32 v149, 0xffff0000, v124
    v_lshlrev_b32 v150, 16, v125
    v_and_b32 v151, 0xffff0000, v125
    v_lshlrev_b32 v152, 16, v126
    v_and_b32 v153, 0xffff0000, v126
    v_lshlrev_b32 v154, 16, v127
    v_and_b32 v155, 0xffff0000, v127
    v_pk_fma_f32 v[156:157], v[102:103], v[148:149], v[156:157] op_sel:[0,0,0] op_sel_hi:[0,1,1]
    v_pk_fma_f32 v[158:159], v[102:103], v[150:151], v[158:159] op_sel:[0,0,0] op_sel_hi:[0,1,1]
    v_pk_fma_f32 v[160:161], v[102:103], v[152:153], v[160:161] op_sel:[0,0,0] op_sel_hi:[0,1,1]
    v_pk_fma_f32 v[162:163], v[102:103], v[154:155], v[162:163] op_sel:[0,0,0] op_sel_hi:[0,1,1]
    v_lshlrev_b32 v148, 16, v128
    v_and_b32 v149, 0xffff0000, v128
    v_lshlrev_b32 v150, 16, v129
    v_and_b32 v151, 0xffff0000, v129
    v_lshlrev_b32 v152, 16, v130
    v_and_b32 v153, 0xffff0000, v130
    v_lshlrev_b32 v154, 16, v131
    v_and_b32 v155, 0xffff0000, v131
    v_pk_fma_f32 v[156:157], v[102:103], v[148:149], v[156:157] op_sel:[1,0,0] op_sel_hi:[1,1,1]
    v_pk_fma_f32 v[158:159], v[102:103], v[150:151], v[158:159] op_sel:[1,0,0] op_sel_hi:[1,1,1]
    v_pk_fma_f32 v[160:161], v[102:103], v[152:153], v[160:161] op_sel:[1,0,0] op_sel_hi:[1,1,1]
    v_pk_fma_f32 v[162:163], v[102:103], v[154:155], v[162:163] op_sel:[1,0,0] op_sel_hi:[1,1,1]
    v_lshlrev_b32 v148, 16, v132
    v_and_b32 v149, 0xffff0000, v132
    v_lshlrev_b32 v150, 16, v133
    v_and_b32 v151, 0xffff0000, v133
    v_lshlrev_b32 v152, 16, v134
    v_and_b32 v153, 0xffff0000, v134
    v_lshlrev_b32 v154, 16, v135
    v_and_b32 v155, 0xffff0000, v135
    v_pk_fma_f32 v[156:157], v[104:105], v[148:149], v[156:157] op_sel:[0,0,0] op_sel_hi:[0,1,1]
    v_pk_fma_f32 v[158:159], v[104:105], v[150:151], v[158:159] op_sel:[0,0,0] op_sel_hi:[0,1,1]
    v_pk_fma_f32 v[160:161], v[104:105], v[152:153], v[160:161] op_sel:[0,0,0] op_sel_hi:[0,1,1]
    v_pk_fma_f32 v[162:163], v[104:105], v[154:155], v[162:163] op_sel:[0,0,0] op_sel_hi:[0,1,1]
    v_lshlrev_b32 v148, 16, v136
    v_and_b32 v149, 0xffff0000, v136
    v_lshlrev_b32 v150, 16, v137
    v_and_b32 v151, 0xffff0000, v137
    v_lshlrev_b32 v152, 16, v138
    v_and_b32 v153, 0xffff0000, v138
    v_lshlrev_b32 v154, 16, v139
    v_and_b32 v155, 0xffff0000, v139
    v_pk_fma_f32 v[156:157], v[104:105], v[148:149], v[156:157] op_sel:[1,0,0] op_sel_hi:[1,1,1]
    v_pk_fma_f32 v[158:159], v[104:105], v[150:151], v[158:159] op_sel:[1,0,0] op_sel_hi:[1,1,1]
    v_pk_fma_f32 v[160:161], v[104:105], v[152:153], v[160:161] op_sel:[1,0,0] op_sel_hi:[1,1,1]
    v_pk_fma_f32 v[162:163], v[104:105], v[154:155], v[162:163] op_sel:[1,0,0] op_sel_hi:[1,1,1]
    v_lshlrev_b32 v148, 16, v140
    v_and_b32 v149, 0xffff0000, v140
    v_lshlrev_b32 v150, 16, v141
    v_and_b32 v151, 0xffff0000, v141
    v_lshlrev_b32 v152, 16, v142
    v_and_b32 v153, 0xffff0000, v142
    v_lshlrev_b32 v154, 16, v143
    v_and_b32 v155, 0xffff0000, v143
    v_pk_fma_f32 v[156:157], v[106:107], v[148:149], v[156:157] op_sel:[0,0,0] op_sel_hi:[0,1,1]
    v_pk_fma_f32 v[158:159], v[106:107], v[150:151], v[158:159] op_sel:[0,0,0] op_sel_hi:[0,1,1]
    v_pk_fma_f32 v[160:161], v[106:107], v[152:153], v[160:161] op_sel:[0,0,0] op_sel_hi:[0,1,1]
    v_pk_fma_f32 v[162:163], v[106:107], v[154:155], v[162:163] op_sel:[0,0,0] op_sel_hi:[0,1,1]
    v_lshlrev_b32 v148, 16, v144
    v_and_b32 v149, 0xffff0000, v144
    v_lshlrev_b32 v150, 16, v145
    v_and_b32 v151, 0xffff0000, v145
    v_lshlrev_b32 v152, 16, v146
    v_and_b32 v153, 0xffff0000, v146
    v_lshlrev_b32 v154, 16, v147
    v_and_b32 v155, 0xffff0000, v147
    v_pk_fma_f32 v[156:157], v[106:107], v[148:149], v[156:157] op_sel:[1,0,0] op_sel_hi:[1,1,1]
    v_pk_fma_f32 v[158:159], v[106:107], v[150:151], v[158:159] op_sel:[1,0,0] op_sel_hi:[1,1,1]
    v_pk_fma_f32 v[160:161], v[106:107], v[152:153], v[160:161] op_sel:[1,0,0] op_sel_hi:[1,1,1]
    v_pk_fma_f32 v[162:163], v[106:107], v[154:155], v[162:163] op_sel:[1,0,0] op_sel_hi:[1,1,1]
    s_nop 0
    v_permlane32_swap_b32 v156, v160
    v_permlane32_swap_b32 v157, v161
    v_permlane32_swap_b32 v158, v162
    v_permlane32_swap_b32 v159, v163
    v_add_f32 v156, v156, v160
    v_add_f32 v157, v157, v161
    v_add_f32 v158, v158, v162
    v_add_f32 v159, v159, v163
    s_nop 0
    v_permlane16_swap_b32 v156, v158
    v_permlane16_swap_b32 v157, v159
    v_add_f32 v156, v156, v158
    v_add_f32 v157, v157, v159
    v_and_b32 v149, 7, v1
    v_lshrrev_b32 v150, 3, v1
    v_add_f32_dpp v148, v156, v156 row_ror:8 row_mask:0xf bank_mask:0x3
    s_nop 1
    v_add_f32_dpp v148, v157, v157 row_ror:8 row_mask:0xf bank_mask:0xc
    v_lshl_add_u32 v149, v149, 3, v150
    s_lshl_b32 s7, s3, 8
    s_add_u32 s7, s7, 123904
    v_lshl_add_u32 v149, v149, 2, s7
    ds_write_b32 v149, v148
    s_waitcnt lgkmcnt(0)
    s_barrier
    v_lshlrev_b32 v149, 2, v1
    v_add_u32 v150, 123904, v149
    ds_read_b32 v156, v150 offset:0
    ds_read_b32 v157, v150 offset:256
    ds_read_b32 v158, v150 offset:512
    ds_read_b32 v159, v150 offset:768
    v_add_u32 v149, s45, v149
    s_waitcnt lgkmcnt(2)
    v_add_f32 v156, v156, v157
    s_waitcnt lgkmcnt(0)
    v_add_f32 v158, v158, v159
    v_add_f32 v156, v156, v158
    v_min_u32 v156, -2, v156
    s_cmp_lg_u32 s3, 0
    s_cbranch_scc1 Lmod_skip_s2
    global_store_dword v149, v156, s[38:39] offset:0 sc1
Lmod_skip_s2:
    v_min_u32 v164, 49, v1
    v_lshlrev_b32 v164, 2, v164
Lbic:
    global_load_dword v165, v164, s[36:37] sc1
    s_waitcnt vmcnt(0)
    v_cmp_eq_u32 vcc, 0, v165
    s_add_u32 s100, s100, 1
    s_cmp_ge_u32 s100, 262144
    s_cbranch_scc1 Lbic_x
    s_cbranch_vccnz Lbic
Lbic_x:
    s_cmp_lt_u32 s50, 100
    s_cbranch_scc1 Lsp_c
    v_lshlrev_b32 v82, 16, v80
    v_and_b32 v83, 0xffff0000, v80
    v_lshlrev_b32 v29, 2, v29
    v_mul_f32 v84, 0xbfb8aa3b, v82
    v_mul_f32 v85, 0xbfb8aa3b, v83
    v_exp_f32 v84, v84
    v_exp_f32 v85, v85
    v_add_f32 v84, 1.0, v84
    v_add_f32 v85, 1.0, v85
    v_rcp_f32 v84, v84
    v_rcp_f32 v85, v85
    v_mul_f32 v82, v82, v84
    v_mul_f32 v83, v83, v85
    v_cvt_pk_bf16_f32 v80, v82, v83
    ds_bpermute_b32 v88, v29, v80 offset:0
    ds_bpermute_b32 v89, v29, v80 offset:32
    ds_bpermute_b32 v90, v29, v80 offset:64
    ds_bpermute_b32 v91, v29, v80 offset:96
    ds_bpermute_b32 v92, v29, v80 offset:128
    s_waitcnt lgkmcnt(4)
    v_lshlrev_b32 v30, 16, v88
    v_and_b32 v31, 0xffff0000, v88
    s_waitcnt lgkmcnt(3)
    v_lshlrev_b32 v32, 16, v89
    v_and_b32 v33, 0xffff0000, v89
    s_waitcnt lgkmcnt(2)
    v_lshlrev_b32 v34, 16, v90
    v_and_b32 v35, 0xffff0000, v90
    s_waitcnt lgkmcnt(1)
    v_lshlrev_b32 v36, 16, v91
    v_and_b32 v37, 0xffff0000, v91
    s_waitcnt lgkmcnt(0)
    v_lshlrev_b32 v38, 16, v92
    v_and_b32 v39, 0xffff0000, v92
    v_lshlrev_b32 v80, 16, v40
    v_and_b32 v81, 0xffff0000, v40
    v_lshlrev_b32 v82, 16, v41
    v_and_b32 v83, 0xffff0000, v41
    v_lshlrev_b32 v84, 16, v42
    v_and_b32 v85, 0xffff0000, v42
    v_lshlrev_b32 v86, 16, v43
    v_and_b32 v87, 0xffff0000, v43
    v_pk_mul_f32 v[88:89], v[30:31], v[80:81] op_sel:[0,0] op_sel_hi:[0,1]
    v_pk_mul_f32 v[90:91], v[30:31], v[82:83] op_sel:[0,0] op_sel_hi:[0,1]
    v_pk_mul_f32 v[92:93], v[30:31], v[84:85] op_sel:[0,0] op_sel_hi:[0,1]
    v_pk_mul_f32 v[94:95], v[30:31], v[86:87] op_sel:[0,0] op_sel_hi:[0,1]
    v_lshlrev_b32 v80, 16, v44
    v_and_b32 v81, 0xffff0000, v44
    v_lshlrev_b32 v82, 16, v45
    v_and_b32 v83, 0xffff0000, v45
    v_lshlrev_b32 v84, 16, v46
    v_and_b32 v85, 0xffff0000, v46
    v_lshlrev_b32 v86, 16, v47
    v_and_b32 v87, 0xffff0000, v47
    v_pk_fma_f32 v[88:89], v[30:31], v[80:81], v[88:89] op_sel:[1,0,0] op_sel_hi:[1,1,1]
    v_pk_fma_f32 v[90:91], v[30:31], v[82:83], v[90:91] op_sel:[1,0,0] op_sel_hi:[1,1,1]
    v_pk_fma_f32 v[92:93], v[30:31], v[84:85], v[92:93] op_sel:[1,0,0] op_sel_hi:[1,1,1]
    v_pk_fma_f32 v[94:95], v[30:31], v[86:87], v[94:95] op_sel:[1,0,0] op_sel_hi:[1,1,1]
    v_lshlrev_b32 v80, 16, v48
    v_and_b32 v81, 0xffff0000, v48
    v_lshlrev_b32 v82, 16, v49
    v_and_b32 v83, 0xffff0000, v49
    v_lshlrev_b32 v84, 16, v50
    v_and_b32 v85, 0xffff0000, v50
    v_lshlrev_b32 v86, 16, v51
    v_and_b32 v87, 0xffff0000, v51
    v_pk_fma_f32 v[88:89], v[32:33], v[80:81], v[88:89] op_sel:[0,0,0] op_sel_hi:[0,1,1]
    v_pk_fma_f32 v[90:91], v[32:33], v[82:83], v[90:91] op_sel:[0,0,0] op_sel_hi:[0,1,1]
    v_pk_fma_f32 v[92:93], v[32:33], v[84:85], v[92:93] op_sel:[0,0,0] op_sel_hi:[0,1,1]
    v_pk_fma_f32 v[94:95], v[32:33], v[86:87], v[94:95] op_sel:[0,0,0] op_sel_hi:[0,1,1]
    v_lshlrev_b32 v80, 16, v52
    v_and_b32 v81, 0xffff0000, v52
    v_lshlrev_b32 v82, 16, v53
    v_and_b32 v83, 0xffff0000, v53
    v_lshlrev_b32 v84, 16, v54
    v_and_b32 v85, 0xffff0000, v54
    v_lshlrev_b32 v86, 16, v55
    v_and_b32 v87, 0xffff0000, v55
    v_pk_fma_f32 v[88:89], v[32:33], v[80:81], v[88:89] op_sel:[1,0,0] op_sel_hi:[1,1,1]
    v_pk_fma_f32 v[90:91], v[32:33], v[82:83], v[90:91] op_sel:[1,0,0] op_sel_hi:[1,1,1]
    v_pk_fma_f32 v[92:93], v[32:33], v[84:85], v[92:93] op_sel:[1,0,0] op_sel_hi:[1,1,1]
    v_pk_fma_f32 v[94:95], v[32:33], v[86:87], v[94:95] op_sel:[1,0,0] op_sel_hi:[1,1,1]
    v_lshlrev_b32 v80, 16, v56
    v_and_b32 v81, 0xffff0000, v56
    v_lshlrev_b32 v82, 16, v57
    v_and_b32 v83, 0xffff0000, v57
    v_lshlrev_b32 v84, 16, v58
    v_and_b32 v85, 0xffff0000, v58
    v_lshlrev_b32 v86, 16, v59
    v_and_b32 v87, 0xffff0000, v59
    v_pk_fma_f32 v[88:89], v[34:35], v[80:81], v[88:89] op_sel:[0,0,0] op_sel_hi:[0,1,1]
    v_pk_fma_f32 v[90:91], v[34:35], v[82:83], v[90:91] op_sel:[0,0,0] op_sel_hi:[0,1,1]
    v_pk_fma_f32 v[92:93], v[34:35], v[84:85], v[92:93] op_sel:[0,0,0] op_sel_hi:[0,1,1]
    v_pk_fma_f32 v[94:95], v[34:35], v[86:87], v[94:95] op_sel:[0,0,0] op_sel_hi:[0,1,1]
    v_lshlrev_b32 v80, 16, v60
    v_and_b32 v81, 0xffff0000, v60
    v_lshlrev_b32 v82, 16, v61
    v_and_b32 v83, 0xffff0000, v61
    v_lshlrev_b32 v84, 16, v62
    v_and_b32 v85, 0xffff0000, v62
    v_lshlrev_b32 v86, 16, v63
    v_and_b32 v87, 0xffff0000, v63
    v_pk_fma_f32 v[88:89], v[34:35], v[80:81], v[88:89] op_sel:[1,0,0] op_sel_hi:[1,1,1]
    v_pk_fma_f32 v[90:91], v[34:35], v[82:83], v[90:91] op_sel:[1,0,0] op_sel_hi:[1,1,1]
    v_pk_fma_f32 v[92:93], v[34:35], v[84:85], v[92:93] op_sel:[1,0,0] op_sel_hi:[1,1,1]
    v_pk_fma_f32 v[94:95], v[34:35], v[86:87], v[94:95] op_sel:[1,0,0] op_sel_hi:[1,1,1]
    v_lshlrev_b32 v80, 16, v64
    v_and_b32 v81, 0xffff0000, v64
    v_lshlrev_b32 v82, 16, v65
    v_and_b32 v83, 0xffff0000, v65
    v_lshlrev_b32 v84, 16, v66
    v_and_b32 v85, 0xffff0000, v66
    v_lshlrev_b32 v86, 16, v67
    v_and_b32 v87, 0xffff0000, v67
    v_pk_fma_f32 v[88:89], v[36:37], v[80:81], v[88:89] op_sel:[0,0,0] op_sel_hi:[0,1,1]
    v_pk_fma_f32 v[90:91], v[36:37], v[82:83], v[90:91] op_sel:[0,0,0] op_sel_hi:[0,1,1]
    v_pk_fma_f32 v[92:93], v[36:37], v[84:85], v[92:93] op_sel:[0,0,0] op_sel_hi:[0,1,1]
    v_pk_fma_f32 v[94:95], v[36:37], v[86:87], v[94:95] op_sel:[0,0,0] op_sel_hi:[0,1,1]
    v_lshlrev_b32 v80, 16, v68
    v_and_b32 v81, 0xffff0000, v68
    v_lshlrev_b32 v82, 16, v69
    v_and_b32 v83, 0xffff0000, v69
    v_lshlrev_b32 v84, 16, v70
    v_and_b32 v85, 0xffff0000, v70
    v_lshlrev_b32 v86, 16, v71
    v_and_b32 v87, 0xffff0000, v71
    v_pk_fma_f32 v[88:89], v[36:37], v[80:81], v[88:89] op_sel:[1,0,0] op_sel_hi:[1,1,1]
    v_pk_fma_f32 v[90:91], v[36:37], v[82:83], v[90:91] op_sel:[1,0,0] op_sel_hi:[1,1,1]
    v_pk_fma_f32 v[92:93], v[36:37], v[84:85], v[92:93] op_sel:[1,0,0] op_sel_hi:[1,1,1]
    v_pk_fma_f32 v[94:95], v[36:37], v[86:87], v[94:95] op_sel:[1,0,0] op_sel_hi:[1,1,1]
    v_lshlrev_b32 v80, 16, v72
    v_and_b32 v81, 0xffff0000, v72
    v_lshlrev_b32 v82, 16, v73
    v_and_b32 v83, 0xffff0000, v73
    v_lshlrev_b32 v84, 16, v74
    v_and_b32 v85, 0xffff0000, v74
    v_lshlrev_b32 v86, 16, v75
    v_and_b32 v87, 0xffff0000, v75
    v_pk_fma_f32 v[88:89], v[38:39], v[80:81], v[88:89] op_sel:[0,0,0] op_sel_hi:[0,1,1]
    v_pk_fma_f32 v[90:91], v[38:39], v[82:83], v[90:91] op_sel:[0,0,0] op_sel_hi:[0,1,1]
    v_pk_fma_f32 v[92:93], v[38:39], v[84:85], v[92:93] op_sel:[0,0,0] op_sel_hi:[0,1,1]
    v_pk_fma_f32 v[94:95], v[38:39], v[86:87], v[94:95] op_sel:[0,0,0] op_sel_hi:[0,1,1]
    v_lshlrev_b32 v80, 16, v76
    v_and_b32 v81, 0xffff0000, v76
    v_lshlrev_b32 v82, 16, v77
    v_and_b32 v83, 0xffff0000, v77
    v_lshlrev_b32 v84, 16, v78
    v_and_b32 v85, 0xffff0000, v78
    v_lshlrev_b32 v86, 16, v79
    v_and_b32 v87, 0xffff0000, v79
    v_pk_fma_f32 v[88:89], v[38:39], v[80:81], v[88:89] op_sel:[1,0,0] op_sel_hi:[1,1,1]
    v_pk_fma_f32 v[90:91], v[38:39], v[82:83], v[90:91] op_sel:[1,0,0] op_sel_hi:[1,1,1]
    v_pk_fma_f32 v[92:93], v[38:39], v[84:85], v[92:93] op_sel:[1,0,0] op_sel_hi:[1,1,1]
    v_pk_fma_f32 v[94:95], v[38:39], v[86:87], v[94:95] op_sel:[1,0,0] op_sel_hi:[1,1,1]
    s_nop 0
    v_permlane32_swap_b32 v88, v92
    v_permlane32_swap_b32 v89, v93
    v_permlane32_swap_b32 v90, v94
    v_permlane32_swap_b32 v91, v95
    v_add_f32 v88, v88, v92
    v_add_f32 v89, v89, v93
    v_add_f32 v90, v90, v94
    v_add_f32 v91, v91, v95
    s_nop 0
    v_permlane16_swap_b32 v88, v90
    v_permlane16_swap_b32 v89, v91
    v_add_f32 v88, v88, v90
    v_add_f32 v89, v89, v91
    v_and_b32 v81, 7, v1
    v_lshrrev_b32 v82, 3, v1
    v_add_f32_dpp v80, v88, v88 row_ror:8 row_mask:0xf bank_mask:0x3
    s_nop 1
    v_add_f32_dpp v80, v89, v89 row_ror:8 row_mask:0xf bank_mask:0xc
    v_lshl_add_u32 v81, v81, 3, v82
    s_lshl_b32 s7, s3, 8
    s_add_u32 s7, s7, 124928
    v_lshl_add_u32 v81, v81, 2, s7
    ds_write_b32 v81, v80
    s_waitcnt lgkmcnt(0)
    s_barrier
    v_lshlrev_b32 v81, 2, v1
    v_add_u32 v82, 124928, v81
    ds_read_b32 v88, v82 offset:0
    ds_read_b32 v89, v82 offset:256
    ds_read_b32 v90, v82 offset:512
    ds_read_b32 v91, v82 offset:768
    v_add_u32 v81, s44, v81
    s_waitcnt lgkmcnt(2)
    v_add_f32 v88, v88, v89
    s_waitcnt lgkmcnt(0)
    v_add_f32 v90, v90, v91
    v_add_f32 v88, v88, v90
    v_min_u32 v88, -2, v88
    s_cmp_lg_u32 s3, 0
    s_cbranch_scc1 Lmod_skip_s3
    global_store_dword v81, v88, s[38:39] offset:0 sc1
Lmod_skip_s3:
    s_branch Lsp_c
Lsp_a2:
    s_and_b32 s4, s42, 1
    s_lshl_b32 s4, s4, 1
    s_and_b32 s5, s3, 1
    s_add_u32 s44, s4, s5
    s_and_b32 s4, s42, -2
    s_lshr_b32 s5, s3, 1
    s_add_u32 s45, s4, s5
    s_and_b32 s4, s42, 1
    s_lshl_b32 s4, s4, 2
    s_add_u32 s4, s4, s3
    s_mul_i32 s4, s4, 276480
    s_lshr_b32 s5, s42, 1
    s_lshl_b32 s5, s5, 7
    s_add_u32 s4, s4, s5
    v_lshrrev_b32 v28, 3, v1
    v_mul_u32_u24 v28, 3328, v28
    v_add3_u32 v28, v28, v4, s4
    s_mul_i32 s5, s3, 10240
    s_add_u32 m0, s5, 0
    s_nop 0
    global_load_lds_dwordx4 v28, s[22:23] nt
    v_add_u32 v28, 27648, v28
    s_add_u32 m0, s5, 1024
    s_nop 0
    global_load_lds_dwordx4 v28, s[22:23] nt
    v_add_u32 v28, 27648, v28
    s_add_u32 m0, s5, 2048
    s_nop 0
    global_load_lds_dwordx4 v28, s[22:23] nt
    v_add_u32 v28, 27648, v28
    s_add_u32 m0, s5, 3072
    s_nop 0
    global_load_lds_dwordx4 v28, s[22:23] nt
    v_add_u32 v28, 27648, v28
    s_add_u32 m0, s5, 4096
    s_nop 0
    global_load_lds_dwordx4 v28, s[22:23] nt
    v_add_u32 v28, 27648, v28
    s_add_u32 m0, s5, 5120
    s_nop 0
    global_load_lds_dwordx4 v28, s[22:23] nt
    v_add_u32 v28, 27648, v28
    s_add_u32 m0, s5, 6144
    s_nop 0
    global_load_lds_dwordx4 v28, s[22:23] nt
    v_add_u32 v28, 27648, v28
    s_add_u32 m0, s5, 7168
    s_nop 0
    global_load_lds_dwordx4 v28, s[22:23] nt
    v_add_u32 v28, 27648, v28
    s_add_u32 m0, s5, 8192
    s_nop 0
    global_load_lds_dwordx4 v28, s[22:23] nt
    v_add_u32 v28, 27648, v28
    s_add_u32 m0, s5, 9216
    s_nop 0
    global_load_lds_dwordx4 v28, s[22:23] nt
    v_add_u32 v28, 27648, v28
    v_min_u32 v72, 624, v4
    s_mul_i32 s5, s44, 640
    s_add_u32 s5, s5, 7680
    v_add_u32 v73, s5, v72
    s_mul_i32 s5, s3, 1280
    s_add_u32 s5, s5, 124928
    v_add_u32 v72, s5, v72
    v_lshl_add_u32 v74, v3, 5, s5
    s_cmp_ge_u32 s45, 27
    s_cselect_b32 s6, -54, 56
    s_lshl_b32 s7, s45, 1
    s_add_u32 s46, s6, s7
    s_mul_i32 s4, s46, 20480
    s_mul_i32 s5, s44, 5120
    s_add_u32 s4, s4, s5
    s_add_u32 s4, s4, 7342080
    v_add_u32 v75, s4, v4
    v_add_u32 v76, 20480, v75
    s_and_b32 s4, s3, 1
    s_mul_i32 s4, s4, 20480
    s_lshr_b32 s5, s3, 1
    s_lshl_b32 s5, s5, 6
    s_add_u32 s4, s4, s5
    v_lshl_add_u32 v28, v3, 10, s4
    v_lshl_add_u32 v28, v2, 2, v28
    s_cmp_lt_u32 s42, 38
    s_cbranch_scc1 Lwp_n0
    s_add_u32 s48, s42, 46
    s_lshr_b32 s4, s48, 1
    s_and_b32 s5, s48, 1
    s_cmp_lt_u32 s4, 50
    s_cselect_b32 s6, -20, 0
    s_cmp_lt_u32 s4, 20
    s_cselect_b32 s6, 30, s6
    s_add_u32 s4, s4, s6
    s_mul_i32 s6, s5, 15360
    s_lshl_b32 s7, s4, 8
    s_add_u32 s47, s6, s7
    s_lshl_b32 s5, s5, 2
    s_add_u32 s5, s5, s3
    s_mul_i32 s5, s5, 80
    s_lshl_b32 s4, s4, 7
    s_mul_i32 s6, s5, 7680
    s_add_u32 s4, s4, s6
    v_min_u32 v78, 39, v1
    s_lshl_b32 s5, s5, 1
    v_lshl_add_u32 v78, v78, 2, s5
    global_load_dword v132, v78, s[30:31]
    v_lshrrev_b32 v79, 3, v1
    v_mul_u32_u24 v78, 15232, v79
    v_add3_u32 v78, v78, v4, s4
    global_load_dwordx4 v[92:95], v78, s[32:33] nt
    v_add_u32 v78, 7680, v78
    global_load_dwordx4 v[96:99], v78, s[32:33] nt
    v_add_u32 v78, 115200, v78
    global_load_dwordx4 v[100:103], v78, s[32:33] nt
    v_add_u32 v78, 7680, v78
    global_load_dwordx4 v[104:107], v78, s[32:33] nt
    v_add_u32 v78, 115200, v78
    global_load_dwordx4 v[108:111], v78, s[32:33] nt
    v_add_u32 v78, 7680, v78
    global_load_dwordx4 v[112:115], v78, s[32:33] nt
    v_add_u32 v78, 115200, v78
    global_load_dwordx4 v[116:119], v78, s[32:33] nt
    v_add_u32 v78, 7680, v78
    global_load_dwordx4 v[120:123], v78, s[32:33] nt
    v_add_u32 v78, 115200, v78
    global_load_dwordx4 v[124:127], v78, s[32:33] nt
    v_add_u32 v78, 7680, v78
    global_load_dwordx4 v[128:131], v78, s[32:33] nt
    s_waitcnt vmcnt(11)
    s_branch Lwp_n2
Lwp_n0:
    s_cmp_lt_u32 s42, 11
    s_cbranch_scc1 Lwp_n1
    s_sub_u32 s48, s42, 11
    s_mul_i32 s4, s48, 40960
    s_mul_i32 s5, s3, 10240
    s_add_u32 s4, s4, s5
    v_lshl_add_u32 v80, v1, 4, s4
    s_add_u32 m0, s5, 40960
    s_nop 0
    global_load_lds_dwordx4 v80, s[28:29] offset:0 nt
    global_load_lds_dwordx4 v80, s[28:29] offset:1024 nt
    global_load_lds_dwordx4 v80, s[28:29] offset:2048 nt
    global_load_lds_dwordx4 v80, s[28:29] offset:3072 nt
    s_add_u32 m0, s5, 45056
    v_add_u32 v80, 4096, v80
    global_load_lds_dwordx4 v80, s[28:29] offset:0 nt
    global_load_lds_dwordx4 v80, s[28:29] offset:1024 nt
    global_load_lds_dwordx4 v80, s[28:29] offset:2048 nt
    global_load_lds_dwordx4 v80, s[28:29] offset:3072 nt
    s_add_u32 m0, s5, 49152
    v_add_u32 v80, 4096, v80
    global_load_lds_dwordx4 v80, s[28:29] offset:0 nt
    global_load_lds_dwordx4 v80, s[28:29] offset:1024 nt
    s_waitcnt vmcnt(10)
    s_branch Lwp_n2
Lwp_n1:
    s_waitcnt vmcnt(0)
Lwp_n2:
    s_barrier
    ds_read_b32 v32, v28 offset:0
    ds_read_b32 v33, v28 offset:128
    ds_read_b32 v34, v28 offset:256
    ds_read_b32 v35, v28 offset:384
    ds_read_b32 v36, v28 offset:512
    ds_read_b32 v37, v28 offset:640
    ds_read_b32 v38, v28 offset:768
    ds_read_b32 v39, v28 offset:896
    ds_read_b32 v40, v28 offset:4096
    ds_read_b32 v41, v28 offset:4224
    ds_read_b32 v42, v28 offset:4352
    ds_read_b32 v43, v28 offset:4480
    ds_read_b32 v44, v28 offset:4608
    ds_read_b32 v45, v28 offset:4736
    ds_read_b32 v46, v28 offset:4864
    ds_read_b32 v47, v28 offset:4992
    ds_read_b32 v48, v28 offset:8192
    ds_read_b32 v49, v28 offset:8320
    ds_read_b32 v50, v28 offset:8448
    ds_read_b32 v51, v28 offset:8576
    ds_read_b32 v52, v28 offset:8704
    ds_read_b32 v53, v28 offset:8832
    ds_read_b32 v54, v28 offset:8960
    ds_read_b32 v55, v28 offset:9088
    ds_read_b32 v56, v28 offset:12288
    ds_read_b32 v57, v28 offset:12416
    ds_read_b32 v58, v28 offset:12544
    ds_read_b32 v59, v28 offset:12672
    ds_read_b32 v60, v28 offset:12800
    ds_read_b32 v61, v28 offset:12928
    ds_read_b32 v62, v28 offset:13056
    ds_read_b32 v63, v28 offset:13184
    ds_read_b32 v64, v28 offset:16384
    ds_read_b32 v65, v28 offset:16512
    ds_read_b32 v66, v28 offset:16640
    ds_read_b32 v67, v28 offset:16768
    ds_read_b32 v68, v28 offset:16896
    ds_read_b32 v69, v28 offset:17024
    ds_read_b32 v70, v28 offset:17152
    ds_read_b32 v71, v28 offset:17280
    s_waitcnt lgkmcnt(15)
    v_lshlrev_b32 v152, 16, v32
    v_and_b32 v153, 0xffff0000, v32
    v_lshlrev_b32 v154, 16, v33
    v_and_b32 v155, 0xffff0000, v33
    v_lshlrev_b32 v156, 16, v34
    v_and_b32 v157, 0xffff0000, v34
    v_lshlrev_b32 v158, 16, v35
    v_and_b32 v159, 0xffff0000, v35
    v_lshlrev_b32 v160, 16, v36
    v_and_b32 v161, 0xffff0000, v36
    v_lshlrev_b32 v162, 16, v37
    v_and_b32 v163, 0xffff0000, v37
    v_lshlrev_b32 v164, 16, v38
    v_and_b32 v165, 0xffff0000, v38
    v_lshlrev_b32 v166, 16, v39
    v_and_b32 v167, 0xffff0000, v39
    v_lshlrev_b32 v168, 16, v40
    v_and_b32 v169, 0xffff0000, v40
    v_lshlrev_b32 v170, 16, v41
    v_and_b32 v171, 0xffff0000, v41
    v_lshlrev_b32 v172, 16, v42
    v_and_b32 v173, 0xffff0000, v42
    v_lshlrev_b32 v174, 16, v43
    v_and_b32 v175, 0xffff0000, v43
    v_lshlrev_b32 v176, 16, v44
    v_and_b32 v177, 0xffff0000, v44
    v_lshlrev_b32 v178, 16, v45
    v_and_b32 v179, 0xffff0000, v45
    v_lshlrev_b32 v180, 16, v46
    v_and_b32 v181, 0xffff0000, v46
    v_lshlrev_b32 v182, 16, v47
    v_and_b32 v183, 0xffff0000, v47
    v_lshlrev_b32 v184, 16, v48
    v_and_b32 v185, 0xffff0000, v48
    v_lshlrev_b32 v186, 16, v49
    v_and_b32 v187, 0xffff0000, v49
    v_lshlrev_b32 v188, 16, v50
    v_and_b32 v189, 0xffff0000, v50
    v_lshlrev_b32 v190, 16, v51
    v_and_b32 v191, 0xffff0000, v51
    v_lshlrev_b32 v192, 16, v52
    v_and_b32 v193, 0xffff0000, v52
    v_lshlrev_b32 v194, 16, v53
    v_and_b32 v195, 0xffff0000, v53
    v_lshlrev_b32 v196, 16, v54
    v_and_b32 v197, 0xffff0000, v54
    v_lshlrev_b32 v198, 16, v55
    v_and_b32 v199, 0xffff0000, v55
    v_lshlrev_b32 v200, 16, v56
    v_and_b32 v201, 0xffff0000, v56
    s_waitcnt lgkmcnt(14)
    v_lshlrev_b32 v202, 16, v57
    v_and_b32 v203, 0xffff0000, v57
    s_waitcnt lgkmcnt(13)
    v_lshlrev_b32 v204, 16, v58
    v_and_b32 v205, 0xffff0000, v58
    s_waitcnt lgkmcnt(12)
    v_lshlrev_b32 v206, 16, v59
    v_and_b32 v207, 0xffff0000, v59
    s_waitcnt lgkmcnt(11)
    v_lshlrev_b32 v208, 16, v60
    v_and_b32 v209, 0xffff0000, v60
    s_waitcnt lgkmcnt(10)
    v_lshlrev_b32 v210, 16, v61
    v_and_b32 v211, 0xffff0000, v61
    s_waitcnt lgkmcnt(9)
    v_lshlrev_b32 v212, 16, v62
    v_and_b32 v213, 0xffff0000, v62
    s_waitcnt lgkmcnt(8)
    v_lshlrev_b32 v214, 16, v63
    v_and_b32 v215, 0xffff0000, v63
    s_waitcnt lgkmcnt(7)
    v_lshlrev_b32 v216, 16, v64
    v_and_b32 v217, 0xffff0000, v64
    s_waitcnt lgkmcnt(6)
    v_lshlrev_b32 v218, 16, v65
    v_and_b32 v219, 0xffff0000, v65
    s_waitcnt lgkmcnt(5)
    v_lshlrev_b32 v220, 16, v66
    v_and_b32 v221, 0xffff0000, v66
    s_waitcnt lgkmcnt(4)
    v_lshlrev_b32 v222, 16, v67
    v_and_b32 v223, 0xffff0000, v67
    s_waitcnt lgkmcnt(3)
    v_lshlrev_b32 v224, 16, v68
    v_and_b32 v225, 0xffff0000, v68
    s_waitcnt lgkmcnt(2)
    v_lshlrev_b32 v226, 16, v69
    v_and_b32 v227, 0xffff0000, v69
    s_waitcnt lgkmcnt(1)
    v_lshlrev_b32 v228, 16, v70
    v_and_b32 v229, 0xffff0000, v70
    s_waitcnt lgkmcnt(0)
    v_lshlrev_b32 v230, 16, v71
    v_and_b32 v231, 0xffff0000, v71
    v_min_u32 v32, 49, v1
    v_lshlrev_b32 v32, 2, v32
Lwic:
    global_load_dword v33, v32, s[36:37] sc1
    s_waitcnt vmcnt(0)
    v_cmp_eq_u32 vcc, 0, v33
    s_add_u32 s100, s100, 1
    s_cmp_ge_u32 s100, 262144
    s_cbranch_scc1 Lwic_x
    s_cbranch_vccnz Lwic
Lwic_x:
    s_cmp_lt_u32 s42, 38
    s_cbranch_scc1 Lwp_n3
    v_lshlrev_b32 v134, 16, v132
    v_and_b32 v135, 0xffff0000, v132
    v_lshlrev_b32 v79, 2, v79
    v_mul_f32 v136, 0xbfb8aa3b, v134
    v_mul_f32 v137, 0xbfb8aa3b, v135
    v_exp_f32 v136, v136
    v_exp_f32 v137, v137
    v_add_f32 v136, 1.0, v136
    v_add_f32 v137, 1.0, v137
    v_rcp_f32 v136, v136
    v_rcp_f32 v137, v137
    v_mul_f32 v134, v134, v136
    v_mul_f32 v135, v135, v137
    v_cvt_pk_bf16_f32 v132, v134, v135
    ds_bpermute_b32 v140, v79, v132 offset:0
    ds_bpermute_b32 v141, v79, v132 offset:32
    ds_bpermute_b32 v142, v79, v132 offset:64
    ds_bpermute_b32 v143, v79, v132 offset:96
    ds_bpermute_b32 v144, v79, v132 offset:128
    s_waitcnt lgkmcnt(4)
    v_lshlrev_b32 v80, 16, v140
    v_and_b32 v81, 0xffff0000, v140
    s_waitcnt lgkmcnt(3)
    v_lshlrev_b32 v82, 16, v141
    v_and_b32 v83, 0xffff0000, v141
    s_waitcnt lgkmcnt(2)
    v_lshlrev_b32 v84, 16, v142
    v_and_b32 v85, 0xffff0000, v142
    s_waitcnt lgkmcnt(1)
    v_lshlrev_b32 v86, 16, v143
    v_and_b32 v87, 0xffff0000, v143
    s_waitcnt lgkmcnt(0)
    v_lshlrev_b32 v88, 16, v144
    v_and_b32 v89, 0xffff0000, v144
    v_lshlrev_b32 v132, 16, v92
    v_and_b32 v133, 0xffff0000, v92
    v_lshlrev_b32 v134, 16, v93
    v_and_b32 v135, 0xffff0000, v93
    v_lshlrev_b32 v136, 16, v94
    v_and_b32 v137, 0xffff0000, v94
    v_lshlrev_b32 v138, 16, v95
    v_and_b32 v139, 0xffff0000, v95
    v_pk_mul_f32 v[140:141], v[80:81], v[132:133] op_sel:[0,0] op_sel_hi:[0,1]
    v_pk_mul_f32 v[142:143], v[80:81], v[134:135] op_sel:[0,0] op_sel_hi:[0,1]
    v_pk_mul_f32 v[144:145], v[80:81], v[136:137] op_sel:[0,0] op_sel_hi:[0,1]
    v_pk_mul_f32 v[146:147], v[80:81], v[138:139] op_sel:[0,0] op_sel_hi:[0,1]
    v_lshlrev_b32 v132, 16, v96
    v_and_b32 v133, 0xffff0000, v96
    v_lshlrev_b32 v134, 16, v97
    v_and_b32 v135, 0xffff0000, v97
    v_lshlrev_b32 v136, 16, v98
    v_and_b32 v137, 0xffff0000, v98
    v_lshlrev_b32 v138, 16, v99
    v_and_b32 v139, 0xffff0000, v99
    v_pk_fma_f32 v[140:141], v[80:81], v[132:133], v[140:141] op_sel:[1,0,0] op_sel_hi:[1,1,1]
    v_pk_fma_f32 v[142:143], v[80:81], v[134:135], v[142:143] op_sel:[1,0,0] op_sel_hi:[1,1,1]
    v_pk_fma_f32 v[144:145], v[80:81], v[136:137], v[144:145] op_sel:[1,0,0] op_sel_hi:[1,1,1]
    v_pk_fma_f32 v[146:147], v[80:81], v[138:139], v[146:147] op_sel:[1,0,0] op_sel_hi:[1,1,1]
    v_lshlrev_b32 v132, 16, v100
    v_and_b32 v133, 0xffff0000, v100
    v_lshlrev_b32 v134, 16, v101
    v_and_b32 v135, 0xffff0000, v101
    v_lshlrev_b32 v136, 16, v102
    v_and_b32 v137, 0xffff0000, v102
    v_lshlrev_b32 v138, 16, v103
    v_and_b32 v139, 0xffff0000, v103
    v_pk_fma_f32 v[140:141], v[82:83], v[132:133], v[140:141] op_sel:[0,0,0] op_sel_hi:[0,1,1]
    v_pk_fma_f32 v[142:143], v[82:83], v[134:135], v[142:143] op_sel:[0,0,0] op_sel_hi:[0,1,1]
    v_pk_fma_f32 v[144:145], v[82:83], v[136:137], v[144:145] op_sel:[0,0,0] op_sel_hi:[0,1,1]
    v_pk_fma_f32 v[146:147], v[82:83], v[138:139], v[146:147] op_sel:[0,0,0] op_sel_hi:[0,1,1]
    v_lshlrev_b32 v132, 16, v104
    v_and_b32 v133, 0xffff0000, v104
    v_lshlrev_b32 v134, 16, v105
    v_and_b32 v135, 0xffff0000, v105
    v_lshlrev_b32 v136, 16, v106
    v_and_b32 v137, 0xffff0000, v106
    v_lshlrev_b32 v138, 16, v107
    v_and_b32 v139, 0xffff0000, v107
    v_pk_fma_f32 v[140:141], v[82:83], v[132:133], v[140:141] op_sel:[1,0,0] op_sel_hi:[1,1,1]
    v_pk_fma_f32 v[142:143], v[82:83], v[134:135], v[142:143] op_sel:[1,0,0] op_sel_hi:[1,1,1]
    v_pk_fma_f32 v[144:145], v[82:83], v[136:137], v[144:145] op_sel:[1,0,0] op_sel_hi:[1,1,1]
    v_pk_fma_f32 v[146:147], v[82:83], v[138:139], v[146:147] op_sel:[1,0,0] op_sel_hi:[1,1,1]
    v_lshlrev_b32 v132, 16, v108
    v_and_b32 v133, 0xffff0000, v108
    v_lshlrev_b32 v134, 16, v109
    v_and_b32 v135, 0xffff0000, v109
    v_lshlrev_b32 v136, 16, v110
    v_and_b32 v137, 0xffff0000, v110
    v_lshlrev_b32 v138, 16, v111
    v_and_b32 v139, 0xffff0000, v111
    v_pk_fma_f32 v[140:141], v[84:85], v[132:133], v[140:141] op_sel:[0,0,0] op_sel_hi:[0,1,1]
    v_pk_fma_f32 v[142:143], v[84:85], v[134:135], v[142:143] op_sel:[0,0,0] op_sel_hi:[0,1,1]
    v_pk_fma_f32 v[144:145], v[84:85], v[136:137], v[144:145] op_sel:[0,0,0] op_sel_hi:[0,1,1]
    v_pk_fma_f32 v[146:147], v[84:85], v[138:139], v[146:147] op_sel:[0,0,0] op_sel_hi:[0,1,1]
    v_lshlrev_b32 v132, 16, v112
    v_and_b32 v133, 0xffff0000, v112
    v_lshlrev_b32 v134, 16, v113
    v_and_b32 v135, 0xffff0000, v113
    v_lshlrev_b32 v136, 16, v114
    v_and_b32 v137, 0xffff0000, v114
    v_lshlrev_b32 v138, 16, v115
    v_and_b32 v139, 0xffff0000, v115
    v_pk_fma_f32 v[140:141], v[84:85], v[132:133], v[140:141] op_sel:[1,0,0] op_sel_hi:[1,1,1]
    v_pk_fma_f32 v[142:143], v[84:85], v[134:135], v[142:143] op_sel:[1,0,0] op_sel_hi:[1,1,1]
    v_pk_fma_f32 v[144:145], v[84:85], v[136:137], v[144:145] op_sel:[1,0,0] op_sel_hi:[1,1,1]
    v_pk_fma_f32 v[146:147], v[84:85], v[138:139], v[146:147] op_sel:[1,0,0] op_sel_hi:[1,1,1]
    v_lshlrev_b32 v132, 16, v116
    v_and_b32 v133, 0xffff0000, v116
    v_lshlrev_b32 v134, 16, v117
    v_and_b32 v135, 0xffff0000, v117
    v_lshlrev_b32 v136, 16, v118
    v_and_b32 v137, 0xffff0000, v118
    v_lshlrev_b32 v138, 16, v119
    v_and_b32 v139, 0xffff0000, v119
    v_pk_fma_f32 v[140:141], v[86:87], v[132:133], v[140:141] op_sel:[0,0,0] op_sel_hi:[0,1,1]
    v_pk_fma_f32 v[142:143], v[86:87], v[134:135], v[142:143] op_sel:[0,0,0] op_sel_hi:[0,1,1]
    v_pk_fma_f32 v[144:145], v[86:87], v[136:137], v[144:145] op_sel:[0,0,0] op_sel_hi:[0,1,1]
    v_pk_fma_f32 v[146:147], v[86:87], v[138:139], v[146:147] op_sel:[0,0,0] op_sel_hi:[0,1,1]
    v_lshlrev_b32 v132, 16, v120
    v_and_b32 v133, 0xffff0000, v120
    v_lshlrev_b32 v134, 16, v121
    v_and_b32 v135, 0xffff0000, v121
    v_lshlrev_b32 v136, 16, v122
    v_and_b32 v137, 0xffff0000, v122
    v_lshlrev_b32 v138, 16, v123
    v_and_b32 v139, 0xffff0000, v123
    v_pk_fma_f32 v[140:141], v[86:87], v[132:133], v[140:141] op_sel:[1,0,0] op_sel_hi:[1,1,1]
    v_pk_fma_f32 v[142:143], v[86:87], v[134:135], v[142:143] op_sel:[1,0,0] op_sel_hi:[1,1,1]
    v_pk_fma_f32 v[144:145], v[86:87], v[136:137], v[144:145] op_sel:[1,0,0] op_sel_hi:[1,1,1]
    v_pk_fma_f32 v[146:147], v[86:87], v[138:139], v[146:147] op_sel:[1,0,0] op_sel_hi:[1,1,1]
    v_lshlrev_b32 v132, 16, v124
    v_and_b32 v133, 0xffff0000, v124
    v_lshlrev_b32 v134, 16, v125
    v_and_b32 v135, 0xffff0000, v125
    v_lshlrev_b32 v136, 16, v126
    v_and_b32 v137, 0xffff0000, v126
    v_lshlrev_b32 v138, 16, v127
    v_and_b32 v139, 0xffff0000, v127
    v_pk_fma_f32 v[140:141], v[88:89], v[132:133], v[140:141] op_sel:[0,0,0] op_sel_hi:[0,1,1]
    v_pk_fma_f32 v[142:143], v[88:89], v[134:135], v[142:143] op_sel:[0,0,0] op_sel_hi:[0,1,1]
    v_pk_fma_f32 v[144:145], v[88:89], v[136:137], v[144:145] op_sel:[0,0,0] op_sel_hi:[0,1,1]
    v_pk_fma_f32 v[146:147], v[88:89], v[138:139], v[146:147] op_sel:[0,0,0] op_sel_hi:[0,1,1]
    v_lshlrev_b32 v132, 16, v128
    v_and_b32 v133, 0xffff0000, v128
    v_lshlrev_b32 v134, 16, v129
    v_and_b32 v135, 0xffff0000, v129
    v_lshlrev_b32 v136, 16, v130
    v_and_b32 v137, 0xffff0000, v130
    v_lshlrev_b32 v138, 16, v131
    v_and_b32 v139, 0xffff0000, v131
    v_pk_fma_f32 v[140:141], v[88:89], v[132:133], v[140:141] op_sel:[1,0,0] op_sel_hi:[1,1,1]
    v_pk_fma_f32 v[142:143], v[88:89], v[134:135], v[142:143] op_sel:[1,0,0] op_sel_hi:[1,1,1]
    v_pk_fma_f32 v[144:145], v[88:89], v[136:137], v[144:145] op_sel:[1,0,0] op_sel_hi:[1,1,1]
    v_pk_fma_f32 v[146:147], v[88:89], v[138:139], v[146:147] op_sel:[1,0,0] op_sel_hi:[1,1,1]
    s_nop 0
    v_permlane32_swap_b32 v140, v144
    v_permlane32_swap_b32 v141, v145
    v_permlane32_swap_b32 v142, v146
    v_permlane32_swap_b32 v143, v147
    v_add_f32 v140, v140, v144
    v_add_f32 v141, v141, v145
    v_add_f32 v142, v142, v146
    v_add_f32 v143, v143, v147
    s_nop 0
    v_permlane16_swap_b32 v140, v142
    v_permlane16_swap_b32 v141, v143
    v_add_f32 v140, v140, v142
    v_add_f32 v141, v141, v143
    v_and_b32 v133, 7, v1
    v_lshrrev_b32 v134, 3, v1
    v_add_f32_dpp v132, v140, v140 row_ror:8 row_mask:0xf bank_mask:0x3
    s_nop 1
    v_add_f32_dpp v132, v141, v141 row_ror:8 row_mask:0xf bank_mask:0xc
    v_lshl_add_u32 v133, v133, 3, v134
    s_lshl_b32 s7, s3, 8
    s_add_u32 s7, s7, 122880
    v_lshl_add_u32 v133, v133, 2, s7
    ds_write_b32 v133, v132
    s_waitcnt lgkmcnt(0)
    s_barrier
    v_lshlrev_b32 v133, 2, v1
    v_add_u32 v134, 122880, v133
    ds_read_b32 v140, v134 offset:0
    ds_read_b32 v141, v134 offset:256
    ds_read_b32 v142, v134 offset:512
    ds_read_b32 v143, v134 offset:768
    v_add_u32 v133, s47, v133
    s_waitcnt lgkmcnt(2)
    v_add_f32 v140, v140, v141
    s_waitcnt lgkmcnt(0)
    v_add_f32 v142, v142, v143
    v_add_f32 v140, v140, v142
    v_min_u32 v140, -2, v140
    s_cmp_lg_u32 s3, 0
    s_cbranch_scc1 Lmod_skip_w
    global_store_dword v133, v140, s[38:39] offset:0 sc1
Lmod_skip_w:
Lwp_n3:
    s_branch Lwm_f
Lwm:
    s_sleep 2
Lwm_f:
    v_add_u32 v77, 0, v73
    global_load_dwordx4 v[80:83], v77, s[38:39] sc1
    global_load_dwordx4 v[84:87], v77, s[38:39] offset:2560 sc1
    v_add_u32 v77, 15360, v73
    global_load_dwordx4 v[88:91], v77, s[38:39] sc1
    global_load_dwordx4 v[92:95], v77, s[38:39] offset:2560 sc1
    s_waitcnt vmcnt(0)
    v_max_u32 v77, v80, v81
    v_max3_u32 v77, v82, v83, v77
    v_max3_u32 v77, v84, v85, v77
    v_max3_u32 v77, v86, v87, v77
    v_max3_u32 v77, v88, v89, v77
    v_max3_u32 v77, v90, v91, v77
    v_max3_u32 v77, v92, v93, v77
    v_max3_u32 v77, v94, v95, v77
    v_cmp_eq_u32 vcc, -1, v77
    s_add_u32 s100, s100, 1
    s_cmp_ge_u32 s100, 262144
    s_cbranch_scc1 Lwm_x
    s_cbranch_vccnz Lwm
Lwm_x:
    v_pk_add_f32 v[80:81], v[80:81], v[88:89] op_sel:[0,0] op_sel_hi:[1,1]
    v_pk_add_f32 v[82:83], v[82:83], v[90:91] op_sel:[0,0] op_sel_hi:[1,1]
    v_pk_add_f32 v[84:85], v[84:85], v[92:93] op_sel:[0,0] op_sel_hi:[1,1]
    v_pk_add_f32 v[86:87], v[86:87], v[94:95] op_sel:[0,0] op_sel_hi:[1,1]
    v_cvt_pk_bf16_f32 v80, v80, v80
    v_lshlrev_b32 v80, 16, v80
    v_cvt_pk_bf16_f32 v81, v81, v81
    v_lshlrev_b32 v81, 16, v81
    v_cvt_pk_bf16_f32 v82, v82, v82
    v_lshlrev_b32 v82, 16, v82
    v_cvt_pk_bf16_f32 v83, v83, v83
    v_lshlrev_b32 v83, 16, v83
    v_cvt_pk_bf16_f32 v84, v84, v84
    v_lshlrev_b32 v84, 16, v84
    v_cvt_pk_bf16_f32 v85, v85, v85
    v_lshlrev_b32 v85, 16, v85
    v_cvt_pk_bf16_f32 v86, v86, v86
    v_lshlrev_b32 v86, 16, v86
    v_cvt_pk_bf16_f32 v87, v87, v87
    v_lshlrev_b32 v87, 16, v87
    v_add_f32 v84, 1.0, v84
    v_add_f32 v85, 1.0, v85
    v_add_f32 v86, 1.0, v86
    v_add_f32 v87, 1.0, v87
    v_cvt_pk_bf16_f32 v84, v84, v84
    v_lshlrev_b32 v84, 16, v84
    v_cvt_pk_bf16_f32 v85, v85, v85
    v_lshlrev_b32 v85, 16, v85
    v_cvt_pk_bf16_f32 v86, v86, v86
    v_lshlrev_b32 v86, 16, v86
    v_cvt_pk_bf16_f32 v87, v87, v87
    v_lshlrev_b32 v87, 16, v87
    ds_write_b128 v72, v[84:87]
    ds_write_b128 v72, v[80:83] offset:640
    ds_read_b128 v[32:35], v74 offset:0
    ds_read_b128 v[36:39], v74 offset:16
    ds_read_b128 v[40:43], v74 offset:128
    ds_read_b128 v[44:47], v74 offset:144
    ds_read_b128 v[48:51], v74 offset:256
    ds_read_b128 v[52:55], v74 offset:272
    ds_read_b128 v[56:59], v74 offset:384
    ds_read_b128 v[60:63], v74 offset:400
    ds_read_b128 v[64:67], v74 offset:512
    ds_read_b128 v[68:71], v74 offset:528
    s_waitcnt lgkmcnt(9)
    v_pk_mul_f32 v[96:97], v[32:33], v[152:153] op_sel:[0,0] op_sel_hi:[0,1]
    v_pk_mul_f32 v[98:99], v[32:33], v[154:155] op_sel:[1,0] op_sel_hi:[1,1]
    v_pk_mul_f32 v[100:101], v[34:35], v[156:157] op_sel:[0,0] op_sel_hi:[0,1]
    v_pk_mul_f32 v[102:103], v[34:35], v[158:159] op_sel:[1,0] op_sel_hi:[1,1]
    s_waitcnt lgkmcnt(8)
    v_pk_mul_f32 v[104:105], v[36:37], v[160:161] op_sel:[0,0] op_sel_hi:[0,1]
    v_pk_mul_f32 v[106:107], v[36:37], v[162:163] op_sel:[1,0] op_sel_hi:[1,1]
    v_pk_mul_f32 v[108:109], v[38:39], v[164:165] op_sel:[0,0] op_sel_hi:[0,1]
    v_pk_mul_f32 v[110:111], v[38:39], v[166:167] op_sel:[1,0] op_sel_hi:[1,1]
    v_cvt_pk_bf16_f32 v112, v96, v98
    v_cvt_pk_bf16_f32 v113, v100, v102
    v_cvt_pk_bf16_f32 v114, v104, v106
    v_cvt_pk_bf16_f32 v115, v108, v110
    v_cvt_pk_bf16_f32 v116, v97, v99
    v_cvt_pk_bf16_f32 v117, v101, v103
    v_cvt_pk_bf16_f32 v118, v105, v107
    v_cvt_pk_bf16_f32 v119, v109, v111
    global_store_dwordx4 v75, v[112:115], s[38:39] offset:-2048 sc1
    global_store_dwordx4 v76, v[116:119], s[38:39] offset:-2048 sc1
    s_waitcnt lgkmcnt(7)
    v_pk_mul_f32 v[96:97], v[40:41], v[168:169] op_sel:[0,0] op_sel_hi:[0,1]
    v_pk_mul_f32 v[98:99], v[40:41], v[170:171] op_sel:[1,0] op_sel_hi:[1,1]
    v_pk_mul_f32 v[100:101], v[42:43], v[172:173] op_sel:[0,0] op_sel_hi:[0,1]
    v_pk_mul_f32 v[102:103], v[42:43], v[174:175] op_sel:[1,0] op_sel_hi:[1,1]
    s_waitcnt lgkmcnt(6)
    v_pk_mul_f32 v[104:105], v[44:45], v[176:177] op_sel:[0,0] op_sel_hi:[0,1]
    v_pk_mul_f32 v[106:107], v[44:45], v[178:179] op_sel:[1,0] op_sel_hi:[1,1]
    v_pk_mul_f32 v[108:109], v[46:47], v[180:181] op_sel:[0,0] op_sel_hi:[0,1]
    v_pk_mul_f32 v[110:111], v[46:47], v[182:183] op_sel:[1,0] op_sel_hi:[1,1]
    v_cvt_pk_bf16_f32 v120, v96, v98
    v_cvt_pk_bf16_f32 v121, v100, v102
    v_cvt_pk_bf16_f32 v122, v104, v106
    v_cvt_pk_bf16_f32 v123, v108, v110
    v_cvt_pk_bf16_f32 v124, v97, v99
    v_cvt_pk_bf16_f32 v125, v101, v103
    v_cvt_pk_bf16_f32 v126, v105, v107
    v_cvt_pk_bf16_f32 v127, v109, v111
    global_store_dwordx4 v75, v[120:123], s[38:39] offset:-1024 sc1
    global_store_dwordx4 v76, v[124:127], s[38:39] offset:-1024 sc1
    s_waitcnt lgkmcnt(5)
    v_pk_mul_f32 v[96:97], v[48:49], v[184:185] op_sel:[0,0] op_sel_hi:[0,1]
    v_pk_mul_f32 v[98:99], v[48:49], v[186:187] op_sel:[1,0] op_sel_hi:[1,1]
    v_pk_mul_f32 v[100:101], v[50:51], v[188:189] op_sel:[0,0] op_sel_hi:[0,1]
    v_pk_mul_f32 v[102:103], v[50:51], v[190:191] op_sel:[1,0] op_sel_hi:[1,1]
    s_waitcnt lgkmcnt(4)
    v_pk_mul_f32 v[104:105], v[52:53], v[192:193] op_sel:[0,0] op_sel_hi:[0,1]
    v_pk_mul_f32 v[106:107], v[52:53], v[194:195] op_sel:[1,0] op_sel_hi:[1,1]
    v_pk_mul_f32 v[108:109], v[54:55], v[196:197] op_sel:[0,0] op_sel_hi:[0,1]
    v_pk_mul_f32 v[110:111], v[54:55], v[198:199] op_sel:[1,0] op_sel_hi:[1,1]
    v_cvt_pk_bf16_f32 v128, v96, v98
    v_cvt_pk_bf16_f32 v129, v100, v102
    v_cvt_pk_bf16_f32 v130, v104, v106
    v_cvt_pk_bf16_f32 v131, v108, v110
    v_cvt_pk_bf16_f32 v132, v97, v99
    v_cvt_pk_bf16_f32 v133, v101, v103
    v_cvt_pk_bf16_f32 v134, v105, v107
    v_cvt_pk_bf16_f32 v135, v109, v111
    global_store_dwordx4 v75, v[128:131], s[38:39] offset:0 sc1
    global_store_dwordx4 v76, v[132:135], s[38:39] offset:0 sc1
    s_waitcnt lgkmcnt(3)
    v_pk_mul_f32 v[96:97], v[56:57], v[200:201] op_sel:[0,0] op_sel_hi:[0,1]
    v_pk_mul_f32 v[98:99], v[56:57], v[202:203] op_sel:[1,0] op_sel_hi:[1,1]
    v_pk_mul_f32 v[100:101], v[58:59], v[204:205] op_sel:[0,0] op_sel_hi:[0,1]
    v_pk_mul_f32 v[102:103], v[58:59], v[206:207] op_sel:[1,0] op_sel_hi:[1,1]
    s_waitcnt lgkmcnt(2)
    v_pk_mul_f32 v[104:105], v[60:61], v[208:209] op_sel:[0,0] op_sel_hi:[0,1]
    v_pk_mul_f32 v[106:107], v[60:61], v[210:211] op_sel:[1,0] op_sel_hi:[1,1]
    v_pk_mul_f32 v[108:109], v[62:63], v[212:213] op_sel:[0,0] op_sel_hi:[0,1]
    v_pk_mul_f32 v[110:111], v[62:63], v[214:215] op_sel:[1,0] op_sel_hi:[1,1]
    v_cvt_pk_bf16_f32 v136, v96, v98
    v_cvt_pk_bf16_f32 v137, v100, v102
    v_cvt_pk_bf16_f32 v138, v104, v106
    v_cvt_pk_bf16_f32 v139, v108, v110
    v_cvt_pk_bf16_f32 v140, v97, v99
    v_cvt_pk_bf16_f32 v141, v101, v103
    v_cvt_pk_bf16_f32 v142, v105, v107
    v_cvt_pk_bf16_f32 v143, v109, v111
    global_store_dwordx4 v75, v[136:139], s[38:39] offset:1024 sc1
    global_store_dwordx4 v76, v[140:143], s[38:39] offset:1024 sc1
    s_waitcnt lgkmcnt(1)
    v_pk_mul_f32 v[96:97], v[64:65], v[216:217] op_sel:[0,0] op_sel_hi:[0,1]
    v_pk_mul_f32 v[98:99], v[64:65], v[218:219] op_sel:[1,0] op_sel_hi:[1,1]
    v_pk_mul_f32 v[100:101], v[66:67], v[220:221] op_sel:[0,0] op_sel_hi:[0,1]
    v_pk_mul_f32 v[102:103], v[66:67], v[222:223] op_sel:[1,0] op_sel_hi:[1,1]
    s_waitcnt lgkmcnt(0)
    v_pk_mul_f32 v[104:105], v[68:69], v[224:225] op_sel:[0,0] op_sel_hi:[0,1]
    v_pk_mul_f32 v[106:107], v[68:69], v[226:227] op_sel:[1,0] op_sel_hi:[1,1]
    v_pk_mul_f32 v[108:109], v[70:71], v[228:229] op_sel:[0,0] op_sel_hi:[0,1]
    v_pk_mul_f32 v[110:111], v[70:71], v[230:231] op_sel:[1,0] op_sel_hi:[1,1]
    v_cvt_pk_bf16_f32 v144, v96, v98
    v_cvt_pk_bf16_f32 v145, v100, v102
    v_cvt_pk_bf16_f32 v146, v104, v106
    v_cvt_pk_bf16_f32 v147, v108, v110
    v_cvt_pk_bf16_f32 v148, v97, v99
    v_cvt_pk_bf16_f32 v149, v101, v103
    v_cvt_pk_bf16_f32 v150, v105, v107
    v_cvt_pk_bf16_f32 v151, v109, v111
    global_store_dwordx4 v75, v[144:147], s[38:39] offset:2048 sc1
    global_store_dwordx4 v76, v[148:151], s[38:39] offset:2048 sc1
    ds_read_b128 v[32:35], v74 offset:640
    ds_read_b128 v[36:39], v74 offset:656
    ds_read_b128 v[40:43], v74 offset:768
    ds_read_b128 v[44:47], v74 offset:784
    ds_read_b128 v[48:51], v74 offset:896
    ds_read_b128 v[52:55], v74 offset:912
    ds_read_b128 v[56:59], v74 offset:1024
    ds_read_b128 v[60:63], v74 offset:1040
    ds_read_b128 v[64:67], v74 offset:1152
    ds_read_b128 v[68:71], v74 offset:1168
    s_mov_b32 s7, 0x3f803f80
    v_mov_b32 v88, 0
    v_mov_b32 v89, 0
    v_mov_b32 v90, 0
    v_mov_b32 v91, 0
    v_mov_b32 v92, 0
    v_mov_b32 v93, 0
    v_mov_b32 v94, 0
    v_mov_b32 v95, 0
    v_dot2_f32_bf16 v88, v112, s7, v88
    v_dot2_f32_bf16 v89, v116, s7, v89
    v_dot2_f32_bf16 v88, v113, s7, v88
    v_dot2_f32_bf16 v89, v117, s7, v89
    v_dot2_f32_bf16 v88, v114, s7, v88
    v_dot2_f32_bf16 v89, v118, s7, v89
    v_dot2_f32_bf16 v88, v115, s7, v88
    v_dot2_f32_bf16 v89, v119, s7, v89
    v_dot2_f32_bf16 v88, v120, s7, v88
    v_dot2_f32_bf16 v89, v124, s7, v89
    v_dot2_f32_bf16 v88, v121, s7, v88
    v_dot2_f32_bf16 v89, v125, s7, v89
    v_dot2_f32_bf16 v88, v122, s7, v88
    v_dot2_f32_bf16 v89, v126, s7, v89
    v_dot2_f32_bf16 v88, v123, s7, v88
    v_dot2_f32_bf16 v89, v127, s7, v89
    v_dot2_f32_bf16 v88, v128, s7, v88
    v_dot2_f32_bf16 v89, v132, s7, v89
    v_dot2_f32_bf16 v88, v129, s7, v88
    v_dot2_f32_bf16 v89, v133, s7, v89
    v_dot2_f32_bf16 v88, v130, s7, v88
    v_dot2_f32_bf16 v89, v134, s7, v89
    v_dot2_f32_bf16 v88, v131, s7, v88
    v_dot2_f32_bf16 v89, v135, s7, v89
    v_dot2_f32_bf16 v88, v136, s7, v88
    v_dot2_f32_bf16 v89, v140, s7, v89
    v_dot2_f32_bf16 v88, v137, s7, v88
    v_dot2_f32_bf16 v89, v141, s7, v89
    v_dot2_f32_bf16 v88, v138, s7, v88
    v_dot2_f32_bf16 v89, v142, s7, v89
    v_dot2_f32_bf16 v88, v139, s7, v88
    v_dot2_f32_bf16 v89, v143, s7, v89
    v_dot2_f32_bf16 v88, v144, s7, v88
    v_dot2_f32_bf16 v89, v148, s7, v89
    v_dot2_f32_bf16 v88, v145, s7, v88
    v_dot2_f32_bf16 v89, v149, s7, v89
    v_dot2_f32_bf16 v88, v146, s7, v88
    v_dot2_f32_bf16 v89, v150, s7, v89
    v_dot2_f32_bf16 v88, v147, s7, v88
    v_dot2_f32_bf16 v89, v151, s7, v89
    s_waitcnt lgkmcnt(9)
    v_pk_fma_f32 v[90:91], v[32:33], v[152:153], v[90:91] op_sel:[0,0,0] op_sel_hi:[0,1,1]
    v_pk_fma_f32 v[92:93], v[32:33], v[154:155], v[92:93] op_sel:[1,0,0] op_sel_hi:[1,1,1]
    v_pk_fma_f32 v[94:95], v[34:35], v[156:157], v[94:95] op_sel:[0,0,0] op_sel_hi:[0,1,1]
    v_pk_fma_f32 v[90:91], v[34:35], v[158:159], v[90:91] op_sel:[1,0,0] op_sel_hi:[1,1,1]
    s_waitcnt lgkmcnt(8)
    v_pk_fma_f32 v[92:93], v[36:37], v[160:161], v[92:93] op_sel:[0,0,0] op_sel_hi:[0,1,1]
    v_pk_fma_f32 v[94:95], v[36:37], v[162:163], v[94:95] op_sel:[1,0,0] op_sel_hi:[1,1,1]
    v_pk_fma_f32 v[90:91], v[38:39], v[164:165], v[90:91] op_sel:[0,0,0] op_sel_hi:[0,1,1]
    v_pk_fma_f32 v[92:93], v[38:39], v[166:167], v[92:93] op_sel:[1,0,0] op_sel_hi:[1,1,1]
    s_waitcnt lgkmcnt(7)
    v_pk_fma_f32 v[94:95], v[40:41], v[168:169], v[94:95] op_sel:[0,0,0] op_sel_hi:[0,1,1]
    v_pk_fma_f32 v[90:91], v[40:41], v[170:171], v[90:91] op_sel:[1,0,0] op_sel_hi:[1,1,1]
    v_pk_fma_f32 v[92:93], v[42:43], v[172:173], v[92:93] op_sel:[0,0,0] op_sel_hi:[0,1,1]
    v_pk_fma_f32 v[94:95], v[42:43], v[174:175], v[94:95] op_sel:[1,0,0] op_sel_hi:[1,1,1]
    s_waitcnt lgkmcnt(6)
    v_pk_fma_f32 v[90:91], v[44:45], v[176:177], v[90:91] op_sel:[0,0,0] op_sel_hi:[0,1,1]
    v_pk_fma_f32 v[92:93], v[44:45], v[178:179], v[92:93] op_sel:[1,0,0] op_sel_hi:[1,1,1]
    v_pk_fma_f32 v[94:95], v[46:47], v[180:181], v[94:95] op_sel:[0,0,0] op_sel_hi:[0,1,1]
    v_pk_fma_f32 v[90:91], v[46:47], v[182:183], v[90:91] op_sel:[1,0,0] op_sel_hi:[1,1,1]
    s_waitcnt lgkmcnt(5)
    v_pk_fma_f32 v[92:93], v[48:49], v[184:185], v[92:93] op_sel:[0,0,0] op_sel_hi:[0,1,1]
    v_pk_fma_f32 v[94:95], v[48:49], v[186:187], v[94:95] op_sel:[1,0,0] op_sel_hi:[1,1,1]
    v_pk_fma_f32 v[90:91], v[50:51], v[188:189], v[90:91] op_sel:[0,0,0] op_sel_hi:[0,1,1]
    v_pk_fma_f32 v[92:93], v[50:51], v[190:191], v[92:93] op_sel:[1,0,0] op_sel_hi:[1,1,1]
    s_waitcnt lgkmcnt(4)
    v_pk_fma_f32 v[94:95], v[52:53], v[192:193], v[94:95] op_sel:[0,0,0] op_sel_hi:[0,1,1]
    v_pk_fma_f32 v[90:91], v[52:53], v[194:195], v[90:91] op_sel:[1,0,0] op_sel_hi:[1,1,1]
    v_pk_fma_f32 v[92:93], v[54:55], v[196:197], v[92:93] op_sel:[0,0,0] op_sel_hi:[0,1,1]
    v_pk_fma_f32 v[94:95], v[54:55], v[198:199], v[94:95] op_sel:[1,0,0] op_sel_hi:[1,1,1]
    s_waitcnt lgkmcnt(3)
    v_pk_fma_f32 v[90:91], v[56:57], v[200:201], v[90:91] op_sel:[0,0,0] op_sel_hi:[0,1,1]
    v_pk_fma_f32 v[92:93], v[56:57], v[202:203], v[92:93] op_sel:[1,0,0] op_sel_hi:[1,1,1]
    v_pk_fma_f32 v[94:95], v[58:59], v[204:205], v[94:95] op_sel:[0,0,0] op_sel_hi:[0,1,1]
    v_pk_fma_f32 v[90:91], v[58:59], v[206:207], v[90:91] op_sel:[1,0,0] op_sel_hi:[1,1,1]
    s_waitcnt lgkmcnt(2)
    v_pk_fma_f32 v[92:93], v[60:61], v[208:209], v[92:93] op_sel:[0,0,0] op_sel_hi:[0,1,1]
    v_pk_fma_f32 v[94:95], v[60:61], v[210:211], v[94:95] op_sel:[1,0,0] op_sel_hi:[1,1,1]
    v_pk_fma_f32 v[90:91], v[62:63], v[212:213], v[90:91] op_sel:[0,0,0] op_sel_hi:[0,1,1]
    v_pk_fma_f32 v[92:93], v[62:63], v[214:215], v[92:93] op_sel:[1,0,0] op_sel_hi:[1,1,1]
    s_waitcnt lgkmcnt(1)
    v_pk_fma_f32 v[94:95], v[64:65], v[216:217], v[94:95] op_sel:[0,0,0] op_sel_hi:[0,1,1]
    v_pk_fma_f32 v[90:91], v[64:65], v[218:219], v[90:91] op_sel:[1,0,0] op_sel_hi:[1,1,1]
    v_pk_fma_f32 v[92:93], v[66:67], v[220:221], v[92:93] op_sel:[0,0,0] op_sel_hi:[0,1,1]
    v_pk_fma_f32 v[94:95], v[66:67], v[222:223], v[94:95] op_sel:[1,0,0] op_sel_hi:[1,1,1]
    s_waitcnt lgkmcnt(0)
    v_pk_fma_f32 v[90:91], v[68:69], v[224:225], v[90:91] op_sel:[0,0,0] op_sel_hi:[0,1,1]
    v_pk_fma_f32 v[92:93], v[68:69], v[226:227], v[92:93] op_sel:[1,0,0] op_sel_hi:[1,1,1]
    v_pk_fma_f32 v[94:95], v[70:71], v[228:229], v[94:95] op_sel:[0,0,0] op_sel_hi:[0,1,1]
    v_pk_fma_f32 v[90:91], v[70:71], v[230:231], v[90:91] op_sel:[1,0,0] op_sel_hi:[1,1,1]
    v_pk_add_f32 v[90:91], v[90:91], v[92:93] op_sel:[0,0] op_sel_hi:[1,1]
    v_pk_add_f32 v[90:91], v[90:91], v[94:95] op_sel:[0,0] op_sel_hi:[1,1]
    v_permlane32_swap_b32 v88, v89
    s_nop 0
    v_permlane32_swap_b32 v90, v91
    v_add_f32 v88, v88, v89
    v_add_f32 v90, v90, v91
    s_nop 1
    v_permlane16_swap_b32 v88, v90
    v_add_f32 v88, v88, v90
    v_lshlrev_b32 v74, 2, v0
    v_add_u32 v74, 131072, v74
    ds_write_b32 v74, v88
    v_xor_b32 v74, 256, v74
    s_waitcnt vmcnt(0) lgkmcnt(0)
    s_barrier
    ds_read_b32 v89, v74
    s_lshl_b32 s6, s46, 7
    s_lshr_b32 s5, s44, 1
    s_mul_i32 s5, s5, 14336
    s_add_u32 s6, s6, s5
    s_add_u32 s6, s6, 49152
    v_lshl_add_u32 v74, v1, 2, s6
    s_waitcnt lgkmcnt(0)
    v_add_f32 v88, v88, v89
    v_min_u32 v88, -2, v88
    s_bitcmp1_b32 s3, 0
    s_cbranch_scc1 Lwp_skip
    global_store_dword v74, v88, s[38:39] sc1
Lwp_skip:
    s_sub_u32 s48, s42, 11
    s_cmp_ge_u32 s48, 27
    s_cbranch_scc1 Lsp_c
    v_and_b32 v33, 15, v1
    v_lshrrev_b32 v34, 4, v1
    v_mul_u32_u24 v34, 10240, v34
    s_mul_i32 s5, s3, 320
    s_add_u32 s5, s5, 40960
    v_add_u32 v34, s5, v34
    v_lshl_add_u32 v31, v33, 2, v34
    v_lshl_add_u32 v32, v33, 1, v34
    s_mul_i32 s5, s3, 276480
    s_mul_i32 s6, s48, 5120
    s_add_u32 s5, s5, s6
    s_add_u32 s5, s5, 10487808
    v_lshl_add_u32 v30, v1, 4, s5
    s_mov_b32 s6, 0x5040100
    s_mov_b32 s7, 0x7060302
    ds_read_b32 v36, v31 offset:0
    ds_read_b32 v37, v31 offset:2560
    ds_read_b32 v38, v31 offset:5120
    ds_read_b32 v39, v31 offset:7680
    ds_read_b32 v40, v31 offset:1280
    ds_read_b32 v41, v31 offset:3840
    ds_read_b32 v42, v31 offset:6400
    ds_read_b32 v43, v31 offset:8960
    ds_read_b32 v44, v31 offset:64
    ds_read_b32 v45, v31 offset:2624
    ds_read_b32 v46, v31 offset:5184
    ds_read_b32 v47, v31 offset:7744
    ds_read_b32 v48, v31 offset:1344
    ds_read_b32 v49, v31 offset:3904
    ds_read_b32 v50, v31 offset:6464
    ds_read_b32 v51, v31 offset:9024
    ds_read_u16 v52, v32 offset:128
    ds_read_u16 v53, v32 offset:2688
    ds_read_u16 v54, v32 offset:5248
    ds_read_u16 v55, v32 offset:7808
    ds_read_u16 v56, v32 offset:1408
    ds_read_u16 v57, v32 offset:3968
    ds_read_u16 v58, v32 offset:6528
    ds_read_u16 v59, v32 offset:9088
    s_waitcnt lgkmcnt(15)
    v_perm_b32 v60, v37, v36, s6
    v_perm_b32 v61, v39, v38, s6
    v_perm_b32 v62, v41, v40, s6
    v_perm_b32 v63, v43, v42, s6
    v_perm_b32 v64, v37, v36, s7
    v_perm_b32 v65, v39, v38, s7
    v_perm_b32 v66, v41, v40, s7
    v_perm_b32 v67, v43, v42, s7
    s_waitcnt lgkmcnt(14)
    v_perm_b32 v68, v45, v44, s6
    s_waitcnt lgkmcnt(12)
    v_perm_b32 v69, v47, v46, s6
    s_waitcnt lgkmcnt(10)
    v_perm_b32 v70, v49, v48, s6
    s_waitcnt lgkmcnt(8)
    v_perm_b32 v71, v51, v50, s6
    v_perm_b32 v72, v45, v44, s7
    v_perm_b32 v73, v47, v46, s7
    v_perm_b32 v74, v49, v48, s7
    v_perm_b32 v75, v51, v50, s7
    s_waitcnt lgkmcnt(6)
    v_perm_b32 v76, v53, v52, s6
    s_waitcnt lgkmcnt(4)
    v_perm_b32 v77, v55, v54, s6
    s_waitcnt lgkmcnt(2)
    v_perm_b32 v78, v57, v56, s6
    s_waitcnt lgkmcnt(0)
    v_perm_b32 v79, v59, v58, s6
    global_store_dwordx4 v30, v[60:63], s[38:39] offset:-2048 sc1
    global_store_dwordx4 v30, v[64:67], s[38:39] offset:-1024 sc1
    global_store_dwordx4 v30, v[68:71], s[38:39] offset:0 sc1
    global_store_dwordx4 v30, v[72:75], s[38:39] offset:1024 sc1
    global_store_dwordx4 v30, v[76:79], s[38:39] offset:2048 sc1
    v_add_u32 v30, 138240, v30
    ds_read_b32 v80, v31 offset:160
    ds_read_b32 v81, v31 offset:2720
    ds_read_b32 v82, v31 offset:5280
    ds_read_b32 v83, v31 offset:7840
    ds_read_b32 v84, v31 offset:1440
    ds_read_b32 v85, v31 offset:4000
    ds_read_b32 v86, v31 offset:6560
    ds_read_b32 v87, v31 offset:9120
    ds_read_b32 v88, v31 offset:224
    ds_read_b32 v89, v31 offset:2784
    ds_read_b32 v90, v31 offset:5344
    ds_read_b32 v91, v31 offset:7904
    ds_read_b32 v92, v31 offset:1504
    ds_read_b32 v93, v31 offset:4064
    ds_read_b32 v94, v31 offset:6624
    ds_read_b32 v95, v31 offset:9184
    ds_read_u16 v96, v32 offset:288
    ds_read_u16 v97, v32 offset:2848
    ds_read_u16 v98, v32 offset:5408
    ds_read_u16 v99, v32 offset:7968
    ds_read_u16 v100, v32 offset:1568
    ds_read_u16 v101, v32 offset:4128
    ds_read_u16 v102, v32 offset:6688
    ds_read_u16 v103, v32 offset:9248
    s_waitcnt lgkmcnt(15)
    v_perm_b32 v104, v81, v80, s6
    v_perm_b32 v105, v83, v82, s6
    v_perm_b32 v106, v85, v84, s6
    v_perm_b32 v107, v87, v86, s6
    v_perm_b32 v108, v81, v80, s7
    v_perm_b32 v109, v83, v82, s7
    v_perm_b32 v110, v85, v84, s7
    v_perm_b32 v111, v87, v86, s7
    s_waitcnt lgkmcnt(14)
    v_perm_b32 v112, v89, v88, s6
    s_waitcnt lgkmcnt(12)
    v_perm_b32 v113, v91, v90, s6
    s_waitcnt lgkmcnt(10)
    v_perm_b32 v114, v93, v92, s6
    s_waitcnt lgkmcnt(8)
    v_perm_b32 v115, v95, v94, s6
    v_perm_b32 v116, v89, v88, s7
    v_perm_b32 v117, v91, v90, s7
    v_perm_b32 v118, v93, v92, s7
    v_perm_b32 v119, v95, v94, s7
    s_waitcnt lgkmcnt(6)
    v_perm_b32 v120, v97, v96, s6
    s_waitcnt lgkmcnt(4)
    v_perm_b32 v121, v99, v98, s6
    s_waitcnt lgkmcnt(2)
    v_perm_b32 v122, v101, v100, s6
    s_waitcnt lgkmcnt(0)
    v_perm_b32 v123, v103, v102, s6
    global_store_dwordx4 v30, v[104:107], s[38:39] offset:-2048 sc1
    global_store_dwordx4 v30, v[108:111], s[38:39] offset:-1024 sc1
    global_store_dwordx4 v30, v[112:115], s[38:39] offset:0 sc1
    global_store_dwordx4 v30, v[116:119], s[38:39] offset:1024 sc1
    global_store_dwordx4 v30, v[120:123], s[38:39] offset:2048 sc1
    s_lshl_b32 s4, s48, 2
    s_add_u32 s4, s4, 98304
    v_mov_b32 v28, s4
    s_waitcnt vmcnt(0) lgkmcnt(0)
    s_barrier
    s_cmp_lg_u32 s3, 0
    s_cbranch_scc1 Lsp_c
    global_store_dword v28, v28, s[38:39] sc1
Lsp_c:
    s_waitcnt lgkmcnt(0)
    s_barrier
    s_and_b32 s4, s41, 3
    s_cmp_eq_u32 s4, 0
    s_cselect_b32 s5, 8, 0
    s_cmp_le_u32 s4, 1
    s_cselect_b32 s6, 16, 8
    s_cmp_eq_u32 s4, 3
    s_cselect_b32 s50, 16, 24
    s_lshl_b32 s44, s4, 3
    s_bitcmp1_b32 s43, 0
    s_cselect_b32 s46, s6, s5
    s_cselect_b32 s48, s5, s6
    s_lshl_b32 s5, s3, 1
    s_add_u32 s44, s44, s5
    s_add_u32 s45, s44, 1
    s_add_u32 s46, s46, s5
    s_add_u32 s47, s46, 1
    s_add_u32 s48, s48, s5
    s_add_u32 s49, s48, 1
    s_add_u32 s50, s50, s5
    s_add_u32 s51, s50, 1
    s_lshl_b32 s5, s40, 18
    s_lshl_b32 s6, s44, 7
    s_add_u32 s6, s6, s5
    s_add_u32 s68, s24, s6
    s_addc_u32 s69, s25, 0
    s_lshl_b32 s6, s45, 7
    s_add_u32 s6, s6, s5
    s_add_u32 s70, s24, s6
    s_addc_u32 s71, s25, 0
    s_lshl_b32 s6, s46, 7
    s_add_u32 s6, s6, s5
    s_add_u32 s72, s24, s6
    s_addc_u32 s73, s25, 0
    s_lshl_b32 s6, s47, 7
    s_add_u32 s6, s6, s5
    s_add_u32 s74, s24, s6
    s_addc_u32 s75, s25, 0
    s_lshl_b32 s6, s48, 7
    s_add_u32 s6, s6, s5
    s_add_u32 s76, s24, s6
    s_addc_u32 s77, s25, 0
    s_lshl_b32 s6, s49, 7
    s_add_u32 s6, s6, s5
    s_add_u32 s78, s24, s6
    s_addc_u32 s79, s25, 0
    s_lshl_b32 s6, s50, 7
    s_add_u32 s6, s6, s5
    s_add_u32 s80, s24, s6
    s_addc_u32 s81, s25, 0
    s_lshl_b32 s6, s51, 7
    s_add_u32 s6, s6, s5
    s_add_u32 s82, s24, s6
    s_addc_u32 s83, s25, 0
    s_lshl_b32 s89, s3, 14
    s_add_u32 s89, s89, 83200
    v_lshrrev_b32 v28, 3, v1
    v_lshlrev_b32 v28, 12, v28
    v_bfe_u32 v29, v1, 4, 1
    v_xor_b32 v29, v29, v1
    v_and_b32 v29, 7, v29
    v_xor_b32 v64, 0, v29
    v_lshl_add_u32 v64, v64, 4, v28
    v_add_u32 v68, 131072, v64
    v_xor_b32 v65, 2, v29
    v_lshl_add_u32 v65, v65, 4, v28
    v_add_u32 v65, 32768, v65
    v_add_u32 v69, 131072, v65
    v_xor_b32 v66, 4, v29
    v_lshl_add_u32 v66, v66, 4, v28
    v_add_u32 v66, 65536, v66
    v_add_u32 v70, 131072, v66
    v_xor_b32 v67, 6, v29
    v_lshl_add_u32 v67, v67, 4, v28
    v_add_u32 v67, 98304, v67
    v_add_u32 v71, 131072, v67
    s_and_b32 s4, s41, 1
    s_lshl_b32 s5, s3, 1
    s_add_u32 s5, s5, s4
    s_cmp_eq_u32 s5, 7
    s_cselect_b32 s5, 0, s5
    s_mul_i32 s96, s41, 7
    s_add_u32 s96, s96, s5
    s_add_u32 s97, s96, 1
    s_cmp_eq_u32 s3, 3
    s_cselect_b32 s97, 55, s97
    s_cselect_b32 s5, 0, -1
    v_and_b32 v7, s5, v4
    s_mul_i32 s4, s96, 20480
    s_add_u32 s5, s4, 7344128
    s_add_u32 s8, s38, s5
    s_addc_u32 s9, s39, 0
    s_add_u32 s5, s4, 7352320
    s_add_u32 s10, s38, s5
    s_addc_u32 s11, s39, 0
    s_add_u32 s5, s4, 7360512
    s_add_u32 s12, s38, s5
    s_addc_u32 s13, s39, 0
    s_mul_i32 s4, s97, 20480
    s_add_u32 s5, s4, 7344128
    s_add_u32 s14, s38, s5
    s_addc_u32 s15, s39, 0
    s_add_u32 s5, s4, 7352320
    s_add_u32 s16, s38, s5
    s_addc_u32 s17, s39, 0
    s_add_u32 s5, s4, 7360512
    s_add_u32 s18, s38, s5
    s_addc_u32 s19, s39, 0
    v_and_b32 v28, 1, v1
    s_sub_u32 s4, s97, s96
    v_mul_u32_u24 v28, s4, v28
    v_add_lshl_u32 v28, v28, s96, 7
    v_bfe_u32 v29, v1, 1, 2
    v_mul_u32_u24 v29, 7168, v29
    v_add_u32 v28, v28, v29
    v_add_u32 v28, 49152, v28
    s_branch Lsup_f
Lsup:
    s_sleep 4
Lsup_f:
    global_load_dword v29, v28, s[38:39] sc1
    s_waitcnt vmcnt(0)
    v_mov_b32 v29, v29
    v_cmp_eq_u32 vcc, -1, v29
    s_add_u32 s100, s100, 1
    s_cmp_ge_u32 s100, 262144
    s_cbranch_scc1 Lsup_x
    s_cbranch_vccnz Lsup
Lsup_x:
Lsu:
    s_lshl_b32 s4, s96, 7
    s_add_u32 s4, s4, 49152
    v_lshl_add_u32 v28, v2, 2, s4
    global_load_dword v8, v28, s[38:39] sc1
    global_load_dword v9, v28, s[38:39] offset:64 sc1
    s_add_u32 s4, s4, 7168
    v_lshl_add_u32 v28, v3, 4, s4
    global_load_dwordx4 v[12:15], v28, s[38:39] sc1
    global_load_dwordx4 v[16:19], v28, s[38:39] offset:64 sc1
    s_lshl_b32 s4, s97, 7
    s_add_u32 s4, s4, 49152
    v_lshl_add_u32 v28, v2, 2, s4
    global_load_dword v10, v28, s[38:39] sc1
    global_load_dword v11, v28, s[38:39] offset:64 sc1
    s_add_u32 s4, s4, 7168
    v_lshl_add_u32 v28, v3, 4, s4
    global_load_dwordx4 v[20:23], v28, s[38:39] sc1
    global_load_dwordx4 v[24:27], v28, s[38:39] offset:64 sc1
    s_lshl_b32 s4, s96, 7
    s_add_u32 s4, s4, 63488
    v_lshl_add_u32 v28, v2, 2, s4
    global_load_dword v40, v28, s[38:39] sc1
    global_load_dword v41, v28, s[38:39] offset:64 sc1
    s_add_u32 s4, s4, 7168
    v_lshl_add_u32 v28, v3, 4, s4
    global_load_dwordx4 v[44:47], v28, s[38:39] sc1
    global_load_dwordx4 v[48:51], v28, s[38:39] offset:64 sc1
    s_lshl_b32 s4, s97, 7
    s_add_u32 s4, s4, 63488
    v_lshl_add_u32 v28, v2, 2, s4
    global_load_dword v42, v28, s[38:39] sc1
    global_load_dword v43, v28, s[38:39] offset:64 sc1
    s_add_u32 s4, s4, 7168
    v_lshl_add_u32 v28, v3, 4, s4
    global_load_dwordx4 v[52:55], v28, s[38:39] sc1
    global_load_dwordx4 v[56:59], v28, s[38:39] offset:64 sc1
    s_waitcnt vmcnt(0)
    v_max_u32 v29, v8, v9
    v_max3_u32 v29, v10, v11, v29
    v_max3_u32 v29, v12, v13, v29
    v_max3_u32 v29, v14, v15, v29
    v_max3_u32 v29, v16, v17, v29
    v_max3_u32 v29, v18, v19, v29
    v_max3_u32 v29, v20, v21, v29
    v_max3_u32 v29, v22, v23, v29
    v_max3_u32 v29, v24, v25, v29
    v_max3_u32 v29, v26, v27, v29
    v_max3_u32 v29, v40, v41, v29
    v_max3_u32 v29, v42, v43, v29
    v_max3_u32 v29, v44, v45, v29
    v_max3_u32 v29, v46, v47, v29
    v_max3_u32 v29, v48, v49, v29
    v_max3_u32 v29, v50, v51, v29
    v_max3_u32 v29, v52, v53, v29
    v_max3_u32 v29, v54, v55, v29
    v_max3_u32 v29, v56, v57, v29
    v_max3_u32 v29, v58, v59, v29
    v_cmp_eq_u32 vcc, -1, v29
    s_add_u32 s100, s100, 1
    s_cmp_ge_u32 s100, 262144
    s_cbranch_scc1 Lsu_x
    s_cbranch_vccnz Lsu
Lsu_x:
    s_sub_u32 s5, s43, 5
    v_mad_u32_u24 v28, v1, 3, s5
    v_min_u32 v28, 159, v28
    v_lshlrev_b32 v28, 7, v28
    v_add_f32 v8, v8, v40
    v_add_f32 v9, v9, v41
    v_add_f32 v10, v10, v42
    v_add_f32 v11, v11, v43
    v_add_f32 v12, v12, v44
    v_add_f32 v13, v13, v45
    v_add_f32 v14, v14, v46
    v_add_f32 v15, v15, v47
    v_add_f32 v16, v16, v48
    v_add_f32 v17, v17, v49
    v_add_f32 v18, v18, v50
    v_add_f32 v19, v19, v51
    v_add_f32 v20, v20, v52
    v_add_f32 v21, v21, v53
    v_add_f32 v22, v22, v54
    v_add_f32 v23, v23, v55
    v_add_f32 v24, v24, v56
    v_add_f32 v25, v25, v57
    v_add_f32 v26, v26, v58
    v_add_f32 v27, v27, v59
    global_load_dwordx4 a[128:131], v4, s[8:9] offset:0 sc1
    global_load_dwordx4 a[132:135], v7, s[14:15] offset:0 sc1
    global_load_dwordx4 a[136:139], v4, s[8:9] offset:1024 sc1
    global_load_dwordx4 a[140:143], v7, s[14:15] offset:1024 sc1
    global_load_dwordx4 a[144:147], v4, s[8:9] offset:2048 sc1
    global_load_dwordx4 a[148:151], v7, s[14:15] offset:2048 sc1
    global_load_dwordx4 a[152:155], v4, s[8:9] offset:3072 sc1
    global_load_dwordx4 a[156:159], v7, s[14:15] offset:3072 sc1
    global_load_dwordx4 a[160:163], v4, s[10:11] offset:-4096 sc1
    global_load_dwordx4 a[164:167], v7, s[16:17] offset:-4096 sc1
    global_load_dwordx4 a[168:171], v4, s[10:11] offset:-3072 sc1
    global_load_dwordx4 a[172:175], v7, s[16:17] offset:-3072 sc1
    global_load_dwordx4 a[176:179], v4, s[10:11] offset:-2048 sc1
    global_load_dwordx4 a[180:183], v7, s[16:17] offset:-2048 sc1
    global_load_dwordx4 a[184:187], v4, s[10:11] offset:-1024 sc1
    global_load_dwordx4 a[188:191], v7, s[16:17] offset:-1024 sc1
    global_load_dwordx4 a[192:195], v4, s[10:11] offset:0 sc1
    global_load_dwordx4 a[196:199], v7, s[16:17] offset:0 sc1
    global_load_dwordx4 a[200:203], v4, s[10:11] offset:1024 sc1
    global_load_dwordx4 a[204:207], v7, s[16:17] offset:1024 sc1
    global_load_dwordx4 a[208:211], v4, s[10:11] offset:2048 sc1
    global_load_dwordx4 a[212:215], v7, s[16:17] offset:2048 sc1
    global_load_dwordx4 a[216:219], v4, s[10:11] offset:3072 sc1
    global_load_dwordx4 a[220:223], v7, s[16:17] offset:3072 sc1
    global_load_dwordx4 a[224:227], v4, s[12:13] offset:-4096 sc1
    global_load_dwordx4 a[228:231], v7, s[18:19] offset:-4096 sc1
    global_load_dwordx4 a[232:235], v4, s[12:13] offset:-3072 sc1
    global_load_dwordx4 a[236:239], v7, s[18:19] offset:-3072 sc1
    global_load_dwordx4 a[240:243], v4, s[12:13] offset:-2048 sc1
    global_load_dwordx4 a[244:247], v7, s[18:19] offset:-2048 sc1
    global_load_dwordx4 a[248:251], v4, s[12:13] offset:-1024 sc1
    global_load_dwordx4 a[252:255], v7, s[18:19] offset:-1024 sc1
    s_mul_i32 s4, s96, 20480
    s_add_u32 s4, s4, 8486912
    v_add_u32 v29, s4, v28
    global_load_dword v32, v29, s[38:39] sc1
    s_mul_i32 s4, s97, 20480
    s_add_u32 s4, s4, 8486912
    v_add_u32 v29, s4, v28
    global_load_dword v33, v29, s[38:39] sc1
    v_mov_b32 v60, -1
    v_mov_b32 v61, -1
    v_mov_b32 v62, -1
    v_mov_b32 v63, -1
    s_lshl_b32 s4, s41, 5
    s_add_u32 s4, s4, s40
    s_mul_i32 s4, s4, 14336
    s_lshl_b32 s5, s3, 12
    s_min_u32 s5, s5, 10240
    s_add_u32 s4, s4, s5
    s_add_u32 s4, s4, 12582912
    v_add_u32 v28, s4, v4
    global_store_dwordx4 v28, v[60:63], s[38:39] offset:0 sc1
    global_store_dwordx4 v28, v[60:63], s[38:39] offset:1024 sc1
    global_store_dwordx4 v28, v[60:63], s[38:39] offset:2048 sc1
    global_store_dwordx4 v28, v[60:63], s[38:39] offset:3072 sc1
    s_lshl_b32 s4, s40, 2
    s_add_u32 s4, s4, s3
    s_mul_i32 s4, s4, 28
    s_mul_i32 s5, s41, 7
    s_lshr_b32 s5, s5, 1
    s_add_u32 s4, s4, s5
    s_lshl_b32 s4, s4, 10
    s_add_u32 s4, s4, 16252928
    v_add_u32 v28, s4, v4
    global_store_dwordx4 v28, v[60:63], s[38:39] offset:0 sc1
    global_store_dwordx4 v28, v[60:63], s[38:39] offset:1024 sc1
    global_store_dwordx4 v28, v[60:63], s[38:39] offset:2048 sc1
    global_store_dwordx4 v28, v[60:63], s[38:39] offset:3072 sc1
    s_lshl_b32 s4, s40, 3
    s_add_u32 s4, s4, s41
    s_lshl_b32 s4, s4, 2
    s_add_u32 s4, s4, s3
    s_lshl_b32 s4, s4, 7
    s_add_u32 s4, s4, 12451840
    v_and_b32 v28, 112, v4
    v_add_u32 v28, s4, v28
    global_store_dwordx4 v28, v[60:63], s[38:39] sc1
    s_branch Lss_f
Lss:
    s_sleep 4
Lss_f:
    v_min_u32 v28, 624, v4
    v_add_u32 v28, 98560, v28
    global_load_dwordx4 v[40:43], v28, s[38:39] sc1
    s_waitcnt vmcnt(0)
    v_max_u32 v29, v40, v41
    v_max3_u32 v29, v42, v43, v29
    v_cmp_eq_u32 vcc, -1, v29
    s_add_u32 s100, s100, 1
    s_cmp_ge_u32 s100, 262144
    s_cbranch_scc1 Lss_x
    s_cbranch_vccnz Lss
Lss_x:
    s_barrier
    s_branch Ljoin
Lconv:
    s_and_b32 s4, s42, 15
    s_lshl_b32 s4, s4, 2
    s_add_u32 s4, s4, s3
    s_mul_i32 s4, s4, 40960
    s_lshr_b32 s5, s42, 4
    s_lshl_b32 s6, s5, 7
    s_add_u32 s4, s4, s6
    v_mul_u32_u24 v38, 10240, v3
    v_lshl_add_u32 v38, v2, 3, v38
    v_add_u32 v38, s4, v38
    v_add_u32 v39, 5120, v38
    global_load_dwordx2 v[48:49], v38, s[10:11] offset:0
    global_load_dwordx2 v[50:51], v38, s[10:11] offset:1280
    global_load_dwordx2 v[52:53], v38, s[10:11] offset:2560
    global_load_dwordx2 v[54:55], v38, s[10:11] offset:3840
    global_load_dwordx2 v[56:57], v39, s[10:11] offset:0
    global_load_dwordx2 v[58:59], v39, s[10:11] offset:1280
    global_load_dwordx2 v[60:61], v39, s[10:11] offset:2560
    global_load_dwordx2 v[62:63], v39, s[10:11] offset:3840
    v_max_u32 v40, 3840, v38
    global_load_dwordx2 v[42:43], v40, s[10:11] offset:-3840
    global_load_dwordx2 v[44:45], v40, s[10:11] offset:-2560
    global_load_dwordx2 v[46:47], v40, s[10:11] offset:-1280
    s_lshl_b32 s5, s5, 9
    v_lshl_add_u32 v40, v2, 5, s5
    global_load_dwordx4 v[80:83], v40, s[14:15] offset:0
    global_load_dwordx4 v[84:87], v40, s[14:15] offset:16
    global_load_dwordx2 v[64:65], v38, s[12:13] offset:0 nt
    global_load_dwordx2 v[66:67], v38, s[12:13] offset:1280 nt
    global_load_dwordx2 v[68:69], v38, s[12:13] offset:2560 nt
    global_load_dwordx2 v[70:71], v38, s[12:13] offset:3840 nt
    global_load_dwordx2 v[72:73], v39, s[12:13] offset:0 nt
    global_load_dwordx2 v[74:75], v39, s[12:13] offset:1280 nt
    global_load_dwordx2 v[76:77], v39, s[12:13] offset:2560 nt
    global_load_dwordx2 v[78:79], v39, s[12:13] offset:3840 nt
    s_lshl_b32 s7, s42, 3
    s_load_dwordx2 s[92:93], s[18:19], s7
    v_mov_b32 v148, 0
    v_mov_b32 v149, 0
    v_mov_b32 v150, 0
    v_mov_b32 v151, 0
    s_mul_i32 s5, s3, 8448
    v_and_b32 v28, 48, v4
    v_add_u32 v28, s5, v28
    ds_write_b128 v28, v[148:151] offset:0
    ds_write_b128 v28, v[148:151] offset:4224
    v_min_u32 v28, 448, v4
    s_mul_i32 s4, s3, 9280
    v_add_u32 v28, s4, v28
    ds_write_b128 v28, v[148:151] offset:37888
    ds_write_b128 v28, v[148:151] offset:42528
    v_add_u32 v31, s5, v4
    v_and_b32 v28, 1, v2
    v_lshrrev_b32 v29, 1, v2
    v_mul_u32_u24 v30, 4224, v28
    v_lshl_add_u32 v30, v29, 3, v30
    v_lshl_add_u32 v30, v3, 4, v30
    v_add_u32 v30, s5, v30
    v_mul_u32_u24 v32, 4640, v28
    v_lshlrev_b32 v29, 6, v29
    v_sub_u32 v32, v32, v29
    v_lshl_add_u32 v32, v3, 4, v32
    s_add_u32 s4, s4, 34256
    v_add_u32 v32, s4, v32
    v_lshl_add_u32 v34, v28, 2, v29
    v_lshl_add_u32 v34, v3, 4, v34
    s_mul_i32 s4, s3, 1056
    s_add_u32 s4, s4, 0
    v_add_u32 v34, s4, v34
    v_lshlrev_b32 v28, 2, v0
    v_sub_u32 v33, 34824, v28
    v_add_u32 v35, 0, v28
    s_lshl_b32 s4, s42, 14
    s_add_u32 s4, s4, 1052672
    v_lshl_add_u32 v36, v0, 4, s4
    v_lshrrev_b32 v28, 5, v0
    v_mul_u32_u24 v37, 81920, v28
    v_and_b32 v28, 31, v0
    v_lshl_add_u32 v37, v28, 4, v37
    s_lshl_b32 s4, s42, 9
    s_add_u32 s4, s4, 4194304
    v_add_u32 v37, s4, v37
    s_waitcnt lgkmcnt(0)
    s_lshl_b32 s52, s92, 16
    s_lshr_b32 s56, s52, 16
    s_and_b32 s53, s92, 0xffff0000
    s_lshr_b32 s57, s53, 16
    s_lshl_b32 s54, s93, 16
    s_lshr_b32 s58, s54, 16
    s_and_b32 s55, s93, 0xffff0000
    s_lshr_b32 s59, s55, 16
    v_and_b32 v203, 7, v1
    v_lshrrev_b32 v204, 3, v1
    s_lshl_b32 s4, s42, 2
    s_add_u32 s4, s4, s3
    s_lshl_b32 s94, s4, 12
    v_add_u32 v28, s94, v4
    s_mul_i32 s5, s3, 8448
    s_add_u32 m0, s5, 4288
    s_nop 0
    global_load_lds_dwordx4 v28, s[16:17] offset:0 nt
    global_load_lds_dwordx4 v28, s[16:17] offset:1024 nt
    global_load_lds_dwordx4 v28, s[16:17] offset:2048 nt
    global_load_lds_dwordx4 v28, s[16:17] offset:3072 nt
    s_waitcnt vmcnt(24)
    v_lshlrev_b32 v116, 16, v48
    v_and_b32 v117, 0xffff0000, v48
    v_lshlrev_b32 v118, 16, v49
    v_and_b32 v119, 0xffff0000, v49
    s_waitcnt vmcnt(23)
    v_lshlrev_b32 v120, 16, v50
    v_and_b32 v121, 0xffff0000, v50
    v_lshlrev_b32 v122, 16, v51
    v_and_b32 v123, 0xffff0000, v51
    s_waitcnt vmcnt(22)
    v_lshlrev_b32 v124, 16, v52
    v_and_b32 v125, 0xffff0000, v52
    v_lshlrev_b32 v126, 16, v53
    v_and_b32 v127, 0xffff0000, v53
    s_waitcnt vmcnt(21)
    v_lshlrev_b32 v128, 16, v54
    v_and_b32 v129, 0xffff0000, v54
    v_lshlrev_b32 v130, 16, v55
    v_and_b32 v131, 0xffff0000, v55
    s_waitcnt vmcnt(20)
    v_lshlrev_b32 v132, 16, v56
    v_and_b32 v133, 0xffff0000, v56
    v_lshlrev_b32 v134, 16, v57
    v_and_b32 v135, 0xffff0000, v57
    s_waitcnt vmcnt(19)
    v_lshlrev_b32 v136, 16, v58
    v_and_b32 v137, 0xffff0000, v58
    v_lshlrev_b32 v138, 16, v59
    v_and_b32 v139, 0xffff0000, v59
    s_waitcnt vmcnt(18)
    v_lshlrev_b32 v140, 16, v60
    v_and_b32 v141, 0xffff0000, v60
    v_lshlrev_b32 v142, 16, v61
    v_and_b32 v143, 0xffff0000, v61
    s_waitcnt vmcnt(17)
    v_lshlrev_b32 v144, 16, v62
    v_and_b32 v145, 0xffff0000, v62
    v_lshlrev_b32 v146, 16, v63
    v_and_b32 v147, 0xffff0000, v63
    s_lshl_b32 s4, s42, 2
    s_add_u32 s4, s4, s3
    s_mul_i32 s4, s4, 5120
    s_cmp_lt_u32 s42, 128
    s_cselect_b32 s5, -1, 0
    v_add_u32 v201, s4, v4
    v_and_b32 v201, s5, v201
    v_add_u32 v201, 2048, v201
    global_load_dwordx4 v[180:183], v201, s[8:9] offset:-2048 nt
    global_load_dwordx4 v[184:187], v201, s[8:9] offset:-1024 nt
    global_load_dwordx4 v[188:191], v201, s[8:9] offset:0 nt
    global_load_dwordx4 v[192:195], v201, s[8:9] offset:1024 nt
    global_load_dwordx4 v[196:199], v201, s[8:9] offset:2048 nt
    v_cmp_le_u32 vcc, 1280, v38
    s_waitcnt vmcnt(21)
    s_nop 0
    v_cndmask_b32 v42, 0, v42, vcc
    v_cndmask_b32 v43, 0, v43, vcc
    s_waitcnt vmcnt(20)
    v_cndmask_b32 v44, 0, v44, vcc
    v_cndmask_b32 v45, 0, v45, vcc
    s_waitcnt vmcnt(19)
    v_cndmask_b32 v46, 0, v46, vcc
    v_cndmask_b32 v47, 0, v47, vcc
    v_lshlrev_b32 v104, 16, v42
    v_and_b32 v105, 0xffff0000, v42
    v_lshlrev_b32 v106, 16, v43
    v_and_b32 v107, 0xffff0000, v43
    v_lshlrev_b32 v108, 16, v44
    v_and_b32 v109, 0xffff0000, v44
    v_lshlrev_b32 v110, 16, v45
    v_and_b32 v111, 0xffff0000, v45
    v_lshlrev_b32 v112, 16, v46
    v_and_b32 v113, 0xffff0000, v46
    v_lshlrev_b32 v114, 16, v47
    v_and_b32 v115, 0xffff0000, v47
    s_waitcnt vmcnt(18)
    v_lshlrev_b32 v88, 16, v80
    v_and_b32 v92, 0xffff0000, v80
    v_lshlrev_b32 v96, 16, v81
    v_and_b32 v100, 0xffff0000, v81
    v_lshlrev_b32 v89, 16, v82
    v_and_b32 v93, 0xffff0000, v82
    v_lshlrev_b32 v97, 16, v83
    v_and_b32 v101, 0xffff0000, v83
    s_waitcnt vmcnt(17)
    v_lshlrev_b32 v90, 16, v84
    v_and_b32 v94, 0xffff0000, v84
    v_lshlrev_b32 v98, 16, v85
    v_and_b32 v102, 0xffff0000, v85
    v_lshlrev_b32 v91, 16, v86
    v_and_b32 v95, 0xffff0000, v86
    v_lshlrev_b32 v99, 16, v87
    v_and_b32 v103, 0xffff0000, v87
    v_pk_mul_f32 v[148:149], v[116:117], v[88:89] op_sel:[0,0] op_sel_hi:[1,1]
    v_pk_mul_f32 v[150:151], v[118:119], v[90:91] op_sel:[0,0] op_sel_hi:[1,1]
    v_pk_mul_f32 v[152:153], v[120:121], v[88:89] op_sel:[0,0] op_sel_hi:[1,1]
    v_pk_mul_f32 v[154:155], v[122:123], v[90:91] op_sel:[0,0] op_sel_hi:[1,1]
    v_pk_mul_f32 v[156:157], v[124:125], v[88:89] op_sel:[0,0] op_sel_hi:[1,1]
    v_pk_mul_f32 v[158:159], v[126:127], v[90:91] op_sel:[0,0] op_sel_hi:[1,1]
    v_pk_mul_f32 v[160:161], v[128:129], v[88:89] op_sel:[0,0] op_sel_hi:[1,1]
    v_pk_mul_f32 v[162:163], v[130:131], v[90:91] op_sel:[0,0] op_sel_hi:[1,1]
    v_pk_mul_f32 v[164:165], v[132:133], v[88:89] op_sel:[0,0] op_sel_hi:[1,1]
    v_pk_mul_f32 v[166:167], v[134:135], v[90:91] op_sel:[0,0] op_sel_hi:[1,1]
    v_pk_mul_f32 v[168:169], v[136:137], v[88:89] op_sel:[0,0] op_sel_hi:[1,1]
    v_pk_mul_f32 v[170:171], v[138:139], v[90:91] op_sel:[0,0] op_sel_hi:[1,1]
    v_pk_mul_f32 v[172:173], v[140:141], v[88:89] op_sel:[0,0] op_sel_hi:[1,1]
    v_pk_mul_f32 v[174:175], v[142:143], v[90:91] op_sel:[0,0] op_sel_hi:[1,1]
    v_pk_mul_f32 v[176:177], v[144:145], v[88:89] op_sel:[0,0] op_sel_hi:[1,1]
    v_pk_mul_f32 v[178:179], v[146:147], v[90:91] op_sel:[0,0] op_sel_hi:[1,1]
    v_pk_fma_f32 v[148:149], v[112:113], v[92:93], v[148:149] op_sel:[0,0,0] op_sel_hi:[1,1,1]
    v_pk_fma_f32 v[150:151], v[114:115], v[94:95], v[150:151] op_sel:[0,0,0] op_sel_hi:[1,1,1]
    v_pk_fma_f32 v[152:153], v[116:117], v[92:93], v[152:153] op_sel:[0,0,0] op_sel_hi:[1,1,1]
    v_pk_fma_f32 v[154:155], v[118:119], v[94:95], v[154:155] op_sel:[0,0,0] op_sel_hi:[1,1,1]
    v_pk_fma_f32 v[156:157], v[120:121], v[92:93], v[156:157] op_sel:[0,0,0] op_sel_hi:[1,1,1]
    v_pk_fma_f32 v[158:159], v[122:123], v[94:95], v[158:159] op_sel:[0,0,0] op_sel_hi:[1,1,1]
    v_pk_fma_f32 v[160:161], v[124:125], v[92:93], v[160:161] op_sel:[0,0,0] op_sel_hi:[1,1,1]
    v_pk_fma_f32 v[162:163], v[126:127], v[94:95], v[162:163] op_sel:[0,0,0] op_sel_hi:[1,1,1]
    v_pk_fma_f32 v[164:165], v[128:129], v[92:93], v[164:165] op_sel:[0,0,0] op_sel_hi:[1,1,1]
    v_pk_fma_f32 v[166:167], v[130:131], v[94:95], v[166:167] op_sel:[0,0,0] op_sel_hi:[1,1,1]
    v_pk_fma_f32 v[168:169], v[132:133], v[92:93], v[168:169] op_sel:[0,0,0] op_sel_hi:[1,1,1]
    v_pk_fma_f32 v[170:171], v[134:135], v[94:95], v[170:171] op_sel:[0,0,0] op_sel_hi:[1,1,1]
    v_pk_fma_f32 v[172:173], v[136:137], v[92:93], v[172:173] op_sel:[0,0,0] op_sel_hi:[1,1,1]
    v_pk_fma_f32 v[174:175], v[138:139], v[94:95], v[174:175] op_sel:[0,0,0] op_sel_hi:[1,1,1]
    v_pk_fma_f32 v[176:177], v[140:141], v[92:93], v[176:177] op_sel:[0,0,0] op_sel_hi:[1,1,1]
    v_pk_fma_f32 v[178:179], v[142:143], v[94:95], v[178:179] op_sel:[0,0,0] op_sel_hi:[1,1,1]
    v_pk_fma_f32 v[148:149], v[108:109], v[96:97], v[148:149] op_sel:[0,0,0] op_sel_hi:[1,1,1]
    v_pk_fma_f32 v[150:151], v[110:111], v[98:99], v[150:151] op_sel:[0,0,0] op_sel_hi:[1,1,1]
    v_pk_fma_f32 v[152:153], v[112:113], v[96:97], v[152:153] op_sel:[0,0,0] op_sel_hi:[1,1,1]
    v_pk_fma_f32 v[154:155], v[114:115], v[98:99], v[154:155] op_sel:[0,0,0] op_sel_hi:[1,1,1]
    v_pk_fma_f32 v[156:157], v[116:117], v[96:97], v[156:157] op_sel:[0,0,0] op_sel_hi:[1,1,1]
    v_pk_fma_f32 v[158:159], v[118:119], v[98:99], v[158:159] op_sel:[0,0,0] op_sel_hi:[1,1,1]
    v_pk_fma_f32 v[160:161], v[120:121], v[96:97], v[160:161] op_sel:[0,0,0] op_sel_hi:[1,1,1]
    v_pk_fma_f32 v[162:163], v[122:123], v[98:99], v[162:163] op_sel:[0,0,0] op_sel_hi:[1,1,1]
    v_pk_fma_f32 v[164:165], v[124:125], v[96:97], v[164:165] op_sel:[0,0,0] op_sel_hi:[1,1,1]
    v_pk_fma_f32 v[166:167], v[126:127], v[98:99], v[166:167] op_sel:[0,0,0] op_sel_hi:[1,1,1]
    v_pk_fma_f32 v[168:169], v[128:129], v[96:97], v[168:169] op_sel:[0,0,0] op_sel_hi:[1,1,1]
    v_pk_fma_f32 v[170:171], v[130:131], v[98:99], v[170:171] op_sel:[0,0,0] op_sel_hi:[1,1,1]
    v_pk_fma_f32 v[172:173], v[132:133], v[96:97], v[172:173] op_sel:[0,0,0] op_sel_hi:[1,1,1]
    v_pk_fma_f32 v[174:175], v[134:135], v[98:99], v[174:175] op_sel:[0,0,0] op_sel_hi:[1,1,1]
    v_pk_fma_f32 v[176:177], v[136:137], v[96:97], v[176:177] op_sel:[0,0,0] op_sel_hi:[1,1,1]
    v_pk_fma_f32 v[178:179], v[138:139], v[98:99], v[178:179] op_sel:[0,0,0] op_sel_hi:[1,1,1]
    v_pk_fma_f32 v[148:149], v[104:105], v[100:101], v[148:149] op_sel:[0,0,0] op_sel_hi:[1,1,1]
    v_pk_fma_f32 v[150:151], v[106:107], v[102:103], v[150:151] op_sel:[0,0,0] op_sel_hi:[1,1,1]
    v_pk_fma_f32 v[152:153], v[108:109], v[100:101], v[152:153] op_sel:[0,0,0] op_sel_hi:[1,1,1]
    v_pk_fma_f32 v[154:155], v[110:111], v[102:103], v[154:155] op_sel:[0,0,0] op_sel_hi:[1,1,1]
    v_pk_fma_f32 v[156:157], v[112:113], v[100:101], v[156:157] op_sel:[0,0,0] op_sel_hi:[1,1,1]
    v_pk_fma_f32 v[158:159], v[114:115], v[102:103], v[158:159] op_sel:[0,0,0] op_sel_hi:[1,1,1]
    v_pk_fma_f32 v[160:161], v[116:117], v[100:101], v[160:161] op_sel:[0,0,0] op_sel_hi:[1,1,1]
    v_pk_fma_f32 v[162:163], v[118:119], v[102:103], v[162:163] op_sel:[0,0,0] op_sel_hi:[1,1,1]
    v_pk_fma_f32 v[164:165], v[120:121], v[100:101], v[164:165] op_sel:[0,0,0] op_sel_hi:[1,1,1]
    v_pk_fma_f32 v[166:167], v[122:123], v[102:103], v[166:167] op_sel:[0,0,0] op_sel_hi:[1,1,1]
    v_pk_fma_f32 v[168:169], v[124:125], v[100:101], v[168:169] op_sel:[0,0,0] op_sel_hi:[1,1,1]
    v_pk_fma_f32 v[170:171], v[126:127], v[102:103], v[170:171] op_sel:[0,0,0] op_sel_hi:[1,1,1]
    v_pk_fma_f32 v[172:173], v[128:129], v[100:101], v[172:173] op_sel:[0,0,0] op_sel_hi:[1,1,1]
    v_pk_fma_f32 v[174:175], v[130:131], v[102:103], v[174:175] op_sel:[0,0,0] op_sel_hi:[1,1,1]
    v_pk_fma_f32 v[176:177], v[132:133], v[100:101], v[176:177] op_sel:[0,0,0] op_sel_hi:[1,1,1]
    v_pk_fma_f32 v[178:179], v[134:135], v[102:103], v[178:179] op_sel:[0,0,0] op_sel_hi:[1,1,1]
    s_lshl_b32 s4, s3, 6
    s_sub_u32 s4, 104688, s4
    v_mul_u32_u24 v40, 272, v2
    v_add_u32 v40, s4, v40
    v_lshlrev_b32 v39, 4, v3
    v_sub_u32 v40, v40, v39
    s_waitcnt vmcnt(16)
    v_lshlrev_b32 v104, 16, v64
    v_and_b32 v105, 0xffff0000, v64
    v_lshlrev_b32 v106, 16, v65
    v_and_b32 v107, 0xffff0000, v65
    v_pk_mul_f32 v[148:149], v[148:149], v[104:105] op_sel:[0,0] op_sel_hi:[1,1]
    v_pk_mul_f32 v[150:151], v[150:151], v[106:107] op_sel:[0,0] op_sel_hi:[1,1]
    s_waitcnt vmcnt(15)
    v_lshlrev_b32 v108, 16, v66
    v_and_b32 v109, 0xffff0000, v66
    v_lshlrev_b32 v110, 16, v67
    v_and_b32 v111, 0xffff0000, v67
    v_pk_mul_f32 v[152:153], v[152:153], v[108:109] op_sel:[0,0] op_sel_hi:[1,1]
    v_pk_mul_f32 v[154:155], v[154:155], v[110:111] op_sel:[0,0] op_sel_hi:[1,1]
    s_waitcnt vmcnt(14)
    v_lshlrev_b32 v112, 16, v68
    v_and_b32 v113, 0xffff0000, v68
    v_lshlrev_b32 v114, 16, v69
    v_and_b32 v115, 0xffff0000, v69
    v_pk_mul_f32 v[156:157], v[156:157], v[112:113] op_sel:[0,0] op_sel_hi:[1,1]
    v_pk_mul_f32 v[158:159], v[158:159], v[114:115] op_sel:[0,0] op_sel_hi:[1,1]
    s_waitcnt vmcnt(13)
    v_lshlrev_b32 v116, 16, v70
    v_and_b32 v117, 0xffff0000, v70
    v_lshlrev_b32 v118, 16, v71
    v_and_b32 v119, 0xffff0000, v71
    v_pk_mul_f32 v[160:161], v[160:161], v[116:117] op_sel:[0,0] op_sel_hi:[1,1]
    v_pk_mul_f32 v[162:163], v[162:163], v[118:119] op_sel:[0,0] op_sel_hi:[1,1]
    s_waitcnt vmcnt(12)
    v_lshlrev_b32 v120, 16, v72
    v_and_b32 v121, 0xffff0000, v72
    v_lshlrev_b32 v122, 16, v73
    v_and_b32 v123, 0xffff0000, v73
    v_pk_mul_f32 v[164:165], v[164:165], v[120:121] op_sel:[0,0] op_sel_hi:[1,1]
    v_pk_mul_f32 v[166:167], v[166:167], v[122:123] op_sel:[0,0] op_sel_hi:[1,1]
    s_waitcnt vmcnt(11)
    v_lshlrev_b32 v124, 16, v74
    v_and_b32 v125, 0xffff0000, v74
    v_lshlrev_b32 v126, 16, v75
    v_and_b32 v127, 0xffff0000, v75
    v_pk_mul_f32 v[168:169], v[168:169], v[124:125] op_sel:[0,0] op_sel_hi:[1,1]
    v_pk_mul_f32 v[170:171], v[170:171], v[126:127] op_sel:[0,0] op_sel_hi:[1,1]
    s_waitcnt vmcnt(10)
    v_lshlrev_b32 v128, 16, v76
    v_and_b32 v129, 0xffff0000, v76
    v_lshlrev_b32 v130, 16, v77
    v_and_b32 v131, 0xffff0000, v77
    v_pk_mul_f32 v[172:173], v[172:173], v[128:129] op_sel:[0,0] op_sel_hi:[1,1]
    v_pk_mul_f32 v[174:175], v[174:175], v[130:131] op_sel:[0,0] op_sel_hi:[1,1]
    s_waitcnt vmcnt(9)
    v_lshlrev_b32 v132, 16, v78
    v_and_b32 v133, 0xffff0000, v78
    v_lshlrev_b32 v134, 16, v79
    v_and_b32 v135, 0xffff0000, v79
    v_pk_mul_f32 v[176:177], v[176:177], v[132:133] op_sel:[0,0] op_sel_hi:[1,1]
    v_pk_mul_f32 v[178:179], v[178:179], v[134:135] op_sel:[0,0] op_sel_hi:[1,1]
    v_cvt_pk_bf16_f32 v88, v176, v172
    v_cvt_pk_bf16_f32 v89, v168, v164
    v_cvt_pk_bf16_f32 v90, v160, v156
    v_cvt_pk_bf16_f32 v91, v152, v148
    ds_write_b128 v40, v[88:91] offset:0
    v_cvt_pk_bf16_f32 v92, v177, v173
    v_cvt_pk_bf16_f32 v93, v169, v165
    v_cvt_pk_bf16_f32 v94, v161, v157
    v_cvt_pk_bf16_f32 v95, v153, v149
    ds_write_b128 v40, v[92:95] offset:4352
    v_cvt_pk_bf16_f32 v96, v178, v174
    v_cvt_pk_bf16_f32 v97, v170, v166
    v_cvt_pk_bf16_f32 v98, v162, v158
    v_cvt_pk_bf16_f32 v99, v154, v150
    ds_write_b128 v40, v[96:99] offset:8704
    v_cvt_pk_bf16_f32 v100, v179, v175
    v_cvt_pk_bf16_f32 v101, v171, v167
    v_cvt_pk_bf16_f32 v102, v163, v159
    v_cvt_pk_bf16_f32 v103, v155, v151
    ds_write_b128 v40, v[100:103] offset:13056
    s_waitcnt lgkmcnt(0)
    s_barrier
    s_mul_i32 s4, s3, 4352
    s_add_u32 s4, s4, 104448
    v_mul_u32_u24 v40, 272, v3
    v_lshl_add_u32 v40, v2, 4, v40
    v_add_u32 v40, s4, v40
    ds_read_b128 v[148:151], v40 offset:0
    ds_read_b128 v[152:155], v40 offset:1088
    ds_read_b128 v[156:159], v40 offset:2176
    ds_read_b128 v[160:163], v40 offset:3264
    s_lshr_b32 s4, s42, 4
    s_lshl_b32 s4, s4, 6
    s_add_u32 s4, s4, s3
    s_lshl_b32 s4, s4, 12
    s_and_b32 s5, s42, 15
    s_lshl_b32 s5, s5, 8
    s_sub_u32 s4, s4, s5
    s_add_u32 s4, s4, 20975360
    v_lshl_add_u32 v38, v3, 14, s4
    v_lshl_add_u32 v38, v2, 4, v38
    s_waitcnt lgkmcnt(3)
    global_store_dwordx4 v38, v[148:151], s[38:39] sc1
    v_add_u32 v38, 65536, v38
    s_waitcnt lgkmcnt(2)
    global_store_dwordx4 v38, v[152:155], s[38:39] sc1
    v_add_u32 v38, 65536, v38
    s_waitcnt lgkmcnt(1)
    global_store_dwordx4 v38, v[156:159], s[38:39] sc1
    v_add_u32 v38, 65536, v38
    s_waitcnt lgkmcnt(0)
    global_store_dwordx4 v38, v[160:163], s[38:39] sc1
    v_min_u32 v212, 7, v1
    v_lshlrev_b32 v212, 2, v212
    global_load_dword v213, v212, s[36:37] sc1
    s_waitcnt vmcnt(10)
    ds_read_b128 v[74:77], v31 offset:4288
    ds_read_b32 v73, v31 offset:4284
    ds_read_b128 v[82:85], v31 offset:5312
    ds_read_b32 v81, v31 offset:5308
    ds_read_b128 v[90:93], v31 offset:6336
    ds_read_b32 v89, v31 offset:6332
    ds_read_b128 v[98:101], v31 offset:7360
    ds_read_b32 v97, v31 offset:7356
    s_waitcnt lgkmcnt(6)
    v_alignbit_b32 v104, v74, v73, 16
    v_alignbit_b32 v105, v75, v74, 16
    v_alignbit_b32 v106, v76, v75, 16
    v_alignbit_b32 v107, v77, v76, 16
    ds_write_b128 v31, v[104:107] offset:64
    s_waitcnt lgkmcnt(5)
    v_alignbit_b32 v108, v82, v81, 16
    v_alignbit_b32 v109, v83, v82, 16
    v_alignbit_b32 v110, v84, v83, 16
    v_alignbit_b32 v111, v85, v84, 16
    ds_write_b128 v31, v[108:111] offset:1088
    s_waitcnt lgkmcnt(4)
    v_alignbit_b32 v112, v90, v89, 16
    v_alignbit_b32 v113, v91, v90, 16
    v_alignbit_b32 v114, v92, v91, 16
    v_alignbit_b32 v115, v93, v92, 16
    ds_write_b128 v31, v[112:115] offset:2112
    s_waitcnt lgkmcnt(3)
    v_alignbit_b32 v116, v98, v97, 16
    v_alignbit_b32 v117, v99, v98, 16
    v_alignbit_b32 v118, v100, v99, 16
    v_alignbit_b32 v119, v101, v100, 16
    ds_write_b128 v31, v[116:119] offset:3136
    ds_read_b64 a[0:1], v30 offset:8
    ds_read_b64 a[2:3], v30 offset:16
    ds_read_b64 a[4:5], v30 offset:72
    ds_read_b64 a[6:7], v30 offset:80
    ds_read_b64 a[8:9], v30 offset:136
    ds_read_b64 a[10:11], v30 offset:144
    ds_read_b64 a[12:13], v30 offset:200
    ds_read_b64 a[14:15], v30 offset:208
    ds_read_b64 a[16:17], v30 offset:264
    ds_read_b64 a[18:19], v30 offset:272
    ds_read_b64 a[20:21], v30 offset:328
    ds_read_b64 a[22:23], v30 offset:336
    ds_read_b64 a[24:25], v30 offset:392
    ds_read_b64 a[26:27], v30 offset:400
    ds_read_b64 a[28:29], v30 offset:456
    ds_read_b64 a[30:31], v30 offset:464
    ds_read_b64 a[32:33], v30 offset:520
    ds_read_b64 a[34:35], v30 offset:528
    ds_read_b64 a[36:37], v30 offset:584
    ds_read_b64 a[38:39], v30 offset:592
    ds_read_b64 a[40:41], v30 offset:648
    ds_read_b64 a[42:43], v30 offset:656
    ds_read_b64 a[44:45], v30 offset:712
    ds_read_b64 a[46:47], v30 offset:720
    ds_read_b64 a[48:49], v30 offset:776
    ds_read_b64 a[50:51], v30 offset:784
    ds_read_b64 a[52:53], v30 offset:840
    ds_read_b64 a[54:55], v30 offset:848
    ds_read_b64 a[56:57], v30 offset:904
    ds_read_b64 a[58:59], v30 offset:912
    ds_read_b64 a[60:61], v30 offset:968
    ds_read_b64 a[62:63], v30 offset:976
    ds_read_b64 a[64:65], v30 offset:1032
    ds_read_b64 a[66:67], v30 offset:1040
    ds_read_b64 a[68:69], v30 offset:1096
    ds_read_b64 a[70:71], v30 offset:1104
    ds_read_b64 a[72:73], v30 offset:1160
    ds_read_b64 a[74:75], v30 offset:1168
    ds_read_b64 a[76:77], v30 offset:1224
    ds_read_b64 a[78:79], v30 offset:1232
    ds_read_b64 a[80:81], v30 offset:1288
    ds_read_b64 a[82:83], v30 offset:1296
    ds_read_b64 a[84:85], v30 offset:1352
    ds_read_b64 a[86:87], v30 offset:1360
    ds_read_b64 a[88:89], v30 offset:1416
    ds_read_b64 a[90:91], v30 offset:1424
    ds_read_b64 a[92:93], v30 offset:1480
    ds_read_b64 a[94:95], v30 offset:1488
    s_mul_i32 s5, s3, 5152
    s_add_u32 s5, s5, 122880
    v_add_u32 v201, s5, v4
    v_lshrrev_b32 v202, 5, v1
    v_lshl_add_u32 v202, v202, 4, v201
    s_waitcnt vmcnt(9)
    ds_write_b128 v201, v[180:183] offset:0
    s_waitcnt vmcnt(8)
    ds_write_b128 v201, v[184:187] offset:1024
    s_waitcnt vmcnt(7)
    ds_write_b128 v202, v[188:191] offset:2048
    s_waitcnt vmcnt(6)
    ds_write_b128 v201, v[192:195] offset:3088
    s_waitcnt vmcnt(5)
    ds_write_b128 v201, v[196:199] offset:4112
    s_lshl_b32 s4, s42, 7
    s_add_u32 s4, s4, 77824
    v_mov_b32 v28, s4
    v_mov_b32 v29, 0
    s_waitcnt vmcnt(0)
    v_cmp_eq_u32 vcc, 0, v213
    s_nop 0
    s_cbranch_vccnz Lic_r
Lic_ok:
    s_waitcnt lgkmcnt(0)
    s_barrier
    s_cmp_lg_u32 s3, 0
    s_cbranch_scc1 Lkf_skip
    global_store_dword v28, v29, s[38:39] sc1
Lkf_skip:
    s_cmp_ge_u32 s42, 128
    s_cbranch_scc1 Lc_m3
    v_mul_u32_u24 v201, 2576, v203
    v_lshl_add_u32 v201, v204, 3, v201
    s_mul_i32 s5, s3, 320
    s_add_u32 s5, s5, 122880
    v_add_u32 v201, s5, v201
    ds_read2_b64 v[180:183], v201 offset0:0 offset1:160
    ds_read2_b64 v[184:187], v201 offset0:8 offset1:168
    ds_read2_b64 v[188:191], v201 offset0:16 offset1:176
    ds_read2_b64 v[192:195], v201 offset0:24 offset1:184
    ds_read2_b64 v[196:199], v201 offset0:32 offset1:192
    s_mul_i32 s5, s3, 655360
    s_lshl_b32 s6, s42, 7
    s_add_u32 s5, s5, s6
    s_add_u32 s5, s5, 1048576
    v_lshl_add_u32 v200, v204, 14, s5
    v_lshl_add_u32 v200, v203, 4, v200
    s_mov_b32 s7, 0x3f803f80
    v_mov_b32 v208, 0
    v_mov_b32 v209, 0
    v_mov_b32 v210, 0
    v_mov_b32 v211, 0
    s_waitcnt lgkmcnt(4)
    global_store_dwordx4 v200, v[180:183], s[38:39] sc1
    v_add_u32 v200, 131072, v200
    s_waitcnt lgkmcnt(3)
    global_store_dwordx4 v200, v[184:187], s[38:39] sc1
    v_add_u32 v200, 131072, v200
    s_waitcnt lgkmcnt(2)
    global_store_dwordx4 v200, v[188:191], s[38:39] sc1
    v_add_u32 v200, 131072, v200
    s_waitcnt lgkmcnt(1)
    global_store_dwordx4 v200, v[192:195], s[38:39] sc1
    v_add_u32 v200, 131072, v200
    s_waitcnt lgkmcnt(0)
    global_store_dwordx4 v200, v[196:199], s[38:39] sc1
    v_dot2_f32_bf16 v208, v180, s7, v208
    v_dot2_f32_bf16 v209, v180, v180, v209
    v_dot2_f32_bf16 v210, v182, s7, v210
    v_dot2_f32_bf16 v211, v182, v182, v211
    v_dot2_f32_bf16 v208, v181, s7, v208
    v_dot2_f32_bf16 v209, v181, v181, v209
    v_dot2_f32_bf16 v210, v183, s7, v210
    v_dot2_f32_bf16 v211, v183, v183, v211
    v_dot2_f32_bf16 v208, v184, s7, v208
    v_dot2_f32_bf16 v209, v184, v184, v209
    v_dot2_f32_bf16 v210, v186, s7, v210
    v_dot2_f32_bf16 v211, v186, v186, v211
    v_dot2_f32_bf16 v208, v185, s7, v208
    v_dot2_f32_bf16 v209, v185, v185, v209
    v_dot2_f32_bf16 v210, v187, s7, v210
    v_dot2_f32_bf16 v211, v187, v187, v211
    v_dot2_f32_bf16 v208, v188, s7, v208
    v_dot2_f32_bf16 v209, v188, v188, v209
    v_dot2_f32_bf16 v210, v190, s7, v210
    v_dot2_f32_bf16 v211, v190, v190, v211
    v_dot2_f32_bf16 v208, v189, s7, v208
    v_dot2_f32_bf16 v209, v189, v189, v209
    v_dot2_f32_bf16 v210, v191, s7, v210
    v_dot2_f32_bf16 v211, v191, v191, v211
    v_dot2_f32_bf16 v208, v192, s7, v208
    v_dot2_f32_bf16 v209, v192, v192, v209
    v_dot2_f32_bf16 v210, v194, s7, v210
    v_dot2_f32_bf16 v211, v194, v194, v211
    v_dot2_f32_bf16 v208, v193, s7, v208
    v_dot2_f32_bf16 v209, v193, v193, v209
    v_dot2_f32_bf16 v210, v195, s7, v210
    v_dot2_f32_bf16 v211, v195, v195, v211
    v_dot2_f32_bf16 v208, v196, s7, v208
    v_dot2_f32_bf16 v209, v196, v196, v209
    v_dot2_f32_bf16 v210, v198, s7, v210
    v_dot2_f32_bf16 v211, v198, v198, v211
    v_dot2_f32_bf16 v208, v197, s7, v208
    v_dot2_f32_bf16 v209, v197, v197, v209
    v_dot2_f32_bf16 v210, v199, s7, v210
    v_dot2_f32_bf16 v211, v199, v199, v211
    s_nop 1
    v_permlane32_swap_b32 v208, v210
    v_permlane32_swap_b32 v209, v211
    v_add_f32 v208, v208, v210
    v_add_f32 v209, v209, v211
    s_nop 1
    v_permlane16_swap_b32 v208, v209
    v_add_f32 v208, v208, v209
    v_lshlrev_b32 v201, 4, v203
    v_lshl_add_u32 v201, v3, 2, v201
    v_add_f32_dpp v208, v208, v208 row_ror:8 row_mask:0xf bank_mask:0xf
    s_lshl_b32 s5, s3, 7
    s_add_u32 s5, s5, 143616
    v_add_u32 v201, s5, v201
    ds_write_b32 v201, v208
Lc_j3:
    s_and_b32 s4, s42, -16
    s_lshl_b32 s4, s4, 7
    s_add_u32 s4, s4, 77824
    v_lshl_add_u32 v29, v2, 7, s4
    ds_read_b64 a[96:97], v30 offset:1544
    ds_read_b64 a[98:99], v30 offset:1552
    ds_read_b64 a[100:101], v30 offset:1608
    ds_read_b64 a[102:103], v30 offset:1616
    ds_read_b64 a[104:105], v30 offset:1672
    ds_read_b64 a[106:107], v30 offset:1680
    ds_read_b64 a[108:109], v30 offset:1736
    ds_read_b64 a[110:111], v30 offset:1744
    ds_read_b64 a[112:113], v30 offset:1800
    ds_read_b64 a[114:115], v30 offset:1808
    ds_read_b64 a[116:117], v30 offset:1864
    ds_read_b64 a[118:119], v30 offset:1872
    ds_read_b64 a[120:121], v30 offset:1928
    ds_read_b64 a[122:123], v30 offset:1936
    ds_read_b64 a[124:125], v30 offset:1992
    ds_read_b64 a[126:127], v30 offset:2000
    ds_read_b64 a[128:129], v30 offset:2056
    ds_read_b64 a[130:131], v30 offset:2064
    ds_read_b64 a[132:133], v30 offset:2120
    ds_read_b64 a[134:135], v30 offset:2128
    ds_read_b64 a[136:137], v30 offset:2184
    ds_read_b64 a[138:139], v30 offset:2192
    ds_read_b64 a[140:141], v30 offset:2248
    ds_read_b64 a[142:143], v30 offset:2256
    ds_read_b64 a[144:145], v30 offset:2312
    ds_read_b64 a[146:147], v30 offset:2320
    ds_read_b64 a[148:149], v30 offset:2376
    ds_read_b64 a[150:151], v30 offset:2384
    ds_read_b64 a[152:153], v30 offset:2440
    ds_read_b64 a[154:155], v30 offset:2448
    ds_read_b64 a[156:157], v30 offset:2504
    ds_read_b64 a[158:159], v30 offset:2512
    ds_read_b64 a[160:161], v30 offset:2568
    ds_read_b64 a[162:163], v30 offset:2576
    ds_read_b64 a[164:165], v30 offset:2632
    ds_read_b64 a[166:167], v30 offset:2640
    ds_read_b64 a[168:169], v30 offset:2696
    ds_read_b64 a[170:171], v30 offset:2704
    ds_read_b64 a[172:173], v30 offset:2760
    ds_read_b64 a[174:175], v30 offset:2768
    global_load_dword v40, v29, s[38:39] sc1
    v_min_u32 v41, 49, v1
    v_lshlrev_b32 v41, 2, v41
    global_load_dword v42, v41, s[36:37] sc1
    ds_read_b64 a[176:177], v30 offset:2824
    ds_read_b64 a[178:179], v30 offset:2832
    ds_read_b64 a[180:181], v30 offset:2888
    ds_read_b64 a[182:183], v30 offset:2896
    ds_read_b64 a[184:185], v30 offset:2952
    ds_read_b64 a[186:187], v30 offset:2960
    ds_read_b64 a[188:189], v30 offset:3016
    ds_read_b64 a[190:191], v30 offset:3024
    ds_read_b64 a[192:193], v30 offset:3080
    ds_read_b64 a[194:195], v30 offset:3088
    ds_read_b64 a[196:197], v30 offset:3144
    ds_read_b64 a[198:199], v30 offset:3152
    ds_read_b64 a[200:201], v30 offset:3208
    ds_read_b64 a[202:203], v30 offset:3216
    ds_read_b64 a[204:205], v30 offset:3272
    ds_read_b64 a[206:207], v30 offset:3280
    ds_read_b64 a[208:209], v30 offset:3336
    ds_read_b64 a[210:211], v30 offset:3344
    ds_read_b64 a[212:213], v30 offset:3400
    ds_read_b64 a[214:215], v30 offset:3408
    ds_read_b64 a[216:217], v30 offset:3464
    ds_read_b64 a[218:219], v30 offset:3472
    ds_read_b64 a[220:221], v30 offset:3528
    ds_read_b64 a[222:223], v30 offset:3536
    ds_read_b64 a[224:225], v30 offset:3592
    ds_read_b64 a[226:227], v30 offset:3600
    ds_read_b64 a[228:229], v30 offset:3656
    ds_read_b64 a[230:231], v30 offset:3664
    ds_read_b64 a[232:233], v30 offset:3720
    ds_read_b64 a[234:235], v30 offset:3728
    ds_read_b64 a[236:237], v30 offset:3784
    ds_read_b64 a[238:239], v30 offset:3792
    ds_read_b64 a[240:241], v30 offset:3848
    ds_read_b64 a[242:243], v30 offset:3856
    ds_read_b64 a[244:245], v30 offset:3912
    ds_read_b64 a[246:247], v30 offset:3920
    ds_read_b64 a[248:249], v30 offset:3976
    ds_read_b64 a[250:251], v30 offset:3984
    ds_read_b64 a[252:253], v30 offset:4040
    ds_read_b64 a[254:255], v30 offset:4048
    s_and_b32 s4, s41, 1
    s_lshl_b32 s5, s3, 1
    s_add_u32 s5, s5, s4
    s_cmp_eq_u32 s5, 7
    s_cselect_b32 s5, 0, s5
    s_mul_i32 s96, s41, 7
    s_add_u32 s96, s96, s5
    s_add_u32 s97, s96, 1
    s_cmp_eq_u32 s3, 3
    s_cselect_b32 s97, 55, s97
    s_cselect_b32 s5, 0, -1
    v_and_b32 v7, s5, v4
    s_mul_i32 s4, s96, 20480
    s_add_u32 s5, s4, 7344128
    s_add_u32 s8, s38, s5
    s_addc_u32 s9, s39, 0
    s_add_u32 s5, s4, 7352320
    s_add_u32 s10, s38, s5
    s_addc_u32 s11, s39, 0
    s_add_u32 s5, s4, 7360512
    s_add_u32 s12, s38, s5
    s_addc_u32 s13, s39, 0
    s_mul_i32 s4, s97, 20480
    s_add_u32 s5, s4, 7344128
    s_add_u32 s14, s38, s5
    s_addc_u32 s15, s39, 0
    s_add_u32 s5, s4, 7352320
    s_add_u32 s16, s38, s5
    s_addc_u32 s17, s39, 0
    s_add_u32 s5, s4, 7360512
    s_add_u32 s18, s38, s5
    s_addc_u32 s19, s39, 0
    s_and_b32 s4, s41, 3
    s_cmp_eq_u32 s4, 0
    s_cselect_b32 s5, 8, 0
    s_cmp_le_u32 s4, 1
    s_cselect_b32 s6, 16, 8
    s_cmp_eq_u32 s4, 3
    s_cselect_b32 s50, 16, 24
    s_lshl_b32 s44, s4, 3
    s_bitcmp1_b32 s43, 0
    s_cselect_b32 s46, s6, s5
    s_cselect_b32 s48, s5, s6
    s_lshl_b32 s5, s3, 1
    s_add_u32 s44, s44, s5
    s_add_u32 s45, s44, 1
    s_add_u32 s46, s46, s5
    s_add_u32 s47, s46, 1
    s_add_u32 s48, s48, s5
    s_add_u32 s49, s48, 1
    s_add_u32 s50, s50, s5
    s_add_u32 s51, s50, 1
    s_lshl_b32 s5, s40, 18
    s_lshl_b32 s6, s44, 7
    s_add_u32 s6, s6, s5
    s_add_u32 s68, s24, s6
    s_addc_u32 s69, s25, 0
    s_lshl_b32 s6, s45, 7
    s_add_u32 s6, s6, s5
    s_add_u32 s70, s24, s6
    s_addc_u32 s71, s25, 0
    s_lshl_b32 s6, s46, 7
    s_add_u32 s6, s6, s5
    s_add_u32 s72, s24, s6
    s_addc_u32 s73, s25, 0
    s_lshl_b32 s6, s47, 7
    s_add_u32 s6, s6, s5
    s_add_u32 s74, s24, s6
    s_addc_u32 s75, s25, 0
    s_lshl_b32 s6, s48, 7
    s_add_u32 s6, s6, s5
    s_add_u32 s76, s24, s6
    s_addc_u32 s77, s25, 0
    s_lshl_b32 s6, s49, 7
    s_add_u32 s6, s6, s5
    s_add_u32 s78, s24, s6
    s_addc_u32 s79, s25, 0
    s_lshl_b32 s6, s50, 7
    s_add_u32 s6, s6, s5
    s_add_u32 s80, s24, s6
    s_addc_u32 s81, s25, 0
    s_lshl_b32 s6, s51, 7
    s_add_u32 s6, s6, s5
    s_add_u32 s82, s24, s6
    s_addc_u32 s83, s25, 0
    s_lshl_b32 s89, s3, 14
    s_add_u32 s89, s89, 83200
    s_waitcnt vmcnt(0) lgkmcnt(0)
    s_barrier
    s_cmp_ge_u32 s42, 128
    s_cbranch_scc1 Lc_j5
    s_cmp_lg_u32 s3, 0
    s_cbranch_scc1 Lc_j5
    v_lshlrev_b32 v201, 3, v2
    v_add_u32 v202, 143616, v201
    ds_read_b64 v[212:213], v202 offset:0
    ds_read_b64 v[214:215], v202 offset:128
    ds_read_b64 v[216:217], v202 offset:256
    ds_read_b64 v[218:219], v202 offset:384
    s_waitcnt lgkmcnt(2)
    v_pk_add_f32 v[212:213], v[212:213], v[214:215] op_sel:[0,0] op_sel_hi:[1,1]
    s_waitcnt lgkmcnt(0)
    v_pk_add_f32 v[216:217], v[216:217], v[218:219] op_sel:[0,0] op_sel_hi:[1,1]
    v_pk_add_f32 v[212:213], v[212:213], v[216:217] op_sel:[0,0] op_sel_hi:[1,1]
    v_mul_f32 v212, 0x3acccccd, v212
    v_mul_f32 v213, 0x3acccccd, v213
    v_fma_f32 v213, -v212, v212, v213
    v_max_f32 v213, 0, v213
    v_add_f32 v213, 0x3727c5ac, v213
    v_rsq_f32 v214, v213
    s_nop 0
    v_mul_f32_e64 v213, -v212, v214
    v_mov_b32 v212, v214
    v_min_u32 v212, -2, v212
    v_min_u32 v213, -2, v213
    s_lshl_b32 s5, s42, 7
    s_add_u32 s5, s5, 32768
    v_add_u32 v201, s5, v201
    global_store_dwordx2 v201, v[212:213], s[38:39] sc1
Lc_j5:
    v_cmp_eq_u32 vcc, 0, v42
    s_nop 0
    s_cbranch_vccnz Lic2_r
Lic2_ok:
    v_cmp_eq_u32 vcc, -1, v40
    s_nop 0
    s_cbranch_vccnz Lkf_r
Lkf_ok:
    s_add_u32 s4, s94, 20971520
    v_add_u32 v28, s4, v4
    s_mul_i32 s5, s3, 9280
    s_add_u32 m0, s5, 33804
    s_nop 0
    global_load_lds_dwordx4 v28, s[38:39] offset:3072 sc1
    s_add_u32 m0, s5, 38448
    s_nop 0
    global_load_lds_dwordx4 v28, s[38:39] offset:3072 sc1
    s_add_u32 m0, s5, 33804
    s_nop 0
    global_load_lds_dwordx4 v28, s[38:39] offset:2048 sc1
    s_add_u32 m0, s5, 38448
    s_nop 0
    global_load_lds_dwordx4 v28, s[38:39] offset:2048 sc1
    s_add_u32 m0, s5, 33804
    s_nop 0
    global_load_lds_dwordx4 v28, s[38:39] offset:1024 sc1
    s_add_u32 m0, s5, 38448
    s_nop 0
    global_load_lds_dwordx4 v28, s[38:39] offset:1024 sc1
    s_add_u32 m0, s5, 33804
    s_nop 0
    global_load_lds_dwordx4 v28, s[38:39] offset:0 sc1
    s_add_u32 m0, s5, 38448
    s_nop 0
    global_load_lds_dwordx4 v28, s[38:39] offset:0 sc1
    v_lshrrev_b32 v168, 3, v1
    v_lshlrev_b32 v168, 12, v168
    v_bfe_u32 v169, v1, 4, 1
    v_xor_b32 v169, v169, v1
    v_and_b32 v169, 7, v169
    v_xor_b32 v160, 0, v169
    v_lshl_add_u32 v160, v160, 4, v168
    v_add_u32 v164, 131072, v160
    v_xor_b32 v161, 2, v169
    v_lshl_add_u32 v161, v161, 4, v168
    v_add_u32 v161, 32768, v161
    v_add_u32 v165, 131072, v161
    v_xor_b32 v162, 4, v169
    v_lshl_add_u32 v162, v162, 4, v168
    v_add_u32 v162, 65536, v162
    v_add_u32 v166, 131072, v162
    v_xor_b32 v163, 6, v169
    v_lshl_add_u32 v163, v163, 4, v168
    v_add_u32 v163, 98304, v163
    v_add_u32 v167, 131072, v163
    s_barrier
    s_waitcnt vmcnt(6)
    ds_read_b128 v[72:75], v32 offset:3584
    ds_read_b128 v[76:79], v32 offset:3648
    ds_read_b128 v[80:83], v32 offset:3712
    ds_read_b128 v[84:87], v32 offset:3776
    ds_read_b128 v[88:91], v32 offset:3840
    ds_read_b128 v[92:95], v32 offset:3904
    ds_read_b128 v[96:99], v32 offset:3968
    ds_read_b128 v[100:103], v32 offset:4032
    s_waitcnt lgkmcnt(7)
    v_mfma_f32_16x16x32_bf16 v[40:43], a[0:3], v[72:75], 0
    ds_read_b128 v[104:107], v32 offset:3072
    v_mfma_f32_16x16x32_bf16 v[44:47], a[32:35], v[72:75], 0
    ds_read_b128 v[108:111], v32 offset:3136
    s_waitcnt lgkmcnt(8)
    v_mfma_f32_16x16x32_bf16 v[40:43], a[4:7], v[76:79], v[40:43]
    ds_read_b128 v[112:115], v32 offset:3200
    v_mfma_f32_16x16x32_bf16 v[44:47], a[36:39], v[76:79], v[44:47]
    ds_read_b128 v[116:119], v32 offset:3264
    s_waitcnt lgkmcnt(9)
    v_mfma_f32_16x16x32_bf16 v[40:43], a[8:11], v[80:83], v[40:43]
    ds_read_b128 v[120:123], v32 offset:3328
    v_mfma_f32_16x16x32_bf16 v[44:47], a[40:43], v[80:83], v[44:47]
    ds_read_b128 v[124:127], v32 offset:3392
    s_waitcnt lgkmcnt(10)
    v_mfma_f32_16x16x32_bf16 v[40:43], a[12:15], v[84:87], v[40:43]
    ds_read_b128 v[128:131], v32 offset:3456
    v_mfma_f32_16x16x32_bf16 v[44:47], a[44:47], v[84:87], v[44:47]
    ds_read_b128 v[132:135], v32 offset:3520
    s_waitcnt lgkmcnt(11)
    v_mfma_f32_16x16x32_bf16 v[40:43], a[16:19], v[88:91], v[40:43]
    v_mfma_f32_16x16x32_bf16 v[44:47], a[48:51], v[88:91], v[44:47]
    s_waitcnt lgkmcnt(10)
    v_mfma_f32_16x16x32_bf16 v[40:43], a[20:23], v[92:95], v[40:43]
    v_mfma_f32_16x16x32_bf16 v[44:47], a[52:55], v[92:95], v[44:47]
    s_waitcnt lgkmcnt(9)
    v_mfma_f32_16x16x32_bf16 v[40:43], a[24:27], v[96:99], v[40:43]
    v_mfma_f32_16x16x32_bf16 v[44:47], a[56:59], v[96:99], v[44:47]
    s_waitcnt lgkmcnt(8)
    v_mfma_f32_16x16x32_bf16 v[40:43], a[28:31], v[100:103], v[40:43]
    v_mfma_f32_16x16x32_bf16 v[44:47], a[60:63], v[100:103], v[44:47]
    s_waitcnt lgkmcnt(7)
    v_mfma_f32_16x16x32_bf16 v[44:47], a[0:3], v[104:107], v[44:47]
    s_waitcnt lgkmcnt(6)
    v_mfma_f32_16x16x32_bf16 v[44:47], a[4:7], v[108:111], v[44:47]
    s_waitcnt lgkmcnt(5)
    v_mfma_f32_16x16x32_bf16 v[44:47], a[8:11], v[112:115], v[44:47]
    s_waitcnt lgkmcnt(4)
    v_mfma_f32_16x16x32_bf16 v[44:47], a[12:15], v[116:119], v[44:47]
    s_waitcnt lgkmcnt(3)
    v_mfma_f32_16x16x32_bf16 v[44:47], a[16:19], v[120:123], v[44:47]
    v_mov_b32 v156, -1
    s_waitcnt lgkmcnt(2)
    v_mfma_f32_16x16x32_bf16 v[44:47], a[20:23], v[124:127], v[44:47]
    s_waitcnt lgkmcnt(1)
    v_mfma_f32_16x16x32_bf16 v[44:47], a[24:27], v[128:131], v[44:47]
    s_waitcnt lgkmcnt(0)
    v_mfma_f32_16x16x32_bf16 v[44:47], a[28:31], v[132:135], v[44:47]
    v_mov_b32 v157, -1
    v_mfma_f32_16x16x32_bf16 v[48:51], a[64:67], v[72:75], 0
    v_mfma_f32_16x16x32_bf16 v[52:55], a[96:99], v[72:75], 0
    v_mfma_f32_16x16x32_bf16 v[56:59], a[128:131], v[72:75], 0
    v_mov_b32 v158, -1
    v_mfma_f32_16x16x32_bf16 v[60:63], a[160:163], v[72:75], 0
    v_mfma_f32_16x16x32_bf16 v[64:67], a[192:195], v[72:75], 0
    v_mfma_f32_16x16x32_bf16 v[68:71], a[224:227], v[72:75], 0
    v_mfma_f32_16x16x32_bf16 v[48:51], a[68:71], v[76:79], v[48:51]
    v_mov_b32 v159, -1
    v_mfma_f32_16x16x32_bf16 v[52:55], a[100:103], v[76:79], v[52:55]
    v_mfma_f32_16x16x32_bf16 v[56:59], a[132:135], v[76:79], v[56:59]
    v_mfma_f32_16x16x32_bf16 v[60:63], a[164:167], v[76:79], v[60:63]
    v_add_u32 v236, 0, v37
    v_mfma_f32_16x16x32_bf16 v[64:67], a[196:199], v[76:79], v[64:67]
    v_mfma_f32_16x16x32_bf16 v[68:71], a[228:231], v[76:79], v[68:71]
    v_mfma_f32_16x16x32_bf16 v[48:51], a[72:75], v[80:83], v[48:51]
    v_mfma_f32_16x16x32_bf16 v[52:55], a[104:107], v[80:83], v[52:55]
    global_store_dwordx4 v236, v[156:159], s[38:39] sc1
    v_mfma_f32_16x16x32_bf16 v[56:59], a[136:139], v[80:83], v[56:59]
    v_mfma_f32_16x16x32_bf16 v[60:63], a[168:171], v[80:83], v[60:63]
    v_mfma_f32_16x16x32_bf16 v[64:67], a[200:203], v[80:83], v[64:67]
    v_add_u32 v236, 655360, v37
    v_mfma_f32_16x16x32_bf16 v[68:71], a[232:235], v[80:83], v[68:71]
    v_mfma_f32_16x16x32_bf16 v[48:51], a[76:79], v[84:87], v[48:51]
    v_mfma_f32_16x16x32_bf16 v[52:55], a[108:111], v[84:87], v[52:55]
    global_store_dwordx4 v236, v[156:159], s[38:39] sc1
    v_mfma_f32_16x16x32_bf16 v[56:59], a[140:143], v[84:87], v[56:59]
    v_mfma_f32_16x16x32_bf16 v[60:63], a[172:175], v[84:87], v[60:63]
    v_mfma_f32_16x16x32_bf16 v[64:67], a[204:207], v[84:87], v[64:67]
    v_mfma_f32_16x16x32_bf16 v[68:71], a[236:239], v[84:87], v[68:71]
    v_add_u32 v236, 1310720, v37
    v_mfma_f32_16x16x32_bf16 v[48:51], a[80:83], v[88:91], v[48:51]
    v_mfma_f32_16x16x32_bf16 v[52:55], a[112:115], v[88:91], v[52:55]
    v_mfma_f32_16x16x32_bf16 v[56:59], a[144:147], v[88:91], v[56:59]
    global_store_dwordx4 v236, v[156:159], s[38:39] sc1
    v_mfma_f32_16x16x32_bf16 v[60:63], a[176:179], v[88:91], v[60:63]
    v_mfma_f32_16x16x32_bf16 v[64:67], a[208:211], v[88:91], v[64:67]
    v_mfma_f32_16x16x32_bf16 v[68:71], a[240:243], v[88:91], v[68:71]
    v_mfma_f32_16x16x32_bf16 v[48:51], a[84:87], v[92:95], v[48:51]
    v_add_u32 v236, 1966080, v37
    v_mfma_f32_16x16x32_bf16 v[52:55], a[116:119], v[92:95], v[52:55]
    v_mfma_f32_16x16x32_bf16 v[56:59], a[148:151], v[92:95], v[56:59]
    v_mfma_f32_16x16x32_bf16 v[60:63], a[180:183], v[92:95], v[60:63]
    global_store_dwordx4 v236, v[156:159], s[38:39] sc1
    v_mfma_f32_16x16x32_bf16 v[64:67], a[212:215], v[92:95], v[64:67]
    v_mfma_f32_16x16x32_bf16 v[68:71], a[244:247], v[92:95], v[68:71]
    v_mfma_f32_16x16x32_bf16 v[48:51], a[88:91], v[96:99], v[48:51]
    v_mfma_f32_16x16x32_bf16 v[52:55], a[120:123], v[96:99], v[52:55]
    v_mfma_f32_16x16x32_bf16 v[56:59], a[152:155], v[96:99], v[56:59]
    v_lshlrev_b32 v28, 4, v0
    v_add_u32 v28, 36864, v28
    v_mfma_f32_16x16x32_bf16 v[60:63], a[184:187], v[96:99], v[60:63]
    global_load_dwordx4 v[200:203], v28, s[38:39] offset:-4096 sc1
    v_mfma_f32_16x16x32_bf16 v[64:67], a[216:219], v[96:99], v[64:67]
    global_load_dwordx4 v[204:207], v28, s[38:39] offset:0 sc1
    v_mfma_f32_16x16x32_bf16 v[68:71], a[248:251], v[96:99], v[68:71]
    v_add_u32 v28, 8192, v28
    v_mfma_f32_16x16x32_bf16 v[48:51], a[92:95], v[100:103], v[48:51]
    global_load_dwordx4 v[208:211], v28, s[38:39] offset:-4096 sc1
    v_mfma_f32_16x16x32_bf16 v[52:55], a[124:127], v[100:103], v[52:55]
    global_load_dwordx4 v[212:215], v28, s[38:39] offset:0 sc1
    v_mfma_f32_16x16x32_bf16 v[56:59], a[156:159], v[100:103], v[56:59]
    v_min_u32 v28, 11, v1
    v_lshrrev_b32 v29, 2, v28
    v_mfma_f32_16x16x32_bf16 v[60:63], a[188:191], v[100:103], v[60:63]
    v_mul_u32_u24 v29, 2544, v29
    v_mfma_f32_16x16x32_bf16 v[64:67], a[220:223], v[100:103], v[64:67]
    v_lshl_add_u32 v28, v28, 2, v29
    v_mfma_f32_16x16x32_bf16 v[68:71], a[252:255], v[100:103], v[68:71]
    s_lshl_b32 s4, s42, 4
    s_add_u32 s4, s4, 0
    v_add_u32 v28, s4, v28
    v_mfma_f32_16x16x32_bf16 v[48:51], a[32:35], v[104:107], v[48:51]
    global_load_dword v180, v28, s[38:39] sc1
    v_mfma_f32_16x16x32_bf16 v[52:55], a[64:67], v[104:107], v[52:55]
    v_add_u32 v28, 15360, v28
    v_mfma_f32_16x16x32_bf16 v[56:59], a[96:99], v[104:107], v[56:59]
    global_load_dword v181, v28, s[38:39] sc1
    v_mfma_f32_16x16x32_bf16 v[60:63], a[128:131], v[104:107], v[60:63]
    v_mfma_f32_16x16x32_bf16 v[64:67], a[160:163], v[104:107], v[64:67]
    v_mfma_f32_16x16x32_bf16 v[68:71], a[192:195], v[104:107], v[68:71]
    v_mfma_f32_16x16x32_bf16 v[48:51], a[36:39], v[108:111], v[48:51]
    v_mfma_f32_16x16x32_bf16 v[52:55], a[68:71], v[108:111], v[52:55]
    v_mfma_f32_16x16x32_bf16 v[56:59], a[100:103], v[108:111], v[56:59]
    v_mfma_f32_16x16x32_bf16 v[60:63], a[132:135], v[108:111], v[60:63]
    v_mfma_f32_16x16x32_bf16 v[64:67], a[164:167], v[108:111], v[64:67]
    v_mfma_f32_16x16x32_bf16 v[68:71], a[196:199], v[108:111], v[68:71]
    v_mfma_f32_16x16x32_bf16 v[48:51], a[40:43], v[112:115], v[48:51]
    v_mfma_f32_16x16x32_bf16 v[52:55], a[72:75], v[112:115], v[52:55]
    v_mfma_f32_16x16x32_bf16 v[56:59], a[104:107], v[112:115], v[56:59]
    v_mfma_f32_16x16x32_bf16 v[60:63], a[136:139], v[112:115], v[60:63]
    v_mfma_f32_16x16x32_bf16 v[64:67], a[168:171], v[112:115], v[64:67]
    v_mfma_f32_16x16x32_bf16 v[68:71], a[200:203], v[112:115], v[68:71]
    v_mfma_f32_16x16x32_bf16 v[48:51], a[44:47], v[116:119], v[48:51]
    v_mfma_f32_16x16x32_bf16 v[52:55], a[76:79], v[116:119], v[52:55]
    v_mfma_f32_16x16x32_bf16 v[56:59], a[108:111], v[116:119], v[56:59]
    v_mfma_f32_16x16x32_bf16 v[60:63], a[140:143], v[116:119], v[60:63]
    v_mfma_f32_16x16x32_bf16 v[64:67], a[172:175], v[116:119], v[64:67]
    v_mfma_f32_16x16x32_bf16 v[68:71], a[204:207], v[116:119], v[68:71]
    v_mfma_f32_16x16x32_bf16 v[48:51], a[48:51], v[120:123], v[48:51]
    v_mfma_f32_16x16x32_bf16 v[52:55], a[80:83], v[120:123], v[52:55]
    v_mfma_f32_16x16x32_bf16 v[56:59], a[112:115], v[120:123], v[56:59]
    v_mfma_f32_16x16x32_bf16 v[60:63], a[144:147], v[120:123], v[60:63]
    v_mfma_f32_16x16x32_bf16 v[64:67], a[176:179], v[120:123], v[64:67]
    v_mfma_f32_16x16x32_bf16 v[68:71], a[208:211], v[120:123], v[68:71]
    v_mfma_f32_16x16x32_bf16 v[48:51], a[52:55], v[124:127], v[48:51]
    v_mfma_f32_16x16x32_bf16 v[52:55], a[84:87], v[124:127], v[52:55]
    v_mfma_f32_16x16x32_bf16 v[56:59], a[116:119], v[124:127], v[56:59]
    v_mfma_f32_16x16x32_bf16 v[60:63], a[148:151], v[124:127], v[60:63]
    v_mfma_f32_16x16x32_bf16 v[64:67], a[180:183], v[124:127], v[64:67]
    v_mfma_f32_16x16x32_bf16 v[68:71], a[212:215], v[124:127], v[68:71]
    v_mfma_f32_16x16x32_bf16 v[48:51], a[56:59], v[128:131], v[48:51]
    s_waitcnt vmcnt(14)
    ds_read_b128 v[72:75], v32 offset:2560
    v_mfma_f32_16x16x32_bf16 v[52:55], a[88:91], v[128:131], v[52:55]
    ds_read_b128 v[76:79], v32 offset:2624
    v_mfma_f32_16x16x32_bf16 v[56:59], a[120:123], v[128:131], v[56:59]
    ds_read_b128 v[80:83], v32 offset:2688
    v_mfma_f32_16x16x32_bf16 v[60:63], a[152:155], v[128:131], v[60:63]
    ds_read_b128 v[84:87], v32 offset:2752
    v_mfma_f32_16x16x32_bf16 v[64:67], a[184:187], v[128:131], v[64:67]
    ds_read_b128 v[88:91], v32 offset:2816
    v_mfma_f32_16x16x32_bf16 v[68:71], a[216:219], v[128:131], v[68:71]
    ds_read_b128 v[92:95], v32 offset:2880
    v_mfma_f32_16x16x32_bf16 v[48:51], a[60:63], v[132:135], v[48:51]
    ds_read_b128 v[96:99], v32 offset:2944
    v_mfma_f32_16x16x32_bf16 v[52:55], a[92:95], v[132:135], v[52:55]
    ds_read_b128 v[100:103], v32 offset:3008
    v_mfma_f32_16x16x32_bf16 v[56:59], a[124:127], v[132:135], v[56:59]
    v_mfma_f32_16x16x32_bf16 v[60:63], a[156:159], v[132:135], v[60:63]
    v_mfma_f32_16x16x32_bf16 v[64:67], a[188:191], v[132:135], v[64:67]
    v_mfma_f32_16x16x32_bf16 v[68:71], a[220:223], v[132:135], v[68:71]
    s_waitcnt lgkmcnt(7)
    v_mfma_f32_16x16x32_bf16 v[48:51], a[0:3], v[72:75], v[48:51]
    ds_read_b128 v[104:107], v32 offset:2048
    v_mfma_f32_16x16x32_bf16 v[52:55], a[32:35], v[72:75], v[52:55]
    ds_read_b128 v[108:111], v32 offset:2112
    s_waitcnt lgkmcnt(8)
    v_mfma_f32_16x16x32_bf16 v[48:51], a[4:7], v[76:79], v[48:51]
    ds_read_b128 v[112:115], v32 offset:2176
    v_mfma_f32_16x16x32_bf16 v[52:55], a[36:39], v[76:79], v[52:55]
    ds_read_b128 v[116:119], v32 offset:2240
    s_waitcnt lgkmcnt(9)
    v_mfma_f32_16x16x32_bf16 v[48:51], a[8:11], v[80:83], v[48:51]
    ds_read_b128 v[120:123], v32 offset:2304
    v_mfma_f32_16x16x32_bf16 v[52:55], a[40:43], v[80:83], v[52:55]
    ds_read_b128 v[124:127], v32 offset:2368
    s_waitcnt lgkmcnt(10)
    v_mfma_f32_16x16x32_bf16 v[48:51], a[12:15], v[84:87], v[48:51]
    ds_read_b128 v[128:131], v32 offset:2432
    v_mfma_f32_16x16x32_bf16 v[52:55], a[44:47], v[84:87], v[52:55]
    ds_read_b128 v[132:135], v32 offset:2496
    s_waitcnt lgkmcnt(11)
    v_mfma_f32_16x16x32_bf16 v[48:51], a[16:19], v[88:91], v[48:51]
    s_waitcnt vmcnt(5)
    v_max_u32 v236, v201, v203
    s_waitcnt vmcnt(4)
    v_max3_u32 v236, v205, v207, v236
    v_mfma_f32_16x16x32_bf16 v[52:55], a[48:51], v[88:91], v[52:55]
    s_waitcnt vmcnt(3)
    v_max3_u32 v236, v209, v211, v236
    s_waitcnt vmcnt(2)
    v_max3_u32 v236, v213, v215, v236
    s_waitcnt lgkmcnt(10)
    v_mfma_f32_16x16x32_bf16 v[48:51], a[20:23], v[92:95], v[48:51]
    s_waitcnt vmcnt(0)
    v_max3_u32 v236, v180, v181, v236
    v_mfma_f32_16x16x32_bf16 v[52:55], a[52:55], v[92:95], v[52:55]
    v_cmp_eq_u32 vcc, -1, v236
    s_nop 0
    s_cbranch_vccnz Lax_r
Lax_ok:
    s_waitcnt lgkmcnt(9)
    v_mfma_f32_16x16x32_bf16 v[48:51], a[24:27], v[96:99], v[48:51]
    global_load_dwordx4 v[184:187], v36, s[38:39] offset:-4096 sc1
    v_mfma_f32_16x16x32_bf16 v[52:55], a[56:59], v[96:99], v[52:55]
    global_load_dwordx4 v[188:191], v36, s[38:39] offset:0 sc1
    v_add_u32 v36, 8192, v36
    s_waitcnt lgkmcnt(8)
    v_mfma_f32_16x16x32_bf16 v[48:51], a[28:31], v[100:103], v[48:51]
    global_load_dwordx4 v[192:195], v36, s[38:39] offset:-4096 sc1
    v_mfma_f32_16x16x32_bf16 v[52:55], a[60:63], v[100:103], v[52:55]
    global_load_dwordx4 v[196:199], v36, s[38:39] offset:0 sc1
    v_add_f32 v180, v180, v181
    s_waitcnt lgkmcnt(7)
    v_mfma_f32_16x16x32_bf16 v[52:55], a[0:3], v[104:107], v[52:55]
    v_cvt_pk_bf16_f32 v180, v180, v180
    v_lshlrev_b32 v180, 16, v180
    s_waitcnt lgkmcnt(6)
    v_mfma_f32_16x16x32_bf16 v[52:55], a[4:7], v[108:111], v[52:55]
    v_mov_b32 v29, 1.0
    s_waitcnt lgkmcnt(5)
    v_mfma_f32_16x16x32_bf16 v[52:55], a[8:11], v[112:115], v[52:55]
    v_add_f32_dpp v180, v180, v29 quad_perm:[0,1,2,3] row_mask:0xf bank_mask:0x2
    v_cvt_pk_bf16_f32 v180, v180, v180
    s_waitcnt lgkmcnt(4)
    v_mfma_f32_16x16x32_bf16 v[52:55], a[12:15], v[116:119], v[52:55]
    v_lshlrev_b32 v180, 16, v180
    s_waitcnt lgkmcnt(3)
    v_mfma_f32_16x16x32_bf16 v[52:55], a[16:19], v[120:123], v[52:55]
    v_mul_f32_dpp v181, v180, v180 row_shl:8 row_mask:0xf bank_mask:0x1
    s_nop 1
    v_mul_f32_dpp v181, v180, v180 row_shl:4 row_mask:0xf bank_mask:0x2
    s_waitcnt lgkmcnt(2)
    v_mfma_f32_16x16x32_bf16 v[52:55], a[20:23], v[124:127], v[52:55]
    v_readlane_b32 s64, v181, 0
    s_waitcnt lgkmcnt(1)
    v_mfma_f32_16x16x32_bf16 v[52:55], a[24:27], v[128:131], v[52:55]
    v_readlane_b32 s65, v181, 1
    v_readlane_b32 s66, v181, 2
    v_cvt_pk_bf16_f32 v136, v40, v41
    s_waitcnt lgkmcnt(0)
    v_mfma_f32_16x16x32_bf16 v[52:55], a[28:31], v[132:135], v[52:55]
    v_readlane_b32 s67, v181, 3
    v_readlane_b32 s60, v181, 4
    v_cvt_pk_bf16_f32 v137, v42, v43
    v_mfma_f32_16x16x32_bf16 v[56:59], a[64:67], v[72:75], v[56:59]
    v_readlane_b32 s61, v181, 5
    ds_write2_b32 v34, v136, v137 offset0:0 offset1:2
    v_mfma_f32_16x16x32_bf16 v[60:63], a[96:99], v[72:75], v[60:63]
    v_readlane_b32 s62, v181, 6
    v_readlane_b32 s63, v181, 7
    v_cvt_pk_bf16_f32 v138, v44, v45
    v_mfma_f32_16x16x32_bf16 v[64:67], a[128:131], v[72:75], v[64:67]
    v_mov_b32 v176, s64
    v_cvt_pk_bf16_f32 v139, v46, v47
    v_mfma_f32_16x16x32_bf16 v[68:71], a[160:163], v[72:75], v[68:71]
    v_mov_b32 v177, s65
    v_mov_b32 v178, s66
    ds_write2_b32 v34, v138, v139 offset0:128 offset1:130
    v_mfma_f32_16x16x32_bf16 v[56:59], a[68:71], v[76:79], v[56:59]
    v_mov_b32 v179, s67
    v_add_u32 v34, 4224, v34
    v_mfma_f32_16x16x32_bf16 v[60:63], a[100:103], v[76:79], v[60:63]
    v_cvt_pk_bf16_f32 v136, v48, v49
    v_mfma_f32_16x16x32_bf16 v[64:67], a[132:135], v[76:79], v[64:67]
    v_cvt_pk_bf16_f32 v137, v50, v51
    s_lshl_b32 s4, s96, 7
    s_add_u32 s4, s4, 49152
    v_lshl_add_u32 v28, v2, 2, s4
    v_mfma_f32_16x16x32_bf16 v[68:71], a[164:167], v[76:79], v[68:71]
    ds_write2_b32 v34, v136, v137 offset0:0 offset1:2
    global_load_dword v8, v28, s[38:39] sc1
    v_mfma_f32_16x16x32_bf16 v[56:59], a[72:75], v[80:83], v[56:59]
    v_cvt_pk_bf16_f32 v138, v52, v53
    global_load_dword v9, v28, s[38:39] offset:64 sc1
    v_mfma_f32_16x16x32_bf16 v[60:63], a[104:107], v[80:83], v[60:63]
    v_cvt_pk_bf16_f32 v139, v54, v55
    s_add_u32 s4, s4, 7168
    v_lshl_add_u32 v28, v3, 4, s4
    v_mfma_f32_16x16x32_bf16 v[64:67], a[136:139], v[80:83], v[64:67]
    ds_write2_b32 v34, v138, v139 offset0:128 offset1:130
    global_load_dwordx4 v[12:15], v28, s[38:39] sc1
    v_mfma_f32_16x16x32_bf16 v[68:71], a[168:171], v[80:83], v[68:71]
    v_add_u32 v34, 4224, v34
    global_load_dwordx4 v[16:19], v28, s[38:39] offset:64 sc1
    v_mfma_f32_16x16x32_bf16 v[56:59], a[76:79], v[84:87], v[56:59]
    s_waitcnt lgkmcnt(0)
    s_barrier
    s_lshl_b32 s4, s97, 7
    s_add_u32 s4, s4, 49152
    v_lshl_add_u32 v28, v2, 2, s4
    v_mfma_f32_16x16x32_bf16 v[60:63], a[108:111], v[84:87], v[60:63]
    s_lshl_b32 s6, s42, 2
    s_add_u32 s6, s6, 98560
    v_mov_b32 v136, s6
    global_load_dword v10, v28, s[38:39] sc1
    v_mfma_f32_16x16x32_bf16 v[64:67], a[140:143], v[84:87], v[64:67]
    s_cmp_lg_u32 s3, 0
    s_cbranch_scc1 Lxf_skip
    global_store_dword v136, v136, s[38:39] sc1
Lxf_skip:
    global_load_dword v11, v28, s[38:39] offset:64 sc1
    v_mfma_f32_16x16x32_bf16 v[68:71], a[172:175], v[84:87], v[68:71]
    s_add_u32 s4, s4, 7168
    v_lshl_add_u32 v28, v3, 4, s4
    v_mfma_f32_16x16x32_bf16 v[56:59], a[80:83], v[88:91], v[56:59]
    global_load_dwordx4 v[20:23], v28, s[38:39] sc1
    v_mfma_f32_16x16x32_bf16 v[60:63], a[112:115], v[88:91], v[60:63]
    global_load_dwordx4 v[24:27], v28, s[38:39] offset:64 sc1
    v_mfma_f32_16x16x32_bf16 v[64:67], a[144:147], v[88:91], v[64:67]
    s_lshl_b32 s4, s96, 7
    s_add_u32 s4, s4, 63488
    v_lshl_add_u32 v28, v2, 2, s4
    v_mfma_f32_16x16x32_bf16 v[68:71], a[176:179], v[88:91], v[68:71]
    global_load_dword v216, v28, s[38:39] sc1
    v_mfma_f32_16x16x32_bf16 v[56:59], a[84:87], v[92:95], v[56:59]
    global_load_dword v217, v28, s[38:39] offset:64 sc1
    v_mfma_f32_16x16x32_bf16 v[60:63], a[116:119], v[92:95], v[60:63]
    s_add_u32 s4, s4, 7168
    v_lshl_add_u32 v28, v3, 4, s4
    v_mfma_f32_16x16x32_bf16 v[64:67], a[148:151], v[92:95], v[64:67]
    global_load_dwordx4 v[220:223], v28, s[38:39] sc1
    v_mfma_f32_16x16x32_bf16 v[68:71], a[180:183], v[92:95], v[68:71]
    global_load_dwordx4 v[224:227], v28, s[38:39] offset:64 sc1
    v_mfma_f32_16x16x32_bf16 v[56:59], a[88:91], v[96:99], v[56:59]
    s_lshl_b32 s4, s97, 7
    s_add_u32 s4, s4, 63488
    v_lshl_add_u32 v28, v2, 2, s4
    v_mfma_f32_16x16x32_bf16 v[60:63], a[120:123], v[96:99], v[60:63]
    global_load_dword v218, v28, s[38:39] sc1
    v_mfma_f32_16x16x32_bf16 v[64:67], a[152:155], v[96:99], v[64:67]
    global_load_dword v219, v28, s[38:39] offset:64 sc1
    v_mfma_f32_16x16x32_bf16 v[68:71], a[184:187], v[96:99], v[68:71]
    s_add_u32 s4, s4, 7168
    v_lshl_add_u32 v28, v3, 4, s4
    v_mfma_f32_16x16x32_bf16 v[56:59], a[92:95], v[100:103], v[56:59]
    global_load_dwordx4 v[228:231], v28, s[38:39] sc1
    v_mfma_f32_16x16x32_bf16 v[60:63], a[124:127], v[100:103], v[60:63]
    global_load_dwordx4 v[232:235], v28, s[38:39] offset:64 sc1
    v_mfma_f32_16x16x32_bf16 v[64:67], a[156:159], v[100:103], v[64:67]
    v_mfma_f32_16x16x32_bf16 v[68:71], a[188:191], v[100:103], v[68:71]
    v_mfma_f32_16x16x32_bf16 v[56:59], a[32:35], v[104:107], v[56:59]
    v_mov_b32 v238, -1
    v_mfma_f32_16x16x32_bf16 v[60:63], a[64:67], v[104:107], v[60:63]
    v_mfma_f32_16x16x32_bf16 v[64:67], a[96:99], v[104:107], v[64:67]
    v_mov_b32 v239, -1
    v_mfma_f32_16x16x32_bf16 v[68:71], a[128:131], v[104:107], v[68:71]
    v_mfma_f32_16x16x32_bf16 v[56:59], a[36:39], v[108:111], v[56:59]
    v_mov_b32 v240, -1
    v_mfma_f32_16x16x32_bf16 v[60:63], a[68:71], v[108:111], v[60:63]
    v_mfma_f32_16x16x32_bf16 v[64:67], a[100:103], v[108:111], v[64:67]
    v_mfma_f32_16x16x32_bf16 v[68:71], a[132:135], v[108:111], v[68:71]
    v_mov_b32 v241, -1
    v_mfma_f32_16x16x32_bf16 v[56:59], a[40:43], v[112:115], v[56:59]
    v_mfma_f32_16x16x32_bf16 v[60:63], a[72:75], v[112:115], v[60:63]
    s_lshl_b32 s4, s41, 5
    s_add_u32 s4, s4, s40
    s_mul_i32 s4, s4, 14336
    s_lshl_b32 s5, s3, 12
    s_min_u32 s5, s5, 10240
    s_add_u32 s4, s4, s5
    s_add_u32 s4, s4, 12582912
    v_add_u32 v182, s4, v4
    v_mfma_f32_16x16x32_bf16 v[64:67], a[104:107], v[112:115], v[64:67]
    v_mfma_f32_16x16x32_bf16 v[68:71], a[136:139], v[112:115], v[68:71]
    v_mfma_f32_16x16x32_bf16 v[56:59], a[44:47], v[116:119], v[56:59]
    global_store_dwordx4 v182, v[238:241], s[38:39] offset:0 sc1
    v_mfma_f32_16x16x32_bf16 v[60:63], a[76:79], v[116:119], v[60:63]
    v_mfma_f32_16x16x32_bf16 v[64:67], a[108:111], v[116:119], v[64:67]
    global_store_dwordx4 v182, v[238:241], s[38:39] offset:1024 sc1
    v_mfma_f32_16x16x32_bf16 v[68:71], a[140:143], v[116:119], v[68:71]
    v_mfma_f32_16x16x32_bf16 v[56:59], a[48:51], v[120:123], v[56:59]
    global_store_dwordx4 v182, v[238:241], s[38:39] offset:2048 sc1
    v_mfma_f32_16x16x32_bf16 v[60:63], a[80:83], v[120:123], v[60:63]
    v_mfma_f32_16x16x32_bf16 v[64:67], a[112:115], v[120:123], v[64:67]
    v_mfma_f32_16x16x32_bf16 v[68:71], a[144:147], v[120:123], v[68:71]
    global_store_dwordx4 v182, v[238:241], s[38:39] offset:3072 sc1
    v_mfma_f32_16x16x32_bf16 v[56:59], a[52:55], v[124:127], v[56:59]
    ds_read_b128 v[72:75], v32 offset:1536
    v_mfma_f32_16x16x32_bf16 v[60:63], a[84:87], v[124:127], v[60:63]
    ds_read_b128 v[76:79], v32 offset:1600
    s_lshl_b32 s4, s40, 2
    s_add_u32 s4, s4, s3
    s_mul_i32 s4, s4, 28
    s_mul_i32 s5, s41, 7
    s_lshr_b32 s5, s5, 1
    s_add_u32 s4, s4, s5
    s_lshl_b32 s4, s4, 10
    s_add_u32 s4, s4, 16252928
    v_add_u32 v182, s4, v4
    v_mfma_f32_16x16x32_bf16 v[64:67], a[116:119], v[124:127], v[64:67]
    ds_read_b128 v[80:83], v32 offset:1664
    v_mfma_f32_16x16x32_bf16 v[68:71], a[148:151], v[124:127], v[68:71]
    ds_read_b128 v[84:87], v32 offset:1728
    v_mfma_f32_16x16x32_bf16 v[56:59], a[56:59], v[128:131], v[56:59]
    ds_read_b128 v[88:91], v32 offset:1792
    s_waitcnt vmcnt(18)
    v_max_u32 v236, v8, v9
    s_waitcnt vmcnt(14)
    v_max3_u32 v236, v10, v11, v236
    global_store_dwordx4 v182, v[238:241], s[38:39] offset:0 sc1
    v_mfma_f32_16x16x32_bf16 v[60:63], a[88:91], v[128:131], v[60:63]
    ds_read_b128 v[92:95], v32 offset:1856
    v_max3_u32 v236, v12, v13, v236
    v_mfma_f32_16x16x32_bf16 v[64:67], a[120:123], v[128:131], v[64:67]
    ds_read_b128 v[96:99], v32 offset:1920
    v_max3_u32 v236, v14, v15, v236
    global_store_dwordx4 v182, v[238:241], s[38:39] offset:1024 sc1
    v_mfma_f32_16x16x32_bf16 v[68:71], a[152:155], v[128:131], v[68:71]
    ds_read_b128 v[100:103], v32 offset:1984
    v_max3_u32 v236, v16, v17, v236
    v_mfma_f32_16x16x32_bf16 v[56:59], a[60:63], v[132:135], v[56:59]
    v_max3_u32 v236, v18, v19, v236
    global_store_dwordx4 v182, v[238:241], s[38:39] offset:2048 sc1
    v_mfma_f32_16x16x32_bf16 v[60:63], a[92:95], v[132:135], v[60:63]
    s_waitcnt vmcnt(16)
    v_max3_u32 v236, v20, v21, v236
    v_mfma_f32_16x16x32_bf16 v[64:67], a[124:127], v[132:135], v[64:67]
    v_max3_u32 v236, v22, v23, v236
    v_mfma_f32_16x16x32_bf16 v[68:71], a[156:159], v[132:135], v[68:71]
    s_waitcnt vmcnt(15)
    v_max3_u32 v236, v24, v25, v236
    global_store_dwordx4 v182, v[238:241], s[38:39] offset:3072 sc1
    s_waitcnt lgkmcnt(7)
    v_mfma_f32_16x16x32_bf16 v[56:59], a[0:3], v[72:75], v[56:59]
    ds_read_b128 v[104:107], v32 offset:1024
    ds_read_b32 v148, v35 offset:0
    ds_read_b32 v149, v35 offset:1056
    v_max3_u32 v236, v26, v27, v236
    v_mfma_f32_16x16x32_bf16 v[60:63], a[32:35], v[72:75], v[60:63]
    ds_read_b128 v[108:111], v32 offset:1088
    ds_read_b32 v150, v35 offset:2112
    ds_read_b32 v151, v35 offset:3168
    s_waitcnt vmcnt(14)
    v_max3_u32 v236, v216, v217, v236
    s_lshl_b32 s4, s40, 3
    s_add_u32 s4, s4, s41
    s_lshl_b32 s4, s4, 2
    s_add_u32 s4, s4, s3
    s_lshl_b32 s4, s4, 7
    s_add_u32 s4, s4, 12451840
    v_and_b32 v182, 112, v4
    s_waitcnt lgkmcnt(12)
    v_mfma_f32_16x16x32_bf16 v[56:59], a[4:7], v[76:79], v[56:59]
    ds_read_b128 v[112:115], v32 offset:1152
    ds_read_b32 v152, v33 offset:3072
    s_waitcnt vmcnt(10)
    v_max3_u32 v236, v218, v219, v236
    v_mfma_f32_16x16x32_bf16 v[60:63], a[36:39], v[76:79], v[60:63]
    ds_read_b128 v[116:119], v32 offset:1216
    ds_read_b32 v153, v33 offset:12352
    ds_read_b32 v154, v33 offset:21632
    v_max3_u32 v236, v220, v221, v236
    s_waitcnt lgkmcnt(15)
    v_mfma_f32_16x16x32_bf16 v[56:59], a[8:11], v[80:83], v[56:59]
    ds_read_b128 v[120:123], v32 offset:1280
    ds_read_b32 v155, v33 offset:30912
    v_max3_u32 v236, v222, v223, v236
    v_add_u32 v182, s4, v182
    v_mfma_f32_16x16x32_bf16 v[60:63], a[40:43], v[80:83], v[60:63]
    ds_read_b128 v[124:127], v32 offset:1344
    v_lshlrev_b32 v156, 16, v184
    v_and_b32 v157, 0xffff0000, v184
    v_max3_u32 v236, v224, v225, v236
    v_mfma_f32_16x16x32_bf16 v[56:59], a[12:15], v[84:87], v[56:59]
    ds_read_b128 v[128:131], v32 offset:1408
    v_lshlrev_b32 v158, 16, v185
    v_and_b32 v159, 0xffff0000, v185
    v_max3_u32 v236, v226, v227, v236
    global_store_dwordx4 v182, v[238:241], s[38:39] sc1
    v_mfma_f32_16x16x32_bf16 v[60:63], a[44:47], v[84:87], v[60:63]
    ds_read_b128 v[132:135], v32 offset:1472
    v_lshlrev_b32 v160, 16, v186
    s_waitcnt vmcnt(10)
    v_max3_u32 v236, v228, v229, v236
    s_waitcnt lgkmcnt(15)
    v_mfma_f32_16x16x32_bf16 v[56:59], a[16:19], v[88:91], v[56:59]
    v_and_b32 v161, 0xffff0000, v186
    v_lshlrev_b32 v162, 16, v187
    v_max3_u32 v236, v230, v231, v236
    v_mfma_f32_16x16x32_bf16 v[60:63], a[48:51], v[88:91], v[60:63]
    v_and_b32 v163, 0xffff0000, v187
    s_waitcnt vmcnt(9)
    v_max3_u32 v236, v232, v233, v236
    v_mfma_f32_16x16x32_bf16 v[56:59], a[20:23], v[92:95], v[56:59]
    v_fma_f32 v164, v156, v200, v201
    v_fma_f32 v165, v157, v200, v201
    v_max3_u32 v236, v234, v235, v236
    v_mfma_f32_16x16x32_bf16 v[60:63], a[52:55], v[92:95], v[60:63]
    v_fma_f32 v166, v158, v200, v201
    v_cmp_eq_u32 vcc, -1, v236
    v_mfma_f32_16x16x32_bf16 v[56:59], a[24:27], v[96:99], v[56:59]
    v_fma_f32 v167, v159, v200, v201
    v_fma_f32 v168, v160, v202, v203
    s_cbranch_vccnz Lcu_r
Lcu_ok:
    v_mfma_f32_16x16x32_bf16 v[60:63], a[56:59], v[96:99], v[60:63]
    v_fma_f32 v169, v161, v202, v203
    v_fma_f32 v170, v162, v202, v203
    global_load_dwordx4 a[252:255], v7, s[18:19] offset:-1024 sc1
    v_mfma_f32_16x16x32_bf16 v[56:59], a[28:31], v[100:103], v[56:59]
    v_fma_f32 v171, v163, v202, v203
    v_mfma_f32_16x16x32_bf16 v[60:63], a[60:63], v[100:103], v[60:63]
    v_fma_f32 v164, v164, s60, v176
    v_fma_f32 v165, v165, s61, v177
    v_mfma_f32_16x16x32_bf16 v[60:63], a[0:3], v[104:107], v[60:63]
    v_fma_f32 v166, v166, s62, v178
    s_waitcnt lgkmcnt(12)
    v_mfma_f32_16x16x32_bf16 v[60:63], a[4:7], v[108:111], v[60:63]
    v_fma_f32 v167, v167, s63, v179
    v_fma_f32 v168, v168, s60, v176
    s_waitcnt lgkmcnt(9)
    v_mfma_f32_16x16x32_bf16 v[60:63], a[8:11], v[112:115], v[60:63]
    v_fma_f32 v169, v169, s61, v177
    global_load_dwordx4 a[248:251], v4, s[12:13] offset:-1024 sc1
    s_waitcnt lgkmcnt(7)
    v_mfma_f32_16x16x32_bf16 v[60:63], a[12:15], v[116:119], v[60:63]
    v_fma_f32 v170, v170, s62, v178
    v_fma_f32 v171, v171, s63, v179
    s_waitcnt lgkmcnt(4)
    v_mfma_f32_16x16x32_bf16 v[60:63], a[16:19], v[120:123], v[60:63]
    v_lshlrev_b32 v140, 16, v148
    v_and_b32 v144, 0xffff0000, v148
    s_waitcnt lgkmcnt(2)
    v_mfma_f32_16x16x32_bf16 v[60:63], a[20:23], v[124:127], v[60:63]
    v_lshlrev_b32 v141, 16, v149
    s_waitcnt lgkmcnt(1)
    v_mfma_f32_16x16x32_bf16 v[60:63], a[24:27], v[128:131], v[60:63]
    v_and_b32 v145, 0xffff0000, v149
    v_lshlrev_b32 v142, 16, v150
    s_waitcnt lgkmcnt(0)
    v_mfma_f32_16x16x32_bf16 v[60:63], a[28:31], v[132:135], v[60:63]
    v_and_b32 v146, 0xffff0000, v150
    global_load_dwordx4 a[244:247], v7, s[18:19] offset:-2048 sc1
    v_mfma_f32_16x16x32_bf16 v[64:67], a[64:67], v[72:75], v[64:67]
    v_lshlrev_b32 v143, 16, v151
    v_and_b32 v147, 0xffff0000, v151
    v_mfma_f32_16x16x32_bf16 v[68:71], a[96:99], v[72:75], v[68:71]
    v_and_b32 v172, 0xffff0000, v152
    v_and_b32 v173, 0xffff0000, v153
    v_mfma_f32_16x16x32_bf16 v[64:67], a[68:71], v[76:79], v[64:67]
    v_and_b32 v174, 0xffff0000, v154
    v_mfma_f32_16x16x32_bf16 v[68:71], a[100:103], v[76:79], v[68:71]
    v_and_b32 v175, 0xffff0000, v155
    v_fmac_f32 v140, s52, v172
    v_mfma_f32_16x16x32_bf16 v[64:67], a[72:75], v[80:83], v[64:67]
    v_fmac_f32 v141, s53, v173
    v_mfma_f32_16x16x32_bf16 v[68:71], a[104:107], v[80:83], v[68:71]
    v_fmac_f32 v142, s54, v174
    v_fmac_f32 v143, s55, v175
    global_load_dwordx4 a[240:243], v4, s[12:13] offset:-2048 sc1
    v_mfma_f32_16x16x32_bf16 v[64:67], a[76:79], v[84:87], v[64:67]
    v_lshlrev_b32 v172, 16, v152
    v_mfma_f32_16x16x32_bf16 v[68:71], a[108:111], v[84:87], v[68:71]
    v_lshlrev_b32 v173, 16, v153
    v_lshlrev_b32 v174, 16, v154
    v_mfma_f32_16x16x32_bf16 v[64:67], a[80:83], v[88:91], v[64:67]
    v_lshlrev_b32 v175, 16, v155
    v_fmac_f32 v144, s52, v172
    v_mfma_f32_16x16x32_bf16 v[68:71], a[112:115], v[88:91], v[68:71]
    v_fmac_f32 v145, s53, v173
    v_mfma_f32_16x16x32_bf16 v[64:67], a[84:87], v[92:95], v[64:67]
    v_fmac_f32 v146, s54, v174
    v_fmac_f32 v147, s55, v175
    global_load_dwordx4 a[236:239], v7, s[18:19] offset:-3072 sc1
    v_mfma_f32_16x16x32_bf16 v[68:71], a[116:119], v[92:95], v[68:71]
    v_fma_f32 v156, v164, v140, v156
    v_mfma_f32_16x16x32_bf16 v[64:67], a[88:91], v[96:99], v[64:67]
    v_fma_f32 v157, v165, v141, v157
    v_fma_f32 v158, v166, v142, v158
    v_mfma_f32_16x16x32_bf16 v[68:71], a[120:123], v[96:99], v[68:71]
    v_fma_f32 v159, v167, v143, v159
    v_mfma_f32_16x16x32_bf16 v[64:67], a[92:95], v[100:103], v[64:67]
    v_fma_f32 v160, v168, v144, v160
    v_fma_f32 v161, v169, v145, v161
    v_mfma_f32_16x16x32_bf16 v[68:71], a[124:127], v[100:103], v[68:71]
    v_fma_f32 v162, v170, v146, v162
    v_fma_f32 v163, v171, v147, v163
    global_load_dwordx4 a[232:235], v4, s[12:13] offset:-3072 sc1
    v_mfma_f32_16x16x32_bf16 v[64:67], a[32:35], v[104:107], v[64:67]
    v_cvt_pk_bf16_f32 v184, v156, v157
    v_mfma_f32_16x16x32_bf16 v[68:71], a[64:67], v[104:107], v[68:71]
    v_cvt_pk_bf16_f32 v185, v158, v159
    v_cvt_pk_bf16_f32 v186, v160, v161
    v_mfma_f32_16x16x32_bf16 v[64:67], a[36:39], v[108:111], v[64:67]
    v_cvt_pk_bf16_f32 v187, v162, v163
    v_mfma_f32_16x16x32_bf16 v[68:71], a[68:71], v[108:111], v[68:71]
    v_min_u32 v187, -2, v187
    global_store_dwordx4 v37, v[184:187], s[38:39] sc1
    v_mfma_f32_16x16x32_bf16 v[64:67], a[40:43], v[112:115], v[64:67]
    v_add_u32 v37, 655360, v37
    ds_read_b128 v[72:75], v32 offset:512
    v_mfma_f32_16x16x32_bf16 v[68:71], a[72:75], v[112:115], v[68:71]
    global_load_dwordx4 a[228:231], v7, s[18:19] offset:-4096 sc1
    ds_read_b128 v[76:79], v32 offset:576
    v_mfma_f32_16x16x32_bf16 v[64:67], a[44:47], v[116:119], v[64:67]
    v_cvt_pk_bf16_f32 v136, v56, v57
    ds_read_b128 v[80:83], v32 offset:640
    v_mfma_f32_16x16x32_bf16 v[68:71], a[76:79], v[116:119], v[68:71]
    v_cvt_pk_bf16_f32 v137, v58, v59
    ds_read_b128 v[84:87], v32 offset:704
    v_mfma_f32_16x16x32_bf16 v[64:67], a[48:51], v[120:123], v[64:67]
    ds_write2_b32 v34, v136, v137 offset0:0 offset1:2
    ds_read_b128 v[88:91], v32 offset:768
    v_mfma_f32_16x16x32_bf16 v[68:71], a[80:83], v[120:123], v[68:71]
    v_cvt_pk_bf16_f32 v138, v60, v61
    ds_read_b128 v[92:95], v32 offset:832
    v_mfma_f32_16x16x32_bf16 v[64:67], a[52:55], v[124:127], v[64:67]
    v_cvt_pk_bf16_f32 v139, v62, v63
    global_load_dwordx4 a[224:227], v4, s[12:13] offset:-4096 sc1
    ds_read_b128 v[96:99], v32 offset:896
    v_mfma_f32_16x16x32_bf16 v[68:71], a[84:87], v[124:127], v[68:71]
    ds_write2_b32 v34, v138, v139 offset0:128 offset1:130
    ds_read_b128 v[100:103], v32 offset:960
    v_mfma_f32_16x16x32_bf16 v[64:67], a[56:59], v[128:131], v[64:67]
    v_add_u32 v34, 4224, v34
    v_mfma_f32_16x16x32_bf16 v[68:71], a[88:91], v[128:131], v[68:71]
    s_waitcnt lgkmcnt(0)
    s_barrier
    v_mfma_f32_16x16x32_bf16 v[64:67], a[60:63], v[132:135], v[64:67]
    v_mfma_f32_16x16x32_bf16 v[68:71], a[92:95], v[132:135], v[68:71]
    v_min_u32 v29, 624, v4
    v_add_u32 v29, 98560, v29
    global_load_dwordx4 v[200:203], v29, s[38:39] sc1
    global_load_dwordx4 a[220:223], v7, s[16:17] offset:3072 sc1
    ds_read_b128 v[104:107], v32 offset:0
    ds_read_b128 v[108:111], v32 offset:64
    ds_read_b128 v[112:115], v32 offset:128
    ds_read_b128 v[116:119], v32 offset:192
    ds_read_b128 v[120:123], v32 offset:256
    ds_read_b128 v[124:127], v32 offset:320
    ds_read_b128 v[128:131], v32 offset:384
    ds_read_b128 v[132:135], v32 offset:448
    ds_read_b32 v148, v35 offset:4224
    ds_read_b32 v149, v35 offset:5280
    ds_read_b32 v150, v35 offset:6336
    ds_read_b32 v151, v35 offset:7392
    ds_read_b32 v152, v33 offset:2048
    ds_read_b32 v153, v33 offset:11328
    global_load_dwordx4 a[216:219], v4, s[10:11] offset:3072 sc1
    ds_read_b32 v154, v33 offset:20608
    ds_read_b32 v155, v33 offset:29888
    v_lshlrev_b32 v156, 16, v188
    v_and_b32 v157, 0xffff0000, v188
    v_lshlrev_b32 v158, 16, v189
    v_and_b32 v159, 0xffff0000, v189
    v_lshlrev_b32 v160, 16, v190
    v_and_b32 v161, 0xffff0000, v190
    v_lshlrev_b32 v162, 16, v191
    v_and_b32 v163, 0xffff0000, v191
    v_pk_fma_f32 v[164:165], v[204:205], v[156:157], v[204:205] op_sel:[0,0,1] op_sel_hi:[0,1,1]
    v_pk_fma_f32 v[166:167], v[204:205], v[158:159], v[204:205] op_sel:[0,0,1] op_sel_hi:[0,1,1]
    v_pk_fma_f32 v[168:169], v[206:207], v[160:161], v[206:207] op_sel:[0,0,1] op_sel_hi:[0,1,1]
    v_pk_fma_f32 v[170:171], v[206:207], v[162:163], v[206:207] op_sel:[0,0,1] op_sel_hi:[0,1,1]
    global_load_dwordx4 a[212:215], v7, s[16:17] offset:2048 sc1
    v_pk_fma_f32 v[164:165], v[164:165], s[60:61], v[176:177] op_sel:[0,0,0] op_sel_hi:[1,1,1]
    v_pk_fma_f32 v[166:167], v[166:167], s[62:63], v[178:179] op_sel:[0,0,0] op_sel_hi:[1,1,1]
    v_pk_fma_f32 v[168:169], v[168:169], s[60:61], v[176:177] op_sel:[0,0,0] op_sel_hi:[1,1,1]
    v_pk_fma_f32 v[170:171], v[170:171], s[62:63], v[178:179] op_sel:[0,0,0] op_sel_hi:[1,1,1]
    s_waitcnt lgkmcnt(7)
    v_lshlrev_b32 v140, 16, v148
    v_and_b32 v144, 0xffff0000, v148
    s_waitcnt lgkmcnt(6)
    v_lshlrev_b32 v141, 16, v149
    v_and_b32 v145, 0xffff0000, v149
    s_waitcnt lgkmcnt(5)
    v_lshlrev_b32 v142, 16, v150
    v_and_b32 v146, 0xffff0000, v150
    s_waitcnt lgkmcnt(4)
    v_lshlrev_b32 v143, 16, v151
    v_and_b32 v147, 0xffff0000, v151
    s_waitcnt lgkmcnt(3)
    v_dot2_f32_bf16 v140, v152, s52, v140
    s_waitcnt lgkmcnt(2)
    v_dot2_f32_bf16 v141, v153, s53, v141
    s_waitcnt lgkmcnt(1)
    v_dot2_f32_bf16 v142, v154, s54, v142
    global_load_dwordx4 a[208:211], v4, s[10:11] offset:2048 sc1
    s_waitcnt lgkmcnt(0)
    v_dot2_f32_bf16 v143, v155, s55, v143
    v_dot2_f32_bf16 v144, v152, s56, v144
    v_dot2_f32_bf16 v145, v153, s57, v145
    v_dot2_f32_bf16 v146, v154, s58, v146
    v_dot2_f32_bf16 v147, v155, s59, v147
    v_pk_fma_f32 v[156:157], v[164:165], v[140:141], v[156:157] op_sel:[0,0,0] op_sel_hi:[1,1,1]
    v_pk_fma_f32 v[158:159], v[166:167], v[142:143], v[158:159] op_sel:[0,0,0] op_sel_hi:[1,1,1]
    v_pk_fma_f32 v[160:161], v[168:169], v[144:145], v[160:161] op_sel:[0,0,0] op_sel_hi:[1,1,1]
    v_pk_fma_f32 v[162:163], v[170:171], v[146:147], v[162:163] op_sel:[0,0,0] op_sel_hi:[1,1,1]
    v_cvt_pk_bf16_f32 v188, v156, v157
    v_cvt_pk_bf16_f32 v189, v158, v159
    v_cvt_pk_bf16_f32 v190, v160, v161
    v_cvt_pk_bf16_f32 v191, v162, v163
    v_min_u32 v191, -2, v191
    global_load_dwordx4 a[204:207], v7, s[16:17] offset:1024 sc1
    global_store_dwordx4 v37, v[188:191], s[38:39] sc1
    v_add_u32 v37, 655360, v37
    ds_read_b32 v148, v35 offset:8448
    ds_read_b32 v149, v35 offset:9504
    ds_read_b32 v150, v35 offset:10560
    ds_read_b32 v151, v35 offset:11616
    ds_read_b32 v152, v33 offset:1024
    ds_read_b32 v153, v33 offset:10304
    ds_read_b32 v154, v33 offset:19584
    ds_read_b32 v155, v33 offset:28864
    v_lshlrev_b32 v156, 16, v192
    v_and_b32 v157, 0xffff0000, v192
    v_lshlrev_b32 v158, 16, v193
    v_and_b32 v159, 0xffff0000, v193
    global_load_dwordx4 a[200:203], v4, s[10:11] offset:1024 sc1
    v_lshlrev_b32 v160, 16, v194
    v_and_b32 v161, 0xffff0000, v194
    v_lshlrev_b32 v162, 16, v195
    v_and_b32 v163, 0xffff0000, v195
    v_pk_fma_f32 v[164:165], v[208:209], v[156:157], v[208:209] op_sel:[0,0,1] op_sel_hi:[0,1,1]
    v_pk_fma_f32 v[166:167], v[208:209], v[158:159], v[208:209] op_sel:[0,0,1] op_sel_hi:[0,1,1]
    v_pk_fma_f32 v[168:169], v[210:211], v[160:161], v[210:211] op_sel:[0,0,1] op_sel_hi:[0,1,1]
    v_pk_fma_f32 v[170:171], v[210:211], v[162:163], v[210:211] op_sel:[0,0,1] op_sel_hi:[0,1,1]
    v_pk_fma_f32 v[164:165], v[164:165], s[60:61], v[176:177] op_sel:[0,0,0] op_sel_hi:[1,1,1]
    v_pk_fma_f32 v[166:167], v[166:167], s[62:63], v[178:179] op_sel:[0,0,0] op_sel_hi:[1,1,1]
    v_pk_fma_f32 v[168:169], v[168:169], s[60:61], v[176:177] op_sel:[0,0,0] op_sel_hi:[1,1,1]
    v_pk_fma_f32 v[170:171], v[170:171], s[62:63], v[178:179] op_sel:[0,0,0] op_sel_hi:[1,1,1]
    s_waitcnt lgkmcnt(7)
    v_lshlrev_b32 v140, 16, v148
    v_and_b32 v144, 0xffff0000, v148
    s_waitcnt lgkmcnt(6)
    v_lshlrev_b32 v141, 16, v149
    global_load_dwordx4 a[196:199], v7, s[16:17] offset:0 sc1
    v_and_b32 v145, 0xffff0000, v149
    s_waitcnt lgkmcnt(5)
    v_lshlrev_b32 v142, 16, v150
    v_and_b32 v146, 0xffff0000, v150
    s_waitcnt lgkmcnt(4)
    v_lshlrev_b32 v143, 16, v151
    v_and_b32 v147, 0xffff0000, v151
    s_waitcnt lgkmcnt(3)
    v_dot2_f32_bf16 v140, v152, s52, v140
    s_waitcnt lgkmcnt(2)
    v_dot2_f32_bf16 v141, v153, s53, v141
    s_waitcnt lgkmcnt(1)
    v_dot2_f32_bf16 v142, v154, s54, v142
    s_waitcnt lgkmcnt(0)
    v_dot2_f32_bf16 v143, v155, s55, v143
    v_dot2_f32_bf16 v144, v152, s56, v144
    v_dot2_f32_bf16 v145, v153, s57, v145
    v_dot2_f32_bf16 v146, v154, s58, v146
    v_dot2_f32_bf16 v147, v155, s59, v147
    v_pk_fma_f32 v[156:157], v[164:165], v[140:141], v[156:157] op_sel:[0,0,0] op_sel_hi:[1,1,1]
    global_load_dwordx4 a[192:195], v4, s[10:11] offset:0 sc1
    v_pk_fma_f32 v[158:159], v[166:167], v[142:143], v[158:159] op_sel:[0,0,0] op_sel_hi:[1,1,1]
    v_pk_fma_f32 v[160:161], v[168:169], v[144:145], v[160:161] op_sel:[0,0,0] op_sel_hi:[1,1,1]
    v_pk_fma_f32 v[162:163], v[170:171], v[146:147], v[162:163] op_sel:[0,0,0] op_sel_hi:[1,1,1]
    v_cvt_pk_bf16_f32 v192, v156, v157
    v_cvt_pk_bf16_f32 v193, v158, v159
    v_cvt_pk_bf16_f32 v194, v160, v161
    v_cvt_pk_bf16_f32 v195, v162, v163
    v_min_u32 v195, -2, v195
    global_store_dwordx4 v37, v[192:195], s[38:39] sc1
    v_add_u32 v37, 655360, v37
    v_mfma_f32_16x16x32_bf16 v[64:67], a[0:3], v[72:75], v[64:67]
    v_mfma_f32_16x16x32_bf16 v[68:71], a[32:35], v[72:75], v[68:71]
    v_mfma_f32_16x16x32_bf16 v[64:67], a[4:7], v[76:79], v[64:67]
    v_mfma_f32_16x16x32_bf16 v[68:71], a[36:39], v[76:79], v[68:71]
    global_load_dwordx4 a[188:191], v7, s[16:17] offset:-1024 sc1
    v_mfma_f32_16x16x32_bf16 v[64:67], a[8:11], v[80:83], v[64:67]
    v_mfma_f32_16x16x32_bf16 v[68:71], a[40:43], v[80:83], v[68:71]
    v_mfma_f32_16x16x32_bf16 v[64:67], a[12:15], v[84:87], v[64:67]
    v_mfma_f32_16x16x32_bf16 v[68:71], a[44:47], v[84:87], v[68:71]
    v_mfma_f32_16x16x32_bf16 v[64:67], a[16:19], v[88:91], v[64:67]
    v_mfma_f32_16x16x32_bf16 v[68:71], a[48:51], v[88:91], v[68:71]
    v_mfma_f32_16x16x32_bf16 v[64:67], a[20:23], v[92:95], v[64:67]
    v_mfma_f32_16x16x32_bf16 v[68:71], a[52:55], v[92:95], v[68:71]
    v_mfma_f32_16x16x32_bf16 v[64:67], a[24:27], v[96:99], v[64:67]
    v_mfma_f32_16x16x32_bf16 v[68:71], a[56:59], v[96:99], v[68:71]
    v_mfma_f32_16x16x32_bf16 v[64:67], a[28:31], v[100:103], v[64:67]
    v_mfma_f32_16x16x32_bf16 v[68:71], a[60:63], v[100:103], v[68:71]
    v_mfma_f32_16x16x32_bf16 v[68:71], a[0:3], v[104:107], v[68:71]
    v_mfma_f32_16x16x32_bf16 v[68:71], a[4:7], v[108:111], v[68:71]
    v_mfma_f32_16x16x32_bf16 v[68:71], a[8:11], v[112:115], v[68:71]
    global_load_dwordx4 a[184:187], v4, s[10:11] offset:-1024 sc1
    v_mfma_f32_16x16x32_bf16 v[68:71], a[12:15], v[116:119], v[68:71]
    v_mfma_f32_16x16x32_bf16 v[68:71], a[16:19], v[120:123], v[68:71]
    v_mfma_f32_16x16x32_bf16 v[68:71], a[20:23], v[124:127], v[68:71]
    v_mfma_f32_16x16x32_bf16 v[68:71], a[24:27], v[128:131], v[68:71]
    v_mfma_f32_16x16x32_bf16 v[68:71], a[28:31], v[132:135], v[68:71]
    v_cvt_pk_bf16_f32 v136, v64, v65
    v_cvt_pk_bf16_f32 v137, v66, v67
    ds_write2_b32 v34, v136, v137 offset0:0 offset1:2
    s_nop 4
    v_cvt_pk_bf16_f32 v138, v68, v69
    v_cvt_pk_bf16_f32 v139, v70, v71
    ds_write2_b32 v34, v138, v139 offset0:128 offset1:130
    s_waitcnt lgkmcnt(0)
    s_barrier
    ds_read_b32 v148, v35 offset:12672
    global_load_dwordx4 a[180:183], v7, s[16:17] offset:-2048 sc1
    ds_read_b32 v149, v35 offset:13728
    ds_read_b32 v150, v35 offset:14784
    ds_read_b32 v151, v35 offset:15840
    ds_read_b32 v152, v33 offset:0
    ds_read_b32 v153, v33 offset:9280
    ds_read_b32 v154, v33 offset:18560
    ds_read_b32 v155, v33 offset:27840
    v_lshlrev_b32 v156, 16, v196
    v_and_b32 v157, 0xffff0000, v196
    v_lshlrev_b32 v158, 16, v197
    v_and_b32 v159, 0xffff0000, v197
    v_lshlrev_b32 v160, 16, v198
    v_and_b32 v161, 0xffff0000, v198
    v_lshlrev_b32 v162, 16, v199
    global_load_dwordx4 a[176:179], v4, s[10:11] offset:-2048 sc1
    v_and_b32 v163, 0xffff0000, v199
    v_pk_fma_f32 v[164:165], v[212:213], v[156:157], v[212:213] op_sel:[0,0,1] op_sel_hi:[0,1,1]
    v_pk_fma_f32 v[166:167], v[212:213], v[158:159], v[212:213] op_sel:[0,0,1] op_sel_hi:[0,1,1]
    v_pk_fma_f32 v[168:169], v[214:215], v[160:161], v[214:215] op_sel:[0,0,1] op_sel_hi:[0,1,1]
    v_pk_fma_f32 v[170:171], v[214:215], v[162:163], v[214:215] op_sel:[0,0,1] op_sel_hi:[0,1,1]
    v_pk_fma_f32 v[164:165], v[164:165], s[60:61], v[176:177] op_sel:[0,0,0] op_sel_hi:[1,1,1]
    v_pk_fma_f32 v[166:167], v[166:167], s[62:63], v[178:179] op_sel:[0,0,0] op_sel_hi:[1,1,1]
    v_pk_fma_f32 v[168:169], v[168:169], s[60:61], v[176:177] op_sel:[0,0,0] op_sel_hi:[1,1,1]
    v_pk_fma_f32 v[170:171], v[170:171], s[62:63], v[178:179] op_sel:[0,0,0] op_sel_hi:[1,1,1]
    s_waitcnt lgkmcnt(7)
    v_lshlrev_b32 v140, 16, v148
    v_and_b32 v144, 0xffff0000, v148
    s_waitcnt lgkmcnt(6)
    v_lshlrev_b32 v141, 16, v149
    v_and_b32 v145, 0xffff0000, v149
    s_waitcnt lgkmcnt(5)
    v_lshlrev_b32 v142, 16, v150
    v_and_b32 v146, 0xffff0000, v150
    s_waitcnt lgkmcnt(4)
    v_lshlrev_b32 v143, 16, v151
    v_and_b32 v147, 0xffff0000, v151
    s_waitcnt lgkmcnt(3)
    v_dot2_f32_bf16 v140, v152, s52, v140
    s_waitcnt lgkmcnt(2)
    v_dot2_f32_bf16 v141, v153, s53, v141
    s_waitcnt lgkmcnt(1)
    v_dot2_f32_bf16 v142, v154, s54, v142
    s_waitcnt lgkmcnt(0)
    v_dot2_f32_bf16 v143, v155, s55, v143
    v_dot2_f32_bf16 v144, v152, s56, v144
    v_dot2_f32_bf16 v145, v153, s57, v145
    v_dot2_f32_bf16 v146, v154, s58, v146
    v_dot2_f32_bf16 v147, v155, s59, v147
    v_pk_fma_f32 v[156:157], v[164:165], v[140:141], v[156:157] op_sel:[0,0,0] op_sel_hi:[1,1,1]
    v_pk_fma_f32 v[158:159], v[166:167], v[142:143], v[158:159] op_sel:[0,0,0] op_sel_hi:[1,1,1]
    v_pk_fma_f32 v[160:161], v[168:169], v[144:145], v[160:161] op_sel:[0,0,0] op_sel_hi:[1,1,1]
    v_pk_fma_f32 v[162:163], v[170:171], v[146:147], v[162:163] op_sel:[0,0,0] op_sel_hi:[1,1,1]
    v_cvt_pk_bf16_f32 v196, v156, v157
    v_cvt_pk_bf16_f32 v197, v158, v159
    v_cvt_pk_bf16_f32 v198, v160, v161
    v_cvt_pk_bf16_f32 v199, v162, v163
    v_min_u32 v199, -2, v199
    global_store_dwordx4 v37, v[196:199], s[38:39] sc1
    s_waitcnt lgkmcnt(0)
    s_barrier
    global_load_dwordx4 a[172:175], v7, s[16:17] offset:-3072 sc1
    global_load_dwordx4 a[168:171], v4, s[10:11] offset:-3072 sc1
    global_load_dwordx4 a[164:167], v7, s[16:17] offset:-4096 sc1
    global_load_dwordx4 a[160:163], v4, s[10:11] offset:-4096 sc1
    global_load_dwordx4 a[156:159], v7, s[14:15] offset:3072 sc1
    global_load_dwordx4 a[152:155], v4, s[8:9] offset:3072 sc1
    global_load_dwordx4 a[148:151], v7, s[14:15] offset:2048 sc1
    global_load_dwordx4 a[144:147], v4, s[8:9] offset:2048 sc1
    global_load_dwordx4 a[140:143], v7, s[14:15] offset:1024 sc1
    global_load_dwordx4 a[136:139], v4, s[8:9] offset:1024 sc1
    global_load_dwordx4 a[132:135], v7, s[14:15] offset:0 sc1
    global_load_dwordx4 a[128:131], v4, s[8:9] offset:0 sc1
    v_add_f32 v8, v8, v216
    v_add_f32 v9, v9, v217
    v_add_f32 v10, v10, v218
    v_add_f32 v11, v11, v219
    v_add_f32 v12, v12, v220
    v_add_f32 v13, v13, v221
    v_add_f32 v14, v14, v222
    v_add_f32 v15, v15, v223
    v_add_f32 v16, v16, v224
    v_add_f32 v17, v17, v225
    v_add_f32 v18, v18, v226
    v_add_f32 v19, v19, v227
    v_add_f32 v20, v20, v228
    v_add_f32 v21, v21, v229
    v_add_f32 v22, v22, v230
    v_add_f32 v23, v23, v231
    v_add_f32 v24, v24, v232
    v_add_f32 v25, v25, v233
    v_add_f32 v26, v26, v234
    v_add_f32 v27, v27, v235
    s_waitcnt vmcnt(27)
    v_max_u32 v236, v200, v201
    v_max3_u32 v236, v202, v203, v236
    v_cmp_eq_u32 vcc, -1, v236
    s_nop 0
    s_cbranch_vccnz Lxf_r
Lxf_ok:
Ljoin:
    v_and_b32 v28, 7, v1
    v_lshl_add_u32 v28, v3, 3, v28
    v_bfe_u32 v29, v1, 3, 1
    v_lshlrev_b32 v66, 9, v29
    v_lshl_add_u32 v66, v28, 4, v66
    s_mul_i32 s4, s3, 20480
    s_mul_i32 s5, s40, 81920
    s_add_u32 s4, s4, s5
    s_add_u32 s4, s4, 4194304
    v_add_u32 v66, s4, v66
    v_lshl_add_u32 v70, v28, 1, v29
    v_min_u32 v72, 39, v1
    v_lshl_add_u32 v72, v72, 9, s4
    s_cmp_lt_u32 s43, 5
    s_cbranch_scc1 Lx_first
Lx_redo:
    s_branch Lxp_f
Lxp:
    s_sleep 1
Lxp_f:
    global_load_dword v71, v72, s[38:39] offset:508 sc1
    s_waitcnt vmcnt(0)
    v_mov_b32 v71, v71
    v_cmp_eq_u32 vcc, -1, v71
    s_add_u32 s100, s100, 1
    s_cmp_ge_u32 s100, 262144
    s_cbranch_scc1 Lxp_x
    s_cbranch_vccnz Lxp
Lxp_x:
Lx_first:
    s_mov_b32 s7, 0x3f803f80
    v_add_u32 v67, 4096, v66
    global_load_dwordx4 v[98:101], v67, s[38:39] offset:-4096 sc1
    global_load_dwordx4 v[102:105], v67, s[38:39] offset:-3072 sc1
    global_load_dwordx4 v[106:109], v67, s[38:39] offset:-2048 sc1
    global_load_dwordx4 v[110:113], v67, s[38:39] offset:-1024 sc1
    global_load_dwordx4 v[114:117], v67, s[38:39] offset:0 sc1
    global_load_dwordx4 v[118:121], v67, s[38:39] offset:1024 sc1
    global_load_dwordx4 v[122:125], v67, s[38:39] offset:2048 sc1
    global_load_dwordx4 v[126:129], v67, s[38:39] offset:3072 sc1
    v_add_u32 v67, 8192, v67
    global_load_dwordx4 v[130:133], v67, s[38:39] offset:-4096 sc1
    global_load_dwordx4 v[134:137], v67, s[38:39] offset:-3072 sc1
    v_lshrrev_b32 v28, 5, v1
    v_bfe_u32 v68, v1, 1, 1
    v_lshl_add_u32 v28, v28, 1, v68
    v_mul_u32_u24 v68, 1040, v28
    v_bfe_u32 v28, v1, 3, 1
    v_lshl_add_u32 v68, v28, 3, v68
    v_bfe_u32 v28, v1, 2, 1
    v_lshl_add_u32 v68, v28, 6, v68
    v_bfe_u32 v28, v1, 4, 1
    v_lshl_add_u32 v68, v28, 7, v68
    v_bfe_u32 v28, v1, 0, 1
    v_lshl_add_u32 v68, v28, 5, v68
    s_mul_i32 s5, s3, 20800
    v_add_u32 v68, s5, v68
    v_lshlrev_b32 v30, 3, v1
    s_lshl_b32 s88, s3, 9
    v_lshrrev_b32 v28, 3, v1
    v_lshlrev_b32 v28, 12, v28
    v_bfe_u32 v29, v1, 4, 1
    v_xor_b32 v29, v29, v1
    v_and_b32 v29, 7, v29
    v_xor_b32 v74, 0, v29
    v_lshl_add_u32 v74, v74, 4, v28
    v_add_u32 v78, 131072, v74
    v_xor_b32 v75, 2, v29
    v_lshl_add_u32 v75, v75, 4, v28
    v_add_u32 v75, 32768, v75
    v_add_u32 v79, 131072, v75
    v_xor_b32 v76, 4, v29
    v_lshl_add_u32 v76, v76, 4, v28
    v_add_u32 v76, 65536, v76
    v_add_u32 v80, 131072, v76
    v_xor_b32 v77, 6, v29
    v_lshl_add_u32 v77, v77, 4, v28
    v_add_u32 v77, 98304, v77
    v_add_u32 v81, 131072, v77
    v_mov_b32 v62, 0
    v_mov_b32 v63, 0
    v_mov_b32 v64, 0
    v_mov_b32 v65, 0
    v_mov_b32 v71, 0
    global_load_dwordx4 v[138:141], v67, s[38:39] offset:-2048 sc1
    v_add_u32 v69, 0, v68
    s_waitcnt vmcnt(10)
    ds_write2_b64 v69, v[98:99], v[100:101] offset0:0 offset1:2
    v_dot2_f32_bf16 v62, v98, s7, v62
    v_dot2_f32_bf16 v63, v98, v98, v63
    v_dot2_f32_bf16 v64, v100, s7, v64
    v_dot2_f32_bf16 v65, v100, v100, v65
    v_dot2_f32_bf16 v62, v99, s7, v62
    v_dot2_f32_bf16 v63, v99, v99, v63
    v_dot2_f32_bf16 v64, v101, s7, v64
    v_dot2_f32_bf16 v65, v101, v101, v65
    global_load_dwordx4 v[142:145], v67, s[38:39] offset:-1024 sc1
    s_waitcnt vmcnt(10)
    ds_write2_b64 v69, v[102:103], v[104:105] offset0:32 offset1:34
    v_max3_u32 v71, v101, v105, v71
    v_dot2_f32_bf16 v62, v102, s7, v62
    v_dot2_f32_bf16 v63, v102, v102, v63
    v_dot2_f32_bf16 v64, v104, s7, v64
    v_dot2_f32_bf16 v65, v104, v104, v65
    v_dot2_f32_bf16 v62, v103, s7, v62
    v_dot2_f32_bf16 v63, v103, v103, v63
    v_dot2_f32_bf16 v64, v105, s7, v64
    v_dot2_f32_bf16 v65, v105, v105, v65
    global_load_dwordx4 v[146:149], v67, s[38:39] offset:0 sc1
    s_waitcnt vmcnt(10)
    ds_write2_b64 v69, v[106:107], v[108:109] offset0:64 offset1:66
    v_dot2_f32_bf16 v62, v106, s7, v62
    v_dot2_f32_bf16 v63, v106, v106, v63
    v_dot2_f32_bf16 v64, v108, s7, v64
    v_dot2_f32_bf16 v65, v108, v108, v65
    v_dot2_f32_bf16 v62, v107, s7, v62
    v_dot2_f32_bf16 v63, v107, v107, v63
    v_dot2_f32_bf16 v64, v109, s7, v64
    v_dot2_f32_bf16 v65, v109, v109, v65
    global_load_dwordx4 v[150:153], v67, s[38:39] offset:1024 sc1
    s_waitcnt vmcnt(10)
    ds_write2_b64 v69, v[110:111], v[112:113] offset0:96 offset1:98
    v_max3_u32 v71, v109, v113, v71
    v_dot2_f32_bf16 v62, v110, s7, v62
    v_dot2_f32_bf16 v63, v110, v110, v63
    v_dot2_f32_bf16 v64, v112, s7, v64
    v_dot2_f32_bf16 v65, v112, v112, v65
    v_dot2_f32_bf16 v62, v111, s7, v62
    v_dot2_f32_bf16 v63, v111, v111, v63
    v_dot2_f32_bf16 v64, v113, s7, v64
    v_dot2_f32_bf16 v65, v113, v113, v65
    global_load_dwordx4 v[154:157], v67, s[38:39] offset:2048 sc1
    v_add_u32 v69, 4160, v68
    s_waitcnt vmcnt(10)
    ds_write2_b64 v69, v[114:115], v[116:117] offset0:0 offset1:2
    v_dot2_f32_bf16 v62, v114, s7, v62
    v_dot2_f32_bf16 v63, v114, v114, v63
    v_dot2_f32_bf16 v64, v116, s7, v64
    v_dot2_f32_bf16 v65, v116, v116, v65
    v_dot2_f32_bf16 v62, v115, s7, v62
    v_dot2_f32_bf16 v63, v115, v115, v63
    v_dot2_f32_bf16 v64, v117, s7, v64
    v_dot2_f32_bf16 v65, v117, v117, v65
    global_load_dwordx4 v[158:161], v67, s[38:39] offset:3072 sc1
    v_add_u32 v67, 8192, v67
    s_waitcnt vmcnt(10)
    ds_write2_b64 v69, v[118:119], v[120:121] offset0:32 offset1:34
    v_max3_u32 v71, v117, v121, v71
    v_dot2_f32_bf16 v62, v118, s7, v62
    v_dot2_f32_bf16 v63, v118, v118, v63
    v_dot2_f32_bf16 v64, v120, s7, v64
    v_dot2_f32_bf16 v65, v120, v120, v65
    v_dot2_f32_bf16 v62, v119, s7, v62
    v_dot2_f32_bf16 v63, v119, v119, v63
    v_dot2_f32_bf16 v64, v121, s7, v64
    v_dot2_f32_bf16 v65, v121, v121, v65
    global_load_dwordx4 v[162:165], v67, s[38:39] offset:-4096 sc1
    s_waitcnt vmcnt(10)
    ds_write2_b64 v69, v[122:123], v[124:125] offset0:64 offset1:66
    v_dot2_f32_bf16 v62, v122, s7, v62
    v_dot2_f32_bf16 v63, v122, v122, v63
    v_dot2_f32_bf16 v64, v124, s7, v64
    v_dot2_f32_bf16 v65, v124, v124, v65
    v_dot2_f32_bf16 v62, v123, s7, v62
    v_dot2_f32_bf16 v63, v123, v123, v63
    v_dot2_f32_bf16 v64, v125, s7, v64
    v_dot2_f32_bf16 v65, v125, v125, v65
    global_load_dwordx4 v[166:169], v67, s[38:39] offset:-3072 sc1
    s_waitcnt vmcnt(10)
    ds_write2_b64 v69, v[126:127], v[128:129] offset0:96 offset1:98
    v_max3_u32 v71, v125, v129, v71
    v_dot2_f32_bf16 v62, v126, s7, v62
    v_dot2_f32_bf16 v63, v126, v126, v63
    v_dot2_f32_bf16 v64, v128, s7, v64
    v_dot2_f32_bf16 v65, v128, v128, v65
    v_dot2_f32_bf16 v62, v127, s7, v62
    v_dot2_f32_bf16 v63, v127, v127, v63
    v_dot2_f32_bf16 v64, v129, s7, v64
    v_dot2_f32_bf16 v65, v129, v129, v65
    global_load_dwordx4 v[170:173], v67, s[38:39] offset:-2048 sc1
    v_add_u32 v69, 8320, v68
    s_waitcnt vmcnt(10)
    ds_write2_b64 v69, v[130:131], v[132:133] offset0:0 offset1:2
    v_dot2_f32_bf16 v62, v130, s7, v62
    v_dot2_f32_bf16 v63, v130, v130, v63
    v_dot2_f32_bf16 v64, v132, s7, v64
    v_dot2_f32_bf16 v65, v132, v132, v65
    v_dot2_f32_bf16 v62, v131, s7, v62
    v_dot2_f32_bf16 v63, v131, v131, v63
    v_dot2_f32_bf16 v64, v133, s7, v64
    v_dot2_f32_bf16 v65, v133, v133, v65
    global_load_dwordx4 v[174:177], v67, s[38:39] offset:-1024 sc1
    s_waitcnt vmcnt(10)
    ds_write2_b64 v69, v[134:135], v[136:137] offset0:32 offset1:34
    v_max3_u32 v71, v133, v137, v71
    v_dot2_f32_bf16 v62, v134, s7, v62
    v_dot2_f32_bf16 v63, v134, v134, v63
    v_dot2_f32_bf16 v64, v136, s7, v64
    v_dot2_f32_bf16 v65, v136, v136, v65
    v_dot2_f32_bf16 v62, v135, s7, v62
    v_dot2_f32_bf16 v63, v135, v135, v63
    v_dot2_f32_bf16 v64, v137, s7, v64
    v_dot2_f32_bf16 v65, v137, v137, v65
    global_load_dwordx4 a[96:99], v4, s[8:9] offset:-4096 sc1
    s_waitcnt vmcnt(10)
    ds_write2_b64 v69, v[138:139], v[140:141] offset0:64 offset1:66
    v_dot2_f32_bf16 v62, v138, s7, v62
    v_dot2_f32_bf16 v63, v138, v138, v63
    v_dot2_f32_bf16 v64, v140, s7, v64
    v_dot2_f32_bf16 v65, v140, v140, v65
    v_dot2_f32_bf16 v62, v139, s7, v62
    v_dot2_f32_bf16 v63, v139, v139, v63
    v_dot2_f32_bf16 v64, v141, s7, v64
    v_dot2_f32_bf16 v65, v141, v141, v65
    global_load_dwordx4 a[100:103], v7, s[14:15] offset:-4096 sc1
    s_waitcnt vmcnt(10)
    ds_write2_b64 v69, v[142:143], v[144:145] offset0:96 offset1:98
    v_max3_u32 v71, v141, v145, v71
    v_dot2_f32_bf16 v62, v142, s7, v62
    v_dot2_f32_bf16 v63, v142, v142, v63
    v_dot2_f32_bf16 v64, v144, s7, v64
    v_dot2_f32_bf16 v65, v144, v144, v65
    v_dot2_f32_bf16 v62, v143, s7, v62
    v_dot2_f32_bf16 v63, v143, v143, v63
    v_dot2_f32_bf16 v64, v145, s7, v64
    v_dot2_f32_bf16 v65, v145, v145, v65
    global_load_dwordx4 a[104:107], v4, s[8:9] offset:-3072 sc1
    v_add_u32 v69, 12480, v68
    s_waitcnt vmcnt(10)
    ds_write2_b64 v69, v[146:147], v[148:149] offset0:0 offset1:2
    v_dot2_f32_bf16 v62, v146, s7, v62
    v_dot2_f32_bf16 v63, v146, v146, v63
    v_dot2_f32_bf16 v64, v148, s7, v64
    v_dot2_f32_bf16 v65, v148, v148, v65
    v_dot2_f32_bf16 v62, v147, s7, v62
    v_dot2_f32_bf16 v63, v147, v147, v63
    v_dot2_f32_bf16 v64, v149, s7, v64
    v_dot2_f32_bf16 v65, v149, v149, v65
    global_load_dwordx4 a[108:111], v7, s[14:15] offset:-3072 sc1
    s_waitcnt vmcnt(10)
    ds_write2_b64 v69, v[150:151], v[152:153] offset0:32 offset1:34
    v_max3_u32 v71, v149, v153, v71
    v_dot2_f32_bf16 v62, v150, s7, v62
    v_dot2_f32_bf16 v63, v150, v150, v63
    v_dot2_f32_bf16 v64, v152, s7, v64
    v_dot2_f32_bf16 v65, v152, v152, v65
    v_dot2_f32_bf16 v62, v151, s7, v62
    v_dot2_f32_bf16 v63, v151, v151, v63
    v_dot2_f32_bf16 v64, v153, s7, v64
    v_dot2_f32_bf16 v65, v153, v153, v65
    global_load_dwordx4 a[112:115], v4, s[8:9] offset:-2048 sc1
    s_waitcnt vmcnt(10)
    ds_write2_b64 v69, v[154:155], v[156:157] offset0:64 offset1:66
    v_dot2_f32_bf16 v62, v154, s7, v62
    v_dot2_f32_bf16 v63, v154, v154, v63
    v_dot2_f32_bf16 v64, v156, s7, v64
    v_dot2_f32_bf16 v65, v156, v156, v65
    v_dot2_f32_bf16 v62, v155, s7, v62
    v_dot2_f32_bf16 v63, v155, v155, v63
    v_dot2_f32_bf16 v64, v157, s7, v64
    v_dot2_f32_bf16 v65, v157, v157, v65
    global_load_dwordx4 a[116:119], v7, s[14:15] offset:-2048 sc1
    s_waitcnt vmcnt(10)
    ds_write2_b64 v69, v[158:159], v[160:161] offset0:96 offset1:98
    v_max3_u32 v71, v157, v161, v71
    v_dot2_f32_bf16 v62, v158, s7, v62
    v_dot2_f32_bf16 v63, v158, v158, v63
    v_dot2_f32_bf16 v64, v160, s7, v64
    v_dot2_f32_bf16 v65, v160, v160, v65
    v_dot2_f32_bf16 v62, v159, s7, v62
    v_dot2_f32_bf16 v63, v159, v159, v63
    v_dot2_f32_bf16 v64, v161, s7, v64
    v_dot2_f32_bf16 v65, v161, v161, v65
    global_load_dwordx4 a[120:123], v4, s[8:9] offset:-1024 sc1
    v_add_u32 v69, 16640, v68
    s_waitcnt vmcnt(10)
    ds_write2_b64 v69, v[162:163], v[164:165] offset0:0 offset1:2
    v_dot2_f32_bf16 v62, v162, s7, v62
    v_dot2_f32_bf16 v63, v162, v162, v63
    v_dot2_f32_bf16 v64, v164, s7, v64
    v_dot2_f32_bf16 v65, v164, v164, v65
    v_dot2_f32_bf16 v62, v163, s7, v62
    v_dot2_f32_bf16 v63, v163, v163, v63
    v_dot2_f32_bf16 v64, v165, s7, v64
    v_dot2_f32_bf16 v65, v165, v165, v65
    global_load_dwordx4 a[124:127], v7, s[14:15] offset:-1024 sc1
    s_waitcnt vmcnt(10)
    ds_write2_b64 v69, v[166:167], v[168:169] offset0:32 offset1:34
    v_max3_u32 v71, v165, v169, v71
    v_dot2_f32_bf16 v62, v166, s7, v62
    v_dot2_f32_bf16 v63, v166, v166, v63
    v_dot2_f32_bf16 v64, v168, s7, v64
    v_dot2_f32_bf16 v65, v168, v168, v65
    v_dot2_f32_bf16 v62, v167, s7, v62
    v_dot2_f32_bf16 v63, v167, v167, v63
    v_dot2_f32_bf16 v64, v169, s7, v64
    v_dot2_f32_bf16 v65, v169, v169, v65
    s_waitcnt vmcnt(9)
    ds_write2_b64 v69, v[170:171], v[172:173] offset0:64 offset1:66
    v_dot2_f32_bf16 v62, v170, s7, v62
    v_dot2_f32_bf16 v63, v170, v170, v63
    v_dot2_f32_bf16 v64, v172, s7, v64
    v_dot2_f32_bf16 v65, v172, v172, v65
    v_dot2_f32_bf16 v62, v171, s7, v62
    v_dot2_f32_bf16 v63, v171, v171, v63
    v_dot2_f32_bf16 v64, v173, s7, v64
    v_dot2_f32_bf16 v65, v173, v173, v65
    s_waitcnt vmcnt(8)
    ds_write2_b64 v69, v[174:175], v[176:177] offset0:96 offset1:98
    v_max3_u32 v71, v173, v177, v71
    v_dot2_f32_bf16 v62, v174, s7, v62
    v_dot2_f32_bf16 v63, v174, v174, v63
    v_dot2_f32_bf16 v64, v176, s7, v64
    v_dot2_f32_bf16 v65, v176, v176, v65
    v_dot2_f32_bf16 v62, v175, s7, v62
    v_dot2_f32_bf16 v63, v175, v175, v63
    v_dot2_f32_bf16 v64, v177, s7, v64
    v_dot2_f32_bf16 v65, v177, v177, v65
    v_cmp_eq_u32 vcc, -1, v71
    s_cmp_ge_u32 s100, 262144
    s_cbranch_scc1 Lx_go
    s_cbranch_vccnz Lx_redo
Lx_go:
    v_add_f32_dpp v90, v62, v62 row_ror:8 row_mask:0xf bank_mask:0x3
    s_nop 1
    v_add_f32_dpp v90, v64, v64 row_ror:8 row_mask:0xf bank_mask:0xc
    v_add_f32_dpp v91, v63, v63 row_ror:8 row_mask:0xf bank_mask:0x3
    s_nop 1
    v_add_f32_dpp v91, v65, v65 row_ror:8 row_mask:0xf bank_mask:0xc
    s_add_u32 s4, s88, 148736
    v_lshl_add_u32 v28, v70, 3, s4
    ds_write_b64 v28, v[90:91]
    s_waitcnt lgkmcnt(0)
    s_barrier
    s_lshl_b32 s4, s2, 2
    s_add_u32 s4, s4, 99328
    v_mov_b32 v175, s4
    s_cmp_lg_u32 s3, 0
    s_cbranch_scc1 Lpf_skip
    global_store_dword v175, v175, s[38:39] sc1
Lpf_skip:
    v_add_u32 v173, 41600, v4
    ds_read_b128 v[48:51], v173 offset:37440
    ds_read_b128 v[52:55], v173 offset:38480
    ds_read_b128 v[56:59], v173 offset:39520
    ds_read_b128 v[60:63], v173 offset:40560
    ds_read_b128 v[64:67], v173 offset:33280
    s_waitcnt lgkmcnt(3)
    v_mfma_f32_16x16x32_bf16 v[178:181], v[48:51], a[248:251], 0
    s_add_u32 m0, s89, 0
    s_nop 0
    global_load_lds_dwordx4 v74, s[68:69]
    ds_read_b128 v[68:71], v173 offset:34320
    v_mfma_f32_16x16x32_bf16 v[194:197], v[48:51], a[252:255], 0
    v_mfma_f32_16x16x32_bf16 v[182:185], v[52:55], a[248:251], 0
    ds_read_b128 v[48:51], v173 offset:35360
    v_mfma_f32_16x16x32_bf16 v[198:201], v[52:55], a[252:255], 0
    s_waitcnt lgkmcnt(3)
    v_mfma_f32_16x16x32_bf16 v[186:189], v[56:59], a[248:251], 0
    v_add_u32 v28, 148736, v30
    ds_read_b128 v[52:55], v173 offset:36400
    v_mfma_f32_16x16x32_bf16 v[202:205], v[56:59], a[252:255], 0
    ds_read_b64 v[90:91], v28 offset:0
    s_add_u32 m0, s89, 1024
    s_nop 0
    global_load_lds_dwordx4 v75, s[68:69]
    v_mfma_f32_16x16x32_bf16 v[190:193], v[60:63], a[248:251], 0
    ds_read_b128 v[56:59], v173 offset:29120
    v_mfma_f32_16x16x32_bf16 v[206:209], v[60:63], a[252:255], 0
    ds_read_b64 v[92:93], v28 offset:512
    s_waitcnt lgkmcnt(5)
    v_mfma_f32_16x16x32_bf16 v[178:181], v[64:67], a[240:243], v[178:181]
    ds_read_b128 v[60:63], v173 offset:30160
    v_mfma_f32_16x16x32_bf16 v[194:197], v[64:67], a[244:247], v[194:197]
    ds_read_b64 v[94:95], v28 offset:1024
    v_mfma_f32_16x16x32_bf16 v[182:185], v[68:71], a[240:243], v[182:185]
    ds_read_b128 v[64:67], v173 offset:31200
    v_mfma_f32_16x16x32_bf16 v[198:201], v[68:71], a[244:247], v[198:201]
    ds_read_b64 v[96:97], v28 offset:1536
    s_add_u32 m0, s89, 2048
    s_nop 0
    global_load_lds_dwordx4 v76, s[68:69]
    s_waitcnt lgkmcnt(7)
    v_mfma_f32_16x16x32_bf16 v[186:189], v[48:51], a[240:243], v[186:189]
    ds_read_b128 v[68:71], v173 offset:32240
    v_mfma_f32_16x16x32_bf16 v[202:205], v[48:51], a[244:247], v[202:205]
    s_add_u32 s4, s88, 150784
    v_lshl_add_u32 v170, v1, 2, s4
    v_mfma_f32_16x16x32_bf16 v[190:193], v[52:55], a[240:243], v[190:193]
    v_lshl_add_u32 v171, v3, 5, s4
    ds_read_b128 v[48:51], v173 offset:24960
    v_mfma_f32_16x16x32_bf16 v[206:209], v[52:55], a[244:247], v[206:209]
    s_waitcnt lgkmcnt(5)
    v_mfma_f32_16x16x32_bf16 v[178:181], v[56:59], a[232:235], v[178:181]
    v_lshl_add_u32 v172, v5, 2, s4
    ds_read_b128 v[52:55], v173 offset:26000
    v_mfma_f32_16x16x32_bf16 v[194:197], v[56:59], a[236:239], v[194:197]
    s_add_u32 m0, s89, 3072
    s_nop 0
    global_load_lds_dwordx4 v77, s[68:69]
    v_mfma_f32_16x16x32_bf16 v[182:185], v[60:63], a[232:235], v[182:185]
    v_add_f32 v90, v90, v92
    ds_read_b128 v[56:59], v173 offset:27040
    v_mfma_f32_16x16x32_bf16 v[198:201], v[60:63], a[236:239], v[198:201]
    s_waitcnt lgkmcnt(3)
    v_mfma_f32_16x16x32_bf16 v[186:189], v[64:67], a[232:235], v[186:189]
    v_add_f32 v91, v91, v93
    ds_read_b128 v[60:63], v173 offset:28080
    v_mfma_f32_16x16x32_bf16 v[202:205], v[64:67], a[236:239], v[202:205]
    v_mfma_f32_16x16x32_bf16 v[190:193], v[68:71], a[232:235], v[190:193]
    v_add_f32 v94, v94, v96
    s_add_u32 m0, s89, 4096
    s_nop 0
    global_load_lds_dwordx4 v78, s[68:69]
    ds_read_b128 v[64:67], v173 offset:20800
    v_mfma_f32_16x16x32_bf16 v[206:209], v[68:71], a[236:239], v[206:209]
    s_waitcnt lgkmcnt(3)
    v_mfma_f32_16x16x32_bf16 v[178:181], v[48:51], a[224:227], v[178:181]
    v_add_f32 v95, v95, v97
    ds_read_b128 v[68:71], v173 offset:21840
    v_mfma_f32_16x16x32_bf16 v[194:197], v[48:51], a[228:231], v[194:197]
    v_add_f32 v90, v90, v94
    v_mfma_f32_16x16x32_bf16 v[182:185], v[52:55], a[224:227], v[182:185]
    ds_read_b128 v[48:51], v173 offset:22880
    v_mfma_f32_16x16x32_bf16 v[198:201], v[52:55], a[228:231], v[198:201]
    v_add_f32 v91, v91, v95
    s_waitcnt lgkmcnt(3)
    v_mfma_f32_16x16x32_bf16 v[186:189], v[56:59], a[224:227], v[186:189]
    s_add_u32 m0, s89, 5120
    s_nop 0
    global_load_lds_dwordx4 v79, s[68:69]
    ds_read_b128 v[52:55], v173 offset:23920
    v_mfma_f32_16x16x32_bf16 v[202:205], v[56:59], a[228:231], v[202:205]
    v_mul_f32 v90, 0x3acccccd, v90
    v_mfma_f32_16x16x32_bf16 v[190:193], v[60:63], a[224:227], v[190:193]
    ds_read_b128 v[56:59], v173 offset:16640
    v_mfma_f32_16x16x32_bf16 v[206:209], v[60:63], a[228:231], v[206:209]
    v_mul_f32 v91, 0x3acccccd, v91
    s_waitcnt lgkmcnt(3)
    v_mfma_f32_16x16x32_bf16 v[178:181], v[64:67], a[216:219], v[178:181]
    ds_read_b128 v[60:63], v173 offset:17680
    v_mfma_f32_16x16x32_bf16 v[194:197], v[64:67], a[220:223], v[194:197]
    v_fma_f32 v91, -v90, v90, v91
    v_mfma_f32_16x16x32_bf16 v[182:185], v[68:71], a[216:219], v[182:185]
    s_add_u32 m0, s89, 6144
    s_nop 0
    global_load_lds_dwordx4 v80, s[68:69]
    ds_read_b128 v[64:67], v173 offset:18720
    v_mfma_f32_16x16x32_bf16 v[198:201], v[68:71], a[220:223], v[198:201]
    v_max_f32 v91, 0, v91
    s_waitcnt lgkmcnt(3)
    v_mfma_f32_16x16x32_bf16 v[186:189], v[48:51], a[216:219], v[186:189]
    v_add_f32 v91, 0x3727c5ac, v91
    ds_read_b128 v[68:71], v173 offset:19760
    v_mfma_f32_16x16x32_bf16 v[202:205], v[48:51], a[220:223], v[202:205]
    v_mfma_f32_16x16x32_bf16 v[190:193], v[52:55], a[216:219], v[190:193]
    v_rsq_f32 v92, v91
    ds_read_b128 v[48:51], v173 offset:12480
    v_mfma_f32_16x16x32_bf16 v[206:209], v[52:55], a[220:223], v[206:209]
    s_waitcnt lgkmcnt(3)
    v_mfma_f32_16x16x32_bf16 v[178:181], v[56:59], a[208:211], v[178:181]
    v_mul_f32_e64 v91, -v90, v92
    s_add_u32 m0, s89, 7168
    s_nop 0
    global_load_lds_dwordx4 v81, s[68:69]
    ds_read_b128 v[52:55], v173 offset:13520
    v_mfma_f32_16x16x32_bf16 v[194:197], v[56:59], a[212:215], v[194:197]
    v_mfma_f32_16x16x32_bf16 v[182:185], v[60:63], a[208:211], v[182:185]
    v_mov_b32 v90, v92
    ds_read_b128 v[56:59], v173 offset:14560
    v_mfma_f32_16x16x32_bf16 v[198:201], v[60:63], a[212:215], v[198:201]
    s_waitcnt lgkmcnt(3)
    v_mfma_f32_16x16x32_bf16 v[186:189], v[64:67], a[208:211], v[186:189]
    ds_write2st64_b32 v170, v90, v91 offset0:0 offset1:1
    ds_read_b128 v[60:63], v173 offset:15600
    v_mfma_f32_16x16x32_bf16 v[202:205], v[64:67], a[212:215], v[202:205]
    s_add_u32 m0, s89, 8192
    s_nop 0
    global_load_lds_dwordx4 v74, s[70:71]
    v_mfma_f32_16x16x32_bf16 v[190:193], v[68:71], a[208:211], v[190:193]
    ds_read_b128 v[98:101], v171 offset:0
    ds_read_b128 v[64:67], v173 offset:8320
    v_mfma_f32_16x16x32_bf16 v[206:209], v[68:71], a[212:215], v[206:209]
    ds_read_b128 v[102:105], v171 offset:16
    s_waitcnt lgkmcnt(6)
    v_mfma_f32_16x16x32_bf16 v[178:181], v[48:51], a[200:203], v[178:181]
    ds_read_b128 v[68:71], v173 offset:9360
    v_mfma_f32_16x16x32_bf16 v[194:197], v[48:51], a[204:207], v[194:197]
    ds_read_b128 v[106:109], v171 offset:128
    v_mfma_f32_16x16x32_bf16 v[182:185], v[52:55], a[200:203], v[182:185]
    ds_read_b128 v[48:51], v173 offset:10400
    v_mfma_f32_16x16x32_bf16 v[198:201], v[52:55], a[204:207], v[198:201]
    ds_read_b128 v[110:113], v171 offset:144
    s_add_u32 m0, s89, 9216
    s_nop 0
    global_load_lds_dwordx4 v75, s[70:71]
    s_waitcnt lgkmcnt(7)
    v_mfma_f32_16x16x32_bf16 v[186:189], v[56:59], a[200:203], v[186:189]
    ds_read_b128 v[52:55], v173 offset:11440
    v_mfma_f32_16x16x32_bf16 v[202:205], v[56:59], a[204:207], v[202:205]
    ds_read_b128 v[114:117], v171 offset:256
    v_mfma_f32_16x16x32_bf16 v[190:193], v[60:63], a[200:203], v[190:193]
    ds_read_b128 v[56:59], v173 offset:4160
    v_mfma_f32_16x16x32_bf16 v[206:209], v[60:63], a[204:207], v[206:209]
    ds_read_b128 v[118:121], v171 offset:272
    s_waitcnt lgkmcnt(7)
    v_mfma_f32_16x16x32_bf16 v[178:181], v[64:67], a[192:195], v[178:181]
    ds_read_b128 v[60:63], v173 offset:5200
    v_mfma_f32_16x16x32_bf16 v[194:197], v[64:67], a[196:199], v[194:197]
    ds_read_b128 v[122:125], v171 offset:384
    s_add_u32 m0, s89, 10240
    s_nop 0
    global_load_lds_dwordx4 v76, s[70:71]
    v_mfma_f32_16x16x32_bf16 v[182:185], v[68:71], a[192:195], v[182:185]
    ds_read_b128 v[126:129], v171 offset:400
    ds_read_b128 v[64:67], v173 offset:6240
    v_mfma_f32_16x16x32_bf16 v[198:201], v[68:71], a[196:199], v[198:201]
    s_waitcnt lgkmcnt(7)
    v_mfma_f32_16x16x32_bf16 v[186:189], v[48:51], a[192:195], v[186:189]
    ds_read_b32 v162, v172 offset:0
    ds_read_b128 v[68:71], v173 offset:7280
    v_mfma_f32_16x16x32_bf16 v[202:205], v[48:51], a[196:199], v[202:205]
    v_mfma_f32_16x16x32_bf16 v[190:193], v[52:55], a[192:195], v[190:193]
    ds_read_b32 v163, v172 offset:256
    s_add_u32 m0, s89, 11264
    s_nop 0
    global_load_lds_dwordx4 v77, s[70:71]
    ds_read_b128 v[48:51], v173 offset:0
    v_mfma_f32_16x16x32_bf16 v[206:209], v[52:55], a[196:199], v[206:209]
    s_waitcnt lgkmcnt(7)
    v_mfma_f32_16x16x32_bf16 v[178:181], v[56:59], a[184:187], v[178:181]
    ds_read_b32 v164, v172 offset:16
    ds_read_b128 v[52:55], v173 offset:1040
    v_mfma_f32_16x16x32_bf16 v[194:197], v[56:59], a[188:191], v[194:197]
    v_mfma_f32_16x16x32_bf16 v[182:185], v[60:63], a[184:187], v[182:185]
    ds_read_b32 v165, v172 offset:272
    ds_read_b128 v[56:59], v173 offset:2080
    v_mfma_f32_16x16x32_bf16 v[198:201], v[60:63], a[188:191], v[198:201]
    s_waitcnt lgkmcnt(6)
    v_mfma_f32_16x16x32_bf16 v[186:189], v[64:67], a[184:187], v[186:189]
    ds_read_b32 v166, v172 offset:128
    s_add_u32 m0, s89, 12288
    s_nop 0
    global_load_lds_dwordx4 v78, s[70:71]
    ds_read_b128 v[60:63], v173 offset:3120
    v_mfma_f32_16x16x32_bf16 v[202:205], v[64:67], a[188:191], v[202:205]
    ds_read_b32 v167, v172 offset:384
    v_mfma_f32_16x16x32_bf16 v[190:193], v[68:71], a[184:187], v[190:193]
    ds_read_b128 v[64:67], v4 offset:37440
    v_mfma_f32_16x16x32_bf16 v[206:209], v[68:71], a[188:191], v[206:209]
    ds_read_b32 v168, v172 offset:144
    s_waitcnt lgkmcnt(7)
    v_mfma_f32_16x16x32_bf16 v[178:181], v[48:51], a[176:179], v[178:181]
    ds_read_b128 v[68:71], v4 offset:38480
    v_mfma_f32_16x16x32_bf16 v[194:197], v[48:51], a[180:183], v[194:197]
    ds_read_b32 v169, v172 offset:400
    v_mfma_f32_16x16x32_bf16 v[182:185], v[52:55], a[176:179], v[182:185]
    s_add_u32 m0, s89, 13312
    s_nop 0
    global_load_lds_dwordx4 v79, s[70:71]
    ds_read_b128 v[48:51], v4 offset:39520
    v_mfma_f32_16x16x32_bf16 v[198:201], v[52:55], a[180:183], v[198:201]
    v_lshrrev_b32 v29, 1, v2
    s_waitcnt lgkmcnt(6)
    v_mfma_f32_16x16x32_bf16 v[186:189], v[56:59], a[176:179], v[186:189]
    ds_read_b128 v[52:55], v4 offset:40560
    v_mfma_f32_16x16x32_bf16 v[202:205], v[56:59], a[180:183], v[202:205]
    v_xor_b32 v29, v29, v3
    v_mfma_f32_16x16x32_bf16 v[190:193], v[60:63], a[176:179], v[190:193]
    ds_read_b128 v[56:59], v4 offset:33280
    v_mfma_f32_16x16x32_bf16 v[206:209], v[60:63], a[180:183], v[206:209]
    v_lshlrev_b32 v29, 4, v29
    s_waitcnt lgkmcnt(4)
    v_mfma_f32_16x16x32_bf16 v[178:181], v[64:67], a[168:171], v[178:181]
    v_lshl_add_u32 v29, v5, 7, v29
    s_add_u32 m0, s89, 14336
    s_nop 0
    global_load_lds_dwordx4 v80, s[70:71]
    ds_read_b128 v[60:63], v4 offset:34320
    v_mfma_f32_16x16x32_bf16 v[194:197], v[64:67], a[172:175], v[194:197]
    v_mfma_f32_16x16x32_bf16 v[182:185], v[68:71], a[168:171], v[182:185]
    s_xor_b32 s4, s3, 0
    s_lshr_b32 s5, s4, 1
    s_lshl_b32 s5, s5, 12
    s_and_b32 s4, s4, 1
    s_lshl_b32 s4, s4, 9
    s_add_u32 s4, s4, s5
    s_add_u32 s4, s4, s89
    v_add_u32 v82, s4, v29
    ds_read_b128 v[64:67], v4 offset:35360
    v_mfma_f32_16x16x32_bf16 v[198:201], v[68:71], a[172:175], v[198:201]
    s_waitcnt lgkmcnt(3)
    v_mfma_f32_16x16x32_bf16 v[186:189], v[48:51], a[168:171], v[186:189]
    v_xor_b32 v83, 64, v82
    ds_read_b128 v[68:71], v4 offset:36400
    v_mfma_f32_16x16x32_bf16 v[202:205], v[48:51], a[172:175], v[202:205]
    s_add_u32 m0, s89, 15360
    s_nop 0
    global_load_lds_dwordx4 v81, s[70:71]
    v_mfma_f32_16x16x32_bf16 v[190:193], v[52:55], a[168:171], v[190:193]
    s_xor_b32 s4, s3, 1
    s_lshr_b32 s5, s4, 1
    s_lshl_b32 s5, s5, 12
    s_and_b32 s4, s4, 1
    s_lshl_b32 s4, s4, 9
    s_add_u32 s4, s4, s5
    s_add_u32 s4, s4, s89
    v_add_u32 v84, s4, v29
    ds_read_b128 v[48:51], v4 offset:29120
    v_mfma_f32_16x16x32_bf16 v[206:209], v[52:55], a[172:175], v[206:209]
    s_waitcnt lgkmcnt(3)
    v_mfma_f32_16x16x32_bf16 v[178:181], v[56:59], a[160:163], v[178:181]
    v_xor_b32 v85, 64, v84
    ds_read_b128 v[52:55], v4 offset:30160
    v_mfma_f32_16x16x32_bf16 v[194:197], v[56:59], a[164:167], v[194:197]
    v_mfma_f32_16x16x32_bf16 v[182:185], v[60:63], a[160:163], v[182:185]
    s_xor_b32 s4, s3, 2
    s_lshr_b32 s5, s4, 1
    s_lshl_b32 s5, s5, 12
    s_and_b32 s4, s4, 1
    s_lshl_b32 s4, s4, 9
    s_add_u32 s4, s4, s5
    s_add_u32 s4, s4, s89
    v_add_u32 v86, s4, v29
    ds_read_b128 v[56:59], v4 offset:31200
    v_mfma_f32_16x16x32_bf16 v[198:201], v[60:63], a[164:167], v[198:201]
    v_xor_b32 v87, 64, v86
    s_add_u32 s8, s8, 1146880
    s_addc_u32 s9, s9, 0
    s_add_u32 s10, s10, 1146880
    s_addc_u32 s11, s11, 0
    s_add_u32 s12, s12, 1146880
    s_addc_u32 s13, s13, 0
    s_add_u32 s14, s14, 1146880
    s_addc_u32 s15, s15, 0
    s_add_u32 s16, s16, 1146880
    s_addc_u32 s17, s17, 0
    s_add_u32 s18, s18, 1146880
    s_addc_u32 s19, s19, 0
    global_load_dwordx4 a[0:3], v4, s[8:9] offset:-4096 sc1
    s_waitcnt lgkmcnt(3)
    v_mfma_f32_16x16x32_bf16 v[186:189], v[64:67], a[160:163], v[186:189]
    ds_read_b128 v[60:63], v4 offset:32240
    v_mfma_f32_16x16x32_bf16 v[202:205], v[64:67], a[164:167], v[202:205]
    s_xor_b32 s4, s3, 3
    s_lshr_b32 s5, s4, 1
    s_lshl_b32 s5, s5, 12
    s_and_b32 s4, s4, 1
    s_lshl_b32 s4, s4, 9
    s_add_u32 s4, s4, s5
    s_add_u32 s4, s4, s89
    v_add_u32 v88, s4, v29
    v_mfma_f32_16x16x32_bf16 v[190:193], v[68:71], a[160:163], v[190:193]
    ds_read_b128 v[64:67], v4 offset:24960
    v_mfma_f32_16x16x32_bf16 v[206:209], v[68:71], a[164:167], v[206:209]
    v_xor_b32 v89, 64, v88
    s_waitcnt lgkmcnt(3)
    v_mfma_f32_16x16x32_bf16 v[178:181], v[48:51], a[152:155], v[178:181]
    ds_read_b128 v[68:71], v4 offset:26000
    v_mfma_f32_16x16x32_bf16 v[194:197], v[48:51], a[156:159], v[194:197]
    s_mov_b32 s84, 0xc0135761
    s_mov_b32 s85, 0xbdd2d3e8
    s_cmp_eq_u32 s3, 3
    s_cselect_b64 s[86:87], 0, -1
    s_mul_i32 s4, s41, 458752
    s_add_u32 s4, s4, 12582912
    v_fma_f32 v130, v114, v8, v9
    global_load_dwordx4 a[4:7], v7, s[14:15] offset:-4096 sc1
    v_mfma_f32_16x16x32_bf16 v[182:185], v[52:55], a[152:155], v[182:185]
    ds_read_b128 v[48:51], v4 offset:27040
    v_mfma_f32_16x16x32_bf16 v[198:201], v[52:55], a[156:159], v[198:201]
    s_mul_i32 s6, s44, 14336
    s_add_u32 s6, s6, s4
    s_add_u32 s52, s38, s6
    s_addc_u32 s53, s39, 0
    v_fma_f32 v131, v115, v8, v9
    s_waitcnt lgkmcnt(3)
    v_mfma_f32_16x16x32_bf16 v[186:189], v[56:59], a[152:155], v[186:189]
    ds_read_b128 v[52:55], v4 offset:28080
    v_mfma_f32_16x16x32_bf16 v[202:205], v[56:59], a[156:159], v[202:205]
    s_mul_i32 s6, s45, 14336
    s_add_u32 s6, s6, s4
    s_add_u32 s54, s38, s6
    s_addc_u32 s55, s39, 0
    v_fma_f32 v132, v116, v8, v9
    v_mfma_f32_16x16x32_bf16 v[190:193], v[60:63], a[152:155], v[190:193]
    s_mul_i32 s6, s46, 14336
    s_add_u32 s6, s6, s4
    s_add_u32 s56, s38, s6
    s_addc_u32 s57, s39, 0
    v_fma_f32 v133, v117, v8, v9
    global_load_dwordx4 a[8:11], v4, s[8:9] offset:-3072 sc1
    ds_read_b128 v[56:59], v4 offset:20800
    v_mfma_f32_16x16x32_bf16 v[206:209], v[60:63], a[156:159], v[206:209]
    s_waitcnt lgkmcnt(3)
    v_mfma_f32_16x16x32_bf16 v[178:181], v[64:67], a[144:147], v[178:181]
    s_mul_i32 s6, s47, 14336
    s_add_u32 s6, s6, s4
    s_add_u32 s58, s38, s6
    s_addc_u32 s59, s39, 0
    v_fma_f32 v134, v118, v8, v9
    ds_read_b128 v[60:63], v4 offset:21840
    v_mfma_f32_16x16x32_bf16 v[194:197], v[64:67], a[148:151], v[194:197]
    v_mfma_f32_16x16x32_bf16 v[182:185], v[68:71], a[144:147], v[182:185]
    s_mul_i32 s6, s48, 14336
    s_add_u32 s6, s6, s4
    s_add_u32 s60, s38, s6
    s_addc_u32 s61, s39, 0
    v_fma_f32 v135, v119, v8, v9
    ds_read_b128 v[64:67], v4 offset:22880
    v_mfma_f32_16x16x32_bf16 v[198:201], v[68:71], a[148:151], v[198:201]
    s_waitcnt lgkmcnt(3)
    v_mfma_f32_16x16x32_bf16 v[186:189], v[48:51], a[144:147], v[186:189]
    s_mul_i32 s6, s49, 14336
    s_add_u32 s6, s6, s4
    s_add_u32 s62, s38, s6
    s_addc_u32 s63, s39, 0
    v_fma_f32 v136, v120, v8, v9
    global_load_dwordx4 a[12:15], v7, s[14:15] offset:-3072 sc1
    ds_read_b128 v[68:71], v4 offset:23920
    v_mfma_f32_16x16x32_bf16 v[202:205], v[48:51], a[148:151], v[202:205]
    v_mfma_f32_16x16x32_bf16 v[190:193], v[52:55], a[144:147], v[190:193]
    s_mul_i32 s6, s50, 14336
    s_add_u32 s6, s6, s4
    s_add_u32 s64, s38, s6
    s_addc_u32 s65, s39, 0
    v_fma_f32 v137, v121, v8, v9
    ds_read_b128 v[48:51], v4 offset:16640
    v_mfma_f32_16x16x32_bf16 v[206:209], v[52:55], a[148:151], v[206:209]
    s_waitcnt lgkmcnt(3)
    v_mfma_f32_16x16x32_bf16 v[178:181], v[56:59], a[136:139], v[178:181]
    s_mul_i32 s6, s51, 14336
    s_add_u32 s6, s6, s4
    s_add_u32 s66, s38, s6
    s_addc_u32 s67, s39, 0
    v_fma_f32 v138, v122, v8, v9
    ds_read_b128 v[52:55], v4 offset:17680
    v_mfma_f32_16x16x32_bf16 v[194:197], v[56:59], a[140:143], v[194:197]
    v_fma_f32 v139, v123, v8, v9
    v_mfma_f32_16x16x32_bf16 v[182:185], v[60:63], a[136:139], v[182:185]
    global_load_dwordx4 a[16:19], v4, s[8:9] offset:-2048 sc1
    ds_read_b128 v[56:59], v4 offset:18720
    v_mfma_f32_16x16x32_bf16 v[198:201], v[60:63], a[140:143], v[198:201]
    v_fma_f32 v140, v124, v8, v9
    s_waitcnt lgkmcnt(3)
    v_mfma_f32_16x16x32_bf16 v[186:189], v[64:67], a[136:139], v[186:189]
    ds_read_b128 v[60:63], v4 offset:19760
    v_mfma_f32_16x16x32_bf16 v[202:205], v[64:67], a[140:143], v[202:205]
    v_fma_f32 v141, v125, v8, v9
    v_mfma_f32_16x16x32_bf16 v[190:193], v[68:71], a[136:139], v[190:193]
    ds_read_b128 v[64:67], v4 offset:0
    v_mfma_f32_16x16x32_bf16 v[206:209], v[68:71], a[140:143], v[206:209]
    v_fma_f32 v142, v126, v8, v9
    s_waitcnt lgkmcnt(3)
    v_mfma_f32_16x16x32_bf16 v[178:181], v[48:51], a[128:131], v[178:181]
    global_load_dwordx4 a[20:23], v7, s[14:15] offset:-2048 sc1
    ds_read_b128 v[68:71], v4 offset:1040
    v_mfma_f32_16x16x32_bf16 v[194:197], v[48:51], a[132:135], v[194:197]
    v_fma_f32 v143, v127, v8, v9
    v_mfma_f32_16x16x32_bf16 v[182:185], v[52:55], a[128:131], v[182:185]
    ds_read_b128 v[48:51], v4 offset:2080
    v_mfma_f32_16x16x32_bf16 v[198:201], v[52:55], a[132:135], v[198:201]
    v_fma_f32 v144, v128, v8, v9
    s_waitcnt lgkmcnt(3)
    v_mfma_f32_16x16x32_bf16 v[186:189], v[56:59], a[128:131], v[186:189]
    v_fma_f32 v145, v129, v8, v9
    ds_read_b128 v[52:55], v4 offset:3120
    v_mfma_f32_16x16x32_bf16 v[202:205], v[56:59], a[132:135], v[202:205]
    global_load_dwordx4 a[24:27], v4, s[8:9] offset:-1024 sc1
    v_mfma_f32_16x16x32_bf16 v[190:193], v[60:63], a[128:131], v[190:193]
    v_fma_f32 v146, v114, v10, v11
    ds_read_b128 v[56:59], v4 offset:4160
    v_mfma_f32_16x16x32_bf16 v[206:209], v[60:63], a[132:135], v[206:209]
    s_waitcnt lgkmcnt(3)
    s_waitcnt vmcnt(30)
    v_mfma_f32_16x16x32_bf16 v[178:181], v[64:67], a[96:99], v[178:181]
    v_fma_f32 v147, v115, v10, v11
    ds_read_b128 v[60:63], v4 offset:5200
    s_waitcnt vmcnt(29)
    v_mfma_f32_16x16x32_bf16 v[194:197], v[64:67], a[100:103], v[194:197]
    v_mfma_f32_16x16x32_bf16 v[182:185], v[68:71], a[96:99], v[182:185]
    v_fma_f32 v148, v116, v10, v11
    ds_read_b128 v[64:67], v4 offset:6240
    v_mfma_f32_16x16x32_bf16 v[198:201], v[68:71], a[100:103], v[198:201]
    global_load_dwordx4 a[28:31], v7, s[14:15] offset:-1024 sc1
    s_waitcnt lgkmcnt(3)
    v_mfma_f32_16x16x32_bf16 v[186:189], v[48:51], a[96:99], v[186:189]
    v_fma_f32 v149, v117, v10, v11
    ds_read_b128 v[68:71], v4 offset:7280
    v_mfma_f32_16x16x32_bf16 v[202:205], v[48:51], a[100:103], v[202:205]
    v_mfma_f32_16x16x32_bf16 v[190:193], v[52:55], a[96:99], v[190:193]
    v_fma_f32 v150, v118, v10, v11
    ds_read_b128 v[48:51], v4 offset:8320
    v_mfma_f32_16x16x32_bf16 v[206:209], v[52:55], a[100:103], v[206:209]
    v_fma_f32 v151, v119, v10, v11
    s_waitcnt lgkmcnt(3)
    s_waitcnt vmcnt(29)
    v_mfma_f32_16x16x32_bf16 v[178:181], v[56:59], a[104:107], v[178:181]
    ds_read_b128 v[52:55], v4 offset:9360
    s_waitcnt vmcnt(28)
    v_mfma_f32_16x16x32_bf16 v[194:197], v[56:59], a[108:111], v[194:197]
    v_fma_f32 v152, v120, v10, v11
    global_load_dwordx4 a[32:35], v4, s[8:9] offset:0 sc1
    v_mfma_f32_16x16x32_bf16 v[182:185], v[60:63], a[104:107], v[182:185]
    ds_read_b128 v[56:59], v4 offset:10400
    v_mfma_f32_16x16x32_bf16 v[198:201], v[60:63], a[108:111], v[198:201]
    v_fma_f32 v153, v121, v10, v11
    s_waitcnt lgkmcnt(3)
    v_mfma_f32_16x16x32_bf16 v[186:189], v[64:67], a[104:107], v[186:189]
    ds_read_b128 v[60:63], v4 offset:11440
    v_mfma_f32_16x16x32_bf16 v[202:205], v[64:67], a[108:111], v[202:205]
    v_fma_f32 v154, v122, v10, v11
    v_mfma_f32_16x16x32_bf16 v[190:193], v[68:71], a[104:107], v[190:193]
    global_load_dwordx4 a[36:39], v7, s[14:15] offset:0 sc1
    ds_read_b128 v[64:67], v4 offset:12480
    v_mfma_f32_16x16x32_bf16 v[206:209], v[68:71], a[108:111], v[206:209]
    v_fma_f32 v155, v123, v10, v11
    s_waitcnt lgkmcnt(3)
    s_waitcnt vmcnt(29)
    v_mfma_f32_16x16x32_bf16 v[178:181], v[48:51], a[112:115], v[178:181]
    ds_read_b128 v[68:71], v4 offset:13520
    s_waitcnt vmcnt(28)
    v_mfma_f32_16x16x32_bf16 v[194:197], v[48:51], a[116:119], v[194:197]
    v_fma_f32 v156, v124, v10, v11
    v_mfma_f32_16x16x32_bf16 v[182:185], v[52:55], a[112:115], v[182:185]
    v_fma_f32 v157, v125, v10, v11
    ds_read_b128 v[48:51], v4 offset:14560
    v_mfma_f32_16x16x32_bf16 v[198:201], v[52:55], a[116:119], v[198:201]
    s_waitcnt lgkmcnt(3)
    v_mfma_f32_16x16x32_bf16 v[186:189], v[56:59], a[112:115], v[186:189]
    v_fma_f32 v158, v126, v10, v11
    global_load_dwordx4 a[40:43], v4, s[8:9] offset:1024 sc1
    ds_read_b128 v[52:55], v4 offset:15600
    v_mfma_f32_16x16x32_bf16 v[202:205], v[56:59], a[116:119], v[202:205]
    v_mfma_f32_16x16x32_bf16 v[190:193], v[60:63], a[112:115], v[190:193]
    v_fma_f32 v159, v127, v10, v11
    v_mfma_f32_16x16x32_bf16 v[206:209], v[60:63], a[116:119], v[206:209]
    s_waitcnt lgkmcnt(2)
    s_waitcnt vmcnt(28)
    v_mfma_f32_16x16x32_bf16 v[178:181], v[64:67], a[120:123], v[178:181]
    v_fma_f32 v160, v128, v10, v11
    s_waitcnt vmcnt(27)
    v_mfma_f32_16x16x32_bf16 v[194:197], v[64:67], a[124:127], v[194:197]
    v_mfma_f32_16x16x32_bf16 v[182:185], v[68:71], a[120:123], v[182:185]
    v_fma_f32 v161, v129, v10, v11
    global_load_dwordx4 a[44:47], v7, s[14:15] offset:1024 sc1
    v_mfma_f32_16x16x32_bf16 v[198:201], v[68:71], a[124:127], v[198:201]
    s_waitcnt lgkmcnt(0)
    v_mfma_f32_16x16x32_bf16 v[186:189], v[48:51], a[120:123], v[186:189]
    v_mfma_f32_16x16x32_bf16 v[202:205], v[48:51], a[124:127], v[202:205]
    v_mfma_f32_16x16x32_bf16 v[190:193], v[52:55], a[120:123], v[190:193]
    v_mfma_f32_16x16x32_bf16 v[206:209], v[52:55], a[124:127], v[206:209]
    s_waitcnt vmcnt(20)
    ds_read_b128 a[160:163], v82 offset:0
    v_pk_fma_f32 v[178:179], v[178:179], v[98:99], v[130:131] op_sel:[0,0,0] op_sel_hi:[1,1,1]
    v_pk_fma_f32 v[180:181], v[180:181], v[100:101], v[132:133] op_sel:[0,0,0] op_sel_hi:[1,1,1]
    v_pk_fma_f32 v[182:183], v[182:183], v[102:103], v[134:135] op_sel:[0,0,0] op_sel_hi:[1,1,1]
    v_pk_fma_f32 v[184:185], v[184:185], v[104:105], v[136:137] op_sel:[0,0,0] op_sel_hi:[1,1,1]
    v_pk_fma_f32 v[186:187], v[186:187], v[106:107], v[138:139] op_sel:[0,0,0] op_sel_hi:[1,1,1]
    ds_read_b128 a[164:167], v84 offset:0
    v_pk_fma_f32 v[188:189], v[188:189], v[108:109], v[140:141] op_sel:[0,0,0] op_sel_hi:[1,1,1]
    v_pk_fma_f32 v[190:191], v[190:191], v[110:111], v[142:143] op_sel:[0,0,0] op_sel_hi:[1,1,1]
    v_pk_fma_f32 v[192:193], v[192:193], v[112:113], v[144:145] op_sel:[0,0,0] op_sel_hi:[1,1,1]
    v_pk_fma_f32 v[194:195], v[194:195], v[98:99], v[146:147] op_sel:[0,0,0] op_sel_hi:[1,1,1]
    v_pk_fma_f32 v[196:197], v[196:197], v[100:101], v[148:149] op_sel:[0,0,0] op_sel_hi:[1,1,1]
    ds_read_b128 a[168:171], v86 offset:0
    v_pk_fma_f32 v[198:199], v[198:199], v[102:103], v[150:151] op_sel:[0,0,0] op_sel_hi:[1,1,1]
    v_pk_fma_f32 v[200:201], v[200:201], v[104:105], v[152:153] op_sel:[0,0,0] op_sel_hi:[1,1,1]
    v_pk_fma_f32 v[202:203], v[202:203], v[106:107], v[154:155] op_sel:[0,0,0] op_sel_hi:[1,1,1]
    v_pk_fma_f32 v[204:205], v[204:205], v[108:109], v[156:157] op_sel:[0,0,0] op_sel_hi:[1,1,1]
    v_pk_fma_f32 v[206:207], v[206:207], v[110:111], v[158:159] op_sel:[0,0,0] op_sel_hi:[1,1,1]
    ds_read_b128 a[172:175], v88 offset:0
    v_pk_fma_f32 v[208:209], v[208:209], v[112:113], v[160:161] op_sel:[0,0,0] op_sel_hi:[1,1,1]
    v_pk_mul_f32 v[130:131], v[178:179], v[178:179] op_sel:[0,0] op_sel_hi:[1,1]
    v_pk_mul_f32 v[132:133], v[180:181], v[180:181] op_sel:[0,0] op_sel_hi:[1,1]
    v_pk_mul_f32 v[134:135], v[182:183], v[182:183] op_sel:[0,0] op_sel_hi:[1,1]
    v_pk_mul_f32 v[136:137], v[184:185], v[184:185] op_sel:[0,0] op_sel_hi:[1,1]
    ds_read_b128 a[176:179], v83 offset:0
    v_pk_mul_f32 v[138:139], v[186:187], v[186:187] op_sel:[0,0] op_sel_hi:[1,1]
    v_pk_mul_f32 v[140:141], v[188:189], v[188:189] op_sel:[0,0] op_sel_hi:[1,1]
    v_pk_mul_f32 v[142:143], v[190:191], v[190:191] op_sel:[0,0] op_sel_hi:[1,1]
    v_pk_mul_f32 v[144:145], v[192:193], v[192:193] op_sel:[0,0] op_sel_hi:[1,1]
    v_pk_mul_f32 v[146:147], v[194:195], v[194:195] op_sel:[0,0] op_sel_hi:[1,1]
    ds_read_b128 a[180:183], v85 offset:0
    v_pk_mul_f32 v[148:149], v[196:197], v[196:197] op_sel:[0,0] op_sel_hi:[1,1]
    v_pk_mul_f32 v[150:151], v[198:199], v[198:199] op_sel:[0,0] op_sel_hi:[1,1]
    v_pk_mul_f32 v[152:153], v[200:201], v[200:201] op_sel:[0,0] op_sel_hi:[1,1]
    v_pk_mul_f32 v[154:155], v[202:203], v[202:203] op_sel:[0,0] op_sel_hi:[1,1]
    v_pk_mul_f32 v[156:157], v[204:205], v[204:205] op_sel:[0,0] op_sel_hi:[1,1]
    ds_read_b128 a[184:187], v87 offset:0
    v_pk_mul_f32 v[158:159], v[206:207], v[206:207] op_sel:[0,0] op_sel_hi:[1,1]
    v_pk_mul_f32 v[160:161], v[208:209], v[208:209] op_sel:[0,0] op_sel_hi:[1,1]
    v_pk_fma_f32 v[130:131], v[130:131], s[84:85], s[84:85] op_sel:[0,1,0] op_sel_hi:[1,1,0]
    v_pk_fma_f32 v[132:133], v[132:133], s[84:85], s[84:85] op_sel:[0,1,0] op_sel_hi:[1,1,0]
    v_pk_fma_f32 v[134:135], v[134:135], s[84:85], s[84:85] op_sel:[0,1,0] op_sel_hi:[1,1,0]
    ds_read_b128 a[188:191], v89 offset:0
    v_pk_fma_f32 v[136:137], v[136:137], s[84:85], s[84:85] op_sel:[0,1,0] op_sel_hi:[1,1,0]
    v_pk_fma_f32 v[138:139], v[138:139], s[84:85], s[84:85] op_sel:[0,1,0] op_sel_hi:[1,1,0]
    v_pk_fma_f32 v[140:141], v[140:141], s[84:85], s[84:85] op_sel:[0,1,0] op_sel_hi:[1,1,0]
    v_pk_fma_f32 v[142:143], v[142:143], s[84:85], s[84:85] op_sel:[0,1,0] op_sel_hi:[1,1,0]
    v_pk_fma_f32 v[144:145], v[144:145], s[84:85], s[84:85] op_sel:[0,1,0] op_sel_hi:[1,1,0]
    v_pk_fma_f32 v[146:147], v[146:147], s[84:85], s[84:85] op_sel:[0,1,0] op_sel_hi:[1,1,0]
    global_load_dwordx4 a[48:51], v4, s[8:9] offset:2048 sc1
    v_pk_fma_f32 v[148:149], v[148:149], s[84:85], s[84:85] op_sel:[0,1,0] op_sel_hi:[1,1,0]
    v_pk_fma_f32 v[150:151], v[150:151], s[84:85], s[84:85] op_sel:[0,1,0] op_sel_hi:[1,1,0]
    v_pk_fma_f32 v[152:153], v[152:153], s[84:85], s[84:85] op_sel:[0,1,0] op_sel_hi:[1,1,0]
    v_pk_fma_f32 v[154:155], v[154:155], s[84:85], s[84:85] op_sel:[0,1,0] op_sel_hi:[1,1,0]
    v_pk_fma_f32 v[156:157], v[156:157], s[84:85], s[84:85] op_sel:[0,1,0] op_sel_hi:[1,1,0]
    global_load_dwordx4 a[52:55], v7, s[14:15] offset:2048 sc1
    v_pk_fma_f32 v[158:159], v[158:159], s[84:85], s[84:85] op_sel:[0,1,0] op_sel_hi:[1,1,0]
    v_pk_fma_f32 v[160:161], v[160:161], s[84:85], s[84:85] op_sel:[0,1,0] op_sel_hi:[1,1,0]
    v_pk_mul_f32 v[130:131], v[130:131], v[178:179] op_sel:[0,0] op_sel_hi:[1,1]
    v_pk_mul_f32 v[132:133], v[132:133], v[180:181] op_sel:[0,0] op_sel_hi:[1,1]
    v_pk_mul_f32 v[134:135], v[134:135], v[182:183] op_sel:[0,0] op_sel_hi:[1,1]
    global_load_dwordx4 a[56:59], v4, s[8:9] offset:3072 sc1
    v_pk_mul_f32 v[136:137], v[136:137], v[184:185] op_sel:[0,0] op_sel_hi:[1,1]
    v_pk_mul_f32 v[138:139], v[138:139], v[186:187] op_sel:[0,0] op_sel_hi:[1,1]
    v_pk_mul_f32 v[140:141], v[140:141], v[188:189] op_sel:[0,0] op_sel_hi:[1,1]
    v_pk_mul_f32 v[142:143], v[142:143], v[190:191] op_sel:[0,0] op_sel_hi:[1,1]
    v_pk_mul_f32 v[144:145], v[144:145], v[192:193] op_sel:[0,0] op_sel_hi:[1,1]
    global_load_dwordx4 a[60:63], v7, s[14:15] offset:3072 sc1
    v_pk_mul_f32 v[146:147], v[146:147], v[194:195] op_sel:[0,0] op_sel_hi:[1,1]
    v_pk_mul_f32 v[148:149], v[148:149], v[196:197] op_sel:[0,0] op_sel_hi:[1,1]
    v_pk_mul_f32 v[150:151], v[150:151], v[198:199] op_sel:[0,0] op_sel_hi:[1,1]
    v_pk_mul_f32 v[152:153], v[152:153], v[200:201] op_sel:[0,0] op_sel_hi:[1,1]
    v_pk_mul_f32 v[154:155], v[154:155], v[202:203] op_sel:[0,0] op_sel_hi:[1,1]
    global_load_dwordx4 a[64:67], v4, s[10:11] offset:-4096 sc1
    v_pk_mul_f32 v[156:157], v[156:157], v[204:205] op_sel:[0,0] op_sel_hi:[1,1]
    v_pk_mul_f32 v[158:159], v[158:159], v[206:207] op_sel:[0,0] op_sel_hi:[1,1]
    v_pk_mul_f32 v[160:161], v[160:161], v[208:209] op_sel:[0,0] op_sel_hi:[1,1]
    v_exp_f32 v130, v130
    v_exp_f32 v131, v131
    global_load_dwordx4 a[68:71], v7, s[16:17] offset:-4096 sc1
    v_exp_f32 v132, v132
    v_exp_f32 v133, v133
    v_exp_f32 v134, v134
    v_exp_f32 v135, v135
    v_exp_f32 v136, v136
    global_load_dwordx4 a[72:75], v4, s[10:11] offset:-3072 sc1
    v_exp_f32 v137, v137
    v_exp_f32 v138, v138
    v_exp_f32 v139, v139
    v_exp_f32 v140, v140
    v_exp_f32 v141, v141
    v_exp_f32 v142, v142
    global_load_dwordx4 a[76:79], v7, s[16:17] offset:-3072 sc1
    v_exp_f32 v143, v143
    v_exp_f32 v144, v144
    v_exp_f32 v145, v145
    v_exp_f32 v146, v146
    v_exp_f32 v147, v147
    global_load_dwordx4 a[80:83], v4, s[10:11] offset:-2048 sc1
    v_exp_f32 v148, v148
    v_exp_f32 v149, v149
    v_exp_f32 v150, v150
    v_exp_f32 v151, v151
    v_exp_f32 v152, v152
    global_load_dwordx4 a[84:87], v7, s[16:17] offset:-2048 sc1
    v_exp_f32 v153, v153
    v_exp_f32 v154, v154
    v_exp_f32 v155, v155
    v_exp_f32 v156, v156
    v_exp_f32 v157, v157
    global_load_dwordx4 a[88:91], v4, s[10:11] offset:-1024 sc1
    v_exp_f32 v158, v158
    v_exp_f32 v159, v159
    v_exp_f32 v160, v160
    v_exp_f32 v161, v161
    v_pk_add_f32 v[130:131], v[130:131], 1.0 op_sel:[0,0] op_sel_hi:[1,0]
    global_load_dwordx4 a[92:95], v7, s[16:17] offset:-1024 sc1
    v_pk_add_f32 v[132:133], v[132:133], 1.0 op_sel:[0,0] op_sel_hi:[1,0]
    v_pk_add_f32 v[134:135], v[134:135], 1.0 op_sel:[0,0] op_sel_hi:[1,0]
    v_pk_add_f32 v[136:137], v[136:137], 1.0 op_sel:[0,0] op_sel_hi:[1,0]
    v_pk_add_f32 v[138:139], v[138:139], 1.0 op_sel:[0,0] op_sel_hi:[1,0]
    v_pk_add_f32 v[140:141], v[140:141], 1.0 op_sel:[0,0] op_sel_hi:[1,0]
    global_load_dwordx4 a[96:99], v4, s[10:11] offset:0 sc1
    v_pk_add_f32 v[142:143], v[142:143], 1.0 op_sel:[0,0] op_sel_hi:[1,0]
    v_pk_add_f32 v[144:145], v[144:145], 1.0 op_sel:[0,0] op_sel_hi:[1,0]
    v_pk_add_f32 v[146:147], v[146:147], 1.0 op_sel:[0,0] op_sel_hi:[1,0]
    v_pk_add_f32 v[148:149], v[148:149], 1.0 op_sel:[0,0] op_sel_hi:[1,0]
    v_pk_add_f32 v[150:151], v[150:151], 1.0 op_sel:[0,0] op_sel_hi:[1,0]
    global_load_dwordx4 a[100:103], v7, s[16:17] offset:0 sc1
    v_pk_add_f32 v[152:153], v[152:153], 1.0 op_sel:[0,0] op_sel_hi:[1,0]
    v_pk_add_f32 v[154:155], v[154:155], 1.0 op_sel:[0,0] op_sel_hi:[1,0]
    v_pk_add_f32 v[156:157], v[156:157], 1.0 op_sel:[0,0] op_sel_hi:[1,0]
    v_pk_add_f32 v[158:159], v[158:159], 1.0 op_sel:[0,0] op_sel_hi:[1,0]
    v_pk_add_f32 v[160:161], v[160:161], 1.0 op_sel:[0,0] op_sel_hi:[1,0]
    v_rcp_f32 v130, v130
    global_load_dwordx4 a[104:107], v4, s[10:11] offset:1024 sc1
    v_rcp_f32 v131, v131
    v_rcp_f32 v132, v132
    v_rcp_f32 v133, v133
    v_rcp_f32 v134, v134
    v_rcp_f32 v135, v135
    global_load_dwordx4 a[108:111], v7, s[16:17] offset:1024 sc1
    v_rcp_f32 v136, v136
    v_rcp_f32 v137, v137
    v_rcp_f32 v138, v138
    v_rcp_f32 v139, v139
    v_rcp_f32 v140, v140
    global_load_dwordx4 a[112:115], v4, s[10:11] offset:2048 sc1
    v_rcp_f32 v141, v141
    v_rcp_f32 v142, v142
    v_rcp_f32 v143, v143
    v_rcp_f32 v144, v144
    v_rcp_f32 v145, v145
    global_load_dwordx4 a[116:119], v7, s[16:17] offset:2048 sc1
    v_rcp_f32 v146, v146
    v_rcp_f32 v147, v147
    v_rcp_f32 v148, v148
    v_rcp_f32 v149, v149
    v_rcp_f32 v150, v150
    global_load_dwordx4 a[120:123], v4, s[10:11] offset:3072 sc1
    v_rcp_f32 v151, v151
    v_rcp_f32 v152, v152
    v_rcp_f32 v153, v153
    v_rcp_f32 v154, v154
    v_rcp_f32 v155, v155
    global_load_dwordx4 a[124:127], v7, s[16:17] offset:3072 sc1
    v_rcp_f32 v156, v156
    v_rcp_f32 v157, v157
    v_rcp_f32 v158, v158
    v_rcp_f32 v159, v159
    v_rcp_f32 v160, v160
    global_load_dwordx4 a[128:131], v4, s[12:13] offset:-4096 sc1
    v_rcp_f32 v161, v161
    v_pk_mul_f32 v[178:179], v[178:179], v[130:131] op_sel:[0,0] op_sel_hi:[1,1]
    v_pk_mul_f32 v[180:181], v[180:181], v[132:133] op_sel:[0,0] op_sel_hi:[1,1]
    v_pk_mul_f32 v[182:183], v[182:183], v[134:135] op_sel:[0,0] op_sel_hi:[1,1]
    v_pk_mul_f32 v[184:185], v[184:185], v[136:137] op_sel:[0,0] op_sel_hi:[1,1]
    global_load_dwordx4 a[132:135], v7, s[18:19] offset:-4096 sc1
    v_pk_mul_f32 v[186:187], v[186:187], v[138:139] op_sel:[0,0] op_sel_hi:[1,1]
    v_pk_mul_f32 v[188:189], v[188:189], v[140:141] op_sel:[0,0] op_sel_hi:[1,1]
    v_pk_mul_f32 v[190:191], v[190:191], v[142:143] op_sel:[0,0] op_sel_hi:[1,1]
    v_pk_mul_f32 v[192:193], v[192:193], v[144:145] op_sel:[0,0] op_sel_hi:[1,1]
    v_pk_mul_f32 v[194:195], v[194:195], v[146:147] op_sel:[0,0] op_sel_hi:[1,1]
    v_pk_mul_f32 v[196:197], v[196:197], v[148:149] op_sel:[0,0] op_sel_hi:[1,1]
    global_load_dwordx4 a[136:139], v4, s[12:13] offset:-3072 sc1
    v_pk_mul_f32 v[198:199], v[198:199], v[150:151] op_sel:[0,0] op_sel_hi:[1,1]
    v_pk_mul_f32 v[200:201], v[200:201], v[152:153] op_sel:[0,0] op_sel_hi:[1,1]
    v_pk_mul_f32 v[202:203], v[202:203], v[154:155] op_sel:[0,0] op_sel_hi:[1,1]
    v_pk_mul_f32 v[204:205], v[204:205], v[156:157] op_sel:[0,0] op_sel_hi:[1,1]
    v_pk_mul_f32 v[206:207], v[206:207], v[158:159] op_sel:[0,0] op_sel_hi:[1,1]
    global_load_dwordx4 a[140:143], v7, s[18:19] offset:-3072 sc1
    v_pk_mul_f32 v[208:209], v[208:209], v[160:161] op_sel:[0,0] op_sel_hi:[1,1]
    v_pk_add_f32 v[130:131], v[178:179], v[194:195] op_sel:[0,0] op_sel_hi:[1,1]
    v_pk_mul_f32 v[146:147], v[178:179], v[178:179] op_sel:[0,0] op_sel_hi:[1,1]
    v_pk_add_f32 v[132:133], v[180:181], v[196:197] op_sel:[0,0] op_sel_hi:[1,1]
    v_pk_mul_f32 v[148:149], v[180:181], v[180:181] op_sel:[0,0] op_sel_hi:[1,1]
    global_load_dwordx4 a[144:147], v4, s[12:13] offset:-2048 sc1
    v_pk_add_f32 v[134:135], v[182:183], v[198:199] op_sel:[0,0] op_sel_hi:[1,1]
    v_pk_mul_f32 v[150:151], v[182:183], v[182:183] op_sel:[0,0] op_sel_hi:[1,1]
    v_pk_add_f32 v[136:137], v[184:185], v[200:201] op_sel:[0,0] op_sel_hi:[1,1]
    v_pk_mul_f32 v[152:153], v[184:185], v[184:185] op_sel:[0,0] op_sel_hi:[1,1]
    v_pk_add_f32 v[138:139], v[186:187], v[202:203] op_sel:[0,0] op_sel_hi:[1,1]
    global_load_dwordx4 a[148:151], v7, s[18:19] offset:-2048 sc1
    v_pk_mul_f32 v[154:155], v[186:187], v[186:187] op_sel:[0,0] op_sel_hi:[1,1]
    v_pk_add_f32 v[140:141], v[188:189], v[204:205] op_sel:[0,0] op_sel_hi:[1,1]
    v_pk_mul_f32 v[156:157], v[188:189], v[188:189] op_sel:[0,0] op_sel_hi:[1,1]
    v_pk_add_f32 v[142:143], v[190:191], v[206:207] op_sel:[0,0] op_sel_hi:[1,1]
    v_pk_mul_f32 v[158:159], v[190:191], v[190:191] op_sel:[0,0] op_sel_hi:[1,1]
    global_load_dwordx4 a[152:155], v4, s[12:13] offset:-1024 sc1
    v_pk_add_f32 v[144:145], v[192:193], v[208:209] op_sel:[0,0] op_sel_hi:[1,1]
    v_pk_mul_f32 v[160:161], v[192:193], v[192:193] op_sel:[0,0] op_sel_hi:[1,1]
    v_pk_fma_f32 v[146:147], v[194:195], v[194:195], v[146:147] op_sel:[0,0,0] op_sel_hi:[1,1,1]
    v_pk_fma_f32 v[148:149], v[196:197], v[196:197], v[148:149] op_sel:[0,0,0] op_sel_hi:[1,1,1]
    v_pk_fma_f32 v[150:151], v[198:199], v[198:199], v[150:151] op_sel:[0,0,0] op_sel_hi:[1,1,1]
    global_load_dwordx4 a[156:159], v7, s[18:19] offset:-1024 sc1
    v_pk_fma_f32 v[152:153], v[200:201], v[200:201], v[152:153] op_sel:[0,0,0] op_sel_hi:[1,1,1]
    v_pk_fma_f32 v[154:155], v[202:203], v[202:203], v[154:155] op_sel:[0,0,0] op_sel_hi:[1,1,1]
    v_pk_fma_f32 v[156:157], v[204:205], v[204:205], v[156:157] op_sel:[0,0,0] op_sel_hi:[1,1,1]
    v_pk_fma_f32 v[158:159], v[206:207], v[206:207], v[158:159] op_sel:[0,0,0] op_sel_hi:[1,1,1]
    v_pk_fma_f32 v[160:161], v[208:209], v[208:209], v[160:161] op_sel:[0,0,0] op_sel_hi:[1,1,1]
    s_waitcnt lgkmcnt(0)
    s_add_u32 m0, s89, 0
    s_nop 0
    global_load_lds_dwordx4 v74, s[72:73]
    v_add_f32_dpp v98, v130, v130 row_ror:8 row_mask:0xf bank_mask:0x3
    v_add_f32_dpp v99, v131, v131 row_ror:8 row_mask:0xf bank_mask:0x3
    v_add_f32_dpp v100, v132, v132 row_ror:8 row_mask:0xf bank_mask:0x3
    v_add_f32_dpp v101, v133, v133 row_ror:8 row_mask:0xf bank_mask:0x3
    v_add_f32_dpp v102, v134, v134 row_ror:8 row_mask:0xf bank_mask:0x3
    v_add_f32_dpp v103, v135, v135 row_ror:8 row_mask:0xf bank_mask:0x3
    s_add_u32 m0, s89, 1024
    s_nop 0
    global_load_lds_dwordx4 v75, s[72:73]
    v_add_f32_dpp v104, v136, v136 row_ror:8 row_mask:0xf bank_mask:0x3
    v_add_f32_dpp v105, v137, v137 row_ror:8 row_mask:0xf bank_mask:0x3
    v_add_f32_dpp v106, v138, v138 row_ror:8 row_mask:0xf bank_mask:0x3
    v_add_f32_dpp v107, v139, v139 row_ror:8 row_mask:0xf bank_mask:0x3
    v_add_f32_dpp v108, v140, v140 row_ror:8 row_mask:0xf bank_mask:0x3
    s_add_u32 m0, s89, 2048
    s_nop 0
    global_load_lds_dwordx4 v76, s[72:73]
    v_add_f32_dpp v109, v141, v141 row_ror:8 row_mask:0xf bank_mask:0x3
    v_add_f32_dpp v110, v142, v142 row_ror:8 row_mask:0xf bank_mask:0x3
    v_add_f32_dpp v111, v143, v143 row_ror:8 row_mask:0xf bank_mask:0x3
    v_add_f32_dpp v112, v144, v144 row_ror:8 row_mask:0xf bank_mask:0x3
    v_add_f32_dpp v113, v145, v145 row_ror:8 row_mask:0xf bank_mask:0x3
    s_add_u32 m0, s89, 3072
    s_nop 0
    global_load_lds_dwordx4 v77, s[72:73]
    v_add_f32_dpp v98, v146, v146 row_ror:8 row_mask:0xf bank_mask:0xc
    v_add_f32_dpp v99, v147, v147 row_ror:8 row_mask:0xf bank_mask:0xc
    v_add_f32_dpp v100, v148, v148 row_ror:8 row_mask:0xf bank_mask:0xc
    v_add_f32_dpp v101, v149, v149 row_ror:8 row_mask:0xf bank_mask:0xc
    v_add_f32_dpp v102, v150, v150 row_ror:8 row_mask:0xf bank_mask:0xc
    s_add_u32 m0, s89, 4096
    s_nop 0
    global_load_lds_dwordx4 v78, s[72:73]
    v_add_f32_dpp v103, v151, v151 row_ror:8 row_mask:0xf bank_mask:0xc
    v_add_f32_dpp v104, v152, v152 row_ror:8 row_mask:0xf bank_mask:0xc
    v_add_f32_dpp v105, v153, v153 row_ror:8 row_mask:0xf bank_mask:0xc
    v_add_f32_dpp v106, v154, v154 row_ror:8 row_mask:0xf bank_mask:0xc
    v_add_f32_dpp v107, v155, v155 row_ror:8 row_mask:0xf bank_mask:0xc
    s_add_u32 m0, s89, 5120
    s_nop 0
    global_load_lds_dwordx4 v79, s[72:73]
    v_add_f32_dpp v108, v156, v156 row_ror:8 row_mask:0xf bank_mask:0xc
    v_add_f32_dpp v109, v157, v157 row_ror:8 row_mask:0xf bank_mask:0xc
    v_add_f32_dpp v110, v158, v158 row_ror:8 row_mask:0xf bank_mask:0xc
    v_add_f32_dpp v111, v159, v159 row_ror:8 row_mask:0xf bank_mask:0xc
    v_add_f32_dpp v112, v160, v160 row_ror:8 row_mask:0xf bank_mask:0xc
    s_add_u32 m0, s89, 6144
    s_nop 0
    global_load_lds_dwordx4 v80, s[72:73]
    v_add_f32_dpp v113, v161, v161 row_ror:8 row_mask:0xf bank_mask:0xc
    v_add_f32_dpp v130, v98, v98 row_half_mirror row_mask:0xf bank_mask:0x5
    v_add_f32_dpp v131, v99, v99 row_half_mirror row_mask:0xf bank_mask:0x5
    v_add_f32_dpp v132, v100, v100 row_half_mirror row_mask:0xf bank_mask:0x5
    v_add_f32_dpp v133, v101, v101 row_half_mirror row_mask:0xf bank_mask:0x5
    s_add_u32 m0, s89, 7168
    s_nop 0
    global_load_lds_dwordx4 v81, s[72:73]
    v_add_f32_dpp v134, v102, v102 row_half_mirror row_mask:0xf bank_mask:0x5
    v_add_f32_dpp v135, v103, v103 row_half_mirror row_mask:0xf bank_mask:0x5
    v_add_f32_dpp v136, v104, v104 row_half_mirror row_mask:0xf bank_mask:0x5
    v_add_f32_dpp v137, v105, v105 row_half_mirror row_mask:0xf bank_mask:0x5
    v_add_f32_dpp v130, v106, v106 row_half_mirror row_mask:0xf bank_mask:0xa
    v_add_f32_dpp v131, v107, v107 row_half_mirror row_mask:0xf bank_mask:0xa
    v_add_f32_dpp v132, v108, v108 row_half_mirror row_mask:0xf bank_mask:0xa
    v_add_f32_dpp v133, v109, v109 row_half_mirror row_mask:0xf bank_mask:0xa
    v_add_f32_dpp v134, v110, v110 row_half_mirror row_mask:0xf bank_mask:0xa
    v_add_f32_dpp v135, v111, v111 row_half_mirror row_mask:0xf bank_mask:0xa
    v_add_f32_dpp v136, v112, v112 row_half_mirror row_mask:0xf bank_mask:0xa
    v_add_f32_dpp v137, v113, v113 row_half_mirror row_mask:0xf bank_mask:0xa
    v_add_f32_dpp v130, v130, v130 quad_perm:[1,0,3,2] row_mask:0xf bank_mask:0xf
    v_add_f32_dpp v131, v131, v131 quad_perm:[1,0,3,2] row_mask:0xf bank_mask:0xf
    v_add_f32_dpp v132, v132, v132 quad_perm:[1,0,3,2] row_mask:0xf bank_mask:0xf
    v_add_f32_dpp v133, v133, v133 quad_perm:[1,0,3,2] row_mask:0xf bank_mask:0xf
    v_add_f32_dpp v134, v134, v134 quad_perm:[1,0,3,2] row_mask:0xf bank_mask:0xf
    v_add_f32_dpp v135, v135, v135 quad_perm:[1,0,3,2] row_mask:0xf bank_mask:0xf
    v_add_f32_dpp v136, v136, v136 quad_perm:[1,0,3,2] row_mask:0xf bank_mask:0xf
    v_add_f32_dpp v137, v137, v137 quad_perm:[1,0,3,2] row_mask:0xf bank_mask:0xf
    v_add_f32_dpp v130, v130, v130 quad_perm:[2,3,0,1] row_mask:0xf bank_mask:0xf
    v_add_f32_dpp v131, v131, v131 quad_perm:[2,3,0,1] row_mask:0xf bank_mask:0xf
    v_add_f32_dpp v132, v132, v132 quad_perm:[2,3,0,1] row_mask:0xf bank_mask:0xf
    v_add_f32_dpp v133, v133, v133 quad_perm:[2,3,0,1] row_mask:0xf bank_mask:0xf
    v_add_f32_dpp v134, v134, v134 quad_perm:[2,3,0,1] row_mask:0xf bank_mask:0xf
    v_add_f32_dpp v135, v135, v135 quad_perm:[2,3,0,1] row_mask:0xf bank_mask:0xf
    v_add_f32_dpp v136, v136, v136 quad_perm:[2,3,0,1] row_mask:0xf bank_mask:0xf
    v_add_f32_dpp v137, v137, v137 quad_perm:[2,3,0,1] row_mask:0xf bank_mask:0xf
    v_lshrrev_b32 v28, 2, v2
    v_lshl_add_u32 v28, v28, 7, v171
    ds_write_b128 v28, v[130:133]
    ds_write_b128 v28, v[134:137] offset:16
    s_waitcnt lgkmcnt(0)
    s_barrier
    v_lshlrev_b32 v28, 2, v1
    v_add_u32 v28, 150784, v28
    ds_read2st64_b32 v[90:91], v28 offset0:0 offset1:1
    ds_read2st64_b32 v[92:93], v28 offset0:2 offset1:3
    ds_read2st64_b32 v[94:95], v28 offset0:4 offset1:5
    ds_read2st64_b32 v[96:97], v28 offset0:6 offset1:7
    s_lshl_b32 s4, s40, 12
    s_add_u32 s4, s4, 12451840
    v_add_u32 v174, s4, v30
    s_lshl_b32 s4, s41, 9
    v_add_u32 v28, s4, v174
    v_subrev_u32 v170, 2048, v170
    v_subrev_u32 v171, 2048, v171
    s_waitcnt lgkmcnt(2)
    v_pk_add_f32 v[90:91], v[90:91], v[92:93] op_sel:[0,0] op_sel_hi:[1,1]
    s_waitcnt lgkmcnt(0)
    v_pk_add_f32 v[94:95], v[94:95], v[96:97] op_sel:[0,0] op_sel_hi:[1,1]
    v_pk_add_f32 v[90:91], v[90:91], v[94:95] op_sel:[0,0] op_sel_hi:[1,1]
    v_min_u32 v90, -2, v90
    v_min_u32 v91, -2, v91
    s_lshl_b32 s4, s3, 4
    s_lshl_b64 exec, 0xffff, s4
    global_store_dwordx2 v28, v[90:91], s[38:39] sc1
    s_mov_b64 exec, -1
    ds_read_b128 v[48:51], v4 offset:0
    ds_read_b128 v[52:55], v4 offset:1040
    ds_read_b128 v[56:59], v4 offset:2080
    ds_read_b128 v[60:63], v4 offset:3120
    ds_read_b128 v[64:67], v4 offset:4160
    s_waitcnt lgkmcnt(3)
    s_waitcnt vmcnt(48)
    v_mfma_f32_16x16x32_bf16 v[210:213], a[0:3], v[48:51], 0
    ds_read_b128 a[192:195], v82 offset:8192
    ds_read_b128 v[68:71], v4 offset:5200
    s_waitcnt vmcnt(47)
    v_mfma_f32_16x16x32_bf16 v[226:229], a[4:7], v[48:51], 0
    ds_read_b128 a[196:199], v84 offset:8192
    v_mfma_f32_16x16x32_bf16 v[214:217], a[0:3], v[52:55], 0
    v_min_u32 v175, 26, v1
    ds_read_b128 v[48:51], v4 offset:6240
    v_mfma_f32_16x16x32_bf16 v[230:233], a[4:7], v[52:55], 0
    ds_read_b128 a[200:203], v86 offset:8192
    v_lshlrev_b32 v175, 2, v175
    s_waitcnt lgkmcnt(6)
    v_mfma_f32_16x16x32_bf16 v[218:221], a[0:3], v[56:59], 0
    ds_read_b128 a[204:207], v88 offset:8192
    v_add_u32 v175, 98304, v175
    ds_read_b128 v[52:55], v4 offset:7280
    v_mfma_f32_16x16x32_bf16 v[234:237], a[4:7], v[56:59], 0
    global_load_dword v250, v175, s[38:39] sc1
    v_mfma_f32_16x16x32_bf16 v[222:225], a[0:3], v[60:63], 0
    ds_read_b128 a[208:211], v83 offset:8192
    ds_read_b128 v[56:59], v4 offset:8320
    v_mfma_f32_16x16x32_bf16 v[238:241], a[4:7], v[60:63], 0
    ds_read_b128 a[212:215], v85 offset:8192
    s_mul_i32 s7, s41, 320
    s_add_u32 s7, s7, 12800
    v_min_u32 v175, 304, v4
    s_waitcnt lgkmcnt(8)
    s_waitcnt vmcnt(47)
    v_mfma_f32_16x16x32_bf16 v[210:213], a[8:11], v[64:67], v[210:213]
    v_add_u32 v175, s7, v175
    ds_read_b128 v[60:63], v4 offset:9360
    s_waitcnt vmcnt(46)
    v_mfma_f32_16x16x32_bf16 v[226:229], a[12:15], v[64:67], v[226:229]
    ds_read_b128 a[216:219], v87 offset:8192
    global_load_dwordx4 v[242:245], v175, s[38:39] sc1
    v_mfma_f32_16x16x32_bf16 v[214:217], a[8:11], v[68:71], v[214:217]
    ds_read_b128 a[220:223], v89 offset:8192
    ds_read_b128 v[64:67], v4 offset:10400
    v_mfma_f32_16x16x32_bf16 v[230:233], a[12:15], v[68:71], v[230:233]
    v_add_u32 v175, 15360, v175
    s_waitcnt lgkmcnt(7)
    v_mfma_f32_16x16x32_bf16 v[218:221], a[8:11], v[48:51], v[218:221]
    s_waitcnt lgkmcnt(1)
    s_add_u32 m0, s89, 8192
    s_nop 0
    global_load_lds_dwordx4 v74, s[74:75]
    global_load_dwordx4 v[246:249], v175, s[38:39] sc1
    ds_read_b128 v[68:71], v4 offset:11440
    v_mfma_f32_16x16x32_bf16 v[234:237], a[12:15], v[48:51], v[234:237]
    s_add_u32 m0, s89, 9216
    s_nop 0
    global_load_lds_dwordx4 v75, s[74:75]
    v_add_u32 v175, 99328, v4
    v_mfma_f32_16x16x32_bf16 v[222:225], a[8:11], v[52:55], v[222:225]
    ds_read_b128 v[48:51], v4 offset:12480
    v_mfma_f32_16x16x32_bf16 v[238:241], a[12:15], v[52:55], v[238:241]
    s_add_u32 m0, s89, 10240
    s_nop 0
    global_load_lds_dwordx4 v76, s[74:75]
    global_load_dwordx4 v[94:97], v175, s[38:39] sc1
    s_waitcnt vmcnt(51)
    v_mfma_f32_16x16x32_bf16 v[210:213], a[16:19], v[56:59], v[210:213]
    s_add_u32 m0, s89, 11264
    s_nop 0
    global_load_lds_dwordx4 v77, s[74:75]
    s_lshr_b32 s5, s3, 1
    s_lshl_b32 s5, s5, 5
    s_and_b32 s6, s3, 1
    s_lshl_b32 s6, s6, 2
    s_add_u32 s6, s6, s5
    s_lshl_b32 s5, s40, 6
    s_add_u32 s90, s6, s5
    v_add_lshl_u32 v28, v5, s90, 1
    ds_read_b128 v[52:55], v4 offset:13520
    s_waitcnt vmcnt(51)
    v_mfma_f32_16x16x32_bf16 v[226:229], a[20:23], v[56:59], v[226:229]
    global_load_ushort v32, v28, s[26:27]
    v_mfma_f32_16x16x32_bf16 v[214:217], a[16:19], v[60:63], v[214:217]
    s_add_u32 m0, s89, 12288
    s_nop 0
    global_load_lds_dwordx4 v78, s[74:75]
    ds_read_b128 v[56:59], v4 offset:14560
    v_mfma_f32_16x16x32_bf16 v[230:233], a[20:23], v[60:63], v[230:233]
    s_add_u32 m0, s89, 13312
    s_nop 0
    global_load_lds_dwordx4 v79, s[74:75]
    s_mul_i32 s5, s41, 10
    s_mul_i32 s6, s3, 1040
    v_add_u32 v28, s5, v3
    s_waitcnt lgkmcnt(3)
    v_mfma_f32_16x16x32_bf16 v[218:221], a[16:19], v[64:67], v[218:221]
    s_add_u32 s5, s5, 4
    v_lshrrev_b32 v29, 2, v28
    ds_read_b128 v[60:63], v4 offset:15600
    v_mfma_f32_16x16x32_bf16 v[234:237], a[20:23], v[64:67], v[234:237]
    s_add_u32 m0, s89, 14336
    s_nop 0
    global_load_lds_dwordx4 v80, s[74:75]
    v_mul_u32_u24 v29, 4160, v29
    v_mfma_f32_16x16x32_bf16 v[222:225], a[16:19], v[68:71], v[222:225]
    s_add_u32 m0, s89, 15360
    s_nop 0
    global_load_lds_dwordx4 v81, s[74:75]
    ds_read_b128 v[64:67], v4 offset:16640
    v_mfma_f32_16x16x32_bf16 v[238:241], a[20:23], v[68:71], v[238:241]
    v_and_b32 v28, 3, v28
    s_waitcnt lgkmcnt(3)
    s_waitcnt vmcnt(55)
    v_mfma_f32_16x16x32_bf16 v[210:213], a[24:27], v[48:51], v[210:213]
    s_waitcnt vmcnt(14)
    ds_read_b128 a[224:227], v82 offset:0
    v_lshl_add_u32 v29, v28, 8, v29
    ds_read_b128 v[68:71], v4 offset:17680
    v_mfma_f32_16x16x32_bf16 v[226:229], a[28:31], v[48:51], v[226:229]
    ds_read_b128 a[228:231], v84 offset:0
    v_lshl_add_u32 v29, v2, 4, v29
    v_mfma_f32_16x16x32_bf16 v[214:217], a[24:27], v[52:55], v[214:217]
    v_add_u32 v29, s6, v29
    ds_read_b128 v[48:51], v4 offset:18720
    v_mfma_f32_16x16x32_bf16 v[230:233], a[28:31], v[52:55], v[230:233]
    ds_read_b128 a[232:235], v86 offset:0
    s_waitcnt lgkmcnt(6)
    v_mfma_f32_16x16x32_bf16 v[218:221], a[24:27], v[56:59], v[218:221]
    ds_read_b128 a[236:239], v88 offset:0
    ds_read_b128 v[36:39], v29 offset:0
    ds_read_b128 v[52:55], v4 offset:19760
    v_mfma_f32_16x16x32_bf16 v[234:237], a[28:31], v[56:59], v[234:237]
    v_add_u32 v28, s5, v3
    v_mfma_f32_16x16x32_bf16 v[222:225], a[24:27], v[60:63], v[222:225]
    ds_read_b128 a[240:243], v83 offset:0
    s_add_u32 s5, s5, 4
    v_lshrrev_b32 v29, 2, v28
    ds_read_b128 v[56:59], v4 offset:20800
    v_mfma_f32_16x16x32_bf16 v[238:241], a[28:31], v[60:63], v[238:241]
    s_waitcnt lgkmcnt(8)
    v_mfma_f32_16x16x32_bf16 v[210:213], a[32:35], v[64:67], v[210:213]
    ds_read_b128 a[244:247], v85 offset:0
    v_mul_u32_u24 v29, 4160, v29
    ds_read_b128 v[60:63], v4 offset:21840
    v_mfma_f32_16x16x32_bf16 v[226:229], a[36:39], v[64:67], v[226:229]
    ds_read_b128 a[248:251], v87 offset:0
    v_and_b32 v28, 3, v28
    v_mfma_f32_16x16x32_bf16 v[214:217], a[32:35], v[68:71], v[214:217]
    v_lshl_add_u32 v29, v28, 8, v29
    ds_read_b128 v[64:67], v4 offset:22880
    v_mfma_f32_16x16x32_bf16 v[230:233], a[36:39], v[68:71], v[230:233]
    ds_read_b128 a[252:255], v89 offset:0
    s_waitcnt lgkmcnt(7)
    v_mfma_f32_16x16x32_bf16 v[218:221], a[32:35], v[48:51], v[218:221]
    v_lshl_add_u32 v29, v2, 4, v29
    ds_read_b128 v[68:71], v4 offset:23920
    v_mfma_f32_16x16x32_bf16 v[234:237], a[36:39], v[48:51], v[234:237]
    s_waitcnt lgkmcnt(1)
    s_add_u32 m0, s89, 0
    s_nop 0
    global_load_lds_dwordx4 v74, s[76:77]
    v_add_u32 v29, s6, v29
    v_mfma_f32_16x16x32_bf16 v[222:225], a[32:35], v[52:55], v[222:225]
    s_add_u32 m0, s89, 1024
    s_nop 0
    global_load_lds_dwordx4 v75, s[76:77]
    ds_read_b128 v[40:43], v29 offset:0
    ds_read_b128 v[48:51], v4 offset:24960
    v_mfma_f32_16x16x32_bf16 v[238:241], a[36:39], v[52:55], v[238:241]
    v_mfma_f32_16x16x32_bf16 v[210:213], a[40:43], v[56:59], v[210:213]
    s_add_u32 m0, s89, 2048
    s_nop 0
    global_load_lds_dwordx4 v76, s[76:77]
    v_lshrrev_b32 v28, 1, v3
    ds_read_b128 v[52:55], v4 offset:26000
    v_mfma_f32_16x16x32_bf16 v[226:229], a[44:47], v[56:59], v[226:229]
    s_add_u32 m0, s89, 3072
    s_nop 0
    global_load_lds_dwordx4 v77, s[76:77]
    v_add_u32 v28, s5, v28
    v_mfma_f32_16x16x32_bf16 v[214:217], a[40:43], v[60:63], v[214:217]
    s_add_u32 s5, s5, 4
    v_lshrrev_b32 v29, 2, v28
    ds_read_b128 v[56:59], v4 offset:27040
    v_mfma_f32_16x16x32_bf16 v[230:233], a[44:47], v[60:63], v[230:233]
    s_add_u32 m0, s89, 4096
    s_nop 0
    global_load_lds_dwordx4 v78, s[76:77]
    s_waitcnt lgkmcnt(4)
    v_mfma_f32_16x16x32_bf16 v[218:221], a[40:43], v[64:67], v[218:221]
    v_mul_u32_u24 v29, 4160, v29
    ds_read_b128 v[60:63], v4 offset:28080
    v_mfma_f32_16x16x32_bf16 v[234:237], a[44:47], v[64:67], v[234:237]
    s_add_u32 m0, s89, 5120
    s_nop 0
    global_load_lds_dwordx4 v79, s[76:77]
    v_and_b32 v28, 3, v28
    v_mfma_f32_16x16x32_bf16 v[222:225], a[40:43], v[68:71], v[222:225]
    s_add_u32 m0, s89, 6144
    s_nop 0
    global_load_lds_dwordx4 v80, s[76:77]
    v_lshl_add_u32 v29, v28, 8, v29
    ds_read_b128 v[64:67], v4 offset:29120
    v_mfma_f32_16x16x32_bf16 v[238:241], a[44:47], v[68:71], v[238:241]
    v_lshl_add_u32 v29, v2, 4, v29
    s_waitcnt lgkmcnt(3)
    v_mfma_f32_16x16x32_bf16 v[210:213], a[48:51], v[48:51], v[210:213]
    s_add_u32 m0, s89, 7168
    s_nop 0
    global_load_lds_dwordx4 v81, s[76:77]
    ds_read_b128 v[68:71], v4 offset:30160
    v_mfma_f32_16x16x32_bf16 v[226:229], a[52:55], v[48:51], v[226:229]
    v_add_u32 v29, s6, v29
    v_mfma_f32_16x16x32_bf16 v[214:217], a[48:51], v[52:55], v[214:217]
    s_waitcnt vmcnt(8)
    ds_read_b128 a[0:3], v82 offset:8192
    v_and_b32 v28, 1, v3
    ds_read_b128 v[48:51], v4 offset:31200
    v_mfma_f32_16x16x32_bf16 v[230:233], a[52:55], v[52:55], v[230:233]
    ds_read_b128 a[4:7], v84 offset:8192
    v_lshl_add_u32 v29, v28, 3, v29
    s_waitcnt lgkmcnt(5)
    v_mfma_f32_16x16x32_bf16 v[218:221], a[48:51], v[56:59], v[218:221]
    ds_read_b128 v[52:55], v4 offset:32240
    v_mfma_f32_16x16x32_bf16 v[234:237], a[52:55], v[56:59], v[234:237]
    ds_read_b128 a[8:11], v86 offset:8192
    ds_read_b64 v[44:45], v29 offset:0
    v_mfma_f32_16x16x32_bf16 v[222:225], a[48:51], v[60:63], v[222:225]
    ds_read_b128 a[12:15], v88 offset:8192
    v_max3_u32 v28, v242, v243, v244
    ds_read_b128 v[56:59], v4 offset:33280
    v_mfma_f32_16x16x32_bf16 v[238:241], a[52:55], v[60:63], v[238:241]
    v_max3_u32 v28, v245, v246, v28
    s_waitcnt lgkmcnt(8)
    v_mfma_f32_16x16x32_bf16 v[210:213], a[56:59], v[64:67], v[210:213]
    ds_read_b128 a[16:19], v83 offset:8192
    ds_read_b128 v[60:63], v4 offset:34320
    v_mfma_f32_16x16x32_bf16 v[226:229], a[60:63], v[64:67], v[226:229]
    v_max3_u32 v28, v247, v248, v28
    v_mfma_f32_16x16x32_bf16 v[214:217], a[56:59], v[68:71], v[214:217]
    ds_read_b128 a[20:23], v85 offset:8192
    v_max3_u32 v28, v249, v250, v28
    ds_read_b128 v[64:67], v4 offset:35360
    v_mfma_f32_16x16x32_bf16 v[230:233], a[60:63], v[68:71], v[230:233]
    ds_read_b128 a[24:27], v87 offset:8192
    v_max3_u32 v28, v94, v95, v28
    s_waitcnt lgkmcnt(9)
    v_mfma_f32_16x16x32_bf16 v[218:221], a[56:59], v[48:51], v[218:221]
    ds_read_b128 v[68:71], v4 offset:36400
    v_mfma_f32_16x16x32_bf16 v[234:237], a[60:63], v[48:51], v[234:237]
    ds_read_b128 a[28:31], v89 offset:8192
    v_max3_u32 v28, v96, v97, v28
    v_mfma_f32_16x16x32_bf16 v[222:225], a[56:59], v[52:55], v[222:225]
    v_cmp_eq_u32 vcc, -1, v28
    ds_read_b128 v[48:51], v4 offset:37440
    v_mfma_f32_16x16x32_bf16 v[238:241], a[60:63], v[52:55], v[238:241]
    s_waitcnt lgkmcnt(1)
    s_add_u32 m0, s89, 8192
    s_nop 0
    global_load_lds_dwordx4 v74, s[78:79]
    s_cbranch_vccnz Lgb_r
Lgb_ok:
    v_mfma_f32_16x16x32_bf16 v[210:213], a[64:67], v[56:59], v[210:213]
    s_add_u32 m0, s89, 9216
    s_nop 0
    global_load_lds_dwordx4 v75, s[78:79]
    ds_read_b128 v[52:55], v4 offset:38480
    v_mfma_f32_16x16x32_bf16 v[226:229], a[68:71], v[56:59], v[226:229]
    v_add_f32 v242, v242, v246
    v_mfma_f32_16x16x32_bf16 v[214:217], a[64:67], v[60:63], v[214:217]
    s_add_u32 m0, s89, 10240
    s_nop 0
    global_load_lds_dwordx4 v76, s[78:79]
    v_add_f32 v243, v243, v247
    ds_read_b128 v[56:59], v4 offset:39520
    v_mfma_f32_16x16x32_bf16 v[230:233], a[68:71], v[60:63], v[230:233]
    s_add_u32 m0, s89, 11264
    s_nop 0
    global_load_lds_dwordx4 v77, s[78:79]
    v_add_f32 v244, v244, v248
    v_mfma_f32_16x16x32_bf16 v[218:221], a[64:67], v[64:67], v[218:221]
    v_add_f32 v245, v245, v249
    ds_read_b128 v[60:63], v4 offset:40560
    v_mfma_f32_16x16x32_bf16 v[234:237], a[68:71], v[64:67], v[234:237]
    s_add_u32 m0, s89, 12288
    s_nop 0
    global_load_lds_dwordx4 v78, s[78:79]
    v_mfma_f32_16x16x32_bf16 v[222:225], a[64:67], v[68:71], v[222:225]
    v_cvt_pk_bf16_f32 v242, v242, v242
    ds_read_b128 v[64:67], v173 offset:0
    v_mfma_f32_16x16x32_bf16 v[238:241], a[68:71], v[68:71], v[238:241]
    s_add_u32 m0, s89, 13312
    s_nop 0
    global_load_lds_dwordx4 v79, s[78:79]
    v_lshlrev_b32 v242, 16, v242
    s_waitcnt lgkmcnt(3)
    v_mfma_f32_16x16x32_bf16 v[210:213], a[72:75], v[48:51], v[210:213]
    s_add_u32 m0, s89, 14336
    s_nop 0
    global_load_lds_dwordx4 v80, s[78:79]
    v_cvt_pk_bf16_f32 v243, v243, v243
    ds_read_b128 v[68:71], v173 offset:1040
    v_mfma_f32_16x16x32_bf16 v[226:229], a[76:79], v[48:51], v[226:229]
    v_mfma_f32_16x16x32_bf16 v[214:217], a[72:75], v[52:55], v[214:217]
    s_add_u32 m0, s89, 15360
    s_nop 0
    global_load_lds_dwordx4 v81, s[78:79]
    v_lshlrev_b32 v243, 16, v243
    ds_read_b128 v[48:51], v173 offset:2080
    v_mfma_f32_16x16x32_bf16 v[230:233], a[76:79], v[52:55], v[230:233]
    v_cvt_pk_bf16_f32 v244, v244, v244
    s_waitcnt lgkmcnt(3)
    v_mfma_f32_16x16x32_bf16 v[218:221], a[72:75], v[56:59], v[218:221]
    s_waitcnt vmcnt(8)
    ds_read_b128 a[32:35], v82 offset:0
    v_lshlrev_b32 v244, 16, v244
    ds_read_b128 v[52:55], v173 offset:3120
    v_mfma_f32_16x16x32_bf16 v[234:237], a[76:79], v[56:59], v[234:237]
    ds_read_b128 a[36:39], v84 offset:0
    v_mfma_f32_16x16x32_bf16 v[222:225], a[72:75], v[60:63], v[222:225]
    v_cvt_pk_bf16_f32 v245, v245, v245
    ds_read_b128 v[56:59], v173 offset:4160
    v_mfma_f32_16x16x32_bf16 v[238:241], a[76:79], v[60:63], v[238:241]
    ds_read_b128 a[40:43], v86 offset:0
    v_lshlrev_b32 v245, 16, v245
    s_waitcnt lgkmcnt(6)
    v_mfma_f32_16x16x32_bf16 v[210:213], a[80:83], v[64:67], v[210:213]
    ds_read_b128 a[44:47], v88 offset:0
    v_min_u32 v175, 304, v4
    ds_read_b128 v[60:63], v173 offset:5200
    v_mfma_f32_16x16x32_bf16 v[226:229], a[84:87], v[64:67], v[226:229]
    v_mfma_f32_16x16x32_bf16 v[214:217], a[80:83], v[68:71], v[214:217]
    ds_read_b128 a[48:51], v83 offset:0
    v_add_u32 v175, 162816, v175
    ds_read_b128 v[64:67], v173 offset:6240
    v_mfma_f32_16x16x32_bf16 v[230:233], a[84:87], v[68:71], v[230:233]
    ds_write_b128 v175, v[242:245]
    s_waitcnt lgkmcnt(8)
    v_mfma_f32_16x16x32_bf16 v[218:221], a[80:83], v[48:51], v[218:221]
    ds_read_b128 a[52:55], v85 offset:0
    v_lshlrev_b32 v32, 16, v32
    ds_read_b128 v[68:71], v173 offset:7280
    v_mfma_f32_16x16x32_bf16 v[234:237], a[84:87], v[48:51], v[234:237]
    ds_read_b128 a[56:59], v87 offset:0
    v_mfma_f32_16x16x32_bf16 v[222:225], a[80:83], v[52:55], v[222:225]
    v_mov_b32 v33, v32
    ds_read_b128 v[48:51], v173 offset:8320
    v_mfma_f32_16x16x32_bf16 v[238:241], a[84:87], v[52:55], v[238:241]
    ds_read_b128 a[60:63], v89 offset:0
    v_mov_b32 v34, v32
    s_waitcnt lgkmcnt(8)
    v_mfma_f32_16x16x32_bf16 v[210:213], a[88:91], v[56:59], v[210:213]
    v_mov_b32 v35, v32
    ds_read_b128 v[52:55], v173 offset:9360
    v_mfma_f32_16x16x32_bf16 v[226:229], a[92:95], v[56:59], v[226:229]
    s_waitcnt lgkmcnt(1)
    s_add_u32 m0, s89, 0
    s_nop 0
    global_load_lds_dwordx4 v74, s[80:81]
    v_mfma_f32_16x16x32_bf16 v[214:217], a[88:91], v[60:63], v[214:217]
    s_add_u32 m0, s89, 1024
    s_nop 0
    global_load_lds_dwordx4 v75, s[80:81]
    global_load_dwordx2 v[130:131], v174, s[38:39] offset:0 sc1
    ds_read_b128 v[56:59], v173 offset:10400
    v_mfma_f32_16x16x32_bf16 v[230:233], a[92:95], v[60:63], v[230:233]
    global_load_dwordx2 v[132:133], v174, s[38:39] offset:512 sc1
    v_mfma_f32_16x16x32_bf16 v[218:221], a[88:91], v[64:67], v[218:221]
    s_add_u32 m0, s89, 2048
    s_nop 0
    global_load_lds_dwordx4 v76, s[80:81]
    global_load_dwordx2 v[134:135], v174, s[38:39] offset:1024 sc1
    ds_read_b128 v[60:63], v173 offset:11440
    v_mfma_f32_16x16x32_bf16 v[234:237], a[92:95], v[64:67], v[234:237]
    s_add_u32 m0, s89, 3072
    s_nop 0
    global_load_lds_dwordx4 v77, s[80:81]
    global_load_dwordx2 v[136:137], v174, s[38:39] offset:1536 sc1
    v_mfma_f32_16x16x32_bf16 v[222:225], a[88:91], v[68:71], v[222:225]
    global_load_dwordx2 v[138:139], v174, s[38:39] offset:2048 sc1
    ds_read_b128 v[64:67], v173 offset:12480
    v_mfma_f32_16x16x32_bf16 v[238:241], a[92:95], v[68:71], v[238:241]
    s_add_u32 m0, s89, 4096
    s_nop 0
    global_load_lds_dwordx4 v78, s[80:81]
    global_load_dwordx2 v[140:141], v174, s[38:39] offset:2560 sc1
    s_waitcnt lgkmcnt(3)
    v_mfma_f32_16x16x32_bf16 v[210:213], a[96:99], v[48:51], v[210:213]
    global_load_dwordx2 v[142:143], v174, s[38:39] offset:3072 sc1
    ds_read_b128 v[68:71], v173 offset:13520
    v_mfma_f32_16x16x32_bf16 v[226:229], a[100:103], v[48:51], v[226:229]
    s_add_u32 m0, s89, 5120
    s_nop 0
    global_load_lds_dwordx4 v79, s[80:81]
    global_load_dwordx2 v[144:145], v174, s[38:39] offset:3584 sc1
    v_mfma_f32_16x16x32_bf16 v[214:217], a[96:99], v[52:55], v[214:217]
    s_add_u32 m0, s89, 6144
    s_nop 0
    global_load_lds_dwordx4 v80, s[80:81]
    ds_read_b128 v[48:51], v173 offset:14560
    v_mfma_f32_16x16x32_bf16 v[230:233], a[100:103], v[52:55], v[230:233]
    s_waitcnt lgkmcnt(3)
    v_mfma_f32_16x16x32_bf16 v[218:221], a[96:99], v[56:59], v[218:221]
    s_add_u32 m0, s89, 7168
    s_nop 0
    global_load_lds_dwordx4 v81, s[80:81]
    ds_read_b128 v[52:55], v173 offset:15600
    v_mfma_f32_16x16x32_bf16 v[234:237], a[100:103], v[56:59], v[234:237]
    v_mfma_f32_16x16x32_bf16 v[222:225], a[96:99], v[60:63], v[222:225]
    s_waitcnt vmcnt(16)
    ds_read_b128 a[64:67], v82 offset:8192
    ds_read_b128 v[56:59], v173 offset:16640
    v_mfma_f32_16x16x32_bf16 v[238:241], a[100:103], v[60:63], v[238:241]
    ds_read_b128 a[68:71], v84 offset:8192
    s_waitcnt lgkmcnt(5)
    v_mfma_f32_16x16x32_bf16 v[210:213], a[104:107], v[64:67], v[210:213]
    ds_read_b128 v[60:63], v173 offset:17680
    v_mfma_f32_16x16x32_bf16 v[226:229], a[108:111], v[64:67], v[226:229]
    ds_read_b128 a[72:75], v86 offset:8192
    v_mfma_f32_16x16x32_bf16 v[214:217], a[104:107], v[68:71], v[214:217]
    ds_read_b128 v[64:67], v173 offset:18720
    v_mfma_f32_16x16x32_bf16 v[230:233], a[108:111], v[68:71], v[230:233]
    ds_read_b128 a[76:79], v88 offset:8192
    s_waitcnt lgkmcnt(7)
    v_mfma_f32_16x16x32_bf16 v[218:221], a[104:107], v[48:51], v[218:221]
    ds_read_b128 v[68:71], v173 offset:19760
    v_mfma_f32_16x16x32_bf16 v[234:237], a[108:111], v[48:51], v[234:237]
    ds_read_b128 a[80:83], v83 offset:8192
    v_mfma_f32_16x16x32_bf16 v[222:225], a[104:107], v[52:55], v[222:225]
    ds_read_b128 a[84:87], v85 offset:8192
    ds_read_b128 v[48:51], v173 offset:20800
    v_mfma_f32_16x16x32_bf16 v[238:241], a[108:111], v[52:55], v[238:241]
    s_waitcnt lgkmcnt(7)
    v_mfma_f32_16x16x32_bf16 v[210:213], a[112:115], v[56:59], v[210:213]
    ds_read_b128 a[88:91], v87 offset:8192
    ds_read_b128 v[52:55], v173 offset:21840
    v_mfma_f32_16x16x32_bf16 v[226:229], a[116:119], v[56:59], v[226:229]
    v_mfma_f32_16x16x32_bf16 v[214:217], a[112:115], v[60:63], v[214:217]
    ds_read_b128 a[92:95], v89 offset:8192
    ds_read_b128 v[56:59], v173 offset:22880
    v_mfma_f32_16x16x32_bf16 v[230:233], a[116:119], v[60:63], v[230:233]
    s_waitcnt lgkmcnt(7)
    v_mfma_f32_16x16x32_bf16 v[218:221], a[112:115], v[64:67], v[218:221]
    s_waitcnt lgkmcnt(1)
    s_add_u32 m0, s89, 8192
    s_nop 0
    global_load_lds_dwordx4 v74, s[82:83]
    ds_read_b128 v[60:63], v173 offset:23920
    v_mfma_f32_16x16x32_bf16 v[234:237], a[116:119], v[64:67], v[234:237]
    s_add_u32 m0, s89, 9216
    s_nop 0
    global_load_lds_dwordx4 v75, s[82:83]
    v_mfma_f32_16x16x32_bf16 v[222:225], a[112:115], v[68:71], v[222:225]
    ds_read_b128 v[64:67], v173 offset:24960
    v_mfma_f32_16x16x32_bf16 v[238:241], a[116:119], v[68:71], v[238:241]
    s_add_u32 m0, s89, 10240
    s_nop 0
    global_load_lds_dwordx4 v76, s[82:83]
    s_waitcnt vmcnt(15)
    v_max_u32 v28, v131, v133
    s_waitcnt vmcnt(11)
    v_max3_u32 v28, v135, v137, v28
    s_waitcnt vmcnt(8)
    v_max3_u32 v28, v139, v141, v28
    s_waitcnt vmcnt(5)
    v_max3_u32 v28, v143, v145, v28
    v_cmp_eq_u32 vcc, -1, v28
    s_nop 0
    s_cbranch_vccnz Ls3_r
Ls3_ok:
    v_pk_add_f32 v[130:131], v[130:131], v[132:133] op_sel:[0,0] op_sel_hi:[1,1]
    v_pk_add_f32 v[134:135], v[134:135], v[136:137] op_sel:[0,0] op_sel_hi:[1,1]
    v_pk_add_f32 v[138:139], v[138:139], v[140:141] op_sel:[0,0] op_sel_hi:[1,1]
    v_pk_add_f32 v[142:143], v[142:143], v[144:145] op_sel:[0,0] op_sel_hi:[1,1]
    v_pk_add_f32 v[130:131], v[130:131], v[134:135] op_sel:[0,0] op_sel_hi:[1,1]
    v_pk_add_f32 v[138:139], v[138:139], v[142:143] op_sel:[0,0] op_sel_hi:[1,1]
    v_pk_add_f32 v[130:131], v[130:131], v[138:139] op_sel:[0,0] op_sel_hi:[1,1]
    v_mul_f32 v130, 0x3a97b426, v130
    v_mul_f32 v131, 0x3a97b426, v131
    v_fma_f32 v131, -v130, v130, v131
    v_max_f32 v131, 0, v131
    v_add_f32 v131, 0x3727c5ac, v131
    v_rsq_f32 v132, v131
    s_nop 0
    v_mul_f32_e64 v131, -v130, v132
    v_mov_b32 v130, v132
    ds_write2st64_b32 v170, v130, v131 offset0:0 offset1:1
    ds_read_b128 v[98:101], v171 offset:0
    ds_read_b128 v[102:105], v171 offset:16
    ds_read_b128 v[106:109], v171 offset:128
    ds_read_b128 v[110:113], v171 offset:144
    ds_read_b128 v[114:117], v171 offset:256
    ds_read_b128 v[118:121], v171 offset:272
    ds_read_b128 v[122:125], v171 offset:384
    ds_read_b128 v[126:129], v171 offset:400
    s_lshl_b32 s4, s41, 6
    s_lshl_b32 s5, s40, 1
    s_add_u32 s4, s4, s5
    s_mul_i32 s4, s4, 7168
    s_lshl_b32 s5, s3, 11
    s_add_u32 s4, s4, s5
    s_add_u32 s4, s4, 12582912
    v_add_u32 v28, s4, v4
    v_add_u32 v29, 7168, v28
    s_waitcnt lgkmcnt(3)
    v_pk_fma_f32 v[178:179], v[178:179], v[98:99], v[114:115] op_sel:[0,0,0] op_sel_hi:[1,1,1]
    v_pk_fma_f32 v[180:181], v[180:181], v[100:101], v[116:117] op_sel:[0,0,0] op_sel_hi:[1,1,1]
    s_waitcnt lgkmcnt(2)
    v_pk_fma_f32 v[182:183], v[182:183], v[102:103], v[118:119] op_sel:[0,0,0] op_sel_hi:[1,1,1]
    v_pk_fma_f32 v[184:185], v[184:185], v[104:105], v[120:121] op_sel:[0,0,0] op_sel_hi:[1,1,1]
    v_cvt_pk_bf16_f32 v130, v178, v179
    v_cvt_pk_bf16_f32 v131, v180, v181
    v_cvt_pk_bf16_f32 v132, v182, v183
    v_cvt_pk_bf16_f32 v133, v184, v185
    v_min_u32 v133, -2, v133
    global_store_dwordx4 v28, v[130:133], s[38:39] offset:0 sc1
    s_waitcnt lgkmcnt(1)
    v_pk_fma_f32 v[186:187], v[186:187], v[106:107], v[122:123] op_sel:[0,0,0] op_sel_hi:[1,1,1]
    v_pk_fma_f32 v[188:189], v[188:189], v[108:109], v[124:125] op_sel:[0,0,0] op_sel_hi:[1,1,1]
    s_waitcnt lgkmcnt(0)
    v_pk_fma_f32 v[190:191], v[190:191], v[110:111], v[126:127] op_sel:[0,0,0] op_sel_hi:[1,1,1]
    v_pk_fma_f32 v[192:193], v[192:193], v[112:113], v[128:129] op_sel:[0,0,0] op_sel_hi:[1,1,1]
    v_cvt_pk_bf16_f32 v134, v186, v187
    v_cvt_pk_bf16_f32 v135, v188, v189
    v_cvt_pk_bf16_f32 v136, v190, v191
    v_cvt_pk_bf16_f32 v137, v192, v193
    v_min_u32 v137, -2, v137
    global_store_dwordx4 v29, v[134:137], s[38:39] offset:0 sc1
    v_pk_fma_f32 v[194:195], v[194:195], v[98:99], v[114:115] op_sel:[0,0,0] op_sel_hi:[1,1,1]
    v_pk_fma_f32 v[196:197], v[196:197], v[100:101], v[116:117] op_sel:[0,0,0] op_sel_hi:[1,1,1]
    v_pk_fma_f32 v[198:199], v[198:199], v[102:103], v[118:119] op_sel:[0,0,0] op_sel_hi:[1,1,1]
    v_pk_fma_f32 v[200:201], v[200:201], v[104:105], v[120:121] op_sel:[0,0,0] op_sel_hi:[1,1,1]
    v_cvt_pk_bf16_f32 v138, v194, v195
    v_cvt_pk_bf16_f32 v139, v196, v197
    v_cvt_pk_bf16_f32 v140, v198, v199
    v_cvt_pk_bf16_f32 v141, v200, v201
    v_min_u32 v141, -2, v141
    s_mov_b64 exec, s[86:87]
    global_store_dwordx4 v28, v[138:141], s[38:39] offset:1024 sc1
    s_mov_b64 exec, -1
    v_pk_fma_f32 v[202:203], v[202:203], v[106:107], v[122:123] op_sel:[0,0,0] op_sel_hi:[1,1,1]
    v_pk_fma_f32 v[204:205], v[204:205], v[108:109], v[124:125] op_sel:[0,0,0] op_sel_hi:[1,1,1]
    v_pk_fma_f32 v[206:207], v[206:207], v[110:111], v[126:127] op_sel:[0,0,0] op_sel_hi:[1,1,1]
    v_pk_fma_f32 v[208:209], v[208:209], v[112:113], v[128:129] op_sel:[0,0,0] op_sel_hi:[1,1,1]
    v_cvt_pk_bf16_f32 v142, v202, v203
    v_cvt_pk_bf16_f32 v143, v204, v205
    v_cvt_pk_bf16_f32 v144, v206, v207
    v_cvt_pk_bf16_f32 v145, v208, v209
    v_min_u32 v145, -2, v145
    s_mov_b64 exec, s[86:87]
    global_store_dwordx4 v29, v[142:145], s[38:39] offset:1024 sc1
    s_mov_b64 exec, -1
    v_mfma_f32_16x16x32_bf16 v[210:213], a[120:123], v[48:51], v[210:213]
    ds_read_b128 v[68:71], v173 offset:26000
    v_mfma_f32_16x16x32_bf16 v[226:229], a[124:127], v[48:51], v[226:229]
    s_add_u32 m0, s89, 11264
    s_nop 0
    global_load_lds_dwordx4 v77, s[82:83]
    v_mfma_f32_16x16x32_bf16 v[214:217], a[120:123], v[52:55], v[214:217]
    ds_read_b128 v[48:51], v173 offset:27040
    v_mfma_f32_16x16x32_bf16 v[230:233], a[124:127], v[52:55], v[230:233]
    s_add_u32 m0, s89, 12288
    s_nop 0
    global_load_lds_dwordx4 v78, s[82:83]
    v_mfma_f32_16x16x32_bf16 v[218:221], a[120:123], v[56:59], v[218:221]
    s_add_u32 m0, s89, 13312
    s_nop 0
    global_load_lds_dwordx4 v79, s[82:83]
    ds_read_b128 v[52:55], v173 offset:28080
    v_mfma_f32_16x16x32_bf16 v[234:237], a[124:127], v[56:59], v[234:237]
    v_mfma_f32_16x16x32_bf16 v[222:225], a[120:123], v[60:63], v[222:225]
    s_add_u32 m0, s89, 14336
    s_nop 0
    global_load_lds_dwordx4 v80, s[82:83]
    ds_read_b128 v[56:59], v173 offset:29120
    v_mfma_f32_16x16x32_bf16 v[238:241], a[124:127], v[60:63], v[238:241]
    s_waitcnt lgkmcnt(3)
    v_mfma_f32_16x16x32_bf16 v[210:213], a[128:131], v[64:67], v[210:213]
    s_add_u32 m0, s89, 15360
    s_nop 0
    global_load_lds_dwordx4 v81, s[82:83]
    ds_read_b128 v[60:63], v173 offset:30160
    v_mfma_f32_16x16x32_bf16 v[226:229], a[132:135], v[64:67], v[226:229]
    v_mfma_f32_16x16x32_bf16 v[214:217], a[128:131], v[68:71], v[214:217]
    s_waitcnt vmcnt(12)
    ds_read_b128 a[96:99], v82 offset:0
    ds_read_b128 v[64:67], v173 offset:31200
    v_mfma_f32_16x16x32_bf16 v[230:233], a[132:135], v[68:71], v[230:233]
    s_waitcnt lgkmcnt(4)
    v_mfma_f32_16x16x32_bf16 v[218:221], a[128:131], v[48:51], v[218:221]
    ds_read_b128 a[100:103], v84 offset:0
    ds_read_b128 v[68:71], v173 offset:32240
    v_mfma_f32_16x16x32_bf16 v[234:237], a[132:135], v[48:51], v[234:237]
    v_mfma_f32_16x16x32_bf16 v[222:225], a[128:131], v[52:55], v[222:225]
    ds_read_b128 v[48:51], v173 offset:33280
    v_mfma_f32_16x16x32_bf16 v[238:241], a[132:135], v[52:55], v[238:241]
    ds_read_b128 a[104:107], v86 offset:0
    s_waitcnt lgkmcnt(6)
    v_mfma_f32_16x16x32_bf16 v[210:213], a[136:139], v[56:59], v[210:213]
    ds_read_b128 v[52:55], v173 offset:34320
    v_mfma_f32_16x16x32_bf16 v[226:229], a[140:143], v[56:59], v[226:229]
    ds_read_b128 a[108:111], v88 offset:0
    v_mfma_f32_16x16x32_bf16 v[214:217], a[136:139], v[60:63], v[214:217]
    ds_read_b128 v[56:59], v173 offset:35360
    v_mfma_f32_16x16x32_bf16 v[230:233], a[140:143], v[60:63], v[230:233]
    s_waitcnt lgkmcnt(5)
    v_mfma_f32_16x16x32_bf16 v[218:221], a[136:139], v[64:67], v[218:221]
    ds_read_b128 a[112:115], v83 offset:0
    ds_read_b128 v[60:63], v173 offset:36400
    v_mfma_f32_16x16x32_bf16 v[234:237], a[140:143], v[64:67], v[234:237]
    v_mfma_f32_16x16x32_bf16 v[222:225], a[136:139], v[68:71], v[222:225]
    ds_read_b128 a[116:119], v85 offset:0
    ds_read_b128 v[64:67], v173 offset:37440
    v_mfma_f32_16x16x32_bf16 v[238:241], a[140:143], v[68:71], v[238:241]
    s_waitcnt lgkmcnt(6)
    v_mfma_f32_16x16x32_bf16 v[210:213], a[144:147], v[48:51], v[210:213]
    ds_read_b128 v[68:71], v173 offset:38480
    v_mfma_f32_16x16x32_bf16 v[226:229], a[148:151], v[48:51], v[226:229]
    ds_read_b128 a[120:123], v87 offset:0
    v_mfma_f32_16x16x32_bf16 v[214:217], a[144:147], v[52:55], v[214:217]
    ds_read_b128 v[48:51], v173 offset:39520
    v_mfma_f32_16x16x32_bf16 v[230:233], a[148:151], v[52:55], v[230:233]
    ds_read_b128 a[124:127], v89 offset:0
    s_waitcnt lgkmcnt(6)
    v_mfma_f32_16x16x32_bf16 v[218:221], a[144:147], v[56:59], v[218:221]
    ds_read_b128 v[52:55], v173 offset:40560
    v_mfma_f32_16x16x32_bf16 v[234:237], a[148:151], v[56:59], v[234:237]
    v_mfma_f32_16x16x32_bf16 v[222:225], a[144:147], v[60:63], v[222:225]
    v_mfma_f32_16x16x32_bf16 v[238:241], a[148:151], v[60:63], v[238:241]
    s_waitcnt lgkmcnt(4)
    v_mfma_f32_16x16x32_bf16 v[210:213], a[152:155], v[64:67], v[210:213]
    v_mfma_f32_16x16x32_bf16 v[226:229], a[156:159], v[64:67], v[226:229]
    v_mfma_f32_16x16x32_bf16 v[214:217], a[152:155], v[68:71], v[214:217]
    v_mfma_f32_16x16x32_bf16 v[230:233], a[156:159], v[68:71], v[230:233]
    s_waitcnt lgkmcnt(0)
    v_mfma_f32_16x16x32_bf16 v[218:221], a[152:155], v[48:51], v[218:221]
    v_mfma_f32_16x16x32_bf16 v[234:237], a[156:159], v[48:51], v[234:237]
    v_mfma_f32_16x16x32_bf16 v[222:225], a[152:155], v[52:55], v[222:225]
    v_mfma_f32_16x16x32_bf16 v[238:241], a[156:159], v[52:55], v[238:241]
    s_waitcnt vmcnt(0)
    ds_read_b128 a[128:131], v82 offset:8192
    ds_read_b128 a[132:135], v84 offset:8192
    ds_read_b128 a[136:139], v86 offset:8192
    ds_read_b128 a[140:143], v88 offset:8192
    ds_read_b128 a[144:147], v83 offset:8192
    ds_read_b128 a[148:151], v85 offset:8192
    ds_read_b128 a[152:155], v87 offset:8192
    ds_read_b128 a[156:159], v89 offset:8192
    s_waitcnt lgkmcnt(0)
    s_barrier
    s_mul_i32 s5, s41, 138240
    s_add_u32 s5, s5, 10485760
    s_add_u32 s92, s38, s5
    s_addc_u32 s93, s39, 0
    s_mul_i32 s95, s3, 34816
    s_min_u32 s95, s95, 103424
    s_add_u32 s92, s92, s95
    s_addc_u32 s93, s93, 0
    s_add_u32 m0, s95, 0
    s_nop 0
    global_load_lds_dwordx4 v4, s[92:93] offset:0 sc1
    s_lshl_b32 s4, s3, 10
    s_add_u32 s4, s4, 138240
    v_add_u32 v170, s4, v30
    s_lshl_b32 s4, s3, 12
    s_add_u32 s4, s4, 138240
    v_add_u32 v171, s4, v30
    v_add_u32 v30, 3072, v4
    v_add_u32 v31, 10240, v4
    v_min_u32 v29, 27, v1
    v_lshlrev_b32 v29, 10, v29
    v_pk_fma_f32 v[178:179], v[162:163], v[12:13], v[16:17] op_sel:[1,0,0] op_sel_hi:[1,1,1]
    global_load_lds_dwordx4 v4, s[92:93] offset:1024 sc1
    v_pk_fma_f32 v[180:181], v[162:163], v[14:15], v[18:19] op_sel:[1,0,0] op_sel_hi:[1,1,1]
    v_pk_fma_f32 v[182:183], v[164:165], v[12:13], v[16:17] op_sel:[1,0,0] op_sel_hi:[1,1,1]
    v_pk_fma_f32 v[184:185], v[164:165], v[14:15], v[18:19] op_sel:[1,0,0] op_sel_hi:[1,1,1]
    v_pk_fma_f32 v[186:187], v[166:167], v[12:13], v[16:17] op_sel:[1,0,0] op_sel_hi:[1,1,1]
    v_pk_fma_f32 v[188:189], v[166:167], v[14:15], v[18:19] op_sel:[1,0,0] op_sel_hi:[1,1,1]
    v_pk_fma_f32 v[190:191], v[168:169], v[12:13], v[16:17] op_sel:[1,0,0] op_sel_hi:[1,1,1]
    v_pk_fma_f32 v[192:193], v[168:169], v[14:15], v[18:19] op_sel:[1,0,0] op_sel_hi:[1,1,1]
    v_pk_fma_f32 v[210:211], v[162:163], v[210:211], v[178:179] op_sel:[0,0,0] op_sel_hi:[0,1,1]
    v_pk_fma_f32 v[212:213], v[162:163], v[212:213], v[180:181] op_sel:[0,0,0] op_sel_hi:[0,1,1]
    v_pk_fma_f32 v[214:215], v[164:165], v[214:215], v[182:183] op_sel:[0,0,0] op_sel_hi:[0,1,1]
    v_pk_fma_f32 v[216:217], v[164:165], v[216:217], v[184:185] op_sel:[0,0,0] op_sel_hi:[0,1,1]
    v_pk_fma_f32 v[218:219], v[166:167], v[218:219], v[186:187] op_sel:[0,0,0] op_sel_hi:[0,1,1]
    global_load_lds_dwordx4 v4, s[92:93] offset:2048 sc1
    v_pk_fma_f32 v[220:221], v[166:167], v[220:221], v[188:189] op_sel:[0,0,0] op_sel_hi:[0,1,1]
    v_pk_fma_f32 v[222:223], v[168:169], v[222:223], v[190:191] op_sel:[0,0,0] op_sel_hi:[0,1,1]
    v_pk_fma_f32 v[224:225], v[168:169], v[224:225], v[192:193] op_sel:[0,0,0] op_sel_hi:[0,1,1]
    v_pk_fma_f32 v[178:179], v[162:163], v[20:21], v[24:25] op_sel:[1,0,0] op_sel_hi:[1,1,1]
    v_pk_fma_f32 v[180:181], v[162:163], v[22:23], v[26:27] op_sel:[1,0,0] op_sel_hi:[1,1,1]
    v_pk_fma_f32 v[182:183], v[164:165], v[20:21], v[24:25] op_sel:[1,0,0] op_sel_hi:[1,1,1]
    v_pk_fma_f32 v[184:185], v[164:165], v[22:23], v[26:27] op_sel:[1,0,0] op_sel_hi:[1,1,1]
    v_pk_fma_f32 v[186:187], v[166:167], v[20:21], v[24:25] op_sel:[1,0,0] op_sel_hi:[1,1,1]
    v_pk_fma_f32 v[188:189], v[166:167], v[22:23], v[26:27] op_sel:[1,0,0] op_sel_hi:[1,1,1]
    v_pk_fma_f32 v[190:191], v[168:169], v[20:21], v[24:25] op_sel:[1,0,0] op_sel_hi:[1,1,1]
    v_pk_fma_f32 v[192:193], v[168:169], v[22:23], v[26:27] op_sel:[1,0,0] op_sel_hi:[1,1,1]
    global_load_lds_dwordx4 v4, s[92:93] offset:3072 sc1
    v_pk_fma_f32 v[226:227], v[162:163], v[226:227], v[178:179] op_sel:[0,0,0] op_sel_hi:[0,1,1]
    v_pk_fma_f32 v[228:229], v[162:163], v[228:229], v[180:181] op_sel:[0,0,0] op_sel_hi:[0,1,1]
    v_pk_fma_f32 v[230:231], v[164:165], v[230:231], v[182:183] op_sel:[0,0,0] op_sel_hi:[0,1,1]
    v_pk_fma_f32 v[232:233], v[164:165], v[232:233], v[184:185] op_sel:[0,0,0] op_sel_hi:[0,1,1]
    v_pk_fma_f32 v[234:235], v[166:167], v[234:235], v[186:187] op_sel:[0,0,0] op_sel_hi:[0,1,1]
    v_pk_fma_f32 v[236:237], v[166:167], v[236:237], v[188:189] op_sel:[0,0,0] op_sel_hi:[0,1,1]
    v_pk_fma_f32 v[238:239], v[168:169], v[238:239], v[190:191] op_sel:[0,0,0] op_sel_hi:[0,1,1]
    v_pk_fma_f32 v[240:241], v[168:169], v[240:241], v[192:193] op_sel:[0,0,0] op_sel_hi:[0,1,1]
    v_pk_mul_f32 v[178:179], v[210:211], v[210:211] op_sel:[0,0] op_sel_hi:[1,1]
    v_pk_mul_f32 v[180:181], v[212:213], v[212:213] op_sel:[0,0] op_sel_hi:[1,1]
    v_pk_mul_f32 v[182:183], v[214:215], v[214:215] op_sel:[0,0] op_sel_hi:[1,1]
    v_pk_mul_f32 v[184:185], v[216:217], v[216:217] op_sel:[0,0] op_sel_hi:[1,1]
    s_add_u32 m0, s95, 4096
    s_add_u32 s92, s92, 4096
    s_addc_u32 s93, s93, 0
    global_load_lds_dwordx4 v4, s[92:93] offset:0 sc1
    v_pk_mul_f32 v[186:187], v[218:219], v[218:219] op_sel:[0,0] op_sel_hi:[1,1]
    v_pk_mul_f32 v[188:189], v[220:221], v[220:221] op_sel:[0,0] op_sel_hi:[1,1]
    v_pk_mul_f32 v[190:191], v[222:223], v[222:223] op_sel:[0,0] op_sel_hi:[1,1]
    v_pk_mul_f32 v[192:193], v[224:225], v[224:225] op_sel:[0,0] op_sel_hi:[1,1]
    v_pk_mul_f32 v[194:195], v[226:227], v[226:227] op_sel:[0,0] op_sel_hi:[1,1]
    v_pk_mul_f32 v[196:197], v[228:229], v[228:229] op_sel:[0,0] op_sel_hi:[1,1]
    v_pk_mul_f32 v[198:199], v[230:231], v[230:231] op_sel:[0,0] op_sel_hi:[1,1]
    v_pk_mul_f32 v[200:201], v[232:233], v[232:233] op_sel:[0,0] op_sel_hi:[1,1]
    v_pk_mul_f32 v[202:203], v[234:235], v[234:235] op_sel:[0,0] op_sel_hi:[1,1]
    v_pk_mul_f32 v[204:205], v[236:237], v[236:237] op_sel:[0,0] op_sel_hi:[1,1]
    v_pk_mul_f32 v[206:207], v[238:239], v[238:239] op_sel:[0,0] op_sel_hi:[1,1]
    global_load_lds_dwordx4 v4, s[92:93] offset:1024 sc1
    v_pk_mul_f32 v[208:209], v[240:241], v[240:241] op_sel:[0,0] op_sel_hi:[1,1]
    v_pk_fma_f32 v[178:179], v[178:179], s[84:85], s[84:85] op_sel:[0,1,0] op_sel_hi:[1,1,0]
    v_pk_fma_f32 v[180:181], v[180:181], s[84:85], s[84:85] op_sel:[0,1,0] op_sel_hi:[1,1,0]
    v_pk_fma_f32 v[182:183], v[182:183], s[84:85], s[84:85] op_sel:[0,1,0] op_sel_hi:[1,1,0]
    v_pk_fma_f32 v[184:185], v[184:185], s[84:85], s[84:85] op_sel:[0,1,0] op_sel_hi:[1,1,0]
    v_pk_fma_f32 v[186:187], v[186:187], s[84:85], s[84:85] op_sel:[0,1,0] op_sel_hi:[1,1,0]
    v_pk_fma_f32 v[188:189], v[188:189], s[84:85], s[84:85] op_sel:[0,1,0] op_sel_hi:[1,1,0]
    v_pk_fma_f32 v[190:191], v[190:191], s[84:85], s[84:85] op_sel:[0,1,0] op_sel_hi:[1,1,0]
    v_pk_fma_f32 v[192:193], v[192:193], s[84:85], s[84:85] op_sel:[0,1,0] op_sel_hi:[1,1,0]
    v_pk_fma_f32 v[194:195], v[194:195], s[84:85], s[84:85] op_sel:[0,1,0] op_sel_hi:[1,1,0]
    v_pk_fma_f32 v[196:197], v[196:197], s[84:85], s[84:85] op_sel:[0,1,0] op_sel_hi:[1,1,0]
    v_pk_fma_f32 v[198:199], v[198:199], s[84:85], s[84:85] op_sel:[0,1,0] op_sel_hi:[1,1,0]
    global_load_lds_dwordx4 v4, s[92:93] offset:2048 sc1
    v_pk_fma_f32 v[200:201], v[200:201], s[84:85], s[84:85] op_sel:[0,1,0] op_sel_hi:[1,1,0]
    v_pk_fma_f32 v[202:203], v[202:203], s[84:85], s[84:85] op_sel:[0,1,0] op_sel_hi:[1,1,0]
    v_pk_fma_f32 v[204:205], v[204:205], s[84:85], s[84:85] op_sel:[0,1,0] op_sel_hi:[1,1,0]
    v_pk_fma_f32 v[206:207], v[206:207], s[84:85], s[84:85] op_sel:[0,1,0] op_sel_hi:[1,1,0]
    v_pk_fma_f32 v[208:209], v[208:209], s[84:85], s[84:85] op_sel:[0,1,0] op_sel_hi:[1,1,0]
    v_pk_mul_f32 v[178:179], v[178:179], v[210:211] op_sel:[0,0] op_sel_hi:[1,1]
    v_pk_mul_f32 v[180:181], v[180:181], v[212:213] op_sel:[0,0] op_sel_hi:[1,1]
    v_pk_mul_f32 v[182:183], v[182:183], v[214:215] op_sel:[0,0] op_sel_hi:[1,1]
    v_pk_mul_f32 v[184:185], v[184:185], v[216:217] op_sel:[0,0] op_sel_hi:[1,1]
    v_pk_mul_f32 v[186:187], v[186:187], v[218:219] op_sel:[0,0] op_sel_hi:[1,1]
    v_pk_mul_f32 v[188:189], v[188:189], v[220:221] op_sel:[0,0] op_sel_hi:[1,1]
    global_load_lds_dwordx4 v4, s[92:93] offset:3072 sc1
    v_pk_mul_f32 v[190:191], v[190:191], v[222:223] op_sel:[0,0] op_sel_hi:[1,1]
    v_pk_mul_f32 v[192:193], v[192:193], v[224:225] op_sel:[0,0] op_sel_hi:[1,1]
    v_pk_mul_f32 v[194:195], v[194:195], v[226:227] op_sel:[0,0] op_sel_hi:[1,1]
    v_pk_mul_f32 v[196:197], v[196:197], v[228:229] op_sel:[0,0] op_sel_hi:[1,1]
    v_pk_mul_f32 v[198:199], v[198:199], v[230:231] op_sel:[0,0] op_sel_hi:[1,1]
    v_pk_mul_f32 v[200:201], v[200:201], v[232:233] op_sel:[0,0] op_sel_hi:[1,1]
    v_pk_mul_f32 v[202:203], v[202:203], v[234:235] op_sel:[0,0] op_sel_hi:[1,1]
    v_pk_mul_f32 v[204:205], v[204:205], v[236:237] op_sel:[0,0] op_sel_hi:[1,1]
    v_pk_mul_f32 v[206:207], v[206:207], v[238:239] op_sel:[0,0] op_sel_hi:[1,1]
    v_pk_mul_f32 v[208:209], v[208:209], v[240:241] op_sel:[0,0] op_sel_hi:[1,1]
    v_exp_f32 v178, v178
    v_exp_f32 v179, v179
    s_add_u32 m0, s95, 8192
    s_add_u32 s92, s92, 4096
    s_addc_u32 s93, s93, 0
    global_load_lds_dwordx4 v4, s[92:93] offset:0 sc1
    v_exp_f32 v180, v180
    v_exp_f32 v181, v181
    v_exp_f32 v182, v182
    v_exp_f32 v183, v183
    v_exp_f32 v184, v184
    v_exp_f32 v185, v185
    v_exp_f32 v186, v186
    v_exp_f32 v187, v187
    v_exp_f32 v188, v188
    v_exp_f32 v189, v189
    v_exp_f32 v190, v190
    global_load_lds_dwordx4 v4, s[92:93] offset:1024 sc1
    v_exp_f32 v191, v191
    global_load_dword v46, v29, s[56:57] offset:1020 sc1
    v_exp_f32 v192, v192
    v_exp_f32 v193, v193
    v_exp_f32 v194, v194
    v_exp_f32 v195, v195
    v_exp_f32 v196, v196
    v_exp_f32 v197, v197
    global_load_dwordx4 v[62:65], v30, s[56:57] offset:-3072 sc1
    v_exp_f32 v198, v198
    v_exp_f32 v199, v199
    v_exp_f32 v200, v200
    v_exp_f32 v201, v201
    v_exp_f32 v202, v202
    v_exp_f32 v203, v203
    global_load_dwordx4 v[66:69], v30, s[56:57] offset:-2048 sc1
    v_exp_f32 v204, v204
    v_exp_f32 v205, v205
    v_exp_f32 v206, v206
    v_exp_f32 v207, v207
    v_exp_f32 v208, v208
    v_exp_f32 v209, v209
    global_load_dwordx4 v[70:73], v30, s[56:57] offset:-1024 sc1
    v_pk_add_f32 v[178:179], v[178:179], 1.0 op_sel:[0,0] op_sel_hi:[1,0]
    v_pk_add_f32 v[180:181], v[180:181], 1.0 op_sel:[0,0] op_sel_hi:[1,0]
    v_pk_add_f32 v[182:183], v[182:183], 1.0 op_sel:[0,0] op_sel_hi:[1,0]
    v_pk_add_f32 v[184:185], v[184:185], 1.0 op_sel:[0,0] op_sel_hi:[1,0]
    v_pk_add_f32 v[186:187], v[186:187], 1.0 op_sel:[0,0] op_sel_hi:[1,0]
    v_pk_add_f32 v[188:189], v[188:189], 1.0 op_sel:[0,0] op_sel_hi:[1,0]
    global_load_dwordx4 v[74:77], v30, s[56:57] offset:0 sc1
    v_pk_add_f32 v[190:191], v[190:191], 1.0 op_sel:[0,0] op_sel_hi:[1,0]
    v_pk_add_f32 v[192:193], v[192:193], 1.0 op_sel:[0,0] op_sel_hi:[1,0]
    v_pk_add_f32 v[194:195], v[194:195], 1.0 op_sel:[0,0] op_sel_hi:[1,0]
    v_pk_add_f32 v[196:197], v[196:197], 1.0 op_sel:[0,0] op_sel_hi:[1,0]
    v_pk_add_f32 v[198:199], v[198:199], 1.0 op_sel:[0,0] op_sel_hi:[1,0]
    v_pk_add_f32 v[200:201], v[200:201], 1.0 op_sel:[0,0] op_sel_hi:[1,0]
    v_pk_add_f32 v[202:203], v[202:203], 1.0 op_sel:[0,0] op_sel_hi:[1,0]
    global_load_dwordx4 v[78:81], v30, s[56:57] offset:1024 sc1
    v_pk_add_f32 v[204:205], v[204:205], 1.0 op_sel:[0,0] op_sel_hi:[1,0]
    v_pk_add_f32 v[206:207], v[206:207], 1.0 op_sel:[0,0] op_sel_hi:[1,0]
    v_pk_add_f32 v[208:209], v[208:209], 1.0 op_sel:[0,0] op_sel_hi:[1,0]
    v_rcp_f32 v178, v178
    v_rcp_f32 v179, v179
    v_rcp_f32 v180, v180
    global_load_dwordx4 v[82:85], v30, s[56:57] offset:2048 sc1
    v_rcp_f32 v181, v181
    v_rcp_f32 v182, v182
    v_rcp_f32 v183, v183
    v_rcp_f32 v184, v184
    v_rcp_f32 v185, v185
    v_rcp_f32 v186, v186
    global_load_dwordx4 v[86:89], v30, s[56:57] offset:3072 sc1
    v_rcp_f32 v187, v187
    v_rcp_f32 v188, v188
    v_rcp_f32 v189, v189
    v_rcp_f32 v190, v190
    v_rcp_f32 v191, v191
    v_rcp_f32 v192, v192
    global_load_dwordx4 v[90:93], v31, s[56:57] offset:-3072 sc1
    v_rcp_f32 v193, v193
    v_rcp_f32 v194, v194
    v_rcp_f32 v195, v195
    v_rcp_f32 v196, v196
    v_rcp_f32 v197, v197
    v_rcp_f32 v198, v198
    v_rcp_f32 v199, v199
    global_load_dwordx4 v[94:97], v31, s[56:57] offset:-2048 sc1
    v_rcp_f32 v200, v200
    v_rcp_f32 v201, v201
    v_rcp_f32 v202, v202
    v_rcp_f32 v203, v203
    v_rcp_f32 v204, v204
    v_rcp_f32 v205, v205
    global_load_dwordx4 v[98:101], v31, s[56:57] offset:-1024 sc1
    v_rcp_f32 v206, v206
    v_rcp_f32 v207, v207
    v_rcp_f32 v208, v208
    v_rcp_f32 v209, v209
    v_pk_mul_f32 v[210:211], v[210:211], v[178:179] op_sel:[0,0] op_sel_hi:[1,1]
    v_pk_mul_f32 v[212:213], v[212:213], v[180:181] op_sel:[0,0] op_sel_hi:[1,1]
    global_load_dwordx4 v[102:105], v31, s[56:57] offset:0 sc1
    v_pk_mul_f32 v[214:215], v[214:215], v[182:183] op_sel:[0,0] op_sel_hi:[1,1]
    v_pk_mul_f32 v[216:217], v[216:217], v[184:185] op_sel:[0,0] op_sel_hi:[1,1]
    v_pk_mul_f32 v[218:219], v[218:219], v[186:187] op_sel:[0,0] op_sel_hi:[1,1]
    v_pk_mul_f32 v[220:221], v[220:221], v[188:189] op_sel:[0,0] op_sel_hi:[1,1]
    v_pk_mul_f32 v[222:223], v[222:223], v[190:191] op_sel:[0,0] op_sel_hi:[1,1]
    v_pk_mul_f32 v[224:225], v[224:225], v[192:193] op_sel:[0,0] op_sel_hi:[1,1]
    global_load_dwordx4 v[106:109], v31, s[56:57] offset:1024 sc1
    v_pk_mul_f32 v[226:227], v[226:227], v[194:195] op_sel:[0,0] op_sel_hi:[1,1]
    v_pk_mul_f32 v[228:229], v[228:229], v[196:197] op_sel:[0,0] op_sel_hi:[1,1]
    v_pk_mul_f32 v[230:231], v[230:231], v[198:199] op_sel:[0,0] op_sel_hi:[1,1]
    v_pk_mul_f32 v[232:233], v[232:233], v[200:201] op_sel:[0,0] op_sel_hi:[1,1]
    v_pk_mul_f32 v[234:235], v[234:235], v[202:203] op_sel:[0,0] op_sel_hi:[1,1]
    v_pk_mul_f32 v[236:237], v[236:237], v[204:205] op_sel:[0,0] op_sel_hi:[1,1]
    v_pk_mul_f32 v[238:239], v[238:239], v[206:207] op_sel:[0,0] op_sel_hi:[1,1]
    global_load_dwordx4 v[110:113], v31, s[56:57] offset:2048 sc1
    v_pk_mul_f32 v[240:241], v[240:241], v[208:209] op_sel:[0,0] op_sel_hi:[1,1]
    v_cvt_pk_bf16_f32 v178, v210, v211
    v_cvt_pk_bf16_f32 v179, v212, v213
    v_cvt_pk_bf16_f32 v180, v214, v215
    v_cvt_pk_bf16_f32 v181, v216, v217
    v_cvt_pk_bf16_f32 v182, v218, v219
    global_load_dwordx4 v[114:117], v31, s[56:57] offset:3072 sc1
    v_cvt_pk_bf16_f32 v183, v220, v221
    v_cvt_pk_bf16_f32 v184, v222, v223
    v_cvt_pk_bf16_f32 v185, v224, v225
    v_cvt_pk_bf16_f32 v186, v226, v227
    v_cvt_pk_bf16_f32 v187, v228, v229
    v_cvt_pk_bf16_f32 v188, v230, v231
    global_load_dwordx4 v[118:121], v30, s[58:59] offset:-3072 sc1
    v_cvt_pk_bf16_f32 v189, v232, v233
    v_cvt_pk_bf16_f32 v190, v234, v235
    v_cvt_pk_bf16_f32 v191, v236, v237
    v_cvt_pk_bf16_f32 v192, v238, v239
    v_cvt_pk_bf16_f32 v193, v240, v241
    ds_write_b64 v170, v[178:179] offset:0
    global_load_dwordx4 v[122:125], v30, s[58:59] offset:-2048 sc1
    ds_write_b64 v170, v[180:181] offset:4096
    ds_write_b64 v170, v[182:183] offset:8192
    ds_write_b64 v170, v[184:185] offset:12288
    ds_write_b64 v170, v[186:187] offset:512
    ds_write_b64 v170, v[188:189] offset:4608
    ds_write_b64 v170, v[190:191] offset:8704
    ds_write_b64 v170, v[192:193] offset:12800
    s_waitcnt lgkmcnt(0)
    s_barrier
    ds_read_b64 v[48:49], v171 offset:0
    ds_read_b64 v[50:51], v171 offset:512
    ds_read_b64 v[52:53], v171 offset:1024
    ds_read_b64 v[54:55], v171 offset:1536
    ds_read_b64 v[56:57], v171 offset:2048
    ds_read_b64 v[58:59], v171 offset:2560
    ds_read_b64 v[60:61], v171 offset:3072
    s_waitcnt vmcnt(14)
    v_max3_u32 v28, v46, v65, v69
    s_waitcnt vmcnt(12)
    v_max3_u32 v28, v73, v77, v28
    v_cmp_eq_u32 vcc, -1, v28
    s_nop 0
    s_cbranch_vccnz Lz0_r
Lz0_ok:
    v_mfma_f32_16x16x32_bf16 v[142:145], v[62:65], a[224:227], v[32:35]
    global_load_dwordx4 v[126:129], v30, s[58:59] offset:-1024 sc1
    v_min_u32 v47, 27, v1
    v_mfma_f32_16x16x32_bf16 v[146:149], v[62:65], a[228:231], 0
    s_mul_i32 s6, s43, 28
    v_add_lshl_u32 v47, v47, s6, 7
    v_mfma_f32_16x16x32_bf16 v[150:153], v[62:65], a[232:235], 0
    v_mfma_f32_16x16x32_bf16 v[154:157], v[62:65], a[236:239], 0
    global_load_dword v8, v47, s[52:53] sc1
    v_mfma_f32_16x16x32_bf16 v[158:161], v[66:69], a[224:227], v[32:35]
    global_load_dwordx4 v[130:133], v30, s[58:59] offset:0 sc1
    v_mfma_f32_16x16x32_bf16 v[162:165], v[66:69], a[228:231], 0
    v_mfma_f32_16x16x32_bf16 v[166:169], v[66:69], a[232:235], 0
    v_mfma_f32_16x16x32_bf16 v[170:173], v[66:69], a[236:239], 0
    v_mfma_f32_16x16x32_bf16 v[174:177], v[70:73], a[224:227], v[32:35]
    global_load_dwordx4 v[134:137], v30, s[58:59] offset:1024 sc1
    v_mfma_f32_16x16x32_bf16 v[178:181], v[70:73], a[228:231], 0
    v_mfma_f32_16x16x32_bf16 v[182:185], v[70:73], a[232:235], 0
    v_mfma_f32_16x16x32_bf16 v[186:189], v[70:73], a[236:239], 0
    s_waitcnt vmcnt(14)
    v_max_u32 v28, v81, v85
    v_mfma_f32_16x16x32_bf16 v[190:193], v[74:77], a[224:227], v[32:35]
    global_load_dwordx4 v[138:141], v30, s[58:59] offset:2048 sc1
    s_waitcnt vmcnt(13)
    v_max3_u32 v28, v89, v93, v28
    v_mfma_f32_16x16x32_bf16 v[194:197], v[74:77], a[228:231], 0
    v_cmp_eq_u32 vcc, -1, v28
    v_mfma_f32_16x16x32_bf16 v[198:201], v[74:77], a[232:235], 0
    v_mfma_f32_16x16x32_bf16 v[202:205], v[74:77], a[236:239], 0
    s_cbranch_vccnz Lz1_r
Lz1_ok:
    v_mfma_f32_16x16x32_bf16 v[206:209], v[78:81], a[224:227], v[32:35]
    global_load_dwordx4 v[62:65], v30, s[58:59] offset:3072 sc1
    s_xor_b32 s4, s3, 1
    s_mul_i32 s4, s4, 3072
    s_add_u32 s4, s4, 138240
    v_add_u32 v20, s4, v4
    v_mfma_f32_16x16x32_bf16 v[210:213], v[78:81], a[228:231], 0
    s_xor_b32 s4, s3, 2
    s_mul_i32 s4, s4, 3072
    s_add_u32 s4, s4, 139264
    v_add_u32 v21, s4, v4
    v_mfma_f32_16x16x32_bf16 v[214:217], v[78:81], a[232:235], 0
    s_xor_b32 s4, s3, 3
    s_mul_i32 s4, s4, 3072
    s_add_u32 s4, s4, 140288
    v_add_u32 v22, s4, v4
    v_mfma_f32_16x16x32_bf16 v[218:221], v[78:81], a[236:239], 0
    v_mfma_f32_16x16x32_bf16 v[222:225], v[82:85], a[224:227], v[32:35]
    global_load_dwordx4 v[66:69], v31, s[58:59] offset:-3072 sc1
    s_mul_i32 s4, s3, 3072
    s_add_u32 s4, s4, 138240
    v_add_u32 v23, s4, v4
    v_mfma_f32_16x16x32_bf16 v[226:229], v[82:85], a[228:231], 0
    s_lshl_b32 s4, s40, 2
    s_add_u32 s4, s4, s3
    s_mul_i32 s4, s4, 28672
    s_add_u32 s91, s4, 16252928
    s_mul_i32 s5, s41, 7
    s_add_u32 s5, s5, 1
    s_lshr_b32 s5, s5, 1
    s_lshl_b32 s5, s5, 10
    s_add_u32 s4, s91, s5
    v_add_u32 v24, s4, v4
    v_mfma_f32_16x16x32_bf16 v[230:233], v[82:85], a[232:235], 0
    v_mfma_f32_16x16x32_bf16 v[234:237], v[82:85], a[236:239], 0
    s_movk_i32 s5, 3072
    s_bitcmp1_b32 s41, 0
    s_cselect_b32 s5, -1016, s5
    v_add_u32 v25, s5, v24
    v_mfma_f32_16x16x32_bf16 v[238:241], v[86:89], a[224:227], v[32:35]
    global_load_dwordx4 v[70:73], v31, s[58:59] offset:-2048 sc1
    s_add_u32 s4, s91, 4096
    v_add_u32 v6, s4, v4
    v_mfma_f32_16x16x32_bf16 v[242:245], v[86:89], a[228:231], 0
    v_mfma_f32_16x16x32_bf16 v[246:249], v[86:89], a[232:235], 0
    v_add_u32 v7, 8192, v6
    v_mfma_f32_16x16x32_bf16 v[250:253], v[86:89], a[236:239], 0
    v_add_u32 v26, 16384, v6
    s_waitcnt vmcnt(14)
    v_max_u32 v28, v97, v101
    v_mfma_f32_16x16x32_bf16 v[142:145], v[90:93], a[240:243], v[142:145]
    global_load_dwordx4 v[74:77], v31, s[58:59] offset:-1024 sc1
    s_waitcnt vmcnt(13)
    v_max3_u32 v28, v105, v109, v28
    v_mfma_f32_16x16x32_bf16 v[146:149], v[90:93], a[244:247], v[146:149]
    v_add_u32 v27, 24576, v6
    v_cmp_eq_u32 vcc, -1, v28
    v_mfma_f32_16x16x32_bf16 v[150:153], v[90:93], a[248:251], v[150:153]
    s_waitcnt lgkmcnt(0)
    s_barrier
    v_mfma_f32_16x16x32_bf16 v[154:157], v[90:93], a[252:255], v[154:157]
    s_cbranch_vccnz Lz2_r
Lz2_ok:
    v_mfma_f32_16x16x32_bf16 v[158:161], v[94:97], a[240:243], v[158:161]
    global_load_dwordx4 v[78:81], v31, s[58:59] offset:0 sc1
    v_mfma_f32_16x16x32_bf16 v[162:165], v[94:97], a[244:247], v[162:165]
    v_mfma_f32_16x16x32_bf16 v[166:169], v[94:97], a[248:251], v[166:169]
    v_mfma_f32_16x16x32_bf16 v[170:173], v[94:97], a[252:255], v[170:173]
    v_mfma_f32_16x16x32_bf16 v[174:177], v[98:101], a[240:243], v[174:177]
    global_load_dwordx4 v[82:85], v31, s[58:59] offset:1024 sc1
    v_mfma_f32_16x16x32_bf16 v[178:181], v[98:101], a[244:247], v[178:181]
    v_mfma_f32_16x16x32_bf16 v[182:185], v[98:101], a[248:251], v[182:185]
    v_mfma_f32_16x16x32_bf16 v[186:189], v[98:101], a[252:255], v[186:189]
    v_mfma_f32_16x16x32_bf16 v[190:193], v[102:105], a[240:243], v[190:193]
    global_load_dwordx4 v[86:89], v31, s[58:59] offset:2048 sc1
    v_mfma_f32_16x16x32_bf16 v[194:197], v[102:105], a[244:247], v[194:197]
    v_mfma_f32_16x16x32_bf16 v[198:201], v[102:105], a[248:251], v[198:201]
    v_mfma_f32_16x16x32_bf16 v[202:205], v[102:105], a[252:255], v[202:205]
    s_waitcnt vmcnt(14)
    v_max_u32 v28, v113, v117
    v_mfma_f32_16x16x32_bf16 v[206:209], v[106:109], a[240:243], v[206:209]
    global_load_dwordx4 v[90:93], v31, s[58:59] offset:3072 sc1
    s_waitcnt vmcnt(13)
    v_max3_u32 v28, v121, v125, v28
    v_mfma_f32_16x16x32_bf16 v[210:213], v[106:109], a[244:247], v[210:213]
    v_cmp_eq_u32 vcc, -1, v28
    v_mfma_f32_16x16x32_bf16 v[214:217], v[106:109], a[248:251], v[214:217]
    v_mfma_f32_16x16x32_bf16 v[218:221], v[106:109], a[252:255], v[218:221]
    s_cbranch_vccnz Lz3_r
Lz3_ok:
    v_mfma_f32_16x16x32_bf16 v[222:225], v[110:113], a[240:243], v[222:225]
    global_load_dwordx4 v[94:97], v30, s[60:61] offset:-3072 sc1
    v_min_u32 v47, 27, v1
    v_mfma_f32_16x16x32_bf16 v[226:229], v[110:113], a[244:247], v[226:229]
    s_mul_i32 s6, s43, 28
    v_add_lshl_u32 v47, v47, s6, 7
    v_mfma_f32_16x16x32_bf16 v[230:233], v[110:113], a[248:251], v[230:233]
    v_mfma_f32_16x16x32_bf16 v[234:237], v[110:113], a[252:255], v[234:237]
    global_load_dword v9, v47, s[64:65] sc1
    v_mfma_f32_16x16x32_bf16 v[238:241], v[114:117], a[240:243], v[238:241]
    global_load_dwordx4 v[98:101], v31, s[60:61] offset:-3072 sc1
    v_mfma_f32_16x16x32_bf16 v[242:245], v[114:117], a[244:247], v[242:245]
    v_mfma_f32_16x16x32_bf16 v[246:249], v[114:117], a[248:251], v[246:249]
    v_mfma_f32_16x16x32_bf16 v[250:253], v[114:117], a[252:255], v[250:253]
    v_mfma_f32_16x16x32_bf16 v[142:145], v[118:121], a[0:3], v[142:145]
    global_load_dwordx4 v[102:105], v30, s[62:63] offset:-3072 sc1
    v_mfma_f32_16x16x32_bf16 v[146:149], v[118:121], a[4:7], v[146:149]
    v_mfma_f32_16x16x32_bf16 v[150:153], v[118:121], a[8:11], v[150:153]
    v_mfma_f32_16x16x32_bf16 v[154:157], v[118:121], a[12:15], v[154:157]
    s_waitcnt vmcnt(14)
    v_max_u32 v28, v129, v133
    v_mfma_f32_16x16x32_bf16 v[158:161], v[122:125], a[0:3], v[158:161]
    global_load_dwordx4 v[106:109], v31, s[62:63] offset:-3072 sc1
    s_waitcnt vmcnt(13)
    v_max3_u32 v28, v137, v141, v28
    v_mfma_f32_16x16x32_bf16 v[162:165], v[122:125], a[4:7], v[162:165]
    v_cmp_eq_u32 vcc, -1, v28
    v_mfma_f32_16x16x32_bf16 v[166:169], v[122:125], a[8:11], v[166:169]
    v_mfma_f32_16x16x32_bf16 v[170:173], v[122:125], a[12:15], v[170:173]
    s_cbranch_vccnz Lz4_r
Lz4_ok:
    v_mfma_f32_16x16x32_bf16 v[174:177], v[126:129], a[0:3], v[174:177]
    global_load_dwordx4 v[110:113], v30, s[52:53] offset:-3072 sc1
    v_mfma_f32_16x16x32_bf16 v[178:181], v[126:129], a[4:7], v[178:181]
    v_mfma_f32_16x16x32_bf16 v[182:185], v[126:129], a[8:11], v[182:185]
    v_mfma_f32_16x16x32_bf16 v[186:189], v[126:129], a[12:15], v[186:189]
    v_mfma_f32_16x16x32_bf16 v[190:193], v[130:133], a[0:3], v[190:193]
    global_load_dwordx4 v[114:117], v31, s[52:53] offset:-3072 sc1
    v_mfma_f32_16x16x32_bf16 v[194:197], v[130:133], a[4:7], v[194:197]
    v_mfma_f32_16x16x32_bf16 v[198:201], v[130:133], a[8:11], v[198:201]
    v_mfma_f32_16x16x32_bf16 v[202:205], v[130:133], a[12:15], v[202:205]
    v_mfma_f32_16x16x32_bf16 v[206:209], v[134:137], a[0:3], v[206:209]
    global_load_dwordx4 v[118:121], v30, s[54:55] offset:-3072 sc1
    v_mfma_f32_16x16x32_bf16 v[210:213], v[134:137], a[4:7], v[210:213]
    v_mfma_f32_16x16x32_bf16 v[214:217], v[134:137], a[8:11], v[214:217]
    v_mfma_f32_16x16x32_bf16 v[218:221], v[134:137], a[12:15], v[218:221]
    s_waitcnt vmcnt(14)
    v_max_u32 v28, v65, v69
    v_mfma_f32_16x16x32_bf16 v[222:225], v[138:141], a[0:3], v[222:225]
    global_load_dwordx4 v[122:125], v31, s[54:55] offset:-3072 sc1
    s_waitcnt vmcnt(13)
    v_max3_u32 v28, v73, v77, v28
    v_mfma_f32_16x16x32_bf16 v[226:229], v[138:141], a[4:7], v[226:229]
    v_cmp_eq_u32 vcc, -1, v28
    v_mfma_f32_16x16x32_bf16 v[230:233], v[138:141], a[8:11], v[230:233]
    v_mfma_f32_16x16x32_bf16 v[234:237], v[138:141], a[12:15], v[234:237]
    s_cbranch_vccnz Lz5_r
Lz5_ok:
    v_mfma_f32_16x16x32_bf16 v[238:241], v[62:65], a[0:3], v[238:241]
    global_load_dwordx4 v[126:129], v30, s[64:65] offset:-3072 sc1
    v_mfma_f32_16x16x32_bf16 v[242:245], v[62:65], a[4:7], v[242:245]
    v_mfma_f32_16x16x32_bf16 v[246:249], v[62:65], a[8:11], v[246:249]
    v_mfma_f32_16x16x32_bf16 v[250:253], v[62:65], a[12:15], v[250:253]
    v_mfma_f32_16x16x32_bf16 v[142:145], v[66:69], a[16:19], v[142:145]
    global_load_dwordx4 v[130:133], v31, s[64:65] offset:-3072 sc1
    v_mfma_f32_16x16x32_bf16 v[146:149], v[66:69], a[20:23], v[146:149]
    v_mfma_f32_16x16x32_bf16 v[150:153], v[66:69], a[24:27], v[150:153]
    v_mfma_f32_16x16x32_bf16 v[154:157], v[66:69], a[28:31], v[154:157]
    v_mfma_f32_16x16x32_bf16 v[158:161], v[70:73], a[16:19], v[158:161]
    global_load_dwordx4 v[134:137], v30, s[66:67] offset:-3072 sc1
    v_mfma_f32_16x16x32_bf16 v[162:165], v[70:73], a[20:23], v[162:165]
    v_mfma_f32_16x16x32_bf16 v[166:169], v[70:73], a[24:27], v[166:169]
    v_mfma_f32_16x16x32_bf16 v[170:173], v[70:73], a[28:31], v[170:173]
    s_waitcnt vmcnt(14)
    v_max_u32 v28, v81, v85
    v_mfma_f32_16x16x32_bf16 v[174:177], v[74:77], a[16:19], v[174:177]
    global_load_dwordx4 v[138:141], v31, s[66:67] offset:-3072 sc1
    s_waitcnt vmcnt(13)
    v_max3_u32 v28, v89, v93, v28
    v_mfma_f32_16x16x32_bf16 v[178:181], v[74:77], a[20:23], v[178:181]
    v_cmp_eq_u32 vcc, -1, v28
    v_mfma_f32_16x16x32_bf16 v[182:185], v[74:77], a[24:27], v[182:185]
    v_mfma_f32_16x16x32_bf16 v[186:189], v[74:77], a[28:31], v[186:189]
    s_cbranch_vccnz Lz6_r
Lz6_ok:
    v_mfma_f32_16x16x32_bf16 v[190:193], v[78:81], a[16:19], v[190:193]
    global_load_dwordx4 v[62:65], v30, s[60:61] offset:-2048 sc1
    v_mfma_f32_16x16x32_bf16 v[194:197], v[78:81], a[20:23], v[194:197]
    v_mfma_f32_16x16x32_bf16 v[198:201], v[78:81], a[24:27], v[198:201]
    v_mfma_f32_16x16x32_bf16 v[202:205], v[78:81], a[28:31], v[202:205]
    v_mfma_f32_16x16x32_bf16 v[206:209], v[82:85], a[16:19], v[206:209]
    global_load_dwordx4 v[66:69], v31, s[60:61] offset:-2048 sc1
    v_mfma_f32_16x16x32_bf16 v[210:213], v[82:85], a[20:23], v[210:213]
    v_mfma_f32_16x16x32_bf16 v[214:217], v[82:85], a[24:27], v[214:217]
    v_mfma_f32_16x16x32_bf16 v[218:221], v[82:85], a[28:31], v[218:221]
    v_mfma_f32_16x16x32_bf16 v[222:225], v[86:89], a[16:19], v[222:225]
    global_load_dwordx4 v[70:73], v30, s[62:63] offset:-2048 sc1
    v_mfma_f32_16x16x32_bf16 v[226:229], v[86:89], a[20:23], v[226:229]
    v_mfma_f32_16x16x32_bf16 v[230:233], v[86:89], a[24:27], v[230:233]
    v_mfma_f32_16x16x32_bf16 v[234:237], v[86:89], a[28:31], v[234:237]
    s_waitcnt vmcnt(13)
    v_max_u32 v28, v97, v101
    v_mfma_f32_16x16x32_bf16 v[238:241], v[90:93], a[16:19], v[238:241]
    global_load_dwordx4 v[74:77], v31, s[62:63] offset:-2048 sc1
    s_waitcnt vmcnt(12)
    v_max3_u32 v28, v105, v109, v28
    v_mfma_f32_16x16x32_bf16 v[242:245], v[90:93], a[20:23], v[242:245]
    v_cmp_eq_u32 vcc, -1, v28
    v_mfma_f32_16x16x32_bf16 v[246:249], v[90:93], a[24:27], v[246:249]
    v_mfma_f32_16x16x32_bf16 v[250:253], v[90:93], a[28:31], v[250:253]
    s_cbranch_vccnz Lz7_r
Lz7_ok:
    v_mfma_f32_16x16x32_bf16 v[142:145], v[94:97], a[32:35], v[142:145]
    global_load_dwordx4 v[78:81], v30, s[52:53] offset:-2048 sc1
    v_mfma_f32_16x16x32_bf16 v[146:149], v[94:97], a[36:39], v[146:149]
    v_mfma_f32_16x16x32_bf16 v[150:153], v[94:97], a[40:43], v[150:153]
    v_mfma_f32_16x16x32_bf16 v[154:157], v[94:97], a[44:47], v[154:157]
    v_mfma_f32_16x16x32_bf16 v[142:145], v[98:101], a[48:51], v[142:145]
    global_load_dwordx4 v[82:85], v31, s[52:53] offset:-2048 sc1
    v_mfma_f32_16x16x32_bf16 v[146:149], v[98:101], a[52:55], v[146:149]
    v_mfma_f32_16x16x32_bf16 v[150:153], v[98:101], a[56:59], v[150:153]
    v_mfma_f32_16x16x32_bf16 v[154:157], v[98:101], a[60:63], v[154:157]
    v_mfma_f32_16x16x32_bf16 v[142:145], v[102:105], a[64:67], v[142:145]
    global_load_dwordx4 v[86:89], v30, s[54:55] offset:-2048 sc1
    v_mfma_f32_16x16x32_bf16 v[146:149], v[102:105], a[68:71], v[146:149]
    v_mfma_f32_16x16x32_bf16 v[150:153], v[102:105], a[72:75], v[150:153]
    v_mfma_f32_16x16x32_bf16 v[154:157], v[102:105], a[76:79], v[154:157]
    s_waitcnt vmcnt(13)
    v_max_u32 v28, v113, v117
    v_mfma_f32_16x16x32_bf16 v[142:145], v[106:109], a[80:83], v[142:145]
    global_load_dwordx4 v[90:93], v31, s[54:55] offset:-2048 sc1
    s_waitcnt vmcnt(12)
    v_max3_u32 v28, v121, v125, v28
    v_mfma_f32_16x16x32_bf16 v[146:149], v[106:109], a[84:87], v[146:149]
    v_cmp_eq_u32 vcc, -1, v28
    v_mfma_f32_16x16x32_bf16 v[150:153], v[106:109], a[88:91], v[150:153]
    v_mfma_f32_16x16x32_bf16 v[154:157], v[106:109], a[92:95], v[154:157]
    s_cbranch_vccnz Lz8_r
Lz8_ok:
    v_mfma_f32_16x16x32_bf16 v[142:145], v[110:113], a[160:163], v[142:145]
    global_load_dwordx4 v[94:97], v30, s[64:65] offset:-2048 sc1
    v_mfma_f32_16x16x32_bf16 v[146:149], v[110:113], a[164:167], v[146:149]
    v_mfma_f32_16x16x32_bf16 v[150:153], v[110:113], a[168:171], v[150:153]
    v_mfma_f32_16x16x32_bf16 v[154:157], v[110:113], a[172:175], v[154:157]
    v_mfma_f32_16x16x32_bf16 v[142:145], v[114:117], a[176:179], v[142:145]
    global_load_dwordx4 v[98:101], v31, s[64:65] offset:-2048 sc1
    v_mfma_f32_16x16x32_bf16 v[146:149], v[114:117], a[180:183], v[146:149]
    v_mfma_f32_16x16x32_bf16 v[150:153], v[114:117], a[184:187], v[150:153]
    v_mfma_f32_16x16x32_bf16 v[154:157], v[114:117], a[188:191], v[154:157]
    v_mfma_f32_16x16x32_bf16 v[142:145], v[118:121], a[192:195], v[142:145]
    global_load_dwordx4 v[102:105], v30, s[66:67] offset:-2048 sc1
    v_mfma_f32_16x16x32_bf16 v[146:149], v[118:121], a[196:199], v[146:149]
    v_mfma_f32_16x16x32_bf16 v[150:153], v[118:121], a[200:203], v[150:153]
    v_mfma_f32_16x16x32_bf16 v[154:157], v[118:121], a[204:207], v[154:157]
    s_waitcnt vmcnt(13)
    v_max_u32 v28, v129, v133
    v_mfma_f32_16x16x32_bf16 v[142:145], v[122:125], a[208:211], v[142:145]
    global_load_dwordx4 v[106:109], v31, s[66:67] offset:-2048 sc1
    s_waitcnt vmcnt(12)
    v_max3_u32 v28, v137, v141, v28
    v_mfma_f32_16x16x32_bf16 v[146:149], v[122:125], a[212:215], v[146:149]
    v_cmp_eq_u32 vcc, -1, v28
    v_mfma_f32_16x16x32_bf16 v[150:153], v[122:125], a[216:219], v[150:153]
    v_mfma_f32_16x16x32_bf16 v[154:157], v[122:125], a[220:223], v[154:157]
    s_cbranch_vccnz Lz9_r
Lz9_ok:
    v_mfma_f32_16x16x32_bf16 v[142:145], v[126:129], a[96:99], v[142:145]
    global_load_dwordx4 v[110:113], v30, s[60:61] offset:-1024 sc1
    v_mfma_f32_16x16x32_bf16 v[146:149], v[126:129], a[100:103], v[146:149]
    v_mfma_f32_16x16x32_bf16 v[150:153], v[126:129], a[104:107], v[150:153]
    v_mfma_f32_16x16x32_bf16 v[154:157], v[126:129], a[108:111], v[154:157]
    v_mfma_f32_16x16x32_bf16 v[142:145], v[130:133], a[112:115], v[142:145]
    global_load_dwordx4 v[114:117], v31, s[60:61] offset:-1024 sc1
    v_mfma_f32_16x16x32_bf16 v[146:149], v[130:133], a[116:119], v[146:149]
    v_mfma_f32_16x16x32_bf16 v[150:153], v[130:133], a[120:123], v[150:153]
    v_mfma_f32_16x16x32_bf16 v[154:157], v[130:133], a[124:127], v[154:157]
    v_mfma_f32_16x16x32_bf16 v[142:145], v[134:137], a[128:131], v[142:145]
    global_load_dwordx4 v[118:121], v30, s[62:63] offset:-1024 sc1
    v_mfma_f32_16x16x32_bf16 v[146:149], v[134:137], a[132:135], v[146:149]
    v_mfma_f32_16x16x32_bf16 v[150:153], v[134:137], a[136:139], v[150:153]
    v_mfma_f32_16x16x32_bf16 v[154:157], v[134:137], a[140:143], v[154:157]
    s_waitcnt vmcnt(13)
    v_max_u32 v28, v65, v69
    v_mfma_f32_16x16x32_bf16 v[142:145], v[138:141], a[144:147], v[142:145]
    global_load_dwordx4 v[122:125], v31, s[62:63] offset:-1024 sc1
    s_waitcnt vmcnt(12)
    v_max3_u32 v28, v73, v77, v28
    v_mfma_f32_16x16x32_bf16 v[146:149], v[138:141], a[148:151], v[146:149]
    v_cmp_eq_u32 vcc, -1, v28
    v_mfma_f32_16x16x32_bf16 v[150:153], v[138:141], a[152:155], v[150:153]
    v_mfma_f32_16x16x32_bf16 v[154:157], v[138:141], a[156:159], v[154:157]
    s_cbranch_vccnz Lz10_r
Lz10_ok:
    v_mfma_f32_16x16x32_bf16 v[158:161], v[62:65], a[32:35], v[158:161]
    global_load_dwordx4 v[126:129], v30, s[52:53] offset:-1024 sc1
    v_mfma_f32_16x16x32_bf16 v[162:165], v[62:65], a[36:39], v[162:165]
    v_mfma_f32_16x16x32_bf16 v[166:169], v[62:65], a[40:43], v[166:169]
    v_mfma_f32_16x16x32_bf16 v[170:173], v[62:65], a[44:47], v[170:173]
    ds_write_b128 v20, v[146:149] offset:0
    v_mfma_f32_16x16x32_bf16 v[158:161], v[66:69], a[48:51], v[158:161]
    global_load_dwordx4 v[130:133], v31, s[52:53] offset:-1024 sc1
    v_mfma_f32_16x16x32_bf16 v[162:165], v[66:69], a[52:55], v[162:165]
    v_mfma_f32_16x16x32_bf16 v[166:169], v[66:69], a[56:59], v[166:169]
    ds_write_b128 v21, v[150:153] offset:0
    v_mfma_f32_16x16x32_bf16 v[170:173], v[66:69], a[60:63], v[170:173]
    v_mfma_f32_16x16x32_bf16 v[158:161], v[70:73], a[64:67], v[158:161]
    global_load_dwordx4 v[134:137], v30, s[54:55] offset:-1024 sc1
    v_mfma_f32_16x16x32_bf16 v[162:165], v[70:73], a[68:71], v[162:165]
    ds_write_b128 v22, v[154:157] offset:0
    v_mfma_f32_16x16x32_bf16 v[166:169], v[70:73], a[72:75], v[166:169]
    v_mfma_f32_16x16x32_bf16 v[170:173], v[70:73], a[76:79], v[170:173]
    s_waitcnt vmcnt(13)
    v_max_u32 v28, v81, v85
    v_mfma_f32_16x16x32_bf16 v[158:161], v[74:77], a[80:83], v[158:161]
    global_load_dwordx4 v[138:141], v31, s[54:55] offset:-1024 sc1
    s_waitcnt vmcnt(12)
    v_max3_u32 v28, v89, v93, v28
    s_waitcnt lgkmcnt(0)
    s_barrier
    v_mfma_f32_16x16x32_bf16 v[162:165], v[74:77], a[84:87], v[162:165]
    v_cmp_eq_u32 vcc, -1, v28
    v_mfma_f32_16x16x32_bf16 v[166:169], v[74:77], a[88:91], v[166:169]
    v_mfma_f32_16x16x32_bf16 v[170:173], v[74:77], a[92:95], v[170:173]
    s_cbranch_vccnz Lz11_r
Lz11_ok:
    v_mfma_f32_16x16x32_bf16 v[158:161], v[78:81], a[160:163], v[158:161]
    global_load_dwordx4 v[62:65], v30, s[64:65] offset:-1024 sc1
    ds_read_b128 v[146:149], v23 offset:0
    v_mfma_f32_16x16x32_bf16 v[162:165], v[78:81], a[164:167], v[162:165]
    ds_read_b128 v[150:153], v23 offset:1024
    v_mfma_f32_16x16x32_bf16 v[166:169], v[78:81], a[168:171], v[166:169]
    ds_read_b128 v[154:157], v23 offset:2048
    v_mfma_f32_16x16x32_bf16 v[170:173], v[78:81], a[172:175], v[170:173]
    v_lshlrev_b32 v12, 16, v48
    v_mfma_f32_16x16x32_bf16 v[158:161], v[82:85], a[176:179], v[158:161]
    global_load_dwordx4 v[66:69], v31, s[64:65] offset:-1024 sc1
    v_and_b32 v13, 0xffff0000, v48
    v_mfma_f32_16x16x32_bf16 v[162:165], v[82:85], a[180:183], v[162:165]
    v_mfma_f32_16x16x32_bf16 v[166:169], v[82:85], a[184:187], v[166:169]
    v_lshlrev_b32 v14, 16, v49
    v_mfma_f32_16x16x32_bf16 v[170:173], v[82:85], a[188:191], v[170:173]
    v_and_b32 v15, 0xffff0000, v49
    v_mfma_f32_16x16x32_bf16 v[158:161], v[86:89], a[192:195], v[158:161]
    global_load_dwordx4 v[70:73], v30, s[66:67] offset:-1024 sc1
    s_waitcnt lgkmcnt(2)
    v_add_f32 v142, v142, v146
    v_mfma_f32_16x16x32_bf16 v[162:165], v[86:89], a[196:199], v[162:165]
    v_add_f32 v143, v143, v147
    v_mfma_f32_16x16x32_bf16 v[166:169], v[86:89], a[200:203], v[166:169]
    v_mfma_f32_16x16x32_bf16 v[170:173], v[86:89], a[204:207], v[170:173]
    s_waitcnt vmcnt(13)
    v_max_u32 v28, v97, v101
    v_add_f32 v144, v144, v148
    v_mfma_f32_16x16x32_bf16 v[158:161], v[90:93], a[208:211], v[158:161]
    global_load_dwordx4 v[74:77], v31, s[66:67] offset:-1024 sc1
    s_waitcnt vmcnt(12)
    v_max3_u32 v28, v105, v109, v28
    v_add_f32 v145, v145, v149
    v_mfma_f32_16x16x32_bf16 v[162:165], v[90:93], a[212:215], v[162:165]
    v_cmp_eq_u32 vcc, -1, v28
    s_waitcnt lgkmcnt(1)
    v_add_f32 v142, v142, v150
    v_mfma_f32_16x16x32_bf16 v[166:169], v[90:93], a[216:219], v[166:169]
    v_add_f32 v143, v143, v151
    v_mfma_f32_16x16x32_bf16 v[170:173], v[90:93], a[220:223], v[170:173]
    s_cbranch_vccnz Lz12_r
Lz12_ok:
    v_mfma_f32_16x16x32_bf16 v[158:161], v[94:97], a[96:99], v[158:161]
    global_load_dwordx4 v[78:81], v30, s[60:61] offset:0 sc1
    v_add_f32 v144, v144, v152
    v_mfma_f32_16x16x32_bf16 v[162:165], v[94:97], a[100:103], v[162:165]
    v_add_f32 v145, v145, v153
    v_mfma_f32_16x16x32_bf16 v[166:169], v[94:97], a[104:107], v[166:169]
    s_waitcnt lgkmcnt(0)
    v_add_f32 v142, v142, v154
    v_mfma_f32_16x16x32_bf16 v[170:173], v[94:97], a[108:111], v[170:173]
    v_mfma_f32_16x16x32_bf16 v[158:161], v[98:101], a[112:115], v[158:161]
    global_load_dwordx4 v[82:85], v31, s[60:61] offset:0 sc1
    v_add_f32 v143, v143, v155
    v_mfma_f32_16x16x32_bf16 v[162:165], v[98:101], a[116:119], v[162:165]
    v_add_f32 v144, v144, v156
    v_mfma_f32_16x16x32_bf16 v[166:169], v[98:101], a[120:123], v[166:169]
    v_add_f32 v145, v145, v157
    v_mfma_f32_16x16x32_bf16 v[170:173], v[98:101], a[124:127], v[170:173]
    v_mfma_f32_16x16x32_bf16 v[158:161], v[102:105], a[128:131], v[158:161]
    global_load_dwordx4 v[86:89], v30, s[62:63] offset:0 sc1
    v_mul_f32 v142, v142, v12
    v_mfma_f32_16x16x32_bf16 v[162:165], v[102:105], a[132:135], v[162:165]
    v_mul_f32 v143, v143, v13
    v_mfma_f32_16x16x32_bf16 v[166:169], v[102:105], a[136:139], v[166:169]
    v_mul_f32 v144, v144, v14
    v_mfma_f32_16x16x32_bf16 v[170:173], v[102:105], a[140:143], v[170:173]
    s_waitcnt vmcnt(13)
    v_max_u32 v28, v113, v117
    v_mfma_f32_16x16x32_bf16 v[158:161], v[106:109], a[144:147], v[158:161]
    global_load_dwordx4 v[90:93], v31, s[62:63] offset:0 sc1
    s_waitcnt vmcnt(12)
    v_max3_u32 v28, v121, v125, v28
    v_mul_f32 v145, v145, v15
    v_mfma_f32_16x16x32_bf16 v[162:165], v[106:109], a[148:151], v[162:165]
    v_cmp_eq_u32 vcc, -1, v28
    v_cvt_pk_bf16_f32 v48, v142, v143
    v_mfma_f32_16x16x32_bf16 v[166:169], v[106:109], a[152:155], v[166:169]
    v_cvt_pk_bf16_f32 v49, v144, v145
    v_mfma_f32_16x16x32_bf16 v[170:173], v[106:109], a[156:159], v[170:173]
    s_cbranch_vccnz Lz13_r
Lz13_ok:
    v_mfma_f32_16x16x32_bf16 v[174:177], v[110:113], a[32:35], v[174:177]
    global_load_dwordx4 v[94:97], v30, s[52:53] offset:0 sc1
    v_mfma_f32_16x16x32_bf16 v[178:181], v[110:113], a[36:39], v[178:181]
    v_mfma_f32_16x16x32_bf16 v[182:185], v[110:113], a[40:43], v[182:185]
    v_mfma_f32_16x16x32_bf16 v[186:189], v[110:113], a[44:47], v[186:189]
    ds_write_b128 v20, v[162:165] offset:12288
    v_mfma_f32_16x16x32_bf16 v[174:177], v[114:117], a[48:51], v[174:177]
    global_load_dwordx4 v[98:101], v31, s[52:53] offset:0 sc1
    v_mfma_f32_16x16x32_bf16 v[178:181], v[114:117], a[52:55], v[178:181]
    v_mfma_f32_16x16x32_bf16 v[182:185], v[114:117], a[56:59], v[182:185]
    ds_write_b128 v21, v[166:169] offset:12288
    v_mfma_f32_16x16x32_bf16 v[186:189], v[114:117], a[60:63], v[186:189]
    v_mfma_f32_16x16x32_bf16 v[174:177], v[118:121], a[64:67], v[174:177]
    global_load_dwordx4 v[102:105], v30, s[54:55] offset:0 sc1
    v_mfma_f32_16x16x32_bf16 v[178:181], v[118:121], a[68:71], v[178:181]
    ds_write_b128 v22, v[170:173] offset:12288
    v_mfma_f32_16x16x32_bf16 v[182:185], v[118:121], a[72:75], v[182:185]
    v_mfma_f32_16x16x32_bf16 v[186:189], v[118:121], a[76:79], v[186:189]
    s_waitcnt vmcnt(13)
    v_max_u32 v28, v129, v133
    v_mfma_f32_16x16x32_bf16 v[174:177], v[122:125], a[80:83], v[174:177]
    global_load_dwordx4 v[106:109], v31, s[54:55] offset:0 sc1
    s_waitcnt vmcnt(12)
    v_max3_u32 v28, v137, v141, v28
    s_waitcnt lgkmcnt(0)
    s_barrier
    v_mfma_f32_16x16x32_bf16 v[178:181], v[122:125], a[84:87], v[178:181]
    v_cmp_eq_u32 vcc, -1, v28
    v_mfma_f32_16x16x32_bf16 v[182:185], v[122:125], a[88:91], v[182:185]
    v_mfma_f32_16x16x32_bf16 v[186:189], v[122:125], a[92:95], v[186:189]
    s_cbranch_vccnz Lz14_r
Lz14_ok:
    v_mfma_f32_16x16x32_bf16 v[174:177], v[126:129], a[160:163], v[174:177]
    global_load_dwordx4 v[110:113], v30, s[64:65] offset:0 sc1
    ds_read_b128 v[162:165], v23 offset:12288
    v_mfma_f32_16x16x32_bf16 v[178:181], v[126:129], a[164:167], v[178:181]
    ds_read_b128 v[166:169], v23 offset:13312
    v_mfma_f32_16x16x32_bf16 v[182:185], v[126:129], a[168:171], v[182:185]
    ds_read_b128 v[170:173], v23 offset:14336
    v_mfma_f32_16x16x32_bf16 v[186:189], v[126:129], a[172:175], v[186:189]
    v_lshlrev_b32 v12, 16, v50
    v_mfma_f32_16x16x32_bf16 v[174:177], v[130:133], a[176:179], v[174:177]
    global_load_dwordx4 v[114:117], v31, s[64:65] offset:0 sc1
    v_and_b32 v13, 0xffff0000, v50
    v_mfma_f32_16x16x32_bf16 v[178:181], v[130:133], a[180:183], v[178:181]
    v_mfma_f32_16x16x32_bf16 v[182:185], v[130:133], a[184:187], v[182:185]
    v_lshlrev_b32 v14, 16, v51
    v_mfma_f32_16x16x32_bf16 v[186:189], v[130:133], a[188:191], v[186:189]
    v_and_b32 v15, 0xffff0000, v51
    v_mfma_f32_16x16x32_bf16 v[174:177], v[134:137], a[192:195], v[174:177]
    global_load_dwordx4 v[118:121], v30, s[66:67] offset:0 sc1
    s_waitcnt lgkmcnt(2)
    v_add_f32 v158, v158, v162
    v_mfma_f32_16x16x32_bf16 v[178:181], v[134:137], a[196:199], v[178:181]
    v_add_f32 v159, v159, v163
    v_mfma_f32_16x16x32_bf16 v[182:185], v[134:137], a[200:203], v[182:185]
    v_mfma_f32_16x16x32_bf16 v[186:189], v[134:137], a[204:207], v[186:189]
    s_waitcnt vmcnt(13)
    v_max_u32 v28, v65, v69
    v_add_f32 v160, v160, v164
    v_mfma_f32_16x16x32_bf16 v[174:177], v[138:141], a[208:211], v[174:177]
    global_load_dwordx4 v[122:125], v31, s[66:67] offset:0 sc1
    s_waitcnt vmcnt(12)
    v_max3_u32 v28, v73, v77, v28
    v_add_f32 v161, v161, v165
    v_mfma_f32_16x16x32_bf16 v[178:181], v[138:141], a[212:215], v[178:181]
    v_cmp_eq_u32 vcc, -1, v28
    s_waitcnt lgkmcnt(1)
    v_add_f32 v158, v158, v166
    v_mfma_f32_16x16x32_bf16 v[182:185], v[138:141], a[216:219], v[182:185]
    v_add_f32 v159, v159, v167
    v_mfma_f32_16x16x32_bf16 v[186:189], v[138:141], a[220:223], v[186:189]
    s_cbranch_vccnz Lz15_r
Lz15_ok:
    v_mfma_f32_16x16x32_bf16 v[174:177], v[62:65], a[96:99], v[174:177]
    global_load_dwordx4 v[126:129], v30, s[60:61] offset:1024 sc1
    v_add_f32 v160, v160, v168
    v_mfma_f32_16x16x32_bf16 v[178:181], v[62:65], a[100:103], v[178:181]
    v_add_f32 v161, v161, v169
    v_mfma_f32_16x16x32_bf16 v[182:185], v[62:65], a[104:107], v[182:185]
    s_waitcnt lgkmcnt(0)
    v_add_f32 v158, v158, v170
    v_mfma_f32_16x16x32_bf16 v[186:189], v[62:65], a[108:111], v[186:189]
    v_add_f32 v159, v159, v171
    v_mfma_f32_16x16x32_bf16 v[174:177], v[66:69], a[112:115], v[174:177]
    global_load_dwordx4 v[130:133], v31, s[60:61] offset:1024 sc1
    v_add_f32 v160, v160, v172
    v_mfma_f32_16x16x32_bf16 v[178:181], v[66:69], a[116:119], v[178:181]
    v_mfma_f32_16x16x32_bf16 v[182:185], v[66:69], a[120:123], v[182:185]
    v_add_f32 v161, v161, v173
    v_mfma_f32_16x16x32_bf16 v[186:189], v[66:69], a[124:127], v[186:189]
    v_mul_f32 v158, v158, v12
    v_mfma_f32_16x16x32_bf16 v[174:177], v[70:73], a[128:131], v[174:177]
    global_load_dwordx4 v[134:137], v30, s[62:63] offset:1024 sc1
    v_mul_f32 v159, v159, v13
    v_mfma_f32_16x16x32_bf16 v[178:181], v[70:73], a[132:135], v[178:181]
    v_mul_f32 v160, v160, v14
    v_mfma_f32_16x16x32_bf16 v[182:185], v[70:73], a[136:139], v[182:185]
    v_mfma_f32_16x16x32_bf16 v[186:189], v[70:73], a[140:143], v[186:189]
    s_waitcnt vmcnt(13)
    v_max_u32 v28, v81, v85
    v_mul_f32 v161, v161, v15
    v_mfma_f32_16x16x32_bf16 v[174:177], v[74:77], a[144:147], v[174:177]
    global_load_dwordx4 v[138:141], v31, s[62:63] offset:1024 sc1
    s_waitcnt vmcnt(12)
    v_max3_u32 v28, v89, v93, v28
    v_cvt_pk_bf16_f32 v50, v158, v159
    v_mfma_f32_16x16x32_bf16 v[178:181], v[74:77], a[148:151], v[178:181]
    v_cmp_eq_u32 vcc, -1, v28
    v_cvt_pk_bf16_f32 v51, v160, v161
    v_mfma_f32_16x16x32_bf16 v[182:185], v[74:77], a[152:155], v[182:185]
    v_min_u32 v51, -2, v51
    v_mfma_f32_16x16x32_bf16 v[186:189], v[74:77], a[156:159], v[186:189]
    s_cbranch_vccnz Lz16_r
Lz16_ok:
    v_mfma_f32_16x16x32_bf16 v[190:193], v[78:81], a[32:35], v[190:193]
    global_load_dwordx4 v[62:65], v30, s[52:53] offset:1024 sc1
    v_mfma_f32_16x16x32_bf16 v[194:197], v[78:81], a[36:39], v[194:197]
    v_mfma_f32_16x16x32_bf16 v[198:201], v[78:81], a[40:43], v[198:201]
    v_mfma_f32_16x16x32_bf16 v[202:205], v[78:81], a[44:47], v[202:205]
    ds_write_b128 v20, v[178:181] offset:0
    v_mfma_f32_16x16x32_bf16 v[190:193], v[82:85], a[48:51], v[190:193]
    global_load_dwordx4 v[66:69], v31, s[52:53] offset:1024 sc1
    v_mfma_f32_16x16x32_bf16 v[194:197], v[82:85], a[52:55], v[194:197]
    v_mfma_f32_16x16x32_bf16 v[198:201], v[82:85], a[56:59], v[198:201]
    ds_write_b128 v21, v[182:185] offset:0
    v_mfma_f32_16x16x32_bf16 v[202:205], v[82:85], a[60:63], v[202:205]
    v_mfma_f32_16x16x32_bf16 v[190:193], v[86:89], a[64:67], v[190:193]
    global_load_dwordx4 v[70:73], v30, s[54:55] offset:1024 sc1
    v_mfma_f32_16x16x32_bf16 v[194:197], v[86:89], a[68:71], v[194:197]
    ds_write_b128 v22, v[186:189] offset:0
    v_mfma_f32_16x16x32_bf16 v[198:201], v[86:89], a[72:75], v[198:201]
    v_mfma_f32_16x16x32_bf16 v[202:205], v[86:89], a[76:79], v[202:205]
    s_waitcnt vmcnt(13)
    v_max_u32 v28, v97, v101
    v_mfma_f32_16x16x32_bf16 v[190:193], v[90:93], a[80:83], v[190:193]
    global_load_dwordx4 v[74:77], v31, s[54:55] offset:1024 sc1
    s_waitcnt vmcnt(12)
    v_max3_u32 v28, v105, v109, v28
    s_waitcnt lgkmcnt(0)
    s_barrier
    v_mfma_f32_16x16x32_bf16 v[194:197], v[90:93], a[84:87], v[194:197]
    v_cmp_eq_u32 vcc, -1, v28
    v_mfma_f32_16x16x32_bf16 v[198:201], v[90:93], a[88:91], v[198:201]
    v_mfma_f32_16x16x32_bf16 v[202:205], v[90:93], a[92:95], v[202:205]
    s_cbranch_vccnz Lz17_r
Lz17_ok:
    v_mfma_f32_16x16x32_bf16 v[190:193], v[94:97], a[160:163], v[190:193]
    global_load_dwordx4 v[78:81], v30, s[64:65] offset:1024 sc1
    ds_read_b128 v[178:181], v23 offset:0
    v_mfma_f32_16x16x32_bf16 v[194:197], v[94:97], a[164:167], v[194:197]
    ds_read_b128 v[182:185], v23 offset:1024
    v_mfma_f32_16x16x32_bf16 v[198:201], v[94:97], a[168:171], v[198:201]
    ds_read_b128 v[186:189], v23 offset:2048
    v_mfma_f32_16x16x32_bf16 v[202:205], v[94:97], a[172:175], v[202:205]
    v_lshlrev_b32 v12, 16, v52
    v_mfma_f32_16x16x32_bf16 v[190:193], v[98:101], a[176:179], v[190:193]
    global_load_dwordx4 v[82:85], v31, s[64:65] offset:1024 sc1
    v_and_b32 v13, 0xffff0000, v52
    v_mfma_f32_16x16x32_bf16 v[194:197], v[98:101], a[180:183], v[194:197]
    v_mfma_f32_16x16x32_bf16 v[198:201], v[98:101], a[184:187], v[198:201]
    v_lshlrev_b32 v14, 16, v53
    v_mfma_f32_16x16x32_bf16 v[202:205], v[98:101], a[188:191], v[202:205]
    v_and_b32 v15, 0xffff0000, v53
    v_mfma_f32_16x16x32_bf16 v[190:193], v[102:105], a[192:195], v[190:193]
    global_load_dwordx4 v[86:89], v30, s[66:67] offset:1024 sc1
    s_waitcnt lgkmcnt(2)
    v_add_f32 v174, v174, v178
    v_mfma_f32_16x16x32_bf16 v[194:197], v[102:105], a[196:199], v[194:197]
    v_add_f32 v175, v175, v179
    v_mfma_f32_16x16x32_bf16 v[198:201], v[102:105], a[200:203], v[198:201]
    v_mfma_f32_16x16x32_bf16 v[202:205], v[102:105], a[204:207], v[202:205]
    s_waitcnt vmcnt(13)
    v_max_u32 v28, v113, v117
    v_add_f32 v176, v176, v180
    v_mfma_f32_16x16x32_bf16 v[190:193], v[106:109], a[208:211], v[190:193]
    global_load_dwordx4 v[90:93], v31, s[66:67] offset:1024 sc1
    s_waitcnt vmcnt(12)
    v_max3_u32 v28, v121, v125, v28
    v_add_f32 v177, v177, v181
    v_mfma_f32_16x16x32_bf16 v[194:197], v[106:109], a[212:215], v[194:197]
    v_cmp_eq_u32 vcc, -1, v28
    s_waitcnt lgkmcnt(1)
    v_add_f32 v174, v174, v182
    v_mfma_f32_16x16x32_bf16 v[198:201], v[106:109], a[216:219], v[198:201]
    v_add_f32 v175, v175, v183
    v_mfma_f32_16x16x32_bf16 v[202:205], v[106:109], a[220:223], v[202:205]
    s_cbranch_vccnz Lz18_r
Lz18_ok:
    v_mfma_f32_16x16x32_bf16 v[190:193], v[110:113], a[96:99], v[190:193]
    global_load_dwordx4 v[94:97], v30, s[60:61] offset:2048 sc1
    v_add_f32 v176, v176, v184
    v_mfma_f32_16x16x32_bf16 v[194:197], v[110:113], a[100:103], v[194:197]
    v_add_f32 v177, v177, v185
    v_mfma_f32_16x16x32_bf16 v[198:201], v[110:113], a[104:107], v[198:201]
    s_waitcnt lgkmcnt(0)
    v_add_f32 v174, v174, v186
    v_mfma_f32_16x16x32_bf16 v[202:205], v[110:113], a[108:111], v[202:205]
    v_mfma_f32_16x16x32_bf16 v[190:193], v[114:117], a[112:115], v[190:193]
    global_load_dwordx4 v[98:101], v31, s[60:61] offset:2048 sc1
    v_add_f32 v175, v175, v187
    v_mfma_f32_16x16x32_bf16 v[194:197], v[114:117], a[116:119], v[194:197]
    v_add_f32 v176, v176, v188
    v_mfma_f32_16x16x32_bf16 v[198:201], v[114:117], a[120:123], v[198:201]
    v_add_f32 v177, v177, v189
    v_mfma_f32_16x16x32_bf16 v[202:205], v[114:117], a[124:127], v[202:205]
    v_mfma_f32_16x16x32_bf16 v[190:193], v[118:121], a[128:131], v[190:193]
    global_load_dwordx4 v[102:105], v30, s[62:63] offset:2048 sc1
    v_mul_f32 v174, v174, v12
    v_mfma_f32_16x16x32_bf16 v[194:197], v[118:121], a[132:135], v[194:197]
    v_mul_f32 v175, v175, v13
    v_mfma_f32_16x16x32_bf16 v[198:201], v[118:121], a[136:139], v[198:201]
    v_mul_f32 v176, v176, v14
    v_mfma_f32_16x16x32_bf16 v[202:205], v[118:121], a[140:143], v[202:205]
    s_waitcnt vmcnt(13)
    v_max_u32 v28, v129, v133
    v_mfma_f32_16x16x32_bf16 v[190:193], v[122:125], a[144:147], v[190:193]
    global_load_dwordx4 v[106:109], v31, s[62:63] offset:2048 sc1
    s_waitcnt vmcnt(12)
    v_max3_u32 v28, v137, v141, v28
    v_mul_f32 v177, v177, v15
    v_mfma_f32_16x16x32_bf16 v[194:197], v[122:125], a[148:151], v[194:197]
    v_cmp_eq_u32 vcc, -1, v28
    v_cvt_pk_bf16_f32 v52, v174, v175
    v_mfma_f32_16x16x32_bf16 v[198:201], v[122:125], a[152:155], v[198:201]
    v_cvt_pk_bf16_f32 v53, v176, v177
    v_mfma_f32_16x16x32_bf16 v[202:205], v[122:125], a[156:159], v[202:205]
    s_cbranch_vccnz Lz19_r
Lz19_ok:
    v_mfma_f32_16x16x32_bf16 v[206:209], v[126:129], a[32:35], v[206:209]
    global_load_dwordx4 v[110:113], v30, s[52:53] offset:2048 sc1
    v_mfma_f32_16x16x32_bf16 v[210:213], v[126:129], a[36:39], v[210:213]
    v_mfma_f32_16x16x32_bf16 v[214:217], v[126:129], a[40:43], v[214:217]
    v_mfma_f32_16x16x32_bf16 v[218:221], v[126:129], a[44:47], v[218:221]
    ds_write_b128 v20, v[194:197] offset:12288
    v_mfma_f32_16x16x32_bf16 v[206:209], v[130:133], a[48:51], v[206:209]
    global_load_dwordx4 v[114:117], v31, s[52:53] offset:2048 sc1
    v_mfma_f32_16x16x32_bf16 v[210:213], v[130:133], a[52:55], v[210:213]
    v_mfma_f32_16x16x32_bf16 v[214:217], v[130:133], a[56:59], v[214:217]
    ds_write_b128 v21, v[198:201] offset:12288
    v_mfma_f32_16x16x32_bf16 v[218:221], v[130:133], a[60:63], v[218:221]
    v_mfma_f32_16x16x32_bf16 v[206:209], v[134:137], a[64:67], v[206:209]
    global_load_dwordx4 v[118:121], v30, s[54:55] offset:2048 sc1
    v_mfma_f32_16x16x32_bf16 v[210:213], v[134:137], a[68:71], v[210:213]
    ds_write_b128 v22, v[202:205] offset:12288
    v_mfma_f32_16x16x32_bf16 v[214:217], v[134:137], a[72:75], v[214:217]
    v_mfma_f32_16x16x32_bf16 v[218:221], v[134:137], a[76:79], v[218:221]
    s_waitcnt vmcnt(13)
    v_max_u32 v28, v65, v69
    v_mfma_f32_16x16x32_bf16 v[206:209], v[138:141], a[80:83], v[206:209]
    global_load_dwordx4 v[122:125], v31, s[54:55] offset:2048 sc1
    s_waitcnt vmcnt(12)
    v_max3_u32 v28, v73, v77, v28
    s_waitcnt lgkmcnt(0)
    s_barrier
    v_mfma_f32_16x16x32_bf16 v[210:213], v[138:141], a[84:87], v[210:213]
    v_cmp_eq_u32 vcc, -1, v28
    v_mfma_f32_16x16x32_bf16 v[214:217], v[138:141], a[88:91], v[214:217]
    v_mfma_f32_16x16x32_bf16 v[218:221], v[138:141], a[92:95], v[218:221]
    s_cbranch_vccnz Lz20_r
Lz20_ok:
    v_mfma_f32_16x16x32_bf16 v[206:209], v[62:65], a[160:163], v[206:209]
    global_load_dwordx4 v[126:129], v30, s[64:65] offset:2048 sc1
    ds_read_b128 v[194:197], v23 offset:12288
    v_mfma_f32_16x16x32_bf16 v[210:213], v[62:65], a[164:167], v[210:213]
    ds_read_b128 v[198:201], v23 offset:13312
    v_mfma_f32_16x16x32_bf16 v[214:217], v[62:65], a[168:171], v[214:217]
    ds_read_b128 v[202:205], v23 offset:14336
    v_mfma_f32_16x16x32_bf16 v[218:221], v[62:65], a[172:175], v[218:221]
    v_lshlrev_b32 v12, 16, v54
    v_mfma_f32_16x16x32_bf16 v[206:209], v[66:69], a[176:179], v[206:209]
    global_load_dwordx4 v[130:133], v31, s[64:65] offset:2048 sc1
    v_and_b32 v13, 0xffff0000, v54
    v_mfma_f32_16x16x32_bf16 v[210:213], v[66:69], a[180:183], v[210:213]
    v_mfma_f32_16x16x32_bf16 v[214:217], v[66:69], a[184:187], v[214:217]
    v_lshlrev_b32 v14, 16, v55
    v_mfma_f32_16x16x32_bf16 v[218:221], v[66:69], a[188:191], v[218:221]
    v_and_b32 v15, 0xffff0000, v55
    v_mfma_f32_16x16x32_bf16 v[206:209], v[70:73], a[192:195], v[206:209]
    global_load_dwordx4 v[134:137], v30, s[66:67] offset:2048 sc1
    s_waitcnt lgkmcnt(2)
    v_add_f32 v190, v190, v194
    v_mfma_f32_16x16x32_bf16 v[210:213], v[70:73], a[196:199], v[210:213]
    v_add_f32 v191, v191, v195
    v_mfma_f32_16x16x32_bf16 v[214:217], v[70:73], a[200:203], v[214:217]
    v_mfma_f32_16x16x32_bf16 v[218:221], v[70:73], a[204:207], v[218:221]
    s_waitcnt vmcnt(13)
    v_max_u32 v28, v81, v85
    v_add_f32 v192, v192, v196
    v_mfma_f32_16x16x32_bf16 v[206:209], v[74:77], a[208:211], v[206:209]
    global_load_dwordx4 v[138:141], v31, s[66:67] offset:2048 sc1
    s_waitcnt vmcnt(12)
    v_max3_u32 v28, v89, v93, v28
    v_add_f32 v193, v193, v197
    v_mfma_f32_16x16x32_bf16 v[210:213], v[74:77], a[212:215], v[210:213]
    v_cmp_eq_u32 vcc, -1, v28
    s_waitcnt lgkmcnt(1)
    v_add_f32 v190, v190, v198
    v_mfma_f32_16x16x32_bf16 v[214:217], v[74:77], a[216:219], v[214:217]
    v_add_f32 v191, v191, v199
    v_mfma_f32_16x16x32_bf16 v[218:221], v[74:77], a[220:223], v[218:221]
    s_cbranch_vccnz Lz21_r
Lz21_ok:
    v_mfma_f32_16x16x32_bf16 v[206:209], v[78:81], a[96:99], v[206:209]
    global_load_dwordx4 v[62:65], v30, s[60:61] offset:3072 sc1
    v_add_f32 v192, v192, v200
    v_mfma_f32_16x16x32_bf16 v[210:213], v[78:81], a[100:103], v[210:213]
    v_add_f32 v193, v193, v201
    v_mfma_f32_16x16x32_bf16 v[214:217], v[78:81], a[104:107], v[214:217]
    s_waitcnt lgkmcnt(0)
    v_add_f32 v190, v190, v202
    v_mfma_f32_16x16x32_bf16 v[218:221], v[78:81], a[108:111], v[218:221]
    v_add_f32 v191, v191, v203
    v_mfma_f32_16x16x32_bf16 v[206:209], v[82:85], a[112:115], v[206:209]
    global_load_dwordx4 v[66:69], v31, s[60:61] offset:3072 sc1
    v_add_f32 v192, v192, v204
    v_mfma_f32_16x16x32_bf16 v[210:213], v[82:85], a[116:119], v[210:213]
    v_mfma_f32_16x16x32_bf16 v[214:217], v[82:85], a[120:123], v[214:217]
    v_add_f32 v193, v193, v205
    v_mfma_f32_16x16x32_bf16 v[218:221], v[82:85], a[124:127], v[218:221]
    v_mul_f32 v190, v190, v12
    v_mfma_f32_16x16x32_bf16 v[206:209], v[86:89], a[128:131], v[206:209]
    global_load_dwordx4 v[70:73], v30, s[62:63] offset:3072 sc1
    v_mul_f32 v191, v191, v13
    v_mfma_f32_16x16x32_bf16 v[210:213], v[86:89], a[132:135], v[210:213]
    v_mul_f32 v192, v192, v14
    v_mfma_f32_16x16x32_bf16 v[214:217], v[86:89], a[136:139], v[214:217]
    v_mfma_f32_16x16x32_bf16 v[218:221], v[86:89], a[140:143], v[218:221]
    s_waitcnt vmcnt(13)
    v_max_u32 v28, v97, v101
    v_mul_f32 v193, v193, v15
    v_mfma_f32_16x16x32_bf16 v[206:209], v[90:93], a[144:147], v[206:209]
    global_load_dwordx4 v[74:77], v31, s[62:63] offset:3072 sc1
    s_waitcnt vmcnt(12)
    v_max3_u32 v28, v105, v109, v28
    v_cvt_pk_bf16_f32 v54, v190, v191
    v_mfma_f32_16x16x32_bf16 v[210:213], v[90:93], a[148:151], v[210:213]
    v_cmp_eq_u32 vcc, -1, v28
    v_cvt_pk_bf16_f32 v55, v192, v193
    v_mfma_f32_16x16x32_bf16 v[214:217], v[90:93], a[152:155], v[214:217]
    v_min_u32 v55, -2, v55
    v_mfma_f32_16x16x32_bf16 v[218:221], v[90:93], a[156:159], v[218:221]
    s_cbranch_vccnz Lz22_r
Lz22_ok:
    v_mfma_f32_16x16x32_bf16 v[222:225], v[94:97], a[32:35], v[222:225]
    global_load_dwordx4 v[78:81], v30, s[52:53] offset:3072 sc1
    v_mfma_f32_16x16x32_bf16 v[226:229], v[94:97], a[36:39], v[226:229]
    v_mfma_f32_16x16x32_bf16 v[230:233], v[94:97], a[40:43], v[230:233]
    v_mfma_f32_16x16x32_bf16 v[234:237], v[94:97], a[44:47], v[234:237]
    ds_write_b128 v20, v[210:213] offset:0
    v_mfma_f32_16x16x32_bf16 v[222:225], v[98:101], a[48:51], v[222:225]
    global_load_dwordx4 v[82:85], v31, s[52:53] offset:3072 sc1
    v_mfma_f32_16x16x32_bf16 v[226:229], v[98:101], a[52:55], v[226:229]
    v_mfma_f32_16x16x32_bf16 v[230:233], v[98:101], a[56:59], v[230:233]
    ds_write_b128 v21, v[214:217] offset:0
    v_mfma_f32_16x16x32_bf16 v[234:237], v[98:101], a[60:63], v[234:237]
    v_mfma_f32_16x16x32_bf16 v[222:225], v[102:105], a[64:67], v[222:225]
    global_load_dwordx4 v[86:89], v30, s[54:55] offset:3072 sc1
    v_mfma_f32_16x16x32_bf16 v[226:229], v[102:105], a[68:71], v[226:229]
    ds_write_b128 v22, v[218:221] offset:0
    v_mfma_f32_16x16x32_bf16 v[230:233], v[102:105], a[72:75], v[230:233]
    v_mfma_f32_16x16x32_bf16 v[234:237], v[102:105], a[76:79], v[234:237]
    s_waitcnt vmcnt(13)
    v_max_u32 v28, v113, v117
    v_mfma_f32_16x16x32_bf16 v[222:225], v[106:109], a[80:83], v[222:225]
    global_load_dwordx4 v[90:93], v31, s[54:55] offset:3072 sc1
    s_waitcnt vmcnt(12)
    v_max3_u32 v28, v121, v125, v28
    s_waitcnt lgkmcnt(0)
    s_barrier
    v_mfma_f32_16x16x32_bf16 v[226:229], v[106:109], a[84:87], v[226:229]
    v_cmp_eq_u32 vcc, -1, v28
    v_mfma_f32_16x16x32_bf16 v[230:233], v[106:109], a[88:91], v[230:233]
    v_mfma_f32_16x16x32_bf16 v[234:237], v[106:109], a[92:95], v[234:237]
    s_cbranch_vccnz Lz23_r
Lz23_ok:
    v_mfma_f32_16x16x32_bf16 v[222:225], v[110:113], a[160:163], v[222:225]
    global_load_dwordx4 v[94:97], v30, s[64:65] offset:3072 sc1
    ds_read_b128 v[210:213], v23 offset:0
    v_mfma_f32_16x16x32_bf16 v[226:229], v[110:113], a[164:167], v[226:229]
    ds_read_b128 v[214:217], v23 offset:1024
    v_mfma_f32_16x16x32_bf16 v[230:233], v[110:113], a[168:171], v[230:233]
    ds_read_b128 v[218:221], v23 offset:2048
    v_mfma_f32_16x16x32_bf16 v[234:237], v[110:113], a[172:175], v[234:237]
    v_lshlrev_b32 v12, 16, v56
    v_mfma_f32_16x16x32_bf16 v[222:225], v[114:117], a[176:179], v[222:225]
    global_load_dwordx4 v[98:101], v31, s[64:65] offset:3072 sc1
    v_and_b32 v13, 0xffff0000, v56
    v_mfma_f32_16x16x32_bf16 v[226:229], v[114:117], a[180:183], v[226:229]
    v_mfma_f32_16x16x32_bf16 v[230:233], v[114:117], a[184:187], v[230:233]
    v_lshlrev_b32 v14, 16, v57
    v_mfma_f32_16x16x32_bf16 v[234:237], v[114:117], a[188:191], v[234:237]
    v_and_b32 v15, 0xffff0000, v57
    v_mfma_f32_16x16x32_bf16 v[222:225], v[118:121], a[192:195], v[222:225]
    global_load_dwordx4 v[102:105], v30, s[66:67] offset:3072 sc1
    s_waitcnt lgkmcnt(2)
    v_add_f32 v206, v206, v210
    v_mfma_f32_16x16x32_bf16 v[226:229], v[118:121], a[196:199], v[226:229]
    v_add_f32 v207, v207, v211
    v_mfma_f32_16x16x32_bf16 v[230:233], v[118:121], a[200:203], v[230:233]
    v_mfma_f32_16x16x32_bf16 v[234:237], v[118:121], a[204:207], v[234:237]
    s_waitcnt vmcnt(13)
    v_max_u32 v28, v129, v133
    v_add_f32 v208, v208, v212
    v_mfma_f32_16x16x32_bf16 v[222:225], v[122:125], a[208:211], v[222:225]
    global_load_dwordx4 v[106:109], v31, s[66:67] offset:3072 sc1
    s_waitcnt vmcnt(12)
    v_max3_u32 v28, v137, v141, v28
    v_add_f32 v209, v209, v213
    v_mfma_f32_16x16x32_bf16 v[226:229], v[122:125], a[212:215], v[226:229]
    v_cmp_eq_u32 vcc, -1, v28
    s_waitcnt lgkmcnt(1)
    v_add_f32 v206, v206, v214
    v_mfma_f32_16x16x32_bf16 v[230:233], v[122:125], a[216:219], v[230:233]
    v_add_f32 v207, v207, v215
    v_mfma_f32_16x16x32_bf16 v[234:237], v[122:125], a[220:223], v[234:237]
    s_cbranch_vccnz Lz24_r
Lz24_ok:
    v_mfma_f32_16x16x32_bf16 v[222:225], v[126:129], a[96:99], v[222:225]
    global_store_dwordx4 v24, v[48:51], s[38:39] offset:0 sc1
    v_add_f32 v208, v208, v216
    v_mfma_f32_16x16x32_bf16 v[226:229], v[126:129], a[100:103], v[226:229]
    v_add_f32 v209, v209, v217
    v_mfma_f32_16x16x32_bf16 v[230:233], v[126:129], a[104:107], v[230:233]
    global_store_dwordx4 v24, v[52:55], s[38:39] offset:1024 sc1
    s_waitcnt lgkmcnt(0)
    v_add_f32 v206, v206, v218
    v_mfma_f32_16x16x32_bf16 v[234:237], v[126:129], a[108:111], v[234:237]
    v_mfma_f32_16x16x32_bf16 v[222:225], v[130:133], a[112:115], v[222:225]
    global_load_lds_dwordx4 v4, s[92:93] offset:2048 sc1
    v_add_f32 v207, v207, v219
    v_mfma_f32_16x16x32_bf16 v[226:229], v[130:133], a[116:119], v[226:229]
    v_add_f32 v208, v208, v220
    v_mfma_f32_16x16x32_bf16 v[230:233], v[130:133], a[120:123], v[230:233]
    global_load_lds_dwordx4 v4, s[92:93] offset:3072 sc1
    v_add_f32 v209, v209, v221
    v_mfma_f32_16x16x32_bf16 v[234:237], v[130:133], a[124:127], v[234:237]
    v_mfma_f32_16x16x32_bf16 v[222:225], v[134:137], a[128:131], v[222:225]
    s_add_u32 m0, s95, 12288
    s_add_u32 s92, s92, 4096
    s_addc_u32 s93, s93, 0
    global_load_lds_dwordx4 v4, s[92:93] offset:0 sc1
    v_mul_f32 v206, v206, v12
    v_mfma_f32_16x16x32_bf16 v[226:229], v[134:137], a[132:135], v[226:229]
    v_mul_f32 v207, v207, v13
    v_mfma_f32_16x16x32_bf16 v[230:233], v[134:137], a[136:139], v[230:233]
    global_load_lds_dwordx4 v4, s[92:93] offset:1024 sc1
    v_mul_f32 v208, v208, v14
    v_mfma_f32_16x16x32_bf16 v[234:237], v[134:137], a[140:143], v[234:237]
    s_waitcnt vmcnt(16)
    v_max_u32 v28, v65, v69
    v_mfma_f32_16x16x32_bf16 v[222:225], v[138:141], a[144:147], v[222:225]
    global_load_lds_dwordx4 v4, s[92:93] offset:2048 sc1
    s_waitcnt vmcnt(15)
    v_max3_u32 v28, v73, v77, v28
    v_mul_f32 v209, v209, v15
    v_mfma_f32_16x16x32_bf16 v[226:229], v[138:141], a[148:151], v[226:229]
    v_cmp_eq_u32 vcc, -1, v28
    v_cvt_pk_bf16_f32 v56, v206, v207
    v_mfma_f32_16x16x32_bf16 v[230:233], v[138:141], a[152:155], v[230:233]
    global_load_lds_dwordx4 v4, s[92:93] offset:3072 sc1
    v_cvt_pk_bf16_f32 v57, v208, v209
    v_mfma_f32_16x16x32_bf16 v[234:237], v[138:141], a[156:159], v[234:237]
    s_cbranch_vccnz Lz25_r
Lz25_ok:
    v_mfma_f32_16x16x32_bf16 v[238:241], v[62:65], a[32:35], v[238:241]
    s_add_u32 m0, s95, 16384
    s_add_u32 s92, s92, 4096
    s_addc_u32 s93, s93, 0
    global_load_lds_dwordx4 v4, s[92:93] offset:0 sc1
    v_mfma_f32_16x16x32_bf16 v[242:245], v[62:65], a[36:39], v[242:245]
    v_mfma_f32_16x16x32_bf16 v[246:249], v[62:65], a[40:43], v[246:249]
    global_load_lds_dwordx4 v4, s[92:93] offset:1024 sc1
    v_mfma_f32_16x16x32_bf16 v[250:253], v[62:65], a[44:47], v[250:253]
    ds_write_b128 v20, v[226:229] offset:12288
    v_mfma_f32_16x16x32_bf16 v[238:241], v[66:69], a[48:51], v[238:241]
    v_mfma_f32_16x16x32_bf16 v[242:245], v[66:69], a[52:55], v[242:245]
    global_load_lds_dwordx4 v4, s[92:93] offset:2048 sc1
    v_mfma_f32_16x16x32_bf16 v[246:249], v[66:69], a[56:59], v[246:249]
    ds_write_b128 v21, v[230:233] offset:12288
    v_mfma_f32_16x16x32_bf16 v[250:253], v[66:69], a[60:63], v[250:253]
    v_mfma_f32_16x16x32_bf16 v[238:241], v[70:73], a[64:67], v[238:241]
    global_load_lds_dwordx4 v4, s[92:93] offset:3072 sc1
    v_mfma_f32_16x16x32_bf16 v[242:245], v[70:73], a[68:71], v[242:245]
    ds_write_b128 v22, v[234:237] offset:12288
    v_mfma_f32_16x16x32_bf16 v[246:249], v[70:73], a[72:75], v[246:249]
    s_add_u32 m0, s95, 20480
    s_add_u32 s92, s92, 4096
    s_addc_u32 s93, s93, 0
    global_load_lds_dwordx4 v4, s[92:93] offset:0 sc1
    v_mfma_f32_16x16x32_bf16 v[250:253], v[70:73], a[76:79], v[250:253]
    s_waitcnt vmcnt(19)
    v_max_u32 v28, v81, v85
    v_mfma_f32_16x16x32_bf16 v[238:241], v[74:77], a[80:83], v[238:241]
    s_waitcnt vmcnt(17)
    v_max3_u32 v28, v89, v93, v28
    s_waitcnt lgkmcnt(0)
    s_barrier
    v_mfma_f32_16x16x32_bf16 v[242:245], v[74:77], a[84:87], v[242:245]
    global_load_lds_dwordx4 v4, s[92:93] offset:1024 sc1
    v_cmp_eq_u32 vcc, -1, v28
    v_mfma_f32_16x16x32_bf16 v[246:249], v[74:77], a[88:91], v[246:249]
    v_mfma_f32_16x16x32_bf16 v[250:253], v[74:77], a[92:95], v[250:253]
    s_cbranch_vccnz Lz26_r
Lz26_ok:
    v_mfma_f32_16x16x32_bf16 v[238:241], v[78:81], a[160:163], v[238:241]
    global_load_lds_dwordx4 v4, s[92:93] offset:2048 sc1
    ds_read_b128 v[226:229], v23 offset:12288
    v_mfma_f32_16x16x32_bf16 v[242:245], v[78:81], a[164:167], v[242:245]
    ds_read_b128 v[230:233], v23 offset:13312
    v_mfma_f32_16x16x32_bf16 v[246:249], v[78:81], a[168:171], v[246:249]
    global_load_lds_dwordx4 v4, s[92:93] offset:3072 sc1
    ds_read_b128 v[234:237], v23 offset:14336
    v_mfma_f32_16x16x32_bf16 v[250:253], v[78:81], a[172:175], v[250:253]
    v_lshlrev_b32 v12, 16, v58
    v_mfma_f32_16x16x32_bf16 v[238:241], v[82:85], a[176:179], v[238:241]
    v_and_b32 v13, 0xffff0000, v58
    v_mfma_f32_16x16x32_bf16 v[242:245], v[82:85], a[180:183], v[242:245]
    s_add_u32 m0, s95, 24576
    s_add_u32 s92, s92, 4096
    s_addc_u32 s93, s93, 0
    global_load_lds_dwordx4 v4, s[92:93] offset:0 sc1
    v_mfma_f32_16x16x32_bf16 v[246:249], v[82:85], a[184:187], v[246:249]
    v_lshlrev_b32 v14, 16, v59
    v_mfma_f32_16x16x32_bf16 v[250:253], v[82:85], a[188:191], v[250:253]
    v_and_b32 v15, 0xffff0000, v59
    v_mfma_f32_16x16x32_bf16 v[238:241], v[86:89], a[192:195], v[238:241]
    global_load_lds_dwordx4 v4, s[92:93] offset:1024 sc1
    s_waitcnt lgkmcnt(2)
    v_add_f32 v222, v222, v226
    v_mfma_f32_16x16x32_bf16 v[242:245], v[86:89], a[196:199], v[242:245]
    v_add_f32 v223, v223, v227
    v_mfma_f32_16x16x32_bf16 v[246:249], v[86:89], a[200:203], v[246:249]
    global_load_lds_dwordx4 v4, s[92:93] offset:2048 sc1
    v_mfma_f32_16x16x32_bf16 v[250:253], v[86:89], a[204:207], v[250:253]
    s_waitcnt vmcnt(21)
    v_max_u32 v28, v97, v101
    v_add_f32 v224, v224, v228
    v_mfma_f32_16x16x32_bf16 v[238:241], v[90:93], a[208:211], v[238:241]
    s_waitcnt vmcnt(19)
    v_max3_u32 v28, v105, v109, v28
    v_add_f32 v225, v225, v229
    v_mfma_f32_16x16x32_bf16 v[242:245], v[90:93], a[212:215], v[242:245]
    global_load_lds_dwordx4 v4, s[92:93] offset:3072 sc1
    v_cmp_eq_u32 vcc, -1, v28
    s_waitcnt lgkmcnt(1)
    v_add_f32 v222, v222, v230
    v_mfma_f32_16x16x32_bf16 v[246:249], v[90:93], a[216:219], v[246:249]
    v_add_f32 v223, v223, v231
    v_mfma_f32_16x16x32_bf16 v[250:253], v[90:93], a[220:223], v[250:253]
    s_cbranch_vccnz Lz27_r
Lz27_ok:
    v_mfma_f32_16x16x32_bf16 v[238:241], v[94:97], a[96:99], v[238:241]
    s_add_u32 m0, s95, 28672
    s_add_u32 s92, s92, 4096
    s_addc_u32 s93, s93, 0
    global_load_lds_dwordx4 v4, s[92:93] offset:0 sc1
    v_add_f32 v224, v224, v232
    v_mfma_f32_16x16x32_bf16 v[242:245], v[94:97], a[100:103], v[242:245]
    v_add_f32 v225, v225, v233
    v_mfma_f32_16x16x32_bf16 v[246:249], v[94:97], a[104:107], v[246:249]
    global_load_lds_dwordx4 v4, s[92:93] offset:1024 sc1
    s_waitcnt lgkmcnt(0)
    v_add_f32 v222, v222, v234
    v_mfma_f32_16x16x32_bf16 v[250:253], v[94:97], a[108:111], v[250:253]
    v_add_f32 v223, v223, v235
    v_mfma_f32_16x16x32_bf16 v[238:241], v[98:101], a[112:115], v[238:241]
    v_add_f32 v224, v224, v236
    v_mfma_f32_16x16x32_bf16 v[242:245], v[98:101], a[116:119], v[242:245]
    global_load_lds_dwordx4 v4, s[92:93] offset:2048 sc1
    v_mfma_f32_16x16x32_bf16 v[246:249], v[98:101], a[120:123], v[246:249]
    v_add_f32 v225, v225, v237
    v_mfma_f32_16x16x32_bf16 v[250:253], v[98:101], a[124:127], v[250:253]
    v_mul_f32 v222, v222, v12
    v_mfma_f32_16x16x32_bf16 v[238:241], v[102:105], a[128:131], v[238:241]
    global_load_lds_dwordx4 v4, s[92:93] offset:3072 sc1
    v_mul_f32 v223, v223, v13
    v_mfma_f32_16x16x32_bf16 v[242:245], v[102:105], a[132:135], v[242:245]
    v_mul_f32 v224, v224, v14
    v_mfma_f32_16x16x32_bf16 v[246:249], v[102:105], a[136:139], v[246:249]
    s_add_u32 m0, s95, 32768
    s_add_u32 s92, s92, 4096
    s_addc_u32 s93, s93, 0
    global_load_lds_dwordx4 v4, s[92:93] offset:0 sc1
    v_mfma_f32_16x16x32_bf16 v[250:253], v[102:105], a[140:143], v[250:253]
    v_mul_f32 v225, v225, v15
    v_mfma_f32_16x16x32_bf16 v[238:241], v[106:109], a[144:147], v[238:241]
    v_cvt_pk_bf16_f32 v58, v222, v223
    v_mfma_f32_16x16x32_bf16 v[242:245], v[106:109], a[148:151], v[242:245]
    global_load_lds_dwordx4 v4, s[92:93] offset:1024 sc1
    v_cvt_pk_bf16_f32 v59, v224, v225
    v_mfma_f32_16x16x32_bf16 v[246:249], v[106:109], a[152:155], v[246:249]
    v_min_u32 v59, -2, v59
    v_mfma_f32_16x16x32_bf16 v[250:253], v[106:109], a[156:159], v[250:253]
    global_load_dwordx4 v[142:145], v6, s[38:39] offset:-4096 sc1
    s_nop 1
    ds_write_b128 v20, v[242:245] offset:0
    global_load_dwordx4 v[146:149], v6, s[38:39] offset:0 sc1
    s_nop 0
    ds_write_b128 v21, v[246:249] offset:0
    global_load_dwordx4 v[150:153], v6, s[38:39] offset:3072 sc1
    ds_write_b128 v22, v[250:253] offset:0
    global_load_dwordx4 v[154:157], v7, s[38:39] offset:-1024 sc1
    s_waitcnt lgkmcnt(0)
    s_barrier
    global_load_dwordx4 v[158:161], v7, s[38:39] offset:2048 sc1
    ds_read_b128 v[242:245], v23 offset:0
    global_load_dwordx4 v[162:165], v26, s[38:39] offset:-2048 sc1
    ds_read_b128 v[246:249], v23 offset:1024
    global_load_dwordx4 v[166:169], v26, s[38:39] offset:1024 sc1
    ds_read_b128 v[250:253], v23 offset:2048
    global_load_dwordx4 v[170:173], v27, s[38:39] offset:-3072 sc1
    v_lshlrev_b32 v12, 16, v60
    v_and_b32 v13, 0xffff0000, v60
    global_load_dwordx4 v[174:177], v6, s[38:39] offset:-3072 sc1
    v_lshlrev_b32 v14, 16, v61
    global_load_dwordx4 v[178:181], v6, s[38:39] offset:1024 sc1
    v_and_b32 v15, 0xffff0000, v61
    global_load_dwordx4 v[182:185], v7, s[38:39] offset:-4096 sc1
    s_waitcnt lgkmcnt(2)
    v_pk_add_f32 v[238:239], v[238:239], v[242:243] op_sel:[0,0] op_sel_hi:[1,1]
    global_load_dwordx4 v[186:189], v7, s[38:39] offset:0 sc1
    v_pk_add_f32 v[240:241], v[240:241], v[244:245] op_sel:[0,0] op_sel_hi:[1,1]
    s_waitcnt lgkmcnt(1)
    v_pk_add_f32 v[238:239], v[238:239], v[246:247] op_sel:[0,0] op_sel_hi:[1,1]
    global_load_dwordx4 v[190:193], v7, s[38:39] offset:3072 sc1
    v_pk_add_f32 v[240:241], v[240:241], v[248:249] op_sel:[0,0] op_sel_hi:[1,1]
    global_load_dwordx4 v[194:197], v26, s[38:39] offset:-1024 sc1
    s_waitcnt lgkmcnt(0)
    v_pk_add_f32 v[238:239], v[238:239], v[250:251] op_sel:[0,0] op_sel_hi:[1,1]
    global_load_dwordx4 v[198:201], v26, s[38:39] offset:2048 sc1
    v_pk_add_f32 v[240:241], v[240:241], v[252:253] op_sel:[0,0] op_sel_hi:[1,1]
    global_load_dwordx4 v[202:205], v27, s[38:39] offset:-2048 sc1
    v_pk_mul_f32 v[238:239], v[238:239], v[12:13] op_sel:[0,0] op_sel_hi:[1,1]
    v_pk_mul_f32 v[240:241], v[240:241], v[14:15] op_sel:[0,0] op_sel_hi:[1,1]
    v_cvt_pk_bf16_f32 v60, v238, v239
    v_cvt_pk_bf16_f32 v61, v240, v241
    v_min_u32 v61, -2, v61
    global_store_dwordx4 v24, v[56:59], s[38:39] offset:2048 sc1
    global_store_dwordx2 v25, v[60:61], s[38:39] sc1
    v_add_u32 v30, 61440, v4
    v_add_u32 v31, 122880, v4
    s_waitcnt vmcnt(18)
    s_barrier
    ds_read_b128 v[82:85], v4 offset:0
    ds_read_b128 v[86:89], v4 offset:1024
    ds_read_b128 v[90:93], v4 offset:2048
    ds_read_b128 v[94:97], v4 offset:3072
    ds_read_b128 v[98:101], v4 offset:4096
    s_waitcnt vmcnt(16)
    v_max_u32 v28, v145, v149
    s_waitcnt vmcnt(14)
    v_max3_u32 v28, v153, v157, v28
    s_waitcnt vmcnt(12)
    v_max3_u32 v28, v161, v165, v28
    s_waitcnt vmcnt(10)
    v_max3_u32 v28, v169, v173, v28
    v_cmp_eq_u32 vcc, -1, v28
    s_nop 0
    s_cbranch_vccnz Lp0_r
Lp0_ok:
    s_waitcnt lgkmcnt(4)
    v_mfma_f32_16x16x32_bf16 v[62:65], v[82:85], v[142:145], 0
    ds_read_b128 v[102:105], v4 offset:20480
    s_waitcnt lgkmcnt(4)
    v_mfma_f32_16x16x32_bf16 v[66:69], v[86:89], v[142:145], 0
    ds_read_b128 v[82:85], v4 offset:21504
    s_waitcnt lgkmcnt(4)
    v_mfma_f32_16x16x32_bf16 v[70:73], v[90:93], v[142:145], 0
    ds_read_b128 v[86:89], v4 offset:22528
    s_waitcnt lgkmcnt(4)
    v_mfma_f32_16x16x32_bf16 v[74:77], v[94:97], v[142:145], 0
    ds_read_b128 v[90:93], v4 offset:23552
    s_waitcnt lgkmcnt(4)
    v_mfma_f32_16x16x32_bf16 v[78:81], v[98:101], v[142:145], 0
    ds_read_b128 v[94:97], v4 offset:24576
    s_waitcnt lgkmcnt(4)
    v_mfma_f32_16x16x32_bf16 v[62:65], v[102:105], v[146:149], v[62:65]
    ds_read_b128 v[98:101], v4 offset:35840
    s_waitcnt lgkmcnt(4)
    v_mfma_f32_16x16x32_bf16 v[66:69], v[82:85], v[146:149], v[66:69]
    ds_read_b128 v[102:105], v4 offset:36864
    s_waitcnt lgkmcnt(4)
    v_mfma_f32_16x16x32_bf16 v[70:73], v[86:89], v[146:149], v[70:73]
    ds_read_b128 v[82:85], v4 offset:37888
    s_waitcnt lgkmcnt(4)
    v_mfma_f32_16x16x32_bf16 v[74:77], v[90:93], v[146:149], v[74:77]
    ds_read_b128 v[86:89], v4 offset:38912
    s_waitcnt lgkmcnt(4)
    v_mfma_f32_16x16x32_bf16 v[78:81], v[94:97], v[146:149], v[78:81]
    ds_read_b128 v[90:93], v4 offset:39936
    s_waitcnt lgkmcnt(4)
    v_mfma_f32_16x16x32_bf16 v[62:65], v[98:101], v[150:153], v[62:65]
    ds_read_b128 v[94:97], v4 offset:56320
    s_waitcnt lgkmcnt(4)
    v_mfma_f32_16x16x32_bf16 v[66:69], v[102:105], v[150:153], v[66:69]
    ds_read_b128 v[98:101], v4 offset:57344
    s_waitcnt lgkmcnt(4)
    v_mfma_f32_16x16x32_bf16 v[70:73], v[82:85], v[150:153], v[70:73]
    ds_read_b128 v[102:105], v4 offset:58368
    s_waitcnt lgkmcnt(4)
    v_mfma_f32_16x16x32_bf16 v[74:77], v[86:89], v[150:153], v[74:77]
    ds_read_b128 v[82:85], v4 offset:59392
    s_waitcnt lgkmcnt(4)
    v_mfma_f32_16x16x32_bf16 v[78:81], v[90:93], v[150:153], v[78:81]
    ds_read_b128 v[86:89], v4 offset:60416
    s_waitcnt lgkmcnt(4)
    v_mfma_f32_16x16x32_bf16 v[62:65], v[94:97], v[154:157], v[62:65]
    ds_read_b128 v[90:93], v30 offset:10240
    s_waitcnt lgkmcnt(4)
    v_mfma_f32_16x16x32_bf16 v[66:69], v[98:101], v[154:157], v[66:69]
    ds_read_b128 v[94:97], v30 offset:11264
    s_waitcnt lgkmcnt(4)
    v_mfma_f32_16x16x32_bf16 v[70:73], v[102:105], v[154:157], v[70:73]
    ds_read_b128 v[98:101], v30 offset:12288
    s_waitcnt lgkmcnt(4)
    v_mfma_f32_16x16x32_bf16 v[74:77], v[82:85], v[154:157], v[74:77]
    ds_read_b128 v[102:105], v30 offset:13312
    s_waitcnt lgkmcnt(4)
    v_mfma_f32_16x16x32_bf16 v[78:81], v[86:89], v[154:157], v[78:81]
    ds_read_b128 v[82:85], v30 offset:14336
    s_waitcnt lgkmcnt(4)
    v_mfma_f32_16x16x32_bf16 v[62:65], v[90:93], v[158:161], v[62:65]
    ds_read_b128 v[86:89], v30 offset:30720
    s_waitcnt lgkmcnt(4)
    v_mfma_f32_16x16x32_bf16 v[66:69], v[94:97], v[158:161], v[66:69]
    ds_read_b128 v[90:93], v30 offset:31744
    s_waitcnt lgkmcnt(4)
    v_mfma_f32_16x16x32_bf16 v[70:73], v[98:101], v[158:161], v[70:73]
    ds_read_b128 v[94:97], v30 offset:32768
    s_waitcnt lgkmcnt(4)
    v_mfma_f32_16x16x32_bf16 v[74:77], v[102:105], v[158:161], v[74:77]
    ds_read_b128 v[98:101], v30 offset:33792
    s_waitcnt lgkmcnt(4)
    v_mfma_f32_16x16x32_bf16 v[78:81], v[82:85], v[158:161], v[78:81]
    ds_read_b128 v[102:105], v30 offset:34816
    s_waitcnt lgkmcnt(4)
    v_mfma_f32_16x16x32_bf16 v[62:65], v[86:89], v[162:165], v[62:65]
    ds_read_b128 v[82:85], v30 offset:46080
    s_waitcnt lgkmcnt(4)
    v_mfma_f32_16x16x32_bf16 v[66:69], v[90:93], v[162:165], v[66:69]
    ds_read_b128 v[86:89], v30 offset:47104
    s_waitcnt lgkmcnt(4)
    v_mfma_f32_16x16x32_bf16 v[70:73], v[94:97], v[162:165], v[70:73]
    ds_read_b128 v[90:93], v30 offset:48128
    s_waitcnt lgkmcnt(4)
    v_mfma_f32_16x16x32_bf16 v[74:77], v[98:101], v[162:165], v[74:77]
    ds_read_b128 v[94:97], v30 offset:49152
    s_waitcnt lgkmcnt(4)
    v_mfma_f32_16x16x32_bf16 v[78:81], v[102:105], v[162:165], v[78:81]
    ds_read_b128 v[98:101], v30 offset:50176
    s_waitcnt lgkmcnt(4)
    v_mfma_f32_16x16x32_bf16 v[62:65], v[82:85], v[166:169], v[62:65]
    ds_read_b128 v[102:105], v31 offset:5120
    s_waitcnt lgkmcnt(4)
    v_mfma_f32_16x16x32_bf16 v[66:69], v[86:89], v[166:169], v[66:69]
    ds_read_b128 v[82:85], v31 offset:6144
    s_waitcnt lgkmcnt(4)
    v_mfma_f32_16x16x32_bf16 v[70:73], v[90:93], v[166:169], v[70:73]
    ds_read_b128 v[86:89], v31 offset:7168
    s_waitcnt lgkmcnt(4)
    v_mfma_f32_16x16x32_bf16 v[74:77], v[94:97], v[166:169], v[74:77]
    ds_read_b128 v[90:93], v31 offset:8192
    s_waitcnt lgkmcnt(4)
    v_mfma_f32_16x16x32_bf16 v[78:81], v[98:101], v[166:169], v[78:81]
    ds_read_b128 v[94:97], v31 offset:9216
    s_waitcnt lgkmcnt(4)
    v_mfma_f32_16x16x32_bf16 v[62:65], v[102:105], v[170:173], v[62:65]
    ds_read_b128 v[98:101], v4 offset:5120
    s_waitcnt lgkmcnt(4)
    v_mfma_f32_16x16x32_bf16 v[66:69], v[82:85], v[170:173], v[66:69]
    ds_read_b128 v[102:105], v4 offset:6144
    s_waitcnt lgkmcnt(4)
    v_mfma_f32_16x16x32_bf16 v[70:73], v[86:89], v[170:173], v[70:73]
    ds_read_b128 v[82:85], v4 offset:7168
    s_waitcnt lgkmcnt(4)
    v_mfma_f32_16x16x32_bf16 v[74:77], v[90:93], v[170:173], v[74:77]
    ds_read_b128 v[86:89], v4 offset:8192
    s_waitcnt lgkmcnt(4)
    v_mfma_f32_16x16x32_bf16 v[78:81], v[94:97], v[170:173], v[78:81]
    ds_read_b128 v[90:93], v4 offset:9216
    s_waitcnt vmcnt(8)
    v_max_u32 v28, v177, v181
    s_waitcnt vmcnt(6)
    v_max3_u32 v28, v185, v189, v28
    s_waitcnt vmcnt(4)
    v_max3_u32 v28, v193, v197, v28
    s_waitcnt vmcnt(2)
    v_max3_u32 v28, v201, v205, v28
    v_cmp_eq_u32 vcc, -1, v28
    s_nop 0
    s_cbranch_vccnz Lp1_r
Lp1_ok:
    s_waitcnt lgkmcnt(4)
    v_mfma_f32_16x16x32_bf16 v[62:65], v[98:101], v[174:177], v[62:65]
    ds_read_b128 v[94:97], v4 offset:25600
    s_waitcnt lgkmcnt(4)
    v_mfma_f32_16x16x32_bf16 v[66:69], v[102:105], v[174:177], v[66:69]
    ds_read_b128 v[98:101], v4 offset:26624
    s_waitcnt lgkmcnt(4)
    v_mfma_f32_16x16x32_bf16 v[70:73], v[82:85], v[174:177], v[70:73]
    ds_read_b128 v[102:105], v4 offset:27648
    s_waitcnt lgkmcnt(4)
    v_mfma_f32_16x16x32_bf16 v[74:77], v[86:89], v[174:177], v[74:77]
    ds_read_b128 v[82:85], v4 offset:28672
    s_waitcnt lgkmcnt(4)
    v_mfma_f32_16x16x32_bf16 v[78:81], v[90:93], v[174:177], v[78:81]
    ds_read_b128 v[86:89], v4 offset:29696
    s_waitcnt lgkmcnt(4)
    v_mfma_f32_16x16x32_bf16 v[62:65], v[94:97], v[178:181], v[62:65]
    ds_read_b128 v[90:93], v4 offset:40960
    s_waitcnt lgkmcnt(4)
    v_mfma_f32_16x16x32_bf16 v[66:69], v[98:101], v[178:181], v[66:69]
    ds_read_b128 v[94:97], v4 offset:41984
    s_waitcnt lgkmcnt(4)
    v_mfma_f32_16x16x32_bf16 v[70:73], v[102:105], v[178:181], v[70:73]
    ds_read_b128 v[98:101], v4 offset:43008
    s_waitcnt lgkmcnt(4)
    v_mfma_f32_16x16x32_bf16 v[74:77], v[82:85], v[178:181], v[74:77]
    ds_read_b128 v[102:105], v4 offset:44032
    s_waitcnt lgkmcnt(4)
    v_mfma_f32_16x16x32_bf16 v[78:81], v[86:89], v[178:181], v[78:81]
    ds_read_b128 v[82:85], v4 offset:45056
    s_waitcnt lgkmcnt(4)
    v_mfma_f32_16x16x32_bf16 v[62:65], v[90:93], v[182:185], v[62:65]
    global_load_dwordx4 v[206:209], v6, s[38:39] offset:-2048 sc1
    ds_read_b128 v[86:89], v30 offset:0
    s_waitcnt lgkmcnt(4)
    v_mfma_f32_16x16x32_bf16 v[66:69], v[94:97], v[182:185], v[66:69]
    ds_read_b128 v[90:93], v30 offset:1024
    s_waitcnt lgkmcnt(4)
    v_mfma_f32_16x16x32_bf16 v[70:73], v[98:101], v[182:185], v[70:73]
    global_load_dwordx4 v[210:213], v6, s[38:39] offset:2048 sc1
    ds_read_b128 v[94:97], v30 offset:2048
    s_waitcnt lgkmcnt(4)
    v_mfma_f32_16x16x32_bf16 v[74:77], v[102:105], v[182:185], v[74:77]
    ds_read_b128 v[98:101], v30 offset:3072
    s_waitcnt lgkmcnt(4)
    v_mfma_f32_16x16x32_bf16 v[78:81], v[82:85], v[182:185], v[78:81]
    ds_read_b128 v[102:105], v30 offset:4096
    s_waitcnt lgkmcnt(4)
    v_mfma_f32_16x16x32_bf16 v[62:65], v[86:89], v[186:189], v[62:65]
    global_load_dwordx4 v[214:217], v7, s[38:39] offset:-3072 sc1
    ds_read_b128 v[82:85], v30 offset:15360
    s_waitcnt lgkmcnt(4)
    v_mfma_f32_16x16x32_bf16 v[66:69], v[90:93], v[186:189], v[66:69]
    ds_read_b128 v[86:89], v30 offset:16384
    s_waitcnt lgkmcnt(4)
    v_mfma_f32_16x16x32_bf16 v[70:73], v[94:97], v[186:189], v[70:73]
    ds_read_b128 v[90:93], v30 offset:17408
    s_waitcnt lgkmcnt(4)
    v_mfma_f32_16x16x32_bf16 v[74:77], v[98:101], v[186:189], v[74:77]
    global_load_dwordx4 v[218:221], v7, s[38:39] offset:1024 sc1
    ds_read_b128 v[94:97], v30 offset:18432
    s_waitcnt lgkmcnt(4)
    v_mfma_f32_16x16x32_bf16 v[78:81], v[102:105], v[186:189], v[78:81]
    ds_read_b128 v[98:101], v30 offset:19456
    s_waitcnt lgkmcnt(4)
    v_mfma_f32_16x16x32_bf16 v[62:65], v[82:85], v[190:193], v[62:65]
    global_load_dwordx4 v[222:225], v26, s[38:39] offset:-4096 sc1
    ds_read_b128 v[102:105], v30 offset:35840
    s_waitcnt lgkmcnt(4)
    v_mfma_f32_16x16x32_bf16 v[66:69], v[86:89], v[190:193], v[66:69]
    ds_read_b128 v[82:85], v30 offset:36864
    s_waitcnt lgkmcnt(4)
    v_mfma_f32_16x16x32_bf16 v[70:73], v[90:93], v[190:193], v[70:73]
    ds_read_b128 v[86:89], v30 offset:37888
    s_waitcnt lgkmcnt(4)
    v_mfma_f32_16x16x32_bf16 v[74:77], v[94:97], v[190:193], v[74:77]
    global_load_dwordx4 v[226:229], v26, s[38:39] offset:0 sc1
    ds_read_b128 v[90:93], v30 offset:38912
    s_waitcnt lgkmcnt(4)
    v_mfma_f32_16x16x32_bf16 v[78:81], v[98:101], v[190:193], v[78:81]
    ds_read_b128 v[94:97], v30 offset:39936
    s_waitcnt lgkmcnt(4)
    v_mfma_f32_16x16x32_bf16 v[62:65], v[102:105], v[194:197], v[62:65]
    ds_read_b128 v[98:101], v30 offset:51200
    s_waitcnt lgkmcnt(4)
    v_mfma_f32_16x16x32_bf16 v[66:69], v[82:85], v[194:197], v[66:69]
    global_load_dwordx4 v[230:233], v26, s[38:39] offset:3072 sc1
    ds_read_b128 v[102:105], v30 offset:52224
    s_waitcnt lgkmcnt(4)
    v_mfma_f32_16x16x32_bf16 v[70:73], v[86:89], v[194:197], v[70:73]
    ds_read_b128 v[82:85], v30 offset:53248
    s_waitcnt lgkmcnt(4)
    v_mfma_f32_16x16x32_bf16 v[74:77], v[90:93], v[194:197], v[74:77]
    ds_read_b128 v[86:89], v30 offset:54272
    s_waitcnt lgkmcnt(4)
    v_mfma_f32_16x16x32_bf16 v[78:81], v[94:97], v[194:197], v[78:81]
    global_load_dwordx4 v[238:241], v6, s[38:39] offset:-1024 sc1
    ds_read_b128 v[90:93], v30 offset:55296
    s_waitcnt lgkmcnt(4)
    v_mfma_f32_16x16x32_bf16 v[62:65], v[98:101], v[198:201], v[62:65]
    ds_read_b128 v[94:97], v31 offset:10240
    s_waitcnt lgkmcnt(4)
    v_mfma_f32_16x16x32_bf16 v[66:69], v[102:105], v[198:201], v[66:69]
    global_load_dwordx4 v[242:245], v7, s[38:39] offset:-2048 sc1
    ds_read_b128 v[98:101], v31 offset:11264
    s_waitcnt lgkmcnt(4)
    v_mfma_f32_16x16x32_bf16 v[70:73], v[82:85], v[198:201], v[70:73]
    ds_read_b128 v[102:105], v31 offset:12288
    s_waitcnt lgkmcnt(4)
    v_mfma_f32_16x16x32_bf16 v[74:77], v[86:89], v[198:201], v[74:77]
    ds_read_b128 v[82:85], v31 offset:13312
    s_waitcnt lgkmcnt(4)
    v_mfma_f32_16x16x32_bf16 v[78:81], v[90:93], v[198:201], v[78:81]
    global_load_dwordx4 v[246:249], v26, s[38:39] offset:-3072 sc1
    ds_read_b128 v[86:89], v31 offset:14336
    s_waitcnt lgkmcnt(4)
    v_mfma_f32_16x16x32_bf16 v[62:65], v[94:97], v[202:205], v[62:65]
    ds_read_b128 v[90:93], v4 offset:10240
    s_waitcnt lgkmcnt(4)
    v_mfma_f32_16x16x32_bf16 v[66:69], v[98:101], v[202:205], v[66:69]
    ds_read_b128 v[94:97], v4 offset:11264
    s_waitcnt lgkmcnt(4)
    v_mfma_f32_16x16x32_bf16 v[70:73], v[102:105], v[202:205], v[70:73]
    global_load_dwordx4 v[250:253], v27, s[38:39] offset:-4096 sc1
    ds_read_b128 v[98:101], v4 offset:12288
    s_waitcnt lgkmcnt(4)
    v_mfma_f32_16x16x32_bf16 v[74:77], v[82:85], v[202:205], v[74:77]
    ds_read_b128 v[102:105], v4 offset:13312
    s_waitcnt lgkmcnt(4)
    v_mfma_f32_16x16x32_bf16 v[78:81], v[86:89], v[202:205], v[78:81]
    ds_read_b128 v[82:85], v4 offset:14336
    v_lshlrev_b32 v29, 5, v3
    v_add_u32 v29, 162816, v29
    ds_read_b128 v[106:109], v29 offset:0
    ds_read_b128 v[110:113], v29 offset:16
    ds_read_b128 v[114:117], v29 offset:128
    ds_read_b128 v[118:121], v29 offset:144
    v_lshlrev_b32 v29, 4, v3
    v_add_u32 v29, 162816, v29
    ds_read_b128 v[122:125], v29 offset:256
    v_lshlrev_b32 v126, 16, v36
    v_and_b32 v127, 0xffff0000, v36
    v_lshlrev_b32 v128, 16, v37
    v_and_b32 v129, 0xffff0000, v37
    v_lshlrev_b32 v130, 16, v38
    v_and_b32 v131, 0xffff0000, v38
    v_lshlrev_b32 v132, 16, v39
    v_and_b32 v133, 0xffff0000, v39
    v_lshlrev_b32 v134, 16, v40
    v_and_b32 v135, 0xffff0000, v40
    v_lshlrev_b32 v136, 16, v41
    v_and_b32 v137, 0xffff0000, v41
    v_lshlrev_b32 v138, 16, v42
    v_and_b32 v139, 0xffff0000, v42
    v_lshlrev_b32 v140, 16, v43
    v_and_b32 v141, 0xffff0000, v43
    v_lshlrev_b32 v12, 16, v44
    v_and_b32 v13, 0xffff0000, v44
    v_lshlrev_b32 v14, 16, v45
    v_and_b32 v15, 0xffff0000, v45
    v_add_u32 v46, s90, v5
    v_mul_u32_u24 v46, 1280, v46
    s_mul_i32 s4, s41, 160
    v_add_u32 v46, s4, v46
    v_lshl_add_u32 v47, v3, 4, v46
    v_lshl_add_u32 v46, v3, 3, v46
    s_waitcnt vmcnt(8)
    v_max3_u32 v28, v209, v213, v217
    s_waitcnt vmcnt(6)
    v_max3_u32 v28, v221, v225, v28
    s_waitcnt vmcnt(4)
    v_max3_u32 v28, v229, v233, v28
    v_cmp_eq_u32 vcc, -1, v28
    s_nop 0
    s_cbranch_vccnz Lp2_r
Lp2_ok:
    s_waitcnt lgkmcnt(9)
    v_mfma_f32_16x16x32_bf16 v[62:65], v[90:93], v[206:209], v[62:65]
    ds_read_b128 v[86:89], v4 offset:30720
    s_waitcnt lgkmcnt(9)
    v_mfma_f32_16x16x32_bf16 v[66:69], v[94:97], v[206:209], v[66:69]
    ds_read_b128 v[90:93], v4 offset:31744
    s_waitcnt lgkmcnt(9)
    v_mfma_f32_16x16x32_bf16 v[70:73], v[98:101], v[206:209], v[70:73]
    ds_read_b128 v[94:97], v4 offset:32768
    s_waitcnt lgkmcnt(9)
    v_mfma_f32_16x16x32_bf16 v[74:77], v[102:105], v[206:209], v[74:77]
    ds_read_b128 v[98:101], v4 offset:33792
    s_waitcnt lgkmcnt(9)
    v_mfma_f32_16x16x32_bf16 v[78:81], v[82:85], v[206:209], v[78:81]
    ds_read_b128 v[102:105], v4 offset:34816
    s_waitcnt lgkmcnt(4)
    v_mfma_f32_16x16x32_bf16 v[62:65], v[86:89], v[210:213], v[62:65]
    ds_read_b128 v[82:85], v4 offset:46080
    s_waitcnt lgkmcnt(4)
    v_mfma_f32_16x16x32_bf16 v[66:69], v[90:93], v[210:213], v[66:69]
    ds_read_b128 v[86:89], v4 offset:47104
    s_waitcnt lgkmcnt(4)
    v_mfma_f32_16x16x32_bf16 v[70:73], v[94:97], v[210:213], v[70:73]
    ds_read_b128 v[90:93], v4 offset:48128
    s_waitcnt lgkmcnt(4)
    v_mfma_f32_16x16x32_bf16 v[74:77], v[98:101], v[210:213], v[74:77]
    ds_read_b128 v[94:97], v4 offset:49152
    s_waitcnt lgkmcnt(4)
    v_mfma_f32_16x16x32_bf16 v[78:81], v[102:105], v[210:213], v[78:81]
    ds_read_b128 v[98:101], v4 offset:50176
    s_waitcnt lgkmcnt(4)
    v_mfma_f32_16x16x32_bf16 v[62:65], v[82:85], v[214:217], v[62:65]
    ds_read_b128 v[102:105], v30 offset:5120
    s_waitcnt lgkmcnt(4)
    v_mfma_f32_16x16x32_bf16 v[66:69], v[86:89], v[214:217], v[66:69]
    ds_read_b128 v[82:85], v30 offset:6144
    s_waitcnt lgkmcnt(4)
    v_mfma_f32_16x16x32_bf16 v[70:73], v[90:93], v[214:217], v[70:73]
    ds_read_b128 v[86:89], v30 offset:7168
    s_waitcnt lgkmcnt(4)
    v_mfma_f32_16x16x32_bf16 v[74:77], v[94:97], v[214:217], v[74:77]
    ds_read_b128 v[90:93], v30 offset:8192
    s_waitcnt lgkmcnt(4)
    v_mfma_f32_16x16x32_bf16 v[78:81], v[98:101], v[214:217], v[78:81]
    ds_read_b128 v[94:97], v30 offset:9216
    s_waitcnt lgkmcnt(4)
    v_mfma_f32_16x16x32_bf16 v[62:65], v[102:105], v[218:221], v[62:65]
    ds_read_b128 v[98:101], v30 offset:20480
    s_waitcnt lgkmcnt(4)
    v_mfma_f32_16x16x32_bf16 v[66:69], v[82:85], v[218:221], v[66:69]
    ds_read_b128 v[102:105], v30 offset:21504
    s_waitcnt lgkmcnt(4)
    v_mfma_f32_16x16x32_bf16 v[70:73], v[86:89], v[218:221], v[70:73]
    ds_read_b128 v[82:85], v30 offset:22528
    s_waitcnt lgkmcnt(4)
    v_mfma_f32_16x16x32_bf16 v[74:77], v[90:93], v[218:221], v[74:77]
    ds_read_b128 v[86:89], v30 offset:23552
    s_waitcnt lgkmcnt(4)
    v_mfma_f32_16x16x32_bf16 v[78:81], v[94:97], v[218:221], v[78:81]
    ds_read_b128 v[90:93], v30 offset:24576
    s_waitcnt lgkmcnt(4)
    v_mfma_f32_16x16x32_bf16 v[62:65], v[98:101], v[222:225], v[62:65]
    ds_read_b128 v[94:97], v30 offset:40960
    s_waitcnt lgkmcnt(4)
    v_mfma_f32_16x16x32_bf16 v[66:69], v[102:105], v[222:225], v[66:69]
    ds_read_b128 v[98:101], v30 offset:41984
    s_waitcnt lgkmcnt(4)
    v_mfma_f32_16x16x32_bf16 v[70:73], v[82:85], v[222:225], v[70:73]
    ds_read_b128 v[102:105], v30 offset:43008
    s_waitcnt lgkmcnt(4)
    v_mfma_f32_16x16x32_bf16 v[74:77], v[86:89], v[222:225], v[74:77]
    ds_read_b128 v[82:85], v30 offset:44032
    s_waitcnt lgkmcnt(4)
    v_mfma_f32_16x16x32_bf16 v[78:81], v[90:93], v[222:225], v[78:81]
    ds_read_b128 v[86:89], v30 offset:45056
    s_waitcnt lgkmcnt(4)
    v_mfma_f32_16x16x32_bf16 v[62:65], v[94:97], v[226:229], v[62:65]
    ds_read_b128 v[90:93], v30 offset:56320
    s_waitcnt lgkmcnt(4)
    v_mfma_f32_16x16x32_bf16 v[66:69], v[98:101], v[226:229], v[66:69]
    ds_read_b128 v[94:97], v30 offset:57344
    s_waitcnt lgkmcnt(4)
    v_mfma_f32_16x16x32_bf16 v[70:73], v[102:105], v[226:229], v[70:73]
    ds_read_b128 v[98:101], v30 offset:58368
    s_waitcnt lgkmcnt(4)
    v_mfma_f32_16x16x32_bf16 v[74:77], v[82:85], v[226:229], v[74:77]
    ds_read_b128 v[102:105], v30 offset:59392
    s_waitcnt lgkmcnt(4)
    v_mfma_f32_16x16x32_bf16 v[78:81], v[86:89], v[226:229], v[78:81]
    ds_read_b128 v[82:85], v30 offset:60416
    s_waitcnt lgkmcnt(4)
    v_mfma_f32_16x16x32_bf16 v[62:65], v[90:93], v[230:233], v[62:65]
    ds_read_b128 v[86:89], v4 offset:15360
    s_waitcnt lgkmcnt(4)
    v_mfma_f32_16x16x32_bf16 v[66:69], v[94:97], v[230:233], v[66:69]
    ds_read_b128 v[90:93], v4 offset:16384
    s_waitcnt lgkmcnt(4)
    v_mfma_f32_16x16x32_bf16 v[70:73], v[98:101], v[230:233], v[70:73]
    ds_read_b128 v[94:97], v4 offset:17408
    s_waitcnt lgkmcnt(4)
    v_mfma_f32_16x16x32_bf16 v[74:77], v[102:105], v[230:233], v[74:77]
    ds_read_b128 v[98:101], v4 offset:18432
    s_waitcnt lgkmcnt(4)
    v_mfma_f32_16x16x32_bf16 v[78:81], v[82:85], v[230:233], v[78:81]
    ds_read_b128 v[102:105], v4 offset:19456
    s_waitcnt vmcnt(3)
    v_max_u32 v28, v239, v241
    s_waitcnt vmcnt(2)
    v_max3_u32 v28, v243, v245, v28
    s_waitcnt vmcnt(1)
    v_max3_u32 v28, v247, v249, v28
    s_waitcnt vmcnt(0)
    v_max3_u32 v28, v251, v253, v28
    v_cmp_eq_u32 vcc, -1, v28
    s_nop 0
    s_cbranch_vccnz Lp3_r
Lp3_ok:
    s_waitcnt lgkmcnt(4)
    v_mfma_f32_16x16x32_bf16 v[62:65], v[86:89], v[238:241], v[62:65]
    ds_read_b128 v[82:85], v4 offset:51200
    s_waitcnt lgkmcnt(4)
    v_mfma_f32_16x16x32_bf16 v[66:69], v[90:93], v[238:241], v[66:69]
    ds_read_b128 v[86:89], v4 offset:52224
    s_waitcnt lgkmcnt(4)
    v_mfma_f32_16x16x32_bf16 v[70:73], v[94:97], v[238:241], v[70:73]
    ds_read_b128 v[90:93], v4 offset:53248
    s_waitcnt lgkmcnt(4)
    v_mfma_f32_16x16x32_bf16 v[74:77], v[98:101], v[238:241], v[74:77]
    ds_read_b128 v[94:97], v4 offset:54272
    s_waitcnt lgkmcnt(4)
    v_mfma_f32_16x16x32_bf16 v[78:81], v[102:105], v[238:241], v[78:81]
    ds_read_b128 v[98:101], v4 offset:55296
    s_waitcnt lgkmcnt(4)
    v_mfma_f32_16x16x32_bf16 v[62:65], v[82:85], v[242:245], v[62:65]
    ds_read_b128 v[102:105], v30 offset:25600
    s_waitcnt lgkmcnt(4)
    v_mfma_f32_16x16x32_bf16 v[66:69], v[86:89], v[242:245], v[66:69]
    ds_read_b128 v[82:85], v30 offset:26624
    s_waitcnt lgkmcnt(4)
    v_mfma_f32_16x16x32_bf16 v[70:73], v[90:93], v[242:245], v[70:73]
    ds_read_b128 v[86:89], v30 offset:27648
    s_waitcnt lgkmcnt(4)
    v_mfma_f32_16x16x32_bf16 v[74:77], v[94:97], v[242:245], v[74:77]
    ds_read_b128 v[90:93], v30 offset:28672
    s_waitcnt lgkmcnt(4)
    v_mfma_f32_16x16x32_bf16 v[78:81], v[98:101], v[242:245], v[78:81]
    ds_read_b128 v[94:97], v30 offset:29696
    s_waitcnt lgkmcnt(4)
    v_mfma_f32_16x16x32_bf16 v[62:65], v[102:105], v[246:249], v[62:65]
    ds_read_b128 v[98:101], v31 offset:0
    s_waitcnt lgkmcnt(4)
    v_mfma_f32_16x16x32_bf16 v[66:69], v[82:85], v[246:249], v[66:69]
    ds_read_b128 v[102:105], v31 offset:1024
    s_waitcnt lgkmcnt(4)
    v_mfma_f32_16x16x32_bf16 v[70:73], v[86:89], v[246:249], v[70:73]
    ds_read_b128 v[82:85], v31 offset:2048
    s_waitcnt lgkmcnt(4)
    v_mfma_f32_16x16x32_bf16 v[74:77], v[90:93], v[246:249], v[74:77]
    ds_read_b128 v[86:89], v31 offset:3072
    s_waitcnt lgkmcnt(4)
    v_mfma_f32_16x16x32_bf16 v[78:81], v[94:97], v[246:249], v[78:81]
    ds_read_b128 v[90:93], v31 offset:4096
    s_waitcnt lgkmcnt(4)
    v_mfma_f32_16x16x32_bf16 v[62:65], v[98:101], v[250:253], v[62:65]
    s_waitcnt lgkmcnt(3)
    v_mfma_f32_16x16x32_bf16 v[66:69], v[102:105], v[250:253], v[66:69]
    s_waitcnt lgkmcnt(2)
    v_mfma_f32_16x16x32_bf16 v[70:73], v[82:85], v[250:253], v[70:73]
    s_waitcnt lgkmcnt(1)
    v_mfma_f32_16x16x32_bf16 v[74:77], v[86:89], v[250:253], v[74:77]
    s_waitcnt lgkmcnt(0)
    v_mfma_f32_16x16x32_bf16 v[78:81], v[90:93], v[250:253], v[78:81]
    v_fmac_f32 v126, v62, v106
    s_nop 0
    v_fmac_f32 v127, v66, v107
    v_fmac_f32 v128, v63, v108
    v_fmac_f32 v129, v67, v109
    v_fmac_f32 v130, v64, v110
    v_fmac_f32 v131, v68, v111
    v_fmac_f32 v132, v65, v112
    v_fmac_f32 v133, v69, v113
    v_cvt_pk_bf16_f32 v142, v126, v127
    v_cvt_pk_bf16_f32 v143, v128, v129
    v_cvt_pk_bf16_f32 v144, v130, v131
    v_cvt_pk_bf16_f32 v145, v132, v133
    global_store_dwordx4 v47, v[142:145], s[34:35] offset:0
    v_fmac_f32 v134, v70, v114
    v_fmac_f32 v135, v74, v115
    v_fmac_f32 v136, v71, v116
    v_fmac_f32 v137, v75, v117
    v_fmac_f32 v138, v72, v118
    v_fmac_f32 v139, v76, v119
    v_fmac_f32 v140, v73, v120
    v_fmac_f32 v141, v77, v121
    v_cvt_pk_bf16_f32 v146, v134, v135
    v_cvt_pk_bf16_f32 v147, v136, v137
    v_cvt_pk_bf16_f32 v148, v138, v139
    v_cvt_pk_bf16_f32 v149, v140, v141
    global_store_dwordx4 v47, v[146:149], s[34:35] offset:64
    v_fmac_f32 v12, v78, v122
    v_fmac_f32 v13, v79, v123
    v_fmac_f32 v14, v80, v124
    v_fmac_f32 v15, v81, v125
    v_cvt_pk_bf16_f32 v150, v12, v13
    v_cvt_pk_bf16_f32 v151, v14, v15
    global_store_dwordx2 v46, v[150:151], s[34:35] offset:128
Lflush:
Lend:
    s_endpgm
Lic_r:
    v_min_u32 v212, 7, v1
    v_lshlrev_b32 v212, 2, v212
Lic_p:
    global_load_dword v213, v212, s[36:37] sc1
    s_waitcnt vmcnt(0)
    v_cmp_eq_u32 vcc, 0, v213
    s_add_u32 s100, s100, 1
    s_cmp_ge_u32 s100, 262144
    s_cbranch_scc1 Lic_p_x
    s_cbranch_vccnz Lic_p
Lic_p_x:
    s_branch Lic_ok
Lc_m3:
    s_cmp_ge_u32 s42, 130
    s_cbranch_scc1 Lc_j3
    s_sub_u32 s46, s42, 128
    v_mov_b32 v148, 0
    v_mov_b32 v149, 0
    v_mov_b32 v150, 0
    v_mov_b32 v151, 0
    s_mul_i32 s4, s46, 1146880
    s_add_u32 s4, s4, 8445952
    v_lshl_add_u32 v152, v0, 4, s4
    global_store_dwordx4 v152, v[148:151], s[38:39] sc1
    v_add_u32 v152, 4096, v152
    global_store_dwordx4 v152, v[148:151], s[38:39] sc1
    v_add_u32 v152, 4096, v152
    global_store_dwordx4 v152, v[148:151], s[38:39] sc1
    v_add_u32 v152, 4096, v152
    global_store_dwordx4 v152, v[148:151], s[38:39] sc1
    v_add_u32 v152, 4096, v152
    global_store_dwordx4 v152, v[148:151], s[38:39] sc1
    v_add_u32 v152, 4096, v152
    global_store_dwordx4 v152, v[148:151], s[38:39] sc1
    v_add_u32 v152, 4096, v152
    global_store_dwordx4 v152, v[148:151], s[38:39] sc1
    v_add_u32 v152, 4096, v152
    global_store_dwordx4 v152, v[148:151], s[38:39] sc1
    v_add_u32 v152, 4096, v152
    global_store_dwordx4 v152, v[148:151], s[38:39] sc1
    v_add_u32 v152, 4096, v152
    global_store_dwordx4 v152, v[148:151], s[38:39] sc1
    v_add_u32 v152, 4096, v152
    s_mul_i32 s4, s46, 7168
    s_and_b32 s5, s3, 1
    s_mul_i32 s5, s5, 14336
    s_add_u32 s4, s4, s5
    s_add_u32 s4, s4, 56064
    v_lshl_add_u32 v152, v1, 2, s4
    s_waitcnt vmcnt(0) lgkmcnt(0)
    s_barrier
    global_store_dword v152, v148, s[38:39] sc1
    s_branch Lc_j3
Lic2_r:
    v_min_u32 v41, 49, v1
    v_lshlrev_b32 v41, 2, v41
Lic2_p:
    global_load_dword v42, v41, s[36:37] sc1
    s_waitcnt vmcnt(0)
    v_cmp_eq_u32 vcc, 0, v42
    s_add_u32 s100, s100, 1
    s_cmp_ge_u32 s100, 262144
    s_cbranch_scc1 Lic2_p_x
    s_cbranch_vccnz Lic2_p
Lic2_p_x:
    s_branch Lic2_ok
Lkf_r:
    s_nop 7
Lkf_p:
    global_load_dword v40, v29, s[38:39] sc1
    s_waitcnt vmcnt(0)
    v_mov_b32 v40, v40
    v_cmp_eq_u32 vcc, -1, v40
    s_add_u32 s100, s100, 1
    s_cmp_ge_u32 s100, 262144
    s_cbranch_scc1 Lkf_p_x
    s_cbranch_vccnz Lkf_p
Lkf_p_x:
    s_nop 1
    s_branch Lkf_ok
Lax_r:
    s_nop 7
Lax_p:
    v_lshlrev_b32 v28, 4, v0
    v_add_u32 v28, 36864, v28
    global_load_dwordx4 v[200:203], v28, s[38:39] offset:-4096 sc1
    global_load_dwordx4 v[204:207], v28, s[38:39] offset:0 sc1
    v_add_u32 v28, 8192, v28
    global_load_dwordx4 v[208:211], v28, s[38:39] offset:-4096 sc1
    global_load_dwordx4 v[212:215], v28, s[38:39] offset:0 sc1
    v_min_u32 v28, 11, v1
    v_lshrrev_b32 v29, 2, v28
    v_mul_u32_u24 v29, 2544, v29
    v_lshl_add_u32 v28, v28, 2, v29
    s_lshl_b32 s4, s42, 4
    s_add_u32 s4, s4, 0
    v_add_u32 v28, s4, v28
    global_load_dword v180, v28, s[38:39] sc1
    v_add_u32 v28, 15360, v28
    global_load_dword v181, v28, s[38:39] sc1
    s_waitcnt vmcnt(0)
    v_max_u32 v236, v201, v203
    v_max3_u32 v236, v205, v207, v236
    v_max3_u32 v236, v209, v211, v236
    v_max3_u32 v236, v213, v215, v236
    v_max3_u32 v236, v180, v181, v236
    v_cmp_eq_u32 vcc, -1, v236
    s_add_u32 s100, s100, 1
    s_cmp_ge_u32 s100, 262144
    s_cbranch_scc1 Lax_p_x
    s_cbranch_vccnz Lax_p
Lax_p_x:
    s_nop 1
    s_branch Lax_ok
Lcu_r:
    s_nop 7
Lcu_p:
    s_lshl_b32 s4, s96, 7
    s_add_u32 s4, s4, 49152
    v_lshl_add_u32 v28, v2, 2, s4
    global_load_dword v8, v28, s[38:39] sc1
    global_load_dword v9, v28, s[38:39] offset:64 sc1
    s_add_u32 s4, s4, 7168
    v_lshl_add_u32 v28, v3, 4, s4
    global_load_dwordx4 v[12:15], v28, s[38:39] sc1
    global_load_dwordx4 v[16:19], v28, s[38:39] offset:64 sc1
    s_lshl_b32 s4, s97, 7
    s_add_u32 s4, s4, 49152
    v_lshl_add_u32 v28, v2, 2, s4
    global_load_dword v10, v28, s[38:39] sc1
    global_load_dword v11, v28, s[38:39] offset:64 sc1
    s_add_u32 s4, s4, 7168
    v_lshl_add_u32 v28, v3, 4, s4
    global_load_dwordx4 v[20:23], v28, s[38:39] sc1
    global_load_dwordx4 v[24:27], v28, s[38:39] offset:64 sc1
    s_lshl_b32 s4, s96, 7
    s_add_u32 s4, s4, 63488
    v_lshl_add_u32 v28, v2, 2, s4
    global_load_dword v216, v28, s[38:39] sc1
    global_load_dword v217, v28, s[38:39] offset:64 sc1
    s_add_u32 s4, s4, 7168
    v_lshl_add_u32 v28, v3, 4, s4
    global_load_dwordx4 v[220:223], v28, s[38:39] sc1
    global_load_dwordx4 v[224:227], v28, s[38:39] offset:64 sc1
    s_lshl_b32 s4, s97, 7
    s_add_u32 s4, s4, 63488
    v_lshl_add_u32 v28, v2, 2, s4
    global_load_dword v218, v28, s[38:39] sc1
    global_load_dword v219, v28, s[38:39] offset:64 sc1
    s_add_u32 s4, s4, 7168
    v_lshl_add_u32 v28, v3, 4, s4
    global_load_dwordx4 v[228:231], v28, s[38:39] sc1
    global_load_dwordx4 v[232:235], v28, s[38:39] offset:64 sc1
    s_waitcnt vmcnt(0)
    v_max_u32 v236, v8, v9
    v_max3_u32 v236, v10, v11, v236
    v_max3_u32 v236, v12, v13, v236
    v_max3_u32 v236, v14, v15, v236
    v_max3_u32 v236, v16, v17, v236
    v_max3_u32 v236, v18, v19, v236
    v_max3_u32 v236, v20, v21, v236
    v_max3_u32 v236, v22, v23, v236
    v_max3_u32 v236, v24, v25, v236
    v_max3_u32 v236, v26, v27, v236
    v_max3_u32 v236, v216, v217, v236
    v_max3_u32 v236, v218, v219, v236
    v_max3_u32 v236, v220, v221, v236
    v_max3_u32 v236, v222, v223, v236
    v_max3_u32 v236, v224, v225, v236
    v_max3_u32 v236, v226, v227, v236
    v_max3_u32 v236, v228, v229, v236
    v_max3_u32 v236, v230, v231, v236
    v_max3_u32 v236, v232, v233, v236
    v_max3_u32 v236, v234, v235, v236
    v_cmp_eq_u32 vcc, -1, v236
    s_add_u32 s100, s100, 1
    s_cmp_ge_u32 s100, 262144
    s_cbranch_scc1 Lcu_p_x
    s_cbranch_vccnz Lcu_p
Lcu_p_x:
    s_nop 1
    s_branch Lcu_ok
Lxf_r:
    s_nop 7
Lxf_p:
    v_min_u32 v29, 624, v4
    v_add_u32 v29, 98560, v29
    global_load_dwordx4 v[200:203], v29, s[38:39] sc1
    s_waitcnt vmcnt(0)
    v_max_u32 v236, v200, v201
    v_max3_u32 v236, v202, v203, v236
    v_cmp_eq_u32 vcc, -1, v236
    s_add_u32 s100, s100, 1
    s_cmp_ge_u32 s100, 262144
    s_cbranch_scc1 Lxf_p_x
    s_cbranch_vccnz Lxf_p
Lxf_p_x:
    s_nop 1
    s_branch Lxf_ok
Lgb_r:
    s_nop 7
Lgb_p:
    v_min_u32 v175, 26, v1
    v_lshlrev_b32 v175, 2, v175
    v_add_u32 v175, 98304, v175
    global_load_dword v250, v175, s[38:39] sc1
    s_mul_i32 s7, s41, 320
    s_add_u32 s7, s7, 12800
    v_min_u32 v175, 304, v4
    v_add_u32 v175, s7, v175
    global_load_dwordx4 v[242:245], v175, s[38:39] sc1
    v_add_u32 v175, 15360, v175
    global_load_dwordx4 v[246:249], v175, s[38:39] sc1
    v_add_u32 v175, 99328, v4
    global_load_dwordx4 v[94:97], v175, s[38:39] sc1
    s_waitcnt vmcnt(0)
    v_max3_u32 v28, v242, v243, v244
    v_max3_u32 v28, v245, v246, v28
    v_max3_u32 v28, v247, v248, v28
    v_max3_u32 v28, v249, v250, v28
    v_max3_u32 v28, v94, v95, v28
    v_max3_u32 v28, v96, v97, v28
    v_cmp_eq_u32 vcc, -1, v28
    s_add_u32 s100, s100, 1
    s_cmp_ge_u32 s100, 262144
    s_cbranch_scc1 Lgb_p_x
    s_cbranch_vccnz Lgb_p
Lgb_p_x:
    s_nop 1
    s_branch Lgb_ok
Ls3_r:
    s_nop 7
Ls3_p:
    global_load_dwordx2 v[130:131], v174, s[38:39] offset:0 sc1
    global_load_dwordx2 v[132:133], v174, s[38:39] offset:512 sc1
    global_load_dwordx2 v[134:135], v174, s[38:39] offset:1024 sc1
    global_load_dwordx2 v[136:137], v174, s[38:39] offset:1536 sc1
    global_load_dwordx2 v[138:139], v174, s[38:39] offset:2048 sc1
    global_load_dwordx2 v[140:141], v174, s[38:39] offset:2560 sc1
    global_load_dwordx2 v[142:143], v174, s[38:39] offset:3072 sc1
    global_load_dwordx2 v[144:145], v174, s[38:39] offset:3584 sc1
    s_waitcnt vmcnt(0)
    v_max_u32 v28, v131, v133
    v_max3_u32 v28, v135, v137, v28
    v_max3_u32 v28, v139, v141, v28
    v_max3_u32 v28, v143, v145, v28
    v_cmp_eq_u32 vcc, -1, v28
    s_add_u32 s100, s100, 1
    s_cmp_ge_u32 s100, 262144
    s_cbranch_scc1 Ls3_p_x
    s_cbranch_vccnz Ls3_p
Ls3_p_x:
    s_nop 1
    s_branch Ls3_ok
Lz0_r:
    s_nop 7
Lz0_p:
    global_load_dword v46, v29, s[56:57] offset:1020 sc1
    global_load_dwordx4 v[62:65], v30, s[56:57] offset:-3072 sc1
    global_load_dwordx4 v[66:69], v30, s[56:57] offset:-2048 sc1
    global_load_dwordx4 v[70:73], v30, s[56:57] offset:-1024 sc1
    global_load_dwordx4 v[74:77], v30, s[56:57] offset:0 sc1
    global_load_dwordx4 v[78:81], v30, s[56:57] offset:1024 sc1
    global_load_dwordx4 v[82:85], v30, s[56:57] offset:2048 sc1
    global_load_dwordx4 v[86:89], v30, s[56:57] offset:3072 sc1
    global_load_dwordx4 v[90:93], v31, s[56:57] offset:-3072 sc1
    global_load_dwordx4 v[94:97], v31, s[56:57] offset:-2048 sc1
    global_load_dwordx4 v[98:101], v31, s[56:57] offset:-1024 sc1
    global_load_dwordx4 v[102:105], v31, s[56:57] offset:0 sc1
    global_load_dwordx4 v[106:109], v31, s[56:57] offset:1024 sc1
    global_load_dwordx4 v[110:113], v31, s[56:57] offset:2048 sc1
    global_load_dwordx4 v[114:117], v31, s[56:57] offset:3072 sc1
    global_load_dwordx4 v[118:121], v30, s[58:59] offset:-3072 sc1
    global_load_dwordx4 v[122:125], v30, s[58:59] offset:-2048 sc1
    s_waitcnt vmcnt(0)
    v_max3_u32 v28, v46, v65, v69
    v_max3_u32 v28, v73, v77, v28
    v_cmp_eq_u32 vcc, -1, v28
    s_add_u32 s100, s100, 1
    s_cmp_ge_u32 s100, 262144
    s_cbranch_scc1 Lz0_p_x
    s_cbranch_vccnz Lz0_p
Lz0_p_x:
    s_nop 1
    s_branch Lz0_ok
Lz1_r:
    s_nop 7
Lz1_p:
    global_load_dwordx4 v[78:81], v30, s[56:57] offset:1024 sc1
    global_load_dwordx4 v[82:85], v30, s[56:57] offset:2048 sc1
    global_load_dwordx4 v[86:89], v30, s[56:57] offset:3072 sc1
    global_load_dwordx4 v[90:93], v31, s[56:57] offset:-3072 sc1
    s_waitcnt vmcnt(0)
    v_max_u32 v28, v81, v85
    v_max3_u32 v28, v89, v93, v28
    v_cmp_eq_u32 vcc, -1, v28
    s_add_u32 s100, s100, 1
    s_cmp_ge_u32 s100, 262144
    s_cbranch_scc1 Lz1_p_x
    s_cbranch_vccnz Lz1_p
Lz1_p_x:
    s_nop 1
    s_branch Lz1_ok
Lz2_r:
    s_nop 7
Lz2_p:
    global_load_dwordx4 v[94:97], v31, s[56:57] offset:-2048 sc1
    global_load_dwordx4 v[98:101], v31, s[56:57] offset:-1024 sc1
    global_load_dwordx4 v[102:105], v31, s[56:57] offset:0 sc1
    global_load_dwordx4 v[106:109], v31, s[56:57] offset:1024 sc1
    s_waitcnt vmcnt(0)
    v_max_u32 v28, v97, v101
    v_max3_u32 v28, v105, v109, v28
    v_cmp_eq_u32 vcc, -1, v28
    s_add_u32 s100, s100, 1
    s_cmp_ge_u32 s100, 262144
    s_cbranch_scc1 Lz2_p_x
    s_cbranch_vccnz Lz2_p
Lz2_p_x:
    s_nop 1
    s_branch Lz2_ok
Lz3_r:
    s_nop 7
Lz3_p:
    global_load_dwordx4 v[110:113], v31, s[56:57] offset:2048 sc1
    global_load_dwordx4 v[114:117], v31, s[56:57] offset:3072 sc1
    global_load_dwordx4 v[118:121], v30, s[58:59] offset:-3072 sc1
    global_load_dwordx4 v[122:125], v30, s[58:59] offset:-2048 sc1
    s_waitcnt vmcnt(0)
    v_max_u32 v28, v113, v117
    v_max3_u32 v28, v121, v125, v28
    v_cmp_eq_u32 vcc, -1, v28
    s_add_u32 s100, s100, 1
    s_cmp_ge_u32 s100, 262144
    s_cbranch_scc1 Lz3_p_x
    s_cbranch_vccnz Lz3_p
Lz3_p_x:
    s_nop 1
    s_branch Lz3_ok
Lz4_r:
    s_nop 7
Lz4_p:
    global_load_dwordx4 v[126:129], v30, s[58:59] offset:-1024 sc1
    global_load_dwordx4 v[130:133], v30, s[58:59] offset:0 sc1
    global_load_dwordx4 v[134:137], v30, s[58:59] offset:1024 sc1
    global_load_dwordx4 v[138:141], v30, s[58:59] offset:2048 sc1
    s_waitcnt vmcnt(0)
    v_max_u32 v28, v129, v133
    v_max3_u32 v28, v137, v141, v28
    v_cmp_eq_u32 vcc, -1, v28
    s_add_u32 s100, s100, 1
    s_cmp_ge_u32 s100, 262144
    s_cbranch_scc1 Lz4_p_x
    s_cbranch_vccnz Lz4_p
Lz4_p_x:
    s_nop 1
    s_branch Lz4_ok
Lz5_r:
    s_nop 7
Lz5_p:
    global_load_dwordx4 v[62:65], v30, s[58:59] offset:3072 sc1
    global_load_dwordx4 v[66:69], v31, s[58:59] offset:-3072 sc1
    global_load_dwordx4 v[70:73], v31, s[58:59] offset:-2048 sc1
    global_load_dwordx4 v[74:77], v31, s[58:59] offset:-1024 sc1
    s_waitcnt vmcnt(0)
    v_max_u32 v28, v65, v69
    v_max3_u32 v28, v73, v77, v28
    v_cmp_eq_u32 vcc, -1, v28
    s_add_u32 s100, s100, 1
    s_cmp_ge_u32 s100, 262144
    s_cbranch_scc1 Lz5_p_x
    s_cbranch_vccnz Lz5_p
Lz5_p_x:
    s_nop 1
    s_branch Lz5_ok
Lz6_r:
    s_nop 7
Lz6_p:
    global_load_dwordx4 v[78:81], v31, s[58:59] offset:0 sc1
    global_load_dwordx4 v[82:85], v31, s[58:59] offset:1024 sc1
    global_load_dwordx4 v[86:89], v31, s[58:59] offset:2048 sc1
    global_load_dwordx4 v[90:93], v31, s[58:59] offset:3072 sc1
    s_waitcnt vmcnt(0)
    v_max_u32 v28, v81, v85
    v_max3_u32 v28, v89, v93, v28
    v_cmp_eq_u32 vcc, -1, v28
    s_add_u32 s100, s100, 1
    s_cmp_ge_u32 s100, 262144
    s_cbranch_scc1 Lz6_p_x
    s_cbranch_vccnz Lz6_p
Lz6_p_x:
    s_nop 1
    s_branch Lz6_ok
Lz7_r:
    s_nop 7
Lz7_p:
    global_load_dwordx4 v[94:97], v30, s[60:61] offset:-3072 sc1
    global_load_dwordx4 v[98:101], v31, s[60:61] offset:-3072 sc1
    global_load_dwordx4 v[102:105], v30, s[62:63] offset:-3072 sc1
    global_load_dwordx4 v[106:109], v31, s[62:63] offset:-3072 sc1
    s_waitcnt vmcnt(0)
    v_max_u32 v28, v97, v101
    v_max3_u32 v28, v105, v109, v28
    v_cmp_eq_u32 vcc, -1, v28
    s_add_u32 s100, s100, 1
    s_cmp_ge_u32 s100, 262144
    s_cbranch_scc1 Lz7_p_x
    s_cbranch_vccnz Lz7_p
Lz7_p_x:
    s_nop 1
    s_branch Lz7_ok
Lz8_r:
    s_nop 7
Lz8_p:
    global_load_dwordx4 v[110:113], v30, s[52:53] offset:-3072 sc1
    global_load_dwordx4 v[114:117], v31, s[52:53] offset:-3072 sc1
    global_load_dwordx4 v[118:121], v30, s[54:55] offset:-3072 sc1
    global_load_dwordx4 v[122:125], v31, s[54:55] offset:-3072 sc1
    s_waitcnt vmcnt(0)
    v_max_u32 v28, v113, v117
    v_max3_u32 v28, v121, v125, v28
    v_cmp_eq_u32 vcc, -1, v28
    s_add_u32 s100, s100, 1
    s_cmp_ge_u32 s100, 262144
    s_cbranch_scc1 Lz8_p_x
    s_cbranch_vccnz Lz8_p
Lz8_p_x:
    s_nop 1
    s_branch Lz8_ok
Lz9_r:
    s_nop 7
Lz9_p:
    global_load_dwordx4 v[126:129], v30, s[64:65] offset:-3072 sc1
    global_load_dwordx4 v[130:133], v31, s[64:65] offset:-3072 sc1
    global_load_dwordx4 v[134:137], v30, s[66:67] offset:-3072 sc1
    global_load_dwordx4 v[138:141], v31, s[66:67] offset:-3072 sc1
    s_waitcnt vmcnt(0)
    v_max_u32 v28, v129, v133
    v_max3_u32 v28, v137, v141, v28
    v_cmp_eq_u32 vcc, -1, v28
    s_add_u32 s100, s100, 1
    s_cmp_ge_u32 s100, 262144
    s_cbranch_scc1 Lz9_p_x
    s_cbranch_vccnz Lz9_p
Lz9_p_x:
    s_nop 1
    s_branch Lz9_ok
Lz10_r:
    s_nop 7
Lz10_p:
    global_load_dwordx4 v[62:65], v30, s[60:61] offset:-2048 sc1
    global_load_dwordx4 v[66:69], v31, s[60:61] offset:-2048 sc1
    global_load_dwordx4 v[70:73], v30, s[62:63] offset:-2048 sc1
    global_load_dwordx4 v[74:77], v31, s[62:63] offset:-2048 sc1
    s_waitcnt vmcnt(0)
    v_max_u32 v28, v65, v69
    v_max3_u32 v28, v73, v77, v28
    v_cmp_eq_u32 vcc, -1, v28
    s_add_u32 s100, s100, 1
    s_cmp_ge_u32 s100, 262144
    s_cbranch_scc1 Lz10_p_x
    s_cbranch_vccnz Lz10_p
Lz10_p_x:
    s_nop 1
    s_branch Lz10_ok
Lz11_r:
    s_nop 7
Lz11_p:
    global_load_dwordx4 v[78:81], v30, s[52:53] offset:-2048 sc1
    global_load_dwordx4 v[82:85], v31, s[52:53] offset:-2048 sc1
    global_load_dwordx4 v[86:89], v30, s[54:55] offset:-2048 sc1
    global_load_dwordx4 v[90:93], v31, s[54:55] offset:-2048 sc1
    s_waitcnt vmcnt(0)
    v_max_u32 v28, v81, v85
    v_max3_u32 v28, v89, v93, v28
    v_cmp_eq_u32 vcc, -1, v28
    s_add_u32 s100, s100, 1
    s_cmp_ge_u32 s100, 262144
    s_cbranch_scc1 Lz11_p_x
    s_cbranch_vccnz Lz11_p
Lz11_p_x:
    s_nop 1
    s_branch Lz11_ok
Lz12_r:
    s_nop 7
Lz12_p:
    global_load_dwordx4 v[94:97], v30, s[64:65] offset:-2048 sc1
    global_load_dwordx4 v[98:101], v31, s[64:65] offset:-2048 sc1
    global_load_dwordx4 v[102:105], v30, s[66:67] offset:-2048 sc1
    global_load_dwordx4 v[106:109], v31, s[66:67] offset:-2048 sc1
    s_waitcnt vmcnt(0)
    v_max_u32 v28, v97, v101
    v_max3_u32 v28, v105, v109, v28
    v_cmp_eq_u32 vcc, -1, v28
    s_add_u32 s100, s100, 1
    s_cmp_ge_u32 s100, 262144
    s_cbranch_scc1 Lz12_p_x
    s_cbranch_vccnz Lz12_p
Lz12_p_x:
    s_nop 1
    s_branch Lz12_ok
Lz13_r:
    s_nop 7
Lz13_p:
    global_load_dwordx4 v[110:113], v30, s[60:61] offset:-1024 sc1
    global_load_dwordx4 v[114:117], v31, s[60:61] offset:-1024 sc1
    global_load_dwordx4 v[118:121], v30, s[62:63] offset:-1024 sc1
    global_load_dwordx4 v[122:125], v31, s[62:63] offset:-1024 sc1
    s_waitcnt vmcnt(0)
    v_max_u32 v28, v113, v117
    v_max3_u32 v28, v121, v125, v28
    v_cmp_eq_u32 vcc, -1, v28
    s_add_u32 s100, s100, 1
    s_cmp_ge_u32 s100, 262144
    s_cbranch_scc1 Lz13_p_x
    s_cbranch_vccnz Lz13_p
Lz13_p_x:
    s_nop 1
    s_branch Lz13_ok
Lz14_r:
    s_nop 7
Lz14_p:
    global_load_dwordx4 v[126:129], v30, s[52:53] offset:-1024 sc1
    global_load_dwordx4 v[130:133], v31, s[52:53] offset:-1024 sc1
    global_load_dwordx4 v[134:137], v30, s[54:55] offset:-1024 sc1
    global_load_dwordx4 v[138:141], v31, s[54:55] offset:-1024 sc1
    s_waitcnt vmcnt(0)
    v_max_u32 v28, v129, v133
    v_max3_u32 v28, v137, v141, v28
    v_cmp_eq_u32 vcc, -1, v28
    s_add_u32 s100, s100, 1
    s_cmp_ge_u32 s100, 262144
    s_cbranch_scc1 Lz14_p_x
    s_cbranch_vccnz Lz14_p
Lz14_p_x:
    s_nop 1
    s_branch Lz14_ok
Lz15_r:
    s_nop 7
Lz15_p:
    global_load_dwordx4 v[62:65], v30, s[64:65] offset:-1024 sc1
    global_load_dwordx4 v[66:69], v31, s[64:65] offset:-1024 sc1
    global_load_dwordx4 v[70:73], v30, s[66:67] offset:-1024 sc1
    global_load_dwordx4 v[74:77], v31, s[66:67] offset:-1024 sc1
    s_waitcnt vmcnt(0)
    v_max_u32 v28, v65, v69
    v_max3_u32 v28, v73, v77, v28
    v_cmp_eq_u32 vcc, -1, v28
    s_add_u32 s100, s100, 1
    s_cmp_ge_u32 s100, 262144
    s_cbranch_scc1 Lz15_p_x
    s_cbranch_vccnz Lz15_p
Lz15_p_x:
    s_nop 1
    s_branch Lz15_ok
Lz16_r:
    s_nop 7
Lz16_p:
    global_load_dwordx4 v[78:81], v30, s[60:61] offset:0 sc1
    global_load_dwordx4 v[82:85], v31, s[60:61] offset:0 sc1
    global_load_dwordx4 v[86:89], v30, s[62:63] offset:0 sc1
    global_load_dwordx4 v[90:93], v31, s[62:63] offset:0 sc1
    s_waitcnt vmcnt(0)
    v_max_u32 v28, v81, v85
    v_max3_u32 v28, v89, v93, v28
    v_cmp_eq_u32 vcc, -1, v28
    s_add_u32 s100, s100, 1
    s_cmp_ge_u32 s100, 262144
    s_cbranch_scc1 Lz16_p_x
    s_cbranch_vccnz Lz16_p
Lz16_p_x:
    s_nop 1
    s_branch Lz16_ok
Lz17_r:
    s_nop 7
Lz17_p:
    global_load_dwordx4 v[94:97], v30, s[52:53] offset:0 sc1
    global_load_dwordx4 v[98:101], v31, s[52:53] offset:0 sc1
    global_load_dwordx4 v[102:105], v30, s[54:55] offset:0 sc1
    global_load_dwordx4 v[106:109], v31, s[54:55] offset:0 sc1
    s_waitcnt vmcnt(0)
    v_max_u32 v28, v97, v101
    v_max3_u32 v28, v105, v109, v28
    v_cmp_eq_u32 vcc, -1, v28
    s_add_u32 s100, s100, 1
    s_cmp_ge_u32 s100, 262144
    s_cbranch_scc1 Lz17_p_x
    s_cbranch_vccnz Lz17_p
Lz17_p_x:
    s_nop 1
    s_branch Lz17_ok
Lz18_r:
    s_nop 7
Lz18_p:
    global_load_dwordx4 v[110:113], v30, s[64:65] offset:0 sc1
    global_load_dwordx4 v[114:117], v31, s[64:65] offset:0 sc1
    global_load_dwordx4 v[118:121], v30, s[66:67] offset:0 sc1
    global_load_dwordx4 v[122:125], v31, s[66:67] offset:0 sc1
    s_waitcnt vmcnt(0)
    v_max_u32 v28, v113, v117
    v_max3_u32 v28, v121, v125, v28
    v_cmp_eq_u32 vcc, -1, v28
    s_add_u32 s100, s100, 1
    s_cmp_ge_u32 s100, 262144
    s_cbranch_scc1 Lz18_p_x
    s_cbranch_vccnz Lz18_p
Lz18_p_x:
    s_nop 1
    s_branch Lz18_ok
Lz19_r:
    s_nop 7
Lz19_p:
    global_load_dwordx4 v[126:129], v30, s[60:61] offset:1024 sc1
    global_load_dwordx4 v[130:133], v31, s[60:61] offset:1024 sc1
    global_load_dwordx4 v[134:137], v30, s[62:63] offset:1024 sc1
    global_load_dwordx4 v[138:141], v31, s[62:63] offset:1024 sc1
    s_waitcnt vmcnt(0)
    v_max_u32 v28, v129, v133
    v_max3_u32 v28, v137, v141, v28
    v_cmp_eq_u32 vcc, -1, v28
    s_add_u32 s100, s100, 1
    s_cmp_ge_u32 s100, 262144
    s_cbranch_scc1 Lz19_p_x
    s_cbranch_vccnz Lz19_p
Lz19_p_x:
    s_nop 1
    s_branch Lz19_ok
Lz20_r:
    s_nop 7
Lz20_p:
    global_load_dwordx4 v[62:65], v30, s[52:53] offset:1024 sc1
    global_load_dwordx4 v[66:69], v31, s[52:53] offset:1024 sc1
    global_load_dwordx4 v[70:73], v30, s[54:55] offset:1024 sc1
    global_load_dwordx4 v[74:77], v31, s[54:55] offset:1024 sc1
    s_waitcnt vmcnt(0)
    v_max_u32 v28, v65, v69
    v_max3_u32 v28, v73, v77, v28
    v_cmp_eq_u32 vcc, -1, v28
    s_add_u32 s100, s100, 1
    s_cmp_ge_u32 s100, 262144
    s_cbranch_scc1 Lz20_p_x
    s_cbranch_vccnz Lz20_p
Lz20_p_x:
    s_nop 1
    s_branch Lz20_ok
Lz21_r:
    s_nop 7
Lz21_p:
    global_load_dwordx4 v[78:81], v30, s[64:65] offset:1024 sc1
    global_load_dwordx4 v[82:85], v31, s[64:65] offset:1024 sc1
    global_load_dwordx4 v[86:89], v30, s[66:67] offset:1024 sc1
    global_load_dwordx4 v[90:93], v31, s[66:67] offset:1024 sc1
    s_waitcnt vmcnt(0)
    v_max_u32 v28, v81, v85
    v_max3_u32 v28, v89, v93, v28
    v_cmp_eq_u32 vcc, -1, v28
    s_add_u32 s100, s100, 1
    s_cmp_ge_u32 s100, 262144
    s_cbranch_scc1 Lz21_p_x
    s_cbranch_vccnz Lz21_p
Lz21_p_x:
    s_nop 1
    s_branch Lz21_ok
Lz22_r:
    s_nop 7
Lz22_p:
    global_load_dwordx4 v[94:97], v30, s[60:61] offset:2048 sc1
    global_load_dwordx4 v[98:101], v31, s[60:61] offset:2048 sc1
    global_load_dwordx4 v[102:105], v30, s[62:63] offset:2048 sc1
    global_load_dwordx4 v[106:109], v31, s[62:63] offset:2048 sc1
    s_waitcnt vmcnt(0)
    v_max_u32 v28, v97, v101
    v_max3_u32 v28, v105, v109, v28
    v_cmp_eq_u32 vcc, -1, v28
    s_add_u32 s100, s100, 1
    s_cmp_ge_u32 s100, 262144
    s_cbranch_scc1 Lz22_p_x
    s_cbranch_vccnz Lz22_p
Lz22_p_x:
    s_nop 1
    s_branch Lz22_ok
Lz23_r:
    s_nop 7
Lz23_p:
    global_load_dwordx4 v[110:113], v30, s[52:53] offset:2048 sc1
    global_load_dwordx4 v[114:117], v31, s[52:53] offset:2048 sc1
    global_load_dwordx4 v[118:121], v30, s[54:55] offset:2048 sc1
    global_load_dwordx4 v[122:125], v31, s[54:55] offset:2048 sc1
    s_waitcnt vmcnt(0)
    v_max_u32 v28, v113, v117
    v_max3_u32 v28, v121, v125, v28
    v_cmp_eq_u32 vcc, -1, v28
    s_add_u32 s100, s100, 1
    s_cmp_ge_u32 s100, 262144
    s_cbranch_scc1 Lz23_p_x
    s_cbranch_vccnz Lz23_p
Lz23_p_x:
    s_nop 1
    s_branch Lz23_ok
Lz24_r:
    s_nop 7
Lz24_p:
    global_load_dwordx4 v[126:129], v30, s[64:65] offset:2048 sc1
    global_load_dwordx4 v[130:133], v31, s[64:65] offset:2048 sc1
    global_load_dwordx4 v[134:137], v30, s[66:67] offset:2048 sc1
    global_load_dwordx4 v[138:141], v31, s[66:67] offset:2048 sc1
    s_waitcnt vmcnt(0)
    v_max_u32 v28, v129, v133
    v_max3_u32 v28, v137, v141, v28
    v_cmp_eq_u32 vcc, -1, v28
    s_add_u32 s100, s100, 1
    s_cmp_ge_u32 s100, 262144
    s_cbranch_scc1 Lz24_p_x
    s_cbranch_vccnz Lz24_p
Lz24_p_x:
    s_nop 1
    s_branch Lz24_ok
Lz25_r:
    s_nop 7
Lz25_p:
    global_load_dwordx4 v[62:65], v30, s[60:61] offset:3072 sc1
    global_load_dwordx4 v[66:69], v31, s[60:61] offset:3072 sc1
    global_load_dwordx4 v[70:73], v30, s[62:63] offset:3072 sc1
    global_load_dwordx4 v[74:77], v31, s[62:63] offset:3072 sc1
    s_waitcnt vmcnt(0)
    v_max_u32 v28, v65, v69
    v_max3_u32 v28, v73, v77, v28
    v_cmp_eq_u32 vcc, -1, v28
    s_add_u32 s100, s100, 1
    s_cmp_ge_u32 s100, 262144
    s_cbranch_scc1 Lz25_p_x
    s_cbranch_vccnz Lz25_p
Lz25_p_x:
    s_nop 1
    s_branch Lz25_ok
Lz26_r:
    s_nop 7
Lz26_p:
    global_load_dwordx4 v[78:81], v30, s[52:53] offset:3072 sc1
    global_load_dwordx4 v[82:85], v31, s[52:53] offset:3072 sc1
    global_load_dwordx4 v[86:89], v30, s[54:55] offset:3072 sc1
    global_load_dwordx4 v[90:93], v31, s[54:55] offset:3072 sc1
    s_waitcnt vmcnt(0)
    v_max_u32 v28, v81, v85
    v_max3_u32 v28, v89, v93, v28
    v_cmp_eq_u32 vcc, -1, v28
    s_add_u32 s100, s100, 1
    s_cmp_ge_u32 s100, 262144
    s_cbranch_scc1 Lz26_p_x
    s_cbranch_vccnz Lz26_p
Lz26_p_x:
    s_nop 1
    s_branch Lz26_ok
Lz27_r:
    s_nop 7
Lz27_p:
    global_load_dwordx4 v[94:97], v30, s[64:65] offset:3072 sc1
    global_load_dwordx4 v[98:101], v31, s[64:65] offset:3072 sc1
    global_load_dwordx4 v[102:105], v30, s[66:67] offset:3072 sc1
    global_load_dwordx4 v[106:109], v31, s[66:67] offset:3072 sc1
    s_waitcnt vmcnt(0)
    v_max_u32 v28, v97, v101
    v_max3_u32 v28, v105, v109, v28
    v_cmp_eq_u32 vcc, -1, v28
    s_add_u32 s100, s100, 1
    s_cmp_ge_u32 s100, 262144
    s_cbranch_scc1 Lz27_p_x
    s_cbranch_vccnz Lz27_p
Lz27_p_x:
    s_nop 1
    s_branch Lz27_ok
Lp0_r:
    s_nop 7
Lp0_p:
    global_load_dwordx4 v[142:145], v6, s[38:39] offset:-4096 sc1
    global_load_dwordx4 v[146:149], v6, s[38:39] offset:0 sc1
    global_load_dwordx4 v[150:153], v6, s[38:39] offset:3072 sc1
    global_load_dwordx4 v[154:157], v7, s[38:39] offset:-1024 sc1
    global_load_dwordx4 v[158:161], v7, s[38:39] offset:2048 sc1
    global_load_dwordx4 v[162:165], v26, s[38:39] offset:-2048 sc1
    global_load_dwordx4 v[166:169], v26, s[38:39] offset:1024 sc1
    global_load_dwordx4 v[170:173], v27, s[38:39] offset:-3072 sc1
    s_waitcnt vmcnt(0)
    v_max_u32 v28, v145, v149
    v_max3_u32 v28, v153, v157, v28
    v_max3_u32 v28, v161, v165, v28
    v_max3_u32 v28, v169, v173, v28
    v_cmp_eq_u32 vcc, -1, v28
    s_add_u32 s100, s100, 1
    s_cmp_ge_u32 s100, 262144
    s_cbranch_scc1 Lp0_p_x
    s_cbranch_vccnz Lp0_p
Lp0_p_x:
    s_nop 1
    s_branch Lp0_ok
Lp1_r:
    s_nop 7
Lp1_p:
    global_load_dwordx4 v[174:177], v6, s[38:39] offset:-3072 sc1
    global_load_dwordx4 v[178:181], v6, s[38:39] offset:1024 sc1
    global_load_dwordx4 v[182:185], v7, s[38:39] offset:-4096 sc1
    global_load_dwordx4 v[186:189], v7, s[38:39] offset:0 sc1
    global_load_dwordx4 v[190:193], v7, s[38:39] offset:3072 sc1
    global_load_dwordx4 v[194:197], v26, s[38:39] offset:-1024 sc1
    global_load_dwordx4 v[198:201], v26, s[38:39] offset:2048 sc1
    global_load_dwordx4 v[202:205], v27, s[38:39] offset:-2048 sc1
    s_waitcnt vmcnt(0)
    v_max_u32 v28, v177, v181
    v_max3_u32 v28, v185, v189, v28
    v_max3_u32 v28, v193, v197, v28
    v_max3_u32 v28, v201, v205, v28
    v_cmp_eq_u32 vcc, -1, v28
    s_add_u32 s100, s100, 1
    s_cmp_ge_u32 s100, 262144
    s_cbranch_scc1 Lp1_p_x
    s_cbranch_vccnz Lp1_p
Lp1_p_x:
    s_nop 1
    s_branch Lp1_ok
Lp2_r:
    s_nop 7
Lp2_p:
    global_load_dwordx4 v[206:209], v6, s[38:39] offset:-2048 sc1
    global_load_dwordx4 v[210:213], v6, s[38:39] offset:2048 sc1
    global_load_dwordx4 v[214:217], v7, s[38:39] offset:-3072 sc1
    global_load_dwordx4 v[218:221], v7, s[38:39] offset:1024 sc1
    global_load_dwordx4 v[222:225], v26, s[38:39] offset:-4096 sc1
    global_load_dwordx4 v[226:229], v26, s[38:39] offset:0 sc1
    global_load_dwordx4 v[230:233], v26, s[38:39] offset:3072 sc1
    s_waitcnt vmcnt(0)
    v_max3_u32 v28, v209, v213, v217
    v_max3_u32 v28, v221, v225, v28
    v_max3_u32 v28, v229, v233, v28
    v_cmp_eq_u32 vcc, -1, v28
    s_add_u32 s100, s100, 1
    s_cmp_ge_u32 s100, 262144
    s_cbranch_scc1 Lp2_p_x
    s_cbranch_vccnz Lp2_p
Lp2_p_x:
    s_nop 1
    s_branch Lp2_ok
Lp3_r:
    s_nop 7
Lp3_p:
    global_load_dwordx4 v[238:241], v6, s[38:39] offset:-1024 sc1
    global_load_dwordx4 v[242:245], v7, s[38:39] offset:-2048 sc1
    global_load_dwordx4 v[246:249], v26, s[38:39] offset:-3072 sc1
    global_load_dwordx4 v[250:253], v27, s[38:39] offset:-4096 sc1
    s_waitcnt vmcnt(0)
    v_max_u32 v28, v239, v241
    v_max3_u32 v28, v243, v245, v28
    v_max3_u32 v28, v247, v249, v28
    v_max3_u32 v28, v251, v253, v28
    v_cmp_eq_u32 vcc, -1, v28
    s_add_u32 s100, s100, 1
    s_cmp_ge_u32 s100, 262144
    s_cbranch_scc1 Lp3_p_x
    s_cbranch_vccnz Lp3_p
Lp3_p_x:
    s_nop 1
    s_branch Lp3_ok
Lcode_end:
    s_endpgm
.section .rodata,"a"
.p2align 6
.amdhsa_kernel adaLN_cond__ssm_conv_h3__mixer_gmlp__prompt_kernel
  .amdhsa_next_free_vgpr 512
  .amdhsa_next_free_sgpr 102
  .amdhsa_accum_offset 256
  .amdhsa_group_segment_fixed_size 0
  .amdhsa_kernarg_size 128
  .amdhsa_user_sgpr_count 2
  .amdhsa_user_sgpr_kernarg_segment_ptr 1
  .amdhsa_system_sgpr_workgroup_id_x 1
  .amdhsa_float_denorm_mode_32 3
.end_amdhsa_kernel
```

```asm
; @launch grid=(256,1,1) block=(256,1,1) lds=163840
.amdgcn_target "amdgcn-amd-amdhsa--gfx950"
.text
.p2align 8
.globl adaLN_cond__ssm_conv_h3__mixer_gmlp__prompt_kernel
.type adaLN_cond__ssm_conv_h3__mixer_gmlp__prompt_kernel,@function
adaLN_cond__ssm_conv_h3__mixer_gmlp__prompt_kernel:
    s_cmp_ge_u32 s2, 256
    s_cbranch_scc1 Lend
    s_load_dwordx16 s[8:23], s[0:1], 0
    s_load_dwordx16 s[24:39], s[0:1], 64
    v_lshrrev_b32 v2, 6, v0
    v_and_b32 v1, 63, v0
    v_readfirstlane_b32 s3, v2
    s_getpc_b64 s[4:5]
Lpf_adaLN_cond__ssm_conv_h3__mixer_gmlp__prompt_kernel_9:
    s_add_u32 s4, s4, adaLN_cond__ssm_conv_h3__mixer_gmlp__prompt_kernel-Lpf_adaLN_cond__ssm_conv_h3__mixer_gmlp__prompt_kernel_9
    s_addc_u32 s5, s5, -1
    s_lshr_b32 s6, s2, 3
    s_and_b32 s6, s6, 31
    v_mul_u32_u24 v254, 32, v0
    v_add_lshl_u32 v254, v254, s6, 7
    v_min_u32 v254, (Lcode_end-adaLN_cond__ssm_conv_h3__mixer_gmlp__prompt_kernel-4), v254
    global_load_dword v254, v254, s[4:5]
    v_and_b32 v2, 15, v1
    v_lshrrev_b32 v3, 4, v1
    v_lshlrev_b32 v4, 4, v1
    v_lshrrev_b32 v6, 2, v2
    v_and_b32 v5, 3, v2
    v_lshl_add_u32 v5, v6, 3, v5
    s_mov_b32 s100, 0
    s_and_b32 s4, s2, 7
    s_lshr_b32 s5, s2, 3
    s_lshr_b32 s43, s5, 2
    s_lshr_b32 s6, s43, 1
    s_lshl_b32 s6, s6, 3
    s_and_b32 s7, s4, 6
    s_add_u32 s6, s6, s7
    s_and_b32 s7, s43, 1
    s_add_u32 s40, s6, s7
    s_and_b32 s6, s4, 1
    s_lshl_b32 s6, s6, 2
    s_and_b32 s7, s5, 3
    s_add_u32 s41, s6, s7
    s_mul_i32 s4, s4, 20
    s_add_u32 s42, s4, s5
    s_waitcnt lgkmcnt(0)
    s_cmp_ge_u32 s2, 160
    s_cbranch_scc0 Lconv
Lspare:
    s_sub_u32 s42, s2, 160
    s_cmp_lt_u32 s42, 54
    s_cbranch_scc0 Lsp_b
    s_and_b32 s5, s42, 0x34
    s_cbranch_scc1 Lsp_a2
    s_lshr_b32 s5, s42, 3
    s_lshl_b32 s5, s5, 2
    s_and_b32 s48, s42, 3
    s_add_u32 s48, s48, s5
    v_mov_b32 v8, -1
    v_mov_b32 v9, -1
    v_mov_b32 v10, -1
    v_mov_b32 v11, -1
    s_lshl_b32 s4, s48, 14
    s_add_u32 s4, s4, 131072
    v_and_b32 v7, 127, v0
    v_lshl_add_u32 v7, v7, 7, s4
    s_mul_i32 s4, s48, 6144
    s_add_u32 s4, s4, 32768
    v_lshl_add_u32 v6, v0, 4, s4
    global_store_dwordx4 v6, v[8:11], s[38:39] sc1
    s_cmp_ge_u32 s3, 2
    s_cbranch_scc1 Linit_b
    global_store_dword v7, v8, s[38:39] sc1
    s_branch Linit_c
Linit_b:
    global_store_dwordx4 v6, v[8:11], s[38:39] offset:2048 sc1
Linit_c:
    s_lshl_b32 s4, s48, 1
    s_add_u32 s4, s4, 112
    v_mov_b32 v6, s4
    s_waitcnt vmcnt(0)
    s_barrier
    s_cmp_lg_u32 s3, 0
    s_cbranch_scc1 Linit_skip
    global_store_short v6, v8, s[36:37] sc1
Linit_skip:
    s_branch Lsp_a2
Lsp_b:
    s_sub_u32 s48, s42, 54
    s_add_u32 s49, s48, 42
    s_add_u32 s50, s48, 84
    s_cmp_ge_u32 s50, 120
    s_cselect_b32 s50, s49, s50
    s_cmp_eq_u32 s3, 1
    s_cselect_b32 s51, s49, s48
    s_cmp_eq_u32 s3, 2
    s_cselect_b32 s51, s50, s51
    s_lshr_b32 s4, s51, 1
    s_and_b32 s5, s51, 1
    s_cmp_lt_u32 s4, 50
    s_cselect_b32 s6, -20, 0
    s_cmp_lt_u32 s4, 20
    s_cselect_b32 s6, 30, s6
    s_add_u32 s4, s4, s6
    s_mul_i32 s6, s5, 15360
    s_lshl_b32 s7, s4, 8
    s_add_u32 s51, s6, s7
    v_lshl_add_u32 v164, v1, 2, s51
    v_mov_b32 v165, -1
    global_store_dword v164, v165, s[38:39] offset:0 sc1
    s_lshr_b32 s4, s48, 1
    s_and_b32 s5, s48, 1
    s_cmp_lt_u32 s4, 50
    s_cselect_b32 s6, -20, 0
    s_cmp_lt_u32 s4, 20
    s_cselect_b32 s6, 30, s6
    s_add_u32 s4, s4, s6
    s_mul_i32 s6, s5, 15360
    s_lshl_b32 s7, s4, 8
    s_add_u32 s44, s6, s7
    s_lshl_b32 s5, s5, 2
    s_add_u32 s5, s5, s3
    s_mul_i32 s5, s5, 80
    s_lshl_b32 s4, s4, 7
    s_mul_i32 s6, s5, 7680
    s_add_u32 s4, s4, s6
    v_min_u32 v28, 39, v1
    s_lshl_b32 s5, s5, 1
    v_lshl_add_u32 v28, v28, 2, s5
    global_load_dword v80, v28, s[30:31]
    v_lshrrev_b32 v29, 3, v1
    v_mul_u32_u24 v28, 15232, v29
    v_add3_u32 v28, v28, v4, s4
    global_load_dwordx4 v[40:43], v28, s[32:33] nt
    v_add_u32 v28, 7680, v28
    global_load_dwordx4 v[44:47], v28, s[32:33] nt
    v_add_u32 v28, 115200, v28
    global_load_dwordx4 v[48:51], v28, s[32:33] nt
    v_add_u32 v28, 7680, v28
    global_load_dwordx4 v[52:55], v28, s[32:33] nt
    v_add_u32 v28, 115200, v28
    global_load_dwordx4 v[56:59], v28, s[32:33] nt
    v_add_u32 v28, 7680, v28
    global_load_dwordx4 v[60:63], v28, s[32:33] nt
    v_add_u32 v28, 115200, v28
    global_load_dwordx4 v[64:67], v28, s[32:33] nt
    v_add_u32 v28, 7680, v28
    global_load_dwordx4 v[68:71], v28, s[32:33] nt
    v_add_u32 v28, 115200, v28
    global_load_dwordx4 v[72:75], v28, s[32:33] nt
    v_add_u32 v28, 7680, v28
    global_load_dwordx4 v[76:79], v28, s[32:33] nt
    s_lshl_b32 s4, s48, 1
    s_add_u32 s4, s4, 128
    v_mov_b32 v164, s4
    s_waitcnt vmcnt(10)
    s_barrier
    s_cmp_lg_u32 s3, 0
    s_cbranch_scc1 Lsb_skip
    global_store_short v164, v165, s[36:37] sc1
Lsb_skip:
    s_lshr_b32 s4, s49, 1
    s_and_b32 s5, s49, 1
    s_cmp_lt_u32 s4, 50
    s_cselect_b32 s6, -20, 0
    s_cmp_lt_u32 s4, 20
    s_cselect_b32 s6, 30, s6
    s_add_u32 s4, s4, s6
    s_mul_i32 s6, s5, 15360
    s_lshl_b32 s7, s4, 8
    s_add_u32 s45, s6, s7
    s_lshl_b32 s5, s5, 2
    s_add_u32 s5, s5, s3
    s_mul_i32 s5, s5, 80
    s_lshl_b32 s4, s4, 7
    s_mul_i32 s6, s5, 7680
    s_add_u32 s4, s4, s6
    v_min_u32 v96, 39, v1
    s_lshl_b32 s5, s5, 1
    v_lshl_add_u32 v96, v96, 2, s5
    global_load_dword v148, v96, s[30:31]
    v_lshrrev_b32 v97, 3, v1
    v_mul_u32_u24 v96, 15232, v97
    v_add3_u32 v96, v96, v4, s4
    global_load_dwordx4 v[108:111], v96, s[32:33] nt
    v_add_u32 v96, 7680, v96
    global_load_dwordx4 v[112:115], v96, s[32:33] nt
    v_add_u32 v96, 115200, v96
    global_load_dwordx4 v[116:119], v96, s[32:33] nt
    v_add_u32 v96, 7680, v96
    global_load_dwordx4 v[120:123], v96, s[32:33] nt
    v_add_u32 v96, 115200, v96
    global_load_dwordx4 v[124:127], v96, s[32:33] nt
    v_add_u32 v96, 7680, v96
    global_load_dwordx4 v[128:131], v96, s[32:33] nt
    v_add_u32 v96, 115200, v96
    v_lshlrev_b32 v82, 16, v80
    v_and_b32 v83, 0xffff0000, v80
    v_lshlrev_b32 v29, 2, v29
    v_mul_f32 v84, 0xbfb8aa3b, v82
    v_mul_f32 v85, 0xbfb8aa3b, v83
    v_exp_f32 v84, v84
    v_exp_f32 v85, v85
    v_add_f32 v84, 1.0, v84
    v_add_f32 v85, 1.0, v85
    v_rcp_f32 v84, v84
    v_rcp_f32 v85, v85
    v_mul_f32 v82, v82, v84
    v_mul_f32 v83, v83, v85
    v_cvt_pk_bf16_f32 v80, v82, v83
    ds_bpermute_b32 v88, v29, v80 offset:0
    ds_bpermute_b32 v89, v29, v80 offset:32
    ds_bpermute_b32 v90, v29, v80 offset:64
    ds_bpermute_b32 v91, v29, v80 offset:96
    ds_bpermute_b32 v92, v29, v80 offset:128
    s_waitcnt lgkmcnt(4)
    v_lshlrev_b32 v30, 16, v88
    v_and_b32 v31, 0xffff0000, v88
    s_waitcnt lgkmcnt(3)
    v_lshlrev_b32 v32, 16, v89
    v_and_b32 v33, 0xffff0000, v89
    s_waitcnt lgkmcnt(2)
    v_lshlrev_b32 v34, 16, v90
    v_and_b32 v35, 0xffff0000, v90
    s_waitcnt lgkmcnt(1)
    v_lshlrev_b32 v36, 16, v91
    v_and_b32 v37, 0xffff0000, v91
    s_waitcnt lgkmcnt(0)
    v_lshlrev_b32 v38, 16, v92
    v_and_b32 v39, 0xffff0000, v92
    s_waitcnt vmcnt(16)
    v_lshlrev_b32 v80, 16, v40
    v_and_b32 v81, 0xffff0000, v40
    v_lshlrev_b32 v82, 16, v41
    v_and_b32 v83, 0xffff0000, v41
    v_lshlrev_b32 v84, 16, v42
    v_and_b32 v85, 0xffff0000, v42
    v_lshlrev_b32 v86, 16, v43
    v_and_b32 v87, 0xffff0000, v43
    v_pk_mul_f32 v[88:89], v[30:31], v[80:81] op_sel:[0,0] op_sel_hi:[0,1]
    v_pk_mul_f32 v[90:91], v[30:31], v[82:83] op_sel:[0,0] op_sel_hi:[0,1]
    v_pk_mul_f32 v[92:93], v[30:31], v[84:85] op_sel:[0,0] op_sel_hi:[0,1]
    v_pk_mul_f32 v[94:95], v[30:31], v[86:87] op_sel:[0,0] op_sel_hi:[0,1]
    s_waitcnt vmcnt(15)
    v_lshlrev_b32 v80, 16, v44
    v_and_b32 v81, 0xffff0000, v44
    v_lshlrev_b32 v82, 16, v45
    v_and_b32 v83, 0xffff0000, v45
    v_lshlrev_b32 v84, 16, v46
    v_and_b32 v85, 0xffff0000, v46
    v_lshlrev_b32 v86, 16, v47
    v_and_b32 v87, 0xffff0000, v47
    v_pk_fma_f32 v[88:89], v[30:31], v[80:81], v[88:89] op_sel:[1,0,0] op_sel_hi:[1,1,1]
    v_pk_fma_f32 v[90:91], v[30:31], v[82:83], v[90:91] op_sel:[1,0,0] op_sel_hi:[1,1,1]
    v_pk_fma_f32 v[92:93], v[30:31], v[84:85], v[92:93] op_sel:[1,0,0] op_sel_hi:[1,1,1]
    v_pk_fma_f32 v[94:95], v[30:31], v[86:87], v[94:95] op_sel:[1,0,0] op_sel_hi:[1,1,1]
    s_waitcnt vmcnt(14)
    v_lshlrev_b32 v80, 16, v48
    v_and_b32 v81, 0xffff0000, v48
    v_lshlrev_b32 v82, 16, v49
    v_and_b32 v83, 0xffff0000, v49
    v_lshlrev_b32 v84, 16, v50
    v_and_b32 v85, 0xffff0000, v50
    v_lshlrev_b32 v86, 16, v51
    v_and_b32 v87, 0xffff0000, v51
    v_pk_fma_f32 v[88:89], v[32:33], v[80:81], v[88:89] op_sel:[0,0,0] op_sel_hi:[0,1,1]
    v_pk_fma_f32 v[90:91], v[32:33], v[82:83], v[90:91] op_sel:[0,0,0] op_sel_hi:[0,1,1]
    v_pk_fma_f32 v[92:93], v[32:33], v[84:85], v[92:93] op_sel:[0,0,0] op_sel_hi:[0,1,1]
    v_pk_fma_f32 v[94:95], v[32:33], v[86:87], v[94:95] op_sel:[0,0,0] op_sel_hi:[0,1,1]
    s_waitcnt vmcnt(13)
    v_lshlrev_b32 v80, 16, v52
    v_and_b32 v81, 0xffff0000, v52
    v_lshlrev_b32 v82, 16, v53
    v_and_b32 v83, 0xffff0000, v53
    v_lshlrev_b32 v84, 16, v54
    v_and_b32 v85, 0xffff0000, v54
    v_lshlrev_b32 v86, 16, v55
    v_and_b32 v87, 0xffff0000, v55
    v_pk_fma_f32 v[88:89], v[32:33], v[80:81], v[88:89] op_sel:[1,0,0] op_sel_hi:[1,1,1]
    v_pk_fma_f32 v[90:91], v[32:33], v[82:83], v[90:91] op_sel:[1,0,0] op_sel_hi:[1,1,1]
    v_pk_fma_f32 v[92:93], v[32:33], v[84:85], v[92:93] op_sel:[1,0,0] op_sel_hi:[1,1,1]
    v_pk_fma_f32 v[94:95], v[32:33], v[86:87], v[94:95] op_sel:[1,0,0] op_sel_hi:[1,1,1]
    s_waitcnt vmcnt(12)
    v_lshlrev_b32 v80, 16, v56
    v_and_b32 v81, 0xffff0000, v56
    v_lshlrev_b32 v82, 16, v57
    v_and_b32 v83, 0xffff0000, v57
    v_lshlrev_b32 v84, 16, v58
    v_and_b32 v85, 0xffff0000, v58
    v_lshlrev_b32 v86, 16, v59
    v_and_b32 v87, 0xffff0000, v59
    v_pk_fma_f32 v[88:89], v[34:35], v[80:81], v[88:89] op_sel:[0,0,0] op_sel_hi:[0,1,1]
    v_pk_fma_f32 v[90:91], v[34:35], v[82:83], v[90:91] op_sel:[0,0,0] op_sel_hi:[0,1,1]
    v_pk_fma_f32 v[92:93], v[34:35], v[84:85], v[92:93] op_sel:[0,0,0] op_sel_hi:[0,1,1]
    v_pk_fma_f32 v[94:95], v[34:35], v[86:87], v[94:95] op_sel:[0,0,0] op_sel_hi:[0,1,1]
    s_waitcnt vmcnt(11)
    v_lshlrev_b32 v80, 16, v60
    v_and_b32 v81, 0xffff0000, v60
    v_lshlrev_b32 v82, 16, v61
    v_and_b32 v83, 0xffff0000, v61
    v_lshlrev_b32 v84, 16, v62
    v_and_b32 v85, 0xffff0000, v62
    v_lshlrev_b32 v86, 16, v63
    v_and_b32 v87, 0xffff0000, v63
    v_pk_fma_f32 v[88:89], v[34:35], v[80:81], v[88:89] op_sel:[1,0,0] op_sel_hi:[1,1,1]
    v_pk_fma_f32 v[90:91], v[34:35], v[82:83], v[90:91] op_sel:[1,0,0] op_sel_hi:[1,1,1]
    v_pk_fma_f32 v[92:93], v[34:35], v[84:85], v[92:93] op_sel:[1,0,0] op_sel_hi:[1,1,1]
    v_pk_fma_f32 v[94:95], v[34:35], v[86:87], v[94:95] op_sel:[1,0,0] op_sel_hi:[1,1,1]
    s_waitcnt vmcnt(10)
    v_lshlrev_b32 v80, 16, v64
    v_and_b32 v81, 0xffff0000, v64
    v_lshlrev_b32 v82, 16, v65
    v_and_b32 v83, 0xffff0000, v65
    v_lshlrev_b32 v84, 16, v66
    v_and_b32 v85, 0xffff0000, v66
    v_lshlrev_b32 v86, 16, v67
    v_and_b32 v87, 0xffff0000, v67
    v_pk_fma_f32 v[88:89], v[36:37], v[80:81], v[88:89] op_sel:[0,0,0] op_sel_hi:[0,1,1]
    v_pk_fma_f32 v[90:91], v[36:37], v[82:83], v[90:91] op_sel:[0,0,0] op_sel_hi:[0,1,1]
    v_pk_fma_f32 v[92:93], v[36:37], v[84:85], v[92:93] op_sel:[0,0,0] op_sel_hi:[0,1,1]
    v_pk_fma_f32 v[94:95], v[36:37], v[86:87], v[94:95] op_sel:[0,0,0] op_sel_hi:[0,1,1]
    s_waitcnt vmcnt(9)
    v_lshlrev_b32 v80, 16, v68
    v_and_b32 v81, 0xffff0000, v68
    v_lshlrev_b32 v82, 16, v69
    v_and_b32 v83, 0xffff0000, v69
    v_lshlrev_b32 v84, 16, v70
    v_and_b32 v85, 0xffff0000, v70
    v_lshlrev_b32 v86, 16, v71
    v_and_b32 v87, 0xffff0000, v71
    v_pk_fma_f32 v[88:89], v[36:37], v[80:81], v[88:89] op_sel:[1,0,0] op_sel_hi:[1,1,1]
    v_pk_fma_f32 v[90:91], v[36:37], v[82:83], v[90:91] op_sel:[1,0,0] op_sel_hi:[1,1,1]
    v_pk_fma_f32 v[92:93], v[36:37], v[84:85], v[92:93] op_sel:[1,0,0] op_sel_hi:[1,1,1]
    v_pk_fma_f32 v[94:95], v[36:37], v[86:87], v[94:95] op_sel:[1,0,0] op_sel_hi:[1,1,1]
    s_waitcnt vmcnt(8)
    v_lshlrev_b32 v80, 16, v72
    v_and_b32 v81, 0xffff0000, v72
    v_lshlrev_b32 v82, 16, v73
    v_and_b32 v83, 0xffff0000, v73
    v_lshlrev_b32 v84, 16, v74
    v_and_b32 v85, 0xffff0000, v74
    v_lshlrev_b32 v86, 16, v75
    v_and_b32 v87, 0xffff0000, v75
    v_pk_fma_f32 v[88:89], v[38:39], v[80:81], v[88:89] op_sel:[0,0,0] op_sel_hi:[0,1,1]
    v_pk_fma_f32 v[90:91], v[38:39], v[82:83], v[90:91] op_sel:[0,0,0] op_sel_hi:[0,1,1]
    v_pk_fma_f32 v[92:93], v[38:39], v[84:85], v[92:93] op_sel:[0,0,0] op_sel_hi:[0,1,1]
    v_pk_fma_f32 v[94:95], v[38:39], v[86:87], v[94:95] op_sel:[0,0,0] op_sel_hi:[0,1,1]
    s_waitcnt vmcnt(7)
    v_lshlrev_b32 v80, 16, v76
    v_and_b32 v81, 0xffff0000, v76
    v_lshlrev_b32 v82, 16, v77
    v_and_b32 v83, 0xffff0000, v77
    v_lshlrev_b32 v84, 16, v78
    v_and_b32 v85, 0xffff0000, v78
    v_lshlrev_b32 v86, 16, v79
    v_and_b32 v87, 0xffff0000, v79
    v_pk_fma_f32 v[88:89], v[38:39], v[80:81], v[88:89] op_sel:[1,0,0] op_sel_hi:[1,1,1]
    v_pk_fma_f32 v[90:91], v[38:39], v[82:83], v[90:91] op_sel:[1,0,0] op_sel_hi:[1,1,1]
    v_pk_fma_f32 v[92:93], v[38:39], v[84:85], v[92:93] op_sel:[1,0,0] op_sel_hi:[1,1,1]
    v_pk_fma_f32 v[94:95], v[38:39], v[86:87], v[94:95] op_sel:[1,0,0] op_sel_hi:[1,1,1]
    s_nop 0
    v_permlane32_swap_b32 v88, v92
    v_permlane32_swap_b32 v89, v93
    v_permlane32_swap_b32 v90, v94
    v_permlane32_swap_b32 v91, v95
    v_add_f32 v88, v88, v92
    v_add_f32 v89, v89, v93
    v_add_f32 v90, v90, v94
    v_add_f32 v91, v91, v95
    s_nop 0
    v_permlane16_swap_b32 v88, v90
    v_permlane16_swap_b32 v89, v91
    v_add_f32 v88, v88, v90
    v_add_f32 v89, v89, v91
    v_and_b32 v81, 7, v1
    v_lshrrev_b32 v82, 3, v1
    v_add_f32_dpp v80, v88, v88 row_ror:8 row_mask:0xf bank_mask:0x3
    s_nop 1
    v_add_f32_dpp v80, v89, v89 row_ror:8 row_mask:0xf bank_mask:0xc
    v_lshl_add_u32 v81, v81, 3, v82
    s_lshl_b32 s7, s3, 8
    s_add_u32 s7, s7, 122880
    v_lshl_add_u32 v81, v81, 2, s7
    ds_write_b32 v81, v80
    s_waitcnt lgkmcnt(0)
    s_barrier
    v_lshlrev_b32 v81, 2, v1
    v_add_u32 v82, 122880, v81
    ds_read_b32 v88, v82 offset:0
    ds_read_b32 v89, v82 offset:256
    ds_read_b32 v90, v82 offset:512
    ds_read_b32 v91, v82 offset:768
    v_add_u32 v81, s44, v81
    s_waitcnt lgkmcnt(2)
    v_add_f32 v88, v88, v89
    s_waitcnt lgkmcnt(0)
    v_add_f32 v90, v90, v91
    v_add_f32 v88, v88, v90
    v_min_u32 v88, -2, v88
    s_cmp_lg_u32 s3, 0
    s_cbranch_scc1 Lmod_skip_s1
    global_store_dword v81, v88, s[38:39] offset:0 sc1
Lmod_skip_s1:
    global_load_dwordx4 v[132:135], v96, s[32:33] nt
    v_add_u32 v96, 7680, v96
    global_load_dwordx4 v[136:139], v96, s[32:33] nt
    v_add_u32 v96, 115200, v96
    global_load_dwordx4 v[140:143], v96, s[32:33] nt
    v_add_u32 v96, 7680, v96
    global_load_dwordx4 v[144:147], v96, s[32:33] nt
    s_cmp_lt_u32 s50, 100
    s_cbranch_scc1 Lsb_n3
    s_lshr_b32 s4, s50, 1
    s_and_b32 s5, s50, 1
    s_cmp_lt_u32 s4, 50
    s_cselect_b32 s6, -20, 0
    s_cmp_lt_u32 s4, 20
    s_cselect_b32 s6, 30, s6
    s_add_u32 s4, s4, s6
    s_mul_i32 s6, s5, 15360
    s_lshl_b32 s7, s4, 8
    s_add_u32 s44, s6, s7
    s_lshl_b32 s5, s5, 2
    s_add_u32 s5, s5, s3
    s_mul_i32 s5, s5, 80
    s_lshl_b32 s4, s4, 7
    s_mul_i32 s6, s5, 7680
    s_add_u32 s4, s4, s6
    v_min_u32 v28, 39, v1
    s_lshl_b32 s5, s5, 1
    v_lshl_add_u32 v28, v28, 2, s5
    global_load_dword v80, v28, s[30:31]
    v_lshrrev_b32 v29, 3, v1
    v_mul_u32_u24 v28, 15232, v29
    v_add3_u32 v28, v28, v4, s4
    global_load_dwordx4 v[40:43], v28, s[32:33] nt
    v_add_u32 v28, 7680, v28
    global_load_dwordx4 v[44:47], v28, s[32:33] nt
    v_add_u32 v28, 115200, v28
    global_load_dwordx4 v[48:51], v28, s[32:33] nt
    v_add_u32 v28, 7680, v28
    global_load_dwordx4 v[52:55], v28, s[32:33] nt
    v_add_u32 v28, 115200, v28
    global_load_dwordx4 v[56:59], v28, s[32:33] nt
    v_add_u32 v28, 7680, v28
    global_load_dwordx4 v[60:63], v28, s[32:33] nt
    v_add_u32 v28, 115200, v28
    global_load_dwordx4 v[64:67], v28, s[32:33] nt
    v_add_u32 v28, 7680, v28
    global_load_dwordx4 v[68:71], v28, s[32:33] nt
    v_add_u32 v28, 115200, v28
    global_load_dwordx4 v[72:75], v28, s[32:33] nt
    v_add_u32 v28, 7680, v28
    global_load_dwordx4 v[76:79], v28, s[32:33] nt
    s_waitcnt vmcnt(11)
    s_branch Lsb_n4
Lsb_n3:
    s_waitcnt vmcnt(0)
Lsb_n4:
    v_lshlrev_b32 v150, 16, v148
    v_and_b32 v151, 0xffff0000, v148
    v_lshlrev_b32 v97, 2, v97
    v_mul_f32 v152, 0xbfb8aa3b, v150
    v_mul_f32 v153, 0xbfb8aa3b, v151
    v_exp_f32 v152, v152
    v_exp_f32 v153, v153
    v_add_f32 v152, 1.0, v152
    v_add_f32 v153, 1.0, v153
    v_rcp_f32 v152, v152
    v_rcp_f32 v153, v153
    v_mul_f32 v150, v150, v152
    v_mul_f32 v151, v151, v153
    v_cvt_pk_bf16_f32 v148, v150, v151
    ds_bpermute_b32 v156, v97, v148 offset:0
    ds_bpermute_b32 v157, v97, v148 offset:32
    ds_bpermute_b32 v158, v97, v148 offset:64
    ds_bpermute_b32 v159, v97, v148 offset:96
    ds_bpermute_b32 v160, v97, v148 offset:128
    s_waitcnt lgkmcnt(4)
    v_lshlrev_b32 v98, 16, v156
    v_and_b32 v99, 0xffff0000, v156
    s_waitcnt lgkmcnt(3)
    v_lshlrev_b32 v100, 16, v157
    v_and_b32 v101, 0xffff0000, v157
    s_waitcnt lgkmcnt(2)
    v_lshlrev_b32 v102, 16, v158
    v_and_b32 v103, 0xffff0000, v158
    s_waitcnt lgkmcnt(1)
    v_lshlrev_b32 v104, 16, v159
    v_and_b32 v105, 0xffff0000, v159
    s_waitcnt lgkmcnt(0)
    v_lshlrev_b32 v106, 16, v160
    v_and_b32 v107, 0xffff0000, v160
    v_lshlrev_b32 v148, 16, v108
    v_and_b32 v149, 0xffff0000, v108
    v_lshlrev_b32 v150, 16, v109
    v_and_b32 v151, 0xffff0000, v109
    v_lshlrev_b32 v152, 16, v110
    v_and_b32 v153, 0xffff0000, v110
    v_lshlrev_b32 v154, 16, v111
    v_and_b32 v155, 0xffff0000, v111
    v_pk_mul_f32 v[156:157], v[98:99], v[148:149] op_sel:[0,0] op_sel_hi:[0,1]
    v_pk_mul_f32 v[158:159], v[98:99], v[150:151] op_sel:[0,0] op_sel_hi:[0,1]
    v_pk_mul_f32 v[160:161], v[98:99], v[152:153] op_sel:[0,0] op_sel_hi:[0,1]
    v_pk_mul_f32 v[162:163], v[98:99], v[154:155] op_sel:[0,0] op_sel_hi:[0,1]
    v_lshlrev_b32 v148, 16, v112
    v_and_b32 v149, 0xffff0000, v112
    v_lshlrev_b32 v150, 16, v113
    v_and_b32 v151, 0xffff0000, v113
    v_lshlrev_b32 v152, 16, v114
    v_and_b32 v153, 0xffff0000, v114
    v_lshlrev_b32 v154, 16, v115
    v_and_b32 v155, 0xffff0000, v115
    v_pk_fma_f32 v[156:157], v[98:99], v[148:149], v[156:157] op_sel:[1,0,0] op_sel_hi:[1,1,1]
    v_pk_fma_f32 v[158:159], v[98:99], v[150:151], v[158:159] op_sel:[1,0,0] op_sel_hi:[1,1,1]
    v_pk_fma_f32 v[160:161], v[98:99], v[152:153], v[160:161] op_sel:[1,0,0] op_sel_hi:[1,1,1]
    v_pk_fma_f32 v[162:163], v[98:99], v[154:155], v[162:163] op_sel:[1,0,0] op_sel_hi:[1,1,1]
    v_lshlrev_b32 v148, 16, v116
    v_and_b32 v149, 0xffff0000, v116
    v_lshlrev_b32 v150, 16, v117
    v_and_b32 v151, 0xffff0000, v117
    v_lshlrev_b32 v152, 16, v118
    v_and_b32 v153, 0xffff0000, v118
    v_lshlrev_b32 v154, 16, v119
    v_and_b32 v155, 0xffff0000, v119
    v_pk_fma_f32 v[156:157], v[100:101], v[148:149], v[156:157] op_sel:[0,0,0] op_sel_hi:[0,1,1]
    v_pk_fma_f32 v[158:159], v[100:101], v[150:151], v[158:159] op_sel:[0,0,0] op_sel_hi:[0,1,1]
    v_pk_fma_f32 v[160:161], v[100:101], v[152:153], v[160:161] op_sel:[0,0,0] op_sel_hi:[0,1,1]
    v_pk_fma_f32 v[162:163], v[100:101], v[154:155], v[162:163] op_sel:[0,0,0] op_sel_hi:[0,1,1]
    v_lshlrev_b32 v148, 16, v120
    v_and_b32 v149, 0xffff0000, v120
    v_lshlrev_b32 v150, 16, v121
    v_and_b32 v151, 0xffff0000, v121
    v_lshlrev_b32 v152, 16, v122
    v_and_b32 v153, 0xffff0000, v122
    v_lshlrev_b32 v154, 16, v123
    v_and_b32 v155, 0xffff0000, v123
    v_pk_fma_f32 v[156:157], v[100:101], v[148:149], v[156:157] op_sel:[1,0,0] op_sel_hi:[1,1,1]
    v_pk_fma_f32 v[158:159], v[100:101], v[150:151], v[158:159] op_sel:[1,0,0] op_sel_hi:[1,1,1]
    v_pk_fma_f32 v[160:161], v[100:101], v[152:153], v[160:161] op_sel:[1,0,0] op_sel_hi:[1,1,1]
    v_pk_fma_f32 v[162:163], v[100:101], v[154:155], v[162:163] op_sel:[1,0,0] op_sel_hi:[1,1,1]
    v_lshlrev_b32 v148, 16, v124
    v_and_b32 v149, 0xffff0000, v124
    v_lshlrev_b32 v150, 16, v125
    v_and_b32 v151, 0xffff0000, v125
    v_lshlrev_b32 v152, 16, v126
    v_and_b32 v153, 0xffff0000, v126
    v_lshlrev_b32 v154, 16, v127
    v_and_b32 v155, 0xffff0000, v127
    v_pk_fma_f32 v[156:157], v[102:103], v[148:149], v[156:157] op_sel:[0,0,0] op_sel_hi:[0,1,1]
    v_pk_fma_f32 v[158:159], v[102:103], v[150:151], v[158:159] op_sel:[0,0,0] op_sel_hi:[0,1,1]
    v_pk_fma_f32 v[160:161], v[102:103], v[152:153], v[160:161] op_sel:[0,0,0] op_sel_hi:[0,1,1]
    v_pk_fma_f32 v[162:163], v[102:103], v[154:155], v[162:163] op_sel:[0,0,0] op_sel_hi:[0,1,1]
    v_lshlrev_b32 v148, 16, v128
    v_and_b32 v149, 0xffff0000, v128
    v_lshlrev_b32 v150, 16, v129
    v_and_b32 v151, 0xffff0000, v129
    v_lshlrev_b32 v152, 16, v130
    v_and_b32 v153, 0xffff0000, v130
    v_lshlrev_b32 v154, 16, v131
    v_and_b32 v155, 0xffff0000, v131
    v_pk_fma_f32 v[156:157], v[102:103], v[148:149], v[156:157] op_sel:[1,0,0] op_sel_hi:[1,1,1]
    v_pk_fma_f32 v[158:159], v[102:103], v[150:151], v[158:159] op_sel:[1,0,0] op_sel_hi:[1,1,1]
    v_pk_fma_f32 v[160:161], v[102:103], v[152:153], v[160:161] op_sel:[1,0,0] op_sel_hi:[1,1,1]
    v_pk_fma_f32 v[162:163], v[102:103], v[154:155], v[162:163] op_sel:[1,0,0] op_sel_hi:[1,1,1]
    v_lshlrev_b32 v148, 16, v132
    v_and_b32 v149, 0xffff0000, v132
    v_lshlrev_b32 v150, 16, v133
    v_and_b32 v151, 0xffff0000, v133
    v_lshlrev_b32 v152, 16, v134
    v_and_b32 v153, 0xffff0000, v134
    v_lshlrev_b32 v154, 16, v135
    v_and_b32 v155, 0xffff0000, v135
    v_pk_fma_f32 v[156:157], v[104:105], v[148:149], v[156:157] op_sel:[0,0,0] op_sel_hi:[0,1,1]
    v_pk_fma_f32 v[158:159], v[104:105], v[150:151], v[158:159] op_sel:[0,0,0] op_sel_hi:[0,1,1]
    v_pk_fma_f32 v[160:161], v[104:105], v[152:153], v[160:161] op_sel:[0,0,0] op_sel_hi:[0,1,1]
    v_pk_fma_f32 v[162:163], v[104:105], v[154:155], v[162:163] op_sel:[0,0,0] op_sel_hi:[0,1,1]
    v_lshlrev_b32 v148, 16, v136
    v_and_b32 v149, 0xffff0000, v136
    v_lshlrev_b32 v150, 16, v137
    v_and_b32 v151, 0xffff0000, v137
    v_lshlrev_b32 v152, 16, v138
    v_and_b32 v153, 0xffff0000, v138
    v_lshlrev_b32 v154, 16, v139
    v_and_b32 v155, 0xffff0000, v139
    v_pk_fma_f32 v[156:157], v[104:105], v[148:149], v[156:157] op_sel:[1,0,0] op_sel_hi:[1,1,1]
    v_pk_fma_f32 v[158:159], v[104:105], v[150:151], v[158:159] op_sel:[1,0,0] op_sel_hi:[1,1,1]
    v_pk_fma_f32 v[160:161], v[104:105], v[152:153], v[160:161] op_sel:[1,0,0] op_sel_hi:[1,1,1]
    v_pk_fma_f32 v[162:163], v[104:105], v[154:155], v[162:163] op_sel:[1,0,0] op_sel_hi:[1,1,1]
    v_lshlrev_b32 v148, 16, v140
    v_and_b32 v149, 0xffff0000, v140
    v_lshlrev_b32 v150, 16, v141
    v_and_b32 v151, 0xffff0000, v141
    v_lshlrev_b32 v152, 16, v142
    v_and_b32 v153, 0xffff0000, v142
    v_lshlrev_b32 v154, 16, v143
    v_and_b32 v155, 0xffff0000, v143
    v_pk_fma_f32 v[156:157], v[106:107], v[148:149], v[156:157] op_sel:[0,0,0] op_sel_hi:[0,1,1]
    v_pk_fma_f32 v[158:159], v[106:107], v[150:151], v[158:159] op_sel:[0,0,0] op_sel_hi:[0,1,1]
    v_pk_fma_f32 v[160:161], v[106:107], v[152:153], v[160:161] op_sel:[0,0,0] op_sel_hi:[0,1,1]
    v_pk_fma_f32 v[162:163], v[106:107], v[154:155], v[162:163] op_sel:[0,0,0] op_sel_hi:[0,1,1]
    v_lshlrev_b32 v148, 16, v144
    v_and_b32 v149, 0xffff0000, v144
    v_lshlrev_b32 v150, 16, v145
    v_and_b32 v151, 0xffff0000, v145
    v_lshlrev_b32 v152, 16, v146
    v_and_b32 v153, 0xffff0000, v146
    v_lshlrev_b32 v154, 16, v147
    v_and_b32 v155, 0xffff0000, v147
    v_pk_fma_f32 v[156:157], v[106:107], v[148:149], v[156:157] op_sel:[1,0,0] op_sel_hi:[1,1,1]
    v_pk_fma_f32 v[158:159], v[106:107], v[150:151], v[158:159] op_sel:[1,0,0] op_sel_hi:[1,1,1]
    v_pk_fma_f32 v[160:161], v[106:107], v[152:153], v[160:161] op_sel:[1,0,0] op_sel_hi:[1,1,1]
    v_pk_fma_f32 v[162:163], v[106:107], v[154:155], v[162:163] op_sel:[1,0,0] op_sel_hi:[1,1,1]
    s_nop 0
    v_permlane32_swap_b32 v156, v160
    v_permlane32_swap_b32 v157, v161
    v_permlane32_swap_b32 v158, v162
    v_permlane32_swap_b32 v159, v163
    v_add_f32 v156, v156, v160
    v_add_f32 v157, v157, v161
    v_add_f32 v158, v158, v162
    v_add_f32 v159, v159, v163
    s_nop 0
    v_permlane16_swap_b32 v156, v158
    v_permlane16_swap_b32 v157, v159
    v_add_f32 v156, v156, v158
    v_add_f32 v157, v157, v159
    v_and_b32 v149, 7, v1
    v_lshrrev_b32 v150, 3, v1
    v_add_f32_dpp v148, v156, v156 row_ror:8 row_mask:0xf bank_mask:0x3
    s_nop 1
    v_add_f32_dpp v148, v157, v157 row_ror:8 row_mask:0xf bank_mask:0xc
    v_lshl_add_u32 v149, v149, 3, v150
    s_lshl_b32 s7, s3, 8
    s_add_u32 s7, s7, 123904
    v_lshl_add_u32 v149, v149, 2, s7
    ds_write_b32 v149, v148
    s_waitcnt lgkmcnt(0)
    s_barrier
    v_lshlrev_b32 v149, 2, v1
    v_add_u32 v150, 123904, v149
    ds_read_b32 v156, v150 offset:0
    ds_read_b32 v157, v150 offset:256
    ds_read_b32 v158, v150 offset:512
    ds_read_b32 v159, v150 offset:768
    v_add_u32 v149, s45, v149
    s_waitcnt lgkmcnt(2)
    v_add_f32 v156, v156, v157
    s_waitcnt lgkmcnt(0)
    v_add_f32 v158, v158, v159
    v_add_f32 v156, v156, v158
    v_min_u32 v156, -2, v156
    s_cmp_lg_u32 s3, 0
    s_cbranch_scc1 Lmod_skip_s2
    global_store_dword v149, v156, s[38:39] offset:0 sc1
Lmod_skip_s2:
    s_cmp_lg_u32 s3, 0
    s_cbranch_scc1 Lbic_x
    v_min_u32 v164, 49, v1
    v_add_u32 v164, 56, v164
    v_lshlrev_b32 v164, 1, v164
    s_branch Lbic_f
Lbic:
    s_sleep 4
Lbic_f:
    global_load_ushort v165, v164, s[36:37] sc1
    s_waitcnt vmcnt(0)
    v_cmp_eq_u32 vcc, 0, v165
    s_add_u32 s100, s100, 1
    s_cmp_ge_u32 s100, 262144
    s_cbranch_scc1 Lbic_x
    s_cbranch_vccnz Lbic
Lbic_x:
    s_waitcnt vmcnt(0)
    s_cmp_lt_u32 s50, 100
    s_cbranch_scc1 Lsp_c
    v_lshlrev_b32 v82, 16, v80
    v_and_b32 v83, 0xffff0000, v80
    v_lshlrev_b32 v29, 2, v29
    v_mul_f32 v84, 0xbfb8aa3b, v82
    v_mul_f32 v85, 0xbfb8aa3b, v83
    v_exp_f32 v84, v84
    v_exp_f32 v85, v85
    v_add_f32 v84, 1.0, v84
    v_add_f32 v85, 1.0, v85
    v_rcp_f32 v84, v84
    v_rcp_f32 v85, v85
    v_mul_f32 v82, v82, v84
    v_mul_f32 v83, v83, v85
    v_cvt_pk_bf16_f32 v80, v82, v83
    ds_bpermute_b32 v88, v29, v80 offset:0
    ds_bpermute_b32 v89, v29, v80 offset:32
    ds_bpermute_b32 v90, v29, v80 offset:64
    ds_bpermute_b32 v91, v29, v80 offset:96
    ds_bpermute_b32 v92, v29, v80 offset:128
    s_waitcnt lgkmcnt(4)
    v_lshlrev_b32 v30, 16, v88
    v_and_b32 v31, 0xffff0000, v88
    s_waitcnt lgkmcnt(3)
    v_lshlrev_b32 v32, 16, v89
    v_and_b32 v33, 0xffff0000, v89
    s_waitcnt lgkmcnt(2)
    v_lshlrev_b32 v34, 16, v90
    v_and_b32 v35, 0xffff0000, v90
    s_waitcnt lgkmcnt(1)
    v_lshlrev_b32 v36, 16, v91
    v_and_b32 v37, 0xffff0000, v91
    s_waitcnt lgkmcnt(0)
    v_lshlrev_b32 v38, 16, v92
    v_and_b32 v39, 0xffff0000, v92
    v_lshlrev_b32 v80, 16, v40
    v_and_b32 v81, 0xffff0000, v40
    v_lshlrev_b32 v82, 16, v41
    v_and_b32 v83, 0xffff0000, v41
    v_lshlrev_b32 v84, 16, v42
    v_and_b32 v85, 0xffff0000, v42
    v_lshlrev_b32 v86, 16, v43
    v_and_b32 v87, 0xffff0000, v43
    v_pk_mul_f32 v[88:89], v[30:31], v[80:81] op_sel:[0,0] op_sel_hi:[0,1]
    v_pk_mul_f32 v[90:91], v[30:31], v[82:83] op_sel:[0,0] op_sel_hi:[0,1]
    v_pk_mul_f32 v[92:93], v[30:31], v[84:85] op_sel:[0,0] op_sel_hi:[0,1]
    v_pk_mul_f32 v[94:95], v[30:31], v[86:87] op_sel:[0,0] op_sel_hi:[0,1]
    v_lshlrev_b32 v80, 16, v44
    v_and_b32 v81, 0xffff0000, v44
    v_lshlrev_b32 v82, 16, v45
    v_and_b32 v83, 0xffff0000, v45
    v_lshlrev_b32 v84, 16, v46
    v_and_b32 v85, 0xffff0000, v46
    v_lshlrev_b32 v86, 16, v47
    v_and_b32 v87, 0xffff0000, v47
    v_pk_fma_f32 v[88:89], v[30:31], v[80:81], v[88:89] op_sel:[1,0,0] op_sel_hi:[1,1,1]
    v_pk_fma_f32 v[90:91], v[30:31], v[82:83], v[90:91] op_sel:[1,0,0] op_sel_hi:[1,1,1]
    v_pk_fma_f32 v[92:93], v[30:31], v[84:85], v[92:93] op_sel:[1,0,0] op_sel_hi:[1,1,1]
    v_pk_fma_f32 v[94:95], v[30:31], v[86:87], v[94:95] op_sel:[1,0,0] op_sel_hi:[1,1,1]
    v_lshlrev_b32 v80, 16, v48
    v_and_b32 v81, 0xffff0000, v48
    v_lshlrev_b32 v82, 16, v49
    v_and_b32 v83, 0xffff0000, v49
    v_lshlrev_b32 v84, 16, v50
    v_and_b32 v85, 0xffff0000, v50
    v_lshlrev_b32 v86, 16, v51
    v_and_b32 v87, 0xffff0000, v51
    v_pk_fma_f32 v[88:89], v[32:33], v[80:81], v[88:89] op_sel:[0,0,0] op_sel_hi:[0,1,1]
    v_pk_fma_f32 v[90:91], v[32:33], v[82:83], v[90:91] op_sel:[0,0,0] op_sel_hi:[0,1,1]
    v_pk_fma_f32 v[92:93], v[32:33], v[84:85], v[92:93] op_sel:[0,0,0] op_sel_hi:[0,1,1]
    v_pk_fma_f32 v[94:95], v[32:33], v[86:87], v[94:95] op_sel:[0,0,0] op_sel_hi:[0,1,1]
    v_lshlrev_b32 v80, 16, v52
    v_and_b32 v81, 0xffff0000, v52
    v_lshlrev_b32 v82, 16, v53
    v_and_b32 v83, 0xffff0000, v53
    v_lshlrev_b32 v84, 16, v54
    v_and_b32 v85, 0xffff0000, v54
    v_lshlrev_b32 v86, 16, v55
    v_and_b32 v87, 0xffff0000, v55
    v_pk_fma_f32 v[88:89], v[32:33], v[80:81], v[88:89] op_sel:[1,0,0] op_sel_hi:[1,1,1]
    v_pk_fma_f32 v[90:91], v[32:33], v[82:83], v[90:91] op_sel:[1,0,0] op_sel_hi:[1,1,1]
    v_pk_fma_f32 v[92:93], v[32:33], v[84:85], v[92:93] op_sel:[1,0,0] op_sel_hi:[1,1,1]
    v_pk_fma_f32 v[94:95], v[32:33], v[86:87], v[94:95] op_sel:[1,0,0] op_sel_hi:[1,1,1]
    v_lshlrev_b32 v80, 16, v56
    v_and_b32 v81, 0xffff0000, v56
    v_lshlrev_b32 v82, 16, v57
    v_and_b32 v83, 0xffff0000, v57
    v_lshlrev_b32 v84, 16, v58
    v_and_b32 v85, 0xffff0000, v58
    v_lshlrev_b32 v86, 16, v59
    v_and_b32 v87, 0xffff0000, v59
    v_pk_fma_f32 v[88:89], v[34:35], v[80:81], v[88:89] op_sel:[0,0,0] op_sel_hi:[0,1,1]
    v_pk_fma_f32 v[90:91], v[34:35], v[82:83], v[90:91] op_sel:[0,0,0] op_sel_hi:[0,1,1]
    v_pk_fma_f32 v[92:93], v[34:35], v[84:85], v[92:93] op_sel:[0,0,0] op_sel_hi:[0,1,1]
    v_pk_fma_f32 v[94:95], v[34:35], v[86:87], v[94:95] op_sel:[0,0,0] op_sel_hi:[0,1,1]
    v_lshlrev_b32 v80, 16, v60
    v_and_b32 v81, 0xffff0000, v60
    v_lshlrev_b32 v82, 16, v61
    v_and_b32 v83, 0xffff0000, v61
    v_lshlrev_b32 v84, 16, v62
    v_and_b32 v85, 0xffff0000, v62
    v_lshlrev_b32 v86, 16, v63
    v_and_b32 v87, 0xffff0000, v63
    v_pk_fma_f32 v[88:89], v[34:35], v[80:81], v[88:89] op_sel:[1,0,0] op_sel_hi:[1,1,1]
    v_pk_fma_f32 v[90:91], v[34:35], v[82:83], v[90:91] op_sel:[1,0,0] op_sel_hi:[1,1,1]
    v_pk_fma_f32 v[92:93], v[34:35], v[84:85], v[92:93] op_sel:[1,0,0] op_sel_hi:[1,1,1]
    v_pk_fma_f32 v[94:95], v[34:35], v[86:87], v[94:95] op_sel:[1,0,0] op_sel_hi:[1,1,1]
    v_lshlrev_b32 v80, 16, v64
    v_and_b32 v81, 0xffff0000, v64
    v_lshlrev_b32 v82, 16, v65
    v_and_b32 v83, 0xffff0000, v65
    v_lshlrev_b32 v84, 16, v66
    v_and_b32 v85, 0xffff0000, v66
    v_lshlrev_b32 v86, 16, v67
    v_and_b32 v87, 0xffff0000, v67
    v_pk_fma_f32 v[88:89], v[36:37], v[80:81], v[88:89] op_sel:[0,0,0] op_sel_hi:[0,1,1]
    v_pk_fma_f32 v[90:91], v[36:37], v[82:83], v[90:91] op_sel:[0,0,0] op_sel_hi:[0,1,1]
    v_pk_fma_f32 v[92:93], v[36:37], v[84:85], v[92:93] op_sel:[0,0,0] op_sel_hi:[0,1,1]
    v_pk_fma_f32 v[94:95], v[36:37], v[86:87], v[94:95] op_sel:[0,0,0] op_sel_hi:[0,1,1]
    v_lshlrev_b32 v80, 16, v68
    v_and_b32 v81, 0xffff0000, v68
    v_lshlrev_b32 v82, 16, v69
    v_and_b32 v83, 0xffff0000, v69
    v_lshlrev_b32 v84, 16, v70
    v_and_b32 v85, 0xffff0000, v70
    v_lshlrev_b32 v86, 16, v71
    v_and_b32 v87, 0xffff0000, v71
    v_pk_fma_f32 v[88:89], v[36:37], v[80:81], v[88:89] op_sel:[1,0,0] op_sel_hi:[1,1,1]
    v_pk_fma_f32 v[90:91], v[36:37], v[82:83], v[90:91] op_sel:[1,0,0] op_sel_hi:[1,1,1]
    v_pk_fma_f32 v[92:93], v[36:37], v[84:85], v[92:93] op_sel:[1,0,0] op_sel_hi:[1,1,1]
    v_pk_fma_f32 v[94:95], v[36:37], v[86:87], v[94:95] op_sel:[1,0,0] op_sel_hi:[1,1,1]
    v_lshlrev_b32 v80, 16, v72
    v_and_b32 v81, 0xffff0000, v72
    v_lshlrev_b32 v82, 16, v73
    v_and_b32 v83, 0xffff0000, v73
    v_lshlrev_b32 v84, 16, v74
    v_and_b32 v85, 0xffff0000, v74
    v_lshlrev_b32 v86, 16, v75
    v_and_b32 v87, 0xffff0000, v75
    v_pk_fma_f32 v[88:89], v[38:39], v[80:81], v[88:89] op_sel:[0,0,0] op_sel_hi:[0,1,1]
    v_pk_fma_f32 v[90:91], v[38:39], v[82:83], v[90:91] op_sel:[0,0,0] op_sel_hi:[0,1,1]
    v_pk_fma_f32 v[92:93], v[38:39], v[84:85], v[92:93] op_sel:[0,0,0] op_sel_hi:[0,1,1]
    v_pk_fma_f32 v[94:95], v[38:39], v[86:87], v[94:95] op_sel:[0,0,0] op_sel_hi:[0,1,1]
    v_lshlrev_b32 v80, 16, v76
    v_and_b32 v81, 0xffff0000, v76
    v_lshlrev_b32 v82, 16, v77
    v_and_b32 v83, 0xffff0000, v77
    v_lshlrev_b32 v84, 16, v78
    v_and_b32 v85, 0xffff0000, v78
    v_lshlrev_b32 v86, 16, v79
    v_and_b32 v87, 0xffff0000, v79
    v_pk_fma_f32 v[88:89], v[38:39], v[80:81], v[88:89] op_sel:[1,0,0] op_sel_hi:[1,1,1]
    v_pk_fma_f32 v[90:91], v[38:39], v[82:83], v[90:91] op_sel:[1,0,0] op_sel_hi:[1,1,1]
    v_pk_fma_f32 v[92:93], v[38:39], v[84:85], v[92:93] op_sel:[1,0,0] op_sel_hi:[1,1,1]
    v_pk_fma_f32 v[94:95], v[38:39], v[86:87], v[94:95] op_sel:[1,0,0] op_sel_hi:[1,1,1]
    s_nop 0
    v_permlane32_swap_b32 v88, v92
    v_permlane32_swap_b32 v89, v93
    v_permlane32_swap_b32 v90, v94
    v_permlane32_swap_b32 v91, v95
    v_add_f32 v88, v88, v92
    v_add_f32 v89, v89, v93
    v_add_f32 v90, v90, v94
    v_add_f32 v91, v91, v95
    s_nop 0
    v_permlane16_swap_b32 v88, v90
    v_permlane16_swap_b32 v89, v91
    v_add_f32 v88, v88, v90
    v_add_f32 v89, v89, v91
    v_and_b32 v81, 7, v1
    v_lshrrev_b32 v82, 3, v1
    v_add_f32_dpp v80, v88, v88 row_ror:8 row_mask:0xf bank_mask:0x3
    s_nop 1
    v_add_f32_dpp v80, v89, v89 row_ror:8 row_mask:0xf bank_mask:0xc
    v_lshl_add_u32 v81, v81, 3, v82
    s_lshl_b32 s7, s3, 8
    s_add_u32 s7, s7, 124928
    v_lshl_add_u32 v81, v81, 2, s7
    ds_write_b32 v81, v80
    s_waitcnt lgkmcnt(0)
    s_barrier
    v_lshlrev_b32 v81, 2, v1
    v_add_u32 v82, 124928, v81
    ds_read_b32 v88, v82 offset:0
    ds_read_b32 v89, v82 offset:256
    ds_read_b32 v90, v82 offset:512
    ds_read_b32 v91, v82 offset:768
    v_add_u32 v81, s44, v81
    s_waitcnt lgkmcnt(2)
    v_add_f32 v88, v88, v89
    s_waitcnt lgkmcnt(0)
    v_add_f32 v90, v90, v91
    v_add_f32 v88, v88, v90
    v_min_u32 v88, -2, v88
    s_cmp_lg_u32 s3, 0
    s_cbranch_scc1 Lmod_skip_s3
    global_store_dword v81, v88, s[38:39] offset:0 sc1
Lmod_skip_s3:
    s_branch Lsp_c
Lsp_a2:
    s_and_b32 s4, s42, 1
    s_lshl_b32 s4, s4, 1
    s_and_b32 s5, s3, 1
    s_add_u32 s44, s4, s5
    s_and_b32 s4, s42, -2
    s_lshr_b32 s5, s3, 1
    s_add_u32 s45, s4, s5
    s_and_b32 s4, s42, 1
    s_lshl_b32 s4, s4, 2
    s_add_u32 s4, s4, s3
    s_mul_i32 s4, s4, 276480
    s_lshr_b32 s5, s42, 1
    s_lshl_b32 s5, s5, 7
    s_add_u32 s4, s4, s5
    v_lshrrev_b32 v28, 3, v1
    v_mul_u32_u24 v28, 3328, v28
    v_add3_u32 v28, v28, v4, s4
    s_mul_i32 s5, s3, 10240
    s_add_u32 m0, s5, 0
    s_nop 0
    global_load_lds_dwordx4 v28, s[22:23] nt
    v_add_u32 v28, 27648, v28
    s_add_u32 m0, s5, 1024
    s_nop 0
    global_load_lds_dwordx4 v28, s[22:23] nt
    v_add_u32 v28, 27648, v28
    s_add_u32 m0, s5, 2048
    s_nop 0
    global_load_lds_dwordx4 v28, s[22:23] nt
    v_add_u32 v28, 27648, v28
    s_add_u32 m0, s5, 3072
    s_nop 0
    global_load_lds_dwordx4 v28, s[22:23] nt
    v_add_u32 v28, 27648, v28
    s_add_u32 m0, s5, 4096
    s_nop 0
    global_load_lds_dwordx4 v28, s[22:23] nt
    v_add_u32 v28, 27648, v28
    s_add_u32 m0, s5, 5120
    s_nop 0
    global_load_lds_dwordx4 v28, s[22:23] nt
    v_add_u32 v28, 27648, v28
    s_add_u32 m0, s5, 6144
    s_nop 0
    global_load_lds_dwordx4 v28, s[22:23] nt
    v_add_u32 v28, 27648, v28
    s_add_u32 m0, s5, 7168
    s_nop 0
    global_load_lds_dwordx4 v28, s[22:23] nt
    v_add_u32 v28, 27648, v28
    s_add_u32 m0, s5, 8192
    s_nop 0
    global_load_lds_dwordx4 v28, s[22:23] nt
    v_add_u32 v28, 27648, v28
    s_add_u32 m0, s5, 9216
    s_nop 0
    global_load_lds_dwordx4 v28, s[22:23] nt
    v_add_u32 v28, 27648, v28
    v_min_u32 v72, 624, v4
    s_mul_i32 s5, s44, 640
    s_add_u32 s5, s5, 7680
    v_add_u32 v73, s5, v72
    s_mul_i32 s5, s3, 1280
    s_add_u32 s5, s5, 124928
    v_add_u32 v72, s5, v72
    v_lshl_add_u32 v74, v3, 5, s5
    s_cmp_ge_u32 s45, 27
    s_cselect_b32 s6, -54, 56
    s_lshl_b32 s7, s45, 1
    s_add_u32 s46, s6, s7
    s_mul_i32 s4, s46, 20480
    s_mul_i32 s5, s44, 5120
    s_add_u32 s4, s4, s5
    s_add_u32 s4, s4, 7342080
    v_add_u32 v75, s4, v4
    v_add_u32 v76, 20480, v75
    s_and_b32 s4, s3, 1
    s_mul_i32 s4, s4, 20480
    s_lshr_b32 s5, s3, 1
    s_lshl_b32 s5, s5, 6
    s_add_u32 s4, s4, s5
    v_lshl_add_u32 v28, v3, 10, s4
    v_lshl_add_u32 v28, v2, 2, v28
    s_cmp_lt_u32 s42, 38
    s_cbranch_scc1 Lwp_n0
    s_add_u32 s48, s42, 46
    s_lshr_b32 s4, s48, 1
    s_and_b32 s5, s48, 1
    s_cmp_lt_u32 s4, 50
    s_cselect_b32 s6, -20, 0
    s_cmp_lt_u32 s4, 20
    s_cselect_b32 s6, 30, s6
    s_add_u32 s4, s4, s6
    s_mul_i32 s6, s5, 15360
    s_lshl_b32 s7, s4, 8
    s_add_u32 s47, s6, s7
    s_lshl_b32 s5, s5, 2
    s_add_u32 s5, s5, s3
    s_mul_i32 s5, s5, 80
    s_lshl_b32 s4, s4, 7
    s_mul_i32 s6, s5, 7680
    s_add_u32 s4, s4, s6
    v_min_u32 v78, 39, v1
    s_lshl_b32 s5, s5, 1
    v_lshl_add_u32 v78, v78, 2, s5
    global_load_dword v132, v78, s[30:31]
    v_lshrrev_b32 v79, 3, v1
    v_mul_u32_u24 v78, 15232, v79
    v_add3_u32 v78, v78, v4, s4
    global_load_dwordx4 v[92:95], v78, s[32:33] nt
    v_add_u32 v78, 7680, v78
    global_load_dwordx4 v[96:99], v78, s[32:33] nt
    v_add_u32 v78, 115200, v78
    global_load_dwordx4 v[100:103], v78, s[32:33] nt
    v_add_u32 v78, 7680, v78
    global_load_dwordx4 v[104:107], v78, s[32:33] nt
    v_add_u32 v78, 115200, v78
    global_load_dwordx4 v[108:111], v78, s[32:33] nt
    v_add_u32 v78, 7680, v78
    global_load_dwordx4 v[112:115], v78, s[32:33] nt
    v_add_u32 v78, 115200, v78
    global_load_dwordx4 v[116:119], v78, s[32:33] nt
    v_add_u32 v78, 7680, v78
    global_load_dwordx4 v[120:123], v78, s[32:33] nt
    v_add_u32 v78, 115200, v78
    global_load_dwordx4 v[124:127], v78, s[32:33] nt
    v_add_u32 v78, 7680, v78
    global_load_dwordx4 v[128:131], v78, s[32:33] nt
    s_waitcnt vmcnt(11)
    s_branch Lwp_n2
Lwp_n0:
    s_cmp_lt_u32 s42, 11
    s_cbranch_scc1 Lwp_n1
    s_sub_u32 s48, s42, 11
    s_mul_i32 s4, s48, 40960
    s_mul_i32 s5, s3, 10240
    s_add_u32 s4, s4, s5
    v_lshl_add_u32 v80, v1, 4, s4
    s_add_u32 m0, s5, 40960
    s_nop 0
    global_load_lds_dwordx4 v80, s[28:29] offset:0 nt
    global_load_lds_dwordx4 v80, s[28:29] offset:1024 nt
    global_load_lds_dwordx4 v80, s[28:29] offset:2048 nt
    global_load_lds_dwordx4 v80, s[28:29] offset:3072 nt
    s_add_u32 m0, s5, 45056
    v_add_u32 v80, 4096, v80
    global_load_lds_dwordx4 v80, s[28:29] offset:0 nt
    global_load_lds_dwordx4 v80, s[28:29] offset:1024 nt
    global_load_lds_dwordx4 v80, s[28:29] offset:2048 nt
    global_load_lds_dwordx4 v80, s[28:29] offset:3072 nt
    s_add_u32 m0, s5, 49152
    v_add_u32 v80, 4096, v80
    global_load_lds_dwordx4 v80, s[28:29] offset:0 nt
    global_load_lds_dwordx4 v80, s[28:29] offset:1024 nt
    s_waitcnt vmcnt(10)
    s_branch Lwp_n2
Lwp_n1:
    s_waitcnt vmcnt(0)
Lwp_n2:
    s_barrier
    ds_read_b32 v32, v28 offset:0
    ds_read_b32 v33, v28 offset:128
    ds_read_b32 v34, v28 offset:256
    ds_read_b32 v35, v28 offset:384
    ds_read_b32 v36, v28 offset:512
    ds_read_b32 v37, v28 offset:640
    ds_read_b32 v38, v28 offset:768
    ds_read_b32 v39, v28 offset:896
    ds_read_b32 v40, v28 offset:4096
    ds_read_b32 v41, v28 offset:4224
    ds_read_b32 v42, v28 offset:4352
    ds_read_b32 v43, v28 offset:4480
    ds_read_b32 v44, v28 offset:4608
    ds_read_b32 v45, v28 offset:4736
    ds_read_b32 v46, v28 offset:4864
    ds_read_b32 v47, v28 offset:4992
    ds_read_b32 v48, v28 offset:8192
    ds_read_b32 v49, v28 offset:8320
    ds_read_b32 v50, v28 offset:8448
    ds_read_b32 v51, v28 offset:8576
    ds_read_b32 v52, v28 offset:8704
    ds_read_b32 v53, v28 offset:8832
    ds_read_b32 v54, v28 offset:8960
    ds_read_b32 v55, v28 offset:9088
    ds_read_b32 v56, v28 offset:12288
    ds_read_b32 v57, v28 offset:12416
    ds_read_b32 v58, v28 offset:12544
    ds_read_b32 v59, v28 offset:12672
    ds_read_b32 v60, v28 offset:12800
    ds_read_b32 v61, v28 offset:12928
    ds_read_b32 v62, v28 offset:13056
    ds_read_b32 v63, v28 offset:13184
    ds_read_b32 v64, v28 offset:16384
    ds_read_b32 v65, v28 offset:16512
    ds_read_b32 v66, v28 offset:16640
    ds_read_b32 v67, v28 offset:16768
    ds_read_b32 v68, v28 offset:16896
    ds_read_b32 v69, v28 offset:17024
    ds_read_b32 v70, v28 offset:17152
    ds_read_b32 v71, v28 offset:17280
    s_waitcnt lgkmcnt(15)
    v_lshlrev_b32 v152, 16, v32
    v_and_b32 v153, 0xffff0000, v32
    v_lshlrev_b32 v154, 16, v33
    v_and_b32 v155, 0xffff0000, v33
    v_lshlrev_b32 v156, 16, v34
    v_and_b32 v157, 0xffff0000, v34
    v_lshlrev_b32 v158, 16, v35
    v_and_b32 v159, 0xffff0000, v35
    v_lshlrev_b32 v160, 16, v36
    v_and_b32 v161, 0xffff0000, v36
    v_lshlrev_b32 v162, 16, v37
    v_and_b32 v163, 0xffff0000, v37
    v_lshlrev_b32 v164, 16, v38
    v_and_b32 v165, 0xffff0000, v38
    v_lshlrev_b32 v166, 16, v39
    v_and_b32 v167, 0xffff0000, v39
    v_lshlrev_b32 v168, 16, v40
    v_and_b32 v169, 0xffff0000, v40
    v_lshlrev_b32 v170, 16, v41
    v_and_b32 v171, 0xffff0000, v41
    v_lshlrev_b32 v172, 16, v42
    v_and_b32 v173, 0xffff0000, v42
    v_lshlrev_b32 v174, 16, v43
    v_and_b32 v175, 0xffff0000, v43
    v_lshlrev_b32 v176, 16, v44
    v_and_b32 v177, 0xffff0000, v44
    v_lshlrev_b32 v178, 16, v45
    v_and_b32 v179, 0xffff0000, v45
    v_lshlrev_b32 v180, 16, v46
    v_and_b32 v181, 0xffff0000, v46
    v_lshlrev_b32 v182, 16, v47
    v_and_b32 v183, 0xffff0000, v47
    v_lshlrev_b32 v184, 16, v48
    v_and_b32 v185, 0xffff0000, v48
    v_lshlrev_b32 v186, 16, v49
    v_and_b32 v187, 0xffff0000, v49
    v_lshlrev_b32 v188, 16, v50
    v_and_b32 v189, 0xffff0000, v50
    v_lshlrev_b32 v190, 16, v51
    v_and_b32 v191, 0xffff0000, v51
    v_lshlrev_b32 v192, 16, v52
    v_and_b32 v193, 0xffff0000, v52
    v_lshlrev_b32 v194, 16, v53
    v_and_b32 v195, 0xffff0000, v53
    v_lshlrev_b32 v196, 16, v54
    v_and_b32 v197, 0xffff0000, v54
    v_lshlrev_b32 v198, 16, v55
    v_and_b32 v199, 0xffff0000, v55
    v_lshlrev_b32 v200, 16, v56
    v_and_b32 v201, 0xffff0000, v56
    s_waitcnt lgkmcnt(14)
    v_lshlrev_b32 v202, 16, v57
    v_and_b32 v203, 0xffff0000, v57
    s_waitcnt lgkmcnt(13)
    v_lshlrev_b32 v204, 16, v58
    v_and_b32 v205, 0xffff0000, v58
    s_waitcnt lgkmcnt(12)
    v_lshlrev_b32 v206, 16, v59
    v_and_b32 v207, 0xffff0000, v59
    s_waitcnt lgkmcnt(11)
    v_lshlrev_b32 v208, 16, v60
    v_and_b32 v209, 0xffff0000, v60
    s_waitcnt lgkmcnt(10)
    v_lshlrev_b32 v210, 16, v61
    v_and_b32 v211, 0xffff0000, v61
    s_waitcnt lgkmcnt(9)
    v_lshlrev_b32 v212, 16, v62
    v_and_b32 v213, 0xffff0000, v62
    s_waitcnt lgkmcnt(8)
    v_lshlrev_b32 v214, 16, v63
    v_and_b32 v215, 0xffff0000, v63
    s_waitcnt lgkmcnt(7)
    v_lshlrev_b32 v216, 16, v64
    v_and_b32 v217, 0xffff0000, v64
    s_waitcnt lgkmcnt(6)
    v_lshlrev_b32 v218, 16, v65
    v_and_b32 v219, 0xffff0000, v65
    s_waitcnt lgkmcnt(5)
    v_lshlrev_b32 v220, 16, v66
    v_and_b32 v221, 0xffff0000, v66
    s_waitcnt lgkmcnt(4)
    v_lshlrev_b32 v222, 16, v67
    v_and_b32 v223, 0xffff0000, v67
    s_waitcnt lgkmcnt(3)
    v_lshlrev_b32 v224, 16, v68
    v_and_b32 v225, 0xffff0000, v68
    s_waitcnt lgkmcnt(2)
    v_lshlrev_b32 v226, 16, v69
    v_and_b32 v227, 0xffff0000, v69
    s_waitcnt lgkmcnt(1)
    v_lshlrev_b32 v228, 16, v70
    v_and_b32 v229, 0xffff0000, v70
    s_waitcnt lgkmcnt(0)
    v_lshlrev_b32 v230, 16, v71
    v_and_b32 v231, 0xffff0000, v71
    s_cmp_lg_u32 s3, 0
    s_cbranch_scc1 Lwic_x
    v_min_u32 v32, 49, v1
    v_add_u32 v32, 56, v32
    v_lshlrev_b32 v32, 1, v32
    s_branch Lwic_f
Lwic:
    s_sleep 4
Lwic_f:
    global_load_ushort v33, v32, s[36:37] sc1
    s_waitcnt vmcnt(0)
    v_cmp_eq_u32 vcc, 0, v33
    s_add_u32 s100, s100, 1
    s_cmp_ge_u32 s100, 262144
    s_cbranch_scc1 Lwic_x
    s_cbranch_vccnz Lwic
Lwic_x:
    s_waitcnt vmcnt(0)
    s_barrier
    s_cmp_lt_u32 s42, 38
    s_cbranch_scc1 Lwp_n3
    v_lshlrev_b32 v134, 16, v132
    v_and_b32 v135, 0xffff0000, v132
    v_lshlrev_b32 v79, 2, v79
    v_mul_f32 v136, 0xbfb8aa3b, v134
    v_mul_f32 v137, 0xbfb8aa3b, v135
    v_exp_f32 v136, v136
    v_exp_f32 v137, v137
    v_add_f32 v136, 1.0, v136
    v_add_f32 v137, 1.0, v137
    v_rcp_f32 v136, v136
    v_rcp_f32 v137, v137
    v_mul_f32 v134, v134, v136
    v_mul_f32 v135, v135, v137
    v_cvt_pk_bf16_f32 v132, v134, v135
    ds_bpermute_b32 v140, v79, v132 offset:0
    ds_bpermute_b32 v141, v79, v132 offset:32
    ds_bpermute_b32 v142, v79, v132 offset:64
    ds_bpermute_b32 v143, v79, v132 offset:96
    ds_bpermute_b32 v144, v79, v132 offset:128
    s_waitcnt lgkmcnt(4)
    v_lshlrev_b32 v80, 16, v140
    v_and_b32 v81, 0xffff0000, v140
    s_waitcnt lgkmcnt(3)
    v_lshlrev_b32 v82, 16, v141
    v_and_b32 v83, 0xffff0000, v141
    s_waitcnt lgkmcnt(2)
    v_lshlrev_b32 v84, 16, v142
    v_and_b32 v85, 0xffff0000, v142
    s_waitcnt lgkmcnt(1)
    v_lshlrev_b32 v86, 16, v143
    v_and_b32 v87, 0xffff0000, v143
    s_waitcnt lgkmcnt(0)
    v_lshlrev_b32 v88, 16, v144
    v_and_b32 v89, 0xffff0000, v144
    v_lshlrev_b32 v132, 16, v92
    v_and_b32 v133, 0xffff0000, v92
    v_lshlrev_b32 v134, 16, v93
    v_and_b32 v135, 0xffff0000, v93
    v_lshlrev_b32 v136, 16, v94
    v_and_b32 v137, 0xffff0000, v94
    v_lshlrev_b32 v138, 16, v95
    v_and_b32 v139, 0xffff0000, v95
    v_pk_mul_f32 v[140:141], v[80:81], v[132:133] op_sel:[0,0] op_sel_hi:[0,1]
    v_pk_mul_f32 v[142:143], v[80:81], v[134:135] op_sel:[0,0] op_sel_hi:[0,1]
    v_pk_mul_f32 v[144:145], v[80:81], v[136:137] op_sel:[0,0] op_sel_hi:[0,1]
    v_pk_mul_f32 v[146:147], v[80:81], v[138:139] op_sel:[0,0] op_sel_hi:[0,1]
    v_lshlrev_b32 v132, 16, v96
    v_and_b32 v133, 0xffff0000, v96
    v_lshlrev_b32 v134, 16, v97
    v_and_b32 v135, 0xffff0000, v97
    v_lshlrev_b32 v136, 16, v98
    v_and_b32 v137, 0xffff0000, v98
    v_lshlrev_b32 v138, 16, v99
    v_and_b32 v139, 0xffff0000, v99
    v_pk_fma_f32 v[140:141], v[80:81], v[132:133], v[140:141] op_sel:[1,0,0] op_sel_hi:[1,1,1]
    v_pk_fma_f32 v[142:143], v[80:81], v[134:135], v[142:143] op_sel:[1,0,0] op_sel_hi:[1,1,1]
    v_pk_fma_f32 v[144:145], v[80:81], v[136:137], v[144:145] op_sel:[1,0,0] op_sel_hi:[1,1,1]
    v_pk_fma_f32 v[146:147], v[80:81], v[138:139], v[146:147] op_sel:[1,0,0] op_sel_hi:[1,1,1]
    v_lshlrev_b32 v132, 16, v100
    v_and_b32 v133, 0xffff0000, v100
    v_lshlrev_b32 v134, 16, v101
    v_and_b32 v135, 0xffff0000, v101
    v_lshlrev_b32 v136, 16, v102
    v_and_b32 v137, 0xffff0000, v102
    v_lshlrev_b32 v138, 16, v103
    v_and_b32 v139, 0xffff0000, v103
    v_pk_fma_f32 v[140:141], v[82:83], v[132:133], v[140:141] op_sel:[0,0,0] op_sel_hi:[0,1,1]
    v_pk_fma_f32 v[142:143], v[82:83], v[134:135], v[142:143] op_sel:[0,0,0] op_sel_hi:[0,1,1]
    v_pk_fma_f32 v[144:145], v[82:83], v[136:137], v[144:145] op_sel:[0,0,0] op_sel_hi:[0,1,1]
    v_pk_fma_f32 v[146:147], v[82:83], v[138:139], v[146:147] op_sel:[0,0,0] op_sel_hi:[0,1,1]
    v_lshlrev_b32 v132, 16, v104
    v_and_b32 v133, 0xffff0000, v104
    v_lshlrev_b32 v134, 16, v105
    v_and_b32 v135, 0xffff0000, v105
    v_lshlrev_b32 v136, 16, v106
    v_and_b32 v137, 0xffff0000, v106
    v_lshlrev_b32 v138, 16, v107
    v_and_b32 v139, 0xffff0000, v107
    v_pk_fma_f32 v[140:141], v[82:83], v[132:133], v[140:141] op_sel:[1,0,0] op_sel_hi:[1,1,1]
    v_pk_fma_f32 v[142:143], v[82:83], v[134:135], v[142:143] op_sel:[1,0,0] op_sel_hi:[1,1,1]
    v_pk_fma_f32 v[144:145], v[82:83], v[136:137], v[144:145] op_sel:[1,0,0] op_sel_hi:[1,1,1]
    v_pk_fma_f32 v[146:147], v[82:83], v[138:139], v[146:147] op_sel:[1,0,0] op_sel_hi:[1,1,1]
    v_lshlrev_b32 v132, 16, v108
    v_and_b32 v133, 0xffff0000, v108
    v_lshlrev_b32 v134, 16, v109
    v_and_b32 v135, 0xffff0000, v109
    v_lshlrev_b32 v136, 16, v110
    v_and_b32 v137, 0xffff0000, v110
    v_lshlrev_b32 v138, 16, v111
    v_and_b32 v139, 0xffff0000, v111
    v_pk_fma_f32 v[140:141], v[84:85], v[132:133], v[140:141] op_sel:[0,0,0] op_sel_hi:[0,1,1]
    v_pk_fma_f32 v[142:143], v[84:85], v[134:135], v[142:143] op_sel:[0,0,0] op_sel_hi:[0,1,1]
    v_pk_fma_f32 v[144:145], v[84:85], v[136:137], v[144:145] op_sel:[0,0,0] op_sel_hi:[0,1,1]
    v_pk_fma_f32 v[146:147], v[84:85], v[138:139], v[146:147] op_sel:[0,0,0] op_sel_hi:[0,1,1]
    v_lshlrev_b32 v132, 16, v112
    v_and_b32 v133, 0xffff0000, v112
    v_lshlrev_b32 v134, 16, v113
    v_and_b32 v135, 0xffff0000, v113
    v_lshlrev_b32 v136, 16, v114
    v_and_b32 v137, 0xffff0000, v114
    v_lshlrev_b32 v138, 16, v115
    v_and_b32 v139, 0xffff0000, v115
    v_pk_fma_f32 v[140:141], v[84:85], v[132:133], v[140:141] op_sel:[1,0,0] op_sel_hi:[1,1,1]
    v_pk_fma_f32 v[142:143], v[84:85], v[134:135], v[142:143] op_sel:[1,0,0] op_sel_hi:[1,1,1]
    v_pk_fma_f32 v[144:145], v[84:85], v[136:137], v[144:145] op_sel:[1,0,0] op_sel_hi:[1,1,1]
    v_pk_fma_f32 v[146:147], v[84:85], v[138:139], v[146:147] op_sel:[1,0,0] op_sel_hi:[1,1,1]
    v_lshlrev_b32 v132, 16, v116
    v_and_b32 v133, 0xffff0000, v116
    v_lshlrev_b32 v134, 16, v117
    v_and_b32 v135, 0xffff0000, v117
    v_lshlrev_b32 v136, 16, v118
    v_and_b32 v137, 0xffff0000, v118
    v_lshlrev_b32 v138, 16, v119
    v_and_b32 v139, 0xffff0000, v119
    v_pk_fma_f32 v[140:141], v[86:87], v[132:133], v[140:141] op_sel:[0,0,0] op_sel_hi:[0,1,1]
    v_pk_fma_f32 v[142:143], v[86:87], v[134:135], v[142:143] op_sel:[0,0,0] op_sel_hi:[0,1,1]
    v_pk_fma_f32 v[144:145], v[86:87], v[136:137], v[144:145] op_sel:[0,0,0] op_sel_hi:[0,1,1]
    v_pk_fma_f32 v[146:147], v[86:87], v[138:139], v[146:147] op_sel:[0,0,0] op_sel_hi:[0,1,1]
    v_lshlrev_b32 v132, 16, v120
    v_and_b32 v133, 0xffff0000, v120
    v_lshlrev_b32 v134, 16, v121
    v_and_b32 v135, 0xffff0000, v121
    v_lshlrev_b32 v136, 16, v122
    v_and_b32 v137, 0xffff0000, v122
    v_lshlrev_b32 v138, 16, v123
    v_and_b32 v139, 0xffff0000, v123
    v_pk_fma_f32 v[140:141], v[86:87], v[132:133], v[140:141] op_sel:[1,0,0] op_sel_hi:[1,1,1]
    v_pk_fma_f32 v[142:143], v[86:87], v[134:135], v[142:143] op_sel:[1,0,0] op_sel_hi:[1,1,1]
    v_pk_fma_f32 v[144:145], v[86:87], v[136:137], v[144:145] op_sel:[1,0,0] op_sel_hi:[1,1,1]
    v_pk_fma_f32 v[146:147], v[86:87], v[138:139], v[146:147] op_sel:[1,0,0] op_sel_hi:[1,1,1]
    v_lshlrev_b32 v132, 16, v124
    v_and_b32 v133, 0xffff0000, v124
    v_lshlrev_b32 v134, 16, v125
    v_and_b32 v135, 0xffff0000, v125
    v_lshlrev_b32 v136, 16, v126
    v_and_b32 v137, 0xffff0000, v126
    v_lshlrev_b32 v138, 16, v127
    v_and_b32 v139, 0xffff0000, v127
    v_pk_fma_f32 v[140:141], v[88:89], v[132:133], v[140:141] op_sel:[0,0,0] op_sel_hi:[0,1,1]
    v_pk_fma_f32 v[142:143], v[88:89], v[134:135], v[142:143] op_sel:[0,0,0] op_sel_hi:[0,1,1]
    v_pk_fma_f32 v[144:145], v[88:89], v[136:137], v[144:145] op_sel:[0,0,0] op_sel_hi:[0,1,1]
    v_pk_fma_f32 v[146:147], v[88:89], v[138:139], v[146:147] op_sel:[0,0,0] op_sel_hi:[0,1,1]
    v_lshlrev_b32 v132, 16, v128
    v_and_b32 v133, 0xffff0000, v128
    v_lshlrev_b32 v134, 16, v129
    v_and_b32 v135, 0xffff0000, v129
    v_lshlrev_b32 v136, 16, v130
    v_and_b32 v137, 0xffff0000, v130
    v_lshlrev_b32 v138, 16, v131
    v_and_b32 v139, 0xffff0000, v131
    v_pk_fma_f32 v[140:141], v[88:89], v[132:133], v[140:141] op_sel:[1,0,0] op_sel_hi:[1,1,1]
    v_pk_fma_f32 v[142:143], v[88:89], v[134:135], v[142:143] op_sel:[1,0,0] op_sel_hi:[1,1,1]
    v_pk_fma_f32 v[144:145], v[88:89], v[136:137], v[144:145] op_sel:[1,0,0] op_sel_hi:[1,1,1]
    v_pk_fma_f32 v[146:147], v[88:89], v[138:139], v[146:147] op_sel:[1,0,0] op_sel_hi:[1,1,1]
    s_nop 0
    v_permlane32_swap_b32 v140, v144
    v_permlane32_swap_b32 v141, v145
    v_permlane32_swap_b32 v142, v146
    v_permlane32_swap_b32 v143, v147
    v_add_f32 v140, v140, v144
    v_add_f32 v141, v141, v145
    v_add_f32 v142, v142, v146
    v_add_f32 v143, v143, v147
    s_nop 0
    v_permlane16_swap_b32 v140, v142
    v_permlane16_swap_b32 v141, v143
    v_add_f32 v140, v140, v142
    v_add_f32 v141, v141, v143
    v_and_b32 v133, 7, v1
    v_lshrrev_b32 v134, 3, v1
    v_add_f32_dpp v132, v140, v140 row_ror:8 row_mask:0xf bank_mask:0x3
    s_nop 1
    v_add_f32_dpp v132, v141, v141 row_ror:8 row_mask:0xf bank_mask:0xc
    v_lshl_add_u32 v133, v133, 3, v134
    s_lshl_b32 s7, s3, 8
    s_add_u32 s7, s7, 122880
    v_lshl_add_u32 v133, v133, 2, s7
    ds_write_b32 v133, v132
    s_waitcnt lgkmcnt(0)
    s_barrier
    v_lshlrev_b32 v133, 2, v1
    v_add_u32 v134, 122880, v133
    ds_read_b32 v140, v134 offset:0
    ds_read_b32 v141, v134 offset:256
    ds_read_b32 v142, v134 offset:512
    ds_read_b32 v143, v134 offset:768
    v_add_u32 v133, s47, v133
    s_waitcnt lgkmcnt(2)
    v_add_f32 v140, v140, v141
    s_waitcnt lgkmcnt(0)
    v_add_f32 v142, v142, v143
    v_add_f32 v140, v140, v142
    v_min_u32 v140, -2, v140
    s_cmp_lg_u32 s3, 0
    s_cbranch_scc1 Lmod_skip_w
    global_store_dword v133, v140, s[38:39] offset:0 sc1
Lmod_skip_w:
Lwp_n3:
    s_branch Lwm_f
Lwm:
    s_sleep 2
Lwm_f:
    v_add_u32 v77, 0, v73
    global_load_dwordx4 v[80:83], v77, s[38:39] sc1
    global_load_dwordx4 v[84:87], v77, s[38:39] offset:2560 sc1
    v_add_u32 v77, 15360, v73
    global_load_dwordx4 v[88:91], v77, s[38:39] sc1
    global_load_dwordx4 v[92:95], v77, s[38:39] offset:2560 sc1
    s_waitcnt vmcnt(0)
    v_max_u32 v77, v80, v81
    v_max3_u32 v77, v82, v83, v77
    v_max3_u32 v77, v84, v85, v77
    v_max3_u32 v77, v86, v87, v77
    v_max3_u32 v77, v88, v89, v77
    v_max3_u32 v77, v90, v91, v77
    v_max3_u32 v77, v92, v93, v77
    v_max3_u32 v77, v94, v95, v77
    v_cmp_eq_u32 vcc, -1, v77
    s_add_u32 s100, s100, 1
    s_cmp_ge_u32 s100, 262144
    s_cbranch_scc1 Lwm_x
    s_cbranch_vccnz Lwm
Lwm_x:
    v_pk_add_f32 v[80:81], v[80:81], v[88:89] op_sel:[0,0] op_sel_hi:[1,1]
    v_pk_add_f32 v[82:83], v[82:83], v[90:91] op_sel:[0,0] op_sel_hi:[1,1]
    v_pk_add_f32 v[84:85], v[84:85], v[92:93] op_sel:[0,0] op_sel_hi:[1,1]
    v_pk_add_f32 v[86:87], v[86:87], v[94:95] op_sel:[0,0] op_sel_hi:[1,1]
    v_cvt_pk_bf16_f32 v80, v80, v80
    v_lshlrev_b32 v80, 16, v80
    v_cvt_pk_bf16_f32 v81, v81, v81
    v_lshlrev_b32 v81, 16, v81
    v_cvt_pk_bf16_f32 v82, v82, v82
    v_lshlrev_b32 v82, 16, v82
    v_cvt_pk_bf16_f32 v83, v83, v83
    v_lshlrev_b32 v83, 16, v83
    v_cvt_pk_bf16_f32 v84, v84, v84
    v_lshlrev_b32 v84, 16, v84
    v_cvt_pk_bf16_f32 v85, v85, v85
    v_lshlrev_b32 v85, 16, v85
    v_cvt_pk_bf16_f32 v86, v86, v86
    v_lshlrev_b32 v86, 16, v86
    v_cvt_pk_bf16_f32 v87, v87, v87
    v_lshlrev_b32 v87, 16, v87
    v_add_f32 v84, 1.0, v84
    v_add_f32 v85, 1.0, v85
    v_add_f32 v86, 1.0, v86
    v_add_f32 v87, 1.0, v87
    v_cvt_pk_bf16_f32 v84, v84, v84
    v_lshlrev_b32 v84, 16, v84
    v_cvt_pk_bf16_f32 v85, v85, v85
    v_lshlrev_b32 v85, 16, v85
    v_cvt_pk_bf16_f32 v86, v86, v86
    v_lshlrev_b32 v86, 16, v86
    v_cvt_pk_bf16_f32 v87, v87, v87
    v_lshlrev_b32 v87, 16, v87
    ds_write_b128 v72, v[84:87]
    ds_write_b128 v72, v[80:83] offset:640
    ds_read_b128 v[32:35], v74 offset:0
    ds_read_b128 v[36:39], v74 offset:16
    ds_read_b128 v[40:43], v74 offset:128
    ds_read_b128 v[44:47], v74 offset:144
    ds_read_b128 v[48:51], v74 offset:256
    ds_read_b128 v[52:55], v74 offset:272
    ds_read_b128 v[56:59], v74 offset:384
    ds_read_b128 v[60:63], v74 offset:400
    ds_read_b128 v[64:67], v74 offset:512
    ds_read_b128 v[68:71], v74 offset:528
    s_waitcnt lgkmcnt(9)
    v_pk_mul_f32 v[96:97], v[32:33], v[152:153] op_sel:[0,0] op_sel_hi:[0,1]
    v_pk_mul_f32 v[98:99], v[32:33], v[154:155] op_sel:[1,0] op_sel_hi:[1,1]
    v_pk_mul_f32 v[100:101], v[34:35], v[156:157] op_sel:[0,0] op_sel_hi:[0,1]
    v_pk_mul_f32 v[102:103], v[34:35], v[158:159] op_sel:[1,0] op_sel_hi:[1,1]
    s_waitcnt lgkmcnt(8)
    v_pk_mul_f32 v[104:105], v[36:37], v[160:161] op_sel:[0,0] op_sel_hi:[0,1]
    v_pk_mul_f32 v[106:107], v[36:37], v[162:163] op_sel:[1,0] op_sel_hi:[1,1]
    v_pk_mul_f32 v[108:109], v[38:39], v[164:165] op_sel:[0,0] op_sel_hi:[0,1]
    v_pk_mul_f32 v[110:111], v[38:39], v[166:167] op_sel:[1,0] op_sel_hi:[1,1]
    v_cvt_pk_bf16_f32 v112, v96, v98
    v_cvt_pk_bf16_f32 v113, v100, v102
    v_cvt_pk_bf16_f32 v114, v104, v106
    v_cvt_pk_bf16_f32 v115, v108, v110
    v_cvt_pk_bf16_f32 v116, v97, v99
    v_cvt_pk_bf16_f32 v117, v101, v103
    v_cvt_pk_bf16_f32 v118, v105, v107
    v_cvt_pk_bf16_f32 v119, v109, v111
    global_store_dwordx4 v75, v[112:115], s[38:39] offset:-2048 sc1
    global_store_dwordx4 v76, v[116:119], s[38:39] offset:-2048 sc1
    s_waitcnt lgkmcnt(7)
    v_pk_mul_f32 v[96:97], v[40:41], v[168:169] op_sel:[0,0] op_sel_hi:[0,1]
    v_pk_mul_f32 v[98:99], v[40:41], v[170:171] op_sel:[1,0] op_sel_hi:[1,1]
    v_pk_mul_f32 v[100:101], v[42:43], v[172:173] op_sel:[0,0] op_sel_hi:[0,1]
    v_pk_mul_f32 v[102:103], v[42:43], v[174:175] op_sel:[1,0] op_sel_hi:[1,1]
    s_waitcnt lgkmcnt(6)
    v_pk_mul_f32 v[104:105], v[44:45], v[176:177] op_sel:[0,0] op_sel_hi:[0,1]
    v_pk_mul_f32 v[106:107], v[44:45], v[178:179] op_sel:[1,0] op_sel_hi:[1,1]
    v_pk_mul_f32 v[108:109], v[46:47], v[180:181] op_sel:[0,0] op_sel_hi:[0,1]
    v_pk_mul_f32 v[110:111], v[46:47], v[182:183] op_sel:[1,0] op_sel_hi:[1,1]
    v_cvt_pk_bf16_f32 v120, v96, v98
    v_cvt_pk_bf16_f32 v121, v100, v102
    v_cvt_pk_bf16_f32 v122, v104, v106
    v_cvt_pk_bf16_f32 v123, v108, v110
    v_cvt_pk_bf16_f32 v124, v97, v99
    v_cvt_pk_bf16_f32 v125, v101, v103
    v_cvt_pk_bf16_f32 v126, v105, v107
    v_cvt_pk_bf16_f32 v127, v109, v111
    global_store_dwordx4 v75, v[120:123], s[38:39] offset:-1024 sc1
    global_store_dwordx4 v76, v[124:127], s[38:39] offset:-1024 sc1
    s_waitcnt lgkmcnt(5)
    v_pk_mul_f32 v[96:97], v[48:49], v[184:185] op_sel:[0,0] op_sel_hi:[0,1]
    v_pk_mul_f32 v[98:99], v[48:49], v[186:187] op_sel:[1,0] op_sel_hi:[1,1]
    v_pk_mul_f32 v[100:101], v[50:51], v[188:189] op_sel:[0,0] op_sel_hi:[0,1]
    v_pk_mul_f32 v[102:103], v[50:51], v[190:191] op_sel:[1,0] op_sel_hi:[1,1]
    s_waitcnt lgkmcnt(4)
    v_pk_mul_f32 v[104:105], v[52:53], v[192:193] op_sel:[0,0] op_sel_hi:[0,1]
    v_pk_mul_f32 v[106:107], v[52:53], v[194:195] op_sel:[1,0] op_sel_hi:[1,1]
    v_pk_mul_f32 v[108:109], v[54:55], v[196:197] op_sel:[0,0] op_sel_hi:[0,1]
    v_pk_mul_f32 v[110:111], v[54:55], v[198:199] op_sel:[1,0] op_sel_hi:[1,1]
    v_cvt_pk_bf16_f32 v128, v96, v98
    v_cvt_pk_bf16_f32 v129, v100, v102
    v_cvt_pk_bf16_f32 v130, v104, v106
    v_cvt_pk_bf16_f32 v131, v108, v110
    v_cvt_pk_bf16_f32 v132, v97, v99
    v_cvt_pk_bf16_f32 v133, v101, v103
    v_cvt_pk_bf16_f32 v134, v105, v107
    v_cvt_pk_bf16_f32 v135, v109, v111
    global_store_dwordx4 v75, v[128:131], s[38:39] offset:0 sc1
    global_store_dwordx4 v76, v[132:135], s[38:39] offset:0 sc1
    s_waitcnt lgkmcnt(3)
    v_pk_mul_f32 v[96:97], v[56:57], v[200:201] op_sel:[0,0] op_sel_hi:[0,1]
    v_pk_mul_f32 v[98:99], v[56:57], v[202:203] op_sel:[1,0] op_sel_hi:[1,1]
    v_pk_mul_f32 v[100:101], v[58:59], v[204:205] op_sel:[0,0] op_sel_hi:[0,1]
    v_pk_mul_f32 v[102:103], v[58:59], v[206:207] op_sel:[1,0] op_sel_hi:[1,1]
    s_waitcnt lgkmcnt(2)
    v_pk_mul_f32 v[104:105], v[60:61], v[208:209] op_sel:[0,0] op_sel_hi:[0,1]
    v_pk_mul_f32 v[106:107], v[60:61], v[210:211] op_sel:[1,0] op_sel_hi:[1,1]
    v_pk_mul_f32 v[108:109], v[62:63], v[212:213] op_sel:[0,0] op_sel_hi:[0,1]
    v_pk_mul_f32 v[110:111], v[62:63], v[214:215] op_sel:[1,0] op_sel_hi:[1,1]
    v_cvt_pk_bf16_f32 v136, v96, v98
    v_cvt_pk_bf16_f32 v137, v100, v102
    v_cvt_pk_bf16_f32 v138, v104, v106
    v_cvt_pk_bf16_f32 v139, v108, v110
    v_cvt_pk_bf16_f32 v140, v97, v99
    v_cvt_pk_bf16_f32 v141, v101, v103
    v_cvt_pk_bf16_f32 v142, v105, v107
    v_cvt_pk_bf16_f32 v143, v109, v111
    global_store_dwordx4 v75, v[136:139], s[38:39] offset:1024 sc1
    global_store_dwordx4 v76, v[140:143], s[38:39] offset:1024 sc1
    s_waitcnt lgkmcnt(1)
    v_pk_mul_f32 v[96:97], v[64:65], v[216:217] op_sel:[0,0] op_sel_hi:[0,1]
    v_pk_mul_f32 v[98:99], v[64:65], v[218:219] op_sel:[1,0] op_sel_hi:[1,1]
    v_pk_mul_f32 v[100:101], v[66:67], v[220:221] op_sel:[0,0] op_sel_hi:[0,1]
    v_pk_mul_f32 v[102:103], v[66:67], v[222:223] op_sel:[1,0] op_sel_hi:[1,1]
    s_waitcnt lgkmcnt(0)
    v_pk_mul_f32 v[104:105], v[68:69], v[224:225] op_sel:[0,0] op_sel_hi:[0,1]
    v_pk_mul_f32 v[106:107], v[68:69], v[226:227] op_sel:[1,0] op_sel_hi:[1,1]
    v_pk_mul_f32 v[108:109], v[70:71], v[228:229] op_sel:[0,0] op_sel_hi:[0,1]
    v_pk_mul_f32 v[110:111], v[70:71], v[230:231] op_sel:[1,0] op_sel_hi:[1,1]
    v_cvt_pk_bf16_f32 v144, v96, v98
    v_cvt_pk_bf16_f32 v145, v100, v102
    v_cvt_pk_bf16_f32 v146, v104, v106
    v_cvt_pk_bf16_f32 v147, v108, v110
    v_cvt_pk_bf16_f32 v148, v97, v99
    v_cvt_pk_bf16_f32 v149, v101, v103
    v_cvt_pk_bf16_f32 v150, v105, v107
    v_cvt_pk_bf16_f32 v151, v109, v111
    global_store_dwordx4 v75, v[144:147], s[38:39] offset:2048 sc1
    global_store_dwordx4 v76, v[148:151], s[38:39] offset:2048 sc1
    ds_read_b128 v[32:35], v74 offset:640
    ds_read_b128 v[36:39], v74 offset:656
    ds_read_b128 v[40:43], v74 offset:768
    ds_read_b128 v[44:47], v74 offset:784
    ds_read_b128 v[48:51], v74 offset:896
    ds_read_b128 v[52:55], v74 offset:912
    ds_read_b128 v[56:59], v74 offset:1024
    ds_read_b128 v[60:63], v74 offset:1040
    ds_read_b128 v[64:67], v74 offset:1152
    ds_read_b128 v[68:71], v74 offset:1168
    s_mov_b32 s7, 0x3f803f80
    v_mov_b32 v88, 0
    v_mov_b32 v89, 0
    v_mov_b32 v90, 0
    v_mov_b32 v91, 0
    v_mov_b32 v92, 0
    v_mov_b32 v93, 0
    v_mov_b32 v94, 0
    v_mov_b32 v95, 0
    v_dot2_f32_bf16 v88, v112, s7, v88
    v_dot2_f32_bf16 v89, v116, s7, v89
    v_dot2_f32_bf16 v88, v113, s7, v88
    v_dot2_f32_bf16 v89, v117, s7, v89
    v_dot2_f32_bf16 v88, v114, s7, v88
    v_dot2_f32_bf16 v89, v118, s7, v89
    v_dot2_f32_bf16 v88, v115, s7, v88
    v_dot2_f32_bf16 v89, v119, s7, v89
    v_dot2_f32_bf16 v88, v120, s7, v88
    v_dot2_f32_bf16 v89, v124, s7, v89
    v_dot2_f32_bf16 v88, v121, s7, v88
    v_dot2_f32_bf16 v89, v125, s7, v89
    v_dot2_f32_bf16 v88, v122, s7, v88
    v_dot2_f32_bf16 v89, v126, s7, v89
    v_dot2_f32_bf16 v88, v123, s7, v88
    v_dot2_f32_bf16 v89, v127, s7, v89
    v_dot2_f32_bf16 v88, v128, s7, v88
    v_dot2_f32_bf16 v89, v132, s7, v89
    v_dot2_f32_bf16 v88, v129, s7, v88
    v_dot2_f32_bf16 v89, v133, s7, v89
    v_dot2_f32_bf16 v88, v130, s7, v88
    v_dot2_f32_bf16 v89, v134, s7, v89
    v_dot2_f32_bf16 v88, v131, s7, v88
    v_dot2_f32_bf16 v89, v135, s7, v89
    v_dot2_f32_bf16 v88, v136, s7, v88
    v_dot2_f32_bf16 v89, v140, s7, v89
    v_dot2_f32_bf16 v88, v137, s7, v88
    v_dot2_f32_bf16 v89, v141, s7, v89
    v_dot2_f32_bf16 v88, v138, s7, v88
    v_dot2_f32_bf16 v89, v142, s7, v89
    v_dot2_f32_bf16 v88, v139, s7, v88
    v_dot2_f32_bf16 v89, v143, s7, v89
    v_dot2_f32_bf16 v88, v144, s7, v88
    v_dot2_f32_bf16 v89, v148, s7, v89
    v_dot2_f32_bf16 v88, v145, s7, v88
    v_dot2_f32_bf16 v89, v149, s7, v89
    v_dot2_f32_bf16 v88, v146, s7, v88
    v_dot2_f32_bf16 v89, v150, s7, v89
    v_dot2_f32_bf16 v88, v147, s7, v88
    v_dot2_f32_bf16 v89, v151, s7, v89
    s_waitcnt lgkmcnt(9)
    v_pk_fma_f32 v[90:91], v[32:33], v[152:153], v[90:91] op_sel:[0,0,0] op_sel_hi:[0,1,1]
    v_pk_fma_f32 v[92:93], v[32:33], v[154:155], v[92:93] op_sel:[1,0,0] op_sel_hi:[1,1,1]
    v_pk_fma_f32 v[94:95], v[34:35], v[156:157], v[94:95] op_sel:[0,0,0] op_sel_hi:[0,1,1]
    v_pk_fma_f32 v[90:91], v[34:35], v[158:159], v[90:91] op_sel:[1,0,0] op_sel_hi:[1,1,1]
    s_waitcnt lgkmcnt(8)
    v_pk_fma_f32 v[92:93], v[36:37], v[160:161], v[92:93] op_sel:[0,0,0] op_sel_hi:[0,1,1]
    v_pk_fma_f32 v[94:95], v[36:37], v[162:163], v[94:95] op_sel:[1,0,0] op_sel_hi:[1,1,1]
    v_pk_fma_f32 v[90:91], v[38:39], v[164:165], v[90:91] op_sel:[0,0,0] op_sel_hi:[0,1,1]
    v_pk_fma_f32 v[92:93], v[38:39], v[166:167], v[92:93] op_sel:[1,0,0] op_sel_hi:[1,1,1]
    s_waitcnt lgkmcnt(7)
    v_pk_fma_f32 v[94:95], v[40:41], v[168:169], v[94:95] op_sel:[0,0,0] op_sel_hi:[0,1,1]
    v_pk_fma_f32 v[90:91], v[40:41], v[170:171], v[90:91] op_sel:[1,0,0] op_sel_hi:[1,1,1]
    v_pk_fma_f32 v[92:93], v[42:43], v[172:173], v[92:93] op_sel:[0,0,0] op_sel_hi:[0,1,1]
    v_pk_fma_f32 v[94:95], v[42:43], v[174:175], v[94:95] op_sel:[1,0,0] op_sel_hi:[1,1,1]
    s_waitcnt lgkmcnt(6)
    v_pk_fma_f32 v[90:91], v[44:45], v[176:177], v[90:91] op_sel:[0,0,0] op_sel_hi:[0,1,1]
    v_pk_fma_f32 v[92:93], v[44:45], v[178:179], v[92:93] op_sel:[1,0,0] op_sel_hi:[1,1,1]
    v_pk_fma_f32 v[94:95], v[46:47], v[180:181], v[94:95] op_sel:[0,0,0] op_sel_hi:[0,1,1]
    v_pk_fma_f32 v[90:91], v[46:47], v[182:183], v[90:91] op_sel:[1,0,0] op_sel_hi:[1,1,1]
    s_waitcnt lgkmcnt(5)
    v_pk_fma_f32 v[92:93], v[48:49], v[184:185], v[92:93] op_sel:[0,0,0] op_sel_hi:[0,1,1]
    v_pk_fma_f32 v[94:95], v[48:49], v[186:187], v[94:95] op_sel:[1,0,0] op_sel_hi:[1,1,1]
    v_pk_fma_f32 v[90:91], v[50:51], v[188:189], v[90:91] op_sel:[0,0,0] op_sel_hi:[0,1,1]
    v_pk_fma_f32 v[92:93], v[50:51], v[190:191], v[92:93] op_sel:[1,0,0] op_sel_hi:[1,1,1]
    s_waitcnt lgkmcnt(4)
    v_pk_fma_f32 v[94:95], v[52:53], v[192:193], v[94:95] op_sel:[0,0,0] op_sel_hi:[0,1,1]
    v_pk_fma_f32 v[90:91], v[52:53], v[194:195], v[90:91] op_sel:[1,0,0] op_sel_hi:[1,1,1]
    v_pk_fma_f32 v[92:93], v[54:55], v[196:197], v[92:93] op_sel:[0,0,0] op_sel_hi:[0,1,1]
    v_pk_fma_f32 v[94:95], v[54:55], v[198:199], v[94:95] op_sel:[1,0,0] op_sel_hi:[1,1,1]
    s_waitcnt lgkmcnt(3)
    v_pk_fma_f32 v[90:91], v[56:57], v[200:201], v[90:91] op_sel:[0,0,0] op_sel_hi:[0,1,1]
    v_pk_fma_f32 v[92:93], v[56:57], v[202:203], v[92:93] op_sel:[1,0,0] op_sel_hi:[1,1,1]
    v_pk_fma_f32 v[94:95], v[58:59], v[204:205], v[94:95] op_sel:[0,0,0] op_sel_hi:[0,1,1]
    v_pk_fma_f32 v[90:91], v[58:59], v[206:207], v[90:91] op_sel:[1,0,0] op_sel_hi:[1,1,1]
    s_waitcnt lgkmcnt(2)
    v_pk_fma_f32 v[92:93], v[60:61], v[208:209], v[92:93] op_sel:[0,0,0] op_sel_hi:[0,1,1]
    v_pk_fma_f32 v[94:95], v[60:61], v[210:211], v[94:95] op_sel:[1,0,0] op_sel_hi:[1,1,1]
    v_pk_fma_f32 v[90:91], v[62:63], v[212:213], v[90:91] op_sel:[0,0,0] op_sel_hi:[0,1,1]
    v_pk_fma_f32 v[92:93], v[62:63], v[214:215], v[92:93] op_sel:[1,0,0] op_sel_hi:[1,1,1]
    s_waitcnt lgkmcnt(1)
    v_pk_fma_f32 v[94:95], v[64:65], v[216:217], v[94:95] op_sel:[0,0,0] op_sel_hi:[0,1,1]
    v_pk_fma_f32 v[90:91], v[64:65], v[218:219], v[90:91] op_sel:[1,0,0] op_sel_hi:[1,1,1]
    v_pk_fma_f32 v[92:93], v[66:67], v[220:221], v[92:93] op_sel:[0,0,0] op_sel_hi:[0,1,1]
    v_pk_fma_f32 v[94:95], v[66:67], v[222:223], v[94:95] op_sel:[1,0,0] op_sel_hi:[1,1,1]
    s_waitcnt lgkmcnt(0)
    v_pk_fma_f32 v[90:91], v[68:69], v[224:225], v[90:91] op_sel:[0,0,0] op_sel_hi:[0,1,1]
    v_pk_fma_f32 v[92:93], v[68:69], v[226:227], v[92:93] op_sel:[1,0,0] op_sel_hi:[1,1,1]
    v_pk_fma_f32 v[94:95], v[70:71], v[228:229], v[94:95] op_sel:[0,0,0] op_sel_hi:[0,1,1]
    v_pk_fma_f32 v[90:91], v[70:71], v[230:231], v[90:91] op_sel:[1,0,0] op_sel_hi:[1,1,1]
    v_pk_add_f32 v[90:91], v[90:91], v[92:93] op_sel:[0,0] op_sel_hi:[1,1]
    v_pk_add_f32 v[90:91], v[90:91], v[94:95] op_sel:[0,0] op_sel_hi:[1,1]
    v_permlane32_swap_b32 v88, v89
    s_nop 0
    v_permlane32_swap_b32 v90, v91
    v_add_f32 v88, v88, v89
    v_add_f32 v90, v90, v91
    s_nop 1
    v_permlane16_swap_b32 v88, v90
    v_add_f32 v88, v88, v90
    v_lshlrev_b32 v74, 2, v0
    v_add_u32 v74, 131072, v74
    ds_write_b32 v74, v88
    v_xor_b32 v74, 256, v74
    s_waitcnt vmcnt(0) lgkmcnt(0)
    s_barrier
    ds_read_b32 v89, v74
    s_lshl_b32 s6, s46, 7
    s_lshr_b32 s5, s44, 1
    s_mul_i32 s5, s5, 14336
    s_add_u32 s6, s6, s5
    s_add_u32 s6, s6, 49152
    v_lshl_add_u32 v74, v1, 2, s6
    s_waitcnt lgkmcnt(0)
    v_add_f32 v88, v88, v89
    v_min_u32 v88, -2, v88
    s_bitcmp1_b32 s3, 0
    s_cbranch_scc1 Lwp_skip
    global_store_dword v74, v88, s[38:39] sc1
Lwp_skip:
    s_sub_u32 s48, s42, 11
    s_cmp_ge_u32 s48, 27
    s_cbranch_scc1 Lsp_c
    v_and_b32 v33, 15, v1
    v_lshrrev_b32 v34, 4, v1
    v_mul_u32_u24 v34, 10240, v34
    s_mul_i32 s5, s3, 320
    s_add_u32 s5, s5, 40960
    v_add_u32 v34, s5, v34
    v_lshl_add_u32 v31, v33, 2, v34
    v_lshl_add_u32 v32, v33, 1, v34
    s_mul_i32 s5, s3, 276480
    s_mul_i32 s6, s48, 5120
    s_add_u32 s5, s5, s6
    s_add_u32 s5, s5, 10487808
    v_lshl_add_u32 v30, v1, 4, s5
    s_mov_b32 s6, 0x5040100
    s_mov_b32 s7, 0x7060302
    ds_read_b32 v36, v31 offset:0
    ds_read_b32 v37, v31 offset:2560
    ds_read_b32 v38, v31 offset:5120
    ds_read_b32 v39, v31 offset:7680
    ds_read_b32 v40, v31 offset:1280
    ds_read_b32 v41, v31 offset:3840
    ds_read_b32 v42, v31 offset:6400
    ds_read_b32 v43, v31 offset:8960
    ds_read_b32 v44, v31 offset:64
    ds_read_b32 v45, v31 offset:2624
    ds_read_b32 v46, v31 offset:5184
    ds_read_b32 v47, v31 offset:7744
    ds_read_b32 v48, v31 offset:1344
    ds_read_b32 v49, v31 offset:3904
    ds_read_b32 v50, v31 offset:6464
    ds_read_b32 v51, v31 offset:9024
    ds_read_u16 v52, v32 offset:128
    ds_read_u16 v53, v32 offset:2688
    ds_read_u16 v54, v32 offset:5248
    ds_read_u16 v55, v32 offset:7808
    ds_read_u16 v56, v32 offset:1408
    ds_read_u16 v57, v32 offset:3968
    ds_read_u16 v58, v32 offset:6528
    ds_read_u16 v59, v32 offset:9088
    s_waitcnt lgkmcnt(15)
    v_perm_b32 v60, v37, v36, s6
    v_perm_b32 v61, v39, v38, s6
    v_perm_b32 v62, v41, v40, s6
    v_perm_b32 v63, v43, v42, s6
    v_perm_b32 v64, v37, v36, s7
    v_perm_b32 v65, v39, v38, s7
    v_perm_b32 v66, v41, v40, s7
    v_perm_b32 v67, v43, v42, s7
    s_waitcnt lgkmcnt(14)
    v_perm_b32 v68, v45, v44, s6
    s_waitcnt lgkmcnt(12)
    v_perm_b32 v69, v47, v46, s6
    s_waitcnt lgkmcnt(10)
    v_perm_b32 v70, v49, v48, s6
    s_waitcnt lgkmcnt(8)
    v_perm_b32 v71, v51, v50, s6
    v_perm_b32 v72, v45, v44, s7
    v_perm_b32 v73, v47, v46, s7
    v_perm_b32 v74, v49, v48, s7
    v_perm_b32 v75, v51, v50, s7
    s_waitcnt lgkmcnt(6)
    v_perm_b32 v76, v53, v52, s6
    s_waitcnt lgkmcnt(4)
    v_perm_b32 v77, v55, v54, s6
    s_waitcnt lgkmcnt(2)
    v_perm_b32 v78, v57, v56, s6
    s_waitcnt lgkmcnt(0)
    v_perm_b32 v79, v59, v58, s6
    global_store_dwordx4 v30, v[60:63], s[38:39] offset:-2048 sc1
    global_store_dwordx4 v30, v[64:67], s[38:39] offset:-1024 sc1
    global_store_dwordx4 v30, v[68:71], s[38:39] offset:0 sc1
    global_store_dwordx4 v30, v[72:75], s[38:39] offset:1024 sc1
    global_store_dwordx4 v30, v[76:79], s[38:39] offset:2048 sc1
    v_add_u32 v30, 138240, v30
    ds_read_b32 v80, v31 offset:160
    ds_read_b32 v81, v31 offset:2720
    ds_read_b32 v82, v31 offset:5280
    ds_read_b32 v83, v31 offset:7840
    ds_read_b32 v84, v31 offset:1440
    ds_read_b32 v85, v31 offset:4000
    ds_read_b32 v86, v31 offset:6560
    ds_read_b32 v87, v31 offset:9120
    ds_read_b32 v88, v31 offset:224
    ds_read_b32 v89, v31 offset:2784
    ds_read_b32 v90, v31 offset:5344
    ds_read_b32 v91, v31 offset:7904
    ds_read_b32 v92, v31 offset:1504
    ds_read_b32 v93, v31 offset:4064
    ds_read_b32 v94, v31 offset:6624
    ds_read_b32 v95, v31 offset:9184
    ds_read_u16 v96, v32 offset:288
    ds_read_u16 v97, v32 offset:2848
    ds_read_u16 v98, v32 offset:5408
    ds_read_u16 v99, v32 offset:7968
    ds_read_u16 v100, v32 offset:1568
    ds_read_u16 v101, v32 offset:4128
    ds_read_u16 v102, v32 offset:6688
    ds_read_u16 v103, v32 offset:9248
    s_waitcnt lgkmcnt(15)
    v_perm_b32 v104, v81, v80, s6
    v_perm_b32 v105, v83, v82, s6
    v_perm_b32 v106, v85, v84, s6
    v_perm_b32 v107, v87, v86, s6
    v_perm_b32 v108, v81, v80, s7
    v_perm_b32 v109, v83, v82, s7
    v_perm_b32 v110, v85, v84, s7
    v_perm_b32 v111, v87, v86, s7
    s_waitcnt lgkmcnt(14)
    v_perm_b32 v112, v89, v88, s6
    s_waitcnt lgkmcnt(12)
    v_perm_b32 v113, v91, v90, s6
    s_waitcnt lgkmcnt(10)
    v_perm_b32 v114, v93, v92, s6
    s_waitcnt lgkmcnt(8)
    v_perm_b32 v115, v95, v94, s6
    v_perm_b32 v116, v89, v88, s7
    v_perm_b32 v117, v91, v90, s7
    v_perm_b32 v118, v93, v92, s7
    v_perm_b32 v119, v95, v94, s7
    s_waitcnt lgkmcnt(6)
    v_perm_b32 v120, v97, v96, s6
    s_waitcnt lgkmcnt(4)
    v_perm_b32 v121, v99, v98, s6
    s_waitcnt lgkmcnt(2)
    v_perm_b32 v122, v101, v100, s6
    s_waitcnt lgkmcnt(0)
    v_perm_b32 v123, v103, v102, s6
    global_store_dwordx4 v30, v[104:107], s[38:39] offset:-2048 sc1
    global_store_dwordx4 v30, v[108:111], s[38:39] offset:-1024 sc1
    global_store_dwordx4 v30, v[112:115], s[38:39] offset:0 sc1
    global_store_dwordx4 v30, v[116:119], s[38:39] offset:1024 sc1
    global_store_dwordx4 v30, v[120:123], s[38:39] offset:2048 sc1
    s_lshl_b32 s4, s48, 7
    s_add_u32 s4, s4, 180224
    v_mov_b32 v28, s4
    s_waitcnt vmcnt(0) lgkmcnt(0)
    s_barrier
    s_cmp_lg_u32 s3, 0
    s_cbranch_scc1 Lsp_c
    global_store_dword v28, v28, s[38:39] sc1
Lsp_c:
    s_waitcnt lgkmcnt(0)
    s_barrier
    s_lshr_b32 s5, s3, 1
    s_lshl_b32 s5, s5, 5
    s_and_b32 s6, s3, 1
    s_lshl_b32 s6, s6, 2
    s_add_u32 s6, s6, s5
    s_lshl_b32 s5, s40, 6
    s_add_u32 s90, s6, s5
    v_add_lshl_u32 v27, v5, s90, 1
    global_load_ushort v27, v27, s[26:27]
    s_and_b32 s4, s41, 3
    s_cmp_eq_u32 s4, 0
    s_cselect_b32 s5, 8, 0
    s_cmp_le_u32 s4, 1
    s_cselect_b32 s6, 16, 8
    s_cmp_eq_u32 s4, 3
    s_cselect_b32 s50, 16, 24
    s_lshl_b32 s44, s4, 3
    s_bitcmp1_b32 s43, 0
    s_cselect_b32 s46, s6, s5
    s_cselect_b32 s48, s5, s6
    s_lshl_b32 s5, s3, 1
    s_add_u32 s44, s44, s5
    s_add_u32 s45, s44, 1
    s_add_u32 s46, s46, s5
    s_add_u32 s47, s46, 1
    s_add_u32 s48, s48, s5
    s_add_u32 s49, s48, 1
    s_add_u32 s50, s50, s5
    s_add_u32 s51, s50, 1
    s_lshl_b32 s5, s40, 18
    s_lshl_b32 s6, s44, 7
    s_add_u32 s6, s6, s5
    s_add_u32 s68, s24, s6
    s_addc_u32 s69, s25, 0
    s_lshl_b32 s6, s45, 7
    s_add_u32 s6, s6, s5
    s_add_u32 s70, s24, s6
    s_addc_u32 s71, s25, 0
    s_lshl_b32 s6, s46, 7
    s_add_u32 s6, s6, s5
    s_add_u32 s72, s24, s6
    s_addc_u32 s73, s25, 0
    s_lshl_b32 s6, s47, 7
    s_add_u32 s6, s6, s5
    s_add_u32 s74, s24, s6
    s_addc_u32 s75, s25, 0
    s_lshl_b32 s6, s48, 7
    s_add_u32 s6, s6, s5
    s_add_u32 s76, s24, s6
    s_addc_u32 s77, s25, 0
    s_lshl_b32 s6, s49, 7
    s_add_u32 s6, s6, s5
    s_add_u32 s78, s24, s6
    s_addc_u32 s79, s25, 0
    s_lshl_b32 s6, s50, 7
    s_add_u32 s6, s6, s5
    s_add_u32 s80, s24, s6
    s_addc_u32 s81, s25, 0
    s_lshl_b32 s6, s51, 7
    s_add_u32 s6, s6, s5
    s_add_u32 s82, s24, s6
    s_addc_u32 s83, s25, 0
    s_lshl_b32 s89, s3, 14
    s_add_u32 s89, s89, 83200
    v_lshrrev_b32 v28, 3, v1
    v_lshlrev_b32 v28, 12, v28
    v_bfe_u32 v29, v1, 4, 1
    v_xor_b32 v29, v29, v1
    v_and_b32 v29, 7, v29
    v_xor_b32 v64, 0, v29
    v_lshl_add_u32 v64, v64, 4, v28
    v_add_u32 v68, 131072, v64
    v_xor_b32 v65, 2, v29
    v_lshl_add_u32 v65, v65, 4, v28
    v_add_u32 v65, 31744, v65
    v_add_u32 v69, 131072, v65
    v_xor_b32 v66, 4, v29
    v_lshl_add_u32 v66, v66, 4, v28
    v_add_u32 v66, 63488, v66
    v_add_u32 v70, 131072, v66
    v_xor_b32 v67, 6, v29
    v_lshl_add_u32 v67, v67, 4, v28
    v_add_u32 v67, 95232, v67
    v_add_u32 v71, 131072, v67
    s_add_u32 m0, s89, 0
    s_nop 0
    global_load_lds_dwordx4 v64, s[68:69] offset:0
    global_load_lds_dwordx4 v65, s[68:69] offset:1024
    global_load_lds_dwordx4 v66, s[68:69] offset:2048
    global_load_lds_dwordx4 v67, s[68:69] offset:3072
    s_add_u32 m0, s89, 4096
    s_nop 0
    global_load_lds_dwordx4 v68, s[68:69] offset:0
    global_load_lds_dwordx4 v69, s[68:69] offset:1024
    global_load_lds_dwordx4 v70, s[68:69] offset:2048
    global_load_lds_dwordx4 v71, s[68:69] offset:3072
    s_and_b32 s4, s41, 1
    s_lshl_b32 s5, s3, 1
    s_add_u32 s5, s5, s4
    s_cmp_eq_u32 s5, 7
    s_cselect_b32 s5, 0, s5
    s_mul_i32 s96, s41, 7
    s_add_u32 s96, s96, s5
    s_cmp_lt_u32 s96, 54
    s_cselect_b32 s101, 2, 0
    s_min_u32 s96, s96, 53
    s_cmp_eq_u32 s3, 3
    s_cselect_b32 s101, 1, s101
    s_lshr_b32 s97, s101, 1
    s_cselect_b32 s5, -1, 0
    v_and_b32 v7, s5, v4
    s_add_u32 s97, s97, s96
    s_mul_i32 s4, s96, 20480
    s_add_u32 s5, s4, 7344128
    s_add_u32 s8, s38, s5
    s_addc_u32 s9, s39, 0
    s_add_u32 s5, s4, 7352320
    s_add_u32 s10, s38, s5
    s_addc_u32 s11, s39, 0
    s_add_u32 s5, s4, 7360512
    s_add_u32 s12, s38, s5
    s_addc_u32 s13, s39, 0
    s_mul_i32 s4, s97, 20480
    s_add_u32 s5, s4, 7344128
    s_add_u32 s14, s38, s5
    s_addc_u32 s15, s39, 0
    s_add_u32 s5, s4, 7352320
    s_add_u32 s16, s38, s5
    s_addc_u32 s17, s39, 0
    s_add_u32 s5, s4, 7360512
    s_add_u32 s18, s38, s5
    s_addc_u32 s19, s39, 0
    v_bfe_u32 v28, v1, 3, 1
    s_sub_u32 s4, s97, s96
    v_mul_u32_u24 v28, s4, v28
    v_add_lshl_u32 v28, v28, s96, 7
    v_mul_u32_u24 v29, 7168, v3
    v_add_u32 v28, v28, v29
    v_and_b32 v29, 112, v4
    v_add_u32 v28, v28, v29
    v_add_u32 v28, 49152, v28
    s_lshl_b32 s4, s40, 9
    s_add_u32 s4, s4, 32772
    v_lshl_add_u32 v30, v1, 3, s4
    s_branch Lsu_f
Lsu:
    s_sleep 4
Lsu_f:
    global_load_dwordx4 v[40:43], v28, s[38:39] sc1
    global_load_dword v44, v30, s[38:39] sc1
    s_waitcnt vmcnt(0)
    v_max3_u32 v29, v40, v41, v42
    v_max3_u32 v29, v43, v44, v29
    v_cmp_eq_u32 vcc, -1, v29
    s_add_u32 s100, s100, 1
    s_cmp_ge_u32 s100, 262144
    s_cbranch_scc1 Lsu_x
    s_cbranch_vccnz Lsu
Lsu_x:
    v_permlane32_swap_b32 v40, v42
    v_permlane32_swap_b32 v41, v43
    s_lshl_b32 s4, s3, 9
    s_add_u32 s4, s4, 156672
    v_and_b32 v28, 496, v4
    v_add_f32 v40, v40, v42
    v_add_f32 v41, v41, v43
    v_bfe_u32 v42, v1, 3, 1
    v_cmp_gt_u32 vcc, s101, v42
    v_lshrrev_b32 v42, 5, v1
    v_lshl_add_u32 v28, v42, 3, v28
    v_cndmask_b32 v40, 0, v40, vcc
    v_cndmask_b32 v41, 0, v41, vcc
    v_add_u32 v28, s4, v28
    ds_write_b64 v28, v[40:41]
    s_barrier
    s_sub_u32 s5, s43, 5
    v_mad_u32_u24 v28, v1, 3, s5
    v_min_u32 v28, 159, v28
    v_lshlrev_b32 v28, 7, v28
    global_load_dwordx4 a[248:251], v4, s[12:13] offset:-1024 sc1
    global_load_dwordx4 a[252:255], v7, s[18:19] offset:-1024 sc1
    global_load_dwordx4 a[240:243], v4, s[12:13] offset:-2048 sc1
    global_load_dwordx4 a[244:247], v7, s[18:19] offset:-2048 sc1
    global_load_dwordx4 a[232:235], v4, s[12:13] offset:-3072 sc1
    global_load_dwordx4 a[236:239], v7, s[18:19] offset:-3072 sc1
    global_load_dwordx4 a[224:227], v4, s[12:13] offset:-4096 sc1
    global_load_dwordx4 a[228:231], v7, s[18:19] offset:-4096 sc1
    global_load_dwordx4 a[216:219], v4, s[10:11] offset:3072 sc1
    global_load_dwordx4 a[220:223], v7, s[16:17] offset:3072 sc1
    global_load_dwordx4 a[208:211], v4, s[10:11] offset:2048 sc1
    global_load_dwordx4 a[212:215], v7, s[16:17] offset:2048 sc1
    global_load_dwordx4 a[200:203], v4, s[10:11] offset:1024 sc1
    global_load_dwordx4 a[204:207], v7, s[16:17] offset:1024 sc1
    global_load_dwordx4 a[192:195], v4, s[10:11] offset:0 sc1
    global_load_dwordx4 a[196:199], v7, s[16:17] offset:0 sc1
    global_load_dwordx4 a[184:187], v4, s[10:11] offset:-1024 sc1
    global_load_dwordx4 a[188:191], v7, s[16:17] offset:-1024 sc1
    global_load_dwordx4 a[176:179], v4, s[10:11] offset:-2048 sc1
    global_load_dwordx4 a[180:183], v7, s[16:17] offset:-2048 sc1
    global_load_dwordx4 a[168:171], v4, s[10:11] offset:-3072 sc1
    global_load_dwordx4 a[172:175], v7, s[16:17] offset:-3072 sc1
    global_load_dwordx4 a[160:163], v4, s[10:11] offset:-4096 sc1
    global_load_dwordx4 a[164:167], v7, s[16:17] offset:-4096 sc1
    global_load_dwordx4 a[152:155], v4, s[8:9] offset:3072 sc1
    global_load_dwordx4 a[156:159], v7, s[14:15] offset:3072 sc1
    global_load_dwordx4 a[144:147], v4, s[8:9] offset:2048 sc1
    global_load_dwordx4 a[148:151], v7, s[14:15] offset:2048 sc1
    global_load_dwordx4 a[136:139], v4, s[8:9] offset:1024 sc1
    global_load_dwordx4 a[140:143], v7, s[14:15] offset:1024 sc1
    global_load_dwordx4 a[128:131], v4, s[8:9] offset:0 sc1
    global_load_dwordx4 a[132:135], v7, s[14:15] offset:0 sc1
    s_mul_i32 s4, s96, 20480
    s_add_u32 s4, s4, 8486912
    v_add_u32 v29, s4, v28
    global_load_dword v32, v29, s[38:39] sc1
    s_mul_i32 s4, s97, 20480
    s_add_u32 s4, s4, 8486912
    v_add_u32 v29, s4, v28
    global_load_dword v33, v29, s[38:39] sc1
    s_barrier
    s_branch Ljoin
Lconv:
    s_and_b32 s4, s42, 15
    s_lshl_b32 s4, s4, 2
    s_add_u32 s4, s4, s3
    s_mul_i32 s4, s4, 40960
    s_lshr_b32 s5, s42, 4
    s_lshl_b32 s6, s5, 7
    s_add_u32 s4, s4, s6
    v_mul_u32_u24 v38, 10240, v3
    v_lshl_add_u32 v38, v2, 3, v38
    v_add_u32 v38, s4, v38
    v_add_u32 v39, 5120, v38
    global_load_dwordx2 v[48:49], v38, s[10:11] offset:0
    global_load_dwordx2 v[50:51], v38, s[10:11] offset:1280
    global_load_dwordx2 v[52:53], v38, s[10:11] offset:2560
    global_load_dwordx2 v[54:55], v38, s[10:11] offset:3840
    global_load_dwordx2 v[56:57], v39, s[10:11] offset:0
    global_load_dwordx2 v[58:59], v39, s[10:11] offset:1280
    global_load_dwordx2 v[60:61], v39, s[10:11] offset:2560
    global_load_dwordx2 v[62:63], v39, s[10:11] offset:3840
    v_max_u32 v40, 3840, v38
    global_load_dwordx2 v[42:43], v40, s[10:11] offset:-3840
    global_load_dwordx2 v[44:45], v40, s[10:11] offset:-2560
    global_load_dwordx2 v[46:47], v40, s[10:11] offset:-1280
    s_lshl_b32 s5, s5, 9
    v_lshl_add_u32 v40, v2, 5, s5
    global_load_dwordx4 v[80:83], v40, s[14:15] offset:0
    global_load_dwordx4 v[84:87], v40, s[14:15] offset:16
    global_load_dwordx2 v[64:65], v38, s[12:13] offset:0 nt
    global_load_dwordx2 v[66:67], v38, s[12:13] offset:1280 nt
    global_load_dwordx2 v[68:69], v38, s[12:13] offset:2560 nt
    global_load_dwordx2 v[70:71], v38, s[12:13] offset:3840 nt
    global_load_dwordx2 v[72:73], v39, s[12:13] offset:0 nt
    global_load_dwordx2 v[74:75], v39, s[12:13] offset:1280 nt
    global_load_dwordx2 v[76:77], v39, s[12:13] offset:2560 nt
    global_load_dwordx2 v[78:79], v39, s[12:13] offset:3840 nt
    s_lshl_b32 s7, s42, 3
    s_load_dwordx2 s[92:93], s[18:19], s7
    v_mov_b32 v148, 0
    v_mov_b32 v149, 0
    v_mov_b32 v150, 0
    v_mov_b32 v151, 0
    s_mul_i32 s5, s3, 8448
    v_and_b32 v28, 48, v4
    v_add_u32 v28, s5, v28
    ds_write_b128 v28, v[148:151] offset:0
    ds_write_b128 v28, v[148:151] offset:4224
    v_min_u32 v28, 448, v4
    s_mul_i32 s4, s3, 9280
    v_add_u32 v28, s4, v28
    ds_write_b128 v28, v[148:151] offset:37888
    ds_write_b128 v28, v[148:151] offset:42528
    v_add_u32 v31, s5, v4
    v_and_b32 v28, 1, v2
    v_lshrrev_b32 v29, 1, v2
    v_mul_u32_u24 v30, 4224, v28
    v_lshl_add_u32 v30, v29, 3, v30
    v_lshl_add_u32 v30, v3, 4, v30
    v_add_u32 v30, s5, v30
    v_mul_u32_u24 v32, 4640, v28
    v_lshlrev_b32 v29, 6, v29
    v_sub_u32 v32, v32, v29
    v_lshl_add_u32 v32, v3, 4, v32
    s_add_u32 s4, s4, 34256
    v_add_u32 v32, s4, v32
    v_lshl_add_u32 v34, v28, 2, v29
    v_lshl_add_u32 v34, v3, 4, v34
    s_mul_i32 s4, s3, 1056
    s_add_u32 s4, s4, 0
    v_add_u32 v34, s4, v34
    v_lshlrev_b32 v28, 2, v0
    v_sub_u32 v33, 34824, v28
    v_add_u32 v35, 0, v28
    v_lshrrev_b32 v28, 5, v0
    v_mul_u32_u24 v37, 114688, v28
    v_and_b32 v28, 31, v0
    v_lshl_add_u32 v37, v28, 4, v37
    s_lshl_b32 s4, s42, 9
    s_add_u32 s4, s4, 1048576
    v_add_u32 v37, s4, v37
    s_waitcnt lgkmcnt(0)
    s_lshl_b32 s52, s92, 16
    s_lshr_b32 s56, s52, 16
    s_and_b32 s53, s92, 0xffff0000
    s_lshr_b32 s57, s53, 16
    s_lshl_b32 s54, s93, 16
    s_lshr_b32 s58, s54, 16
    s_and_b32 s55, s93, 0xffff0000
    s_lshr_b32 s59, s55, 16
    v_and_b32 v203, 7, v1
    v_lshrrev_b32 v204, 3, v1
    s_lshl_b32 s4, s42, 2
    s_add_u32 s4, s4, s3
    s_lshl_b32 s94, s4, 12
    v_add_u32 v28, s94, v4
    s_mul_i32 s5, s3, 8448
    s_add_u32 m0, s5, 4288
    s_nop 0
    global_load_lds_dwordx4 v28, s[16:17] offset:0 nt
    global_load_lds_dwordx4 v28, s[16:17] offset:1024 nt
    global_load_lds_dwordx4 v28, s[16:17] offset:2048 nt
    global_load_lds_dwordx4 v28, s[16:17] offset:3072 nt
    s_lshr_b32 s5, s3, 1
    s_lshl_b32 s5, s5, 5
    s_and_b32 s6, s3, 1
    s_lshl_b32 s6, s6, 2
    s_add_u32 s6, s6, s5
    s_lshl_b32 s5, s40, 6
    s_add_u32 s90, s6, s5
    v_add_lshl_u32 v27, v5, s90, 1
    global_load_ushort v27, v27, s[26:27]
    s_waitcnt vmcnt(25)
    v_lshlrev_b32 v116, 16, v48
    v_and_b32 v117, 0xffff0000, v48
    v_lshlrev_b32 v118, 16, v49
    v_and_b32 v119, 0xffff0000, v49
    s_waitcnt vmcnt(24)
    v_lshlrev_b32 v120, 16, v50
    v_and_b32 v121, 0xffff0000, v50
    v_lshlrev_b32 v122, 16, v51
    v_and_b32 v123, 0xffff0000, v51
    s_waitcnt vmcnt(23)
    v_lshlrev_b32 v124, 16, v52
    v_and_b32 v125, 0xffff0000, v52
    v_lshlrev_b32 v126, 16, v53
    v_and_b32 v127, 0xffff0000, v53
    s_waitcnt vmcnt(22)
    v_lshlrev_b32 v128, 16, v54
    v_and_b32 v129, 0xffff0000, v54
    v_lshlrev_b32 v130, 16, v55
    v_and_b32 v131, 0xffff0000, v55
    s_waitcnt vmcnt(21)
    v_lshlrev_b32 v132, 16, v56
    v_and_b32 v133, 0xffff0000, v56
    v_lshlrev_b32 v134, 16, v57
    v_and_b32 v135, 0xffff0000, v57
    s_waitcnt vmcnt(20)
    v_lshlrev_b32 v136, 16, v58
    v_and_b32 v137, 0xffff0000, v58
    v_lshlrev_b32 v138, 16, v59
    v_and_b32 v139, 0xffff0000, v59
    s_waitcnt vmcnt(19)
    v_lshlrev_b32 v140, 16, v60
    v_and_b32 v141, 0xffff0000, v60
    v_lshlrev_b32 v142, 16, v61
    v_and_b32 v143, 0xffff0000, v61
    s_waitcnt vmcnt(18)
    v_lshlrev_b32 v144, 16, v62
    v_and_b32 v145, 0xffff0000, v62
    v_lshlrev_b32 v146, 16, v63
    v_and_b32 v147, 0xffff0000, v63
    s_lshl_b32 s4, s42, 2
    s_add_u32 s4, s4, s3
    s_mul_i32 s4, s4, 5120
    s_cmp_lt_u32 s42, 128
    s_cselect_b32 s5, -1, 0
    v_add_u32 v201, s4, v4
    v_and_b32 v201, s5, v201
    v_add_u32 v201, 2048, v201
    global_load_dwordx4 v[180:183], v201, s[8:9] offset:-2048 nt
    global_load_dwordx4 v[184:187], v201, s[8:9] offset:-1024 nt
    global_load_dwordx4 v[188:191], v201, s[8:9] offset:0 nt
    global_load_dwordx4 v[192:195], v201, s[8:9] offset:1024 nt
    global_load_dwordx4 v[196:199], v201, s[8:9] offset:2048 nt
    v_cmp_le_u32 vcc, 1280, v38
    s_waitcnt vmcnt(22)
    s_nop 0
    v_cndmask_b32 v42, 0, v42, vcc
    v_cndmask_b32 v43, 0, v43, vcc
    s_waitcnt vmcnt(21)
    v_cndmask_b32 v44, 0, v44, vcc
    v_cndmask_b32 v45, 0, v45, vcc
    s_waitcnt vmcnt(20)
    v_cndmask_b32 v46, 0, v46, vcc
    v_cndmask_b32 v47, 0, v47, vcc
    v_lshlrev_b32 v104, 16, v42
    v_and_b32 v105, 0xffff0000, v42
    v_lshlrev_b32 v106, 16, v43
    v_and_b32 v107, 0xffff0000, v43
    v_lshlrev_b32 v108, 16, v44
    v_and_b32 v109, 0xffff0000, v44
    v_lshlrev_b32 v110, 16, v45
    v_and_b32 v111, 0xffff0000, v45
    v_lshlrev_b32 v112, 16, v46
    v_and_b32 v113, 0xffff0000, v46
    v_lshlrev_b32 v114, 16, v47
    v_and_b32 v115, 0xffff0000, v47
    s_waitcnt vmcnt(19)
    v_lshlrev_b32 v88, 16, v80
    v_and_b32 v92, 0xffff0000, v80
    v_lshlrev_b32 v96, 16, v81
    v_and_b32 v100, 0xffff0000, v81
    v_lshlrev_b32 v89, 16, v82
    v_and_b32 v93, 0xffff0000, v82
    v_lshlrev_b32 v97, 16, v83
    v_and_b32 v101, 0xffff0000, v83
    s_waitcnt vmcnt(18)
    v_lshlrev_b32 v90, 16, v84
    v_and_b32 v94, 0xffff0000, v84
    v_lshlrev_b32 v98, 16, v85
    v_and_b32 v102, 0xffff0000, v85
    v_lshlrev_b32 v91, 16, v86
    v_and_b32 v95, 0xffff0000, v86
    v_lshlrev_b32 v99, 16, v87
    v_and_b32 v103, 0xffff0000, v87
    v_pk_mul_f32 v[148:149], v[116:117], v[88:89] op_sel:[0,0] op_sel_hi:[1,1]
    v_pk_mul_f32 v[150:151], v[118:119], v[90:91] op_sel:[0,0] op_sel_hi:[1,1]
    v_pk_mul_f32 v[152:153], v[120:121], v[88:89] op_sel:[0,0] op_sel_hi:[1,1]
    v_pk_mul_f32 v[154:155], v[122:123], v[90:91] op_sel:[0,0] op_sel_hi:[1,1]
    v_pk_mul_f32 v[156:157], v[124:125], v[88:89] op_sel:[0,0] op_sel_hi:[1,1]
    v_pk_mul_f32 v[158:159], v[126:127], v[90:91] op_sel:[0,0] op_sel_hi:[1,1]
    v_pk_mul_f32 v[160:161], v[128:129], v[88:89] op_sel:[0,0] op_sel_hi:[1,1]
    v_pk_mul_f32 v[162:163], v[130:131], v[90:91] op_sel:[0,0] op_sel_hi:[1,1]
    v_pk_mul_f32 v[164:165], v[132:133], v[88:89] op_sel:[0,0] op_sel_hi:[1,1]
    v_pk_mul_f32 v[166:167], v[134:135], v[90:91] op_sel:[0,0] op_sel_hi:[1,1]
    v_pk_mul_f32 v[168:169], v[136:137], v[88:89] op_sel:[0,0] op_sel_hi:[1,1]
    v_pk_mul_f32 v[170:171], v[138:139], v[90:91] op_sel:[0,0] op_sel_hi:[1,1]
    v_pk_mul_f32 v[172:173], v[140:141], v[88:89] op_sel:[0,0] op_sel_hi:[1,1]
    v_pk_mul_f32 v[174:175], v[142:143], v[90:91] op_sel:[0,0] op_sel_hi:[1,1]
    v_pk_mul_f32 v[176:177], v[144:145], v[88:89] op_sel:[0,0] op_sel_hi:[1,1]
    v_pk_mul_f32 v[178:179], v[146:147], v[90:91] op_sel:[0,0] op_sel_hi:[1,1]
    v_pk_fma_f32 v[148:149], v[112:113], v[92:93], v[148:149] op_sel:[0,0,0] op_sel_hi:[1,1,1]
    v_pk_fma_f32 v[150:151], v[114:115], v[94:95], v[150:151] op_sel:[0,0,0] op_sel_hi:[1,1,1]
    v_pk_fma_f32 v[152:153], v[116:117], v[92:93], v[152:153] op_sel:[0,0,0] op_sel_hi:[1,1,1]
    v_pk_fma_f32 v[154:155], v[118:119], v[94:95], v[154:155] op_sel:[0,0,0] op_sel_hi:[1,1,1]
    v_pk_fma_f32 v[156:157], v[120:121], v[92:93], v[156:157] op_sel:[0,0,0] op_sel_hi:[1,1,1]
    v_pk_fma_f32 v[158:159], v[122:123], v[94:95], v[158:159] op_sel:[0,0,0] op_sel_hi:[1,1,1]
    v_pk_fma_f32 v[160:161], v[124:125], v[92:93], v[160:161] op_sel:[0,0,0] op_sel_hi:[1,1,1]
    v_pk_fma_f32 v[162:163], v[126:127], v[94:95], v[162:163] op_sel:[0,0,0] op_sel_hi:[1,1,1]
    v_pk_fma_f32 v[164:165], v[128:129], v[92:93], v[164:165] op_sel:[0,0,0] op_sel_hi:[1,1,1]
    v_pk_fma_f32 v[166:167], v[130:131], v[94:95], v[166:167] op_sel:[0,0,0] op_sel_hi:[1,1,1]
    v_pk_fma_f32 v[168:169], v[132:133], v[92:93], v[168:169] op_sel:[0,0,0] op_sel_hi:[1,1,1]
    v_pk_fma_f32 v[170:171], v[134:135], v[94:95], v[170:171] op_sel:[0,0,0] op_sel_hi:[1,1,1]
    v_pk_fma_f32 v[172:173], v[136:137], v[92:93], v[172:173] op_sel:[0,0,0] op_sel_hi:[1,1,1]
    v_pk_fma_f32 v[174:175], v[138:139], v[94:95], v[174:175] op_sel:[0,0,0] op_sel_hi:[1,1,1]
    v_pk_fma_f32 v[176:177], v[140:141], v[92:93], v[176:177] op_sel:[0,0,0] op_sel_hi:[1,1,1]
    v_pk_fma_f32 v[178:179], v[142:143], v[94:95], v[178:179] op_sel:[0,0,0] op_sel_hi:[1,1,1]
    v_pk_fma_f32 v[148:149], v[108:109], v[96:97], v[148:149] op_sel:[0,0,0] op_sel_hi:[1,1,1]
    v_pk_fma_f32 v[150:151], v[110:111], v[98:99], v[150:151] op_sel:[0,0,0] op_sel_hi:[1,1,1]
    v_pk_fma_f32 v[152:153], v[112:113], v[96:97], v[152:153] op_sel:[0,0,0] op_sel_hi:[1,1,1]
    v_pk_fma_f32 v[154:155], v[114:115], v[98:99], v[154:155] op_sel:[0,0,0] op_sel_hi:[1,1,1]
    v_pk_fma_f32 v[156:157], v[116:117], v[96:97], v[156:157] op_sel:[0,0,0] op_sel_hi:[1,1,1]
    v_pk_fma_f32 v[158:159], v[118:119], v[98:99], v[158:159] op_sel:[0,0,0] op_sel_hi:[1,1,1]
    v_pk_fma_f32 v[160:161], v[120:121], v[96:97], v[160:161] op_sel:[0,0,0] op_sel_hi:[1,1,1]
    v_pk_fma_f32 v[162:163], v[122:123], v[98:99], v[162:163] op_sel:[0,0,0] op_sel_hi:[1,1,1]
    v_pk_fma_f32 v[164:165], v[124:125], v[96:97], v[164:165] op_sel:[0,0,0] op_sel_hi:[1,1,1]
    v_pk_fma_f32 v[166:167], v[126:127], v[98:99], v[166:167] op_sel:[0,0,0] op_sel_hi:[1,1,1]
    v_pk_fma_f32 v[168:169], v[128:129], v[96:97], v[168:169] op_sel:[0,0,0] op_sel_hi:[1,1,1]
    v_pk_fma_f32 v[170:171], v[130:131], v[98:99], v[170:171] op_sel:[0,0,0] op_sel_hi:[1,1,1]
    v_pk_fma_f32 v[172:173], v[132:133], v[96:97], v[172:173] op_sel:[0,0,0] op_sel_hi:[1,1,1]
    v_pk_fma_f32 v[174:175], v[134:135], v[98:99], v[174:175] op_sel:[0,0,0] op_sel_hi:[1,1,1]
    v_pk_fma_f32 v[176:177], v[136:137], v[96:97], v[176:177] op_sel:[0,0,0] op_sel_hi:[1,1,1]
    v_pk_fma_f32 v[178:179], v[138:139], v[98:99], v[178:179] op_sel:[0,0,0] op_sel_hi:[1,1,1]
    v_pk_fma_f32 v[148:149], v[104:105], v[100:101], v[148:149] op_sel:[0,0,0] op_sel_hi:[1,1,1]
    v_pk_fma_f32 v[150:151], v[106:107], v[102:103], v[150:151] op_sel:[0,0,0] op_sel_hi:[1,1,1]
    v_pk_fma_f32 v[152:153], v[108:109], v[100:101], v[152:153] op_sel:[0,0,0] op_sel_hi:[1,1,1]
    v_pk_fma_f32 v[154:155], v[110:111], v[102:103], v[154:155] op_sel:[0,0,0] op_sel_hi:[1,1,1]
    v_pk_fma_f32 v[156:157], v[112:113], v[100:101], v[156:157] op_sel:[0,0,0] op_sel_hi:[1,1,1]
    v_pk_fma_f32 v[158:159], v[114:115], v[102:103], v[158:159] op_sel:[0,0,0] op_sel_hi:[1,1,1]
    v_pk_fma_f32 v[160:161], v[116:117], v[100:101], v[160:161] op_sel:[0,0,0] op_sel_hi:[1,1,1]
    v_pk_fma_f32 v[162:163], v[118:119], v[102:103], v[162:163] op_sel:[0,0,0] op_sel_hi:[1,1,1]
    v_pk_fma_f32 v[164:165], v[120:121], v[100:101], v[164:165] op_sel:[0,0,0] op_sel_hi:[1,1,1]
    v_pk_fma_f32 v[166:167], v[122:123], v[102:103], v[166:167] op_sel:[0,0,0] op_sel_hi:[1,1,1]
    v_pk_fma_f32 v[168:169], v[124:125], v[100:101], v[168:169] op_sel:[0,0,0] op_sel_hi:[1,1,1]
    v_pk_fma_f32 v[170:171], v[126:127], v[102:103], v[170:171] op_sel:[0,0,0] op_sel_hi:[1,1,1]
    v_pk_fma_f32 v[172:173], v[128:129], v[100:101], v[172:173] op_sel:[0,0,0] op_sel_hi:[1,1,1]
    v_pk_fma_f32 v[174:175], v[130:131], v[102:103], v[174:175] op_sel:[0,0,0] op_sel_hi:[1,1,1]
    v_pk_fma_f32 v[176:177], v[132:133], v[100:101], v[176:177] op_sel:[0,0,0] op_sel_hi:[1,1,1]
    v_pk_fma_f32 v[178:179], v[134:135], v[102:103], v[178:179] op_sel:[0,0,0] op_sel_hi:[1,1,1]
    s_lshl_b32 s4, s3, 6
    s_sub_u32 s4, 104688, s4
    v_mul_u32_u24 v40, 272, v2
    v_add_u32 v40, s4, v40
    v_lshlrev_b32 v39, 4, v3
    v_sub_u32 v40, v40, v39
    s_waitcnt vmcnt(17)
    v_lshlrev_b32 v104, 16, v64
    v_and_b32 v105, 0xffff0000, v64
    v_lshlrev_b32 v106, 16, v65
    v_and_b32 v107, 0xffff0000, v65
    v_pk_mul_f32 v[148:149], v[148:149], v[104:105] op_sel:[0,0] op_sel_hi:[1,1]
    v_pk_mul_f32 v[150:151], v[150:151], v[106:107] op_sel:[0,0] op_sel_hi:[1,1]
    s_waitcnt vmcnt(16)
    v_lshlrev_b32 v108, 16, v66
    v_and_b32 v109, 0xffff0000, v66
    v_lshlrev_b32 v110, 16, v67
    v_and_b32 v111, 0xffff0000, v67
    v_pk_mul_f32 v[152:153], v[152:153], v[108:109] op_sel:[0,0] op_sel_hi:[1,1]
    v_pk_mul_f32 v[154:155], v[154:155], v[110:111] op_sel:[0,0] op_sel_hi:[1,1]
    s_waitcnt vmcnt(15)
    v_lshlrev_b32 v112, 16, v68
    v_and_b32 v113, 0xffff0000, v68
    v_lshlrev_b32 v114, 16, v69
    v_and_b32 v115, 0xffff0000, v69
    v_pk_mul_f32 v[156:157], v[156:157], v[112:113] op_sel:[0,0] op_sel_hi:[1,1]
    v_pk_mul_f32 v[158:159], v[158:159], v[114:115] op_sel:[0,0] op_sel_hi:[1,1]
    s_waitcnt vmcnt(14)
    v_lshlrev_b32 v116, 16, v70
    v_and_b32 v117, 0xffff0000, v70
    v_lshlrev_b32 v118, 16, v71
    v_and_b32 v119, 0xffff0000, v71
    v_pk_mul_f32 v[160:161], v[160:161], v[116:117] op_sel:[0,0] op_sel_hi:[1,1]
    v_pk_mul_f32 v[162:163], v[162:163], v[118:119] op_sel:[0,0] op_sel_hi:[1,1]
    s_waitcnt vmcnt(13)
    v_lshlrev_b32 v120, 16, v72
    v_and_b32 v121, 0xffff0000, v72
    v_lshlrev_b32 v122, 16, v73
    v_and_b32 v123, 0xffff0000, v73
    v_pk_mul_f32 v[164:165], v[164:165], v[120:121] op_sel:[0,0] op_sel_hi:[1,1]
    v_pk_mul_f32 v[166:167], v[166:167], v[122:123] op_sel:[0,0] op_sel_hi:[1,1]
    s_waitcnt vmcnt(12)
    v_lshlrev_b32 v124, 16, v74
    v_and_b32 v125, 0xffff0000, v74
    v_lshlrev_b32 v126, 16, v75
    v_and_b32 v127, 0xffff0000, v75
    v_pk_mul_f32 v[168:169], v[168:169], v[124:125] op_sel:[0,0] op_sel_hi:[1,1]
    v_pk_mul_f32 v[170:171], v[170:171], v[126:127] op_sel:[0,0] op_sel_hi:[1,1]
    s_waitcnt vmcnt(11)
    v_lshlrev_b32 v128, 16, v76
    v_and_b32 v129, 0xffff0000, v76
    v_lshlrev_b32 v130, 16, v77
    v_and_b32 v131, 0xffff0000, v77
    v_pk_mul_f32 v[172:173], v[172:173], v[128:129] op_sel:[0,0] op_sel_hi:[1,1]
    v_pk_mul_f32 v[174:175], v[174:175], v[130:131] op_sel:[0,0] op_sel_hi:[1,1]
    s_waitcnt vmcnt(10)
    v_lshlrev_b32 v132, 16, v78
    v_and_b32 v133, 0xffff0000, v78
    v_lshlrev_b32 v134, 16, v79
    v_and_b32 v135, 0xffff0000, v79
    v_pk_mul_f32 v[176:177], v[176:177], v[132:133] op_sel:[0,0] op_sel_hi:[1,1]
    v_pk_mul_f32 v[178:179], v[178:179], v[134:135] op_sel:[0,0] op_sel_hi:[1,1]
    v_cvt_pk_bf16_f32 v88, v176, v172
    v_cvt_pk_bf16_f32 v89, v168, v164
    v_cvt_pk_bf16_f32 v90, v160, v156
    v_cvt_pk_bf16_f32 v91, v152, v148
    v_and_b32 v91, -2, v91
    ds_write_b128 v40, v[88:91] offset:0
    v_cvt_pk_bf16_f32 v92, v177, v173
    v_cvt_pk_bf16_f32 v93, v169, v165
    v_cvt_pk_bf16_f32 v94, v161, v157
    v_cvt_pk_bf16_f32 v95, v153, v149
    v_and_b32 v95, -2, v95
    ds_write_b128 v40, v[92:95] offset:4352
    v_cvt_pk_bf16_f32 v96, v178, v174
    v_cvt_pk_bf16_f32 v97, v170, v166
    v_cvt_pk_bf16_f32 v98, v162, v158
    v_cvt_pk_bf16_f32 v99, v154, v150
    v_and_b32 v99, -2, v99
    ds_write_b128 v40, v[96:99] offset:8704
    v_cvt_pk_bf16_f32 v100, v179, v175
    v_cvt_pk_bf16_f32 v101, v171, v167
    v_cvt_pk_bf16_f32 v102, v163, v159
    v_cvt_pk_bf16_f32 v103, v155, v151
    v_and_b32 v103, -2, v103
    ds_write_b128 v40, v[100:103] offset:13056
    s_waitcnt lgkmcnt(0)
    s_barrier
    s_mul_i32 s4, s3, 4352
    s_add_u32 s4, s4, 104448
    v_mul_u32_u24 v40, 272, v3
    v_lshl_add_u32 v40, v2, 4, v40
    v_add_u32 v40, s4, v40
    ds_read_b128 v[148:151], v40 offset:0
    ds_read_b128 v[152:155], v40 offset:1088
    ds_read_b128 v[156:159], v40 offset:2176
    ds_read_b128 v[160:163], v40 offset:3264
    s_lshr_b32 s4, s42, 4
    s_lshl_b32 s4, s4, 6
    s_add_u32 s4, s4, s3
    s_lshl_b32 s4, s4, 12
    s_and_b32 s5, s42, 15
    s_lshl_b32 s5, s5, 8
    s_sub_u32 s4, s4, s5
    s_add_u32 s4, s4, 12586752
    v_lshl_add_u32 v38, v3, 14, s4
    v_lshl_add_u32 v38, v2, 4, v38
    s_waitcnt lgkmcnt(3)
    global_store_dwordx4 v38, v[148:151], s[38:39] sc1
    v_add_u32 v38, 65536, v38
    s_waitcnt lgkmcnt(2)
    global_store_dwordx4 v38, v[152:155], s[38:39] sc1
    v_add_u32 v38, 65536, v38
    s_waitcnt lgkmcnt(1)
    global_store_dwordx4 v38, v[156:159], s[38:39] sc1
    v_add_u32 v38, 65536, v38
    s_waitcnt lgkmcnt(0)
    global_store_dwordx4 v38, v[160:163], s[38:39] sc1
    v_min_u32 v212, 7, v1
    v_add_u32 v212, 56, v212
    v_lshlrev_b32 v212, 1, v212
    v_mov_b32 v213, 1
    s_cmp_lg_u32 s3, 0
    s_cbranch_scc1 Ldb1
    global_load_ushort v213, v212, s[36:37] sc1
Ldb1:
    s_waitcnt vmcnt(10)
    ds_read_b128 v[74:77], v31 offset:4288
    ds_read_b32 v73, v31 offset:4284
    ds_read_b128 v[82:85], v31 offset:5312
    ds_read_b32 v81, v31 offset:5308
    ds_read_b128 v[90:93], v31 offset:6336
    ds_read_b32 v89, v31 offset:6332
    ds_read_b128 v[98:101], v31 offset:7360
    ds_read_b32 v97, v31 offset:7356
    s_waitcnt lgkmcnt(6)
    v_alignbit_b32 v104, v74, v73, 16
    v_alignbit_b32 v105, v75, v74, 16
    v_alignbit_b32 v106, v76, v75, 16
    v_alignbit_b32 v107, v77, v76, 16
    ds_write_b128 v31, v[104:107] offset:64
    s_waitcnt lgkmcnt(5)
    v_alignbit_b32 v108, v82, v81, 16
    v_alignbit_b32 v109, v83, v82, 16
    v_alignbit_b32 v110, v84, v83, 16
    v_alignbit_b32 v111, v85, v84, 16
    ds_write_b128 v31, v[108:111] offset:1088
    s_waitcnt lgkmcnt(4)
    v_alignbit_b32 v112, v90, v89, 16
    v_alignbit_b32 v113, v91, v90, 16
    v_alignbit_b32 v114, v92, v91, 16
    v_alignbit_b32 v115, v93, v92, 16
    ds_write_b128 v31, v[112:115] offset:2112
    s_waitcnt lgkmcnt(3)
    v_alignbit_b32 v116, v98, v97, 16
    v_alignbit_b32 v117, v99, v98, 16
    v_alignbit_b32 v118, v100, v99, 16
    v_alignbit_b32 v119, v101, v100, 16
    ds_write_b128 v31, v[116:119] offset:3136
    ds_read_b64 a[0:1], v30 offset:8
    ds_read_b64 a[2:3], v30 offset:16
    ds_read_b64 a[4:5], v30 offset:72
    ds_read_b64 a[6:7], v30 offset:80
    ds_read_b64 a[8:9], v30 offset:136
    ds_read_b64 a[10:11], v30 offset:144
    ds_read_b64 a[12:13], v30 offset:200
    ds_read_b64 a[14:15], v30 offset:208
    ds_read_b64 a[16:17], v30 offset:264
    ds_read_b64 a[18:19], v30 offset:272
    ds_read_b64 a[20:21], v30 offset:328
    ds_read_b64 a[22:23], v30 offset:336
    ds_read_b64 a[24:25], v30 offset:392
    ds_read_b64 a[26:27], v30 offset:400
    ds_read_b64 a[28:29], v30 offset:456
    ds_read_b64 a[30:31], v30 offset:464
    ds_read_b64 a[32:33], v30 offset:520
    ds_read_b64 a[34:35], v30 offset:528
    ds_read_b64 a[36:37], v30 offset:584
    ds_read_b64 a[38:39], v30 offset:592
    ds_read_b64 a[40:41], v30 offset:648
    ds_read_b64 a[42:43], v30 offset:656
    ds_read_b64 a[44:45], v30 offset:712
    ds_read_b64 a[46:47], v30 offset:720
    ds_read_b64 a[48:49], v30 offset:776
    ds_read_b64 a[50:51], v30 offset:784
    ds_read_b64 a[52:53], v30 offset:840
    ds_read_b64 a[54:55], v30 offset:848
    ds_read_b64 a[56:57], v30 offset:904
    ds_read_b64 a[58:59], v30 offset:912
    ds_read_b64 a[60:61], v30 offset:968
    ds_read_b64 a[62:63], v30 offset:976
    ds_read_b64 a[64:65], v30 offset:1032
    ds_read_b64 a[66:67], v30 offset:1040
    ds_read_b64 a[68:69], v30 offset:1096
    ds_read_b64 a[70:71], v30 offset:1104
    ds_read_b64 a[72:73], v30 offset:1160
    ds_read_b64 a[74:75], v30 offset:1168
    ds_read_b64 a[76:77], v30 offset:1224
    ds_read_b64 a[78:79], v30 offset:1232
    ds_read_b64 a[80:81], v30 offset:1288
    ds_read_b64 a[82:83], v30 offset:1296
    ds_read_b64 a[84:85], v30 offset:1352
    ds_read_b64 a[86:87], v30 offset:1360
    ds_read_b64 a[88:89], v30 offset:1416
    ds_read_b64 a[90:91], v30 offset:1424
    ds_read_b64 a[92:93], v30 offset:1480
    ds_read_b64 a[94:95], v30 offset:1488
    s_mul_i32 s5, s3, 5152
    s_add_u32 s5, s5, 122880
    v_add_u32 v201, s5, v4
    v_lshrrev_b32 v202, 5, v1
    v_lshl_add_u32 v202, v202, 4, v201
    s_waitcnt vmcnt(8)
    ds_write_b128 v201, v[180:183] offset:0
    s_waitcnt vmcnt(7)
    ds_write_b128 v201, v[184:187] offset:1024
    s_waitcnt vmcnt(6)
    ds_write_b128 v202, v[188:191] offset:2048
    s_waitcnt vmcnt(5)
    ds_write_b128 v201, v[192:195] offset:3088
    s_waitcnt vmcnt(4)
    ds_write_b128 v201, v[196:199] offset:4112
    s_lshl_b32 s95, s42, 7
    s_add_u32 s95, s95, 131072
    s_waitcnt vmcnt(0)
    v_cmp_eq_u32 vcc, 0, v213
    s_nop 0
    s_cbranch_vccnz Lic_r
Lic_ok:
    s_waitcnt lgkmcnt(0)
    s_barrier
    v_mov_b32 v29, s95
    s_cmp_lg_u32 s3, 0
    s_cbranch_scc1 Lkf_skip
    global_store_dword v29, v29, s[38:39] sc1
Lkf_skip:
    s_cmp_ge_u32 s42, 128
    s_cbranch_scc1 Lc_j3
    v_mul_u32_u24 v201, 2576, v203
    v_lshl_add_u32 v201, v204, 3, v201
    s_mul_i32 s5, s3, 320
    s_add_u32 s5, s5, 122880
    v_add_u32 v201, s5, v201
    ds_read2_b64 v[180:183], v201 offset0:0 offset1:160
    ds_read2_b64 v[184:187], v201 offset0:8 offset1:168
    ds_read2_b64 v[188:191], v201 offset0:16 offset1:176
    ds_read2_b64 v[192:195], v201 offset0:24 offset1:184
    ds_read2_b64 v[196:199], v201 offset0:32 offset1:192
    s_lshr_b32 s4, s42, 2
    s_mul_i32 s4, s4, 114688
    s_and_b32 s5, s42, 3
    s_lshl_b32 s5, s5, 7
    s_add_u32 s4, s4, s5
    s_mul_i32 s5, s3, 20480
    s_add_u32 s4, s4, s5
    s_add_u32 s4, s4, 1052672
    v_lshl_add_u32 v200, v204, 9, s4
    v_lshl_add_u32 v200, v203, 4, v200
    s_mov_b32 s7, 0x3f803f80
    v_mov_b32 v208, 0
    v_mov_b32 v209, 0
    v_mov_b32 v210, 0
    v_mov_b32 v211, 0
    s_waitcnt lgkmcnt(4)
    v_and_b32 v183, -2, v183
    global_store_dwordx4 v200, v[180:183], s[38:39] offset:-4096 sc1
    s_waitcnt lgkmcnt(3)
    v_and_b32 v187, -2, v187
    global_store_dwordx4 v200, v[184:187], s[38:39] offset:0 sc1
    v_add_u32 v200, 8192, v200
    s_waitcnt lgkmcnt(2)
    v_and_b32 v191, -2, v191
    global_store_dwordx4 v200, v[188:191], s[38:39] offset:-4096 sc1
    s_waitcnt lgkmcnt(1)
    v_and_b32 v195, -2, v195
    global_store_dwordx4 v200, v[192:195], s[38:39] offset:0 sc1
    v_add_u32 v200, 8192, v200
    s_waitcnt lgkmcnt(0)
    v_and_b32 v199, -2, v199
    global_store_dwordx4 v200, v[196:199], s[38:39] offset:-4096 sc1
    v_dot2_f32_bf16 v208, v180, s7, v208
    v_dot2_f32_bf16 v209, v180, v180, v209
    v_dot2_f32_bf16 v210, v182, s7, v210
    v_dot2_f32_bf16 v211, v182, v182, v211
    v_dot2_f32_bf16 v208, v181, s7, v208
    v_dot2_f32_bf16 v209, v181, v181, v209
    v_dot2_f32_bf16 v210, v183, s7, v210
    v_dot2_f32_bf16 v211, v183, v183, v211
    v_dot2_f32_bf16 v208, v184, s7, v208
    v_dot2_f32_bf16 v209, v184, v184, v209
    v_dot2_f32_bf16 v210, v186, s7, v210
    v_dot2_f32_bf16 v211, v186, v186, v211
    v_dot2_f32_bf16 v208, v185, s7, v208
    v_dot2_f32_bf16 v209, v185, v185, v209
    v_dot2_f32_bf16 v210, v187, s7, v210
    v_dot2_f32_bf16 v211, v187, v187, v211
    v_dot2_f32_bf16 v208, v188, s7, v208
    v_dot2_f32_bf16 v209, v188, v188, v209
    v_dot2_f32_bf16 v210, v190, s7, v210
    v_dot2_f32_bf16 v211, v190, v190, v211
    v_dot2_f32_bf16 v208, v189, s7, v208
    v_dot2_f32_bf16 v209, v189, v189, v209
    v_dot2_f32_bf16 v210, v191, s7, v210
    v_dot2_f32_bf16 v211, v191, v191, v211
    v_dot2_f32_bf16 v208, v192, s7, v208
    v_dot2_f32_bf16 v209, v192, v192, v209
    v_dot2_f32_bf16 v210, v194, s7, v210
    v_dot2_f32_bf16 v211, v194, v194, v211
    v_dot2_f32_bf16 v208, v193, s7, v208
    v_dot2_f32_bf16 v209, v193, v193, v209
    v_dot2_f32_bf16 v210, v195, s7, v210
    v_dot2_f32_bf16 v211, v195, v195, v211
    v_dot2_f32_bf16 v208, v196, s7, v208
    v_dot2_f32_bf16 v209, v196, v196, v209
    v_dot2_f32_bf16 v210, v198, s7, v210
    v_dot2_f32_bf16 v211, v198, v198, v211
    v_dot2_f32_bf16 v208, v197, s7, v208
    v_dot2_f32_bf16 v209, v197, v197, v209
    v_dot2_f32_bf16 v210, v199, s7, v210
    v_dot2_f32_bf16 v211, v199, v199, v211
    s_nop 1
    v_permlane32_swap_b32 v208, v210
    v_permlane32_swap_b32 v209, v211
    v_add_f32 v208, v208, v210
    v_add_f32 v209, v209, v211
    s_nop 1
    v_permlane16_swap_b32 v208, v209
    v_add_f32 v208, v208, v209
    v_lshlrev_b32 v201, 4, v203
    v_lshl_add_u32 v201, v3, 2, v201
    v_add_f32_dpp v208, v208, v208 row_ror:8 row_mask:0xf bank_mask:0xf
    s_lshl_b32 s5, s3, 7
    s_add_u32 s5, s5, 143616
    v_add_u32 v201, s5, v201
    ds_write_b32 v201, v208
Lc_j3:
    s_and_b32 s4, s42, -16
    s_lshl_b32 s4, s4, 7
    s_add_u32 s4, s4, 131072
    v_lshl_add_u32 v136, v2, 7, s4
    ds_read_b64 a[96:97], v30 offset:1544
    ds_read_b64 a[98:99], v30 offset:1552
    ds_read_b64 a[100:101], v30 offset:1608
    ds_read_b64 a[102:103], v30 offset:1616
    ds_read_b64 a[104:105], v30 offset:1672
    ds_read_b64 a[106:107], v30 offset:1680
    ds_read_b64 a[108:109], v30 offset:1736
    ds_read_b64 a[110:111], v30 offset:1744
    ds_read_b64 a[112:113], v30 offset:1800
    ds_read_b64 a[114:115], v30 offset:1808
    ds_read_b64 a[116:117], v30 offset:1864
    ds_read_b64 a[118:119], v30 offset:1872
    ds_read_b64 a[120:121], v30 offset:1928
    ds_read_b64 a[122:123], v30 offset:1936
    ds_read_b64 a[124:125], v30 offset:1992
    ds_read_b64 a[126:127], v30 offset:2000
    ds_read_b64 a[128:129], v30 offset:2056
    ds_read_b64 a[130:131], v30 offset:2064
    ds_read_b64 a[132:133], v30 offset:2120
    ds_read_b64 a[134:135], v30 offset:2128
    ds_read_b64 a[136:137], v30 offset:2184
    ds_read_b64 a[138:139], v30 offset:2192
    ds_read_b64 a[140:141], v30 offset:2248
    ds_read_b64 a[142:143], v30 offset:2256
    ds_read_b64 a[144:145], v30 offset:2312
    ds_read_b64 a[146:147], v30 offset:2320
    ds_read_b64 a[148:149], v30 offset:2376
    ds_read_b64 a[150:151], v30 offset:2384
    ds_read_b64 a[152:153], v30 offset:2440
    ds_read_b64 a[154:155], v30 offset:2448
    ds_read_b64 a[156:157], v30 offset:2504
    ds_read_b64 a[158:159], v30 offset:2512
    ds_read_b64 a[160:161], v30 offset:2568
    ds_read_b64 a[162:163], v30 offset:2576
    ds_read_b64 a[164:165], v30 offset:2632
    ds_read_b64 a[166:167], v30 offset:2640
    ds_read_b64 a[168:169], v30 offset:2696
    ds_read_b64 a[170:171], v30 offset:2704
    ds_read_b64 a[172:173], v30 offset:2760
    ds_read_b64 a[174:175], v30 offset:2768
    global_load_dword v137, v136, s[38:39] sc1
    v_min_u32 v41, 49, v1
    v_add_u32 v41, 56, v41
    v_lshlrev_b32 v41, 1, v41
    v_mov_b32 v42, 1
    s_cmp_lg_u32 s3, 0
    s_cbranch_scc1 Ldb2
    global_load_ushort v42, v41, s[36:37] sc1
Ldb2:
    ds_read_b64 a[176:177], v30 offset:2824
    ds_read_b64 a[178:179], v30 offset:2832
    ds_read_b64 a[180:181], v30 offset:2888
    ds_read_b64 a[182:183], v30 offset:2896
    ds_read_b64 a[184:185], v30 offset:2952
    ds_read_b64 a[186:187], v30 offset:2960
    ds_read_b64 a[188:189], v30 offset:3016
    ds_read_b64 a[190:191], v30 offset:3024
    ds_read_b64 a[192:193], v30 offset:3080
    ds_read_b64 a[194:195], v30 offset:3088
    ds_read_b64 a[196:197], v30 offset:3144
    ds_read_b64 a[198:199], v30 offset:3152
    ds_read_b64 a[200:201], v30 offset:3208
    ds_read_b64 a[202:203], v30 offset:3216
    ds_read_b64 a[204:205], v30 offset:3272
    ds_read_b64 a[206:207], v30 offset:3280
    ds_read_b64 a[208:209], v30 offset:3336
    ds_read_b64 a[210:211], v30 offset:3344
    ds_read_b64 a[212:213], v30 offset:3400
    ds_read_b64 a[214:215], v30 offset:3408
    ds_read_b64 a[216:217], v30 offset:3464
    ds_read_b64 a[218:219], v30 offset:3472
    ds_read_b64 a[220:221], v30 offset:3528
    ds_read_b64 a[222:223], v30 offset:3536
    ds_read_b64 a[224:225], v30 offset:3592
    ds_read_b64 a[226:227], v30 offset:3600
    ds_read_b64 a[228:229], v30 offset:3656
    ds_read_b64 a[230:231], v30 offset:3664
    ds_read_b64 a[232:233], v30 offset:3720
    ds_read_b64 a[234:235], v30 offset:3728
    ds_read_b64 a[236:237], v30 offset:3784
    ds_read_b64 a[238:239], v30 offset:3792
    ds_read_b64 a[240:241], v30 offset:3848
    ds_read_b64 a[242:243], v30 offset:3856
    ds_read_b64 a[244:245], v30 offset:3912
    ds_read_b64 a[246:247], v30 offset:3920
    ds_read_b64 a[248:249], v30 offset:3976
    ds_read_b64 a[250:251], v30 offset:3984
    ds_read_b64 a[252:253], v30 offset:4040
    ds_read_b64 a[254:255], v30 offset:4048
    s_add_u32 s4, s94, 12582912
    v_add_u32 v28, s4, v4
    s_waitcnt vmcnt(0) lgkmcnt(0)
    v_cmp_eq_u32 vcc, 0, v42
    s_nop 0
    s_cbranch_vccnz Lic2_r
Lic2_ok:
    s_barrier
    s_cmp_ge_u32 s42, 128
    s_cbranch_scc1 Lc_j5
    s_cmp_lg_u32 s3, 0
    s_cbranch_scc1 Lc_j5
    v_lshlrev_b32 v201, 3, v2
    v_add_u32 v202, 143616, v201
    ds_read_b64 v[212:213], v202 offset:0
    ds_read_b64 v[214:215], v202 offset:128
    ds_read_b64 v[216:217], v202 offset:256
    ds_read_b64 v[218:219], v202 offset:384
    s_waitcnt lgkmcnt(2)
    v_pk_add_f32 v[212:213], v[212:213], v[214:215] op_sel:[0,0] op_sel_hi:[1,1]
    s_waitcnt lgkmcnt(0)
    v_pk_add_f32 v[216:217], v[216:217], v[218:219] op_sel:[0,0] op_sel_hi:[1,1]
    v_pk_add_f32 v[212:213], v[212:213], v[216:217] op_sel:[0,0] op_sel_hi:[1,1]
    v_mul_f32 v212, 0x3acccccd, v212
    v_mul_f32 v213, 0x3acccccd, v213
    v_fma_f32 v213, -v212, v212, v213
    v_max_f32 v213, 0, v213
    v_add_f32 v213, 0x3727c5ac, v213
    v_rsq_f32 v214, v213
    s_nop 0
    v_mul_f32_e64 v213, -v212, v214
    v_mov_b32 v212, v214
    v_min_u32 v212, -2, v212
    v_min_u32 v213, -2, v213
    s_lshl_b32 s5, s42, 7
    s_add_u32 s5, s5, 32768
    v_add_u32 v201, s5, v201
    global_store_dwordx2 v201, v[212:213], s[38:39] sc1
Lc_j5:
    v_cmp_eq_u32 vcc, -1, v137
    s_nop 0
    s_cbranch_vccnz Lkf_r
Lkf_ok:
    s_mul_i32 s5, s3, 9280
    s_add_u32 m0, s5, 33804
    s_nop 0
    global_load_lds_dwordx4 v28, s[38:39] offset:3072 sc1
    s_add_u32 m0, s5, 38448
    s_nop 0
    global_load_lds_dwordx4 v28, s[38:39] offset:3072 sc1
    s_add_u32 m0, s5, 33804
    s_nop 0
    global_load_lds_dwordx4 v28, s[38:39] offset:2048 sc1
    s_add_u32 m0, s5, 38448
    s_nop 0
    global_load_lds_dwordx4 v28, s[38:39] offset:2048 sc1
    s_add_u32 m0, s5, 33804
    s_nop 0
    global_load_lds_dwordx4 v28, s[38:39] offset:1024 sc1
    s_add_u32 m0, s5, 38448
    s_nop 0
    global_load_lds_dwordx4 v28, s[38:39] offset:1024 sc1
    s_add_u32 m0, s5, 33804
    s_nop 0
    global_load_lds_dwordx4 v28, s[38:39] offset:0 sc1
    s_add_u32 m0, s5, 38448
    s_nop 0
    global_load_lds_dwordx4 v28, s[38:39] offset:0 sc1
    s_and_b32 s4, s41, 1
    s_lshl_b32 s5, s3, 1
    s_add_u32 s5, s5, s4
    s_cmp_eq_u32 s5, 7
    s_cselect_b32 s5, 0, s5
    s_mul_i32 s96, s41, 7
    s_add_u32 s96, s96, s5
    s_cmp_lt_u32 s96, 54
    s_cselect_b32 s101, 2, 0
    s_min_u32 s96, s96, 53
    s_cmp_eq_u32 s3, 3
    s_cselect_b32 s101, 1, s101
    s_lshr_b32 s97, s101, 1
    s_cselect_b32 s5, -1, 0
    v_and_b32 v7, s5, v4
    s_add_u32 s97, s97, s96
    s_mul_i32 s4, s96, 20480
    s_add_u32 s5, s4, 7344128
    s_add_u32 s8, s38, s5
    s_addc_u32 s9, s39, 0
    s_add_u32 s5, s4, 7352320
    s_add_u32 s10, s38, s5
    s_addc_u32 s11, s39, 0
    s_add_u32 s5, s4, 7360512
    s_add_u32 s12, s38, s5
    s_addc_u32 s13, s39, 0
    s_mul_i32 s4, s97, 20480
    s_add_u32 s5, s4, 7344128
    s_add_u32 s14, s38, s5
    s_addc_u32 s15, s39, 0
    s_add_u32 s5, s4, 7352320
    s_add_u32 s16, s38, s5
    s_addc_u32 s17, s39, 0
    s_add_u32 s5, s4, 7360512
    s_add_u32 s18, s38, s5
    s_addc_u32 s19, s39, 0
    s_and_b32 s4, s41, 3
    s_cmp_eq_u32 s4, 0
    s_cselect_b32 s5, 8, 0
    s_cmp_le_u32 s4, 1
    s_cselect_b32 s6, 16, 8
    s_cmp_eq_u32 s4, 3
    s_cselect_b32 s50, 16, 24
    s_lshl_b32 s44, s4, 3
    s_bitcmp1_b32 s43, 0
    s_cselect_b32 s46, s6, s5
    s_cselect_b32 s48, s5, s6
    s_lshl_b32 s5, s3, 1
    s_add_u32 s44, s44, s5
    s_add_u32 s45, s44, 1
    s_add_u32 s46, s46, s5
    s_add_u32 s47, s46, 1
    s_add_u32 s48, s48, s5
    s_add_u32 s49, s48, 1
    s_add_u32 s50, s50, s5
    s_add_u32 s51, s50, 1
    s_lshl_b32 s5, s40, 18
    s_lshl_b32 s6, s44, 7
    s_add_u32 s6, s6, s5
    s_add_u32 s68, s24, s6
    s_addc_u32 s69, s25, 0
    s_lshl_b32 s6, s45, 7
    s_add_u32 s6, s6, s5
    s_add_u32 s70, s24, s6
    s_addc_u32 s71, s25, 0
    s_lshl_b32 s6, s46, 7
    s_add_u32 s6, s6, s5
    s_add_u32 s72, s24, s6
    s_addc_u32 s73, s25, 0
    s_lshl_b32 s6, s47, 7
    s_add_u32 s6, s6, s5
    s_add_u32 s74, s24, s6
    s_addc_u32 s75, s25, 0
    s_lshl_b32 s6, s48, 7
    s_add_u32 s6, s6, s5
    s_add_u32 s76, s24, s6
    s_addc_u32 s77, s25, 0
    s_lshl_b32 s6, s49, 7
    s_add_u32 s6, s6, s5
    s_add_u32 s78, s24, s6
    s_addc_u32 s79, s25, 0
    s_lshl_b32 s6, s50, 7
    s_add_u32 s6, s6, s5
    s_add_u32 s80, s24, s6
    s_addc_u32 s81, s25, 0
    s_lshl_b32 s6, s51, 7
    s_add_u32 s6, s6, s5
    s_add_u32 s82, s24, s6
    s_addc_u32 s83, s25, 0
    s_lshl_b32 s89, s3, 14
    s_add_u32 s89, s89, 83200
    v_bfe_u32 v223, v1, 3, 1
    s_sub_u32 s4, s97, s96
    v_mul_u32_u24 v223, s4, v223
    v_add_lshl_u32 v223, v223, s96, 7
    v_mul_u32_u24 v170, 7168, v3
    v_add_u32 v223, v223, v170
    v_and_b32 v170, 112, v4
    v_add_u32 v223, v223, v170
    v_add_u32 v223, 49152, v223
    v_lshrrev_b32 v170, 3, v1
    v_lshlrev_b32 v170, 12, v170
    v_bfe_u32 v171, v1, 4, 1
    v_xor_b32 v171, v171, v1
    v_and_b32 v171, 7, v171
    v_xor_b32 v8, 0, v171
    v_lshl_add_u32 v8, v8, 4, v170
    v_add_u32 v12, 131072, v8
    v_xor_b32 v9, 2, v171
    v_lshl_add_u32 v9, v9, 4, v170
    v_add_u32 v9, 31744, v9
    v_add_u32 v13, 131072, v9
    v_xor_b32 v10, 4, v171
    v_lshl_add_u32 v10, v10, 4, v170
    v_add_u32 v10, 63488, v10
    v_add_u32 v14, 131072, v10
    v_xor_b32 v11, 6, v171
    v_lshl_add_u32 v11, v11, 4, v170
    v_add_u32 v11, 95232, v11
    v_add_u32 v15, 131072, v11
    s_barrier
    s_waitcnt vmcnt(6)
    ds_read_b128 v[72:75], v32 offset:3584
    ds_read_b128 v[76:79], v32 offset:3648
    ds_read_b128 v[80:83], v32 offset:3712
    ds_read_b128 v[84:87], v32 offset:3776
    ds_read_b128 v[88:91], v32 offset:3840
    ds_read_b128 v[92:95], v32 offset:3904
    ds_read_b128 v[96:99], v32 offset:3968
    ds_read_b128 v[100:103], v32 offset:4032
    s_waitcnt lgkmcnt(7)
    v_mfma_f32_16x16x32_bf16 v[40:43], a[0:3], v[72:75], 0
    ds_read_b128 v[104:107], v32 offset:3072
    v_mfma_f32_16x16x32_bf16 v[44:47], a[32:35], v[72:75], 0
    ds_read_b128 v[108:111], v32 offset:3136
    s_waitcnt lgkmcnt(8)
    v_mfma_f32_16x16x32_bf16 v[40:43], a[4:7], v[76:79], v[40:43]
    ds_read_b128 v[112:115], v32 offset:3200
    v_mfma_f32_16x16x32_bf16 v[44:47], a[36:39], v[76:79], v[44:47]
    ds_read_b128 v[116:119], v32 offset:3264
    s_waitcnt lgkmcnt(9)
    v_mfma_f32_16x16x32_bf16 v[40:43], a[8:11], v[80:83], v[40:43]
    ds_read_b128 v[120:123], v32 offset:3328
    v_mfma_f32_16x16x32_bf16 v[44:47], a[40:43], v[80:83], v[44:47]
    ds_read_b128 v[124:127], v32 offset:3392
    s_waitcnt lgkmcnt(10)
    v_mfma_f32_16x16x32_bf16 v[40:43], a[12:15], v[84:87], v[40:43]
    ds_read_b128 v[128:131], v32 offset:3456
    v_mfma_f32_16x16x32_bf16 v[44:47], a[44:47], v[84:87], v[44:47]
    ds_read_b128 v[132:135], v32 offset:3520
    s_waitcnt lgkmcnt(11)
    v_mfma_f32_16x16x32_bf16 v[40:43], a[16:19], v[88:91], v[40:43]
    v_mfma_f32_16x16x32_bf16 v[44:47], a[48:51], v[88:91], v[44:47]
    s_waitcnt lgkmcnt(10)
    v_mfma_f32_16x16x32_bf16 v[40:43], a[20:23], v[92:95], v[40:43]
    v_mfma_f32_16x16x32_bf16 v[44:47], a[52:55], v[92:95], v[44:47]
    s_waitcnt lgkmcnt(9)
    v_mfma_f32_16x16x32_bf16 v[40:43], a[24:27], v[96:99], v[40:43]
    v_mfma_f32_16x16x32_bf16 v[44:47], a[56:59], v[96:99], v[44:47]
    s_waitcnt lgkmcnt(8)
    v_mfma_f32_16x16x32_bf16 v[40:43], a[28:31], v[100:103], v[40:43]
    v_mfma_f32_16x16x32_bf16 v[44:47], a[60:63], v[100:103], v[44:47]
    s_waitcnt lgkmcnt(7)
    v_mfma_f32_16x16x32_bf16 v[44:47], a[0:3], v[104:107], v[44:47]
    s_waitcnt lgkmcnt(6)
    v_mfma_f32_16x16x32_bf16 v[44:47], a[4:7], v[108:111], v[44:47]
    s_waitcnt lgkmcnt(5)
    v_mfma_f32_16x16x32_bf16 v[44:47], a[8:11], v[112:115], v[44:47]
    s_waitcnt lgkmcnt(4)
    v_mfma_f32_16x16x32_bf16 v[44:47], a[12:15], v[116:119], v[44:47]
    s_waitcnt lgkmcnt(3)
    v_mfma_f32_16x16x32_bf16 v[44:47], a[16:19], v[120:123], v[44:47]
    v_mov_b32 v162, 0
    s_waitcnt lgkmcnt(2)
    v_mfma_f32_16x16x32_bf16 v[44:47], a[20:23], v[124:127], v[44:47]
    v_mov_b32 v163, 0
    s_waitcnt lgkmcnt(1)
    v_mfma_f32_16x16x32_bf16 v[44:47], a[24:27], v[128:131], v[44:47]
    v_mov_b32 v164, 0
    s_waitcnt lgkmcnt(0)
    v_mfma_f32_16x16x32_bf16 v[44:47], a[28:31], v[132:135], v[44:47]
    v_mfma_f32_16x16x32_bf16 v[48:51], a[64:67], v[72:75], 0
    v_mov_b32 v165, 0
    v_mfma_f32_16x16x32_bf16 v[52:55], a[96:99], v[72:75], 0
    s_min_u32 s5, s42, 127
    v_mfma_f32_16x16x32_bf16 v[56:59], a[128:131], v[72:75], 0
    v_mfma_f32_16x16x32_bf16 v[60:63], a[160:163], v[72:75], 0
    s_lshl_b32 s4, s5, 13
    v_mfma_f32_16x16x32_bf16 v[64:67], a[192:195], v[72:75], 0
    s_add_u32 s4, s4, 15208448
    v_mfma_f32_16x16x32_bf16 v[68:71], a[224:227], v[72:75], 0
    v_mfma_f32_16x16x32_bf16 v[48:51], a[68:71], v[76:79], v[48:51]
    v_lshl_add_u32 v224, v0, 4, s4
    v_mfma_f32_16x16x32_bf16 v[52:55], a[100:103], v[76:79], v[52:55]
    global_store_dwordx4 v224, v[162:165], s[38:39] offset:-4096 sc1
    v_mfma_f32_16x16x32_bf16 v[56:59], a[132:135], v[76:79], v[56:59]
    v_mfma_f32_16x16x32_bf16 v[60:63], a[164:167], v[76:79], v[60:63]
    global_store_dwordx4 v224, v[162:165], s[38:39] offset:0 sc1
    v_mfma_f32_16x16x32_bf16 v[64:67], a[196:199], v[76:79], v[64:67]
    v_mov_b32 v158, -1
    v_mfma_f32_16x16x32_bf16 v[68:71], a[228:231], v[76:79], v[68:71]
    v_mfma_f32_16x16x32_bf16 v[48:51], a[72:75], v[80:83], v[48:51]
    v_mov_b32 v159, -1
    v_mfma_f32_16x16x32_bf16 v[52:55], a[104:107], v[80:83], v[52:55]
    v_mov_b32 v160, -1
    v_mfma_f32_16x16x32_bf16 v[56:59], a[136:139], v[80:83], v[56:59]
    v_mfma_f32_16x16x32_bf16 v[60:63], a[168:171], v[80:83], v[60:63]
    v_mov_b32 v161, -1
    v_mfma_f32_16x16x32_bf16 v[64:67], a[200:203], v[80:83], v[64:67]
    s_lshr_b32 s4, s5, 2
    v_mfma_f32_16x16x32_bf16 v[68:71], a[232:235], v[80:83], v[68:71]
    s_mul_i32 s4, s4, 114688
    v_mfma_f32_16x16x32_bf16 v[48:51], a[76:79], v[84:87], v[48:51]
    v_mfma_f32_16x16x32_bf16 v[52:55], a[108:111], v[84:87], v[52:55]
    s_and_b32 s5, s5, 3
    v_mfma_f32_16x16x32_bf16 v[56:59], a[140:143], v[84:87], v[56:59]
    s_lshl_b32 s5, s5, 13
    v_mfma_f32_16x16x32_bf16 v[60:63], a[172:175], v[84:87], v[60:63]
    v_mfma_f32_16x16x32_bf16 v[64:67], a[204:207], v[84:87], v[64:67]
    s_add_u32 s4, s4, s5
    v_mfma_f32_16x16x32_bf16 v[68:71], a[236:239], v[84:87], v[68:71]
    s_add_u32 s4, s4, 1134592
    v_mfma_f32_16x16x32_bf16 v[48:51], a[80:83], v[88:91], v[48:51]
    v_mfma_f32_16x16x32_bf16 v[52:55], a[112:115], v[88:91], v[52:55]
    v_lshl_add_u32 v224, v0, 4, s4
    v_mfma_f32_16x16x32_bf16 v[56:59], a[144:147], v[88:91], v[56:59]
    global_store_dwordx4 v224, v[158:161], s[38:39] offset:-4096 sc1
    v_mfma_f32_16x16x32_bf16 v[60:63], a[176:179], v[88:91], v[60:63]
    v_mfma_f32_16x16x32_bf16 v[64:67], a[208:211], v[88:91], v[64:67]
    global_store_dwordx4 v224, v[158:161], s[38:39] offset:0 sc1
    v_mfma_f32_16x16x32_bf16 v[68:71], a[240:243], v[88:91], v[68:71]
    s_min_u32 s4, s42, 127
    v_mfma_f32_16x16x32_bf16 v[48:51], a[84:87], v[92:95], v[48:51]
    v_mfma_f32_16x16x32_bf16 v[52:55], a[116:119], v[92:95], v[52:55]
    s_lshl_b32 s4, s4, 10
    v_mfma_f32_16x16x32_bf16 v[56:59], a[148:151], v[92:95], v[56:59]
    s_add_u32 s4, s4, 12451840
    v_mfma_f32_16x16x32_bf16 v[60:63], a[180:183], v[92:95], v[60:63]
    v_mfma_f32_16x16x32_bf16 v[64:67], a[212:215], v[92:95], v[64:67]
    v_lshl_add_u32 v224, v0, 2, s4
    v_mfma_f32_16x16x32_bf16 v[68:71], a[244:247], v[92:95], v[68:71]
    global_store_dword v224, v158, s[38:39] sc1
    v_mfma_f32_16x16x32_bf16 v[48:51], a[88:91], v[96:99], v[48:51]
    v_mfma_f32_16x16x32_bf16 v[52:55], a[120:123], v[96:99], v[52:55]
    v_mfma_f32_16x16x32_bf16 v[56:59], a[152:155], v[96:99], v[56:59]
    v_mfma_f32_16x16x32_bf16 v[60:63], a[184:187], v[96:99], v[60:63]
    v_mfma_f32_16x16x32_bf16 v[64:67], a[216:219], v[96:99], v[64:67]
    v_mfma_f32_16x16x32_bf16 v[68:71], a[248:251], v[96:99], v[68:71]
    v_mfma_f32_16x16x32_bf16 v[48:51], a[92:95], v[100:103], v[48:51]
    v_mfma_f32_16x16x32_bf16 v[52:55], a[124:127], v[100:103], v[52:55]
    v_mfma_f32_16x16x32_bf16 v[56:59], a[156:159], v[100:103], v[56:59]
    v_mfma_f32_16x16x32_bf16 v[60:63], a[188:191], v[100:103], v[60:63]
    v_mfma_f32_16x16x32_bf16 v[64:67], a[220:223], v[100:103], v[64:67]
    v_mfma_f32_16x16x32_bf16 v[68:71], a[252:255], v[100:103], v[68:71]
    v_mfma_f32_16x16x32_bf16 v[48:51], a[32:35], v[104:107], v[48:51]
    v_mfma_f32_16x16x32_bf16 v[52:55], a[64:67], v[104:107], v[52:55]
    v_mfma_f32_16x16x32_bf16 v[56:59], a[96:99], v[104:107], v[56:59]
    v_mfma_f32_16x16x32_bf16 v[60:63], a[128:131], v[104:107], v[60:63]
    v_mfma_f32_16x16x32_bf16 v[64:67], a[160:163], v[104:107], v[64:67]
    v_mfma_f32_16x16x32_bf16 v[68:71], a[192:195], v[104:107], v[68:71]
    v_mfma_f32_16x16x32_bf16 v[48:51], a[36:39], v[108:111], v[48:51]
    v_mfma_f32_16x16x32_bf16 v[52:55], a[68:71], v[108:111], v[52:55]
    v_mfma_f32_16x16x32_bf16 v[56:59], a[100:103], v[108:111], v[56:59]
    v_mfma_f32_16x16x32_bf16 v[60:63], a[132:135], v[108:111], v[60:63]
    v_mfma_f32_16x16x32_bf16 v[64:67], a[164:167], v[108:111], v[64:67]
    v_mfma_f32_16x16x32_bf16 v[68:71], a[196:199], v[108:111], v[68:71]
    v_mfma_f32_16x16x32_bf16 v[48:51], a[40:43], v[112:115], v[48:51]
    v_mfma_f32_16x16x32_bf16 v[52:55], a[72:75], v[112:115], v[52:55]
    v_mfma_f32_16x16x32_bf16 v[56:59], a[104:107], v[112:115], v[56:59]
    v_mfma_f32_16x16x32_bf16 v[60:63], a[136:139], v[112:115], v[60:63]
    v_mfma_f32_16x16x32_bf16 v[64:67], a[168:171], v[112:115], v[64:67]
    v_mfma_f32_16x16x32_bf16 v[68:71], a[200:203], v[112:115], v[68:71]
    v_mfma_f32_16x16x32_bf16 v[48:51], a[44:47], v[116:119], v[48:51]
    v_mfma_f32_16x16x32_bf16 v[52:55], a[76:79], v[116:119], v[52:55]
    v_mfma_f32_16x16x32_bf16 v[56:59], a[108:111], v[116:119], v[56:59]
    v_mfma_f32_16x16x32_bf16 v[60:63], a[140:143], v[116:119], v[60:63]
    v_mfma_f32_16x16x32_bf16 v[64:67], a[172:175], v[116:119], v[64:67]
    v_mfma_f32_16x16x32_bf16 v[68:71], a[204:207], v[116:119], v[68:71]
    v_mfma_f32_16x16x32_bf16 v[48:51], a[48:51], v[120:123], v[48:51]
    v_mfma_f32_16x16x32_bf16 v[52:55], a[80:83], v[120:123], v[52:55]
    v_mfma_f32_16x16x32_bf16 v[56:59], a[112:115], v[120:123], v[56:59]
    v_mfma_f32_16x16x32_bf16 v[60:63], a[144:147], v[120:123], v[60:63]
    v_mfma_f32_16x16x32_bf16 v[64:67], a[176:179], v[120:123], v[64:67]
    v_mfma_f32_16x16x32_bf16 v[68:71], a[208:211], v[120:123], v[68:71]
    v_mfma_f32_16x16x32_bf16 v[48:51], a[52:55], v[124:127], v[48:51]
    v_mfma_f32_16x16x32_bf16 v[52:55], a[84:87], v[124:127], v[52:55]
    v_mfma_f32_16x16x32_bf16 v[56:59], a[116:119], v[124:127], v[56:59]
    v_lshlrev_b32 v28, 4, v0
    v_add_u32 v28, 36864, v28
    v_mfma_f32_16x16x32_bf16 v[60:63], a[148:151], v[124:127], v[60:63]
    global_load_dwordx4 v[202:205], v28, s[38:39] offset:-4096 sc1
    v_mfma_f32_16x16x32_bf16 v[64:67], a[180:183], v[124:127], v[64:67]
    global_load_dwordx4 v[206:209], v28, s[38:39] offset:0 sc1
    v_mfma_f32_16x16x32_bf16 v[68:71], a[212:215], v[124:127], v[68:71]
    v_add_u32 v28, 8192, v28
    global_load_dwordx4 v[210:213], v28, s[38:39] offset:-4096 sc1
    v_mfma_f32_16x16x32_bf16 v[48:51], a[56:59], v[128:131], v[48:51]
    s_waitcnt vmcnt(12)
    ds_read_b128 v[72:75], v32 offset:2560
    global_load_dwordx4 v[214:217], v28, s[38:39] offset:0 sc1
    v_mfma_f32_16x16x32_bf16 v[52:55], a[88:91], v[128:131], v[52:55]
    v_min_u32 v28, 11, v1
    ds_read_b128 v[76:79], v32 offset:2624
    v_mfma_f32_16x16x32_bf16 v[56:59], a[120:123], v[128:131], v[56:59]
    v_lshrrev_b32 v29, 2, v28
    ds_read_b128 v[80:83], v32 offset:2688
    v_mfma_f32_16x16x32_bf16 v[60:63], a[152:155], v[128:131], v[60:63]
    v_mul_u32_u24 v29, 2544, v29
    ds_read_b128 v[84:87], v32 offset:2752
    v_mfma_f32_16x16x32_bf16 v[64:67], a[184:187], v[128:131], v[64:67]
    v_lshl_add_u32 v28, v28, 2, v29
    ds_read_b128 v[88:91], v32 offset:2816
    s_lshl_b32 s4, s42, 4
    v_mfma_f32_16x16x32_bf16 v[68:71], a[216:219], v[128:131], v[68:71]
    ds_read_b128 v[92:95], v32 offset:2880
    s_add_u32 s4, s4, 0
    v_add_u32 v28, s4, v28
    v_mfma_f32_16x16x32_bf16 v[48:51], a[60:63], v[132:135], v[48:51]
    ds_read_b128 v[96:99], v32 offset:2944
    global_load_dword v182, v28, s[38:39] sc1
    v_mfma_f32_16x16x32_bf16 v[52:55], a[92:95], v[132:135], v[52:55]
    ds_read_b128 v[100:103], v32 offset:3008
    v_add_u32 v28, 15360, v28
    v_mfma_f32_16x16x32_bf16 v[56:59], a[124:127], v[132:135], v[56:59]
    global_load_dword v183, v28, s[38:39] sc1
    v_mfma_f32_16x16x32_bf16 v[60:63], a[156:159], v[132:135], v[60:63]
    v_mfma_f32_16x16x32_bf16 v[64:67], a[188:191], v[132:135], v[64:67]
    global_load_dwordx4 v[218:221], v223, s[38:39] sc1
    v_mfma_f32_16x16x32_bf16 v[68:71], a[220:223], v[132:135], v[68:71]
    s_waitcnt lgkmcnt(7)
    v_mfma_f32_16x16x32_bf16 v[48:51], a[0:3], v[72:75], v[48:51]
    ds_read_b128 v[104:107], v32 offset:2048
    v_mfma_f32_16x16x32_bf16 v[52:55], a[32:35], v[72:75], v[52:55]
    ds_read_b128 v[108:111], v32 offset:2112
    s_waitcnt lgkmcnt(8)
    v_mfma_f32_16x16x32_bf16 v[48:51], a[4:7], v[76:79], v[48:51]
    ds_read_b128 v[112:115], v32 offset:2176
    v_mfma_f32_16x16x32_bf16 v[52:55], a[36:39], v[76:79], v[52:55]
    ds_read_b128 v[116:119], v32 offset:2240
    s_waitcnt lgkmcnt(9)
    v_mfma_f32_16x16x32_bf16 v[48:51], a[8:11], v[80:83], v[48:51]
    ds_read_b128 v[120:123], v32 offset:2304
    v_mfma_f32_16x16x32_bf16 v[52:55], a[40:43], v[80:83], v[52:55]
    ds_read_b128 v[124:127], v32 offset:2368
    s_waitcnt lgkmcnt(10)
    v_mfma_f32_16x16x32_bf16 v[48:51], a[12:15], v[84:87], v[48:51]
    ds_read_b128 v[128:131], v32 offset:2432
    v_mfma_f32_16x16x32_bf16 v[52:55], a[44:47], v[84:87], v[52:55]
    ds_read_b128 v[132:135], v32 offset:2496
    s_waitcnt lgkmcnt(11)
    v_mfma_f32_16x16x32_bf16 v[48:51], a[16:19], v[88:91], v[48:51]
    v_mfma_f32_16x16x32_bf16 v[52:55], a[48:51], v[88:91], v[52:55]
    s_waitcnt lgkmcnt(10)
    v_mfma_f32_16x16x32_bf16 v[48:51], a[20:23], v[92:95], v[48:51]
    v_mfma_f32_16x16x32_bf16 v[52:55], a[52:55], v[92:95], v[52:55]
    s_waitcnt lgkmcnt(9)
    v_mfma_f32_16x16x32_bf16 v[48:51], a[24:27], v[96:99], v[48:51]
    v_mfma_f32_16x16x32_bf16 v[52:55], a[56:59], v[96:99], v[52:55]
    s_waitcnt lgkmcnt(8)
    v_mfma_f32_16x16x32_bf16 v[48:51], a[28:31], v[100:103], v[48:51]
    v_mfma_f32_16x16x32_bf16 v[52:55], a[60:63], v[100:103], v[52:55]
    s_waitcnt lgkmcnt(7)
    v_mfma_f32_16x16x32_bf16 v[52:55], a[0:3], v[104:107], v[52:55]
    s_waitcnt lgkmcnt(6)
    v_mfma_f32_16x16x32_bf16 v[52:55], a[4:7], v[108:111], v[52:55]
    s_waitcnt lgkmcnt(5)
    v_mfma_f32_16x16x32_bf16 v[52:55], a[8:11], v[112:115], v[52:55]
    s_waitcnt lgkmcnt(4)
    v_mfma_f32_16x16x32_bf16 v[52:55], a[12:15], v[116:119], v[52:55]
    s_waitcnt lgkmcnt(3)
    v_mfma_f32_16x16x32_bf16 v[52:55], a[16:19], v[120:123], v[52:55]
    s_waitcnt lgkmcnt(2)
    v_mfma_f32_16x16x32_bf16 v[52:55], a[20:23], v[124:127], v[52:55]
    s_waitcnt lgkmcnt(1)
    v_mfma_f32_16x16x32_bf16 v[52:55], a[24:27], v[128:131], v[52:55]
    s_waitcnt lgkmcnt(0)
    v_mfma_f32_16x16x32_bf16 v[52:55], a[28:31], v[132:135], v[52:55]
    v_mfma_f32_16x16x32_bf16 v[56:59], a[64:67], v[72:75], v[56:59]
    v_mfma_f32_16x16x32_bf16 v[60:63], a[96:99], v[72:75], v[60:63]
    v_mfma_f32_16x16x32_bf16 v[64:67], a[128:131], v[72:75], v[64:67]
    v_mfma_f32_16x16x32_bf16 v[68:71], a[160:163], v[72:75], v[68:71]
    v_mfma_f32_16x16x32_bf16 v[56:59], a[68:71], v[76:79], v[56:59]
    v_mfma_f32_16x16x32_bf16 v[60:63], a[100:103], v[76:79], v[60:63]
    v_mfma_f32_16x16x32_bf16 v[64:67], a[132:135], v[76:79], v[64:67]
    v_mfma_f32_16x16x32_bf16 v[68:71], a[164:167], v[76:79], v[68:71]
    v_mfma_f32_16x16x32_bf16 v[56:59], a[72:75], v[80:83], v[56:59]
    s_waitcnt vmcnt(0)
    v_max_u32 v224, v218, v219
    v_mfma_f32_16x16x32_bf16 v[60:63], a[104:107], v[80:83], v[60:63]
    v_max3_u32 v224, v220, v221, v224
    v_mfma_f32_16x16x32_bf16 v[64:67], a[136:139], v[80:83], v[64:67]
    v_cmp_eq_u32 vcc, -1, v224
    v_mfma_f32_16x16x32_bf16 v[68:71], a[168:171], v[80:83], v[68:71]
    s_cbranch_vccnz Lcu_r
Lcu_ok:
    v_mfma_f32_16x16x32_bf16 v[56:59], a[76:79], v[84:87], v[56:59]
    v_cvt_pk_bf16_f32 v138, v40, v41
    global_load_dwordx4 a[248:251], v4, s[12:13] offset:-1024 sc1
    v_mfma_f32_16x16x32_bf16 v[60:63], a[108:111], v[84:87], v[60:63]
    v_mfma_f32_16x16x32_bf16 v[64:67], a[140:143], v[84:87], v[64:67]
    v_cvt_pk_bf16_f32 v139, v42, v43
    v_mfma_f32_16x16x32_bf16 v[68:71], a[172:175], v[84:87], v[68:71]
    ds_write2_b32 v34, v138, v139 offset0:0 offset1:2
    v_mfma_f32_16x16x32_bf16 v[56:59], a[80:83], v[88:91], v[56:59]
    v_cvt_pk_bf16_f32 v140, v44, v45
    v_max_u32 v224, v203, v205
    v_mfma_f32_16x16x32_bf16 v[60:63], a[112:115], v[88:91], v[60:63]
    v_cvt_pk_bf16_f32 v141, v46, v47
    v_max3_u32 v224, v207, v209, v224
    v_mfma_f32_16x16x32_bf16 v[64:67], a[144:147], v[88:91], v[64:67]
    v_max3_u32 v224, v211, v213, v224
    ds_write2_b32 v34, v140, v141 offset0:128 offset1:130
    v_mfma_f32_16x16x32_bf16 v[68:71], a[176:179], v[88:91], v[68:71]
    v_max3_u32 v224, v215, v217, v224
    v_add_u32 v34, 4224, v34
    v_mfma_f32_16x16x32_bf16 v[56:59], a[84:87], v[92:95], v[56:59]
    v_max3_u32 v224, v182, v183, v224
    v_cmp_eq_u32 vcc, -1, v224
    s_nop 0
    s_cbranch_vccnz Lax_r
Lax_ok:
    v_mfma_f32_16x16x32_bf16 v[60:63], a[116:119], v[92:95], v[60:63]
    v_cvt_pk_bf16_f32 v138, v48, v49
    v_cvt_pk_bf16_f32 v139, v50, v51
    v_mfma_f32_16x16x32_bf16 v[64:67], a[148:151], v[92:95], v[64:67]
    v_add_u32 v36, 0, v37
    ds_write2_b32 v34, v138, v139 offset0:0 offset1:2
    s_add_u32 m0, s89, 0
    v_mfma_f32_16x16x32_bf16 v[68:71], a[180:183], v[92:95], v[68:71]
    global_load_dwordx4 v[186:189], v36, s[38:39] sc1
    v_add_u32 v36, 917504, v37
    v_mfma_f32_16x16x32_bf16 v[56:59], a[88:91], v[96:99], v[56:59]
    v_cvt_pk_bf16_f32 v140, v52, v53
    global_load_dwordx4 v[190:193], v36, s[38:39] sc1
    v_mfma_f32_16x16x32_bf16 v[60:63], a[120:123], v[96:99], v[60:63]
    v_cvt_pk_bf16_f32 v141, v54, v55
    v_add_u32 v36, 1835008, v37
    v_mfma_f32_16x16x32_bf16 v[64:67], a[152:155], v[96:99], v[64:67]
    ds_write2_b32 v34, v140, v141 offset0:128 offset1:130
    global_load_dwordx4 v[194:197], v36, s[38:39] sc1
    v_mfma_f32_16x16x32_bf16 v[68:71], a[184:187], v[96:99], v[68:71]
    v_add_u32 v36, 2752512, v37
    v_add_u32 v34, 4224, v34
    v_mfma_f32_16x16x32_bf16 v[56:59], a[92:95], v[100:103], v[56:59]
    s_waitcnt lgkmcnt(0)
    s_barrier
    global_load_dwordx4 v[198:201], v36, s[38:39] sc1
    v_mfma_f32_16x16x32_bf16 v[60:63], a[124:127], v[100:103], v[60:63]
    v_add_f32 v182, v182, v183
    v_cvt_pk_bf16_f32 v182, v182, v182
    v_mfma_f32_16x16x32_bf16 v[64:67], a[156:159], v[100:103], v[64:67]
    v_lshlrev_b32 v182, 16, v182
    global_load_dwordx4 a[252:255], v7, s[18:19] offset:-1024 sc1
    v_mfma_f32_16x16x32_bf16 v[68:71], a[188:191], v[100:103], v[68:71]
    v_mov_b32 v29, 1.0
    s_nop 1
    v_add_f32_dpp v182, v182, v29 quad_perm:[0,1,2,3] row_mask:0xf bank_mask:0x2
    v_mfma_f32_16x16x32_bf16 v[56:59], a[32:35], v[104:107], v[56:59]
    v_cvt_pk_bf16_f32 v182, v182, v182
    v_lshlrev_b32 v182, 16, v182
    v_mfma_f32_16x16x32_bf16 v[60:63], a[64:67], v[104:107], v[60:63]
    s_nop 0
    v_mul_f32_dpp v183, v182, v182 row_shl:8 row_mask:0xf bank_mask:0x1
    s_nop 1
    v_mul_f32_dpp v183, v182, v182 row_shl:4 row_mask:0xf bank_mask:0x2
    v_mfma_f32_16x16x32_bf16 v[64:67], a[96:99], v[104:107], v[64:67]
    v_readlane_b32 s64, v183, 0
    global_load_lds_dwordx4 v8, s[68:69] offset:0
    v_mfma_f32_16x16x32_bf16 v[68:71], a[128:131], v[104:107], v[68:71]
    v_readlane_b32 s65, v183, 1
    v_readlane_b32 s66, v183, 2
    v_mfma_f32_16x16x32_bf16 v[56:59], a[36:39], v[108:111], v[56:59]
    v_readlane_b32 s67, v183, 3
    v_readlane_b32 s60, v183, 4
    v_mfma_f32_16x16x32_bf16 v[60:63], a[68:71], v[108:111], v[60:63]
    v_readlane_b32 s61, v183, 5
    v_readlane_b32 s62, v183, 6
    v_mfma_f32_16x16x32_bf16 v[64:67], a[100:103], v[108:111], v[64:67]
    v_readlane_b32 s63, v183, 7
    v_mov_b32 v178, s64
    v_mfma_f32_16x16x32_bf16 v[68:71], a[132:135], v[108:111], v[68:71]
    v_mov_b32 v179, s65
    global_load_lds_dwordx4 v9, s[68:69] offset:1024
    v_mfma_f32_16x16x32_bf16 v[56:59], a[40:43], v[112:115], v[56:59]
    v_mov_b32 v180, s66
    v_mov_b32 v181, s67
    v_mfma_f32_16x16x32_bf16 v[60:63], a[72:75], v[112:115], v[60:63]
    global_load_dwordx4 a[240:243], v4, s[12:13] offset:-2048 sc1
    v_mfma_f32_16x16x32_bf16 v[64:67], a[104:107], v[112:115], v[64:67]
    v_mfma_f32_16x16x32_bf16 v[68:71], a[136:139], v[112:115], v[68:71]
    v_mfma_f32_16x16x32_bf16 v[56:59], a[44:47], v[116:119], v[56:59]
    global_load_lds_dwordx4 v10, s[68:69] offset:2048
    v_mfma_f32_16x16x32_bf16 v[60:63], a[76:79], v[116:119], v[60:63]
    v_mfma_f32_16x16x32_bf16 v[64:67], a[108:111], v[116:119], v[64:67]
    v_mfma_f32_16x16x32_bf16 v[68:71], a[140:143], v[116:119], v[68:71]
    v_mfma_f32_16x16x32_bf16 v[56:59], a[48:51], v[120:123], v[56:59]
    v_mfma_f32_16x16x32_bf16 v[60:63], a[80:83], v[120:123], v[60:63]
    v_mfma_f32_16x16x32_bf16 v[64:67], a[112:115], v[120:123], v[64:67]
    v_mfma_f32_16x16x32_bf16 v[68:71], a[144:147], v[120:123], v[68:71]
    global_load_dwordx4 a[244:247], v7, s[18:19] offset:-2048 sc1
    v_mfma_f32_16x16x32_bf16 v[56:59], a[52:55], v[124:127], v[56:59]
    ds_read_b128 v[72:75], v32 offset:1536
    global_load_lds_dwordx4 v11, s[68:69] offset:3072
    v_mfma_f32_16x16x32_bf16 v[60:63], a[84:87], v[124:127], v[60:63]
    ds_read_b128 v[76:79], v32 offset:1600
    v_mfma_f32_16x16x32_bf16 v[64:67], a[116:119], v[124:127], v[64:67]
    ds_read_b128 v[80:83], v32 offset:1664
    v_mfma_f32_16x16x32_bf16 v[68:71], a[148:151], v[124:127], v[68:71]
    ds_read_b128 v[84:87], v32 offset:1728
    v_mfma_f32_16x16x32_bf16 v[56:59], a[56:59], v[128:131], v[56:59]
    ds_read_b128 v[88:91], v32 offset:1792
    v_mfma_f32_16x16x32_bf16 v[60:63], a[88:91], v[128:131], v[60:63]
    ds_read_b128 v[92:95], v32 offset:1856
    v_mfma_f32_16x16x32_bf16 v[64:67], a[120:123], v[128:131], v[64:67]
    ds_read_b128 v[96:99], v32 offset:1920
    v_mfma_f32_16x16x32_bf16 v[68:71], a[152:155], v[128:131], v[68:71]
    ds_read_b128 v[100:103], v32 offset:1984
    s_add_u32 m0, s89, 4096
    v_mfma_f32_16x16x32_bf16 v[56:59], a[60:63], v[132:135], v[56:59]
    v_mfma_f32_16x16x32_bf16 v[60:63], a[92:95], v[132:135], v[60:63]
    v_mfma_f32_16x16x32_bf16 v[64:67], a[124:127], v[132:135], v[64:67]
    v_mfma_f32_16x16x32_bf16 v[68:71], a[156:159], v[132:135], v[68:71]
    s_waitcnt lgkmcnt(7)
    v_mfma_f32_16x16x32_bf16 v[56:59], a[0:3], v[72:75], v[56:59]
    ds_read_b128 v[104:107], v32 offset:1024
    global_load_dwordx4 a[232:235], v4, s[12:13] offset:-3072 sc1
    v_mfma_f32_16x16x32_bf16 v[60:63], a[32:35], v[72:75], v[60:63]
    ds_read_b128 v[108:111], v32 offset:1088
    s_waitcnt lgkmcnt(8)
    v_mfma_f32_16x16x32_bf16 v[56:59], a[4:7], v[76:79], v[56:59]
    ds_read_b128 v[112:115], v32 offset:1152
    v_mfma_f32_16x16x32_bf16 v[60:63], a[36:39], v[76:79], v[60:63]
    ds_read_b128 v[116:119], v32 offset:1216
    global_load_lds_dwordx4 v12, s[68:69] offset:0
    s_waitcnt lgkmcnt(9)
    v_mfma_f32_16x16x32_bf16 v[56:59], a[8:11], v[80:83], v[56:59]
    ds_read_b128 v[120:123], v32 offset:1280
    ds_read_b32 v150, v35 offset:0
    v_mfma_f32_16x16x32_bf16 v[60:63], a[40:43], v[80:83], v[60:63]
    ds_read_b128 v[124:127], v32 offset:1344
    ds_read_b32 v151, v35 offset:1056
    s_waitcnt lgkmcnt(12)
    v_mfma_f32_16x16x32_bf16 v[56:59], a[12:15], v[84:87], v[56:59]
    ds_read_b128 v[128:131], v32 offset:1408
    ds_read_b32 v152, v35 offset:2112
    v_mfma_f32_16x16x32_bf16 v[60:63], a[44:47], v[84:87], v[60:63]
    ds_read_b128 v[132:135], v32 offset:1472
    ds_read_b32 v153, v35 offset:3168
    s_waitcnt lgkmcnt(15)
    v_mfma_f32_16x16x32_bf16 v[56:59], a[16:19], v[88:91], v[56:59]
    ds_read_b32 v154, v33 offset:3072
    ds_read_b32 v155, v33 offset:12352
    v_mfma_f32_16x16x32_bf16 v[60:63], a[48:51], v[88:91], v[60:63]
    ds_read_b32 v156, v33 offset:21632
    ds_read_b32 v157, v33 offset:30912
    s_waitcnt lgkmcnt(15)
    v_mfma_f32_16x16x32_bf16 v[56:59], a[20:23], v[92:95], v[56:59]
    s_waitcnt vmcnt(12)
    v_lshlrev_b32 v158, 16, v186
    v_and_b32 v159, 0xffff0000, v186
    v_mfma_f32_16x16x32_bf16 v[60:63], a[52:55], v[92:95], v[60:63]
    v_lshlrev_b32 v160, 16, v187
    v_and_b32 v161, 0xffff0000, v187
    v_mfma_f32_16x16x32_bf16 v[56:59], a[24:27], v[96:99], v[56:59]
    v_lshlrev_b32 v162, 16, v188
    v_and_b32 v163, 0xffff0000, v188
    v_mfma_f32_16x16x32_bf16 v[60:63], a[56:59], v[96:99], v[60:63]
    v_lshlrev_b32 v164, 16, v189
    global_load_lds_dwordx4 v13, s[68:69] offset:1024
    v_mfma_f32_16x16x32_bf16 v[56:59], a[28:31], v[100:103], v[56:59]
    v_and_b32 v165, 0xffff0000, v189
    v_fma_f32 v166, v158, v202, v203
    v_mfma_f32_16x16x32_bf16 v[60:63], a[60:63], v[100:103], v[60:63]
    v_fma_f32 v167, v159, v202, v203
    v_fma_f32 v168, v160, v202, v203
    v_mfma_f32_16x16x32_bf16 v[60:63], a[0:3], v[104:107], v[60:63]
    global_load_dwordx4 a[236:239], v7, s[18:19] offset:-3072 sc1
    v_fma_f32 v169, v161, v202, v203
    s_waitcnt lgkmcnt(14)
    v_mfma_f32_16x16x32_bf16 v[60:63], a[4:7], v[108:111], v[60:63]
    v_fma_f32 v170, v162, v204, v205
    v_fma_f32 v171, v163, v204, v205
    s_waitcnt lgkmcnt(13)
    v_mfma_f32_16x16x32_bf16 v[60:63], a[8:11], v[112:115], v[60:63]
    v_fma_f32 v172, v164, v204, v205
    v_fma_f32 v173, v165, v204, v205
    s_waitcnt lgkmcnt(12)
    v_mfma_f32_16x16x32_bf16 v[60:63], a[12:15], v[116:119], v[60:63]
    v_fma_f32 v166, v166, s60, v178
    v_fma_f32 v167, v167, s61, v179
    s_waitcnt lgkmcnt(11)
    v_mfma_f32_16x16x32_bf16 v[60:63], a[16:19], v[120:123], v[60:63]
    v_fma_f32 v168, v168, s62, v180
    global_load_lds_dwordx4 v14, s[68:69] offset:2048
    s_waitcnt lgkmcnt(9)
    v_mfma_f32_16x16x32_bf16 v[60:63], a[20:23], v[124:127], v[60:63]
    v_fma_f32 v169, v169, s63, v181
    v_fma_f32 v170, v170, s60, v178
    s_waitcnt lgkmcnt(7)
    v_mfma_f32_16x16x32_bf16 v[60:63], a[24:27], v[128:131], v[60:63]
    v_fma_f32 v171, v171, s61, v179
    v_fma_f32 v172, v172, s62, v180
    s_waitcnt lgkmcnt(5)
    v_mfma_f32_16x16x32_bf16 v[60:63], a[28:31], v[132:135], v[60:63]
    v_fma_f32 v173, v173, s63, v181
    v_lshlrev_b32 v142, 16, v150
    v_mfma_f32_16x16x32_bf16 v[64:67], a[64:67], v[72:75], v[64:67]
    v_and_b32 v146, 0xffff0000, v150
    v_lshlrev_b32 v143, 16, v151
    v_mfma_f32_16x16x32_bf16 v[68:71], a[96:99], v[72:75], v[68:71]
    v_and_b32 v147, 0xffff0000, v151
    v_lshlrev_b32 v144, 16, v152
    v_mfma_f32_16x16x32_bf16 v[64:67], a[68:71], v[76:79], v[64:67]
    v_and_b32 v148, 0xffff0000, v152
    s_waitcnt lgkmcnt(4)
    v_lshlrev_b32 v145, 16, v153
    v_mfma_f32_16x16x32_bf16 v[68:71], a[100:103], v[76:79], v[68:71]
    v_and_b32 v149, 0xffff0000, v153
    global_load_lds_dwordx4 v15, s[68:69] offset:3072
    v_mfma_f32_16x16x32_bf16 v[64:67], a[72:75], v[80:83], v[64:67]
    s_waitcnt lgkmcnt(3)
    v_and_b32 v174, 0xffff0000, v154
    s_waitcnt lgkmcnt(2)
    v_and_b32 v175, 0xffff0000, v155
    v_mfma_f32_16x16x32_bf16 v[68:71], a[104:107], v[80:83], v[68:71]
    s_waitcnt lgkmcnt(1)
    v_and_b32 v176, 0xffff0000, v156
    global_load_dwordx4 a[224:227], v4, s[12:13] offset:-4096 sc1
    v_mfma_f32_16x16x32_bf16 v[64:67], a[76:79], v[84:87], v[64:67]
    s_waitcnt lgkmcnt(0)
    v_and_b32 v177, 0xffff0000, v157
    v_fmac_f32 v142, s52, v174
    v_mfma_f32_16x16x32_bf16 v[68:71], a[108:111], v[84:87], v[68:71]
    v_fmac_f32 v143, s53, v175
    v_fmac_f32 v144, s54, v176
    v_mfma_f32_16x16x32_bf16 v[64:67], a[80:83], v[88:91], v[64:67]
    v_fmac_f32 v145, s55, v177
    v_lshlrev_b32 v174, 16, v154
    v_mfma_f32_16x16x32_bf16 v[68:71], a[112:115], v[88:91], v[68:71]
    v_lshlrev_b32 v175, 16, v155
    v_lshlrev_b32 v176, 16, v156
    v_mfma_f32_16x16x32_bf16 v[64:67], a[84:87], v[92:95], v[64:67]
    v_lshlrev_b32 v177, 16, v157
    v_fmac_f32 v146, s52, v174
    v_mfma_f32_16x16x32_bf16 v[68:71], a[116:119], v[92:95], v[68:71]
    v_fmac_f32 v147, s53, v175
    v_fmac_f32 v148, s54, v176
    v_mfma_f32_16x16x32_bf16 v[64:67], a[88:91], v[96:99], v[64:67]
    v_fmac_f32 v149, s55, v177
    v_fma_f32 v158, v166, v142, v158
    v_mfma_f32_16x16x32_bf16 v[68:71], a[120:123], v[96:99], v[68:71]
    v_fma_f32 v159, v167, v143, v159
    v_fma_f32 v160, v168, v144, v160
    v_mfma_f32_16x16x32_bf16 v[64:67], a[92:95], v[100:103], v[64:67]
    v_fma_f32 v161, v169, v145, v161
    v_fma_f32 v162, v170, v146, v162
    v_mfma_f32_16x16x32_bf16 v[68:71], a[124:127], v[100:103], v[68:71]
    v_fma_f32 v163, v171, v147, v163
    v_fma_f32 v164, v172, v148, v164
    v_mfma_f32_16x16x32_bf16 v[64:67], a[32:35], v[104:107], v[64:67]
    v_fma_f32 v165, v173, v149, v165
    v_cvt_pk_bf16_f32 v186, v158, v159
    v_mfma_f32_16x16x32_bf16 v[68:71], a[64:67], v[104:107], v[68:71]
    v_cvt_pk_bf16_f32 v187, v160, v161
    v_mfma_f32_16x16x32_bf16 v[64:67], a[36:39], v[108:111], v[64:67]
    v_cvt_pk_bf16_f32 v188, v162, v163
    global_load_dwordx4 a[228:231], v7, s[18:19] offset:-4096 sc1
    v_mfma_f32_16x16x32_bf16 v[68:71], a[68:71], v[108:111], v[68:71]
    v_cvt_pk_bf16_f32 v189, v164, v165
    v_or_b32 v189, 1, v189
    v_mfma_f32_16x16x32_bf16 v[64:67], a[40:43], v[112:115], v[64:67]
    v_add_u32 v136, 0, v37
    global_store_dwordx4 v136, v[186:189], s[38:39] sc1
    v_mfma_f32_16x16x32_bf16 v[68:71], a[72:75], v[112:115], v[68:71]
    ds_read_b128 v[72:75], v32 offset:512
    ds_read_b128 v[76:79], v32 offset:576
    v_mfma_f32_16x16x32_bf16 v[64:67], a[44:47], v[116:119], v[64:67]
    v_cvt_pk_bf16_f32 v138, v56, v57
    ds_read_b128 v[80:83], v32 offset:640
    v_mfma_f32_16x16x32_bf16 v[68:71], a[76:79], v[116:119], v[68:71]
    v_cvt_pk_bf16_f32 v139, v58, v59
    ds_read_b128 v[84:87], v32 offset:704
    v_mfma_f32_16x16x32_bf16 v[64:67], a[48:51], v[120:123], v[64:67]
    ds_write2_b32 v34, v138, v139 offset0:0 offset1:2
    ds_read_b128 v[88:91], v32 offset:768
    v_mfma_f32_16x16x32_bf16 v[68:71], a[80:83], v[120:123], v[68:71]
    v_cvt_pk_bf16_f32 v140, v60, v61
    ds_read_b128 v[92:95], v32 offset:832
    v_mfma_f32_16x16x32_bf16 v[64:67], a[52:55], v[124:127], v[64:67]
    v_cvt_pk_bf16_f32 v141, v62, v63
    ds_read_b128 v[96:99], v32 offset:896
    v_mfma_f32_16x16x32_bf16 v[68:71], a[84:87], v[124:127], v[68:71]
    ds_read_b128 v[100:103], v32 offset:960
    ds_write2_b32 v34, v140, v141 offset0:128 offset1:130
    v_mfma_f32_16x16x32_bf16 v[64:67], a[56:59], v[128:131], v[64:67]
    v_add_u32 v34, 4224, v34
    s_waitcnt lgkmcnt(0)
    s_barrier
    v_mfma_f32_16x16x32_bf16 v[68:71], a[88:91], v[128:131], v[68:71]
    v_mfma_f32_16x16x32_bf16 v[64:67], a[60:63], v[132:135], v[64:67]
    v_mfma_f32_16x16x32_bf16 v[68:71], a[92:95], v[132:135], v[68:71]
    global_load_dwordx4 a[216:219], v4, s[10:11] offset:3072 sc1
    ds_read_b128 v[104:107], v32 offset:0
    ds_read_b128 v[108:111], v32 offset:64
    ds_read_b128 v[112:115], v32 offset:128
    ds_read_b128 v[116:119], v32 offset:192
    ds_read_b128 v[120:123], v32 offset:256
    ds_read_b128 v[124:127], v32 offset:320
    ds_read_b128 v[128:131], v32 offset:384
    ds_read_b128 v[132:135], v32 offset:448
    ds_read_b32 v150, v35 offset:4224
    ds_read_b32 v151, v35 offset:5280
    ds_read_b32 v152, v35 offset:6336
    ds_read_b32 v153, v35 offset:7392
    ds_read_b32 v154, v33 offset:2048
    ds_read_b32 v155, v33 offset:11328
    ds_read_b32 v156, v33 offset:20608
    ds_read_b32 v157, v33 offset:29888
    s_waitcnt vmcnt(19)
    v_lshlrev_b32 v158, 16, v190
    global_load_dwordx4 a[220:223], v7, s[16:17] offset:3072 sc1
    v_and_b32 v159, 0xffff0000, v190
    v_lshlrev_b32 v160, 16, v191
    v_and_b32 v161, 0xffff0000, v191
    v_lshlrev_b32 v162, 16, v192
    v_and_b32 v163, 0xffff0000, v192
    v_lshlrev_b32 v164, 16, v193
    v_and_b32 v165, 0xffff0000, v193
    v_pk_fma_f32 v[166:167], v[206:207], v[158:159], v[206:207] op_sel:[0,0,1] op_sel_hi:[0,1,1]
    v_pk_fma_f32 v[168:169], v[206:207], v[160:161], v[206:207] op_sel:[0,0,1] op_sel_hi:[0,1,1]
    v_pk_fma_f32 v[170:171], v[208:209], v[162:163], v[208:209] op_sel:[0,0,1] op_sel_hi:[0,1,1]
    v_pk_fma_f32 v[172:173], v[208:209], v[164:165], v[208:209] op_sel:[0,0,1] op_sel_hi:[0,1,1]
    v_pk_fma_f32 v[166:167], v[166:167], s[60:61], v[178:179] op_sel:[0,0,0] op_sel_hi:[1,1,1]
    v_pk_fma_f32 v[168:169], v[168:169], s[62:63], v[180:181] op_sel:[0,0,0] op_sel_hi:[1,1,1]
    v_pk_fma_f32 v[170:171], v[170:171], s[60:61], v[178:179] op_sel:[0,0,0] op_sel_hi:[1,1,1]
    v_pk_fma_f32 v[172:173], v[172:173], s[62:63], v[180:181] op_sel:[0,0,0] op_sel_hi:[1,1,1]
    s_waitcnt lgkmcnt(7)
    v_lshlrev_b32 v142, 16, v150
    v_and_b32 v146, 0xffff0000, v150
    global_load_dwordx4 a[208:211], v4, s[10:11] offset:2048 sc1
    s_waitcnt lgkmcnt(6)
    v_lshlrev_b32 v143, 16, v151
    v_and_b32 v147, 0xffff0000, v151
    s_waitcnt lgkmcnt(5)
    v_lshlrev_b32 v144, 16, v152
    v_and_b32 v148, 0xffff0000, v152
    s_waitcnt lgkmcnt(4)
    v_lshlrev_b32 v145, 16, v153
    v_and_b32 v149, 0xffff0000, v153
    s_waitcnt lgkmcnt(3)
    v_dot2_f32_bf16 v142, v154, s52, v142
    s_waitcnt lgkmcnt(2)
    v_dot2_f32_bf16 v143, v155, s53, v143
    s_waitcnt lgkmcnt(1)
    v_dot2_f32_bf16 v144, v156, s54, v144
    s_waitcnt lgkmcnt(0)
    v_dot2_f32_bf16 v145, v157, s55, v145
    v_dot2_f32_bf16 v146, v154, s56, v146
    v_dot2_f32_bf16 v147, v155, s57, v147
    v_dot2_f32_bf16 v148, v156, s58, v148
    v_dot2_f32_bf16 v149, v157, s59, v149
    v_pk_fma_f32 v[158:159], v[166:167], v[142:143], v[158:159] op_sel:[0,0,0] op_sel_hi:[1,1,1]
    v_pk_fma_f32 v[160:161], v[168:169], v[144:145], v[160:161] op_sel:[0,0,0] op_sel_hi:[1,1,1]
    v_pk_fma_f32 v[162:163], v[170:171], v[146:147], v[162:163] op_sel:[0,0,0] op_sel_hi:[1,1,1]
    global_load_dwordx4 a[212:215], v7, s[16:17] offset:2048 sc1
    v_pk_fma_f32 v[164:165], v[172:173], v[148:149], v[164:165] op_sel:[0,0,0] op_sel_hi:[1,1,1]
    v_cvt_pk_bf16_f32 v190, v158, v159
    v_cvt_pk_bf16_f32 v191, v160, v161
    v_cvt_pk_bf16_f32 v192, v162, v163
    v_cvt_pk_bf16_f32 v193, v164, v165
    v_or_b32 v193, 1, v193
    v_add_u32 v136, 917504, v37
    global_store_dwordx4 v136, v[190:193], s[38:39] sc1
    ds_read_b32 v150, v35 offset:8448
    ds_read_b32 v151, v35 offset:9504
    ds_read_b32 v152, v35 offset:10560
    ds_read_b32 v153, v35 offset:11616
    ds_read_b32 v154, v33 offset:1024
    ds_read_b32 v155, v33 offset:10304
    ds_read_b32 v156, v33 offset:19584
    ds_read_b32 v157, v33 offset:28864
    s_waitcnt vmcnt(22)
    v_lshlrev_b32 v158, 16, v194
    v_and_b32 v159, 0xffff0000, v194
    global_load_dwordx4 a[200:203], v4, s[10:11] offset:1024 sc1
    v_lshlrev_b32 v160, 16, v195
    v_and_b32 v161, 0xffff0000, v195
    v_lshlrev_b32 v162, 16, v196
    v_and_b32 v163, 0xffff0000, v196
    v_lshlrev_b32 v164, 16, v197
    v_and_b32 v165, 0xffff0000, v197
    v_pk_fma_f32 v[166:167], v[210:211], v[158:159], v[210:211] op_sel:[0,0,1] op_sel_hi:[0,1,1]
    v_pk_fma_f32 v[168:169], v[210:211], v[160:161], v[210:211] op_sel:[0,0,1] op_sel_hi:[0,1,1]
    v_pk_fma_f32 v[170:171], v[212:213], v[162:163], v[212:213] op_sel:[0,0,1] op_sel_hi:[0,1,1]
    v_pk_fma_f32 v[172:173], v[212:213], v[164:165], v[212:213] op_sel:[0,0,1] op_sel_hi:[0,1,1]
    v_pk_fma_f32 v[166:167], v[166:167], s[60:61], v[178:179] op_sel:[0,0,0] op_sel_hi:[1,1,1]
    v_pk_fma_f32 v[168:169], v[168:169], s[62:63], v[180:181] op_sel:[0,0,0] op_sel_hi:[1,1,1]
    v_pk_fma_f32 v[170:171], v[170:171], s[60:61], v[178:179] op_sel:[0,0,0] op_sel_hi:[1,1,1]
    v_pk_fma_f32 v[172:173], v[172:173], s[62:63], v[180:181] op_sel:[0,0,0] op_sel_hi:[1,1,1]
    s_waitcnt lgkmcnt(7)
    v_lshlrev_b32 v142, 16, v150
    v_and_b32 v146, 0xffff0000, v150
    s_waitcnt lgkmcnt(6)
    v_lshlrev_b32 v143, 16, v151
    global_load_dwordx4 a[204:207], v7, s[16:17] offset:1024 sc1
    v_and_b32 v147, 0xffff0000, v151
    s_waitcnt lgkmcnt(5)
    v_lshlrev_b32 v144, 16, v152
    v_and_b32 v148, 0xffff0000, v152
    s_waitcnt lgkmcnt(4)
    v_lshlrev_b32 v145, 16, v153
    v_and_b32 v149, 0xffff0000, v153
    s_waitcnt lgkmcnt(3)
    v_dot2_f32_bf16 v142, v154, s52, v142
    s_waitcnt lgkmcnt(2)
    v_dot2_f32_bf16 v143, v155, s53, v143
    s_waitcnt lgkmcnt(1)
    v_dot2_f32_bf16 v144, v156, s54, v144
    s_waitcnt lgkmcnt(0)
    v_dot2_f32_bf16 v145, v157, s55, v145
    v_dot2_f32_bf16 v146, v154, s56, v146
    v_dot2_f32_bf16 v147, v155, s57, v147
    v_dot2_f32_bf16 v148, v156, s58, v148
    v_dot2_f32_bf16 v149, v157, s59, v149
    v_pk_fma_f32 v[158:159], v[166:167], v[142:143], v[158:159] op_sel:[0,0,0] op_sel_hi:[1,1,1]
    v_pk_fma_f32 v[160:161], v[168:169], v[144:145], v[160:161] op_sel:[0,0,0] op_sel_hi:[1,1,1]
    v_pk_fma_f32 v[162:163], v[170:171], v[146:147], v[162:163] op_sel:[0,0,0] op_sel_hi:[1,1,1]
    v_pk_fma_f32 v[164:165], v[172:173], v[148:149], v[164:165] op_sel:[0,0,0] op_sel_hi:[1,1,1]
    global_load_dwordx4 a[192:195], v4, s[10:11] offset:0 sc1
    v_cvt_pk_bf16_f32 v194, v158, v159
    v_cvt_pk_bf16_f32 v195, v160, v161
    v_cvt_pk_bf16_f32 v196, v162, v163
    v_cvt_pk_bf16_f32 v197, v164, v165
    v_or_b32 v197, 1, v197
    v_add_u32 v136, 1835008, v37
    global_store_dwordx4 v136, v[194:197], s[38:39] sc1
    v_mfma_f32_16x16x32_bf16 v[64:67], a[0:3], v[72:75], v[64:67]
    v_mfma_f32_16x16x32_bf16 v[68:71], a[32:35], v[72:75], v[68:71]
    v_mfma_f32_16x16x32_bf16 v[64:67], a[4:7], v[76:79], v[64:67]
    v_mfma_f32_16x16x32_bf16 v[68:71], a[36:39], v[76:79], v[68:71]
    v_mfma_f32_16x16x32_bf16 v[64:67], a[8:11], v[80:83], v[64:67]
    v_mfma_f32_16x16x32_bf16 v[68:71], a[40:43], v[80:83], v[68:71]
    v_mfma_f32_16x16x32_bf16 v[64:67], a[12:15], v[84:87], v[64:67]
    v_mfma_f32_16x16x32_bf16 v[68:71], a[44:47], v[84:87], v[68:71]
    v_mfma_f32_16x16x32_bf16 v[64:67], a[16:19], v[88:91], v[64:67]
    v_mfma_f32_16x16x32_bf16 v[68:71], a[48:51], v[88:91], v[68:71]
    v_mfma_f32_16x16x32_bf16 v[64:67], a[20:23], v[92:95], v[64:67]
    global_load_dwordx4 a[196:199], v7, s[16:17] offset:0 sc1
    v_mfma_f32_16x16x32_bf16 v[68:71], a[52:55], v[92:95], v[68:71]
    v_mfma_f32_16x16x32_bf16 v[64:67], a[24:27], v[96:99], v[64:67]
    v_mfma_f32_16x16x32_bf16 v[68:71], a[56:59], v[96:99], v[68:71]
    v_mfma_f32_16x16x32_bf16 v[64:67], a[28:31], v[100:103], v[64:67]
    v_mfma_f32_16x16x32_bf16 v[68:71], a[60:63], v[100:103], v[68:71]
    v_mfma_f32_16x16x32_bf16 v[68:71], a[0:3], v[104:107], v[68:71]
    v_mfma_f32_16x16x32_bf16 v[68:71], a[4:7], v[108:111], v[68:71]
    v_mfma_f32_16x16x32_bf16 v[68:71], a[8:11], v[112:115], v[68:71]
    v_mfma_f32_16x16x32_bf16 v[68:71], a[12:15], v[116:119], v[68:71]
    v_mfma_f32_16x16x32_bf16 v[68:71], a[16:19], v[120:123], v[68:71]
    v_mfma_f32_16x16x32_bf16 v[68:71], a[20:23], v[124:127], v[68:71]
    v_mfma_f32_16x16x32_bf16 v[68:71], a[24:27], v[128:131], v[68:71]
    v_mfma_f32_16x16x32_bf16 v[68:71], a[28:31], v[132:135], v[68:71]
    v_cvt_pk_bf16_f32 v138, v64, v65
    v_cvt_pk_bf16_f32 v139, v66, v67
    ds_write2_b32 v34, v138, v139 offset0:0 offset1:2
    s_nop 4
    v_cvt_pk_bf16_f32 v140, v68, v69
    global_load_dwordx4 a[184:187], v4, s[10:11] offset:-1024 sc1
    v_cvt_pk_bf16_f32 v141, v70, v71
    ds_write2_b32 v34, v140, v141 offset0:128 offset1:130
    s_waitcnt lgkmcnt(0)
    s_barrier
    ds_read_b32 v150, v35 offset:12672
    ds_read_b32 v151, v35 offset:13728
    ds_read_b32 v152, v35 offset:14784
    ds_read_b32 v153, v35 offset:15840
    ds_read_b32 v154, v33 offset:0
    ds_read_b32 v155, v33 offset:9280
    ds_read_b32 v156, v33 offset:18560
    ds_read_b32 v157, v33 offset:27840
    s_waitcnt vmcnt(27)
    v_lshlrev_b32 v158, 16, v198
    v_and_b32 v159, 0xffff0000, v198
    v_lshlrev_b32 v160, 16, v199
    v_and_b32 v161, 0xffff0000, v199
    v_lshlrev_b32 v162, 16, v200
    global_load_dwordx4 a[188:191], v7, s[16:17] offset:-1024 sc1
    v_and_b32 v163, 0xffff0000, v200
    v_lshlrev_b32 v164, 16, v201
    v_and_b32 v165, 0xffff0000, v201
    v_pk_fma_f32 v[166:167], v[214:215], v[158:159], v[214:215] op_sel:[0,0,1] op_sel_hi:[0,1,1]
    v_pk_fma_f32 v[168:169], v[214:215], v[160:161], v[214:215] op_sel:[0,0,1] op_sel_hi:[0,1,1]
    v_pk_fma_f32 v[170:171], v[216:217], v[162:163], v[216:217] op_sel:[0,0,1] op_sel_hi:[0,1,1]
    v_pk_fma_f32 v[172:173], v[216:217], v[164:165], v[216:217] op_sel:[0,0,1] op_sel_hi:[0,1,1]
    v_pk_fma_f32 v[166:167], v[166:167], s[60:61], v[178:179] op_sel:[0,0,0] op_sel_hi:[1,1,1]
    v_pk_fma_f32 v[168:169], v[168:169], s[62:63], v[180:181] op_sel:[0,0,0] op_sel_hi:[1,1,1]
    v_pk_fma_f32 v[170:171], v[170:171], s[60:61], v[178:179] op_sel:[0,0,0] op_sel_hi:[1,1,1]
    v_pk_fma_f32 v[172:173], v[172:173], s[62:63], v[180:181] op_sel:[0,0,0] op_sel_hi:[1,1,1]
    s_waitcnt lgkmcnt(7)
    v_lshlrev_b32 v142, 16, v150
    v_and_b32 v146, 0xffff0000, v150
    s_waitcnt lgkmcnt(6)
    v_lshlrev_b32 v143, 16, v151
    v_and_b32 v147, 0xffff0000, v151
    s_waitcnt lgkmcnt(5)
    v_lshlrev_b32 v144, 16, v152
    v_and_b32 v148, 0xffff0000, v152
    s_waitcnt lgkmcnt(4)
    v_lshlrev_b32 v145, 16, v153
    v_and_b32 v149, 0xffff0000, v153
    s_waitcnt lgkmcnt(3)
    v_dot2_f32_bf16 v142, v154, s52, v142
    s_waitcnt lgkmcnt(2)
    v_dot2_f32_bf16 v143, v155, s53, v143
    s_waitcnt lgkmcnt(1)
    v_dot2_f32_bf16 v144, v156, s54, v144
    s_waitcnt lgkmcnt(0)
    v_dot2_f32_bf16 v145, v157, s55, v145
    v_dot2_f32_bf16 v146, v154, s56, v146
    v_dot2_f32_bf16 v147, v155, s57, v147
    v_dot2_f32_bf16 v148, v156, s58, v148
    v_dot2_f32_bf16 v149, v157, s59, v149
    v_pk_fma_f32 v[158:159], v[166:167], v[142:143], v[158:159] op_sel:[0,0,0] op_sel_hi:[1,1,1]
    v_pk_fma_f32 v[160:161], v[168:169], v[144:145], v[160:161] op_sel:[0,0,0] op_sel_hi:[1,1,1]
    v_pk_fma_f32 v[162:163], v[170:171], v[146:147], v[162:163] op_sel:[0,0,0] op_sel_hi:[1,1,1]
    v_pk_fma_f32 v[164:165], v[172:173], v[148:149], v[164:165] op_sel:[0,0,0] op_sel_hi:[1,1,1]
    v_cvt_pk_bf16_f32 v198, v158, v159
    v_cvt_pk_bf16_f32 v199, v160, v161
    v_cvt_pk_bf16_f32 v200, v162, v163
    v_cvt_pk_bf16_f32 v201, v164, v165
    v_or_b32 v201, 1, v201
    v_add_u32 v136, 2752512, v37
    global_store_dwordx4 v136, v[198:201], s[38:39] sc1
    s_waitcnt lgkmcnt(0)
    s_barrier
    global_load_dwordx4 a[176:179], v4, s[10:11] offset:-2048 sc1
    global_load_dwordx4 a[180:183], v7, s[16:17] offset:-2048 sc1
    global_load_dwordx4 a[168:171], v4, s[10:11] offset:-3072 sc1
    global_load_dwordx4 a[172:175], v7, s[16:17] offset:-3072 sc1
    global_load_dwordx4 a[160:163], v4, s[10:11] offset:-4096 sc1
    global_load_dwordx4 a[164:167], v7, s[16:17] offset:-4096 sc1
    global_load_dwordx4 a[152:155], v4, s[8:9] offset:3072 sc1
    global_load_dwordx4 a[156:159], v7, s[14:15] offset:3072 sc1
    global_load_dwordx4 a[144:147], v4, s[8:9] offset:2048 sc1
    global_load_dwordx4 a[148:151], v7, s[14:15] offset:2048 sc1
    global_load_dwordx4 a[136:139], v4, s[8:9] offset:1024 sc1
    global_load_dwordx4 a[140:143], v7, s[14:15] offset:1024 sc1
    global_load_dwordx4 a[128:131], v4, s[8:9] offset:0 sc1
    global_load_dwordx4 a[132:135], v7, s[14:15] offset:0 sc1
    v_permlane32_swap_b32 v218, v220
    v_permlane32_swap_b32 v219, v221
    s_lshl_b32 s4, s3, 9
    s_add_u32 s4, s4, 156672
    v_and_b32 v223, 496, v4
    v_add_f32 v218, v218, v220
    v_add_f32 v219, v219, v221
    v_bfe_u32 v220, v1, 3, 1
    v_cmp_gt_u32 vcc, s101, v220
    v_lshrrev_b32 v220, 5, v1
    v_lshl_add_u32 v223, v220, 3, v223
    v_cndmask_b32 v218, 0, v218, vcc
    v_cndmask_b32 v219, 0, v219, vcc
    v_add_u32 v223, s4, v223
    ds_write_b64 v223, v[218:219]
Ljoin:
    v_and_b32 v28, 7, v1
    v_lshl_add_u32 v28, v3, 3, v28
    v_bfe_u32 v29, v1, 3, 1
    v_lshlrev_b32 v66, 9, v29
    v_lshl_add_u32 v66, v28, 4, v66
    s_mul_i32 s4, s3, 20480
    s_mul_i32 s5, s40, 114688
    s_add_u32 s4, s4, s5
    s_add_u32 s4, s4, 1048576
    v_add_u32 v66, s4, v66
    v_lshl_add_u32 v70, v28, 1, v29
    v_min_u32 v72, 39, v1
    v_lshl_add_u32 v72, v72, 9, s4
    s_cmp_lt_u32 s43, 5
    s_cbranch_scc1 Lx_first
Lx_redo:
    s_branch Lxp_f
Lxp:
    s_sleep 1
Lxp_f:
    global_load_dword v71, v72, s[38:39] offset:508 sc1
    s_waitcnt vmcnt(0)
    v_and_b32 v71, 1, v71
    v_cmp_ne_u32 vcc, 1, v71
    s_add_u32 s100, s100, 1
    s_cmp_ge_u32 s100, 262144
    s_cbranch_scc1 Lxp_x
    s_cbranch_vccnz Lxp
Lxp_x:
Lx_first:
    s_mov_b32 s7, 0x3f803f80
    v_add_u32 v67, 4096, v66
    global_load_dwordx4 v[98:101], v67, s[38:39] offset:-4096 sc1
    global_load_dwordx4 v[102:105], v67, s[38:39] offset:-3072 sc1
    global_load_dwordx4 v[106:109], v67, s[38:39] offset:-2048 sc1
    global_load_dwordx4 v[110:113], v67, s[38:39] offset:-1024 sc1
    global_load_dwordx4 v[114:117], v67, s[38:39] offset:0 sc1
    global_load_dwordx4 v[118:121], v67, s[38:39] offset:1024 sc1
    global_load_dwordx4 v[122:125], v67, s[38:39] offset:2048 sc1
    global_load_dwordx4 v[126:129], v67, s[38:39] offset:3072 sc1
    v_add_u32 v67, 8192, v67
    global_load_dwordx4 v[130:133], v67, s[38:39] offset:-4096 sc1
    global_load_dwordx4 v[134:137], v67, s[38:39] offset:-3072 sc1
    v_lshrrev_b32 v28, 5, v1
    v_bfe_u32 v68, v1, 1, 1
    v_lshl_add_u32 v28, v28, 1, v68
    v_mul_u32_u24 v68, 1040, v28
    v_bfe_u32 v28, v1, 3, 1
    v_lshl_add_u32 v68, v28, 3, v68
    v_bfe_u32 v28, v1, 2, 1
    v_lshl_add_u32 v68, v28, 6, v68
    v_bfe_u32 v28, v1, 4, 1
    v_lshl_add_u32 v68, v28, 7, v68
    v_bfe_u32 v28, v1, 0, 1
    v_lshl_add_u32 v68, v28, 5, v68
    s_mul_i32 s5, s3, 20800
    v_add_u32 v68, s5, v68
    v_lshlrev_b32 v30, 3, v1
    s_lshl_b32 s88, s3, 9
    v_lshrrev_b32 v28, 3, v1
    v_lshlrev_b32 v28, 12, v28
    v_bfe_u32 v29, v1, 4, 1
    v_xor_b32 v29, v29, v1
    v_and_b32 v29, 7, v29
    v_xor_b32 v74, 0, v29
    v_lshl_add_u32 v74, v74, 4, v28
    v_add_u32 v78, 131072, v74
    v_xor_b32 v75, 2, v29
    v_lshl_add_u32 v75, v75, 4, v28
    v_add_u32 v75, 31744, v75
    v_add_u32 v79, 131072, v75
    v_xor_b32 v76, 4, v29
    v_lshl_add_u32 v76, v76, 4, v28
    v_add_u32 v76, 63488, v76
    v_add_u32 v80, 131072, v76
    v_xor_b32 v77, 6, v29
    v_lshl_add_u32 v77, v77, 4, v28
    v_add_u32 v77, 95232, v77
    v_add_u32 v81, 131072, v77
    v_lshrrev_b32 v29, 1, v2
    v_xor_b32 v29, v29, v3
    v_lshlrev_b32 v29, 4, v29
    v_lshl_add_u32 v29, v5, 7, v29
    s_xor_b32 s4, s3, 0
    s_lshr_b32 s5, s4, 1
    s_lshl_b32 s5, s5, 12
    s_and_b32 s4, s4, 1
    s_lshl_b32 s4, s4, 9
    s_add_u32 s4, s4, s5
    s_add_u32 s4, s4, s89
    v_add_u32 v82, s4, v29
    v_xor_b32 v83, 64, v82
    s_xor_b32 s4, s3, 1
    s_lshr_b32 s5, s4, 1
    s_lshl_b32 s5, s5, 12
    s_and_b32 s4, s4, 1
    s_lshl_b32 s4, s4, 9
    s_add_u32 s4, s4, s5
    s_add_u32 s4, s4, s89
    v_add_u32 v84, s4, v29
    v_xor_b32 v85, 64, v84
    s_xor_b32 s4, s3, 2
    s_lshr_b32 s5, s4, 1
    s_lshl_b32 s5, s5, 12
    s_and_b32 s4, s4, 1
    s_lshl_b32 s4, s4, 9
    s_add_u32 s4, s4, s5
    s_add_u32 s4, s4, s89
    v_add_u32 v86, s4, v29
    v_xor_b32 v87, 64, v86
    s_xor_b32 s4, s3, 3
    s_lshr_b32 s5, s4, 1
    s_lshl_b32 s5, s5, 12
    s_and_b32 s4, s4, 1
    s_lshl_b32 s4, s4, 9
    s_add_u32 s4, s4, s5
    s_add_u32 s4, s4, s89
    v_add_u32 v88, s4, v29
    v_xor_b32 v89, 64, v88
    s_add_u32 s52, s8, 1146880
    s_addc_u32 s53, s9, 0
    s_add_u32 s54, s10, 1146880
    s_addc_u32 s55, s11, 0
    s_add_u32 s56, s12, 1146880
    s_addc_u32 s57, s13, 0
    s_add_u32 s58, s14, 1146880
    s_addc_u32 s59, s15, 0
    s_add_u32 s60, s16, 1146880
    s_addc_u32 s61, s17, 0
    s_add_u32 s62, s18, 1146880
    s_addc_u32 s63, s19, 0
    s_mov_b32 s84, 0xc0135761
    s_mov_b32 s85, 0xbdd2d3e8
    v_lshlrev_b32 v32, 16, v27
    v_lshlrev_b32 v33, 16, v27
    v_lshlrev_b32 v34, 16, v27
    v_lshlrev_b32 v35, 16, v27
    s_mul_i32 s5, s41, 10
    s_mul_i32 s6, s3, 1040
    v_add_u32 v28, s5, v3
    v_lshrrev_b32 v29, 2, v28
    v_mul_u32_u24 v29, 3136, v29
    v_lshl_add_u32 v29, v28, 8, v29
    v_lshl_add_u32 v29, v2, 4, v29
    v_add_u32 v46, s6, v29
    v_lshrrev_b32 v28, 1, v3
    v_add_u32 v28, s5, v28
    v_lshrrev_b32 v29, 2, v28
    v_mul_u32_u24 v29, 3136, v29
    v_lshl_add_u32 v29, v28, 8, v29
    v_lshl_add_u32 v29, v2, 4, v29
    v_add_u32 v47, s6, v29
    v_and_b32 v28, 1, v3
    v_lshl_add_u32 v47, v28, 3, v47
    v_mov_b32 v62, 0
    v_mov_b32 v63, 0
    v_mov_b32 v64, 0
    v_mov_b32 v65, 0
    v_mov_b32 v71, -1
    global_load_dwordx4 v[138:141], v67, s[38:39] offset:-2048 sc1
    v_add_u32 v69, 0, v68
    s_waitcnt vmcnt(10)
    ds_write2_b64 v69, v[98:99], v[100:101] offset0:0 offset1:2
    v_dot2_f32_bf16 v62, v98, s7, v62
    v_dot2_f32_bf16 v63, v98, v98, v63
    v_dot2_f32_bf16 v64, v100, s7, v64
    v_dot2_f32_bf16 v65, v100, v100, v65
    v_dot2_f32_bf16 v62, v99, s7, v62
    v_dot2_f32_bf16 v63, v99, v99, v63
    v_dot2_f32_bf16 v64, v101, s7, v64
    v_dot2_f32_bf16 v65, v101, v101, v65
    global_load_dwordx4 v[142:145], v67, s[38:39] offset:-1024 sc1
    s_waitcnt vmcnt(10)
    ds_write2_b64 v69, v[102:103], v[104:105] offset0:32 offset1:34
    v_bitop3_b32 v71, v101, v105, v71 bitop3:0x80
    v_dot2_f32_bf16 v62, v102, s7, v62
    v_dot2_f32_bf16 v63, v102, v102, v63
    v_dot2_f32_bf16 v64, v104, s7, v64
    v_dot2_f32_bf16 v65, v104, v104, v65
    v_dot2_f32_bf16 v62, v103, s7, v62
    v_dot2_f32_bf16 v63, v103, v103, v63
    v_dot2_f32_bf16 v64, v105, s7, v64
    v_dot2_f32_bf16 v65, v105, v105, v65
    global_load_dwordx4 v[146:149], v67, s[38:39] offset:0 sc1
    s_waitcnt vmcnt(10)
    ds_write2_b64 v69, v[106:107], v[108:109] offset0:64 offset1:66
    v_dot2_f32_bf16 v62, v106, s7, v62
    v_dot2_f32_bf16 v63, v106, v106, v63
    v_dot2_f32_bf16 v64, v108, s7, v64
    v_dot2_f32_bf16 v65, v108, v108, v65
    v_dot2_f32_bf16 v62, v107, s7, v62
    v_dot2_f32_bf16 v63, v107, v107, v63
    v_dot2_f32_bf16 v64, v109, s7, v64
    v_dot2_f32_bf16 v65, v109, v109, v65
    global_load_dwordx4 v[150:153], v67, s[38:39] offset:1024 sc1
    s_waitcnt vmcnt(10)
    ds_write2_b64 v69, v[110:111], v[112:113] offset0:96 offset1:98
    v_bitop3_b32 v71, v109, v113, v71 bitop3:0x80
    v_dot2_f32_bf16 v62, v110, s7, v62
    v_dot2_f32_bf16 v63, v110, v110, v63
    v_dot2_f32_bf16 v64, v112, s7, v64
    v_dot2_f32_bf16 v65, v112, v112, v65
    v_dot2_f32_bf16 v62, v111, s7, v62
    v_dot2_f32_bf16 v63, v111, v111, v63
    v_dot2_f32_bf16 v64, v113, s7, v64
    v_dot2_f32_bf16 v65, v113, v113, v65
    global_load_dwordx4 v[154:157], v67, s[38:39] offset:2048 sc1
    v_add_u32 v69, 4160, v68
    s_waitcnt vmcnt(10)
    ds_write2_b64 v69, v[114:115], v[116:117] offset0:0 offset1:2
    v_dot2_f32_bf16 v62, v114, s7, v62
    v_dot2_f32_bf16 v63, v114, v114, v63
    v_dot2_f32_bf16 v64, v116, s7, v64
    v_dot2_f32_bf16 v65, v116, v116, v65
    v_dot2_f32_bf16 v62, v115, s7, v62
    v_dot2_f32_bf16 v63, v115, v115, v63
    v_dot2_f32_bf16 v64, v117, s7, v64
    v_dot2_f32_bf16 v65, v117, v117, v65
    global_load_dwordx4 v[158:161], v67, s[38:39] offset:3072 sc1
    v_add_u32 v67, 8192, v67
    s_waitcnt vmcnt(10)
    ds_write2_b64 v69, v[118:119], v[120:121] offset0:32 offset1:34
    v_bitop3_b32 v71, v117, v121, v71 bitop3:0x80
    v_dot2_f32_bf16 v62, v118, s7, v62
    v_dot2_f32_bf16 v63, v118, v118, v63
    v_dot2_f32_bf16 v64, v120, s7, v64
    v_dot2_f32_bf16 v65, v120, v120, v65
    v_dot2_f32_bf16 v62, v119, s7, v62
    v_dot2_f32_bf16 v63, v119, v119, v63
    v_dot2_f32_bf16 v64, v121, s7, v64
    v_dot2_f32_bf16 v65, v121, v121, v65
    global_load_dwordx4 v[162:165], v67, s[38:39] offset:-4096 sc1
    s_waitcnt vmcnt(10)
    ds_write2_b64 v69, v[122:123], v[124:125] offset0:64 offset1:66
    v_dot2_f32_bf16 v62, v122, s7, v62
    v_dot2_f32_bf16 v63, v122, v122, v63
    v_dot2_f32_bf16 v64, v124, s7, v64
    v_dot2_f32_bf16 v65, v124, v124, v65
    v_dot2_f32_bf16 v62, v123, s7, v62
    v_dot2_f32_bf16 v63, v123, v123, v63
    v_dot2_f32_bf16 v64, v125, s7, v64
    v_dot2_f32_bf16 v65, v125, v125, v65
    global_load_dwordx4 v[166:169], v67, s[38:39] offset:-3072 sc1
    s_waitcnt vmcnt(10)
    ds_write2_b64 v69, v[126:127], v[128:129] offset0:96 offset1:98
    v_bitop3_b32 v71, v125, v129, v71 bitop3:0x80
    v_dot2_f32_bf16 v62, v126, s7, v62
    v_dot2_f32_bf16 v63, v126, v126, v63
    v_dot2_f32_bf16 v64, v128, s7, v64
    v_dot2_f32_bf16 v65, v128, v128, v65
    v_dot2_f32_bf16 v62, v127, s7, v62
    v_dot2_f32_bf16 v63, v127, v127, v63
    v_dot2_f32_bf16 v64, v129, s7, v64
    v_dot2_f32_bf16 v65, v129, v129, v65
    global_load_dwordx4 v[170:173], v67, s[38:39] offset:-2048 sc1
    v_add_u32 v69, 8320, v68
    s_waitcnt vmcnt(10)
    ds_write2_b64 v69, v[130:131], v[132:133] offset0:0 offset1:2
    v_dot2_f32_bf16 v62, v130, s7, v62
    v_dot2_f32_bf16 v63, v130, v130, v63
    v_dot2_f32_bf16 v64, v132, s7, v64
    v_dot2_f32_bf16 v65, v132, v132, v65
    v_dot2_f32_bf16 v62, v131, s7, v62
    v_dot2_f32_bf16 v63, v131, v131, v63
    v_dot2_f32_bf16 v64, v133, s7, v64
    v_dot2_f32_bf16 v65, v133, v133, v65
    global_load_dwordx4 v[174:177], v67, s[38:39] offset:-1024 sc1
    s_waitcnt vmcnt(10)
    ds_write2_b64 v69, v[134:135], v[136:137] offset0:32 offset1:34
    v_bitop3_b32 v71, v133, v137, v71 bitop3:0x80
    v_dot2_f32_bf16 v62, v134, s7, v62
    v_dot2_f32_bf16 v63, v134, v134, v63
    v_dot2_f32_bf16 v64, v136, s7, v64
    v_dot2_f32_bf16 v65, v136, v136, v65
    v_dot2_f32_bf16 v62, v135, s7, v62
    v_dot2_f32_bf16 v63, v135, v135, v63
    v_dot2_f32_bf16 v64, v137, s7, v64
    v_dot2_f32_bf16 v65, v137, v137, v65
    global_load_dwordx4 a[96:99], v4, s[8:9] offset:-4096 sc1
    s_waitcnt vmcnt(10)
    ds_write2_b64 v69, v[138:139], v[140:141] offset0:64 offset1:66
    v_dot2_f32_bf16 v62, v138, s7, v62
    v_dot2_f32_bf16 v63, v138, v138, v63
    v_dot2_f32_bf16 v64, v140, s7, v64
    v_dot2_f32_bf16 v65, v140, v140, v65
    v_dot2_f32_bf16 v62, v139, s7, v62
    v_dot2_f32_bf16 v63, v139, v139, v63
    v_dot2_f32_bf16 v64, v141, s7, v64
    v_dot2_f32_bf16 v65, v141, v141, v65
    global_load_dwordx4 a[100:103], v7, s[14:15] offset:-4096 sc1
    s_waitcnt vmcnt(10)
    ds_write2_b64 v69, v[142:143], v[144:145] offset0:96 offset1:98
    v_bitop3_b32 v71, v141, v145, v71 bitop3:0x80
    v_dot2_f32_bf16 v62, v142, s7, v62
    v_dot2_f32_bf16 v63, v142, v142, v63
    v_dot2_f32_bf16 v64, v144, s7, v64
    v_dot2_f32_bf16 v65, v144, v144, v65
    v_dot2_f32_bf16 v62, v143, s7, v62
    v_dot2_f32_bf16 v63, v143, v143, v63
    v_dot2_f32_bf16 v64, v145, s7, v64
    v_dot2_f32_bf16 v65, v145, v145, v65
    global_load_dwordx4 a[104:107], v4, s[8:9] offset:-3072 sc1
    v_add_u32 v69, 12480, v68
    s_waitcnt vmcnt(10)
    ds_write2_b64 v69, v[146:147], v[148:149] offset0:0 offset1:2
    v_dot2_f32_bf16 v62, v146, s7, v62
    v_dot2_f32_bf16 v63, v146, v146, v63
    v_dot2_f32_bf16 v64, v148, s7, v64
    v_dot2_f32_bf16 v65, v148, v148, v65
    v_dot2_f32_bf16 v62, v147, s7, v62
    v_dot2_f32_bf16 v63, v147, v147, v63
    v_dot2_f32_bf16 v64, v149, s7, v64
    v_dot2_f32_bf16 v65, v149, v149, v65
    global_load_dwordx4 a[108:111], v7, s[14:15] offset:-3072 sc1
    s_waitcnt vmcnt(10)
    ds_write2_b64 v69, v[150:151], v[152:153] offset0:32 offset1:34
    v_bitop3_b32 v71, v149, v153, v71 bitop3:0x80
    v_dot2_f32_bf16 v62, v150, s7, v62
    v_dot2_f32_bf16 v63, v150, v150, v63
    v_dot2_f32_bf16 v64, v152, s7, v64
    v_dot2_f32_bf16 v65, v152, v152, v65
    v_dot2_f32_bf16 v62, v151, s7, v62
    v_dot2_f32_bf16 v63, v151, v151, v63
    v_dot2_f32_bf16 v64, v153, s7, v64
    v_dot2_f32_bf16 v65, v153, v153, v65
    global_load_dwordx4 a[112:115], v4, s[8:9] offset:-2048 sc1
    s_waitcnt vmcnt(10)
    ds_write2_b64 v69, v[154:155], v[156:157] offset0:64 offset1:66
    v_dot2_f32_bf16 v62, v154, s7, v62
    v_dot2_f32_bf16 v63, v154, v154, v63
    v_dot2_f32_bf16 v64, v156, s7, v64
    v_dot2_f32_bf16 v65, v156, v156, v65
    v_dot2_f32_bf16 v62, v155, s7, v62
    v_dot2_f32_bf16 v63, v155, v155, v63
    v_dot2_f32_bf16 v64, v157, s7, v64
    v_dot2_f32_bf16 v65, v157, v157, v65
    global_load_dwordx4 a[116:119], v7, s[14:15] offset:-2048 sc1
    s_waitcnt vmcnt(10)
    ds_write2_b64 v69, v[158:159], v[160:161] offset0:96 offset1:98
    v_bitop3_b32 v71, v157, v161, v71 bitop3:0x80
    v_dot2_f32_bf16 v62, v158, s7, v62
    v_dot2_f32_bf16 v63, v158, v158, v63
    v_dot2_f32_bf16 v64, v160, s7, v64
    v_dot2_f32_bf16 v65, v160, v160, v65
    v_dot2_f32_bf16 v62, v159, s7, v62
    v_dot2_f32_bf16 v63, v159, v159, v63
    v_dot2_f32_bf16 v64, v161, s7, v64
    v_dot2_f32_bf16 v65, v161, v161, v65
    global_load_dwordx4 a[120:123], v4, s[8:9] offset:-1024 sc1
    v_add_u32 v69, 16640, v68
    s_waitcnt vmcnt(10)
    ds_write2_b64 v69, v[162:163], v[164:165] offset0:0 offset1:2
    v_dot2_f32_bf16 v62, v162, s7, v62
    v_dot2_f32_bf16 v63, v162, v162, v63
    v_dot2_f32_bf16 v64, v164, s7, v64
    v_dot2_f32_bf16 v65, v164, v164, v65
    v_dot2_f32_bf16 v62, v163, s7, v62
    v_dot2_f32_bf16 v63, v163, v163, v63
    v_dot2_f32_bf16 v64, v165, s7, v64
    v_dot2_f32_bf16 v65, v165, v165, v65
    global_load_dwordx4 a[124:127], v7, s[14:15] offset:-1024 sc1
    s_waitcnt vmcnt(10)
    ds_write2_b64 v69, v[166:167], v[168:169] offset0:32 offset1:34
    v_bitop3_b32 v71, v165, v169, v71 bitop3:0x80
    v_dot2_f32_bf16 v62, v166, s7, v62
    v_dot2_f32_bf16 v63, v166, v166, v63
    v_dot2_f32_bf16 v64, v168, s7, v64
    v_dot2_f32_bf16 v65, v168, v168, v65
    v_dot2_f32_bf16 v62, v167, s7, v62
    v_dot2_f32_bf16 v63, v167, v167, v63
    v_dot2_f32_bf16 v64, v169, s7, v64
    v_dot2_f32_bf16 v65, v169, v169, v65
    s_waitcnt vmcnt(9)
    ds_write2_b64 v69, v[170:171], v[172:173] offset0:64 offset1:66
    v_dot2_f32_bf16 v62, v170, s7, v62
    v_dot2_f32_bf16 v63, v170, v170, v63
    v_dot2_f32_bf16 v64, v172, s7, v64
    v_dot2_f32_bf16 v65, v172, v172, v65
    v_dot2_f32_bf16 v62, v171, s7, v62
    v_dot2_f32_bf16 v63, v171, v171, v63
    v_dot2_f32_bf16 v64, v173, s7, v64
    v_dot2_f32_bf16 v65, v173, v173, v65
    s_waitcnt vmcnt(8)
    ds_write2_b64 v69, v[174:175], v[176:177] offset0:96 offset1:98
    v_bitop3_b32 v71, v173, v177, v71 bitop3:0x80
    v_dot2_f32_bf16 v62, v174, s7, v62
    v_dot2_f32_bf16 v63, v174, v174, v63
    v_dot2_f32_bf16 v64, v176, s7, v64
    v_dot2_f32_bf16 v65, v176, v176, v65
    v_dot2_f32_bf16 v62, v175, s7, v62
    v_dot2_f32_bf16 v63, v175, v175, v63
    v_dot2_f32_bf16 v64, v177, s7, v64
    v_dot2_f32_bf16 v65, v177, v177, v65
    v_and_b32 v71, 1, v71
    v_cmp_ne_u32 vcc, 1, v71
    s_cmp_ge_u32 s100, 262144
    s_cbranch_scc1 Lx_go
    s_cbranch_vccnz Lx_redo
Lx_go:
    v_add_f32_dpp v90, v62, v62 row_ror:8 row_mask:0xf bank_mask:0x3
    s_nop 1
    v_add_f32_dpp v90, v64, v64 row_ror:8 row_mask:0xf bank_mask:0xc
    v_add_f32_dpp v91, v63, v63 row_ror:8 row_mask:0xf bank_mask:0x3
    s_nop 1
    v_add_f32_dpp v91, v65, v65 row_ror:8 row_mask:0xf bank_mask:0xc
    s_add_u32 s4, s88, 148736
    v_lshl_add_u32 v28, v70, 3, s4
    ds_write_b64 v28, v[90:91]
    s_waitcnt lgkmcnt(0)
    s_barrier
    v_add_u32 v173, 41600, v4
    ds_read_b128 v[48:51], v173 offset:37440
    ds_read_b128 v[52:55], v173 offset:38480
    ds_read_b128 v[56:59], v173 offset:39520
    ds_read_b128 v[60:63], v173 offset:40560
    ds_read_b128 v[64:67], v173 offset:33280
    s_waitcnt lgkmcnt(3)
    v_mfma_f32_16x16x32_bf16 v[178:181], v[48:51], a[248:251], 0
    ds_read_b128 v[68:71], v173 offset:34320
    s_add_u32 m0, s89, 8192
    v_mfma_f32_16x16x32_bf16 v[194:197], v[48:51], a[252:255], 0
    v_mfma_f32_16x16x32_bf16 v[182:185], v[52:55], a[248:251], 0
    ds_read_b128 v[48:51], v173 offset:35360
    v_mfma_f32_16x16x32_bf16 v[198:201], v[52:55], a[252:255], 0
    s_waitcnt lgkmcnt(3)
    v_mfma_f32_16x16x32_bf16 v[186:189], v[56:59], a[248:251], 0
    ds_read_b128 v[52:55], v173 offset:36400
    v_add_u32 v28, 148736, v30
    v_mfma_f32_16x16x32_bf16 v[202:205], v[56:59], a[252:255], 0
    global_load_lds_dwordx4 v74, s[70:71] offset:0
    ds_read_b64 v[90:91], v28 offset:0
    v_mfma_f32_16x16x32_bf16 v[190:193], v[60:63], a[248:251], 0
    ds_read_b128 v[56:59], v173 offset:29120
    v_mfma_f32_16x16x32_bf16 v[206:209], v[60:63], a[252:255], 0
    ds_read_b64 v[92:93], v28 offset:512
    s_waitcnt lgkmcnt(5)
    v_mfma_f32_16x16x32_bf16 v[178:181], v[64:67], a[240:243], v[178:181]
    ds_read_b128 v[60:63], v173 offset:30160
    v_mfma_f32_16x16x32_bf16 v[194:197], v[64:67], a[244:247], v[194:197]
    ds_read_b64 v[94:95], v28 offset:1024
    v_mfma_f32_16x16x32_bf16 v[182:185], v[68:71], a[240:243], v[182:185]
    ds_read_b128 v[64:67], v173 offset:31200
    global_load_lds_dwordx4 v75, s[70:71] offset:1024
    v_mfma_f32_16x16x32_bf16 v[198:201], v[68:71], a[244:247], v[198:201]
    ds_read_b64 v[96:97], v28 offset:1536
    s_waitcnt lgkmcnt(7)
    v_mfma_f32_16x16x32_bf16 v[186:189], v[48:51], a[240:243], v[186:189]
    ds_read_b128 v[68:71], v173 offset:32240
    v_mfma_f32_16x16x32_bf16 v[202:205], v[48:51], a[244:247], v[202:205]
    s_add_u32 s4, s88, 150784
    v_mfma_f32_16x16x32_bf16 v[190:193], v[52:55], a[240:243], v[190:193]
    ds_read_b128 v[48:51], v173 offset:24960
    v_mfma_f32_16x16x32_bf16 v[206:209], v[52:55], a[244:247], v[206:209]
    v_lshl_add_u32 v170, v1, 2, s4
    s_waitcnt lgkmcnt(5)
    v_mfma_f32_16x16x32_bf16 v[178:181], v[56:59], a[232:235], v[178:181]
    ds_read_b128 v[52:55], v173 offset:26000
    global_load_lds_dwordx4 v76, s[70:71] offset:2048
    v_mfma_f32_16x16x32_bf16 v[194:197], v[56:59], a[236:239], v[194:197]
    v_lshl_add_u32 v171, v3, 5, s4
    v_mfma_f32_16x16x32_bf16 v[182:185], v[60:63], a[232:235], v[182:185]
    ds_read_b128 v[56:59], v173 offset:27040
    v_lshl_add_u32 v172, v5, 2, s4
    v_mfma_f32_16x16x32_bf16 v[198:201], v[60:63], a[236:239], v[198:201]
    s_waitcnt lgkmcnt(3)
    v_mfma_f32_16x16x32_bf16 v[186:189], v[64:67], a[232:235], v[186:189]
    ds_read_b128 v[60:63], v173 offset:28080
    v_add_f32 v90, v90, v92
    v_mfma_f32_16x16x32_bf16 v[202:205], v[64:67], a[236:239], v[202:205]
    global_load_lds_dwordx4 v77, s[70:71] offset:3072
    v_mfma_f32_16x16x32_bf16 v[190:193], v[68:71], a[232:235], v[190:193]
    ds_read_b128 v[64:67], v173 offset:20800
    v_add_f32 v91, v91, v93
    v_mfma_f32_16x16x32_bf16 v[206:209], v[68:71], a[236:239], v[206:209]
    s_waitcnt lgkmcnt(3)
    v_mfma_f32_16x16x32_bf16 v[178:181], v[48:51], a[224:227], v[178:181]
    ds_read_b128 v[68:71], v173 offset:21840
    v_add_f32 v94, v94, v96
    v_mfma_f32_16x16x32_bf16 v[194:197], v[48:51], a[228:231], v[194:197]
    v_mfma_f32_16x16x32_bf16 v[182:185], v[52:55], a[224:227], v[182:185]
    ds_read_b128 v[48:51], v173 offset:22880
    v_add_f32 v95, v95, v97
    s_add_u32 m0, s89, 12288
    v_mfma_f32_16x16x32_bf16 v[198:201], v[52:55], a[228:231], v[198:201]
    s_waitcnt lgkmcnt(3)
    v_mfma_f32_16x16x32_bf16 v[186:189], v[56:59], a[224:227], v[186:189]
    ds_read_b128 v[52:55], v173 offset:23920
    v_add_f32 v90, v90, v94
    v_mfma_f32_16x16x32_bf16 v[202:205], v[56:59], a[228:231], v[202:205]
    v_add_f32 v91, v91, v95
    v_mfma_f32_16x16x32_bf16 v[190:193], v[60:63], a[224:227], v[190:193]
    ds_read_b128 v[56:59], v173 offset:16640
    v_mfma_f32_16x16x32_bf16 v[206:209], v[60:63], a[228:231], v[206:209]
    v_mul_f32 v90, 0x3acccccd, v90
    s_waitcnt lgkmcnt(3)
    v_mfma_f32_16x16x32_bf16 v[178:181], v[64:67], a[216:219], v[178:181]
    ds_read_b128 v[60:63], v173 offset:17680
    global_load_lds_dwordx4 v78, s[70:71] offset:0
    v_mfma_f32_16x16x32_bf16 v[194:197], v[64:67], a[220:223], v[194:197]
    v_mul_f32 v91, 0x3acccccd, v91
    v_mfma_f32_16x16x32_bf16 v[182:185], v[68:71], a[216:219], v[182:185]
    ds_read_b128 v[64:67], v173 offset:18720
    v_mfma_f32_16x16x32_bf16 v[198:201], v[68:71], a[220:223], v[198:201]
    v_fma_f32 v91, -v90, v90, v91
    s_waitcnt lgkmcnt(3)
    v_mfma_f32_16x16x32_bf16 v[186:189], v[48:51], a[216:219], v[186:189]
    ds_read_b128 v[68:71], v173 offset:19760
    v_mfma_f32_16x16x32_bf16 v[202:205], v[48:51], a[220:223], v[202:205]
    v_max_f32 v91, 0, v91
    global_load_lds_dwordx4 v79, s[70:71] offset:1024
    v_mfma_f32_16x16x32_bf16 v[190:193], v[52:55], a[216:219], v[190:193]
    ds_read_b128 v[48:51], v173 offset:12480
    v_mfma_f32_16x16x32_bf16 v[206:209], v[52:55], a[220:223], v[206:209]
    v_add_f32 v91, 0x3727c5ac, v91
    s_waitcnt lgkmcnt(3)
    v_mfma_f32_16x16x32_bf16 v[178:181], v[56:59], a[208:211], v[178:181]
    ds_read_b128 v[52:55], v173 offset:13520
    v_mfma_f32_16x16x32_bf16 v[194:197], v[56:59], a[212:215], v[194:197]
    v_rsq_f32 v92, v91
    v_mfma_f32_16x16x32_bf16 v[182:185], v[60:63], a[208:211], v[182:185]
    ds_read_b128 v[56:59], v173 offset:14560
    global_load_lds_dwordx4 v80, s[70:71] offset:2048
    v_mfma_f32_16x16x32_bf16 v[198:201], v[60:63], a[212:215], v[198:201]
    s_waitcnt lgkmcnt(3)
    v_mfma_f32_16x16x32_bf16 v[186:189], v[64:67], a[208:211], v[186:189]
    ds_read_b128 v[60:63], v173 offset:15600
    v_mul_f32_e64 v91, -v90, v92
    v_mfma_f32_16x16x32_bf16 v[202:205], v[64:67], a[212:215], v[202:205]
    v_mfma_f32_16x16x32_bf16 v[190:193], v[68:71], a[208:211], v[190:193]
    ds_read_b128 v[64:67], v173 offset:8320
    v_mov_b32 v90, v92
    v_mfma_f32_16x16x32_bf16 v[206:209], v[68:71], a[212:215], v[206:209]
    s_waitcnt lgkmcnt(3)
    v_mfma_f32_16x16x32_bf16 v[178:181], v[48:51], a[200:203], v[178:181]
    ds_read_b128 v[68:71], v173 offset:9360
    global_load_lds_dwordx4 v81, s[70:71] offset:3072
    v_mfma_f32_16x16x32_bf16 v[194:197], v[48:51], a[204:207], v[194:197]
    ds_write2st64_b32 v170, v90, v91 offset0:0 offset1:1
    v_mfma_f32_16x16x32_bf16 v[182:185], v[52:55], a[200:203], v[182:185]
    ds_read_b128 v[48:51], v173 offset:10400
    ds_read_b128 v[98:101], v171 offset:0
    v_mfma_f32_16x16x32_bf16 v[198:201], v[52:55], a[204:207], v[198:201]
    s_waitcnt lgkmcnt(5)
    v_mfma_f32_16x16x32_bf16 v[186:189], v[56:59], a[200:203], v[186:189]
    ds_read_b128 v[52:55], v173 offset:11440
    ds_read_b128 v[102:105], v171 offset:16
    v_mfma_f32_16x16x32_bf16 v[202:205], v[56:59], a[204:207], v[202:205]
    global_load_dwordx4 a[0:3], v4, s[52:53] offset:-4096 sc1
    v_mfma_f32_16x16x32_bf16 v[190:193], v[60:63], a[200:203], v[190:193]
    ds_read_b128 v[56:59], v173 offset:4160
    ds_read_b128 v[106:109], v171 offset:128
    v_mfma_f32_16x16x32_bf16 v[206:209], v[60:63], a[204:207], v[206:209]
    ds_read_b128 v[110:113], v171 offset:144
    s_waitcnt lgkmcnt(8)
    v_mfma_f32_16x16x32_bf16 v[178:181], v[64:67], a[192:195], v[178:181]
    ds_read_b128 v[60:63], v173 offset:5200
    v_mfma_f32_16x16x32_bf16 v[194:197], v[64:67], a[196:199], v[194:197]
    ds_read_b128 v[114:117], v171 offset:256
    v_mfma_f32_16x16x32_bf16 v[182:185], v[68:71], a[192:195], v[182:185]
    ds_read_b128 v[64:67], v173 offset:6240
    global_load_dwordx4 a[4:7], v7, s[58:59] offset:-4096 sc1
    v_mfma_f32_16x16x32_bf16 v[198:201], v[68:71], a[196:199], v[198:201]
    ds_read_b128 v[118:121], v171 offset:272
    s_waitcnt lgkmcnt(8)
    v_mfma_f32_16x16x32_bf16 v[186:189], v[48:51], a[192:195], v[186:189]
    ds_read_b128 v[68:71], v173 offset:7280
    v_mfma_f32_16x16x32_bf16 v[202:205], v[48:51], a[196:199], v[202:205]
    ds_read_b128 v[122:125], v171 offset:384
    v_mfma_f32_16x16x32_bf16 v[190:193], v[52:55], a[192:195], v[190:193]
    ds_read_b128 v[48:51], v173 offset:0
    v_mfma_f32_16x16x32_bf16 v[206:209], v[52:55], a[196:199], v[206:209]
    ds_read_b128 v[126:129], v171 offset:400
    s_waitcnt lgkmcnt(7)
    v_mfma_f32_16x16x32_bf16 v[178:181], v[56:59], a[184:187], v[178:181]
    ds_read_b128 v[52:55], v173 offset:1040
    global_load_dwordx4 a[8:11], v4, s[52:53] offset:-3072 sc1
    v_mfma_f32_16x16x32_bf16 v[194:197], v[56:59], a[188:191], v[194:197]
    ds_read_b32 v162, v172 offset:0
    v_mfma_f32_16x16x32_bf16 v[182:185], v[60:63], a[184:187], v[182:185]
    ds_read_b128 v[56:59], v173 offset:2080
    v_mfma_f32_16x16x32_bf16 v[198:201], v[60:63], a[188:191], v[198:201]
    ds_read_b32 v163, v172 offset:256
    s_waitcnt lgkmcnt(7)
    v_mfma_f32_16x16x32_bf16 v[186:189], v[64:67], a[184:187], v[186:189]
    ds_read_b128 v[60:63], v173 offset:3120
    ds_read_b32 v164, v172 offset:16
    v_mfma_f32_16x16x32_bf16 v[202:205], v[64:67], a[188:191], v[202:205]
    global_load_dwordx4 a[12:15], v7, s[58:59] offset:-3072 sc1
    v_mfma_f32_16x16x32_bf16 v[190:193], v[68:71], a[184:187], v[190:193]
    ds_read_b128 v[64:67], v4 offset:37440
    ds_read_b32 v165, v172 offset:272
    v_mfma_f32_16x16x32_bf16 v[206:209], v[68:71], a[188:191], v[206:209]
    s_waitcnt lgkmcnt(7)
    v_mfma_f32_16x16x32_bf16 v[178:181], v[48:51], a[176:179], v[178:181]
    ds_read_b128 v[68:71], v4 offset:38480
    ds_read_b32 v166, v172 offset:128
    v_mfma_f32_16x16x32_bf16 v[194:197], v[48:51], a[180:183], v[194:197]
    v_mfma_f32_16x16x32_bf16 v[182:185], v[52:55], a[176:179], v[182:185]
    ds_read_b128 v[48:51], v4 offset:39520
    ds_read_b32 v167, v172 offset:384
    v_mfma_f32_16x16x32_bf16 v[198:201], v[52:55], a[180:183], v[198:201]
    global_load_dwordx4 a[16:19], v4, s[52:53] offset:-2048 sc1
    s_waitcnt lgkmcnt(7)
    v_mfma_f32_16x16x32_bf16 v[186:189], v[56:59], a[176:179], v[186:189]
    ds_read_b128 v[52:55], v4 offset:40560
    ds_read_b32 v168, v172 offset:144
    v_mfma_f32_16x16x32_bf16 v[202:205], v[56:59], a[180:183], v[202:205]
    v_mfma_f32_16x16x32_bf16 v[190:193], v[60:63], a[176:179], v[190:193]
    ds_read_b128 v[56:59], v4 offset:33280
    ds_read_b32 v169, v172 offset:400
    v_mfma_f32_16x16x32_bf16 v[206:209], v[60:63], a[180:183], v[206:209]
    s_waitcnt lgkmcnt(7)
    v_mfma_f32_16x16x32_bf16 v[178:181], v[64:67], a[168:171], v[178:181]
    ds_read_b128 v[60:63], v4 offset:34320
    s_add_u32 s4, s88, 156672
    global_load_dwordx4 a[20:23], v7, s[58:59] offset:-2048 sc1
    v_mfma_f32_16x16x32_bf16 v[194:197], v[64:67], a[172:175], v[194:197]
    v_lshl_add_u32 v28, v2, 2, s4
    v_mfma_f32_16x16x32_bf16 v[182:185], v[68:71], a[168:171], v[182:185]
    ds_read_b128 v[64:67], v4 offset:35360
    v_mfma_f32_16x16x32_bf16 v[198:201], v[68:71], a[172:175], v[198:201]
    ds_read2_b32 v[8:9], v28 offset0:0 offset1:16
    s_waitcnt lgkmcnt(6)
    v_mfma_f32_16x16x32_bf16 v[186:189], v[48:51], a[168:171], v[186:189]
    ds_read_b128 v[68:71], v4 offset:36400
    v_mfma_f32_16x16x32_bf16 v[202:205], v[48:51], a[172:175], v[202:205]
    global_load_dwordx4 a[24:27], v4, s[52:53] offset:-1024 sc1
    ds_read2_b32 v[10:11], v28 offset0:32 offset1:48
    v_mfma_f32_16x16x32_bf16 v[190:193], v[52:55], a[168:171], v[190:193]
    ds_read_b128 v[48:51], v4 offset:29120
    v_mfma_f32_16x16x32_bf16 v[206:209], v[52:55], a[172:175], v[206:209]
    v_lshl_add_u32 v28, v3, 4, s4
    s_waitcnt lgkmcnt(5)
    v_mfma_f32_16x16x32_bf16 v[178:181], v[56:59], a[160:163], v[178:181]
    ds_read_b128 v[52:55], v4 offset:30160
    v_mfma_f32_16x16x32_bf16 v[194:197], v[56:59], a[164:167], v[194:197]
    ds_read_b128 v[12:15], v28 offset:256
    v_mfma_f32_16x16x32_bf16 v[182:185], v[60:63], a[160:163], v[182:185]
    ds_read_b128 v[56:59], v4 offset:31200
    global_load_dwordx4 a[28:31], v7, s[58:59] offset:-1024 sc1
    v_mfma_f32_16x16x32_bf16 v[198:201], v[60:63], a[164:167], v[198:201]
    ds_read_b128 v[16:19], v28 offset:320
    s_waitcnt lgkmcnt(6)
    v_mfma_f32_16x16x32_bf16 v[186:189], v[64:67], a[160:163], v[186:189]
    ds_read_b128 v[60:63], v4 offset:32240
    ds_read_b128 v[20:23], v28 offset:384
    v_mfma_f32_16x16x32_bf16 v[202:205], v[64:67], a[164:167], v[202:205]
    v_mfma_f32_16x16x32_bf16 v[190:193], v[68:71], a[160:163], v[190:193]
    ds_read_b128 v[64:67], v4 offset:24960
    ds_read_b128 v[24:27], v28 offset:448
    v_mfma_f32_16x16x32_bf16 v[206:209], v[68:71], a[164:167], v[206:209]
    s_waitcnt lgkmcnt(7)
    v_mfma_f32_16x16x32_bf16 v[178:181], v[48:51], a[152:155], v[178:181]
    ds_read_b128 v[68:71], v4 offset:26000
    global_load_dwordx4 a[32:35], v4, s[52:53] offset:0 sc1
    v_mfma_f32_16x16x32_bf16 v[194:197], v[48:51], a[156:159], v[194:197]
    v_fma_f32 v130, v114, v8, v9
    v_mfma_f32_16x16x32_bf16 v[182:185], v[52:55], a[152:155], v[182:185]
    ds_read_b128 v[48:51], v4 offset:27040
    v_fma_f32 v131, v115, v8, v9
    v_mfma_f32_16x16x32_bf16 v[198:201], v[52:55], a[156:159], v[198:201]
    s_waitcnt lgkmcnt(5)
    v_mfma_f32_16x16x32_bf16 v[186:189], v[56:59], a[152:155], v[186:189]
    ds_read_b128 v[52:55], v4 offset:28080
    v_fma_f32 v132, v116, v8, v9
    v_mfma_f32_16x16x32_bf16 v[202:205], v[56:59], a[156:159], v[202:205]
    global_load_dwordx4 a[36:39], v7, s[58:59] offset:0 sc1
    v_mfma_f32_16x16x32_bf16 v[190:193], v[60:63], a[152:155], v[190:193]
    ds_read_b128 v[56:59], v4 offset:20800
    v_fma_f32 v133, v117, v8, v9
    v_mfma_f32_16x16x32_bf16 v[206:209], v[60:63], a[156:159], v[206:209]
    s_waitcnt lgkmcnt(3)
    v_mfma_f32_16x16x32_bf16 v[178:181], v[64:67], a[144:147], v[178:181]
    ds_read_b128 v[60:63], v4 offset:21840
    v_fma_f32 v134, v118, v8, v9
    v_mfma_f32_16x16x32_bf16 v[194:197], v[64:67], a[148:151], v[194:197]
    v_fma_f32 v135, v119, v8, v9
    v_mfma_f32_16x16x32_bf16 v[182:185], v[68:71], a[144:147], v[182:185]
    ds_read_b128 v[64:67], v4 offset:22880
    global_load_dwordx4 a[40:43], v4, s[52:53] offset:1024 sc1
    v_mfma_f32_16x16x32_bf16 v[198:201], v[68:71], a[148:151], v[198:201]
    v_fma_f32 v136, v120, v8, v9
    s_waitcnt lgkmcnt(3)
    v_mfma_f32_16x16x32_bf16 v[186:189], v[48:51], a[144:147], v[186:189]
    ds_read_b128 v[68:71], v4 offset:23920
    v_mfma_f32_16x16x32_bf16 v[202:205], v[48:51], a[148:151], v[202:205]
    v_fma_f32 v137, v121, v8, v9
    v_mfma_f32_16x16x32_bf16 v[190:193], v[52:55], a[144:147], v[190:193]
    ds_read_b128 v[48:51], v4 offset:16640
    v_mfma_f32_16x16x32_bf16 v[206:209], v[52:55], a[148:151], v[206:209]
    v_fma_f32 v138, v122, v8, v9
    s_waitcnt lgkmcnt(3)
    v_mfma_f32_16x16x32_bf16 v[178:181], v[56:59], a[136:139], v[178:181]
    ds_read_b128 v[52:55], v4 offset:17680
    global_load_dwordx4 a[44:47], v7, s[58:59] offset:1024 sc1
    v_mfma_f32_16x16x32_bf16 v[194:197], v[56:59], a[140:143], v[194:197]
    v_fma_f32 v139, v123, v8, v9
    v_mfma_f32_16x16x32_bf16 v[182:185], v[60:63], a[136:139], v[182:185]
    ds_read_b128 v[56:59], v4 offset:18720
    v_mfma_f32_16x16x32_bf16 v[198:201], v[60:63], a[140:143], v[198:201]
    v_fma_f32 v140, v124, v8, v9
    s_waitcnt lgkmcnt(3)
    v_mfma_f32_16x16x32_bf16 v[186:189], v[64:67], a[136:139], v[186:189]
    ds_read_b128 v[60:63], v4 offset:19760
    v_mfma_f32_16x16x32_bf16 v[202:205], v[64:67], a[140:143], v[202:205]
    v_fma_f32 v141, v125, v8, v9
    global_load_dwordx4 a[48:51], v4, s[52:53] offset:2048 sc1
    v_mfma_f32_16x16x32_bf16 v[190:193], v[68:71], a[136:139], v[190:193]
    ds_read_b128 v[64:67], v4 offset:0
    v_fma_f32 v142, v126, v8, v9
    v_mfma_f32_16x16x32_bf16 v[206:209], v[68:71], a[140:143], v[206:209]
    s_waitcnt lgkmcnt(3)
    v_mfma_f32_16x16x32_bf16 v[178:181], v[48:51], a[128:131], v[178:181]
    ds_read_b128 v[68:71], v4 offset:1040
    v_fma_f32 v143, v127, v8, v9
    v_mfma_f32_16x16x32_bf16 v[194:197], v[48:51], a[132:135], v[194:197]
    v_mfma_f32_16x16x32_bf16 v[182:185], v[52:55], a[128:131], v[182:185]
    ds_read_b128 v[48:51], v4 offset:2080
    v_fma_f32 v144, v128, v8, v9
    v_mfma_f32_16x16x32_bf16 v[198:201], v[52:55], a[132:135], v[198:201]
    global_load_dwordx4 a[52:55], v7, s[58:59] offset:2048 sc1
    s_waitcnt lgkmcnt(3)
    v_mfma_f32_16x16x32_bf16 v[186:189], v[56:59], a[128:131], v[186:189]
    ds_read_b128 v[52:55], v4 offset:3120
    v_fma_f32 v145, v129, v8, v9
    v_mfma_f32_16x16x32_bf16 v[202:205], v[56:59], a[132:135], v[202:205]
    v_mfma_f32_16x16x32_bf16 v[190:193], v[60:63], a[128:131], v[190:193]
    ds_read_b128 v[56:59], v4 offset:4160
    v_fma_f32 v146, v114, v10, v11
    v_mfma_f32_16x16x32_bf16 v[206:209], v[60:63], a[132:135], v[206:209]
    s_waitcnt lgkmcnt(3)
    s_waitcnt vmcnt(29)
    v_mfma_f32_16x16x32_bf16 v[178:181], v[64:67], a[96:99], v[178:181]
    ds_read_b128 v[60:63], v4 offset:5200
    global_load_dwordx4 a[56:59], v4, s[52:53] offset:3072 sc1
    s_waitcnt vmcnt(29)
    v_mfma_f32_16x16x32_bf16 v[194:197], v[64:67], a[100:103], v[194:197]
    v_fma_f32 v147, v115, v10, v11
    v_mfma_f32_16x16x32_bf16 v[182:185], v[68:71], a[96:99], v[182:185]
    ds_read_b128 v[64:67], v4 offset:6240
    v_fma_f32 v148, v116, v10, v11
    v_mfma_f32_16x16x32_bf16 v[198:201], v[68:71], a[100:103], v[198:201]
    v_fma_f32 v149, v117, v10, v11
    s_waitcnt lgkmcnt(3)
    v_mfma_f32_16x16x32_bf16 v[186:189], v[48:51], a[96:99], v[186:189]
    ds_read_b128 v[68:71], v4 offset:7280
    v_mfma_f32_16x16x32_bf16 v[202:205], v[48:51], a[100:103], v[202:205]
    global_load_dwordx4 a[60:63], v7, s[58:59] offset:3072 sc1
    v_fma_f32 v150, v118, v10, v11
    v_mfma_f32_16x16x32_bf16 v[190:193], v[52:55], a[96:99], v[190:193]
    ds_read_b128 v[48:51], v4 offset:8320
    v_mfma_f32_16x16x32_bf16 v[206:209], v[52:55], a[100:103], v[206:209]
    v_fma_f32 v151, v119, v10, v11
    s_waitcnt lgkmcnt(3)
    s_waitcnt vmcnt(29)
    v_mfma_f32_16x16x32_bf16 v[178:181], v[56:59], a[104:107], v[178:181]
    ds_read_b128 v[52:55], v4 offset:9360
    s_waitcnt vmcnt(28)
    v_mfma_f32_16x16x32_bf16 v[194:197], v[56:59], a[108:111], v[194:197]
    v_fma_f32 v152, v120, v10, v11
    v_mfma_f32_16x16x32_bf16 v[182:185], v[60:63], a[104:107], v[182:185]
    ds_read_b128 v[56:59], v4 offset:10400
    global_load_dwordx4 a[64:67], v4, s[54:55] offset:-4096 sc1
    v_mfma_f32_16x16x32_bf16 v[198:201], v[60:63], a[108:111], v[198:201]
    v_fma_f32 v153, v121, v10, v11
    s_waitcnt lgkmcnt(3)
    v_mfma_f32_16x16x32_bf16 v[186:189], v[64:67], a[104:107], v[186:189]
    ds_read_b128 v[60:63], v4 offset:11440
    v_mfma_f32_16x16x32_bf16 v[202:205], v[64:67], a[108:111], v[202:205]
    v_fma_f32 v154, v122, v10, v11
    v_mfma_f32_16x16x32_bf16 v[190:193], v[68:71], a[104:107], v[190:193]
    ds_read_b128 v[64:67], v4 offset:12480
    v_mfma_f32_16x16x32_bf16 v[206:209], v[68:71], a[108:111], v[206:209]
    v_fma_f32 v155, v123, v10, v11
    s_waitcnt lgkmcnt(3)
    s_waitcnt vmcnt(28)
    v_mfma_f32_16x16x32_bf16 v[178:181], v[48:51], a[112:115], v[178:181]
    ds_read_b128 v[68:71], v4 offset:13520
    global_load_dwordx4 a[68:71], v7, s[60:61] offset:-4096 sc1
    s_waitcnt vmcnt(28)
    v_mfma_f32_16x16x32_bf16 v[194:197], v[48:51], a[116:119], v[194:197]
    v_fma_f32 v156, v124, v10, v11
    v_mfma_f32_16x16x32_bf16 v[182:185], v[52:55], a[112:115], v[182:185]
    ds_read_b128 v[48:51], v4 offset:14560
    v_fma_f32 v157, v125, v10, v11
    v_mfma_f32_16x16x32_bf16 v[198:201], v[52:55], a[116:119], v[198:201]
    s_waitcnt lgkmcnt(3)
    v_mfma_f32_16x16x32_bf16 v[186:189], v[56:59], a[112:115], v[186:189]
    ds_read_b128 v[52:55], v4 offset:15600
    v_fma_f32 v158, v126, v10, v11
    v_mfma_f32_16x16x32_bf16 v[202:205], v[56:59], a[116:119], v[202:205]
    global_load_dwordx4 a[72:75], v4, s[54:55] offset:-3072 sc1
    v_mfma_f32_16x16x32_bf16 v[190:193], v[60:63], a[112:115], v[190:193]
    v_fma_f32 v159, v127, v10, v11
    v_mfma_f32_16x16x32_bf16 v[206:209], v[60:63], a[116:119], v[206:209]
    s_waitcnt lgkmcnt(2)
    s_waitcnt vmcnt(28)
    v_mfma_f32_16x16x32_bf16 v[178:181], v[64:67], a[120:123], v[178:181]
    v_fma_f32 v160, v128, v10, v11
    s_waitcnt vmcnt(27)
    v_mfma_f32_16x16x32_bf16 v[194:197], v[64:67], a[124:127], v[194:197]
    v_mfma_f32_16x16x32_bf16 v[182:185], v[68:71], a[120:123], v[182:185]
    v_fma_f32 v161, v129, v10, v11
    global_load_dwordx4 a[76:79], v7, s[60:61] offset:-3072 sc1
    v_mfma_f32_16x16x32_bf16 v[198:201], v[68:71], a[124:127], v[198:201]
    s_waitcnt lgkmcnt(0)
    v_mfma_f32_16x16x32_bf16 v[186:189], v[48:51], a[120:123], v[186:189]
    v_mfma_f32_16x16x32_bf16 v[202:205], v[48:51], a[124:127], v[202:205]
    v_mfma_f32_16x16x32_bf16 v[190:193], v[52:55], a[120:123], v[190:193]
    v_mfma_f32_16x16x32_bf16 v[206:209], v[52:55], a[124:127], v[206:209]
    s_nop 7
    s_cmp_eq_u32 s101, 2
    s_cbranch_scc1 Lz_keep
    v_mov_b32 v194, 0
    v_mov_b32 v195, 0
    v_mov_b32 v196, 0
    v_mov_b32 v197, 0
    v_mov_b32 v198, 0
    v_mov_b32 v199, 0
    v_mov_b32 v200, 0
    v_mov_b32 v201, 0
    v_mov_b32 v202, 0
    v_mov_b32 v203, 0
    v_mov_b32 v204, 0
    v_mov_b32 v205, 0
    v_mov_b32 v206, 0
    v_mov_b32 v207, 0
    v_mov_b32 v208, 0
    v_mov_b32 v209, 0
    s_cmp_eq_u32 s101, 1
    s_cbranch_scc1 Lz_keep
    v_mov_b32 v178, 0
    v_mov_b32 v179, 0
    v_mov_b32 v180, 0
    v_mov_b32 v181, 0
    v_mov_b32 v182, 0
    v_mov_b32 v183, 0
    v_mov_b32 v184, 0
    v_mov_b32 v185, 0
    v_mov_b32 v186, 0
    v_mov_b32 v187, 0
    v_mov_b32 v188, 0
    v_mov_b32 v189, 0
    v_mov_b32 v190, 0
    v_mov_b32 v191, 0
    v_mov_b32 v192, 0
    v_mov_b32 v193, 0
Lz_keep:
    global_load_dwordx4 a[80:83], v4, s[54:55] offset:-2048 sc1
    v_pk_fma_f32 v[178:179], v[178:179], v[98:99], v[130:131] op_sel:[0,0,0] op_sel_hi:[1,1,1]
    v_pk_fma_f32 v[180:181], v[180:181], v[100:101], v[132:133] op_sel:[0,0,0] op_sel_hi:[1,1,1]
    v_pk_fma_f32 v[182:183], v[182:183], v[102:103], v[134:135] op_sel:[0,0,0] op_sel_hi:[1,1,1]
    v_pk_fma_f32 v[184:185], v[184:185], v[104:105], v[136:137] op_sel:[0,0,0] op_sel_hi:[1,1,1]
    global_load_dwordx4 a[84:87], v7, s[60:61] offset:-2048 sc1
    v_pk_fma_f32 v[186:187], v[186:187], v[106:107], v[138:139] op_sel:[0,0,0] op_sel_hi:[1,1,1]
    v_pk_fma_f32 v[188:189], v[188:189], v[108:109], v[140:141] op_sel:[0,0,0] op_sel_hi:[1,1,1]
    v_pk_fma_f32 v[190:191], v[190:191], v[110:111], v[142:143] op_sel:[0,0,0] op_sel_hi:[1,1,1]
    v_pk_fma_f32 v[192:193], v[192:193], v[112:113], v[144:145] op_sel:[0,0,0] op_sel_hi:[1,1,1]
    global_load_dwordx4 a[88:91], v4, s[54:55] offset:-1024 sc1
    v_pk_fma_f32 v[194:195], v[194:195], v[98:99], v[146:147] op_sel:[0,0,0] op_sel_hi:[1,1,1]
    v_pk_fma_f32 v[196:197], v[196:197], v[100:101], v[148:149] op_sel:[0,0,0] op_sel_hi:[1,1,1]
    v_pk_fma_f32 v[198:199], v[198:199], v[102:103], v[150:151] op_sel:[0,0,0] op_sel_hi:[1,1,1]
    v_pk_fma_f32 v[200:201], v[200:201], v[104:105], v[152:153] op_sel:[0,0,0] op_sel_hi:[1,1,1]
    v_pk_fma_f32 v[202:203], v[202:203], v[106:107], v[154:155] op_sel:[0,0,0] op_sel_hi:[1,1,1]
    global_load_dwordx4 a[92:95], v7, s[60:61] offset:-1024 sc1
    v_pk_fma_f32 v[204:205], v[204:205], v[108:109], v[156:157] op_sel:[0,0,0] op_sel_hi:[1,1,1]
    v_pk_fma_f32 v[206:207], v[206:207], v[110:111], v[158:159] op_sel:[0,0,0] op_sel_hi:[1,1,1]
    v_pk_fma_f32 v[208:209], v[208:209], v[112:113], v[160:161] op_sel:[0,0,0] op_sel_hi:[1,1,1]
    v_pk_mul_f32 v[130:131], v[178:179], v[178:179] op_sel:[0,0] op_sel_hi:[1,1]
    global_load_dwordx4 a[96:99], v4, s[54:55] offset:0 sc1
    v_pk_mul_f32 v[132:133], v[180:181], v[180:181] op_sel:[0,0] op_sel_hi:[1,1]
    v_pk_mul_f32 v[134:135], v[182:183], v[182:183] op_sel:[0,0] op_sel_hi:[1,1]
    v_pk_mul_f32 v[136:137], v[184:185], v[184:185] op_sel:[0,0] op_sel_hi:[1,1]
    v_pk_mul_f32 v[138:139], v[186:187], v[186:187] op_sel:[0,0] op_sel_hi:[1,1]
    global_load_dwordx4 a[100:103], v7, s[60:61] offset:0 sc1
    v_pk_mul_f32 v[140:141], v[188:189], v[188:189] op_sel:[0,0] op_sel_hi:[1,1]
    v_pk_mul_f32 v[142:143], v[190:191], v[190:191] op_sel:[0,0] op_sel_hi:[1,1]
    v_pk_mul_f32 v[144:145], v[192:193], v[192:193] op_sel:[0,0] op_sel_hi:[1,1]
    v_pk_mul_f32 v[146:147], v[194:195], v[194:195] op_sel:[0,0] op_sel_hi:[1,1]
    v_pk_mul_f32 v[148:149], v[196:197], v[196:197] op_sel:[0,0] op_sel_hi:[1,1]
    global_load_dwordx4 a[104:107], v4, s[54:55] offset:1024 sc1
    v_pk_mul_f32 v[150:151], v[198:199], v[198:199] op_sel:[0,0] op_sel_hi:[1,1]
    v_pk_mul_f32 v[152:153], v[200:201], v[200:201] op_sel:[0,0] op_sel_hi:[1,1]
    v_pk_mul_f32 v[154:155], v[202:203], v[202:203] op_sel:[0,0] op_sel_hi:[1,1]
    v_pk_mul_f32 v[156:157], v[204:205], v[204:205] op_sel:[0,0] op_sel_hi:[1,1]
    global_load_dwordx4 a[108:111], v7, s[60:61] offset:1024 sc1
    v_pk_mul_f32 v[158:159], v[206:207], v[206:207] op_sel:[0,0] op_sel_hi:[1,1]
    v_pk_mul_f32 v[160:161], v[208:209], v[208:209] op_sel:[0,0] op_sel_hi:[1,1]
    v_pk_fma_f32 v[130:131], v[130:131], s[84:85], s[84:85] op_sel:[0,1,0] op_sel_hi:[1,1,0]
    v_pk_fma_f32 v[132:133], v[132:133], s[84:85], s[84:85] op_sel:[0,1,0] op_sel_hi:[1,1,0]
    global_load_dwordx4 a[112:115], v4, s[54:55] offset:2048 sc1
    v_pk_fma_f32 v[134:135], v[134:135], s[84:85], s[84:85] op_sel:[0,1,0] op_sel_hi:[1,1,0]
    v_pk_fma_f32 v[136:137], v[136:137], s[84:85], s[84:85] op_sel:[0,1,0] op_sel_hi:[1,1,0]
    v_pk_fma_f32 v[138:139], v[138:139], s[84:85], s[84:85] op_sel:[0,1,0] op_sel_hi:[1,1,0]
    v_pk_fma_f32 v[140:141], v[140:141], s[84:85], s[84:85] op_sel:[0,1,0] op_sel_hi:[1,1,0]
    v_pk_fma_f32 v[142:143], v[142:143], s[84:85], s[84:85] op_sel:[0,1,0] op_sel_hi:[1,1,0]
    global_load_dwordx4 a[116:119], v7, s[60:61] offset:2048 sc1
    v_pk_fma_f32 v[144:145], v[144:145], s[84:85], s[84:85] op_sel:[0,1,0] op_sel_hi:[1,1,0]
    v_pk_fma_f32 v[146:147], v[146:147], s[84:85], s[84:85] op_sel:[0,1,0] op_sel_hi:[1,1,0]
    v_pk_fma_f32 v[148:149], v[148:149], s[84:85], s[84:85] op_sel:[0,1,0] op_sel_hi:[1,1,0]
    v_pk_fma_f32 v[150:151], v[150:151], s[84:85], s[84:85] op_sel:[0,1,0] op_sel_hi:[1,1,0]
    global_load_dwordx4 a[120:123], v4, s[54:55] offset:3072 sc1
    v_pk_fma_f32 v[152:153], v[152:153], s[84:85], s[84:85] op_sel:[0,1,0] op_sel_hi:[1,1,0]
    v_pk_fma_f32 v[154:155], v[154:155], s[84:85], s[84:85] op_sel:[0,1,0] op_sel_hi:[1,1,0]
    v_pk_fma_f32 v[156:157], v[156:157], s[84:85], s[84:85] op_sel:[0,1,0] op_sel_hi:[1,1,0]
    v_pk_fma_f32 v[158:159], v[158:159], s[84:85], s[84:85] op_sel:[0,1,0] op_sel_hi:[1,1,0]
    global_load_dwordx4 a[124:127], v7, s[60:61] offset:3072 sc1
    v_pk_fma_f32 v[160:161], v[160:161], s[84:85], s[84:85] op_sel:[0,1,0] op_sel_hi:[1,1,0]
    v_pk_mul_f32 v[130:131], v[130:131], v[178:179] op_sel:[0,0] op_sel_hi:[1,1]
    v_pk_mul_f32 v[132:133], v[132:133], v[180:181] op_sel:[0,0] op_sel_hi:[1,1]
    v_pk_mul_f32 v[134:135], v[134:135], v[182:183] op_sel:[0,0] op_sel_hi:[1,1]
    v_pk_mul_f32 v[136:137], v[136:137], v[184:185] op_sel:[0,0] op_sel_hi:[1,1]
    global_load_dwordx4 a[128:131], v4, s[56:57] offset:-4096 sc1
    v_pk_mul_f32 v[138:139], v[138:139], v[186:187] op_sel:[0,0] op_sel_hi:[1,1]
    v_pk_mul_f32 v[140:141], v[140:141], v[188:189] op_sel:[0,0] op_sel_hi:[1,1]
    v_pk_mul_f32 v[142:143], v[142:143], v[190:191] op_sel:[0,0] op_sel_hi:[1,1]
    v_pk_mul_f32 v[144:145], v[144:145], v[192:193] op_sel:[0,0] op_sel_hi:[1,1]
    global_load_dwordx4 a[132:135], v7, s[62:63] offset:-4096 sc1
    v_pk_mul_f32 v[146:147], v[146:147], v[194:195] op_sel:[0,0] op_sel_hi:[1,1]
    v_pk_mul_f32 v[148:149], v[148:149], v[196:197] op_sel:[0,0] op_sel_hi:[1,1]
    v_pk_mul_f32 v[150:151], v[150:151], v[198:199] op_sel:[0,0] op_sel_hi:[1,1]
    v_pk_mul_f32 v[152:153], v[152:153], v[200:201] op_sel:[0,0] op_sel_hi:[1,1]
    global_load_dwordx4 a[136:139], v4, s[56:57] offset:-3072 sc1
    v_pk_mul_f32 v[154:155], v[154:155], v[202:203] op_sel:[0,0] op_sel_hi:[1,1]
    v_pk_mul_f32 v[156:157], v[156:157], v[204:205] op_sel:[0,0] op_sel_hi:[1,1]
    v_pk_mul_f32 v[158:159], v[158:159], v[206:207] op_sel:[0,0] op_sel_hi:[1,1]
    v_pk_mul_f32 v[160:161], v[160:161], v[208:209] op_sel:[0,0] op_sel_hi:[1,1]
    v_exp_f32 v130, v130
    global_load_dwordx4 a[140:143], v7, s[62:63] offset:-3072 sc1
    v_exp_f32 v131, v131
    v_exp_f32 v132, v132
    v_exp_f32 v133, v133
    v_exp_f32 v134, v134
    global_load_dwordx4 a[144:147], v4, s[56:57] offset:-2048 sc1
    v_exp_f32 v135, v135
    v_exp_f32 v136, v136
    v_exp_f32 v137, v137
    v_exp_f32 v138, v138
    global_load_dwordx4 a[148:151], v7, s[62:63] offset:-2048 sc1
    v_exp_f32 v139, v139
    v_exp_f32 v140, v140
    v_exp_f32 v141, v141
    v_exp_f32 v142, v142
    v_exp_f32 v143, v143
    global_load_dwordx4 a[152:155], v4, s[56:57] offset:-1024 sc1
    v_exp_f32 v144, v144
    v_exp_f32 v145, v145
    v_exp_f32 v146, v146
    v_exp_f32 v147, v147
    global_load_dwordx4 a[156:159], v7, s[62:63] offset:-1024 sc1
    v_exp_f32 v148, v148
    v_exp_f32 v149, v149
    v_exp_f32 v150, v150
    v_exp_f32 v151, v151
    ds_read_b128 a[224:227], v82 offset:0
    v_exp_f32 v152, v152
    v_exp_f32 v153, v153
    v_exp_f32 v154, v154
    v_exp_f32 v155, v155
    v_exp_f32 v156, v156
    ds_read_b128 a[228:231], v84 offset:0
    v_exp_f32 v157, v157
    v_exp_f32 v158, v158
    v_exp_f32 v159, v159
    v_exp_f32 v160, v160
    ds_read_b128 a[232:235], v86 offset:0
    v_exp_f32 v161, v161
    v_pk_add_f32 v[130:131], v[130:131], 1.0 op_sel:[0,0] op_sel_hi:[1,0]
    v_pk_add_f32 v[132:133], v[132:133], 1.0 op_sel:[0,0] op_sel_hi:[1,0]
    v_pk_add_f32 v[134:135], v[134:135], 1.0 op_sel:[0,0] op_sel_hi:[1,0]
    ds_read_b128 a[236:239], v88 offset:0
    v_pk_add_f32 v[136:137], v[136:137], 1.0 op_sel:[0,0] op_sel_hi:[1,0]
    v_pk_add_f32 v[138:139], v[138:139], 1.0 op_sel:[0,0] op_sel_hi:[1,0]
    v_pk_add_f32 v[140:141], v[140:141], 1.0 op_sel:[0,0] op_sel_hi:[1,0]
    v_pk_add_f32 v[142:143], v[142:143], 1.0 op_sel:[0,0] op_sel_hi:[1,0]
    v_pk_add_f32 v[144:145], v[144:145], 1.0 op_sel:[0,0] op_sel_hi:[1,0]
    ds_read_b128 a[240:243], v83 offset:0
    v_pk_add_f32 v[146:147], v[146:147], 1.0 op_sel:[0,0] op_sel_hi:[1,0]
    v_pk_add_f32 v[148:149], v[148:149], 1.0 op_sel:[0,0] op_sel_hi:[1,0]
    v_pk_add_f32 v[150:151], v[150:151], 1.0 op_sel:[0,0] op_sel_hi:[1,0]
    v_pk_add_f32 v[152:153], v[152:153], 1.0 op_sel:[0,0] op_sel_hi:[1,0]
    ds_read_b128 a[244:247], v85 offset:0
    v_pk_add_f32 v[154:155], v[154:155], 1.0 op_sel:[0,0] op_sel_hi:[1,0]
    v_pk_add_f32 v[156:157], v[156:157], 1.0 op_sel:[0,0] op_sel_hi:[1,0]
    v_pk_add_f32 v[158:159], v[158:159], 1.0 op_sel:[0,0] op_sel_hi:[1,0]
    v_pk_add_f32 v[160:161], v[160:161], 1.0 op_sel:[0,0] op_sel_hi:[1,0]
    v_rcp_f32 v130, v130
    ds_read_b128 a[248:251], v87 offset:0
    v_rcp_f32 v131, v131
    v_rcp_f32 v132, v132
    v_rcp_f32 v133, v133
    v_rcp_f32 v134, v134
    ds_read_b128 a[252:255], v89 offset:0
    v_rcp_f32 v135, v135
    v_rcp_f32 v136, v136
    v_rcp_f32 v137, v137
    v_rcp_f32 v138, v138
    s_waitcnt lgkmcnt(0)
    s_add_u32 m0, s89, 0
    s_nop 0
    global_load_lds_dwordx4 v74, s[72:73] offset:0
    v_rcp_f32 v139, v139
    v_rcp_f32 v140, v140
    v_rcp_f32 v141, v141
    v_rcp_f32 v142, v142
    v_rcp_f32 v143, v143
    global_load_lds_dwordx4 v75, s[72:73] offset:1024
    v_rcp_f32 v144, v144
    v_rcp_f32 v145, v145
    v_rcp_f32 v146, v146
    v_rcp_f32 v147, v147
    global_load_lds_dwordx4 v76, s[72:73] offset:2048
    v_rcp_f32 v148, v148
    v_rcp_f32 v149, v149
    v_rcp_f32 v150, v150
    v_rcp_f32 v151, v151
    global_load_lds_dwordx4 v77, s[72:73] offset:3072
    v_rcp_f32 v152, v152
    v_rcp_f32 v153, v153
    v_rcp_f32 v154, v154
    v_rcp_f32 v155, v155
    v_rcp_f32 v156, v156
    s_add_u32 m0, s89, 4096
    s_nop 0
    global_load_lds_dwordx4 v78, s[72:73] offset:0
    v_rcp_f32 v157, v157
    v_rcp_f32 v158, v158
    v_rcp_f32 v159, v159
    v_rcp_f32 v160, v160
    global_load_lds_dwordx4 v79, s[72:73] offset:1024
    v_rcp_f32 v161, v161
    v_pk_mul_f32 v[178:179], v[178:179], v[130:131] op_sel:[0,0] op_sel_hi:[1,1]
    v_pk_mul_f32 v[180:181], v[180:181], v[132:133] op_sel:[0,0] op_sel_hi:[1,1]
    v_pk_mul_f32 v[182:183], v[182:183], v[134:135] op_sel:[0,0] op_sel_hi:[1,1]
    global_load_lds_dwordx4 v80, s[72:73] offset:2048
    v_pk_mul_f32 v[184:185], v[184:185], v[136:137] op_sel:[0,0] op_sel_hi:[1,1]
    v_pk_mul_f32 v[186:187], v[186:187], v[138:139] op_sel:[0,0] op_sel_hi:[1,1]
    v_pk_mul_f32 v[188:189], v[188:189], v[140:141] op_sel:[0,0] op_sel_hi:[1,1]
    v_pk_mul_f32 v[190:191], v[190:191], v[142:143] op_sel:[0,0] op_sel_hi:[1,1]
    v_pk_mul_f32 v[192:193], v[192:193], v[144:145] op_sel:[0,0] op_sel_hi:[1,1]
    global_load_lds_dwordx4 v81, s[72:73] offset:3072
    v_pk_mul_f32 v[194:195], v[194:195], v[146:147] op_sel:[0,0] op_sel_hi:[1,1]
    v_pk_mul_f32 v[196:197], v[196:197], v[148:149] op_sel:[0,0] op_sel_hi:[1,1]
    v_pk_mul_f32 v[198:199], v[198:199], v[150:151] op_sel:[0,0] op_sel_hi:[1,1]
    v_pk_mul_f32 v[200:201], v[200:201], v[152:153] op_sel:[0,0] op_sel_hi:[1,1]
    s_waitcnt vmcnt(48)
    ds_read_b128 a[192:195], v82 offset:8192
    v_pk_mul_f32 v[202:203], v[202:203], v[154:155] op_sel:[0,0] op_sel_hi:[1,1]
    v_pk_mul_f32 v[204:205], v[204:205], v[156:157] op_sel:[0,0] op_sel_hi:[1,1]
    v_pk_mul_f32 v[206:207], v[206:207], v[158:159] op_sel:[0,0] op_sel_hi:[1,1]
    v_pk_mul_f32 v[208:209], v[208:209], v[160:161] op_sel:[0,0] op_sel_hi:[1,1]
    ds_read_b128 a[196:199], v84 offset:8192
    v_pk_add_f32 v[130:131], v[178:179], v[194:195] op_sel:[0,0] op_sel_hi:[1,1]
    v_pk_mul_f32 v[146:147], v[178:179], v[178:179] op_sel:[0,0] op_sel_hi:[1,1]
    v_pk_add_f32 v[132:133], v[180:181], v[196:197] op_sel:[0,0] op_sel_hi:[1,1]
    v_pk_mul_f32 v[148:149], v[180:181], v[180:181] op_sel:[0,0] op_sel_hi:[1,1]
    v_pk_add_f32 v[134:135], v[182:183], v[198:199] op_sel:[0,0] op_sel_hi:[1,1]
    ds_read_b128 a[200:203], v86 offset:8192
    v_pk_mul_f32 v[150:151], v[182:183], v[182:183] op_sel:[0,0] op_sel_hi:[1,1]
    v_pk_add_f32 v[136:137], v[184:185], v[200:201] op_sel:[0,0] op_sel_hi:[1,1]
    v_pk_mul_f32 v[152:153], v[184:185], v[184:185] op_sel:[0,0] op_sel_hi:[1,1]
    v_pk_add_f32 v[138:139], v[186:187], v[202:203] op_sel:[0,0] op_sel_hi:[1,1]
    ds_read_b128 a[204:207], v88 offset:8192
    v_pk_mul_f32 v[154:155], v[186:187], v[186:187] op_sel:[0,0] op_sel_hi:[1,1]
    v_pk_add_f32 v[140:141], v[188:189], v[204:205] op_sel:[0,0] op_sel_hi:[1,1]
    v_pk_mul_f32 v[156:157], v[188:189], v[188:189] op_sel:[0,0] op_sel_hi:[1,1]
    v_pk_add_f32 v[142:143], v[190:191], v[206:207] op_sel:[0,0] op_sel_hi:[1,1]
    ds_read_b128 a[208:211], v83 offset:8192
    v_pk_mul_f32 v[158:159], v[190:191], v[190:191] op_sel:[0,0] op_sel_hi:[1,1]
    v_pk_add_f32 v[144:145], v[192:193], v[208:209] op_sel:[0,0] op_sel_hi:[1,1]
    v_pk_mul_f32 v[160:161], v[192:193], v[192:193] op_sel:[0,0] op_sel_hi:[1,1]
    v_pk_fma_f32 v[146:147], v[194:195], v[194:195], v[146:147] op_sel:[0,0,0] op_sel_hi:[1,1,1]
    v_pk_fma_f32 v[148:149], v[196:197], v[196:197], v[148:149] op_sel:[0,0,0] op_sel_hi:[1,1,1]
    ds_read_b128 a[212:215], v85 offset:8192
    v_pk_fma_f32 v[150:151], v[198:199], v[198:199], v[150:151] op_sel:[0,0,0] op_sel_hi:[1,1,1]
    v_pk_fma_f32 v[152:153], v[200:201], v[200:201], v[152:153] op_sel:[0,0,0] op_sel_hi:[1,1,1]
    v_pk_fma_f32 v[154:155], v[202:203], v[202:203], v[154:155] op_sel:[0,0,0] op_sel_hi:[1,1,1]
    v_pk_fma_f32 v[156:157], v[204:205], v[204:205], v[156:157] op_sel:[0,0,0] op_sel_hi:[1,1,1]
    ds_read_b128 a[216:219], v87 offset:8192
    v_pk_fma_f32 v[158:159], v[206:207], v[206:207], v[158:159] op_sel:[0,0,0] op_sel_hi:[1,1,1]
    v_pk_fma_f32 v[160:161], v[208:209], v[208:209], v[160:161] op_sel:[0,0,0] op_sel_hi:[1,1,1]
    v_add_f32_dpp v98, v130, v130 row_ror:8 row_mask:0xf bank_mask:0x3
    v_add_f32_dpp v99, v131, v131 row_ror:8 row_mask:0xf bank_mask:0x3
    ds_read_b128 a[220:223], v89 offset:8192
    v_add_f32_dpp v100, v132, v132 row_ror:8 row_mask:0xf bank_mask:0x3
    v_add_f32_dpp v101, v133, v133 row_ror:8 row_mask:0xf bank_mask:0x3
    v_add_f32_dpp v102, v134, v134 row_ror:8 row_mask:0xf bank_mask:0x3
    v_add_f32_dpp v103, v135, v135 row_ror:8 row_mask:0xf bank_mask:0x3
    v_add_f32_dpp v104, v136, v136 row_ror:8 row_mask:0xf bank_mask:0x3
    s_waitcnt lgkmcnt(0)
    s_add_u32 m0, s89, 8192
    s_nop 0
    global_load_lds_dwordx4 v74, s[74:75] offset:0
    v_add_f32_dpp v105, v137, v137 row_ror:8 row_mask:0xf bank_mask:0x3
    v_add_f32_dpp v106, v138, v138 row_ror:8 row_mask:0xf bank_mask:0x3
    v_add_f32_dpp v107, v139, v139 row_ror:8 row_mask:0xf bank_mask:0x3
    v_add_f32_dpp v108, v140, v140 row_ror:8 row_mask:0xf bank_mask:0x3
    global_load_lds_dwordx4 v75, s[74:75] offset:1024
    v_add_f32_dpp v109, v141, v141 row_ror:8 row_mask:0xf bank_mask:0x3
    v_add_f32_dpp v110, v142, v142 row_ror:8 row_mask:0xf bank_mask:0x3
    v_add_f32_dpp v111, v143, v143 row_ror:8 row_mask:0xf bank_mask:0x3
    v_add_f32_dpp v112, v144, v144 row_ror:8 row_mask:0xf bank_mask:0x3
    global_load_lds_dwordx4 v76, s[74:75] offset:2048
    v_add_f32_dpp v113, v145, v145 row_ror:8 row_mask:0xf bank_mask:0x3
    v_add_f32_dpp v98, v146, v146 row_ror:8 row_mask:0xf bank_mask:0xc
    v_add_f32_dpp v99, v147, v147 row_ror:8 row_mask:0xf bank_mask:0xc
    v_add_f32_dpp v100, v148, v148 row_ror:8 row_mask:0xf bank_mask:0xc
    v_add_f32_dpp v101, v149, v149 row_ror:8 row_mask:0xf bank_mask:0xc
    global_load_lds_dwordx4 v77, s[74:75] offset:3072
    v_add_f32_dpp v102, v150, v150 row_ror:8 row_mask:0xf bank_mask:0xc
    v_add_f32_dpp v103, v151, v151 row_ror:8 row_mask:0xf bank_mask:0xc
    v_add_f32_dpp v104, v152, v152 row_ror:8 row_mask:0xf bank_mask:0xc
    v_add_f32_dpp v105, v153, v153 row_ror:8 row_mask:0xf bank_mask:0xc
    s_add_u32 m0, s89, 12288
    s_nop 0
    global_load_lds_dwordx4 v78, s[74:75] offset:0
    v_add_f32_dpp v106, v154, v154 row_ror:8 row_mask:0xf bank_mask:0xc
    v_add_f32_dpp v107, v155, v155 row_ror:8 row_mask:0xf bank_mask:0xc
    v_add_f32_dpp v108, v156, v156 row_ror:8 row_mask:0xf bank_mask:0xc
    v_add_f32_dpp v109, v157, v157 row_ror:8 row_mask:0xf bank_mask:0xc
    global_load_lds_dwordx4 v79, s[74:75] offset:1024
    v_add_f32_dpp v110, v158, v158 row_ror:8 row_mask:0xf bank_mask:0xc
    v_add_f32_dpp v111, v159, v159 row_ror:8 row_mask:0xf bank_mask:0xc
    v_add_f32_dpp v112, v160, v160 row_ror:8 row_mask:0xf bank_mask:0xc
    v_add_f32_dpp v113, v161, v161 row_ror:8 row_mask:0xf bank_mask:0xc
    v_add_f32_dpp v130, v98, v98 row_half_mirror row_mask:0xf bank_mask:0x5
    global_load_lds_dwordx4 v80, s[74:75] offset:2048
    v_add_f32_dpp v131, v99, v99 row_half_mirror row_mask:0xf bank_mask:0x5
    v_add_f32_dpp v132, v100, v100 row_half_mirror row_mask:0xf bank_mask:0x5
    v_add_f32_dpp v133, v101, v101 row_half_mirror row_mask:0xf bank_mask:0x5
    v_add_f32_dpp v134, v102, v102 row_half_mirror row_mask:0xf bank_mask:0x5
    global_load_lds_dwordx4 v81, s[74:75] offset:3072
    v_add_f32_dpp v135, v103, v103 row_half_mirror row_mask:0xf bank_mask:0x5
    v_add_f32_dpp v136, v104, v104 row_half_mirror row_mask:0xf bank_mask:0x5
    v_add_f32_dpp v137, v105, v105 row_half_mirror row_mask:0xf bank_mask:0x5
    v_add_f32_dpp v130, v106, v106 row_half_mirror row_mask:0xf bank_mask:0xa
    v_add_f32_dpp v131, v107, v107 row_half_mirror row_mask:0xf bank_mask:0xa
    v_add_f32_dpp v132, v108, v108 row_half_mirror row_mask:0xf bank_mask:0xa
    v_add_f32_dpp v133, v109, v109 row_half_mirror row_mask:0xf bank_mask:0xa
    v_add_f32_dpp v134, v110, v110 row_half_mirror row_mask:0xf bank_mask:0xa
    v_add_f32_dpp v135, v111, v111 row_half_mirror row_mask:0xf bank_mask:0xa
    v_add_f32_dpp v136, v112, v112 row_half_mirror row_mask:0xf bank_mask:0xa
    v_add_f32_dpp v137, v113, v113 row_half_mirror row_mask:0xf bank_mask:0xa
    v_add_f32_dpp v130, v130, v130 quad_perm:[1,0,3,2] row_mask:0xf bank_mask:0xf
    v_add_f32_dpp v131, v131, v131 quad_perm:[1,0,3,2] row_mask:0xf bank_mask:0xf
    v_add_f32_dpp v132, v132, v132 quad_perm:[1,0,3,2] row_mask:0xf bank_mask:0xf
    v_add_f32_dpp v133, v133, v133 quad_perm:[1,0,3,2] row_mask:0xf bank_mask:0xf
    v_add_f32_dpp v134, v134, v134 quad_perm:[1,0,3,2] row_mask:0xf bank_mask:0xf
    v_add_f32_dpp v135, v135, v135 quad_perm:[1,0,3,2] row_mask:0xf bank_mask:0xf
    v_add_f32_dpp v136, v136, v136 quad_perm:[1,0,3,2] row_mask:0xf bank_mask:0xf
    v_add_f32_dpp v137, v137, v137 quad_perm:[1,0,3,2] row_mask:0xf bank_mask:0xf
    v_add_f32_dpp v130, v130, v130 quad_perm:[2,3,0,1] row_mask:0xf bank_mask:0xf
    v_add_f32_dpp v131, v131, v131 quad_perm:[2,3,0,1] row_mask:0xf bank_mask:0xf
    v_add_f32_dpp v132, v132, v132 quad_perm:[2,3,0,1] row_mask:0xf bank_mask:0xf
    v_add_f32_dpp v133, v133, v133 quad_perm:[2,3,0,1] row_mask:0xf bank_mask:0xf
    v_add_f32_dpp v134, v134, v134 quad_perm:[2,3,0,1] row_mask:0xf bank_mask:0xf
    v_add_f32_dpp v135, v135, v135 quad_perm:[2,3,0,1] row_mask:0xf bank_mask:0xf
    v_add_f32_dpp v136, v136, v136 quad_perm:[2,3,0,1] row_mask:0xf bank_mask:0xf
    v_add_f32_dpp v137, v137, v137 quad_perm:[2,3,0,1] row_mask:0xf bank_mask:0xf
    v_lshrrev_b32 v28, 2, v2
    v_lshl_add_u32 v28, v28, 7, v171
    ds_write_b128 v28, v[130:133]
    ds_write_b128 v28, v[134:137] offset:16
    s_waitcnt lgkmcnt(0)
    s_barrier
    v_lshlrev_b32 v28, 2, v1
    v_add_u32 v28, 150784, v28
    ds_read2st64_b32 v[90:91], v28 offset0:0 offset1:1
    ds_read2st64_b32 v[92:93], v28 offset0:2 offset1:3
    ds_read2st64_b32 v[94:95], v28 offset0:4 offset1:5
    ds_read2st64_b32 v[96:97], v28 offset0:6 offset1:7
    s_lshl_b32 s4, s40, 12
    s_add_u32 s4, s4, 12451840
    v_add_u32 v174, s4, v30
    s_lshl_b32 s4, s41, 9
    v_add_u32 v28, s4, v174
    v_subrev_u32 v170, 2048, v170
    v_subrev_u32 v171, 2048, v171
    s_waitcnt lgkmcnt(2)
    v_pk_add_f32 v[90:91], v[90:91], v[92:93] op_sel:[0,0] op_sel_hi:[1,1]
    s_waitcnt lgkmcnt(0)
    v_pk_add_f32 v[94:95], v[94:95], v[96:97] op_sel:[0,0] op_sel_hi:[1,1]
    v_pk_add_f32 v[90:91], v[90:91], v[94:95] op_sel:[0,0] op_sel_hi:[1,1]
    v_min_u32 v90, -2, v90
    v_min_u32 v91, -2, v91
    s_lshl_b32 s4, s3, 4
    s_lshl_b64 exec, 0xffff, s4
    global_store_dwordx2 v28, v[90:91], s[38:39] sc1
    s_mov_b64 exec, -1
    ds_read_b128 v[48:51], v4 offset:0
    ds_read_b128 v[52:55], v4 offset:1040
    ds_read_b128 v[56:59], v4 offset:2080
    ds_read_b128 v[60:63], v4 offset:3120
    ds_read_b128 v[64:67], v4 offset:4160
    s_waitcnt lgkmcnt(3)
    s_waitcnt vmcnt(56)
    v_mfma_f32_16x16x32_bf16 v[210:213], a[0:3], v[48:51], 0
    ds_read_b128 v[68:71], v4 offset:5200
    s_waitcnt vmcnt(55)
    v_mfma_f32_16x16x32_bf16 v[226:229], a[4:7], v[48:51], 0
    v_mfma_f32_16x16x32_bf16 v[214:217], a[0:3], v[52:55], 0
    ds_read_b128 v[48:51], v4 offset:6240
    s_waitcnt vmcnt(9)
    ds_read_b128 a[160:163], v82 offset:0
    v_mfma_f32_16x16x32_bf16 v[230:233], a[4:7], v[52:55], 0
    v_min_u32 v175, 26, v1
    s_waitcnt lgkmcnt(4)
    v_mfma_f32_16x16x32_bf16 v[218:221], a[0:3], v[56:59], 0
    ds_read_b128 v[52:55], v4 offset:7280
    v_lshlrev_b32 v175, 7, v175
    v_mfma_f32_16x16x32_bf16 v[234:237], a[4:7], v[56:59], 0
    ds_read_b128 a[164:167], v84 offset:0
    v_mfma_f32_16x16x32_bf16 v[222:225], a[0:3], v[60:63], 0
    ds_read_b128 v[56:59], v4 offset:8320
    ds_read_b128 a[168:171], v86 offset:0
    v_mfma_f32_16x16x32_bf16 v[238:241], a[4:7], v[60:63], 0
    v_add_u32 v175, 180224, v175
    s_waitcnt lgkmcnt(6)
    v_mfma_f32_16x16x32_bf16 v[210:213], a[8:11], v[64:67], v[210:213]
    ds_read_b128 v[60:63], v4 offset:9360
    ds_read_b128 a[172:175], v88 offset:0
    v_mfma_f32_16x16x32_bf16 v[226:229], a[12:15], v[64:67], v[226:229]
    global_load_dword v250, v175, s[38:39] sc1
    v_mfma_f32_16x16x32_bf16 v[214:217], a[8:11], v[68:71], v[214:217]
    ds_read_b128 v[64:67], v4 offset:10400
    ds_read_b128 a[176:179], v83 offset:0
    v_mfma_f32_16x16x32_bf16 v[230:233], a[12:15], v[68:71], v[230:233]
    ds_read_b128 a[180:183], v85 offset:0
    s_mul_i32 s7, s41, 320
    s_waitcnt lgkmcnt(8)
    v_mfma_f32_16x16x32_bf16 v[218:221], a[8:11], v[48:51], v[218:221]
    ds_read_b128 v[68:71], v4 offset:11440
    v_mfma_f32_16x16x32_bf16 v[234:237], a[12:15], v[48:51], v[234:237]
    ds_read_b128 a[184:187], v87 offset:0
    s_add_u32 s7, s7, 12800
    v_mfma_f32_16x16x32_bf16 v[222:225], a[8:11], v[52:55], v[222:225]
    ds_read_b128 v[48:51], v4 offset:12480
    ds_read_b128 a[188:191], v89 offset:0
    v_mfma_f32_16x16x32_bf16 v[238:241], a[12:15], v[52:55], v[238:241]
    s_waitcnt lgkmcnt(8)
    v_mfma_f32_16x16x32_bf16 v[210:213], a[16:19], v[56:59], v[210:213]
    ds_read_b128 v[52:55], v4 offset:13520
    s_waitcnt lgkmcnt(1)
    s_add_u32 m0, s89, 0
    v_mfma_f32_16x16x32_bf16 v[226:229], a[20:23], v[56:59], v[226:229]
    v_min_u32 v175, 304, v4
    v_mfma_f32_16x16x32_bf16 v[214:217], a[16:19], v[60:63], v[214:217]
    ds_read_b128 v[56:59], v4 offset:14560
    v_add_u32 v175, s7, v175
    v_mfma_f32_16x16x32_bf16 v[230:233], a[20:23], v[60:63], v[230:233]
    global_load_lds_dwordx4 v74, s[76:77] offset:0
    v_mfma_f32_16x16x32_bf16 v[218:221], a[16:19], v[64:67], v[218:221]
    ds_read_b128 v[60:63], v4 offset:15600
    v_mfma_f32_16x16x32_bf16 v[234:237], a[20:23], v[64:67], v[234:237]
    global_load_lds_dwordx4 v75, s[76:77] offset:1024
    global_load_dwordx4 v[242:245], v175, s[38:39] sc1
    v_mfma_f32_16x16x32_bf16 v[222:225], a[16:19], v[68:71], v[222:225]
    ds_read_b128 v[64:67], v4 offset:16640
    global_load_lds_dwordx4 v76, s[76:77] offset:2048
    v_mfma_f32_16x16x32_bf16 v[238:241], a[20:23], v[68:71], v[238:241]
    v_add_u32 v175, 15360, v175
    s_waitcnt lgkmcnt(3)
    v_mfma_f32_16x16x32_bf16 v[210:213], a[24:27], v[48:51], v[210:213]
    ds_read_b128 v[68:71], v4 offset:17680
    global_load_lds_dwordx4 v77, s[76:77] offset:3072
    v_mfma_f32_16x16x32_bf16 v[226:229], a[28:31], v[48:51], v[226:229]
    global_load_dwordx4 v[246:249], v175, s[38:39] sc1
    v_mfma_f32_16x16x32_bf16 v[214:217], a[24:27], v[52:55], v[214:217]
    ds_read_b128 v[48:51], v4 offset:18720
    s_add_u32 m0, s89, 4096
    v_mfma_f32_16x16x32_bf16 v[230:233], a[28:31], v[52:55], v[230:233]
    global_load_lds_dwordx4 v78, s[76:77] offset:0
    s_waitcnt lgkmcnt(3)
    v_mfma_f32_16x16x32_bf16 v[218:221], a[24:27], v[56:59], v[218:221]
    ds_read_b128 v[52:55], v4 offset:19760
    ds_read_b128 v[36:39], v46 offset:0
    v_mfma_f32_16x16x32_bf16 v[234:237], a[28:31], v[56:59], v[234:237]
    global_load_lds_dwordx4 v79, s[76:77] offset:1024
    v_mfma_f32_16x16x32_bf16 v[222:225], a[24:27], v[60:63], v[222:225]
    ds_read_b128 v[56:59], v4 offset:20800
    global_load_lds_dwordx4 v80, s[76:77] offset:2048
    v_mfma_f32_16x16x32_bf16 v[238:241], a[28:31], v[60:63], v[238:241]
    ds_read_b128 v[40:43], v46 offset:4160
    s_waitcnt lgkmcnt(5)
    v_mfma_f32_16x16x32_bf16 v[210:213], a[32:35], v[64:67], v[210:213]
    ds_read_b128 v[60:63], v4 offset:21840
    global_load_lds_dwordx4 v81, s[76:77] offset:3072
    v_mfma_f32_16x16x32_bf16 v[226:229], a[36:39], v[64:67], v[226:229]
    ds_read_b64 v[44:45], v47 offset:8320
    v_mfma_f32_16x16x32_bf16 v[214:217], a[32:35], v[68:71], v[214:217]
    ds_read_b128 v[64:67], v4 offset:22880
    s_waitcnt vmcnt(12)
    ds_read_b128 a[0:3], v82 offset:8192
    v_mfma_f32_16x16x32_bf16 v[230:233], a[36:39], v[68:71], v[230:233]
    s_waitcnt vmcnt(7)
    v_max3_u32 v28, v242, v243, v244
    s_waitcnt lgkmcnt(7)
    v_mfma_f32_16x16x32_bf16 v[218:221], a[32:35], v[48:51], v[218:221]
    ds_read_b128 v[68:71], v4 offset:23920
    v_mfma_f32_16x16x32_bf16 v[234:237], a[36:39], v[48:51], v[234:237]
    ds_read_b128 a[4:7], v84 offset:8192
    s_waitcnt vmcnt(4)
    v_max3_u32 v28, v245, v246, v28
    v_mfma_f32_16x16x32_bf16 v[222:225], a[32:35], v[52:55], v[222:225]
    ds_read_b128 v[48:51], v4 offset:24960
    ds_read_b128 a[8:11], v86 offset:8192
    v_mfma_f32_16x16x32_bf16 v[238:241], a[36:39], v[52:55], v[238:241]
    s_waitcnt lgkmcnt(7)
    v_mfma_f32_16x16x32_bf16 v[210:213], a[40:43], v[56:59], v[210:213]
    ds_read_b128 v[52:55], v4 offset:26000
    ds_read_b128 a[12:15], v88 offset:8192
    v_mfma_f32_16x16x32_bf16 v[226:229], a[44:47], v[56:59], v[226:229]
    v_max3_u32 v28, v247, v248, v28
    v_mfma_f32_16x16x32_bf16 v[214:217], a[40:43], v[60:63], v[214:217]
    ds_read_b128 v[56:59], v4 offset:27040
    ds_read_b128 a[16:19], v83 offset:8192
    v_mfma_f32_16x16x32_bf16 v[230:233], a[44:47], v[60:63], v[230:233]
    v_max3_u32 v28, v249, v250, v28
    ds_read_b128 a[20:23], v85 offset:8192
    s_waitcnt lgkmcnt(8)
    v_mfma_f32_16x16x32_bf16 v[218:221], a[40:43], v[64:67], v[218:221]
    ds_read_b128 v[60:63], v4 offset:28080
    v_cmp_eq_u32 vcc, -1, v28
    v_mfma_f32_16x16x32_bf16 v[234:237], a[44:47], v[64:67], v[234:237]
    ds_read_b128 a[24:27], v87 offset:8192
    v_mfma_f32_16x16x32_bf16 v[222:225], a[40:43], v[68:71], v[222:225]
    ds_read_b128 v[64:67], v4 offset:29120
    ds_read_b128 a[28:31], v89 offset:8192
    v_mfma_f32_16x16x32_bf16 v[238:241], a[44:47], v[68:71], v[238:241]
    s_cbranch_vccnz Lgb_r
Lgb_ok:
    s_waitcnt lgkmcnt(8)
    v_mfma_f32_16x16x32_bf16 v[210:213], a[48:51], v[48:51], v[210:213]
    ds_read_b128 v[68:71], v4 offset:30160
    s_waitcnt lgkmcnt(1)
    s_add_u32 m0, s89, 8192
    v_mfma_f32_16x16x32_bf16 v[226:229], a[52:55], v[48:51], v[226:229]
    v_add_f32 v242, v242, v246
    v_mfma_f32_16x16x32_bf16 v[214:217], a[48:51], v[52:55], v[214:217]
    ds_read_b128 v[48:51], v4 offset:31200
    v_mfma_f32_16x16x32_bf16 v[230:233], a[52:55], v[52:55], v[230:233]
    global_load_lds_dwordx4 v74, s[78:79] offset:0
    v_add_f32 v243, v243, v247
    v_mfma_f32_16x16x32_bf16 v[218:221], a[48:51], v[56:59], v[218:221]
    ds_read_b128 v[52:55], v4 offset:32240
    v_mfma_f32_16x16x32_bf16 v[234:237], a[52:55], v[56:59], v[234:237]
    global_load_lds_dwordx4 v75, s[78:79] offset:1024
    v_mfma_f32_16x16x32_bf16 v[222:225], a[48:51], v[60:63], v[222:225]
    ds_read_b128 v[56:59], v4 offset:33280
    v_add_f32 v244, v244, v248
    v_mfma_f32_16x16x32_bf16 v[238:241], a[52:55], v[60:63], v[238:241]
    global_load_lds_dwordx4 v76, s[78:79] offset:2048
    s_waitcnt lgkmcnt(3)
    v_mfma_f32_16x16x32_bf16 v[210:213], a[56:59], v[64:67], v[210:213]
    ds_read_b128 v[60:63], v4 offset:34320
    global_load_lds_dwordx4 v77, s[78:79] offset:3072
    v_mfma_f32_16x16x32_bf16 v[226:229], a[60:63], v[64:67], v[226:229]
    v_add_f32 v245, v245, v249
    v_mfma_f32_16x16x32_bf16 v[214:217], a[56:59], v[68:71], v[214:217]
    ds_read_b128 v[64:67], v4 offset:35360
    s_add_u32 m0, s89, 12288
    v_mfma_f32_16x16x32_bf16 v[230:233], a[60:63], v[68:71], v[230:233]
    global_load_lds_dwordx4 v78, s[78:79] offset:0
    v_cvt_pk_bf16_f32 v242, v242, v242
    s_waitcnt lgkmcnt(3)
    v_mfma_f32_16x16x32_bf16 v[218:221], a[56:59], v[48:51], v[218:221]
    ds_read_b128 v[68:71], v4 offset:36400
    v_mfma_f32_16x16x32_bf16 v[234:237], a[60:63], v[48:51], v[234:237]
    global_load_lds_dwordx4 v79, s[78:79] offset:1024
    v_lshlrev_b32 v242, 16, v242
    v_mfma_f32_16x16x32_bf16 v[222:225], a[56:59], v[52:55], v[222:225]
    ds_read_b128 v[48:51], v4 offset:37440
    global_load_lds_dwordx4 v80, s[78:79] offset:2048
    v_mfma_f32_16x16x32_bf16 v[238:241], a[60:63], v[52:55], v[238:241]
    v_cvt_pk_bf16_f32 v243, v243, v243
    s_waitcnt lgkmcnt(3)
    v_mfma_f32_16x16x32_bf16 v[210:213], a[64:67], v[56:59], v[210:213]
    ds_read_b128 v[52:55], v4 offset:38480
    global_load_lds_dwordx4 v81, s[78:79] offset:3072
    v_mfma_f32_16x16x32_bf16 v[226:229], a[68:71], v[56:59], v[226:229]
    v_mfma_f32_16x16x32_bf16 v[214:217], a[64:67], v[60:63], v[214:217]
    ds_read_b128 v[56:59], v4 offset:39520
    s_waitcnt vmcnt(8)
    ds_read_b128 a[32:35], v82 offset:0
    v_mfma_f32_16x16x32_bf16 v[230:233], a[68:71], v[60:63], v[230:233]
    v_lshlrev_b32 v243, 16, v243
    s_waitcnt lgkmcnt(4)
    v_mfma_f32_16x16x32_bf16 v[218:221], a[64:67], v[64:67], v[218:221]
    ds_read_b128 v[60:63], v4 offset:40560
    v_cvt_pk_bf16_f32 v244, v244, v244
    v_mfma_f32_16x16x32_bf16 v[234:237], a[68:71], v[64:67], v[234:237]
    ds_read_b128 a[36:39], v84 offset:0
    v_mfma_f32_16x16x32_bf16 v[222:225], a[64:67], v[68:71], v[222:225]
    ds_read_b128 v[64:67], v173 offset:0
    ds_read_b128 a[40:43], v86 offset:0
    v_mfma_f32_16x16x32_bf16 v[238:241], a[68:71], v[68:71], v[238:241]
    v_lshlrev_b32 v244, 16, v244
    s_waitcnt lgkmcnt(6)
    v_mfma_f32_16x16x32_bf16 v[210:213], a[72:75], v[48:51], v[210:213]
    ds_read_b128 v[68:71], v173 offset:1040
    ds_read_b128 a[44:47], v88 offset:0
    v_mfma_f32_16x16x32_bf16 v[226:229], a[76:79], v[48:51], v[226:229]
    v_cvt_pk_bf16_f32 v245, v245, v245
    v_mfma_f32_16x16x32_bf16 v[214:217], a[72:75], v[52:55], v[214:217]
    ds_read_b128 v[48:51], v173 offset:2080
    ds_read_b128 a[48:51], v83 offset:0
    v_mfma_f32_16x16x32_bf16 v[230:233], a[76:79], v[52:55], v[230:233]
    ds_read_b128 a[52:55], v85 offset:0
    v_lshlrev_b32 v245, 16, v245
    s_waitcnt lgkmcnt(8)
    v_mfma_f32_16x16x32_bf16 v[218:221], a[72:75], v[56:59], v[218:221]
    ds_read_b128 v[52:55], v173 offset:3120
    v_mfma_f32_16x16x32_bf16 v[234:237], a[76:79], v[56:59], v[234:237]
    ds_read_b128 a[56:59], v87 offset:0
    v_mfma_f32_16x16x32_bf16 v[222:225], a[72:75], v[60:63], v[222:225]
    ds_read_b128 v[56:59], v173 offset:4160
    v_min_u32 v175, 304, v4
    v_mfma_f32_16x16x32_bf16 v[238:241], a[76:79], v[60:63], v[238:241]
    ds_read_b128 a[60:63], v89 offset:0
    s_waitcnt lgkmcnt(8)
    v_mfma_f32_16x16x32_bf16 v[210:213], a[80:83], v[64:67], v[210:213]
    ds_read_b128 v[60:63], v173 offset:5200
    s_waitcnt lgkmcnt(1)
    s_add_u32 m0, s89, 0
    v_mfma_f32_16x16x32_bf16 v[226:229], a[84:87], v[64:67], v[226:229]
    v_add_u32 v175, 162816, v175
    v_mfma_f32_16x16x32_bf16 v[214:217], a[80:83], v[68:71], v[214:217]
    ds_read_b128 v[64:67], v173 offset:6240
    v_mfma_f32_16x16x32_bf16 v[230:233], a[84:87], v[68:71], v[230:233]
    global_load_lds_dwordx4 v74, s[80:81] offset:0
    v_mfma_f32_16x16x32_bf16 v[218:221], a[80:83], v[48:51], v[218:221]
    ds_read_b128 v[68:71], v173 offset:7280
    v_mfma_f32_16x16x32_bf16 v[234:237], a[84:87], v[48:51], v[234:237]
    ds_write_b128 v175, v[242:245]
    v_mfma_f32_16x16x32_bf16 v[222:225], a[80:83], v[52:55], v[222:225]
    ds_read_b128 v[48:51], v173 offset:8320
    global_load_lds_dwordx4 v75, s[80:81] offset:1024
    v_mfma_f32_16x16x32_bf16 v[238:241], a[84:87], v[52:55], v[238:241]
    global_load_lds_dwordx4 v76, s[80:81] offset:2048
    s_waitcnt lgkmcnt(4)
    v_mfma_f32_16x16x32_bf16 v[210:213], a[88:91], v[56:59], v[210:213]
    ds_read_b128 v[52:55], v173 offset:9360
    global_load_lds_dwordx4 v77, s[80:81] offset:3072
    v_mfma_f32_16x16x32_bf16 v[226:229], a[92:95], v[56:59], v[226:229]
    v_mfma_f32_16x16x32_bf16 v[214:217], a[88:91], v[60:63], v[214:217]
    ds_read_b128 v[56:59], v173 offset:10400
    global_load_dwordx2 v[130:131], v174, s[38:39] offset:0 sc1
    s_add_u32 m0, s89, 4096
    v_mfma_f32_16x16x32_bf16 v[230:233], a[92:95], v[60:63], v[230:233]
    global_load_dwordx2 v[132:133], v174, s[38:39] offset:512 sc1
    global_load_lds_dwordx4 v78, s[80:81] offset:0
    s_waitcnt lgkmcnt(4)
    v_mfma_f32_16x16x32_bf16 v[218:221], a[88:91], v[64:67], v[218:221]
    ds_read_b128 v[60:63], v173 offset:11440
    global_load_dwordx2 v[134:135], v174, s[38:39] offset:1024 sc1
    v_mfma_f32_16x16x32_bf16 v[234:237], a[92:95], v[64:67], v[234:237]
    global_load_dwordx2 v[136:137], v174, s[38:39] offset:1536 sc1
    global_load_lds_dwordx4 v79, s[80:81] offset:1024
    v_mfma_f32_16x16x32_bf16 v[222:225], a[88:91], v[68:71], v[222:225]
    ds_read_b128 v[64:67], v173 offset:12480
    global_load_dwordx2 v[138:139], v174, s[38:39] offset:2048 sc1
    v_mfma_f32_16x16x32_bf16 v[238:241], a[92:95], v[68:71], v[238:241]
    global_load_dwordx2 v[140:141], v174, s[38:39] offset:2560 sc1
    global_load_lds_dwordx4 v80, s[80:81] offset:2048
    s_waitcnt lgkmcnt(3)
    v_mfma_f32_16x16x32_bf16 v[210:213], a[96:99], v[48:51], v[210:213]
    ds_read_b128 v[68:71], v173 offset:13520
    global_load_dwordx2 v[142:143], v174, s[38:39] offset:3072 sc1
    v_mfma_f32_16x16x32_bf16 v[226:229], a[100:103], v[48:51], v[226:229]
    global_load_lds_dwordx4 v81, s[80:81] offset:3072
    global_load_dwordx2 v[144:145], v174, s[38:39] offset:3584 sc1
    v_mfma_f32_16x16x32_bf16 v[214:217], a[96:99], v[52:55], v[214:217]
    ds_read_b128 v[48:51], v173 offset:14560
    s_waitcnt vmcnt(16)
    ds_read_b128 a[64:67], v82 offset:8192
    v_mfma_f32_16x16x32_bf16 v[230:233], a[100:103], v[52:55], v[230:233]
    s_waitcnt lgkmcnt(4)
    v_mfma_f32_16x16x32_bf16 v[218:221], a[96:99], v[56:59], v[218:221]
    ds_read_b128 v[52:55], v173 offset:15600
    v_mfma_f32_16x16x32_bf16 v[234:237], a[100:103], v[56:59], v[234:237]
    ds_read_b128 a[68:71], v84 offset:8192
    v_mfma_f32_16x16x32_bf16 v[222:225], a[96:99], v[60:63], v[222:225]
    ds_read_b128 v[56:59], v173 offset:16640
    ds_read_b128 a[72:75], v86 offset:8192
    v_mfma_f32_16x16x32_bf16 v[238:241], a[100:103], v[60:63], v[238:241]
    s_waitcnt lgkmcnt(6)
    v_mfma_f32_16x16x32_bf16 v[210:213], a[104:107], v[64:67], v[210:213]
    ds_read_b128 v[60:63], v173 offset:17680
    ds_read_b128 a[76:79], v88 offset:8192
    v_mfma_f32_16x16x32_bf16 v[226:229], a[108:111], v[64:67], v[226:229]
    v_mfma_f32_16x16x32_bf16 v[214:217], a[104:107], v[68:71], v[214:217]
    ds_read_b128 v[64:67], v173 offset:18720
    ds_read_b128 a[80:83], v83 offset:8192
    v_mfma_f32_16x16x32_bf16 v[230:233], a[108:111], v[68:71], v[230:233]
    ds_read_b128 a[84:87], v85 offset:8192
    s_waitcnt lgkmcnt(8)
    v_mfma_f32_16x16x32_bf16 v[218:221], a[104:107], v[48:51], v[218:221]
    ds_read_b128 v[68:71], v173 offset:19760
    v_mfma_f32_16x16x32_bf16 v[234:237], a[108:111], v[48:51], v[234:237]
    ds_read_b128 a[88:91], v87 offset:8192
    v_mfma_f32_16x16x32_bf16 v[222:225], a[104:107], v[52:55], v[222:225]
    ds_read_b128 v[48:51], v173 offset:20800
    ds_read_b128 a[92:95], v89 offset:8192
    v_mfma_f32_16x16x32_bf16 v[238:241], a[108:111], v[52:55], v[238:241]
    s_waitcnt lgkmcnt(8)
    v_mfma_f32_16x16x32_bf16 v[210:213], a[112:115], v[56:59], v[210:213]
    ds_read_b128 v[52:55], v173 offset:21840
    s_waitcnt lgkmcnt(1)
    s_add_u32 m0, s89, 8192
    v_mfma_f32_16x16x32_bf16 v[226:229], a[116:119], v[56:59], v[226:229]
    v_mfma_f32_16x16x32_bf16 v[214:217], a[112:115], v[60:63], v[214:217]
    ds_read_b128 v[56:59], v173 offset:22880
    v_mfma_f32_16x16x32_bf16 v[230:233], a[116:119], v[60:63], v[230:233]
    global_load_lds_dwordx4 v74, s[82:83] offset:0
    v_mfma_f32_16x16x32_bf16 v[218:221], a[112:115], v[64:67], v[218:221]
    ds_read_b128 v[60:63], v173 offset:23920
    v_mfma_f32_16x16x32_bf16 v[234:237], a[116:119], v[64:67], v[234:237]
    global_load_lds_dwordx4 v75, s[82:83] offset:1024
    v_mfma_f32_16x16x32_bf16 v[222:225], a[112:115], v[68:71], v[222:225]
    ds_read_b128 v[64:67], v173 offset:24960
    global_load_lds_dwordx4 v76, s[82:83] offset:2048
    v_mfma_f32_16x16x32_bf16 v[238:241], a[116:119], v[68:71], v[238:241]
    s_waitcnt lgkmcnt(3)
    s_waitcnt vmcnt(13)
    v_max_u32 v28, v131, v133
    s_waitcnt vmcnt(10)
    v_max3_u32 v28, v135, v137, v28
    s_waitcnt vmcnt(7)
    v_max3_u32 v28, v139, v141, v28
    s_waitcnt vmcnt(3)
    v_max3_u32 v28, v143, v145, v28
    v_cmp_eq_u32 vcc, -1, v28
    s_nop 0
    s_cbranch_vccnz Ls3_r
Ls3_ok:
    v_pk_add_f32 v[130:131], v[130:131], v[132:133] op_sel:[0,0] op_sel_hi:[1,1]
    v_pk_add_f32 v[134:135], v[134:135], v[136:137] op_sel:[0,0] op_sel_hi:[1,1]
    v_pk_add_f32 v[138:139], v[138:139], v[140:141] op_sel:[0,0] op_sel_hi:[1,1]
    v_pk_add_f32 v[142:143], v[142:143], v[144:145] op_sel:[0,0] op_sel_hi:[1,1]
    v_pk_add_f32 v[130:131], v[130:131], v[134:135] op_sel:[0,0] op_sel_hi:[1,1]
    v_pk_add_f32 v[138:139], v[138:139], v[142:143] op_sel:[0,0] op_sel_hi:[1,1]
    v_pk_add_f32 v[130:131], v[130:131], v[138:139] op_sel:[0,0] op_sel_hi:[1,1]
    v_mul_f32 v130, 0x3a97b426, v130
    v_mul_f32 v131, 0x3a97b426, v131
    v_fma_f32 v131, -v130, v130, v131
    v_max_f32 v131, 0, v131
    v_add_f32 v131, 0x3727c5ac, v131
    v_rsq_f32 v132, v131
    s_nop 0
    v_mul_f32_e64 v131, -v130, v132
    v_mov_b32 v130, v132
    ds_write2st64_b32 v170, v130, v131 offset0:0 offset1:1
    ds_read_b128 v[98:101], v171 offset:0
    ds_read_b128 v[102:105], v171 offset:16
    ds_read_b128 v[106:109], v171 offset:128
    ds_read_b128 v[110:113], v171 offset:144
    ds_read_b128 v[114:117], v171 offset:256
    ds_read_b128 v[118:121], v171 offset:272
    ds_read_b128 v[122:125], v171 offset:384
    ds_read_b128 v[126:129], v171 offset:400
    s_lshl_b32 s4, s41, 6
    s_lshl_b32 s5, s40, 1
    s_add_u32 s4, s4, s5
    s_mul_i32 s4, s4, 7168
    s_lshl_b32 s5, s3, 11
    s_add_u32 s4, s4, s5
    s_add_u32 s4, s4, 12582912
    v_add_u32 v28, s4, v4
    v_add_u32 v29, 7168, v28
    s_waitcnt lgkmcnt(3)
    v_pk_fma_f32 v[178:179], v[178:179], v[98:99], v[114:115] op_sel:[0,0,0] op_sel_hi:[1,1,1]
    v_pk_fma_f32 v[180:181], v[180:181], v[100:101], v[116:117] op_sel:[0,0,0] op_sel_hi:[1,1,1]
    s_waitcnt lgkmcnt(2)
    v_pk_fma_f32 v[182:183], v[182:183], v[102:103], v[118:119] op_sel:[0,0,0] op_sel_hi:[1,1,1]
    v_pk_fma_f32 v[184:185], v[184:185], v[104:105], v[120:121] op_sel:[0,0,0] op_sel_hi:[1,1,1]
    v_cvt_pk_bf16_f32 v130, v178, v179
    v_cvt_pk_bf16_f32 v131, v180, v181
    v_cvt_pk_bf16_f32 v132, v182, v183
    v_cvt_pk_bf16_f32 v133, v184, v185
    v_or_b32 v133, 1, v133
    global_store_dwordx4 v28, v[130:133], s[38:39] offset:0 sc1
    s_waitcnt lgkmcnt(1)
    v_pk_fma_f32 v[186:187], v[186:187], v[106:107], v[122:123] op_sel:[0,0,0] op_sel_hi:[1,1,1]
    v_pk_fma_f32 v[188:189], v[188:189], v[108:109], v[124:125] op_sel:[0,0,0] op_sel_hi:[1,1,1]
    s_waitcnt lgkmcnt(0)
    v_pk_fma_f32 v[190:191], v[190:191], v[110:111], v[126:127] op_sel:[0,0,0] op_sel_hi:[1,1,1]
    v_pk_fma_f32 v[192:193], v[192:193], v[112:113], v[128:129] op_sel:[0,0,0] op_sel_hi:[1,1,1]
    v_cvt_pk_bf16_f32 v134, v186, v187
    v_cvt_pk_bf16_f32 v135, v188, v189
    v_cvt_pk_bf16_f32 v136, v190, v191
    v_cvt_pk_bf16_f32 v137, v192, v193
    v_or_b32 v137, 1, v137
    global_store_dwordx4 v29, v[134:137], s[38:39] offset:0 sc1
    v_pk_fma_f32 v[194:195], v[194:195], v[98:99], v[114:115] op_sel:[0,0,0] op_sel_hi:[1,1,1]
    v_pk_fma_f32 v[196:197], v[196:197], v[100:101], v[116:117] op_sel:[0,0,0] op_sel_hi:[1,1,1]
    v_pk_fma_f32 v[198:199], v[198:199], v[102:103], v[118:119] op_sel:[0,0,0] op_sel_hi:[1,1,1]
    v_pk_fma_f32 v[200:201], v[200:201], v[104:105], v[120:121] op_sel:[0,0,0] op_sel_hi:[1,1,1]
    v_cvt_pk_bf16_f32 v138, v194, v195
    v_cvt_pk_bf16_f32 v139, v196, v197
    v_cvt_pk_bf16_f32 v140, v198, v199
    v_cvt_pk_bf16_f32 v141, v200, v201
    v_or_b32 v141, 1, v141
    s_cmp_eq_u32 s3, 3
    s_cbranch_scc1 Lzs_0
    global_store_dwordx4 v28, v[138:141], s[38:39] offset:1024 sc1
Lzs_0:
    v_pk_fma_f32 v[202:203], v[202:203], v[106:107], v[122:123] op_sel:[0,0,0] op_sel_hi:[1,1,1]
    v_pk_fma_f32 v[204:205], v[204:205], v[108:109], v[124:125] op_sel:[0,0,0] op_sel_hi:[1,1,1]
    v_pk_fma_f32 v[206:207], v[206:207], v[110:111], v[126:127] op_sel:[0,0,0] op_sel_hi:[1,1,1]
    v_pk_fma_f32 v[208:209], v[208:209], v[112:113], v[128:129] op_sel:[0,0,0] op_sel_hi:[1,1,1]
    v_cvt_pk_bf16_f32 v142, v202, v203
    v_cvt_pk_bf16_f32 v143, v204, v205
    v_cvt_pk_bf16_f32 v144, v206, v207
    v_cvt_pk_bf16_f32 v145, v208, v209
    v_or_b32 v145, 1, v145
    s_cmp_eq_u32 s3, 3
    s_cbranch_scc1 Lzs_1
    global_store_dwordx4 v29, v[142:145], s[38:39] offset:1024 sc1
Lzs_1:
    v_mfma_f32_16x16x32_bf16 v[210:213], a[120:123], v[48:51], v[210:213]
    ds_read_b128 v[68:71], v173 offset:26000
    global_load_lds_dwordx4 v77, s[82:83] offset:3072
    v_mfma_f32_16x16x32_bf16 v[226:229], a[124:127], v[48:51], v[226:229]
    s_mul_i32 s91, s41, 458752
    v_mfma_f32_16x16x32_bf16 v[214:217], a[120:123], v[52:55], v[214:217]
    ds_read_b128 v[48:51], v173 offset:27040
    s_add_u32 m0, s89, 12288
    s_add_u32 s91, s91, 12582912
    v_mfma_f32_16x16x32_bf16 v[230:233], a[124:127], v[52:55], v[230:233]
    global_load_lds_dwordx4 v78, s[82:83] offset:0
    s_mul_i32 s6, s44, 14336
    v_mfma_f32_16x16x32_bf16 v[218:221], a[120:123], v[56:59], v[218:221]
    ds_read_b128 v[52:55], v173 offset:28080
    v_mfma_f32_16x16x32_bf16 v[234:237], a[124:127], v[56:59], v[234:237]
    global_load_lds_dwordx4 v79, s[82:83] offset:1024
    s_add_u32 s6, s6, s91
    v_mfma_f32_16x16x32_bf16 v[222:225], a[120:123], v[60:63], v[222:225]
    ds_read_b128 v[56:59], v173 offset:29120
    global_load_lds_dwordx4 v80, s[82:83] offset:2048
    v_mfma_f32_16x16x32_bf16 v[238:241], a[124:127], v[60:63], v[238:241]
    s_add_u32 s52, s38, s6
    s_addc_u32 s53, s39, 0
    s_waitcnt lgkmcnt(3)
    v_mfma_f32_16x16x32_bf16 v[210:213], a[128:131], v[64:67], v[210:213]
    ds_read_b128 v[60:63], v173 offset:30160
    global_load_lds_dwordx4 v81, s[82:83] offset:3072
    v_mfma_f32_16x16x32_bf16 v[226:229], a[132:135], v[64:67], v[226:229]
    s_add_u32 s54, s52, 14336
    s_addc_u32 s55, s53, 0
    v_mfma_f32_16x16x32_bf16 v[214:217], a[128:131], v[68:71], v[214:217]
    ds_read_b128 v[64:67], v173 offset:31200
    ds_read_b128 a[96:99], v82 offset:0
    v_mfma_f32_16x16x32_bf16 v[230:233], a[132:135], v[68:71], v[230:233]
    s_waitcnt lgkmcnt(4)
    v_mfma_f32_16x16x32_bf16 v[218:221], a[128:131], v[48:51], v[218:221]
    ds_read_b128 v[68:71], v173 offset:32240
    s_mul_i32 s6, s46, 14336
    v_mfma_f32_16x16x32_bf16 v[234:237], a[132:135], v[48:51], v[234:237]
    v_mfma_f32_16x16x32_bf16 v[222:225], a[128:131], v[52:55], v[222:225]
    ds_read_b128 v[48:51], v173 offset:33280
    s_add_u32 s6, s6, s91
    ds_read_b128 a[100:103], v84 offset:0
    v_mfma_f32_16x16x32_bf16 v[238:241], a[132:135], v[52:55], v[238:241]
    s_add_u32 s56, s38, s6
    s_addc_u32 s57, s39, 0
    s_waitcnt lgkmcnt(5)
    v_mfma_f32_16x16x32_bf16 v[210:213], a[136:139], v[56:59], v[210:213]
    ds_read_b128 v[52:55], v173 offset:34320
    v_mfma_f32_16x16x32_bf16 v[226:229], a[140:143], v[56:59], v[226:229]
    ds_read_b128 a[104:107], v86 offset:0
    v_mfma_f32_16x16x32_bf16 v[214:217], a[136:139], v[60:63], v[214:217]
    ds_read_b128 v[56:59], v173 offset:35360
    s_add_u32 s58, s56, 14336
    s_addc_u32 s59, s57, 0
    v_mfma_f32_16x16x32_bf16 v[230:233], a[140:143], v[60:63], v[230:233]
    ds_read_b128 a[108:111], v88 offset:0
    s_waitcnt lgkmcnt(6)
    v_mfma_f32_16x16x32_bf16 v[218:221], a[136:139], v[64:67], v[218:221]
    ds_read_b128 v[60:63], v173 offset:36400
    v_mfma_f32_16x16x32_bf16 v[234:237], a[140:143], v[64:67], v[234:237]
    ds_read_b128 a[112:115], v83 offset:0
    s_mul_i32 s6, s48, 14336
    v_mfma_f32_16x16x32_bf16 v[222:225], a[136:139], v[68:71], v[222:225]
    ds_read_b128 v[64:67], v173 offset:37440
    s_add_u32 s6, s6, s91
    v_mfma_f32_16x16x32_bf16 v[238:241], a[140:143], v[68:71], v[238:241]
    s_waitcnt lgkmcnt(6)
    v_mfma_f32_16x16x32_bf16 v[210:213], a[144:147], v[48:51], v[210:213]
    ds_read_b128 v[68:71], v173 offset:38480
    ds_read_b128 a[116:119], v85 offset:0
    v_mfma_f32_16x16x32_bf16 v[226:229], a[148:151], v[48:51], v[226:229]
    s_add_u32 s60, s38, s6
    s_addc_u32 s61, s39, 0
    v_mfma_f32_16x16x32_bf16 v[214:217], a[144:147], v[52:55], v[214:217]
    ds_read_b128 v[48:51], v173 offset:39520
    ds_read_b128 a[120:123], v87 offset:0
    v_mfma_f32_16x16x32_bf16 v[230:233], a[148:151], v[52:55], v[230:233]
    s_add_u32 s62, s60, 14336
    s_addc_u32 s63, s61, 0
    s_waitcnt lgkmcnt(6)
    v_mfma_f32_16x16x32_bf16 v[218:221], a[144:147], v[56:59], v[218:221]
    ds_read_b128 v[52:55], v173 offset:40560
    ds_read_b128 a[124:127], v89 offset:0
    v_mfma_f32_16x16x32_bf16 v[234:237], a[148:151], v[56:59], v[234:237]
    v_mfma_f32_16x16x32_bf16 v[222:225], a[144:147], v[60:63], v[222:225]
    s_mul_i32 s6, s50, 14336
    v_mfma_f32_16x16x32_bf16 v[238:241], a[148:151], v[60:63], v[238:241]
    s_add_u32 s6, s6, s91
    s_waitcnt lgkmcnt(5)
    v_mfma_f32_16x16x32_bf16 v[210:213], a[152:155], v[64:67], v[210:213]
    v_mfma_f32_16x16x32_bf16 v[226:229], a[156:159], v[64:67], v[226:229]
    s_add_u32 s64, s38, s6
    s_addc_u32 s65, s39, 0
    v_mfma_f32_16x16x32_bf16 v[214:217], a[152:155], v[68:71], v[214:217]
    v_mfma_f32_16x16x32_bf16 v[230:233], a[156:159], v[68:71], v[230:233]
    s_waitcnt lgkmcnt(1)
    v_mfma_f32_16x16x32_bf16 v[218:221], a[152:155], v[48:51], v[218:221]
    s_add_u32 s66, s64, 14336
    s_addc_u32 s67, s65, 0
    v_mfma_f32_16x16x32_bf16 v[234:237], a[156:159], v[48:51], v[234:237]
    v_mfma_f32_16x16x32_bf16 v[222:225], a[152:155], v[52:55], v[222:225]
    v_mfma_f32_16x16x32_bf16 v[238:241], a[156:159], v[52:55], v[238:241]
    s_waitcnt vmcnt(0)
    ds_read_b128 a[128:131], v82 offset:8192
    ds_read_b128 a[132:135], v84 offset:8192
    ds_read_b128 a[136:139], v86 offset:8192
    ds_read_b128 a[140:143], v88 offset:8192
    ds_read_b128 a[144:147], v83 offset:8192
    ds_read_b128 a[148:151], v85 offset:8192
    ds_read_b128 a[152:155], v87 offset:8192
    ds_read_b128 a[156:159], v89 offset:8192
    s_waitcnt lgkmcnt(0)
    s_barrier
    s_mul_i32 s5, s41, 138240
    s_add_u32 s5, s5, 10485760
    s_add_u32 s92, s38, s5
    s_addc_u32 s93, s39, 0
    s_mul_i32 s95, s3, 34816
    s_min_u32 s95, s95, 103424
    s_add_u32 s92, s92, s95
    s_addc_u32 s93, s93, 0
    s_add_u32 m0, s95, 0
    s_nop 0
    global_load_lds_dwordx4 v4, s[92:93] offset:0 sc1
    s_lshl_b32 s4, s3, 10
    s_add_u32 s4, s4, 138240
    v_add_u32 v170, s4, v30
    s_lshl_b32 s4, s3, 12
    s_add_u32 s4, s4, 138240
    v_add_u32 v171, s4, v30
    v_add_u32 v30, 3072, v4
    v_add_u32 v31, 10240, v4
    v_min_u32 v29, 27, v1
    v_lshlrev_b32 v29, 10, v29
    v_pk_fma_f32 v[178:179], v[162:163], v[12:13], v[16:17] op_sel:[1,0,0] op_sel_hi:[1,1,1]
    global_load_lds_dwordx4 v4, s[92:93] offset:1024 sc1
    v_pk_fma_f32 v[180:181], v[162:163], v[14:15], v[18:19] op_sel:[1,0,0] op_sel_hi:[1,1,1]
    v_pk_fma_f32 v[182:183], v[164:165], v[12:13], v[16:17] op_sel:[1,0,0] op_sel_hi:[1,1,1]
    v_pk_fma_f32 v[184:185], v[164:165], v[14:15], v[18:19] op_sel:[1,0,0] op_sel_hi:[1,1,1]
    v_pk_fma_f32 v[186:187], v[166:167], v[12:13], v[16:17] op_sel:[1,0,0] op_sel_hi:[1,1,1]
    v_pk_fma_f32 v[188:189], v[166:167], v[14:15], v[18:19] op_sel:[1,0,0] op_sel_hi:[1,1,1]
    v_pk_fma_f32 v[190:191], v[168:169], v[12:13], v[16:17] op_sel:[1,0,0] op_sel_hi:[1,1,1]
    v_pk_fma_f32 v[192:193], v[168:169], v[14:15], v[18:19] op_sel:[1,0,0] op_sel_hi:[1,1,1]
    v_pk_fma_f32 v[210:211], v[162:163], v[210:211], v[178:179] op_sel:[0,0,0] op_sel_hi:[0,1,1]
    v_pk_fma_f32 v[212:213], v[162:163], v[212:213], v[180:181] op_sel:[0,0,0] op_sel_hi:[0,1,1]
    v_pk_fma_f32 v[214:215], v[164:165], v[214:215], v[182:183] op_sel:[0,0,0] op_sel_hi:[0,1,1]
    v_pk_fma_f32 v[216:217], v[164:165], v[216:217], v[184:185] op_sel:[0,0,0] op_sel_hi:[0,1,1]
    v_pk_fma_f32 v[218:219], v[166:167], v[218:219], v[186:187] op_sel:[0,0,0] op_sel_hi:[0,1,1]
    global_load_lds_dwordx4 v4, s[92:93] offset:2048 sc1
    v_pk_fma_f32 v[220:221], v[166:167], v[220:221], v[188:189] op_sel:[0,0,0] op_sel_hi:[0,1,1]
    v_pk_fma_f32 v[222:223], v[168:169], v[222:223], v[190:191] op_sel:[0,0,0] op_sel_hi:[0,1,1]
    v_pk_fma_f32 v[224:225], v[168:169], v[224:225], v[192:193] op_sel:[0,0,0] op_sel_hi:[0,1,1]
    v_pk_fma_f32 v[178:179], v[162:163], v[20:21], v[24:25] op_sel:[1,0,0] op_sel_hi:[1,1,1]
    v_pk_fma_f32 v[180:181], v[162:163], v[22:23], v[26:27] op_sel:[1,0,0] op_sel_hi:[1,1,1]
    v_pk_fma_f32 v[182:183], v[164:165], v[20:21], v[24:25] op_sel:[1,0,0] op_sel_hi:[1,1,1]
    v_pk_fma_f32 v[184:185], v[164:165], v[22:23], v[26:27] op_sel:[1,0,0] op_sel_hi:[1,1,1]
    v_pk_fma_f32 v[186:187], v[166:167], v[20:21], v[24:25] op_sel:[1,0,0] op_sel_hi:[1,1,1]
    v_pk_fma_f32 v[188:189], v[166:167], v[22:23], v[26:27] op_sel:[1,0,0] op_sel_hi:[1,1,1]
    v_pk_fma_f32 v[190:191], v[168:169], v[20:21], v[24:25] op_sel:[1,0,0] op_sel_hi:[1,1,1]
    v_pk_fma_f32 v[192:193], v[168:169], v[22:23], v[26:27] op_sel:[1,0,0] op_sel_hi:[1,1,1]
    global_load_lds_dwordx4 v4, s[92:93] offset:3072 sc1
    v_pk_fma_f32 v[226:227], v[162:163], v[226:227], v[178:179] op_sel:[0,0,0] op_sel_hi:[0,1,1]
    v_pk_fma_f32 v[228:229], v[162:163], v[228:229], v[180:181] op_sel:[0,0,0] op_sel_hi:[0,1,1]
    v_pk_fma_f32 v[230:231], v[164:165], v[230:231], v[182:183] op_sel:[0,0,0] op_sel_hi:[0,1,1]
    v_pk_fma_f32 v[232:233], v[164:165], v[232:233], v[184:185] op_sel:[0,0,0] op_sel_hi:[0,1,1]
    v_pk_fma_f32 v[234:235], v[166:167], v[234:235], v[186:187] op_sel:[0,0,0] op_sel_hi:[0,1,1]
    v_pk_fma_f32 v[236:237], v[166:167], v[236:237], v[188:189] op_sel:[0,0,0] op_sel_hi:[0,1,1]
    v_pk_fma_f32 v[238:239], v[168:169], v[238:239], v[190:191] op_sel:[0,0,0] op_sel_hi:[0,1,1]
    v_pk_fma_f32 v[240:241], v[168:169], v[240:241], v[192:193] op_sel:[0,0,0] op_sel_hi:[0,1,1]
    v_pk_mul_f32 v[178:179], v[210:211], v[210:211] op_sel:[0,0] op_sel_hi:[1,1]
    v_pk_mul_f32 v[180:181], v[212:213], v[212:213] op_sel:[0,0] op_sel_hi:[1,1]
    v_pk_mul_f32 v[182:183], v[214:215], v[214:215] op_sel:[0,0] op_sel_hi:[1,1]
    v_pk_mul_f32 v[184:185], v[216:217], v[216:217] op_sel:[0,0] op_sel_hi:[1,1]
    s_add_u32 m0, s95, 4096
    s_add_u32 s92, s92, 4096
    s_addc_u32 s93, s93, 0
    global_load_lds_dwordx4 v4, s[92:93] offset:0 sc1
    v_pk_mul_f32 v[186:187], v[218:219], v[218:219] op_sel:[0,0] op_sel_hi:[1,1]
    v_pk_mul_f32 v[188:189], v[220:221], v[220:221] op_sel:[0,0] op_sel_hi:[1,1]
    v_pk_mul_f32 v[190:191], v[222:223], v[222:223] op_sel:[0,0] op_sel_hi:[1,1]
    v_pk_mul_f32 v[192:193], v[224:225], v[224:225] op_sel:[0,0] op_sel_hi:[1,1]
    v_pk_mul_f32 v[194:195], v[226:227], v[226:227] op_sel:[0,0] op_sel_hi:[1,1]
    v_pk_mul_f32 v[196:197], v[228:229], v[228:229] op_sel:[0,0] op_sel_hi:[1,1]
    v_pk_mul_f32 v[198:199], v[230:231], v[230:231] op_sel:[0,0] op_sel_hi:[1,1]
    v_pk_mul_f32 v[200:201], v[232:233], v[232:233] op_sel:[0,0] op_sel_hi:[1,1]
    v_pk_mul_f32 v[202:203], v[234:235], v[234:235] op_sel:[0,0] op_sel_hi:[1,1]
    v_pk_mul_f32 v[204:205], v[236:237], v[236:237] op_sel:[0,0] op_sel_hi:[1,1]
    v_pk_mul_f32 v[206:207], v[238:239], v[238:239] op_sel:[0,0] op_sel_hi:[1,1]
    global_load_lds_dwordx4 v4, s[92:93] offset:1024 sc1
    v_pk_mul_f32 v[208:209], v[240:241], v[240:241] op_sel:[0,0] op_sel_hi:[1,1]
    v_pk_fma_f32 v[178:179], v[178:179], s[84:85], s[84:85] op_sel:[0,1,0] op_sel_hi:[1,1,0]
    v_pk_fma_f32 v[180:181], v[180:181], s[84:85], s[84:85] op_sel:[0,1,0] op_sel_hi:[1,1,0]
    v_pk_fma_f32 v[182:183], v[182:183], s[84:85], s[84:85] op_sel:[0,1,0] op_sel_hi:[1,1,0]
    v_pk_fma_f32 v[184:185], v[184:185], s[84:85], s[84:85] op_sel:[0,1,0] op_sel_hi:[1,1,0]
    v_pk_fma_f32 v[186:187], v[186:187], s[84:85], s[84:85] op_sel:[0,1,0] op_sel_hi:[1,1,0]
    v_pk_fma_f32 v[188:189], v[188:189], s[84:85], s[84:85] op_sel:[0,1,0] op_sel_hi:[1,1,0]
    v_pk_fma_f32 v[190:191], v[190:191], s[84:85], s[84:85] op_sel:[0,1,0] op_sel_hi:[1,1,0]
    v_pk_fma_f32 v[192:193], v[192:193], s[84:85], s[84:85] op_sel:[0,1,0] op_sel_hi:[1,1,0]
    v_pk_fma_f32 v[194:195], v[194:195], s[84:85], s[84:85] op_sel:[0,1,0] op_sel_hi:[1,1,0]
    v_pk_fma_f32 v[196:197], v[196:197], s[84:85], s[84:85] op_sel:[0,1,0] op_sel_hi:[1,1,0]
    v_pk_fma_f32 v[198:199], v[198:199], s[84:85], s[84:85] op_sel:[0,1,0] op_sel_hi:[1,1,0]
    global_load_lds_dwordx4 v4, s[92:93] offset:2048 sc1
    v_pk_fma_f32 v[200:201], v[200:201], s[84:85], s[84:85] op_sel:[0,1,0] op_sel_hi:[1,1,0]
    v_pk_fma_f32 v[202:203], v[202:203], s[84:85], s[84:85] op_sel:[0,1,0] op_sel_hi:[1,1,0]
    v_pk_fma_f32 v[204:205], v[204:205], s[84:85], s[84:85] op_sel:[0,1,0] op_sel_hi:[1,1,0]
    v_pk_fma_f32 v[206:207], v[206:207], s[84:85], s[84:85] op_sel:[0,1,0] op_sel_hi:[1,1,0]
    v_pk_fma_f32 v[208:209], v[208:209], s[84:85], s[84:85] op_sel:[0,1,0] op_sel_hi:[1,1,0]
    v_pk_mul_f32 v[178:179], v[178:179], v[210:211] op_sel:[0,0] op_sel_hi:[1,1]
    v_pk_mul_f32 v[180:181], v[180:181], v[212:213] op_sel:[0,0] op_sel_hi:[1,1]
    v_pk_mul_f32 v[182:183], v[182:183], v[214:215] op_sel:[0,0] op_sel_hi:[1,1]
    v_pk_mul_f32 v[184:185], v[184:185], v[216:217] op_sel:[0,0] op_sel_hi:[1,1]
    v_pk_mul_f32 v[186:187], v[186:187], v[218:219] op_sel:[0,0] op_sel_hi:[1,1]
    v_pk_mul_f32 v[188:189], v[188:189], v[220:221] op_sel:[0,0] op_sel_hi:[1,1]
    global_load_lds_dwordx4 v4, s[92:93] offset:3072 sc1
    v_pk_mul_f32 v[190:191], v[190:191], v[222:223] op_sel:[0,0] op_sel_hi:[1,1]
    v_pk_mul_f32 v[192:193], v[192:193], v[224:225] op_sel:[0,0] op_sel_hi:[1,1]
    v_pk_mul_f32 v[194:195], v[194:195], v[226:227] op_sel:[0,0] op_sel_hi:[1,1]
    v_pk_mul_f32 v[196:197], v[196:197], v[228:229] op_sel:[0,0] op_sel_hi:[1,1]
    v_pk_mul_f32 v[198:199], v[198:199], v[230:231] op_sel:[0,0] op_sel_hi:[1,1]
    v_pk_mul_f32 v[200:201], v[200:201], v[232:233] op_sel:[0,0] op_sel_hi:[1,1]
    v_pk_mul_f32 v[202:203], v[202:203], v[234:235] op_sel:[0,0] op_sel_hi:[1,1]
    v_pk_mul_f32 v[204:205], v[204:205], v[236:237] op_sel:[0,0] op_sel_hi:[1,1]
    v_pk_mul_f32 v[206:207], v[206:207], v[238:239] op_sel:[0,0] op_sel_hi:[1,1]
    v_pk_mul_f32 v[208:209], v[208:209], v[240:241] op_sel:[0,0] op_sel_hi:[1,1]
    v_exp_f32 v178, v178
    v_exp_f32 v179, v179
    s_add_u32 m0, s95, 8192
    s_add_u32 s92, s92, 4096
    s_addc_u32 s93, s93, 0
    global_load_lds_dwordx4 v4, s[92:93] offset:0 sc1
    v_exp_f32 v180, v180
    v_exp_f32 v181, v181
    v_exp_f32 v182, v182
    v_exp_f32 v183, v183
    v_exp_f32 v184, v184
    v_exp_f32 v185, v185
    v_exp_f32 v186, v186
    v_exp_f32 v187, v187
    v_exp_f32 v188, v188
    v_exp_f32 v189, v189
    v_exp_f32 v190, v190
    global_load_lds_dwordx4 v4, s[92:93] offset:1024 sc1
    v_exp_f32 v191, v191
    global_load_dword v46, v29, s[56:57] offset:1020 sc1
    v_exp_f32 v192, v192
    v_exp_f32 v193, v193
    v_exp_f32 v194, v194
    v_exp_f32 v195, v195
    v_exp_f32 v196, v196
    v_exp_f32 v197, v197
    global_load_dwordx4 v[62:65], v30, s[56:57] offset:-3072 sc1
    v_exp_f32 v198, v198
    v_exp_f32 v199, v199
    v_exp_f32 v200, v200
    v_exp_f32 v201, v201
    v_exp_f32 v202, v202
    v_exp_f32 v203, v203
    global_load_dwordx4 v[66:69], v30, s[56:57] offset:-2048 sc1
    v_exp_f32 v204, v204
    v_exp_f32 v205, v205
    v_exp_f32 v206, v206
    v_exp_f32 v207, v207
    v_exp_f32 v208, v208
    v_exp_f32 v209, v209
    global_load_dwordx4 v[70:73], v30, s[56:57] offset:-1024 sc1
    v_pk_add_f32 v[178:179], v[178:179], 1.0 op_sel:[0,0] op_sel_hi:[1,0]
    v_pk_add_f32 v[180:181], v[180:181], 1.0 op_sel:[0,0] op_sel_hi:[1,0]
    v_pk_add_f32 v[182:183], v[182:183], 1.0 op_sel:[0,0] op_sel_hi:[1,0]
    v_pk_add_f32 v[184:185], v[184:185], 1.0 op_sel:[0,0] op_sel_hi:[1,0]
    v_pk_add_f32 v[186:187], v[186:187], 1.0 op_sel:[0,0] op_sel_hi:[1,0]
    v_pk_add_f32 v[188:189], v[188:189], 1.0 op_sel:[0,0] op_sel_hi:[1,0]
    global_load_dwordx4 v[74:77], v30, s[56:57] offset:0 sc1
    v_pk_add_f32 v[190:191], v[190:191], 1.0 op_sel:[0,0] op_sel_hi:[1,0]
    v_pk_add_f32 v[192:193], v[192:193], 1.0 op_sel:[0,0] op_sel_hi:[1,0]
    v_pk_add_f32 v[194:195], v[194:195], 1.0 op_sel:[0,0] op_sel_hi:[1,0]
    v_pk_add_f32 v[196:197], v[196:197], 1.0 op_sel:[0,0] op_sel_hi:[1,0]
    v_pk_add_f32 v[198:199], v[198:199], 1.0 op_sel:[0,0] op_sel_hi:[1,0]
    v_pk_add_f32 v[200:201], v[200:201], 1.0 op_sel:[0,0] op_sel_hi:[1,0]
    v_pk_add_f32 v[202:203], v[202:203], 1.0 op_sel:[0,0] op_sel_hi:[1,0]
    global_load_dwordx4 v[78:81], v30, s[56:57] offset:1024 sc1
    v_pk_add_f32 v[204:205], v[204:205], 1.0 op_sel:[0,0] op_sel_hi:[1,0]
    v_pk_add_f32 v[206:207], v[206:207], 1.0 op_sel:[0,0] op_sel_hi:[1,0]
    v_pk_add_f32 v[208:209], v[208:209], 1.0 op_sel:[0,0] op_sel_hi:[1,0]
    v_rcp_f32 v178, v178
    v_rcp_f32 v179, v179
    v_rcp_f32 v180, v180
    global_load_dwordx4 v[82:85], v30, s[56:57] offset:2048 sc1
    v_rcp_f32 v181, v181
    v_rcp_f32 v182, v182
    v_rcp_f32 v183, v183
    v_rcp_f32 v184, v184
    v_rcp_f32 v185, v185
    v_rcp_f32 v186, v186
    global_load_dwordx4 v[86:89], v30, s[56:57] offset:3072 sc1
    v_rcp_f32 v187, v187
    v_rcp_f32 v188, v188
    v_rcp_f32 v189, v189
    v_rcp_f32 v190, v190
    v_rcp_f32 v191, v191
    v_rcp_f32 v192, v192
    global_load_dwordx4 v[90:93], v31, s[56:57] offset:-3072 sc1
    v_rcp_f32 v193, v193
    v_rcp_f32 v194, v194
    v_rcp_f32 v195, v195
    v_rcp_f32 v196, v196
    v_rcp_f32 v197, v197
    v_rcp_f32 v198, v198
    v_rcp_f32 v199, v199
    global_load_dwordx4 v[94:97], v31, s[56:57] offset:-2048 sc1
    v_rcp_f32 v200, v200
    v_rcp_f32 v201, v201
    v_rcp_f32 v202, v202
    v_rcp_f32 v203, v203
    v_rcp_f32 v204, v204
    v_rcp_f32 v205, v205
    global_load_dwordx4 v[98:101], v31, s[56:57] offset:-1024 sc1
    v_rcp_f32 v206, v206
    v_rcp_f32 v207, v207
    v_rcp_f32 v208, v208
    v_rcp_f32 v209, v209
    v_pk_mul_f32 v[210:211], v[210:211], v[178:179] op_sel:[0,0] op_sel_hi:[1,1]
    v_pk_mul_f32 v[212:213], v[212:213], v[180:181] op_sel:[0,0] op_sel_hi:[1,1]
    global_load_dwordx4 v[102:105], v31, s[56:57] offset:0 sc1
    v_pk_mul_f32 v[214:215], v[214:215], v[182:183] op_sel:[0,0] op_sel_hi:[1,1]
    v_pk_mul_f32 v[216:217], v[216:217], v[184:185] op_sel:[0,0] op_sel_hi:[1,1]
    v_pk_mul_f32 v[218:219], v[218:219], v[186:187] op_sel:[0,0] op_sel_hi:[1,1]
    v_pk_mul_f32 v[220:221], v[220:221], v[188:189] op_sel:[0,0] op_sel_hi:[1,1]
    v_pk_mul_f32 v[222:223], v[222:223], v[190:191] op_sel:[0,0] op_sel_hi:[1,1]
    v_pk_mul_f32 v[224:225], v[224:225], v[192:193] op_sel:[0,0] op_sel_hi:[1,1]
    global_load_dwordx4 v[106:109], v31, s[56:57] offset:1024 sc1
    v_pk_mul_f32 v[226:227], v[226:227], v[194:195] op_sel:[0,0] op_sel_hi:[1,1]
    v_pk_mul_f32 v[228:229], v[228:229], v[196:197] op_sel:[0,0] op_sel_hi:[1,1]
    v_pk_mul_f32 v[230:231], v[230:231], v[198:199] op_sel:[0,0] op_sel_hi:[1,1]
    v_pk_mul_f32 v[232:233], v[232:233], v[200:201] op_sel:[0,0] op_sel_hi:[1,1]
    v_pk_mul_f32 v[234:235], v[234:235], v[202:203] op_sel:[0,0] op_sel_hi:[1,1]
    v_pk_mul_f32 v[236:237], v[236:237], v[204:205] op_sel:[0,0] op_sel_hi:[1,1]
    v_pk_mul_f32 v[238:239], v[238:239], v[206:207] op_sel:[0,0] op_sel_hi:[1,1]
    global_load_dwordx4 v[110:113], v31, s[56:57] offset:2048 sc1
    v_pk_mul_f32 v[240:241], v[240:241], v[208:209] op_sel:[0,0] op_sel_hi:[1,1]
    v_cvt_pk_bf16_f32 v178, v210, v211
    v_cvt_pk_bf16_f32 v179, v212, v213
    v_cvt_pk_bf16_f32 v180, v214, v215
    v_cvt_pk_bf16_f32 v181, v216, v217
    v_cvt_pk_bf16_f32 v182, v218, v219
    global_load_dwordx4 v[114:117], v31, s[56:57] offset:3072 sc1
    v_cvt_pk_bf16_f32 v183, v220, v221
    v_cvt_pk_bf16_f32 v184, v222, v223
    v_cvt_pk_bf16_f32 v185, v224, v225
    v_cvt_pk_bf16_f32 v186, v226, v227
    v_cvt_pk_bf16_f32 v187, v228, v229
    v_cvt_pk_bf16_f32 v188, v230, v231
    global_load_dwordx4 v[118:121], v30, s[58:59] offset:-3072 sc1
    v_cvt_pk_bf16_f32 v189, v232, v233
    v_cvt_pk_bf16_f32 v190, v234, v235
    v_cvt_pk_bf16_f32 v191, v236, v237
    v_cvt_pk_bf16_f32 v192, v238, v239
    v_cvt_pk_bf16_f32 v193, v240, v241
    ds_write_b64 v170, v[178:179] offset:0
    global_load_dwordx4 v[122:125], v30, s[58:59] offset:-2048 sc1
    ds_write_b64 v170, v[180:181] offset:4096
    ds_write_b64 v170, v[182:183] offset:8192
    ds_write_b64 v170, v[184:185] offset:12288
    ds_write_b64 v170, v[186:187] offset:512
    ds_write_b64 v170, v[188:189] offset:4608
    ds_write_b64 v170, v[190:191] offset:8704
    ds_write_b64 v170, v[192:193] offset:12800
    s_waitcnt lgkmcnt(0)
    s_barrier
    ds_read_b64 v[48:49], v171 offset:0
    ds_read_b64 v[50:51], v171 offset:512
    ds_read_b64 v[52:53], v171 offset:1024
    ds_read_b64 v[54:55], v171 offset:1536
    ds_read_b64 v[56:57], v171 offset:2048
    ds_read_b64 v[58:59], v171 offset:2560
    ds_read_b64 v[60:61], v171 offset:3072
    s_waitcnt vmcnt(14)
    v_bitop3_b32 v28, v46, v65, v69 bitop3:0x80
    s_waitcnt vmcnt(12)
    v_bitop3_b32 v28, v73, v77, v28 bitop3:0x80
    v_and_b32 v28, 1, v28
    v_cmp_ne_u32 vcc, 1, v28
    s_nop 0
    s_cbranch_vccnz Lz0_r
Lz0_ok:
    v_mfma_f32_16x16x32_bf16 v[142:145], v[62:65], a[160:163], v[32:35]
    v_min_u32 v47, 27, v1
    global_load_dwordx4 v[126:129], v30, s[58:59] offset:-1024 sc1
    v_mfma_f32_16x16x32_bf16 v[146:149], v[62:65], a[164:167], 0
    s_mul_i32 s6, s43, 28
    v_mfma_f32_16x16x32_bf16 v[150:153], v[62:65], a[168:171], 0
    v_add_lshl_u32 v47, v47, s6, 7
    v_mfma_f32_16x16x32_bf16 v[154:157], v[62:65], a[172:175], 0
    global_load_dword v8, v47, s[52:53] sc1
    v_mfma_f32_16x16x32_bf16 v[158:161], v[66:69], a[160:163], v[32:35]
    global_load_dwordx4 v[130:133], v30, s[58:59] offset:0 sc1
    v_mfma_f32_16x16x32_bf16 v[162:165], v[66:69], a[164:167], 0
    v_mfma_f32_16x16x32_bf16 v[166:169], v[66:69], a[168:171], 0
    v_mfma_f32_16x16x32_bf16 v[170:173], v[66:69], a[172:175], 0
    v_mfma_f32_16x16x32_bf16 v[174:177], v[70:73], a[160:163], v[32:35]
    global_load_dwordx4 v[134:137], v30, s[58:59] offset:1024 sc1
    v_mfma_f32_16x16x32_bf16 v[178:181], v[70:73], a[164:167], 0
    v_mfma_f32_16x16x32_bf16 v[182:185], v[70:73], a[168:171], 0
    s_waitcnt vmcnt(14)
    v_and_b32 v28, v81, v85
    v_mfma_f32_16x16x32_bf16 v[186:189], v[70:73], a[172:175], 0
    s_waitcnt vmcnt(12)
    v_bitop3_b32 v28, v89, v93, v28 bitop3:0x80
    v_mfma_f32_16x16x32_bf16 v[190:193], v[74:77], a[160:163], v[32:35]
    v_and_b32 v28, 1, v28
    global_load_dwordx4 v[138:141], v30, s[58:59] offset:2048 sc1
    v_mfma_f32_16x16x32_bf16 v[194:197], v[74:77], a[164:167], 0
    v_cmp_ne_u32 vcc, 1, v28
    v_mfma_f32_16x16x32_bf16 v[198:201], v[74:77], a[168:171], 0
    v_mfma_f32_16x16x32_bf16 v[202:205], v[74:77], a[172:175], 0
    s_cbranch_vccnz Lz1_r
Lz1_ok:
    v_mfma_f32_16x16x32_bf16 v[206:209], v[78:81], a[160:163], v[32:35]
    global_load_dwordx4 v[62:65], v30, s[58:59] offset:3072 sc1
    s_xor_b32 s4, s3, 1
    s_mul_i32 s4, s4, 3072
    v_mfma_f32_16x16x32_bf16 v[210:213], v[78:81], a[164:167], 0
    s_add_u32 s4, s4, 138240
    v_add_u32 v20, s4, v4
    s_xor_b32 s4, s3, 2
    v_mfma_f32_16x16x32_bf16 v[214:217], v[78:81], a[168:171], 0
    s_mul_i32 s4, s4, 3072
    s_add_u32 s4, s4, 139264
    v_add_u32 v21, s4, v4
    v_mfma_f32_16x16x32_bf16 v[218:221], v[78:81], a[172:175], 0
    s_xor_b32 s4, s3, 3
    s_mul_i32 s4, s4, 3072
    v_mfma_f32_16x16x32_bf16 v[222:225], v[82:85], a[160:163], v[32:35]
    global_load_dwordx4 v[66:69], v31, s[58:59] offset:-3072 sc1
    s_add_u32 s4, s4, 140288
    v_add_u32 v22, s4, v4
    v_mfma_f32_16x16x32_bf16 v[226:229], v[82:85], a[164:167], 0
    s_mul_i32 s4, s3, 3072
    s_add_u32 s4, s4, 138240
    v_add_u32 v23, s4, v4
    v_mfma_f32_16x16x32_bf16 v[230:233], v[82:85], a[168:171], 0
    s_mul_i32 s4, s40, 114688
    s_add_u32 s4, s4, 1052672
    v_mfma_f32_16x16x32_bf16 v[234:237], v[82:85], a[172:175], 0
    s_lshl_b32 s5, s3, 13
    s_add_u32 s5, s5, s4
    v_mfma_f32_16x16x32_bf16 v[238:241], v[86:89], a[160:163], v[32:35]
    global_load_dwordx4 v[70:73], v31, s[58:59] offset:-2048 sc1
    v_add_u32 v6, s5, v4
    v_mfma_f32_16x16x32_bf16 v[242:245], v[86:89], a[164:167], 0
    v_add_u32 v7, 32768, v6
    v_add_u32 v26, 65536, v6
    s_lshl_b32 s5, s3, 12
    v_mfma_f32_16x16x32_bf16 v[246:249], v[86:89], a[168:171], 0
    s_waitcnt vmcnt(14)
    v_and_b32 v28, v97, v101
    s_add_u32 s5, s5, s4
    s_add_u32 s5, s5, 98304
    v_mfma_f32_16x16x32_bf16 v[250:253], v[86:89], a[172:175], 0
    s_waitcnt vmcnt(12)
    v_bitop3_b32 v28, v105, v109, v28 bitop3:0x80
    v_add_u32 v27, s5, v4
    s_lshl_b32 s4, s41, 10
    v_mfma_f32_16x16x32_bf16 v[142:145], v[90:93], a[176:179], v[142:145]
    s_add_u32 s8, s38, s4
    s_addc_u32 s9, s39, 0
    v_and_b32 v28, 1, v28
    v_mfma_f32_16x16x32_bf16 v[146:149], v[90:93], a[180:183], v[146:149]
    global_load_dwordx4 v[74:77], v31, s[58:59] offset:-1024 sc1
    s_lshr_b32 s4, s41, 1
    s_lshl_b32 s4, s4, 10
    s_and_b32 s5, s41, 1
    v_mfma_f32_16x16x32_bf16 v[150:153], v[90:93], a[184:187], v[150:153]
    v_cmp_ne_u32 vcc, 1, v28
    s_lshl_b32 s5, s5, 3
    s_add_u32 s4, s4, s5
    s_add_u32 s10, s38, s4
    s_addc_u32 s11, s39, 0
    v_mfma_f32_16x16x32_bf16 v[154:157], v[90:93], a[188:191], v[154:157]
    s_waitcnt lgkmcnt(0)
    s_barrier
    s_cbranch_vccnz Lz2_r
Lz2_ok:
    v_mfma_f32_16x16x32_bf16 v[158:161], v[94:97], a[176:179], v[158:161]
    global_load_dwordx4 v[78:81], v31, s[58:59] offset:0 sc1
    v_mfma_f32_16x16x32_bf16 v[162:165], v[94:97], a[180:183], v[162:165]
    v_mfma_f32_16x16x32_bf16 v[166:169], v[94:97], a[184:187], v[166:169]
    v_mfma_f32_16x16x32_bf16 v[170:173], v[94:97], a[188:191], v[170:173]
    v_mfma_f32_16x16x32_bf16 v[174:177], v[98:101], a[176:179], v[174:177]
    global_load_dwordx4 v[82:85], v31, s[58:59] offset:1024 sc1
    v_mfma_f32_16x16x32_bf16 v[178:181], v[98:101], a[180:183], v[178:181]
    v_mfma_f32_16x16x32_bf16 v[182:185], v[98:101], a[184:187], v[182:185]
    v_mfma_f32_16x16x32_bf16 v[186:189], v[98:101], a[188:191], v[186:189]
    v_mfma_f32_16x16x32_bf16 v[190:193], v[102:105], a[176:179], v[190:193]
    global_load_dwordx4 v[86:89], v31, s[58:59] offset:2048 sc1
    v_mfma_f32_16x16x32_bf16 v[194:197], v[102:105], a[180:183], v[194:197]
    v_mfma_f32_16x16x32_bf16 v[198:201], v[102:105], a[184:187], v[198:201]
    s_waitcnt vmcnt(14)
    v_and_b32 v28, v113, v117
    v_mfma_f32_16x16x32_bf16 v[202:205], v[102:105], a[188:191], v[202:205]
    s_waitcnt vmcnt(12)
    v_bitop3_b32 v28, v121, v125, v28 bitop3:0x80
    v_mfma_f32_16x16x32_bf16 v[206:209], v[106:109], a[176:179], v[206:209]
    v_and_b32 v28, 1, v28
    global_load_dwordx4 v[90:93], v31, s[58:59] offset:3072 sc1
    v_mfma_f32_16x16x32_bf16 v[210:213], v[106:109], a[180:183], v[210:213]
    v_cmp_ne_u32 vcc, 1, v28
    v_mfma_f32_16x16x32_bf16 v[214:217], v[106:109], a[184:187], v[214:217]
    v_mfma_f32_16x16x32_bf16 v[218:221], v[106:109], a[188:191], v[218:221]
    s_cbranch_vccnz Lz3_r
Lz3_ok:
    v_mfma_f32_16x16x32_bf16 v[222:225], v[110:113], a[176:179], v[222:225]
    v_min_u32 v47, 27, v1
    global_load_dwordx4 v[94:97], v30, s[60:61] offset:-3072 sc1
    v_mfma_f32_16x16x32_bf16 v[226:229], v[110:113], a[180:183], v[226:229]
    s_mul_i32 s6, s43, 28
    v_mfma_f32_16x16x32_bf16 v[230:233], v[110:113], a[184:187], v[230:233]
    v_add_lshl_u32 v47, v47, s6, 7
    v_mfma_f32_16x16x32_bf16 v[234:237], v[110:113], a[188:191], v[234:237]
    global_load_dword v9, v47, s[64:65] sc1
    v_mfma_f32_16x16x32_bf16 v[238:241], v[114:117], a[176:179], v[238:241]
    global_load_dwordx4 v[98:101], v31, s[60:61] offset:-3072 sc1
    v_mfma_f32_16x16x32_bf16 v[242:245], v[114:117], a[180:183], v[242:245]
    v_mfma_f32_16x16x32_bf16 v[246:249], v[114:117], a[184:187], v[246:249]
    v_mfma_f32_16x16x32_bf16 v[250:253], v[114:117], a[188:191], v[250:253]
    v_mfma_f32_16x16x32_bf16 v[142:145], v[118:121], a[0:3], v[142:145]
    global_load_dwordx4 v[102:105], v30, s[62:63] offset:-3072 sc1
    v_mfma_f32_16x16x32_bf16 v[146:149], v[118:121], a[4:7], v[146:149]
    v_mfma_f32_16x16x32_bf16 v[150:153], v[118:121], a[8:11], v[150:153]
    s_waitcnt vmcnt(14)
    v_and_b32 v28, v129, v133
    v_mfma_f32_16x16x32_bf16 v[154:157], v[118:121], a[12:15], v[154:157]
    s_waitcnt vmcnt(12)
    v_bitop3_b32 v28, v137, v141, v28 bitop3:0x80
    v_mfma_f32_16x16x32_bf16 v[158:161], v[122:125], a[0:3], v[158:161]
    v_and_b32 v28, 1, v28
    global_load_dwordx4 v[106:109], v31, s[62:63] offset:-3072 sc1
    v_mfma_f32_16x16x32_bf16 v[162:165], v[122:125], a[4:7], v[162:165]
    v_cmp_ne_u32 vcc, 1, v28
    v_mfma_f32_16x16x32_bf16 v[166:169], v[122:125], a[8:11], v[166:169]
    v_mfma_f32_16x16x32_bf16 v[170:173], v[122:125], a[12:15], v[170:173]
    s_cbranch_vccnz Lz4_r
Lz4_ok:
    v_mfma_f32_16x16x32_bf16 v[174:177], v[126:129], a[0:3], v[174:177]
    global_load_dwordx4 v[110:113], v30, s[52:53] offset:-3072 sc1
    v_mfma_f32_16x16x32_bf16 v[178:181], v[126:129], a[4:7], v[178:181]
    v_mfma_f32_16x16x32_bf16 v[182:185], v[126:129], a[8:11], v[182:185]
    v_mfma_f32_16x16x32_bf16 v[186:189], v[126:129], a[12:15], v[186:189]
    v_mfma_f32_16x16x32_bf16 v[190:193], v[130:133], a[0:3], v[190:193]
    global_load_dwordx4 v[114:117], v31, s[52:53] offset:-3072 sc1
    v_mfma_f32_16x16x32_bf16 v[194:197], v[130:133], a[4:7], v[194:197]
    v_mfma_f32_16x16x32_bf16 v[198:201], v[130:133], a[8:11], v[198:201]
    v_mfma_f32_16x16x32_bf16 v[202:205], v[130:133], a[12:15], v[202:205]
    v_mfma_f32_16x16x32_bf16 v[206:209], v[134:137], a[0:3], v[206:209]
    global_load_dwordx4 v[118:121], v30, s[54:55] offset:-3072 sc1
    v_mfma_f32_16x16x32_bf16 v[210:213], v[134:137], a[4:7], v[210:213]
    v_mfma_f32_16x16x32_bf16 v[214:217], v[134:137], a[8:11], v[214:217]
    s_waitcnt vmcnt(14)
    v_and_b32 v28, v65, v69
    v_mfma_f32_16x16x32_bf16 v[218:221], v[134:137], a[12:15], v[218:221]
    s_waitcnt vmcnt(12)
    v_bitop3_b32 v28, v73, v77, v28 bitop3:0x80
    v_mfma_f32_16x16x32_bf16 v[222:225], v[138:141], a[0:3], v[222:225]
    v_and_b32 v28, 1, v28
    global_load_dwordx4 v[122:125], v31, s[54:55] offset:-3072 sc1
    v_mfma_f32_16x16x32_bf16 v[226:229], v[138:141], a[4:7], v[226:229]
    v_cmp_ne_u32 vcc, 1, v28
    v_mfma_f32_16x16x32_bf16 v[230:233], v[138:141], a[8:11], v[230:233]
    v_mfma_f32_16x16x32_bf16 v[234:237], v[138:141], a[12:15], v[234:237]
    s_cbranch_vccnz Lz5_r
Lz5_ok:
    v_mfma_f32_16x16x32_bf16 v[238:241], v[62:65], a[0:3], v[238:241]
    global_load_dwordx4 v[126:129], v30, s[64:65] offset:-3072 sc1
    v_mfma_f32_16x16x32_bf16 v[242:245], v[62:65], a[4:7], v[242:245]
    v_mfma_f32_16x16x32_bf16 v[246:249], v[62:65], a[8:11], v[246:249]
    v_mfma_f32_16x16x32_bf16 v[250:253], v[62:65], a[12:15], v[250:253]
    v_mfma_f32_16x16x32_bf16 v[142:145], v[66:69], a[16:19], v[142:145]
    global_load_dwordx4 v[130:133], v31, s[64:65] offset:-3072 sc1
    v_mfma_f32_16x16x32_bf16 v[146:149], v[66:69], a[20:23], v[146:149]
    v_mfma_f32_16x16x32_bf16 v[150:153], v[66:69], a[24:27], v[150:153]
    v_mfma_f32_16x16x32_bf16 v[154:157], v[66:69], a[28:31], v[154:157]
    v_mfma_f32_16x16x32_bf16 v[158:161], v[70:73], a[16:19], v[158:161]
    global_load_dwordx4 v[134:137], v30, s[66:67] offset:-3072 sc1
    v_mfma_f32_16x16x32_bf16 v[162:165], v[70:73], a[20:23], v[162:165]
    v_mfma_f32_16x16x32_bf16 v[166:169], v[70:73], a[24:27], v[166:169]
    s_waitcnt vmcnt(14)
    v_and_b32 v28, v81, v85
    v_mfma_f32_16x16x32_bf16 v[170:173], v[70:73], a[28:31], v[170:173]
    s_waitcnt vmcnt(12)
    v_bitop3_b32 v28, v89, v93, v28 bitop3:0x80
    v_mfma_f32_16x16x32_bf16 v[174:177], v[74:77], a[16:19], v[174:177]
    v_and_b32 v28, 1, v28
    global_load_dwordx4 v[138:141], v31, s[66:67] offset:-3072 sc1
    v_mfma_f32_16x16x32_bf16 v[178:181], v[74:77], a[20:23], v[178:181]
    v_cmp_ne_u32 vcc, 1, v28
    v_mfma_f32_16x16x32_bf16 v[182:185], v[74:77], a[24:27], v[182:185]
    v_mfma_f32_16x16x32_bf16 v[186:189], v[74:77], a[28:31], v[186:189]
    s_cbranch_vccnz Lz6_r
Lz6_ok:
    v_mfma_f32_16x16x32_bf16 v[190:193], v[78:81], a[16:19], v[190:193]
    global_load_dwordx4 v[62:65], v30, s[60:61] offset:-2048 sc1
    v_mfma_f32_16x16x32_bf16 v[194:197], v[78:81], a[20:23], v[194:197]
    v_mfma_f32_16x16x32_bf16 v[198:201], v[78:81], a[24:27], v[198:201]
    v_mfma_f32_16x16x32_bf16 v[202:205], v[78:81], a[28:31], v[202:205]
    v_mfma_f32_16x16x32_bf16 v[206:209], v[82:85], a[16:19], v[206:209]
    global_load_dwordx4 v[66:69], v31, s[60:61] offset:-2048 sc1
    v_mfma_f32_16x16x32_bf16 v[210:213], v[82:85], a[20:23], v[210:213]
    v_mfma_f32_16x16x32_bf16 v[214:217], v[82:85], a[24:27], v[214:217]
    v_mfma_f32_16x16x32_bf16 v[218:221], v[82:85], a[28:31], v[218:221]
    v_mfma_f32_16x16x32_bf16 v[222:225], v[86:89], a[16:19], v[222:225]
    global_load_dwordx4 v[70:73], v30, s[62:63] offset:-2048 sc1
    v_mfma_f32_16x16x32_bf16 v[226:229], v[86:89], a[20:23], v[226:229]
    v_mfma_f32_16x16x32_bf16 v[230:233], v[86:89], a[24:27], v[230:233]
    s_waitcnt vmcnt(13)
    v_and_b32 v28, v97, v101
    v_mfma_f32_16x16x32_bf16 v[234:237], v[86:89], a[28:31], v[234:237]
    s_waitcnt vmcnt(11)
    v_bitop3_b32 v28, v105, v109, v28 bitop3:0x80
    v_mfma_f32_16x16x32_bf16 v[238:241], v[90:93], a[16:19], v[238:241]
    v_and_b32 v28, 1, v28
    global_load_dwordx4 v[74:77], v31, s[62:63] offset:-2048 sc1
    v_mfma_f32_16x16x32_bf16 v[242:245], v[90:93], a[20:23], v[242:245]
    v_cmp_ne_u32 vcc, 1, v28
    v_mfma_f32_16x16x32_bf16 v[246:249], v[90:93], a[24:27], v[246:249]
    v_mfma_f32_16x16x32_bf16 v[250:253], v[90:93], a[28:31], v[250:253]
    s_cbranch_vccnz Lz7_r
Lz7_ok:
    v_mfma_f32_16x16x32_bf16 v[142:145], v[94:97], a[32:35], v[142:145]
    global_load_dwordx4 v[78:81], v30, s[52:53] offset:-2048 sc1
    v_mfma_f32_16x16x32_bf16 v[146:149], v[94:97], a[36:39], v[146:149]
    v_mfma_f32_16x16x32_bf16 v[150:153], v[94:97], a[40:43], v[150:153]
    v_mfma_f32_16x16x32_bf16 v[154:157], v[94:97], a[44:47], v[154:157]
    v_mfma_f32_16x16x32_bf16 v[142:145], v[98:101], a[48:51], v[142:145]
    global_load_dwordx4 v[82:85], v31, s[52:53] offset:-2048 sc1
    v_mfma_f32_16x16x32_bf16 v[146:149], v[98:101], a[52:55], v[146:149]
    v_mfma_f32_16x16x32_bf16 v[150:153], v[98:101], a[56:59], v[150:153]
    v_mfma_f32_16x16x32_bf16 v[154:157], v[98:101], a[60:63], v[154:157]
    v_mfma_f32_16x16x32_bf16 v[142:145], v[102:105], a[64:67], v[142:145]
    global_load_dwordx4 v[86:89], v30, s[54:55] offset:-2048 sc1
    v_mfma_f32_16x16x32_bf16 v[146:149], v[102:105], a[68:71], v[146:149]
    v_mfma_f32_16x16x32_bf16 v[150:153], v[102:105], a[72:75], v[150:153]
    s_waitcnt vmcnt(13)
    v_and_b32 v28, v113, v117
    v_mfma_f32_16x16x32_bf16 v[154:157], v[102:105], a[76:79], v[154:157]
    s_waitcnt vmcnt(11)
    v_bitop3_b32 v28, v121, v125, v28 bitop3:0x80
    v_mfma_f32_16x16x32_bf16 v[142:145], v[106:109], a[80:83], v[142:145]
    v_and_b32 v28, 1, v28
    global_load_dwordx4 v[90:93], v31, s[54:55] offset:-2048 sc1
    v_mfma_f32_16x16x32_bf16 v[146:149], v[106:109], a[84:87], v[146:149]
    v_cmp_ne_u32 vcc, 1, v28
    v_mfma_f32_16x16x32_bf16 v[150:153], v[106:109], a[88:91], v[150:153]
    v_mfma_f32_16x16x32_bf16 v[154:157], v[106:109], a[92:95], v[154:157]
    s_cbranch_vccnz Lz8_r
Lz8_ok:
    v_mfma_f32_16x16x32_bf16 v[142:145], v[110:113], a[224:227], v[142:145]
    global_load_dwordx4 v[94:97], v30, s[64:65] offset:-2048 sc1
    v_mfma_f32_16x16x32_bf16 v[146:149], v[110:113], a[228:231], v[146:149]
    v_mfma_f32_16x16x32_bf16 v[150:153], v[110:113], a[232:235], v[150:153]
    v_mfma_f32_16x16x32_bf16 v[154:157], v[110:113], a[236:239], v[154:157]
    v_mfma_f32_16x16x32_bf16 v[142:145], v[114:117], a[240:243], v[142:145]
    global_load_dwordx4 v[98:101], v31, s[64:65] offset:-2048 sc1
    v_mfma_f32_16x16x32_bf16 v[146:149], v[114:117], a[244:247], v[146:149]
    v_mfma_f32_16x16x32_bf16 v[150:153], v[114:117], a[248:251], v[150:153]
    v_mfma_f32_16x16x32_bf16 v[154:157], v[114:117], a[252:255], v[154:157]
    v_mfma_f32_16x16x32_bf16 v[142:145], v[118:121], a[192:195], v[142:145]
    global_load_dwordx4 v[102:105], v30, s[66:67] offset:-2048 sc1
    v_mfma_f32_16x16x32_bf16 v[146:149], v[118:121], a[196:199], v[146:149]
    v_mfma_f32_16x16x32_bf16 v[150:153], v[118:121], a[200:203], v[150:153]
    s_waitcnt vmcnt(13)
    v_and_b32 v28, v129, v133
    v_mfma_f32_16x16x32_bf16 v[154:157], v[118:121], a[204:207], v[154:157]
    s_waitcnt vmcnt(11)
    v_bitop3_b32 v28, v137, v141, v28 bitop3:0x80
    v_mfma_f32_16x16x32_bf16 v[142:145], v[122:125], a[208:211], v[142:145]
    v_and_b32 v28, 1, v28
    global_load_dwordx4 v[106:109], v31, s[66:67] offset:-2048 sc1
    v_mfma_f32_16x16x32_bf16 v[146:149], v[122:125], a[212:215], v[146:149]
    v_cmp_ne_u32 vcc, 1, v28
    v_mfma_f32_16x16x32_bf16 v[150:153], v[122:125], a[216:219], v[150:153]
    v_mfma_f32_16x16x32_bf16 v[154:157], v[122:125], a[220:223], v[154:157]
    s_cbranch_vccnz Lz9_r
Lz9_ok:
    v_mfma_f32_16x16x32_bf16 v[142:145], v[126:129], a[96:99], v[142:145]
    global_load_dwordx4 v[110:113], v30, s[60:61] offset:-1024 sc1
    v_mfma_f32_16x16x32_bf16 v[146:149], v[126:129], a[100:103], v[146:149]
    v_mfma_f32_16x16x32_bf16 v[150:153], v[126:129], a[104:107], v[150:153]
    v_mfma_f32_16x16x32_bf16 v[154:157], v[126:129], a[108:111], v[154:157]
    v_mfma_f32_16x16x32_bf16 v[142:145], v[130:133], a[112:115], v[142:145]
    global_load_dwordx4 v[114:117], v31, s[60:61] offset:-1024 sc1
    v_mfma_f32_16x16x32_bf16 v[146:149], v[130:133], a[116:119], v[146:149]
    v_mfma_f32_16x16x32_bf16 v[150:153], v[130:133], a[120:123], v[150:153]
    v_mfma_f32_16x16x32_bf16 v[154:157], v[130:133], a[124:127], v[154:157]
    v_mfma_f32_16x16x32_bf16 v[142:145], v[134:137], a[128:131], v[142:145]
    global_load_dwordx4 v[118:121], v30, s[62:63] offset:-1024 sc1
    v_mfma_f32_16x16x32_bf16 v[146:149], v[134:137], a[132:135], v[146:149]
    v_mfma_f32_16x16x32_bf16 v[150:153], v[134:137], a[136:139], v[150:153]
    s_waitcnt vmcnt(13)
    v_and_b32 v28, v65, v69
    v_mfma_f32_16x16x32_bf16 v[154:157], v[134:137], a[140:143], v[154:157]
    s_waitcnt vmcnt(11)
    v_bitop3_b32 v28, v73, v77, v28 bitop3:0x80
    v_mfma_f32_16x16x32_bf16 v[142:145], v[138:141], a[144:147], v[142:145]
    v_and_b32 v28, 1, v28
    global_load_dwordx4 v[122:125], v31, s[62:63] offset:-1024 sc1
    v_mfma_f32_16x16x32_bf16 v[146:149], v[138:141], a[148:151], v[146:149]
    v_cmp_ne_u32 vcc, 1, v28
    v_mfma_f32_16x16x32_bf16 v[150:153], v[138:141], a[152:155], v[150:153]
    v_mfma_f32_16x16x32_bf16 v[154:157], v[138:141], a[156:159], v[154:157]
    s_cbranch_vccnz Lz10_r
Lz10_ok:
    v_mfma_f32_16x16x32_bf16 v[158:161], v[62:65], a[32:35], v[158:161]
    global_load_dwordx4 v[126:129], v30, s[52:53] offset:-1024 sc1
    v_mfma_f32_16x16x32_bf16 v[162:165], v[62:65], a[36:39], v[162:165]
    v_mfma_f32_16x16x32_bf16 v[166:169], v[62:65], a[40:43], v[166:169]
    v_mfma_f32_16x16x32_bf16 v[170:173], v[62:65], a[44:47], v[170:173]
    ds_write_b128 v20, v[146:149] offset:0
    v_mfma_f32_16x16x32_bf16 v[158:161], v[66:69], a[48:51], v[158:161]
    global_load_dwordx4 v[130:133], v31, s[52:53] offset:-1024 sc1
    v_mfma_f32_16x16x32_bf16 v[162:165], v[66:69], a[52:55], v[162:165]
    v_mfma_f32_16x16x32_bf16 v[166:169], v[66:69], a[56:59], v[166:169]
    ds_write_b128 v21, v[150:153] offset:0
    v_mfma_f32_16x16x32_bf16 v[170:173], v[66:69], a[60:63], v[170:173]
    v_mfma_f32_16x16x32_bf16 v[158:161], v[70:73], a[64:67], v[158:161]
    global_load_dwordx4 v[134:137], v30, s[54:55] offset:-1024 sc1
    v_mfma_f32_16x16x32_bf16 v[162:165], v[70:73], a[68:71], v[162:165]
    ds_write_b128 v22, v[154:157] offset:0
    v_mfma_f32_16x16x32_bf16 v[166:169], v[70:73], a[72:75], v[166:169]
    s_waitcnt vmcnt(13)
    v_and_b32 v28, v81, v85
    v_mfma_f32_16x16x32_bf16 v[170:173], v[70:73], a[76:79], v[170:173]
    s_waitcnt vmcnt(11)
    v_bitop3_b32 v28, v89, v93, v28 bitop3:0x80
    v_mfma_f32_16x16x32_bf16 v[158:161], v[74:77], a[80:83], v[158:161]
    v_and_b32 v28, 1, v28
    global_load_dwordx4 v[138:141], v31, s[54:55] offset:-1024 sc1
    v_mfma_f32_16x16x32_bf16 v[162:165], v[74:77], a[84:87], v[162:165]
    s_waitcnt lgkmcnt(0)
    s_barrier
    v_cmp_ne_u32 vcc, 1, v28
    v_mfma_f32_16x16x32_bf16 v[166:169], v[74:77], a[88:91], v[166:169]
    v_mfma_f32_16x16x32_bf16 v[170:173], v[74:77], a[92:95], v[170:173]
    s_cbranch_vccnz Lz11_r
Lz11_ok:
    v_mfma_f32_16x16x32_bf16 v[158:161], v[78:81], a[224:227], v[158:161]
    global_load_dwordx4 v[62:65], v30, s[64:65] offset:-1024 sc1
    ds_read_b128 v[146:149], v23 offset:0
    v_mfma_f32_16x16x32_bf16 v[162:165], v[78:81], a[228:231], v[162:165]
    ds_read_b128 v[150:153], v23 offset:1024
    v_mfma_f32_16x16x32_bf16 v[166:169], v[78:81], a[232:235], v[166:169]
    ds_read_b128 v[154:157], v23 offset:2048
    v_mfma_f32_16x16x32_bf16 v[170:173], v[78:81], a[236:239], v[170:173]
    v_lshlrev_b32 v12, 16, v48
    v_mfma_f32_16x16x32_bf16 v[158:161], v[82:85], a[240:243], v[158:161]
    global_load_dwordx4 v[66:69], v31, s[64:65] offset:-1024 sc1
    v_and_b32 v13, 0xffff0000, v48
    v_mfma_f32_16x16x32_bf16 v[162:165], v[82:85], a[244:247], v[162:165]
    v_mfma_f32_16x16x32_bf16 v[166:169], v[82:85], a[248:251], v[166:169]
    v_lshlrev_b32 v14, 16, v49
    v_mfma_f32_16x16x32_bf16 v[170:173], v[82:85], a[252:255], v[170:173]
    v_and_b32 v15, 0xffff0000, v49
    v_mfma_f32_16x16x32_bf16 v[158:161], v[86:89], a[192:195], v[158:161]
    global_load_dwordx4 v[70:73], v30, s[66:67] offset:-1024 sc1
    s_waitcnt lgkmcnt(2)
    v_add_f32 v142, v142, v146
    v_mfma_f32_16x16x32_bf16 v[162:165], v[86:89], a[196:199], v[162:165]
    v_add_f32 v143, v143, v147
    v_mfma_f32_16x16x32_bf16 v[166:169], v[86:89], a[200:203], v[166:169]
    s_waitcnt vmcnt(13)
    v_and_b32 v28, v97, v101
    v_mfma_f32_16x16x32_bf16 v[170:173], v[86:89], a[204:207], v[170:173]
    s_waitcnt vmcnt(11)
    v_bitop3_b32 v28, v105, v109, v28 bitop3:0x80
    v_add_f32 v144, v144, v148
    v_mfma_f32_16x16x32_bf16 v[158:161], v[90:93], a[208:211], v[158:161]
    v_and_b32 v28, 1, v28
    global_load_dwordx4 v[74:77], v31, s[66:67] offset:-1024 sc1
    v_mfma_f32_16x16x32_bf16 v[162:165], v[90:93], a[212:215], v[162:165]
    v_add_f32 v145, v145, v149
    v_cmp_ne_u32 vcc, 1, v28
    v_mfma_f32_16x16x32_bf16 v[166:169], v[90:93], a[216:219], v[166:169]
    s_waitcnt lgkmcnt(1)
    v_add_f32 v142, v142, v150
    v_add_f32 v143, v143, v151
    v_mfma_f32_16x16x32_bf16 v[170:173], v[90:93], a[220:223], v[170:173]
    s_cbranch_vccnz Lz12_r
Lz12_ok:
    v_mfma_f32_16x16x32_bf16 v[158:161], v[94:97], a[96:99], v[158:161]
    global_load_dwordx4 v[78:81], v30, s[60:61] offset:0 sc1
    v_add_f32 v144, v144, v152
    v_mfma_f32_16x16x32_bf16 v[162:165], v[94:97], a[100:103], v[162:165]
    v_add_f32 v145, v145, v153
    v_mfma_f32_16x16x32_bf16 v[166:169], v[94:97], a[104:107], v[166:169]
    s_waitcnt lgkmcnt(0)
    v_add_f32 v142, v142, v154
    v_mfma_f32_16x16x32_bf16 v[170:173], v[94:97], a[108:111], v[170:173]
    v_mfma_f32_16x16x32_bf16 v[158:161], v[98:101], a[112:115], v[158:161]
    global_load_dwordx4 v[82:85], v31, s[60:61] offset:0 sc1
    v_add_f32 v143, v143, v155
    v_mfma_f32_16x16x32_bf16 v[162:165], v[98:101], a[116:119], v[162:165]
    v_add_f32 v144, v144, v156
    v_mfma_f32_16x16x32_bf16 v[166:169], v[98:101], a[120:123], v[166:169]
    v_add_f32 v145, v145, v157
    v_mfma_f32_16x16x32_bf16 v[170:173], v[98:101], a[124:127], v[170:173]
    v_mfma_f32_16x16x32_bf16 v[158:161], v[102:105], a[128:131], v[158:161]
    global_load_dwordx4 v[86:89], v30, s[62:63] offset:0 sc1
    v_mul_f32 v142, v142, v12
    v_mfma_f32_16x16x32_bf16 v[162:165], v[102:105], a[132:135], v[162:165]
    v_mul_f32 v143, v143, v13
    v_mfma_f32_16x16x32_bf16 v[166:169], v[102:105], a[136:139], v[166:169]
    s_waitcnt vmcnt(13)
    v_and_b32 v28, v113, v117
    v_mul_f32 v144, v144, v14
    v_mfma_f32_16x16x32_bf16 v[170:173], v[102:105], a[140:143], v[170:173]
    s_waitcnt vmcnt(11)
    v_bitop3_b32 v28, v121, v125, v28 bitop3:0x80
    v_mfma_f32_16x16x32_bf16 v[158:161], v[106:109], a[144:147], v[158:161]
    v_and_b32 v28, 1, v28
    global_load_dwordx4 v[90:93], v31, s[62:63] offset:0 sc1
    v_mfma_f32_16x16x32_bf16 v[162:165], v[106:109], a[148:151], v[162:165]
    v_mul_f32 v145, v145, v15
    v_cmp_ne_u32 vcc, 1, v28
    v_mfma_f32_16x16x32_bf16 v[166:169], v[106:109], a[152:155], v[166:169]
    v_cvt_pk_bf16_f32 v48, v142, v143
    v_cvt_pk_bf16_f32 v49, v144, v145
    v_mfma_f32_16x16x32_bf16 v[170:173], v[106:109], a[156:159], v[170:173]
    s_cbranch_vccnz Lz13_r
Lz13_ok:
    v_mfma_f32_16x16x32_bf16 v[174:177], v[110:113], a[32:35], v[174:177]
    global_load_dwordx4 v[94:97], v30, s[52:53] offset:0 sc1
    v_mfma_f32_16x16x32_bf16 v[178:181], v[110:113], a[36:39], v[178:181]
    v_mfma_f32_16x16x32_bf16 v[182:185], v[110:113], a[40:43], v[182:185]
    v_mfma_f32_16x16x32_bf16 v[186:189], v[110:113], a[44:47], v[186:189]
    ds_write_b128 v20, v[162:165] offset:12288
    v_mfma_f32_16x16x32_bf16 v[174:177], v[114:117], a[48:51], v[174:177]
    global_load_dwordx4 v[98:101], v31, s[52:53] offset:0 sc1
    v_mfma_f32_16x16x32_bf16 v[178:181], v[114:117], a[52:55], v[178:181]
    v_mfma_f32_16x16x32_bf16 v[182:185], v[114:117], a[56:59], v[182:185]
    ds_write_b128 v21, v[166:169] offset:12288
    v_mfma_f32_16x16x32_bf16 v[186:189], v[114:117], a[60:63], v[186:189]
    v_mfma_f32_16x16x32_bf16 v[174:177], v[118:121], a[64:67], v[174:177]
    global_load_dwordx4 v[102:105], v30, s[54:55] offset:0 sc1
    v_mfma_f32_16x16x32_bf16 v[178:181], v[118:121], a[68:71], v[178:181]
    ds_write_b128 v22, v[170:173] offset:12288
    v_mfma_f32_16x16x32_bf16 v[182:185], v[118:121], a[72:75], v[182:185]
    s_waitcnt vmcnt(13)
    v_and_b32 v28, v129, v133
    v_mfma_f32_16x16x32_bf16 v[186:189], v[118:121], a[76:79], v[186:189]
    s_waitcnt vmcnt(11)
    v_bitop3_b32 v28, v137, v141, v28 bitop3:0x80
    v_mfma_f32_16x16x32_bf16 v[174:177], v[122:125], a[80:83], v[174:177]
    v_and_b32 v28, 1, v28
    global_load_dwordx4 v[106:109], v31, s[54:55] offset:0 sc1
    v_mfma_f32_16x16x32_bf16 v[178:181], v[122:125], a[84:87], v[178:181]
    s_waitcnt lgkmcnt(0)
    s_barrier
    v_cmp_ne_u32 vcc, 1, v28
    v_mfma_f32_16x16x32_bf16 v[182:185], v[122:125], a[88:91], v[182:185]
    v_mfma_f32_16x16x32_bf16 v[186:189], v[122:125], a[92:95], v[186:189]
    s_cbranch_vccnz Lz14_r
Lz14_ok:
    v_mfma_f32_16x16x32_bf16 v[174:177], v[126:129], a[224:227], v[174:177]
    global_load_dwordx4 v[110:113], v30, s[64:65] offset:0 sc1
    ds_read_b128 v[162:165], v23 offset:12288
    v_mfma_f32_16x16x32_bf16 v[178:181], v[126:129], a[228:231], v[178:181]
    ds_read_b128 v[166:169], v23 offset:13312
    v_mfma_f32_16x16x32_bf16 v[182:185], v[126:129], a[232:235], v[182:185]
    ds_read_b128 v[170:173], v23 offset:14336
    v_mfma_f32_16x16x32_bf16 v[186:189], v[126:129], a[236:239], v[186:189]
    v_lshlrev_b32 v12, 16, v50
    v_mfma_f32_16x16x32_bf16 v[174:177], v[130:133], a[240:243], v[174:177]
    global_load_dwordx4 v[114:117], v31, s[64:65] offset:0 sc1
    v_and_b32 v13, 0xffff0000, v50
    v_mfma_f32_16x16x32_bf16 v[178:181], v[130:133], a[244:247], v[178:181]
    v_mfma_f32_16x16x32_bf16 v[182:185], v[130:133], a[248:251], v[182:185]
    v_lshlrev_b32 v14, 16, v51
    v_mfma_f32_16x16x32_bf16 v[186:189], v[130:133], a[252:255], v[186:189]
    v_and_b32 v15, 0xffff0000, v51
    v_mfma_f32_16x16x32_bf16 v[174:177], v[134:137], a[192:195], v[174:177]
    global_load_dwordx4 v[118:121], v30, s[66:67] offset:0 sc1
    s_waitcnt lgkmcnt(2)
    v_add_f32 v158, v158, v162
    v_mfma_f32_16x16x32_bf16 v[178:181], v[134:137], a[196:199], v[178:181]
    v_add_f32 v159, v159, v163
    v_mfma_f32_16x16x32_bf16 v[182:185], v[134:137], a[200:203], v[182:185]
    s_waitcnt vmcnt(13)
    v_and_b32 v28, v65, v69
    v_mfma_f32_16x16x32_bf16 v[186:189], v[134:137], a[204:207], v[186:189]
    s_waitcnt vmcnt(11)
    v_bitop3_b32 v28, v73, v77, v28 bitop3:0x80
    v_add_f32 v160, v160, v164
    v_mfma_f32_16x16x32_bf16 v[174:177], v[138:141], a[208:211], v[174:177]
    v_and_b32 v28, 1, v28
    global_load_dwordx4 v[122:125], v31, s[66:67] offset:0 sc1
    v_mfma_f32_16x16x32_bf16 v[178:181], v[138:141], a[212:215], v[178:181]
    v_add_f32 v161, v161, v165
    v_cmp_ne_u32 vcc, 1, v28
    v_mfma_f32_16x16x32_bf16 v[182:185], v[138:141], a[216:219], v[182:185]
    s_waitcnt lgkmcnt(1)
    v_add_f32 v158, v158, v166
    v_add_f32 v159, v159, v167
    v_mfma_f32_16x16x32_bf16 v[186:189], v[138:141], a[220:223], v[186:189]
    s_cbranch_vccnz Lz15_r
Lz15_ok:
    v_mfma_f32_16x16x32_bf16 v[174:177], v[62:65], a[96:99], v[174:177]
    global_load_dwordx4 v[126:129], v30, s[60:61] offset:1024 sc1
    v_add_f32 v160, v160, v168
    v_mfma_f32_16x16x32_bf16 v[178:181], v[62:65], a[100:103], v[178:181]
    v_add_f32 v161, v161, v169
    v_mfma_f32_16x16x32_bf16 v[182:185], v[62:65], a[104:107], v[182:185]
    s_waitcnt lgkmcnt(0)
    v_add_f32 v158, v158, v170
    v_mfma_f32_16x16x32_bf16 v[186:189], v[62:65], a[108:111], v[186:189]
    v_add_f32 v159, v159, v171
    v_mfma_f32_16x16x32_bf16 v[174:177], v[66:69], a[112:115], v[174:177]
    global_load_dwordx4 v[130:133], v31, s[60:61] offset:1024 sc1
    v_add_f32 v160, v160, v172
    v_mfma_f32_16x16x32_bf16 v[178:181], v[66:69], a[116:119], v[178:181]
    v_mfma_f32_16x16x32_bf16 v[182:185], v[66:69], a[120:123], v[182:185]
    v_add_f32 v161, v161, v173
    v_mfma_f32_16x16x32_bf16 v[186:189], v[66:69], a[124:127], v[186:189]
    v_mul_f32 v158, v158, v12
    v_mfma_f32_16x16x32_bf16 v[174:177], v[70:73], a[128:131], v[174:177]
    global_load_dwordx4 v[134:137], v30, s[62:63] offset:1024 sc1
    v_mul_f32 v159, v159, v13
    v_mfma_f32_16x16x32_bf16 v[178:181], v[70:73], a[132:135], v[178:181]
    v_mul_f32 v160, v160, v14
    v_mfma_f32_16x16x32_bf16 v[182:185], v[70:73], a[136:139], v[182:185]
    s_waitcnt vmcnt(13)
    v_and_b32 v28, v81, v85
    v_mfma_f32_16x16x32_bf16 v[186:189], v[70:73], a[140:143], v[186:189]
    s_waitcnt vmcnt(11)
    v_bitop3_b32 v28, v89, v93, v28 bitop3:0x80
    v_mul_f32 v161, v161, v15
    v_mfma_f32_16x16x32_bf16 v[174:177], v[74:77], a[144:147], v[174:177]
    v_and_b32 v28, 1, v28
    global_load_dwordx4 v[138:141], v31, s[62:63] offset:1024 sc1
    v_mfma_f32_16x16x32_bf16 v[178:181], v[74:77], a[148:151], v[178:181]
    v_cvt_pk_bf16_f32 v50, v158, v159
    v_cmp_ne_u32 vcc, 1, v28
    v_mfma_f32_16x16x32_bf16 v[182:185], v[74:77], a[152:155], v[182:185]
    v_cvt_pk_bf16_f32 v51, v160, v161
    v_and_b32 v51, -2, v51
    v_mfma_f32_16x16x32_bf16 v[186:189], v[74:77], a[156:159], v[186:189]
    s_cbranch_vccnz Lz16_r
Lz16_ok:
    v_mfma_f32_16x16x32_bf16 v[190:193], v[78:81], a[32:35], v[190:193]
    global_load_dwordx4 v[62:65], v30, s[52:53] offset:1024 sc1
    v_mfma_f32_16x16x32_bf16 v[194:197], v[78:81], a[36:39], v[194:197]
    v_mfma_f32_16x16x32_bf16 v[198:201], v[78:81], a[40:43], v[198:201]
    v_mfma_f32_16x16x32_bf16 v[202:205], v[78:81], a[44:47], v[202:205]
    ds_write_b128 v20, v[178:181] offset:0
    v_mfma_f32_16x16x32_bf16 v[190:193], v[82:85], a[48:51], v[190:193]
    global_load_dwordx4 v[66:69], v31, s[52:53] offset:1024 sc1
    v_mfma_f32_16x16x32_bf16 v[194:197], v[82:85], a[52:55], v[194:197]
    v_mfma_f32_16x16x32_bf16 v[198:201], v[82:85], a[56:59], v[198:201]
    ds_write_b128 v21, v[182:185] offset:0
    v_mfma_f32_16x16x32_bf16 v[202:205], v[82:85], a[60:63], v[202:205]
    v_mfma_f32_16x16x32_bf16 v[190:193], v[86:89], a[64:67], v[190:193]
    global_load_dwordx4 v[70:73], v30, s[54:55] offset:1024 sc1
    v_mfma_f32_16x16x32_bf16 v[194:197], v[86:89], a[68:71], v[194:197]
    ds_write_b128 v22, v[186:189] offset:0
    v_mfma_f32_16x16x32_bf16 v[198:201], v[86:89], a[72:75], v[198:201]
    s_waitcnt vmcnt(13)
    v_and_b32 v28, v97, v101
    v_mfma_f32_16x16x32_bf16 v[202:205], v[86:89], a[76:79], v[202:205]
    s_waitcnt vmcnt(11)
    v_bitop3_b32 v28, v105, v109, v28 bitop3:0x80
    v_mfma_f32_16x16x32_bf16 v[190:193], v[90:93], a[80:83], v[190:193]
    v_and_b32 v28, 1, v28
    global_load_dwordx4 v[74:77], v31, s[54:55] offset:1024 sc1
    v_mfma_f32_16x16x32_bf16 v[194:197], v[90:93], a[84:87], v[194:197]
    s_waitcnt lgkmcnt(0)
    s_barrier
    v_cmp_ne_u32 vcc, 1, v28
    v_mfma_f32_16x16x32_bf16 v[198:201], v[90:93], a[88:91], v[198:201]
    v_mfma_f32_16x16x32_bf16 v[202:205], v[90:93], a[92:95], v[202:205]
    s_cbranch_vccnz Lz17_r
Lz17_ok:
    v_mfma_f32_16x16x32_bf16 v[190:193], v[94:97], a[224:227], v[190:193]
    global_load_dwordx4 v[78:81], v30, s[64:65] offset:1024 sc1
    ds_read_b128 v[178:181], v23 offset:0
    v_mfma_f32_16x16x32_bf16 v[194:197], v[94:97], a[228:231], v[194:197]
    ds_read_b128 v[182:185], v23 offset:1024
    v_mfma_f32_16x16x32_bf16 v[198:201], v[94:97], a[232:235], v[198:201]
    ds_read_b128 v[186:189], v23 offset:2048
    v_mfma_f32_16x16x32_bf16 v[202:205], v[94:97], a[236:239], v[202:205]
    v_lshlrev_b32 v12, 16, v52
    v_mfma_f32_16x16x32_bf16 v[190:193], v[98:101], a[240:243], v[190:193]
    global_load_dwordx4 v[82:85], v31, s[64:65] offset:1024 sc1
    v_and_b32 v13, 0xffff0000, v52
    v_mfma_f32_16x16x32_bf16 v[194:197], v[98:101], a[244:247], v[194:197]
    v_mfma_f32_16x16x32_bf16 v[198:201], v[98:101], a[248:251], v[198:201]
    v_lshlrev_b32 v14, 16, v53
    v_mfma_f32_16x16x32_bf16 v[202:205], v[98:101], a[252:255], v[202:205]
    v_and_b32 v15, 0xffff0000, v53
    v_mfma_f32_16x16x32_bf16 v[190:193], v[102:105], a[192:195], v[190:193]
    global_load_dwordx4 v[86:89], v30, s[66:67] offset:1024 sc1
    s_waitcnt lgkmcnt(2)
    v_add_f32 v174, v174, v178
    v_mfma_f32_16x16x32_bf16 v[194:197], v[102:105], a[196:199], v[194:197]
    v_add_f32 v175, v175, v179
    v_mfma_f32_16x16x32_bf16 v[198:201], v[102:105], a[200:203], v[198:201]
    s_waitcnt vmcnt(13)
    v_and_b32 v28, v113, v117
    v_mfma_f32_16x16x32_bf16 v[202:205], v[102:105], a[204:207], v[202:205]
    s_waitcnt vmcnt(11)
    v_bitop3_b32 v28, v121, v125, v28 bitop3:0x80
    v_add_f32 v176, v176, v180
    v_mfma_f32_16x16x32_bf16 v[190:193], v[106:109], a[208:211], v[190:193]
    v_and_b32 v28, 1, v28
    global_load_dwordx4 v[90:93], v31, s[66:67] offset:1024 sc1
    v_mfma_f32_16x16x32_bf16 v[194:197], v[106:109], a[212:215], v[194:197]
    v_add_f32 v177, v177, v181
    v_cmp_ne_u32 vcc, 1, v28
    v_mfma_f32_16x16x32_bf16 v[198:201], v[106:109], a[216:219], v[198:201]
    s_waitcnt lgkmcnt(1)
    v_add_f32 v174, v174, v182
    v_add_f32 v175, v175, v183
    v_mfma_f32_16x16x32_bf16 v[202:205], v[106:109], a[220:223], v[202:205]
    s_cbranch_vccnz Lz18_r
Lz18_ok:
    v_mfma_f32_16x16x32_bf16 v[190:193], v[110:113], a[96:99], v[190:193]
    global_load_dwordx4 v[94:97], v30, s[60:61] offset:2048 sc1
    v_add_f32 v176, v176, v184
    v_mfma_f32_16x16x32_bf16 v[194:197], v[110:113], a[100:103], v[194:197]
    v_add_f32 v177, v177, v185
    v_mfma_f32_16x16x32_bf16 v[198:201], v[110:113], a[104:107], v[198:201]
    s_waitcnt lgkmcnt(0)
    v_add_f32 v174, v174, v186
    v_mfma_f32_16x16x32_bf16 v[202:205], v[110:113], a[108:111], v[202:205]
    v_mfma_f32_16x16x32_bf16 v[190:193], v[114:117], a[112:115], v[190:193]
    global_load_dwordx4 v[98:101], v31, s[60:61] offset:2048 sc1
    v_add_f32 v175, v175, v187
    v_mfma_f32_16x16x32_bf16 v[194:197], v[114:117], a[116:119], v[194:197]
    v_add_f32 v176, v176, v188
    v_mfma_f32_16x16x32_bf16 v[198:201], v[114:117], a[120:123], v[198:201]
    v_add_f32 v177, v177, v189
    v_mfma_f32_16x16x32_bf16 v[202:205], v[114:117], a[124:127], v[202:205]
    v_mfma_f32_16x16x32_bf16 v[190:193], v[118:121], a[128:131], v[190:193]
    global_load_dwordx4 v[102:105], v30, s[62:63] offset:2048 sc1
    v_mul_f32 v174, v174, v12
    v_mfma_f32_16x16x32_bf16 v[194:197], v[118:121], a[132:135], v[194:197]
    v_mul_f32 v175, v175, v13
    v_mfma_f32_16x16x32_bf16 v[198:201], v[118:121], a[136:139], v[198:201]
    s_waitcnt vmcnt(13)
    v_and_b32 v28, v129, v133
    v_mul_f32 v176, v176, v14
    v_mfma_f32_16x16x32_bf16 v[202:205], v[118:121], a[140:143], v[202:205]
    s_waitcnt vmcnt(11)
    v_bitop3_b32 v28, v137, v141, v28 bitop3:0x80
    v_mfma_f32_16x16x32_bf16 v[190:193], v[122:125], a[144:147], v[190:193]
    v_and_b32 v28, 1, v28
    global_load_dwordx4 v[106:109], v31, s[62:63] offset:2048 sc1
    v_mfma_f32_16x16x32_bf16 v[194:197], v[122:125], a[148:151], v[194:197]
    v_mul_f32 v177, v177, v15
    v_cmp_ne_u32 vcc, 1, v28
    v_mfma_f32_16x16x32_bf16 v[198:201], v[122:125], a[152:155], v[198:201]
    v_cvt_pk_bf16_f32 v52, v174, v175
    v_cvt_pk_bf16_f32 v53, v176, v177
    v_mfma_f32_16x16x32_bf16 v[202:205], v[122:125], a[156:159], v[202:205]
    s_cbranch_vccnz Lz19_r
Lz19_ok:
    v_mfma_f32_16x16x32_bf16 v[206:209], v[126:129], a[32:35], v[206:209]
    global_load_dwordx4 v[110:113], v30, s[52:53] offset:2048 sc1
    v_mfma_f32_16x16x32_bf16 v[210:213], v[126:129], a[36:39], v[210:213]
    v_mfma_f32_16x16x32_bf16 v[214:217], v[126:129], a[40:43], v[214:217]
    v_mfma_f32_16x16x32_bf16 v[218:221], v[126:129], a[44:47], v[218:221]
    ds_write_b128 v20, v[194:197] offset:12288
    v_mfma_f32_16x16x32_bf16 v[206:209], v[130:133], a[48:51], v[206:209]
    global_load_dwordx4 v[114:117], v31, s[52:53] offset:2048 sc1
    v_mfma_f32_16x16x32_bf16 v[210:213], v[130:133], a[52:55], v[210:213]
    v_mfma_f32_16x16x32_bf16 v[214:217], v[130:133], a[56:59], v[214:217]
    ds_write_b128 v21, v[198:201] offset:12288
    v_mfma_f32_16x16x32_bf16 v[218:221], v[130:133], a[60:63], v[218:221]
    v_mfma_f32_16x16x32_bf16 v[206:209], v[134:137], a[64:67], v[206:209]
    global_load_dwordx4 v[118:121], v30, s[54:55] offset:2048 sc1
    v_mfma_f32_16x16x32_bf16 v[210:213], v[134:137], a[68:71], v[210:213]
    ds_write_b128 v22, v[202:205] offset:12288
    v_mfma_f32_16x16x32_bf16 v[214:217], v[134:137], a[72:75], v[214:217]
    s_waitcnt vmcnt(13)
    v_and_b32 v28, v65, v69
    v_mfma_f32_16x16x32_bf16 v[218:221], v[134:137], a[76:79], v[218:221]
    s_waitcnt vmcnt(11)
    v_bitop3_b32 v28, v73, v77, v28 bitop3:0x80
    v_mfma_f32_16x16x32_bf16 v[206:209], v[138:141], a[80:83], v[206:209]
    v_and_b32 v28, 1, v28
    global_load_dwordx4 v[122:125], v31, s[54:55] offset:2048 sc1
    v_mfma_f32_16x16x32_bf16 v[210:213], v[138:141], a[84:87], v[210:213]
    s_waitcnt lgkmcnt(0)
    s_barrier
    v_cmp_ne_u32 vcc, 1, v28
    v_mfma_f32_16x16x32_bf16 v[214:217], v[138:141], a[88:91], v[214:217]
    v_mfma_f32_16x16x32_bf16 v[218:221], v[138:141], a[92:95], v[218:221]
    s_cbranch_vccnz Lz20_r
Lz20_ok:
    v_mfma_f32_16x16x32_bf16 v[206:209], v[62:65], a[224:227], v[206:209]
    global_load_dwordx4 v[126:129], v30, s[64:65] offset:2048 sc1
    ds_read_b128 v[194:197], v23 offset:12288
    v_mfma_f32_16x16x32_bf16 v[210:213], v[62:65], a[228:231], v[210:213]
    ds_read_b128 v[198:201], v23 offset:13312
    v_mfma_f32_16x16x32_bf16 v[214:217], v[62:65], a[232:235], v[214:217]
    ds_read_b128 v[202:205], v23 offset:14336
    v_mfma_f32_16x16x32_bf16 v[218:221], v[62:65], a[236:239], v[218:221]
    v_lshlrev_b32 v12, 16, v54
    v_mfma_f32_16x16x32_bf16 v[206:209], v[66:69], a[240:243], v[206:209]
    global_load_dwordx4 v[130:133], v31, s[64:65] offset:2048 sc1
    v_and_b32 v13, 0xffff0000, v54
    v_mfma_f32_16x16x32_bf16 v[210:213], v[66:69], a[244:247], v[210:213]
    v_mfma_f32_16x16x32_bf16 v[214:217], v[66:69], a[248:251], v[214:217]
    v_lshlrev_b32 v14, 16, v55
    v_mfma_f32_16x16x32_bf16 v[218:221], v[66:69], a[252:255], v[218:221]
    v_and_b32 v15, 0xffff0000, v55
    v_mfma_f32_16x16x32_bf16 v[206:209], v[70:73], a[192:195], v[206:209]
    global_load_dwordx4 v[134:137], v30, s[66:67] offset:2048 sc1
    s_waitcnt lgkmcnt(2)
    v_add_f32 v190, v190, v194
    v_mfma_f32_16x16x32_bf16 v[210:213], v[70:73], a[196:199], v[210:213]
    v_add_f32 v191, v191, v195
    v_mfma_f32_16x16x32_bf16 v[214:217], v[70:73], a[200:203], v[214:217]
    s_waitcnt vmcnt(13)
    v_and_b32 v28, v81, v85
    v_mfma_f32_16x16x32_bf16 v[218:221], v[70:73], a[204:207], v[218:221]
    s_waitcnt vmcnt(11)
    v_bitop3_b32 v28, v89, v93, v28 bitop3:0x80
    v_add_f32 v192, v192, v196
    v_mfma_f32_16x16x32_bf16 v[206:209], v[74:77], a[208:211], v[206:209]
    v_and_b32 v28, 1, v28
    global_load_dwordx4 v[138:141], v31, s[66:67] offset:2048 sc1
    v_mfma_f32_16x16x32_bf16 v[210:213], v[74:77], a[212:215], v[210:213]
    v_add_f32 v193, v193, v197
    v_cmp_ne_u32 vcc, 1, v28
    v_mfma_f32_16x16x32_bf16 v[214:217], v[74:77], a[216:219], v[214:217]
    s_waitcnt lgkmcnt(1)
    v_add_f32 v190, v190, v198
    v_add_f32 v191, v191, v199
    v_mfma_f32_16x16x32_bf16 v[218:221], v[74:77], a[220:223], v[218:221]
    s_cbranch_vccnz Lz21_r
Lz21_ok:
    v_mfma_f32_16x16x32_bf16 v[206:209], v[78:81], a[96:99], v[206:209]
    global_load_dwordx4 v[62:65], v30, s[60:61] offset:3072 sc1
    v_add_f32 v192, v192, v200
    v_mfma_f32_16x16x32_bf16 v[210:213], v[78:81], a[100:103], v[210:213]
    v_add_f32 v193, v193, v201
    v_mfma_f32_16x16x32_bf16 v[214:217], v[78:81], a[104:107], v[214:217]
    s_waitcnt lgkmcnt(0)
    v_add_f32 v190, v190, v202
    v_mfma_f32_16x16x32_bf16 v[218:221], v[78:81], a[108:111], v[218:221]
    v_add_f32 v191, v191, v203
    v_mfma_f32_16x16x32_bf16 v[206:209], v[82:85], a[112:115], v[206:209]
    global_load_dwordx4 v[66:69], v31, s[60:61] offset:3072 sc1
    v_add_f32 v192, v192, v204
    v_mfma_f32_16x16x32_bf16 v[210:213], v[82:85], a[116:119], v[210:213]
    v_mfma_f32_16x16x32_bf16 v[214:217], v[82:85], a[120:123], v[214:217]
    v_add_f32 v193, v193, v205
    v_mfma_f32_16x16x32_bf16 v[218:221], v[82:85], a[124:127], v[218:221]
    v_mul_f32 v190, v190, v12
    v_mfma_f32_16x16x32_bf16 v[206:209], v[86:89], a[128:131], v[206:209]
    global_load_dwordx4 v[70:73], v30, s[62:63] offset:3072 sc1
    v_mul_f32 v191, v191, v13
    v_mfma_f32_16x16x32_bf16 v[210:213], v[86:89], a[132:135], v[210:213]
    v_mul_f32 v192, v192, v14
    v_mfma_f32_16x16x32_bf16 v[214:217], v[86:89], a[136:139], v[214:217]
    s_waitcnt vmcnt(13)
    v_and_b32 v28, v97, v101
    v_mfma_f32_16x16x32_bf16 v[218:221], v[86:89], a[140:143], v[218:221]
    s_waitcnt vmcnt(11)
    v_bitop3_b32 v28, v105, v109, v28 bitop3:0x80
    v_mul_f32 v193, v193, v15
    v_mfma_f32_16x16x32_bf16 v[206:209], v[90:93], a[144:147], v[206:209]
    v_and_b32 v28, 1, v28
    global_load_dwordx4 v[74:77], v31, s[62:63] offset:3072 sc1
    v_mfma_f32_16x16x32_bf16 v[210:213], v[90:93], a[148:151], v[210:213]
    v_cvt_pk_bf16_f32 v54, v190, v191
    v_cmp_ne_u32 vcc, 1, v28
    v_mfma_f32_16x16x32_bf16 v[214:217], v[90:93], a[152:155], v[214:217]
    v_cvt_pk_bf16_f32 v55, v192, v193
    v_and_b32 v55, -2, v55
    v_mfma_f32_16x16x32_bf16 v[218:221], v[90:93], a[156:159], v[218:221]
    s_cbranch_vccnz Lz22_r
Lz22_ok:
    v_mfma_f32_16x16x32_bf16 v[222:225], v[94:97], a[32:35], v[222:225]
    global_load_dwordx4 v[78:81], v30, s[52:53] offset:3072 sc1
    v_mfma_f32_16x16x32_bf16 v[226:229], v[94:97], a[36:39], v[226:229]
    v_mfma_f32_16x16x32_bf16 v[230:233], v[94:97], a[40:43], v[230:233]
    v_mfma_f32_16x16x32_bf16 v[234:237], v[94:97], a[44:47], v[234:237]
    ds_write_b128 v20, v[210:213] offset:0
    v_mfma_f32_16x16x32_bf16 v[222:225], v[98:101], a[48:51], v[222:225]
    global_load_dwordx4 v[82:85], v31, s[52:53] offset:3072 sc1
    v_mfma_f32_16x16x32_bf16 v[226:229], v[98:101], a[52:55], v[226:229]
    v_mfma_f32_16x16x32_bf16 v[230:233], v[98:101], a[56:59], v[230:233]
    ds_write_b128 v21, v[214:217] offset:0
    v_mfma_f32_16x16x32_bf16 v[234:237], v[98:101], a[60:63], v[234:237]
    v_mfma_f32_16x16x32_bf16 v[222:225], v[102:105], a[64:67], v[222:225]
    global_load_dwordx4 v[86:89], v30, s[54:55] offset:3072 sc1
    v_mfma_f32_16x16x32_bf16 v[226:229], v[102:105], a[68:71], v[226:229]
    ds_write_b128 v22, v[218:221] offset:0
    v_mfma_f32_16x16x32_bf16 v[230:233], v[102:105], a[72:75], v[230:233]
    s_waitcnt vmcnt(13)
    v_and_b32 v28, v113, v117
    v_mfma_f32_16x16x32_bf16 v[234:237], v[102:105], a[76:79], v[234:237]
    s_waitcnt vmcnt(11)
    v_bitop3_b32 v28, v121, v125, v28 bitop3:0x80
    v_mfma_f32_16x16x32_bf16 v[222:225], v[106:109], a[80:83], v[222:225]
    v_and_b32 v28, 1, v28
    global_load_dwordx4 v[90:93], v31, s[54:55] offset:3072 sc1
    v_mfma_f32_16x16x32_bf16 v[226:229], v[106:109], a[84:87], v[226:229]
    s_waitcnt lgkmcnt(0)
    s_barrier
    v_cmp_ne_u32 vcc, 1, v28
    v_mfma_f32_16x16x32_bf16 v[230:233], v[106:109], a[88:91], v[230:233]
    v_mfma_f32_16x16x32_bf16 v[234:237], v[106:109], a[92:95], v[234:237]
    s_cbranch_vccnz Lz23_r
Lz23_ok:
    v_mfma_f32_16x16x32_bf16 v[222:225], v[110:113], a[224:227], v[222:225]
    global_load_dwordx4 v[94:97], v30, s[64:65] offset:3072 sc1
    ds_read_b128 v[210:213], v23 offset:0
    v_mfma_f32_16x16x32_bf16 v[226:229], v[110:113], a[228:231], v[226:229]
    ds_read_b128 v[214:217], v23 offset:1024
    v_mfma_f32_16x16x32_bf16 v[230:233], v[110:113], a[232:235], v[230:233]
    ds_read_b128 v[218:221], v23 offset:2048
    v_mfma_f32_16x16x32_bf16 v[234:237], v[110:113], a[236:239], v[234:237]
    v_lshlrev_b32 v12, 16, v56
    v_mfma_f32_16x16x32_bf16 v[222:225], v[114:117], a[240:243], v[222:225]
    global_load_dwordx4 v[98:101], v31, s[64:65] offset:3072 sc1
    v_and_b32 v13, 0xffff0000, v56
    v_mfma_f32_16x16x32_bf16 v[226:229], v[114:117], a[244:247], v[226:229]
    v_mfma_f32_16x16x32_bf16 v[230:233], v[114:117], a[248:251], v[230:233]
    v_lshlrev_b32 v14, 16, v57
    v_mfma_f32_16x16x32_bf16 v[234:237], v[114:117], a[252:255], v[234:237]
    v_and_b32 v15, 0xffff0000, v57
    v_mfma_f32_16x16x32_bf16 v[222:225], v[118:121], a[192:195], v[222:225]
    global_load_dwordx4 v[102:105], v30, s[66:67] offset:3072 sc1
    s_waitcnt lgkmcnt(2)
    v_add_f32 v206, v206, v210
    v_mfma_f32_16x16x32_bf16 v[226:229], v[118:121], a[196:199], v[226:229]
    v_add_f32 v207, v207, v211
    v_mfma_f32_16x16x32_bf16 v[230:233], v[118:121], a[200:203], v[230:233]
    s_waitcnt vmcnt(13)
    v_and_b32 v28, v129, v133
    v_mfma_f32_16x16x32_bf16 v[234:237], v[118:121], a[204:207], v[234:237]
    s_waitcnt vmcnt(11)
    v_bitop3_b32 v28, v137, v141, v28 bitop3:0x80
    v_add_f32 v208, v208, v212
    v_mfma_f32_16x16x32_bf16 v[222:225], v[122:125], a[208:211], v[222:225]
    v_and_b32 v28, 1, v28
    global_load_dwordx4 v[106:109], v31, s[66:67] offset:3072 sc1
    v_mfma_f32_16x16x32_bf16 v[226:229], v[122:125], a[212:215], v[226:229]
    v_add_f32 v209, v209, v213
    v_cmp_ne_u32 vcc, 1, v28
    v_mfma_f32_16x16x32_bf16 v[230:233], v[122:125], a[216:219], v[230:233]
    s_waitcnt lgkmcnt(1)
    v_add_f32 v206, v206, v214
    v_add_f32 v207, v207, v215
    v_mfma_f32_16x16x32_bf16 v[234:237], v[122:125], a[220:223], v[234:237]
    s_cbranch_vccnz Lz24_r
Lz24_ok:
    v_mfma_f32_16x16x32_bf16 v[222:225], v[126:129], a[96:99], v[222:225]
    global_store_dwordx4 v6, v[48:51], s[8:9] offset:-4096 sc1
    v_add_f32 v208, v208, v216
    v_mfma_f32_16x16x32_bf16 v[226:229], v[126:129], a[100:103], v[226:229]
    v_add_f32 v209, v209, v217
    global_store_dwordx4 v7, v[52:55], s[8:9] offset:-4096 sc1
    v_mfma_f32_16x16x32_bf16 v[230:233], v[126:129], a[104:107], v[230:233]
    s_waitcnt lgkmcnt(0)
    v_add_f32 v206, v206, v218
    global_load_lds_dwordx4 v4, s[92:93] offset:2048 sc1
    v_mfma_f32_16x16x32_bf16 v[234:237], v[126:129], a[108:111], v[234:237]
    v_mfma_f32_16x16x32_bf16 v[222:225], v[130:133], a[112:115], v[222:225]
    v_add_f32 v207, v207, v219
    global_load_lds_dwordx4 v4, s[92:93] offset:3072 sc1
    v_mfma_f32_16x16x32_bf16 v[226:229], v[130:133], a[116:119], v[226:229]
    v_add_f32 v208, v208, v220
    s_add_u32 m0, s95, 12288
    v_mfma_f32_16x16x32_bf16 v[230:233], v[130:133], a[120:123], v[230:233]
    v_add_f32 v209, v209, v221
    v_mfma_f32_16x16x32_bf16 v[234:237], v[130:133], a[124:127], v[234:237]
    s_add_u32 s92, s92, 4096
    s_addc_u32 s93, s93, 0
    v_mfma_f32_16x16x32_bf16 v[222:225], v[134:137], a[128:131], v[222:225]
    v_mul_f32 v206, v206, v12
    v_mfma_f32_16x16x32_bf16 v[226:229], v[134:137], a[132:135], v[226:229]
    v_mul_f32 v207, v207, v13
    v_mfma_f32_16x16x32_bf16 v[230:233], v[134:137], a[136:139], v[230:233]
    s_waitcnt vmcnt(14)
    v_and_b32 v28, v65, v69
    global_load_lds_dwordx4 v4, s[92:93] offset:0 sc1
    v_mfma_f32_16x16x32_bf16 v[234:237], v[134:137], a[140:143], v[234:237]
    s_waitcnt vmcnt(13)
    v_bitop3_b32 v28, v73, v77, v28 bitop3:0x80
    v_mul_f32 v208, v208, v14
    v_mfma_f32_16x16x32_bf16 v[222:225], v[138:141], a[144:147], v[222:225]
    v_and_b32 v28, 1, v28
    global_load_lds_dwordx4 v4, s[92:93] offset:1024 sc1
    v_mfma_f32_16x16x32_bf16 v[226:229], v[138:141], a[148:151], v[226:229]
    v_mul_f32 v209, v209, v15
    global_load_lds_dwordx4 v4, s[92:93] offset:2048 sc1
    v_mfma_f32_16x16x32_bf16 v[230:233], v[138:141], a[152:155], v[230:233]
    v_cmp_ne_u32 vcc, 1, v28
    v_cvt_pk_bf16_f32 v56, v206, v207
    v_mfma_f32_16x16x32_bf16 v[234:237], v[138:141], a[156:159], v[234:237]
    global_load_lds_dwordx4 v4, s[92:93] offset:3072 sc1
    v_cvt_pk_bf16_f32 v57, v208, v209
    s_cbranch_vccnz Lz25_r
Lz25_ok:
    v_mfma_f32_16x16x32_bf16 v[238:241], v[62:65], a[32:35], v[238:241]
    s_add_u32 m0, s95, 16384
    v_mfma_f32_16x16x32_bf16 v[242:245], v[62:65], a[36:39], v[242:245]
    s_add_u32 s92, s92, 4096
    s_addc_u32 s93, s93, 0
    v_mfma_f32_16x16x32_bf16 v[246:249], v[62:65], a[40:43], v[246:249]
    v_mfma_f32_16x16x32_bf16 v[250:253], v[62:65], a[44:47], v[250:253]
    ds_write_b128 v20, v[226:229] offset:12288
    v_mfma_f32_16x16x32_bf16 v[238:241], v[66:69], a[48:51], v[238:241]
    global_load_lds_dwordx4 v4, s[92:93] offset:0 sc1
    v_mfma_f32_16x16x32_bf16 v[242:245], v[66:69], a[52:55], v[242:245]
    global_load_lds_dwordx4 v4, s[92:93] offset:1024 sc1
    v_mfma_f32_16x16x32_bf16 v[246:249], v[66:69], a[56:59], v[246:249]
    ds_write_b128 v21, v[230:233] offset:12288
    v_mfma_f32_16x16x32_bf16 v[250:253], v[66:69], a[60:63], v[250:253]
    global_load_lds_dwordx4 v4, s[92:93] offset:2048 sc1
    v_mfma_f32_16x16x32_bf16 v[238:241], v[70:73], a[64:67], v[238:241]
    global_load_lds_dwordx4 v4, s[92:93] offset:3072 sc1
    v_mfma_f32_16x16x32_bf16 v[242:245], v[70:73], a[68:71], v[242:245]
    s_add_u32 m0, s95, 20480
    v_mfma_f32_16x16x32_bf16 v[246:249], v[70:73], a[72:75], v[246:249]
    s_waitcnt vmcnt(18)
    v_and_b32 v28, v81, v85
    s_add_u32 s92, s92, 4096
    s_addc_u32 s93, s93, 0
    v_mfma_f32_16x16x32_bf16 v[250:253], v[70:73], a[76:79], v[250:253]
    ds_write_b128 v22, v[234:237] offset:12288
    v_mfma_f32_16x16x32_bf16 v[238:241], v[74:77], a[80:83], v[238:241]
    s_waitcnt vmcnt(16)
    v_bitop3_b32 v28, v89, v93, v28 bitop3:0x80
    v_and_b32 v28, 1, v28
    v_mfma_f32_16x16x32_bf16 v[242:245], v[74:77], a[84:87], v[242:245]
    s_waitcnt lgkmcnt(0)
    s_barrier
    v_cmp_ne_u32 vcc, 1, v28
    v_mfma_f32_16x16x32_bf16 v[246:249], v[74:77], a[88:91], v[246:249]
    global_load_lds_dwordx4 v4, s[92:93] offset:0 sc1
    global_load_lds_dwordx4 v4, s[92:93] offset:1024 sc1
    v_mfma_f32_16x16x32_bf16 v[250:253], v[74:77], a[92:95], v[250:253]
    s_cbranch_vccnz Lz26_r
Lz26_ok:
    v_mfma_f32_16x16x32_bf16 v[238:241], v[78:81], a[224:227], v[238:241]
    global_load_lds_dwordx4 v4, s[92:93] offset:2048 sc1
    ds_read_b128 v[226:229], v23 offset:12288
    v_mfma_f32_16x16x32_bf16 v[242:245], v[78:81], a[228:231], v[242:245]
    ds_read_b128 v[230:233], v23 offset:13312
    global_load_lds_dwordx4 v4, s[92:93] offset:3072 sc1
    v_mfma_f32_16x16x32_bf16 v[246:249], v[78:81], a[232:235], v[246:249]
    ds_read_b128 v[234:237], v23 offset:14336
    v_mfma_f32_16x16x32_bf16 v[250:253], v[78:81], a[236:239], v[250:253]
    s_add_u32 m0, s95, 24576
    v_lshlrev_b32 v12, 16, v58
    v_mfma_f32_16x16x32_bf16 v[238:241], v[82:85], a[240:243], v[238:241]
    v_and_b32 v13, 0xffff0000, v58
    v_mfma_f32_16x16x32_bf16 v[242:245], v[82:85], a[244:247], v[242:245]
    s_add_u32 s92, s92, 4096
    s_addc_u32 s93, s93, 0
    v_mfma_f32_16x16x32_bf16 v[246:249], v[82:85], a[248:251], v[246:249]
    v_lshlrev_b32 v14, 16, v59
    v_mfma_f32_16x16x32_bf16 v[250:253], v[82:85], a[252:255], v[250:253]
    v_and_b32 v15, 0xffff0000, v59
    v_mfma_f32_16x16x32_bf16 v[238:241], v[86:89], a[192:195], v[238:241]
    s_waitcnt lgkmcnt(2)
    v_add_f32 v222, v222, v226
    global_load_lds_dwordx4 v4, s[92:93] offset:0 sc1
    v_mfma_f32_16x16x32_bf16 v[242:245], v[86:89], a[196:199], v[242:245]
    v_add_f32 v223, v223, v227
    v_mfma_f32_16x16x32_bf16 v[246:249], v[86:89], a[200:203], v[246:249]
    s_waitcnt vmcnt(19)
    v_and_b32 v28, v97, v101
    global_load_lds_dwordx4 v4, s[92:93] offset:1024 sc1
    v_mfma_f32_16x16x32_bf16 v[250:253], v[86:89], a[204:207], v[250:253]
    s_waitcnt vmcnt(18)
    v_bitop3_b32 v28, v105, v109, v28 bitop3:0x80
    v_add_f32 v224, v224, v228
    v_mfma_f32_16x16x32_bf16 v[238:241], v[90:93], a[208:211], v[238:241]
    v_and_b32 v28, 1, v28
    v_add_f32 v225, v225, v229
    v_mfma_f32_16x16x32_bf16 v[242:245], v[90:93], a[212:215], v[242:245]
    global_load_lds_dwordx4 v4, s[92:93] offset:2048 sc1
    v_cmp_ne_u32 vcc, 1, v28
    v_mfma_f32_16x16x32_bf16 v[246:249], v[90:93], a[216:219], v[246:249]
    s_waitcnt lgkmcnt(1)
    v_add_f32 v222, v222, v230
    global_load_lds_dwordx4 v4, s[92:93] offset:3072 sc1
    v_mfma_f32_16x16x32_bf16 v[250:253], v[90:93], a[220:223], v[250:253]
    v_add_f32 v223, v223, v231
    s_cbranch_vccnz Lz27_r
Lz27_ok:
    v_mfma_f32_16x16x32_bf16 v[238:241], v[94:97], a[96:99], v[238:241]
    s_add_u32 m0, s95, 28672
    v_add_f32 v224, v224, v232
    v_mfma_f32_16x16x32_bf16 v[242:245], v[94:97], a[100:103], v[242:245]
    v_add_f32 v225, v225, v233
    s_add_u32 s92, s92, 4096
    s_addc_u32 s93, s93, 0
    v_mfma_f32_16x16x32_bf16 v[246:249], v[94:97], a[104:107], v[246:249]
    s_waitcnt lgkmcnt(0)
    v_add_f32 v222, v222, v234
    v_mfma_f32_16x16x32_bf16 v[250:253], v[94:97], a[108:111], v[250:253]
    v_add_f32 v223, v223, v235
    v_mfma_f32_16x16x32_bf16 v[238:241], v[98:101], a[112:115], v[238:241]
    global_load_lds_dwordx4 v4, s[92:93] offset:0 sc1
    v_add_f32 v224, v224, v236
    v_mfma_f32_16x16x32_bf16 v[242:245], v[98:101], a[116:119], v[242:245]
    global_load_lds_dwordx4 v4, s[92:93] offset:1024 sc1
    v_mfma_f32_16x16x32_bf16 v[246:249], v[98:101], a[120:123], v[246:249]
    v_add_f32 v225, v225, v237
    global_load_lds_dwordx4 v4, s[92:93] offset:2048 sc1
    v_mfma_f32_16x16x32_bf16 v[250:253], v[98:101], a[124:127], v[250:253]
    v_mul_f32 v222, v222, v12
    v_mfma_f32_16x16x32_bf16 v[238:241], v[102:105], a[128:131], v[238:241]
    global_load_lds_dwordx4 v4, s[92:93] offset:3072 sc1
    v_mul_f32 v223, v223, v13
    v_mfma_f32_16x16x32_bf16 v[242:245], v[102:105], a[132:135], v[242:245]
    s_add_u32 m0, s95, 32768
    v_mul_f32 v224, v224, v14
    v_mfma_f32_16x16x32_bf16 v[246:249], v[102:105], a[136:139], v[246:249]
    s_add_u32 s92, s92, 4096
    s_addc_u32 s93, s93, 0
    v_mfma_f32_16x16x32_bf16 v[250:253], v[102:105], a[140:143], v[250:253]
    v_mul_f32 v225, v225, v15
    v_mfma_f32_16x16x32_bf16 v[238:241], v[106:109], a[144:147], v[238:241]
    v_cvt_pk_bf16_f32 v58, v222, v223
    v_mfma_f32_16x16x32_bf16 v[242:245], v[106:109], a[148:151], v[242:245]
    global_load_lds_dwordx4 v4, s[92:93] offset:0 sc1
    v_cvt_pk_bf16_f32 v59, v224, v225
    v_mfma_f32_16x16x32_bf16 v[246:249], v[106:109], a[152:155], v[246:249]
    global_load_lds_dwordx4 v4, s[92:93] offset:1024 sc1
    v_and_b32 v59, -2, v59
    v_mfma_f32_16x16x32_bf16 v[250:253], v[106:109], a[156:159], v[250:253]
    global_load_dwordx4 v[142:145], v6, s[38:39] offset:-4096 sc1
    s_nop 0
    ds_write_b128 v20, v[242:245] offset:0
    global_load_dwordx4 v[146:149], v6, s[38:39] offset:-3072 sc1
    s_nop 0
    ds_write_b128 v21, v[246:249] offset:0
    global_load_dwordx4 v[150:153], v6, s[38:39] offset:-2048 sc1
    s_nop 0
    ds_write_b128 v22, v[250:253] offset:0
    global_load_dwordx4 v[154:157], v6, s[38:39] offset:-1024 sc1
    s_waitcnt lgkmcnt(0)
    s_barrier
    global_load_dwordx4 v[158:161], v6, s[38:39] offset:0 sc1
    ds_read_b128 v[242:245], v23 offset:0
    global_load_dwordx4 v[162:165], v6, s[38:39] offset:1024 sc1
    ds_read_b128 v[246:249], v23 offset:1024
    global_load_dwordx4 v[166:169], v6, s[38:39] offset:2048 sc1
    ds_read_b128 v[250:253], v23 offset:2048
    global_load_dwordx4 v[170:173], v6, s[38:39] offset:3072 sc1
    v_lshlrev_b32 v12, 16, v60
    v_and_b32 v13, 0xffff0000, v60
    global_load_dwordx4 v[174:177], v7, s[38:39] offset:-4096 sc1
    v_lshlrev_b32 v14, 16, v61
    global_load_dwordx4 v[178:181], v7, s[38:39] offset:-3072 sc1
    v_and_b32 v15, 0xffff0000, v61
    global_load_dwordx4 v[182:185], v7, s[38:39] offset:-2048 sc1
    s_waitcnt lgkmcnt(2)
    v_pk_add_f32 v[238:239], v[238:239], v[242:243] op_sel:[0,0] op_sel_hi:[1,1]
    global_load_dwordx4 v[186:189], v7, s[38:39] offset:-1024 sc1
    v_pk_add_f32 v[240:241], v[240:241], v[244:245] op_sel:[0,0] op_sel_hi:[1,1]
    s_waitcnt lgkmcnt(1)
    v_pk_add_f32 v[238:239], v[238:239], v[246:247] op_sel:[0,0] op_sel_hi:[1,1]
    global_load_dwordx4 v[190:193], v7, s[38:39] offset:0 sc1
    v_pk_add_f32 v[240:241], v[240:241], v[248:249] op_sel:[0,0] op_sel_hi:[1,1]
    global_load_dwordx4 v[194:197], v7, s[38:39] offset:1024 sc1
    s_waitcnt lgkmcnt(0)
    v_pk_add_f32 v[238:239], v[238:239], v[250:251] op_sel:[0,0] op_sel_hi:[1,1]
    global_load_dwordx4 v[198:201], v7, s[38:39] offset:2048 sc1
    v_pk_add_f32 v[240:241], v[240:241], v[252:253] op_sel:[0,0] op_sel_hi:[1,1]
    global_load_dwordx4 v[202:205], v7, s[38:39] offset:3072 sc1
    v_pk_mul_f32 v[238:239], v[238:239], v[12:13] op_sel:[0,0] op_sel_hi:[1,1]
    v_pk_mul_f32 v[240:241], v[240:241], v[14:15] op_sel:[0,0] op_sel_hi:[1,1]
    v_cvt_pk_bf16_f32 v60, v238, v239
    v_cvt_pk_bf16_f32 v61, v240, v241
    v_and_b32 v61, -2, v61
    global_store_dwordx4 v26, v[56:59], s[8:9] offset:-4096 sc1
    global_store_dwordx2 v27, v[60:61], s[10:11] offset:-4096 sc1
    v_add_u32 v30, 61440, v4
    v_add_u32 v31, 122880, v4
    s_waitcnt vmcnt(18)
    s_barrier
    ds_read_b128 v[82:85], v4 offset:0
    ds_read_b128 v[86:89], v4 offset:1024
    ds_read_b128 v[90:93], v4 offset:2048
    ds_read_b128 v[94:97], v4 offset:3072
    ds_read_b128 v[98:101], v4 offset:4096
    s_waitcnt vmcnt(16)
    v_or_b32 v28, v145, v149
    s_waitcnt vmcnt(14)
    v_or3_b32 v28, v153, v157, v28
    s_waitcnt vmcnt(12)
    v_or3_b32 v28, v161, v165, v28
    s_waitcnt vmcnt(10)
    v_or3_b32 v28, v169, v173, v28
    v_and_b32 v28, 1, v28
    v_cmp_ne_u32 vcc, 0, v28
    s_nop 0
    s_cbranch_vccnz Lp0_r
Lp0_ok:
    s_waitcnt lgkmcnt(4)
    v_mfma_f32_16x16x32_bf16 v[62:65], v[82:85], v[142:145], 0
    ds_read_b128 v[102:105], v4 offset:20480
    s_waitcnt lgkmcnt(4)
    v_mfma_f32_16x16x32_bf16 v[66:69], v[86:89], v[142:145], 0
    ds_read_b128 v[82:85], v4 offset:21504
    s_waitcnt lgkmcnt(4)
    v_mfma_f32_16x16x32_bf16 v[70:73], v[90:93], v[142:145], 0
    ds_read_b128 v[86:89], v4 offset:22528
    s_waitcnt lgkmcnt(4)
    v_mfma_f32_16x16x32_bf16 v[74:77], v[94:97], v[142:145], 0
    ds_read_b128 v[90:93], v4 offset:23552
    s_waitcnt lgkmcnt(4)
    v_mfma_f32_16x16x32_bf16 v[78:81], v[98:101], v[142:145], 0
    ds_read_b128 v[94:97], v4 offset:24576
    s_waitcnt lgkmcnt(4)
    v_mfma_f32_16x16x32_bf16 v[62:65], v[102:105], v[146:149], v[62:65]
    ds_read_b128 v[98:101], v4 offset:35840
    s_waitcnt lgkmcnt(4)
    v_mfma_f32_16x16x32_bf16 v[66:69], v[82:85], v[146:149], v[66:69]
    ds_read_b128 v[102:105], v4 offset:36864
    s_waitcnt lgkmcnt(4)
    v_mfma_f32_16x16x32_bf16 v[70:73], v[86:89], v[146:149], v[70:73]
    ds_read_b128 v[82:85], v4 offset:37888
    s_waitcnt lgkmcnt(4)
    v_mfma_f32_16x16x32_bf16 v[74:77], v[90:93], v[146:149], v[74:77]
    ds_read_b128 v[86:89], v4 offset:38912
    s_waitcnt lgkmcnt(4)
    v_mfma_f32_16x16x32_bf16 v[78:81], v[94:97], v[146:149], v[78:81]
    ds_read_b128 v[90:93], v4 offset:39936
    s_waitcnt lgkmcnt(4)
    v_mfma_f32_16x16x32_bf16 v[62:65], v[98:101], v[150:153], v[62:65]
    ds_read_b128 v[94:97], v4 offset:56320
    s_waitcnt lgkmcnt(4)
    v_mfma_f32_16x16x32_bf16 v[66:69], v[102:105], v[150:153], v[66:69]
    ds_read_b128 v[98:101], v4 offset:57344
    s_waitcnt lgkmcnt(4)
    v_mfma_f32_16x16x32_bf16 v[70:73], v[82:85], v[150:153], v[70:73]
    ds_read_b128 v[102:105], v4 offset:58368
    s_waitcnt lgkmcnt(4)
    v_mfma_f32_16x16x32_bf16 v[74:77], v[86:89], v[150:153], v[74:77]
    ds_read_b128 v[82:85], v4 offset:59392
    s_waitcnt lgkmcnt(4)
    v_mfma_f32_16x16x32_bf16 v[78:81], v[90:93], v[150:153], v[78:81]
    ds_read_b128 v[86:89], v4 offset:60416
    s_waitcnt lgkmcnt(4)
    v_mfma_f32_16x16x32_bf16 v[62:65], v[94:97], v[154:157], v[62:65]
    ds_read_b128 v[90:93], v30 offset:10240
    s_waitcnt lgkmcnt(4)
    v_mfma_f32_16x16x32_bf16 v[66:69], v[98:101], v[154:157], v[66:69]
    ds_read_b128 v[94:97], v30 offset:11264
    s_waitcnt lgkmcnt(4)
    v_mfma_f32_16x16x32_bf16 v[70:73], v[102:105], v[154:157], v[70:73]
    ds_read_b128 v[98:101], v30 offset:12288
    s_waitcnt lgkmcnt(4)
    v_mfma_f32_16x16x32_bf16 v[74:77], v[82:85], v[154:157], v[74:77]
    ds_read_b128 v[102:105], v30 offset:13312
    s_waitcnt lgkmcnt(4)
    v_mfma_f32_16x16x32_bf16 v[78:81], v[86:89], v[154:157], v[78:81]
    ds_read_b128 v[82:85], v30 offset:14336
    s_waitcnt lgkmcnt(4)
    v_mfma_f32_16x16x32_bf16 v[62:65], v[90:93], v[158:161], v[62:65]
    ds_read_b128 v[86:89], v30 offset:30720
    s_waitcnt lgkmcnt(4)
    v_mfma_f32_16x16x32_bf16 v[66:69], v[94:97], v[158:161], v[66:69]
    ds_read_b128 v[90:93], v30 offset:31744
    s_waitcnt lgkmcnt(4)
    v_mfma_f32_16x16x32_bf16 v[70:73], v[98:101], v[158:161], v[70:73]
    ds_read_b128 v[94:97], v30 offset:32768
    s_waitcnt lgkmcnt(4)
    v_mfma_f32_16x16x32_bf16 v[74:77], v[102:105], v[158:161], v[74:77]
    ds_read_b128 v[98:101], v30 offset:33792
    s_waitcnt lgkmcnt(4)
    v_mfma_f32_16x16x32_bf16 v[78:81], v[82:85], v[158:161], v[78:81]
    ds_read_b128 v[102:105], v30 offset:34816
    s_waitcnt lgkmcnt(4)
    v_mfma_f32_16x16x32_bf16 v[62:65], v[86:89], v[162:165], v[62:65]
    ds_read_b128 v[82:85], v30 offset:46080
    s_waitcnt lgkmcnt(4)
    v_mfma_f32_16x16x32_bf16 v[66:69], v[90:93], v[162:165], v[66:69]
    ds_read_b128 v[86:89], v30 offset:47104
    s_waitcnt lgkmcnt(4)
    v_mfma_f32_16x16x32_bf16 v[70:73], v[94:97], v[162:165], v[70:73]
    ds_read_b128 v[90:93], v30 offset:48128
    s_waitcnt lgkmcnt(4)
    v_mfma_f32_16x16x32_bf16 v[74:77], v[98:101], v[162:165], v[74:77]
    ds_read_b128 v[94:97], v30 offset:49152
    s_waitcnt lgkmcnt(4)
    v_mfma_f32_16x16x32_bf16 v[78:81], v[102:105], v[162:165], v[78:81]
    ds_read_b128 v[98:101], v30 offset:50176
    s_waitcnt lgkmcnt(4)
    v_mfma_f32_16x16x32_bf16 v[62:65], v[82:85], v[166:169], v[62:65]
    ds_read_b128 v[102:105], v31 offset:5120
    s_waitcnt lgkmcnt(4)
    v_mfma_f32_16x16x32_bf16 v[66:69], v[86:89], v[166:169], v[66:69]
    ds_read_b128 v[82:85], v31 offset:6144
    s_waitcnt lgkmcnt(4)
    v_mfma_f32_16x16x32_bf16 v[70:73], v[90:93], v[166:169], v[70:73]
    ds_read_b128 v[86:89], v31 offset:7168
    s_waitcnt lgkmcnt(4)
    v_mfma_f32_16x16x32_bf16 v[74:77], v[94:97], v[166:169], v[74:77]
    ds_read_b128 v[90:93], v31 offset:8192
    s_waitcnt lgkmcnt(4)
    v_mfma_f32_16x16x32_bf16 v[78:81], v[98:101], v[166:169], v[78:81]
    ds_read_b128 v[94:97], v31 offset:9216
    s_waitcnt lgkmcnt(4)
    v_mfma_f32_16x16x32_bf16 v[62:65], v[102:105], v[170:173], v[62:65]
    ds_read_b128 v[98:101], v4 offset:5120
    s_waitcnt lgkmcnt(4)
    v_mfma_f32_16x16x32_bf16 v[66:69], v[82:85], v[170:173], v[66:69]
    ds_read_b128 v[102:105], v4 offset:6144
    s_waitcnt lgkmcnt(4)
    v_mfma_f32_16x16x32_bf16 v[70:73], v[86:89], v[170:173], v[70:73]
    ds_read_b128 v[82:85], v4 offset:7168
    s_waitcnt lgkmcnt(4)
    v_mfma_f32_16x16x32_bf16 v[74:77], v[90:93], v[170:173], v[74:77]
    ds_read_b128 v[86:89], v4 offset:8192
    s_waitcnt lgkmcnt(4)
    v_mfma_f32_16x16x32_bf16 v[78:81], v[94:97], v[170:173], v[78:81]
    ds_read_b128 v[90:93], v4 offset:9216
    s_waitcnt vmcnt(8)
    v_or_b32 v28, v177, v181
    s_waitcnt vmcnt(6)
    v_or3_b32 v28, v185, v189, v28
    s_waitcnt vmcnt(4)
    v_or3_b32 v28, v193, v197, v28
    s_waitcnt vmcnt(2)
    v_or3_b32 v28, v201, v205, v28
    v_and_b32 v28, 1, v28
    v_cmp_ne_u32 vcc, 0, v28
    s_nop 0
    s_cbranch_vccnz Lp1_r
Lp1_ok:
    s_waitcnt lgkmcnt(4)
    v_mfma_f32_16x16x32_bf16 v[62:65], v[98:101], v[174:177], v[62:65]
    ds_read_b128 v[94:97], v4 offset:25600
    s_waitcnt lgkmcnt(4)
    v_mfma_f32_16x16x32_bf16 v[66:69], v[102:105], v[174:177], v[66:69]
    ds_read_b128 v[98:101], v4 offset:26624
    s_waitcnt lgkmcnt(4)
    v_mfma_f32_16x16x32_bf16 v[70:73], v[82:85], v[174:177], v[70:73]
    ds_read_b128 v[102:105], v4 offset:27648
    s_waitcnt lgkmcnt(4)
    v_mfma_f32_16x16x32_bf16 v[74:77], v[86:89], v[174:177], v[74:77]
    ds_read_b128 v[82:85], v4 offset:28672
    s_waitcnt lgkmcnt(4)
    v_mfma_f32_16x16x32_bf16 v[78:81], v[90:93], v[174:177], v[78:81]
    ds_read_b128 v[86:89], v4 offset:29696
    s_waitcnt lgkmcnt(4)
    v_mfma_f32_16x16x32_bf16 v[62:65], v[94:97], v[178:181], v[62:65]
    ds_read_b128 v[90:93], v4 offset:40960
    s_waitcnt lgkmcnt(4)
    v_mfma_f32_16x16x32_bf16 v[66:69], v[98:101], v[178:181], v[66:69]
    ds_read_b128 v[94:97], v4 offset:41984
    s_waitcnt lgkmcnt(4)
    v_mfma_f32_16x16x32_bf16 v[70:73], v[102:105], v[178:181], v[70:73]
    ds_read_b128 v[98:101], v4 offset:43008
    s_waitcnt lgkmcnt(4)
    v_mfma_f32_16x16x32_bf16 v[74:77], v[82:85], v[178:181], v[74:77]
    ds_read_b128 v[102:105], v4 offset:44032
    s_waitcnt lgkmcnt(4)
    v_mfma_f32_16x16x32_bf16 v[78:81], v[86:89], v[178:181], v[78:81]
    ds_read_b128 v[82:85], v4 offset:45056
    s_waitcnt lgkmcnt(4)
    v_mfma_f32_16x16x32_bf16 v[62:65], v[90:93], v[182:185], v[62:65]
    ds_read_b128 v[86:89], v30 offset:0
    global_load_dwordx4 v[206:209], v26, s[38:39] offset:-4096 sc1
    s_waitcnt lgkmcnt(4)
    v_mfma_f32_16x16x32_bf16 v[66:69], v[94:97], v[182:185], v[66:69]
    ds_read_b128 v[90:93], v30 offset:1024
    s_waitcnt lgkmcnt(4)
    v_mfma_f32_16x16x32_bf16 v[70:73], v[98:101], v[182:185], v[70:73]
    ds_read_b128 v[94:97], v30 offset:2048
    global_load_dwordx4 v[210:213], v26, s[38:39] offset:-3072 sc1
    s_waitcnt lgkmcnt(4)
    v_mfma_f32_16x16x32_bf16 v[74:77], v[102:105], v[182:185], v[74:77]
    ds_read_b128 v[98:101], v30 offset:3072
    s_waitcnt lgkmcnt(4)
    v_mfma_f32_16x16x32_bf16 v[78:81], v[82:85], v[182:185], v[78:81]
    ds_read_b128 v[102:105], v30 offset:4096
    s_waitcnt lgkmcnt(4)
    v_mfma_f32_16x16x32_bf16 v[62:65], v[86:89], v[186:189], v[62:65]
    ds_read_b128 v[82:85], v30 offset:15360
    global_load_dwordx4 v[214:217], v26, s[38:39] offset:-2048 sc1
    s_waitcnt lgkmcnt(4)
    v_mfma_f32_16x16x32_bf16 v[66:69], v[90:93], v[186:189], v[66:69]
    ds_read_b128 v[86:89], v30 offset:16384
    s_waitcnt lgkmcnt(4)
    v_mfma_f32_16x16x32_bf16 v[70:73], v[94:97], v[186:189], v[70:73]
    ds_read_b128 v[90:93], v30 offset:17408
    s_waitcnt lgkmcnt(4)
    v_mfma_f32_16x16x32_bf16 v[74:77], v[98:101], v[186:189], v[74:77]
    ds_read_b128 v[94:97], v30 offset:18432
    global_load_dwordx4 v[218:221], v26, s[38:39] offset:-1024 sc1
    s_waitcnt lgkmcnt(4)
    v_mfma_f32_16x16x32_bf16 v[78:81], v[102:105], v[186:189], v[78:81]
    ds_read_b128 v[98:101], v30 offset:19456
    s_waitcnt lgkmcnt(4)
    v_mfma_f32_16x16x32_bf16 v[62:65], v[82:85], v[190:193], v[62:65]
    ds_read_b128 v[102:105], v30 offset:35840
    global_load_dwordx4 v[222:225], v26, s[38:39] offset:0 sc1
    s_waitcnt lgkmcnt(4)
    v_mfma_f32_16x16x32_bf16 v[66:69], v[86:89], v[190:193], v[66:69]
    ds_read_b128 v[82:85], v30 offset:36864
    s_waitcnt lgkmcnt(4)
    v_mfma_f32_16x16x32_bf16 v[70:73], v[90:93], v[190:193], v[70:73]
    ds_read_b128 v[86:89], v30 offset:37888
    s_waitcnt lgkmcnt(4)
    v_mfma_f32_16x16x32_bf16 v[74:77], v[94:97], v[190:193], v[74:77]
    ds_read_b128 v[90:93], v30 offset:38912
    global_load_dwordx4 v[226:229], v26, s[38:39] offset:1024 sc1
    s_waitcnt lgkmcnt(4)
    v_mfma_f32_16x16x32_bf16 v[78:81], v[98:101], v[190:193], v[78:81]
    ds_read_b128 v[94:97], v30 offset:39936
    s_waitcnt lgkmcnt(4)
    v_mfma_f32_16x16x32_bf16 v[62:65], v[102:105], v[194:197], v[62:65]
    ds_read_b128 v[98:101], v30 offset:51200
    s_waitcnt lgkmcnt(4)
    v_mfma_f32_16x16x32_bf16 v[66:69], v[82:85], v[194:197], v[66:69]
    ds_read_b128 v[102:105], v30 offset:52224
    global_load_dwordx4 v[230:233], v26, s[38:39] offset:2048 sc1
    s_waitcnt lgkmcnt(4)
    v_mfma_f32_16x16x32_bf16 v[70:73], v[86:89], v[194:197], v[70:73]
    ds_read_b128 v[82:85], v30 offset:53248
    s_waitcnt lgkmcnt(4)
    v_mfma_f32_16x16x32_bf16 v[74:77], v[90:93], v[194:197], v[74:77]
    ds_read_b128 v[86:89], v30 offset:54272
    s_waitcnt lgkmcnt(4)
    v_mfma_f32_16x16x32_bf16 v[78:81], v[94:97], v[194:197], v[78:81]
    ds_read_b128 v[90:93], v30 offset:55296
    global_load_dwordx4 v[238:241], v27, s[38:39] offset:-4096 sc1
    s_waitcnt lgkmcnt(4)
    v_mfma_f32_16x16x32_bf16 v[62:65], v[98:101], v[198:201], v[62:65]
    ds_read_b128 v[94:97], v31 offset:10240
    s_waitcnt lgkmcnt(4)
    v_mfma_f32_16x16x32_bf16 v[66:69], v[102:105], v[198:201], v[66:69]
    ds_read_b128 v[98:101], v31 offset:11264
    global_load_dwordx4 v[242:245], v27, s[38:39] offset:-3072 sc1
    s_waitcnt lgkmcnt(4)
    v_mfma_f32_16x16x32_bf16 v[70:73], v[82:85], v[198:201], v[70:73]
    ds_read_b128 v[102:105], v31 offset:12288
    s_waitcnt lgkmcnt(4)
    v_mfma_f32_16x16x32_bf16 v[74:77], v[86:89], v[198:201], v[74:77]
    ds_read_b128 v[82:85], v31 offset:13312
    s_waitcnt lgkmcnt(4)
    v_mfma_f32_16x16x32_bf16 v[78:81], v[90:93], v[198:201], v[78:81]
    ds_read_b128 v[86:89], v31 offset:14336
    global_load_dwordx4 v[246:249], v27, s[38:39] offset:-2048 sc1
    s_waitcnt lgkmcnt(4)
    v_mfma_f32_16x16x32_bf16 v[62:65], v[94:97], v[202:205], v[62:65]
    ds_read_b128 v[90:93], v4 offset:10240
    s_waitcnt lgkmcnt(4)
    v_mfma_f32_16x16x32_bf16 v[66:69], v[98:101], v[202:205], v[66:69]
    ds_read_b128 v[94:97], v4 offset:11264
    s_waitcnt lgkmcnt(4)
    v_mfma_f32_16x16x32_bf16 v[70:73], v[102:105], v[202:205], v[70:73]
    ds_read_b128 v[98:101], v4 offset:12288
    global_load_dwordx4 v[250:253], v27, s[38:39] offset:-1024 sc1
    s_waitcnt lgkmcnt(4)
    v_mfma_f32_16x16x32_bf16 v[74:77], v[82:85], v[202:205], v[74:77]
    ds_read_b128 v[102:105], v4 offset:13312
    s_waitcnt lgkmcnt(4)
    v_mfma_f32_16x16x32_bf16 v[78:81], v[86:89], v[202:205], v[78:81]
    ds_read_b128 v[82:85], v4 offset:14336
    v_lshlrev_b32 v29, 5, v3
    v_add_u32 v29, 162816, v29
    ds_read_b128 v[106:109], v29 offset:0
    ds_read_b128 v[110:113], v29 offset:16
    ds_read_b128 v[114:117], v29 offset:128
    ds_read_b128 v[118:121], v29 offset:144
    v_lshlrev_b32 v29, 4, v3
    v_add_u32 v29, 162816, v29
    ds_read_b128 v[122:125], v29 offset:256
    v_lshlrev_b32 v126, 16, v36
    v_and_b32 v127, 0xffff0000, v36
    v_lshlrev_b32 v128, 16, v37
    v_and_b32 v129, 0xffff0000, v37
    v_lshlrev_b32 v130, 16, v38
    v_and_b32 v131, 0xffff0000, v38
    v_lshlrev_b32 v132, 16, v39
    v_and_b32 v133, 0xffff0000, v39
    v_lshlrev_b32 v134, 16, v40
    v_and_b32 v135, 0xffff0000, v40
    v_lshlrev_b32 v136, 16, v41
    v_and_b32 v137, 0xffff0000, v41
    v_lshlrev_b32 v138, 16, v42
    v_and_b32 v139, 0xffff0000, v42
    v_lshlrev_b32 v140, 16, v43
    v_and_b32 v141, 0xffff0000, v43
    v_lshlrev_b32 v12, 16, v44
    v_and_b32 v13, 0xffff0000, v44
    v_lshlrev_b32 v14, 16, v45
    v_and_b32 v15, 0xffff0000, v45
    v_add_u32 v46, s90, v5
    v_mul_u32_u24 v46, 1280, v46
    s_mul_i32 s4, s41, 160
    v_add_u32 v46, s4, v46
    v_lshl_add_u32 v47, v3, 4, v46
    v_lshl_add_u32 v46, v3, 3, v46
    s_waitcnt vmcnt(8)
    v_or3_b32 v28, v209, v213, v217
    s_waitcnt vmcnt(6)
    v_or3_b32 v28, v221, v225, v28
    s_waitcnt vmcnt(4)
    v_or3_b32 v28, v229, v233, v28
    v_and_b32 v28, 1, v28
    v_cmp_ne_u32 vcc, 0, v28
    s_nop 0
    s_cbranch_vccnz Lp2_r
Lp2_ok:
    s_waitcnt lgkmcnt(9)
    v_mfma_f32_16x16x32_bf16 v[62:65], v[90:93], v[206:209], v[62:65]
    ds_read_b128 v[86:89], v4 offset:30720
    s_waitcnt lgkmcnt(9)
    v_mfma_f32_16x16x32_bf16 v[66:69], v[94:97], v[206:209], v[66:69]
    ds_read_b128 v[90:93], v4 offset:31744
    s_waitcnt lgkmcnt(9)
    v_mfma_f32_16x16x32_bf16 v[70:73], v[98:101], v[206:209], v[70:73]
    ds_read_b128 v[94:97], v4 offset:32768
    s_waitcnt lgkmcnt(9)
    v_mfma_f32_16x16x32_bf16 v[74:77], v[102:105], v[206:209], v[74:77]
    ds_read_b128 v[98:101], v4 offset:33792
    s_waitcnt lgkmcnt(9)
    v_mfma_f32_16x16x32_bf16 v[78:81], v[82:85], v[206:209], v[78:81]
    ds_read_b128 v[102:105], v4 offset:34816
    s_waitcnt lgkmcnt(4)
    v_mfma_f32_16x16x32_bf16 v[62:65], v[86:89], v[210:213], v[62:65]
    ds_read_b128 v[82:85], v4 offset:46080
    s_waitcnt lgkmcnt(4)
    v_mfma_f32_16x16x32_bf16 v[66:69], v[90:93], v[210:213], v[66:69]
    ds_read_b128 v[86:89], v4 offset:47104
    s_waitcnt lgkmcnt(4)
    v_mfma_f32_16x16x32_bf16 v[70:73], v[94:97], v[210:213], v[70:73]
    ds_read_b128 v[90:93], v4 offset:48128
    s_waitcnt lgkmcnt(4)
    v_mfma_f32_16x16x32_bf16 v[74:77], v[98:101], v[210:213], v[74:77]
    ds_read_b128 v[94:97], v4 offset:49152
    s_waitcnt lgkmcnt(4)
    v_mfma_f32_16x16x32_bf16 v[78:81], v[102:105], v[210:213], v[78:81]
    ds_read_b128 v[98:101], v4 offset:50176
    s_waitcnt lgkmcnt(4)
    v_mfma_f32_16x16x32_bf16 v[62:65], v[82:85], v[214:217], v[62:65]
    ds_read_b128 v[102:105], v30 offset:5120
    s_waitcnt lgkmcnt(4)
    v_mfma_f32_16x16x32_bf16 v[66:69], v[86:89], v[214:217], v[66:69]
    ds_read_b128 v[82:85], v30 offset:6144
    s_waitcnt lgkmcnt(4)
    v_mfma_f32_16x16x32_bf16 v[70:73], v[90:93], v[214:217], v[70:73]
    ds_read_b128 v[86:89], v30 offset:7168
    s_waitcnt lgkmcnt(4)
    v_mfma_f32_16x16x32_bf16 v[74:77], v[94:97], v[214:217], v[74:77]
    ds_read_b128 v[90:93], v30 offset:8192
    s_waitcnt lgkmcnt(4)
    v_mfma_f32_16x16x32_bf16 v[78:81], v[98:101], v[214:217], v[78:81]
    ds_read_b128 v[94:97], v30 offset:9216
    s_waitcnt lgkmcnt(4)
    v_mfma_f32_16x16x32_bf16 v[62:65], v[102:105], v[218:221], v[62:65]
    ds_read_b128 v[98:101], v30 offset:20480
    s_waitcnt lgkmcnt(4)
    v_mfma_f32_16x16x32_bf16 v[66:69], v[82:85], v[218:221], v[66:69]
    ds_read_b128 v[102:105], v30 offset:21504
    s_waitcnt lgkmcnt(4)
    v_mfma_f32_16x16x32_bf16 v[70:73], v[86:89], v[218:221], v[70:73]
    ds_read_b128 v[82:85], v30 offset:22528
    s_waitcnt lgkmcnt(4)
    v_mfma_f32_16x16x32_bf16 v[74:77], v[90:93], v[218:221], v[74:77]
    ds_read_b128 v[86:89], v30 offset:23552
    s_waitcnt lgkmcnt(4)
    v_mfma_f32_16x16x32_bf16 v[78:81], v[94:97], v[218:221], v[78:81]
    ds_read_b128 v[90:93], v30 offset:24576
    s_waitcnt lgkmcnt(4)
    v_mfma_f32_16x16x32_bf16 v[62:65], v[98:101], v[222:225], v[62:65]
    ds_read_b128 v[94:97], v30 offset:40960
    s_waitcnt lgkmcnt(4)
    v_mfma_f32_16x16x32_bf16 v[66:69], v[102:105], v[222:225], v[66:69]
    ds_read_b128 v[98:101], v30 offset:41984
    s_waitcnt lgkmcnt(4)
    v_mfma_f32_16x16x32_bf16 v[70:73], v[82:85], v[222:225], v[70:73]
    ds_read_b128 v[102:105], v30 offset:43008
    s_waitcnt lgkmcnt(4)
    v_mfma_f32_16x16x32_bf16 v[74:77], v[86:89], v[222:225], v[74:77]
    ds_read_b128 v[82:85], v30 offset:44032
    s_waitcnt lgkmcnt(4)
    v_mfma_f32_16x16x32_bf16 v[78:81], v[90:93], v[222:225], v[78:81]
    ds_read_b128 v[86:89], v30 offset:45056
    s_waitcnt lgkmcnt(4)
    v_mfma_f32_16x16x32_bf16 v[62:65], v[94:97], v[226:229], v[62:65]
    ds_read_b128 v[90:93], v30 offset:56320
    s_waitcnt lgkmcnt(4)
    v_mfma_f32_16x16x32_bf16 v[66:69], v[98:101], v[226:229], v[66:69]
    ds_read_b128 v[94:97], v30 offset:57344
    s_waitcnt lgkmcnt(4)
    v_mfma_f32_16x16x32_bf16 v[70:73], v[102:105], v[226:229], v[70:73]
    ds_read_b128 v[98:101], v30 offset:58368
    s_waitcnt lgkmcnt(4)
    v_mfma_f32_16x16x32_bf16 v[74:77], v[82:85], v[226:229], v[74:77]
    ds_read_b128 v[102:105], v30 offset:59392
    s_waitcnt lgkmcnt(4)
    v_mfma_f32_16x16x32_bf16 v[78:81], v[86:89], v[226:229], v[78:81]
    ds_read_b128 v[82:85], v30 offset:60416
    s_waitcnt lgkmcnt(4)
    v_mfma_f32_16x16x32_bf16 v[62:65], v[90:93], v[230:233], v[62:65]
    ds_read_b128 v[86:89], v4 offset:15360
    s_waitcnt lgkmcnt(4)
    v_mfma_f32_16x16x32_bf16 v[66:69], v[94:97], v[230:233], v[66:69]
    ds_read_b128 v[90:93], v4 offset:16384
    s_waitcnt lgkmcnt(4)
    v_mfma_f32_16x16x32_bf16 v[70:73], v[98:101], v[230:233], v[70:73]
    ds_read_b128 v[94:97], v4 offset:17408
    s_waitcnt lgkmcnt(4)
    v_mfma_f32_16x16x32_bf16 v[74:77], v[102:105], v[230:233], v[74:77]
    ds_read_b128 v[98:101], v4 offset:18432
    s_waitcnt lgkmcnt(4)
    v_mfma_f32_16x16x32_bf16 v[78:81], v[82:85], v[230:233], v[78:81]
    ds_read_b128 v[102:105], v4 offset:19456
    s_waitcnt vmcnt(3)
    v_or_b32 v28, v239, v241
    s_waitcnt vmcnt(2)
    v_or3_b32 v28, v243, v245, v28
    s_waitcnt vmcnt(1)
    v_or3_b32 v28, v247, v249, v28
    s_waitcnt vmcnt(0)
    v_or3_b32 v28, v251, v253, v28
    v_and_b32 v28, 1, v28
    v_cmp_ne_u32 vcc, 0, v28
    s_nop 0
    s_cbranch_vccnz Lp3_r
Lp3_ok:
    s_waitcnt lgkmcnt(4)
    v_mfma_f32_16x16x32_bf16 v[62:65], v[86:89], v[238:241], v[62:65]
    ds_read_b128 v[82:85], v4 offset:51200
    s_waitcnt lgkmcnt(4)
    v_mfma_f32_16x16x32_bf16 v[66:69], v[90:93], v[238:241], v[66:69]
    ds_read_b128 v[86:89], v4 offset:52224
    s_waitcnt lgkmcnt(4)
    v_mfma_f32_16x16x32_bf16 v[70:73], v[94:97], v[238:241], v[70:73]
    ds_read_b128 v[90:93], v4 offset:53248
    s_waitcnt lgkmcnt(4)
    v_mfma_f32_16x16x32_bf16 v[74:77], v[98:101], v[238:241], v[74:77]
    ds_read_b128 v[94:97], v4 offset:54272
    s_waitcnt lgkmcnt(4)
    v_mfma_f32_16x16x32_bf16 v[78:81], v[102:105], v[238:241], v[78:81]
    ds_read_b128 v[98:101], v4 offset:55296
    s_waitcnt lgkmcnt(4)
    v_mfma_f32_16x16x32_bf16 v[62:65], v[82:85], v[242:245], v[62:65]
    ds_read_b128 v[102:105], v30 offset:25600
    s_waitcnt lgkmcnt(4)
    v_mfma_f32_16x16x32_bf16 v[66:69], v[86:89], v[242:245], v[66:69]
    ds_read_b128 v[82:85], v30 offset:26624
    s_waitcnt lgkmcnt(4)
    v_mfma_f32_16x16x32_bf16 v[70:73], v[90:93], v[242:245], v[70:73]
    ds_read_b128 v[86:89], v30 offset:27648
    s_waitcnt lgkmcnt(4)
    v_mfma_f32_16x16x32_bf16 v[74:77], v[94:97], v[242:245], v[74:77]
    ds_read_b128 v[90:93], v30 offset:28672
    s_waitcnt lgkmcnt(4)
    v_mfma_f32_16x16x32_bf16 v[78:81], v[98:101], v[242:245], v[78:81]
    ds_read_b128 v[94:97], v30 offset:29696
    s_waitcnt lgkmcnt(4)
    v_mfma_f32_16x16x32_bf16 v[62:65], v[102:105], v[246:249], v[62:65]
    ds_read_b128 v[98:101], v31 offset:0
    s_waitcnt lgkmcnt(4)
    v_mfma_f32_16x16x32_bf16 v[66:69], v[82:85], v[246:249], v[66:69]
    ds_read_b128 v[102:105], v31 offset:1024
    s_waitcnt lgkmcnt(4)
    v_mfma_f32_16x16x32_bf16 v[70:73], v[86:89], v[246:249], v[70:73]
    ds_read_b128 v[82:85], v31 offset:2048
    s_waitcnt lgkmcnt(4)
    v_mfma_f32_16x16x32_bf16 v[74:77], v[90:93], v[246:249], v[74:77]
    ds_read_b128 v[86:89], v31 offset:3072
    s_waitcnt lgkmcnt(4)
    v_mfma_f32_16x16x32_bf16 v[78:81], v[94:97], v[246:249], v[78:81]
    ds_read_b128 v[90:93], v31 offset:4096
    s_waitcnt lgkmcnt(4)
    v_mfma_f32_16x16x32_bf16 v[62:65], v[98:101], v[250:253], v[62:65]
    s_waitcnt lgkmcnt(3)
    v_mfma_f32_16x16x32_bf16 v[66:69], v[102:105], v[250:253], v[66:69]
    s_waitcnt lgkmcnt(2)
    v_mfma_f32_16x16x32_bf16 v[70:73], v[82:85], v[250:253], v[70:73]
    s_waitcnt lgkmcnt(1)
    v_mfma_f32_16x16x32_bf16 v[74:77], v[86:89], v[250:253], v[74:77]
    s_waitcnt lgkmcnt(0)
    v_mfma_f32_16x16x32_bf16 v[78:81], v[90:93], v[250:253], v[78:81]
    v_fmac_f32 v126, v62, v106
    s_nop 0
    v_fmac_f32 v127, v66, v107
    v_fmac_f32 v128, v63, v108
    v_fmac_f32 v129, v67, v109
    v_fmac_f32 v130, v64, v110
    v_fmac_f32 v131, v68, v111
    v_fmac_f32 v132, v65, v112
    v_fmac_f32 v133, v69, v113
    v_cvt_pk_bf16_f32 v142, v126, v127
    v_cvt_pk_bf16_f32 v143, v128, v129
    v_cvt_pk_bf16_f32 v144, v130, v131
    v_cvt_pk_bf16_f32 v145, v132, v133
    global_store_dwordx4 v47, v[142:145], s[34:35] offset:0
    v_fmac_f32 v134, v70, v114
    v_fmac_f32 v135, v74, v115
    v_fmac_f32 v136, v71, v116
    v_fmac_f32 v137, v75, v117
    v_fmac_f32 v138, v72, v118
    v_fmac_f32 v139, v76, v119
    v_fmac_f32 v140, v73, v120
    v_fmac_f32 v141, v77, v121
    v_cvt_pk_bf16_f32 v146, v134, v135
    v_cvt_pk_bf16_f32 v147, v136, v137
    v_cvt_pk_bf16_f32 v148, v138, v139
    v_cvt_pk_bf16_f32 v149, v140, v141
    global_store_dwordx4 v47, v[146:149], s[34:35] offset:64
    v_fmac_f32 v12, v78, v122
    v_fmac_f32 v13, v79, v123
    v_fmac_f32 v14, v80, v124
    v_fmac_f32 v15, v81, v125
    v_cvt_pk_bf16_f32 v150, v12, v13
    v_cvt_pk_bf16_f32 v151, v14, v15
    global_store_dwordx2 v46, v[150:151], s[34:35] offset:128
Lflush:
Lend:
    s_endpgm
Lic_r:
    s_branch Lic_p_f
Lic_p:
    s_sleep 4
Lic_p_f:
    global_load_ushort v213, v212, s[36:37] sc1
    s_waitcnt vmcnt(0)
    v_cmp_eq_u32 vcc, 0, v213
    s_add_u32 s100, s100, 1
    s_cmp_ge_u32 s100, 262144
    s_cbranch_scc1 Lic_p_x
    s_cbranch_vccnz Lic_p
Lic_p_x:
    s_branch Lic_ok
Lic2_r:
    s_branch Lic2_p_f
Lic2_p:
    s_sleep 4
Lic2_p_f:
    global_load_ushort v42, v41, s[36:37] sc1
    s_waitcnt vmcnt(0)
    v_cmp_eq_u32 vcc, 0, v42
    s_add_u32 s100, s100, 1
    s_cmp_ge_u32 s100, 262144
    s_cbranch_scc1 Lic2_p_x
    s_cbranch_vccnz Lic2_p
Lic2_p_x:
    s_branch Lic2_ok
Lkf_r:
    s_nop 7
Lkf_p:
    global_load_dword v137, v136, s[38:39] sc1
    s_waitcnt vmcnt(0)
    v_cmp_eq_u32 vcc, -1, v137
    s_add_u32 s100, s100, 1
    s_cmp_ge_u32 s100, 262144
    s_cbranch_scc1 Lkf_p_x
    s_cbranch_vccnz Lkf_p
Lkf_p_x:
    s_nop 1
    s_branch Lkf_ok
Lcu_r:
    s_nop 7
Lcu_p:
    global_load_dwordx4 v[218:221], v223, s[38:39] sc1
    s_waitcnt vmcnt(0)
    v_max_u32 v224, v218, v219
    v_max3_u32 v224, v220, v221, v224
    v_cmp_eq_u32 vcc, -1, v224
    s_add_u32 s100, s100, 1
    s_cmp_ge_u32 s100, 262144
    s_cbranch_scc1 Lcu_p_x
    s_cbranch_vccnz Lcu_p
Lcu_p_x:
    s_nop 1
    s_branch Lcu_ok
Lax_r:
    s_nop 7
Lax_p:
    v_lshlrev_b32 v28, 4, v0
    v_add_u32 v28, 36864, v28
    global_load_dwordx4 v[202:205], v28, s[38:39] offset:-4096 sc1
    global_load_dwordx4 v[206:209], v28, s[38:39] offset:0 sc1
    v_add_u32 v28, 8192, v28
    global_load_dwordx4 v[210:213], v28, s[38:39] offset:-4096 sc1
    global_load_dwordx4 v[214:217], v28, s[38:39] offset:0 sc1
    v_min_u32 v28, 11, v1
    v_lshrrev_b32 v29, 2, v28
    v_mul_u32_u24 v29, 2544, v29
    v_lshl_add_u32 v28, v28, 2, v29
    s_lshl_b32 s4, s42, 4
    s_add_u32 s4, s4, 0
    v_add_u32 v28, s4, v28
    global_load_dword v182, v28, s[38:39] sc1
    v_add_u32 v28, 15360, v28
    global_load_dword v183, v28, s[38:39] sc1
    s_waitcnt vmcnt(0)
    v_max_u32 v224, v203, v205
    v_max3_u32 v224, v207, v209, v224
    v_max3_u32 v224, v211, v213, v224
    v_max3_u32 v224, v215, v217, v224
    v_max3_u32 v224, v182, v183, v224
    v_cmp_eq_u32 vcc, -1, v224
    s_add_u32 s100, s100, 1
    s_cmp_ge_u32 s100, 262144
    s_cbranch_scc1 Lax_p_x
    s_cbranch_vccnz Lax_p
Lax_p_x:
    s_nop 1
    s_branch Lax_ok
Lgb_r:
    s_nop 7
Lgb_p:
    v_min_u32 v175, 26, v1
    v_lshlrev_b32 v175, 7, v175
    v_add_u32 v175, 180224, v175
    global_load_dword v250, v175, s[38:39] sc1
    s_mul_i32 s7, s41, 320
    s_add_u32 s7, s7, 12800
    v_min_u32 v175, 304, v4
    v_add_u32 v175, s7, v175
    global_load_dwordx4 v[242:245], v175, s[38:39] sc1
    v_add_u32 v175, 15360, v175
    global_load_dwordx4 v[246:249], v175, s[38:39] sc1
    s_waitcnt vmcnt(0)
    v_max3_u32 v28, v242, v243, v244
    v_max3_u32 v28, v245, v246, v28
    v_max3_u32 v28, v247, v248, v28
    v_max3_u32 v28, v249, v250, v28
    v_cmp_eq_u32 vcc, -1, v28
    s_add_u32 s100, s100, 1
    s_cmp_ge_u32 s100, 262144
    s_cbranch_scc1 Lgb_p_x
    s_cbranch_vccnz Lgb_p
Lgb_p_x:
    s_nop 1
    s_branch Lgb_ok
Ls3_r:
    s_nop 7
Ls3_p:
    global_load_dwordx2 v[130:131], v174, s[38:39] offset:0 sc1
    global_load_dwordx2 v[132:133], v174, s[38:39] offset:512 sc1
    global_load_dwordx2 v[134:135], v174, s[38:39] offset:1024 sc1
    global_load_dwordx2 v[136:137], v174, s[38:39] offset:1536 sc1
    global_load_dwordx2 v[138:139], v174, s[38:39] offset:2048 sc1
    global_load_dwordx2 v[140:141], v174, s[38:39] offset:2560 sc1
    global_load_dwordx2 v[142:143], v174, s[38:39] offset:3072 sc1
    global_load_dwordx2 v[144:145], v174, s[38:39] offset:3584 sc1
    s_waitcnt vmcnt(0)
    v_max_u32 v28, v131, v133
    v_max3_u32 v28, v135, v137, v28
    v_max3_u32 v28, v139, v141, v28
    v_max3_u32 v28, v143, v145, v28
    v_cmp_eq_u32 vcc, -1, v28
    s_add_u32 s100, s100, 1
    s_cmp_ge_u32 s100, 262144
    s_cbranch_scc1 Ls3_p_x
    s_cbranch_vccnz Ls3_p
Ls3_p_x:
    s_nop 1
    s_branch Ls3_ok
Lz0_r:
    s_nop 7
Lz0_p:
    global_load_dword v46, v29, s[56:57] offset:1020 sc1
    global_load_dwordx4 v[62:65], v30, s[56:57] offset:-3072 sc1
    global_load_dwordx4 v[66:69], v30, s[56:57] offset:-2048 sc1
    global_load_dwordx4 v[70:73], v30, s[56:57] offset:-1024 sc1
    global_load_dwordx4 v[74:77], v30, s[56:57] offset:0 sc1
    global_load_dwordx4 v[78:81], v30, s[56:57] offset:1024 sc1
    global_load_dwordx4 v[82:85], v30, s[56:57] offset:2048 sc1
    global_load_dwordx4 v[86:89], v30, s[56:57] offset:3072 sc1
    global_load_dwordx4 v[90:93], v31, s[56:57] offset:-3072 sc1
    global_load_dwordx4 v[94:97], v31, s[56:57] offset:-2048 sc1
    global_load_dwordx4 v[98:101], v31, s[56:57] offset:-1024 sc1
    global_load_dwordx4 v[102:105], v31, s[56:57] offset:0 sc1
    global_load_dwordx4 v[106:109], v31, s[56:57] offset:1024 sc1
    global_load_dwordx4 v[110:113], v31, s[56:57] offset:2048 sc1
    global_load_dwordx4 v[114:117], v31, s[56:57] offset:3072 sc1
    global_load_dwordx4 v[118:121], v30, s[58:59] offset:-3072 sc1
    global_load_dwordx4 v[122:125], v30, s[58:59] offset:-2048 sc1
    s_waitcnt vmcnt(0)
    v_bitop3_b32 v28, v46, v65, v69 bitop3:0x80
    v_bitop3_b32 v28, v73, v77, v28 bitop3:0x80
    v_and_b32 v28, 1, v28
    v_cmp_ne_u32 vcc, 1, v28
    s_add_u32 s100, s100, 1
    s_cmp_ge_u32 s100, 262144
    s_cbranch_scc1 Lz0_p_x
    s_cbranch_vccnz Lz0_p
Lz0_p_x:
    s_nop 1
    s_branch Lz0_ok
Lz1_r:
    s_nop 7
Lz1_p:
    global_load_dwordx4 v[78:81], v30, s[56:57] offset:1024 sc1
    global_load_dwordx4 v[82:85], v30, s[56:57] offset:2048 sc1
    global_load_dwordx4 v[86:89], v30, s[56:57] offset:3072 sc1
    global_load_dwordx4 v[90:93], v31, s[56:57] offset:-3072 sc1
    s_waitcnt vmcnt(0)
    v_and_b32 v28, v81, v85
    v_bitop3_b32 v28, v89, v93, v28 bitop3:0x80
    v_and_b32 v28, 1, v28
    v_cmp_ne_u32 vcc, 1, v28
    s_add_u32 s100, s100, 1
    s_cmp_ge_u32 s100, 262144
    s_cbranch_scc1 Lz1_p_x
    s_cbranch_vccnz Lz1_p
Lz1_p_x:
    s_nop 1
    s_branch Lz1_ok
Lz2_r:
    s_nop 7
Lz2_p:
    global_load_dwordx4 v[94:97], v31, s[56:57] offset:-2048 sc1
    global_load_dwordx4 v[98:101], v31, s[56:57] offset:-1024 sc1
    global_load_dwordx4 v[102:105], v31, s[56:57] offset:0 sc1
    global_load_dwordx4 v[106:109], v31, s[56:57] offset:1024 sc1
    s_waitcnt vmcnt(0)
    v_and_b32 v28, v97, v101
    v_bitop3_b32 v28, v105, v109, v28 bitop3:0x80
    v_and_b32 v28, 1, v28
    v_cmp_ne_u32 vcc, 1, v28
    s_add_u32 s100, s100, 1
    s_cmp_ge_u32 s100, 262144
    s_cbranch_scc1 Lz2_p_x
    s_cbranch_vccnz Lz2_p
Lz2_p_x:
    s_nop 1
    s_branch Lz2_ok
Lz3_r:
    s_nop 7
Lz3_p:
    global_load_dwordx4 v[110:113], v31, s[56:57] offset:2048 sc1
    global_load_dwordx4 v[114:117], v31, s[56:57] offset:3072 sc1
    global_load_dwordx4 v[118:121], v30, s[58:59] offset:-3072 sc1
    global_load_dwordx4 v[122:125], v30, s[58:59] offset:-2048 sc1
    s_waitcnt vmcnt(0)
    v_and_b32 v28, v113, v117
    v_bitop3_b32 v28, v121, v125, v28 bitop3:0x80
    v_and_b32 v28, 1, v28
    v_cmp_ne_u32 vcc, 1, v28
    s_add_u32 s100, s100, 1
    s_cmp_ge_u32 s100, 262144
    s_cbranch_scc1 Lz3_p_x
    s_cbranch_vccnz Lz3_p
Lz3_p_x:
    s_nop 1
    s_branch Lz3_ok
Lz4_r:
    s_nop 7
Lz4_p:
    global_load_dwordx4 v[126:129], v30, s[58:59] offset:-1024 sc1
    global_load_dwordx4 v[130:133], v30, s[58:59] offset:0 sc1
    global_load_dwordx4 v[134:137], v30, s[58:59] offset:1024 sc1
    global_load_dwordx4 v[138:141], v30, s[58:59] offset:2048 sc1
    s_waitcnt vmcnt(0)
    v_and_b32 v28, v129, v133
    v_bitop3_b32 v28, v137, v141, v28 bitop3:0x80
    v_and_b32 v28, 1, v28
    v_cmp_ne_u32 vcc, 1, v28
    s_add_u32 s100, s100, 1
    s_cmp_ge_u32 s100, 262144
    s_cbranch_scc1 Lz4_p_x
    s_cbranch_vccnz Lz4_p
Lz4_p_x:
    s_nop 1
    s_branch Lz4_ok
Lz5_r:
    s_nop 7
Lz5_p:
    global_load_dwordx4 v[62:65], v30, s[58:59] offset:3072 sc1
    global_load_dwordx4 v[66:69], v31, s[58:59] offset:-3072 sc1
    global_load_dwordx4 v[70:73], v31, s[58:59] offset:-2048 sc1
    global_load_dwordx4 v[74:77], v31, s[58:59] offset:-1024 sc1
    s_waitcnt vmcnt(0)
    v_and_b32 v28, v65, v69
    v_bitop3_b32 v28, v73, v77, v28 bitop3:0x80
    v_and_b32 v28, 1, v28
    v_cmp_ne_u32 vcc, 1, v28
    s_add_u32 s100, s100, 1
    s_cmp_ge_u32 s100, 262144
    s_cbranch_scc1 Lz5_p_x
    s_cbranch_vccnz Lz5_p
Lz5_p_x:
    s_nop 1
    s_branch Lz5_ok
Lz6_r:
    s_nop 7
Lz6_p:
    global_load_dwordx4 v[78:81], v31, s[58:59] offset:0 sc1
    global_load_dwordx4 v[82:85], v31, s[58:59] offset:1024 sc1
    global_load_dwordx4 v[86:89], v31, s[58:59] offset:2048 sc1
    global_load_dwordx4 v[90:93], v31, s[58:59] offset:3072 sc1
    s_waitcnt vmcnt(0)
    v_and_b32 v28, v81, v85
    v_bitop3_b32 v28, v89, v93, v28 bitop3:0x80
    v_and_b32 v28, 1, v28
    v_cmp_ne_u32 vcc, 1, v28
    s_add_u32 s100, s100, 1
    s_cmp_ge_u32 s100, 262144
    s_cbranch_scc1 Lz6_p_x
    s_cbranch_vccnz Lz6_p
Lz6_p_x:
    s_nop 1
    s_branch Lz6_ok
Lz7_r:
    s_nop 7
Lz7_p:
    global_load_dwordx4 v[94:97], v30, s[60:61] offset:-3072 sc1
    global_load_dwordx4 v[98:101], v31, s[60:61] offset:-3072 sc1
    global_load_dwordx4 v[102:105], v30, s[62:63] offset:-3072 sc1
    global_load_dwordx4 v[106:109], v31, s[62:63] offset:-3072 sc1
    s_waitcnt vmcnt(0)
    v_and_b32 v28, v97, v101
    v_bitop3_b32 v28, v105, v109, v28 bitop3:0x80
    v_and_b32 v28, 1, v28
    v_cmp_ne_u32 vcc, 1, v28
    s_add_u32 s100, s100, 1
    s_cmp_ge_u32 s100, 262144
    s_cbranch_scc1 Lz7_p_x
    s_cbranch_vccnz Lz7_p
Lz7_p_x:
    s_nop 1
    s_branch Lz7_ok
Lz8_r:
    s_nop 7
Lz8_p:
    global_load_dwordx4 v[110:113], v30, s[52:53] offset:-3072 sc1
    global_load_dwordx4 v[114:117], v31, s[52:53] offset:-3072 sc1
    global_load_dwordx4 v[118:121], v30, s[54:55] offset:-3072 sc1
    global_load_dwordx4 v[122:125], v31, s[54:55] offset:-3072 sc1
    s_waitcnt vmcnt(0)
    v_and_b32 v28, v113, v117
    v_bitop3_b32 v28, v121, v125, v28 bitop3:0x80
    v_and_b32 v28, 1, v28
    v_cmp_ne_u32 vcc, 1, v28
    s_add_u32 s100, s100, 1
    s_cmp_ge_u32 s100, 262144
    s_cbranch_scc1 Lz8_p_x
    s_cbranch_vccnz Lz8_p
Lz8_p_x:
    s_nop 1
    s_branch Lz8_ok
Lz9_r:
    s_nop 7
Lz9_p:
    global_load_dwordx4 v[126:129], v30, s[64:65] offset:-3072 sc1
    global_load_dwordx4 v[130:133], v31, s[64:65] offset:-3072 sc1
    global_load_dwordx4 v[134:137], v30, s[66:67] offset:-3072 sc1
    global_load_dwordx4 v[138:141], v31, s[66:67] offset:-3072 sc1
    s_waitcnt vmcnt(0)
    v_and_b32 v28, v129, v133
    v_bitop3_b32 v28, v137, v141, v28 bitop3:0x80
    v_and_b32 v28, 1, v28
    v_cmp_ne_u32 vcc, 1, v28
    s_add_u32 s100, s100, 1
    s_cmp_ge_u32 s100, 262144
    s_cbranch_scc1 Lz9_p_x
    s_cbranch_vccnz Lz9_p
Lz9_p_x:
    s_nop 1
    s_branch Lz9_ok
Lz10_r:
    s_nop 7
Lz10_p:
    global_load_dwordx4 v[62:65], v30, s[60:61] offset:-2048 sc1
    global_load_dwordx4 v[66:69], v31, s[60:61] offset:-2048 sc1
    global_load_dwordx4 v[70:73], v30, s[62:63] offset:-2048 sc1
    global_load_dwordx4 v[74:77], v31, s[62:63] offset:-2048 sc1
    s_waitcnt vmcnt(0)
    v_and_b32 v28, v65, v69
    v_bitop3_b32 v28, v73, v77, v28 bitop3:0x80
    v_and_b32 v28, 1, v28
    v_cmp_ne_u32 vcc, 1, v28
    s_add_u32 s100, s100, 1
    s_cmp_ge_u32 s100, 262144
    s_cbranch_scc1 Lz10_p_x
    s_cbranch_vccnz Lz10_p
Lz10_p_x:
    s_nop 1
    s_branch Lz10_ok
Lz11_r:
    s_nop 7
Lz11_p:
    global_load_dwordx4 v[78:81], v30, s[52:53] offset:-2048 sc1
    global_load_dwordx4 v[82:85], v31, s[52:53] offset:-2048 sc1
    global_load_dwordx4 v[86:89], v30, s[54:55] offset:-2048 sc1
    global_load_dwordx4 v[90:93], v31, s[54:55] offset:-2048 sc1
    s_waitcnt vmcnt(0)
    v_and_b32 v28, v81, v85
    v_bitop3_b32 v28, v89, v93, v28 bitop3:0x80
    v_and_b32 v28, 1, v28
    v_cmp_ne_u32 vcc, 1, v28
    s_add_u32 s100, s100, 1
    s_cmp_ge_u32 s100, 262144
    s_cbranch_scc1 Lz11_p_x
    s_cbranch_vccnz Lz11_p
Lz11_p_x:
    s_nop 1
    s_branch Lz11_ok
Lz12_r:
    s_nop 7
Lz12_p:
    global_load_dwordx4 v[94:97], v30, s[64:65] offset:-2048 sc1
    global_load_dwordx4 v[98:101], v31, s[64:65] offset:-2048 sc1
    global_load_dwordx4 v[102:105], v30, s[66:67] offset:-2048 sc1
    global_load_dwordx4 v[106:109], v31, s[66:67] offset:-2048 sc1
    s_waitcnt vmcnt(0)
    v_and_b32 v28, v97, v101
    v_bitop3_b32 v28, v105, v109, v28 bitop3:0x80
    v_and_b32 v28, 1, v28
    v_cmp_ne_u32 vcc, 1, v28
    s_add_u32 s100, s100, 1
    s_cmp_ge_u32 s100, 262144
    s_cbranch_scc1 Lz12_p_x
    s_cbranch_vccnz Lz12_p
Lz12_p_x:
    s_nop 1
    s_branch Lz12_ok
Lz13_r:
    s_nop 7
Lz13_p:
    global_load_dwordx4 v[110:113], v30, s[60:61] offset:-1024 sc1
    global_load_dwordx4 v[114:117], v31, s[60:61] offset:-1024 sc1
    global_load_dwordx4 v[118:121], v30, s[62:63] offset:-1024 sc1
    global_load_dwordx4 v[122:125], v31, s[62:63] offset:-1024 sc1
    s_waitcnt vmcnt(0)
    v_and_b32 v28, v113, v117
    v_bitop3_b32 v28, v121, v125, v28 bitop3:0x80
    v_and_b32 v28, 1, v28
    v_cmp_ne_u32 vcc, 1, v28
    s_add_u32 s100, s100, 1
    s_cmp_ge_u32 s100, 262144
    s_cbranch_scc1 Lz13_p_x
    s_cbranch_vccnz Lz13_p
Lz13_p_x:
    s_nop 1
    s_branch Lz13_ok
Lz14_r:
    s_nop 7
Lz14_p:
    global_load_dwordx4 v[126:129], v30, s[52:53] offset:-1024 sc1
    global_load_dwordx4 v[130:133], v31, s[52:53] offset:-1024 sc1
    global_load_dwordx4 v[134:137], v30, s[54:55] offset:-1024 sc1
    global_load_dwordx4 v[138:141], v31, s[54:55] offset:-1024 sc1
    s_waitcnt vmcnt(0)
    v_and_b32 v28, v129, v133
    v_bitop3_b32 v28, v137, v141, v28 bitop3:0x80
    v_and_b32 v28, 1, v28
    v_cmp_ne_u32 vcc, 1, v28
    s_add_u32 s100, s100, 1
    s_cmp_ge_u32 s100, 262144
    s_cbranch_scc1 Lz14_p_x
    s_cbranch_vccnz Lz14_p
Lz14_p_x:
    s_nop 1
    s_branch Lz14_ok
Lz15_r:
    s_nop 7
Lz15_p:
    global_load_dwordx4 v[62:65], v30, s[64:65] offset:-1024 sc1
    global_load_dwordx4 v[66:69], v31, s[64:65] offset:-1024 sc1
    global_load_dwordx4 v[70:73], v30, s[66:67] offset:-1024 sc1
    global_load_dwordx4 v[74:77], v31, s[66:67] offset:-1024 sc1
    s_waitcnt vmcnt(0)
    v_and_b32 v28, v65, v69
    v_bitop3_b32 v28, v73, v77, v28 bitop3:0x80
    v_and_b32 v28, 1, v28
    v_cmp_ne_u32 vcc, 1, v28
    s_add_u32 s100, s100, 1
    s_cmp_ge_u32 s100, 262144
    s_cbranch_scc1 Lz15_p_x
    s_cbranch_vccnz Lz15_p
Lz15_p_x:
    s_nop 1
    s_branch Lz15_ok
Lz16_r:
    s_nop 7
Lz16_p:
    global_load_dwordx4 v[78:81], v30, s[60:61] offset:0 sc1
    global_load_dwordx4 v[82:85], v31, s[60:61] offset:0 sc1
    global_load_dwordx4 v[86:89], v30, s[62:63] offset:0 sc1
    global_load_dwordx4 v[90:93], v31, s[62:63] offset:0 sc1
    s_waitcnt vmcnt(0)
    v_and_b32 v28, v81, v85
    v_bitop3_b32 v28, v89, v93, v28 bitop3:0x80
    v_and_b32 v28, 1, v28
    v_cmp_ne_u32 vcc, 1, v28
    s_add_u32 s100, s100, 1
    s_cmp_ge_u32 s100, 262144
    s_cbranch_scc1 Lz16_p_x
    s_cbranch_vccnz Lz16_p
Lz16_p_x:
    s_nop 1
    s_branch Lz16_ok
Lz17_r:
    s_nop 7
Lz17_p:
    global_load_dwordx4 v[94:97], v30, s[52:53] offset:0 sc1
    global_load_dwordx4 v[98:101], v31, s[52:53] offset:0 sc1
    global_load_dwordx4 v[102:105], v30, s[54:55] offset:0 sc1
    global_load_dwordx4 v[106:109], v31, s[54:55] offset:0 sc1
    s_waitcnt vmcnt(0)
    v_and_b32 v28, v97, v101
    v_bitop3_b32 v28, v105, v109, v28 bitop3:0x80
    v_and_b32 v28, 1, v28
    v_cmp_ne_u32 vcc, 1, v28
    s_add_u32 s100, s100, 1
    s_cmp_ge_u32 s100, 262144
    s_cbranch_scc1 Lz17_p_x
    s_cbranch_vccnz Lz17_p
Lz17_p_x:
    s_nop 1
    s_branch Lz17_ok
Lz18_r:
    s_nop 7
Lz18_p:
    global_load_dwordx4 v[110:113], v30, s[64:65] offset:0 sc1
    global_load_dwordx4 v[114:117], v31, s[64:65] offset:0 sc1
    global_load_dwordx4 v[118:121], v30, s[66:67] offset:0 sc1
    global_load_dwordx4 v[122:125], v31, s[66:67] offset:0 sc1
    s_waitcnt vmcnt(0)
    v_and_b32 v28, v113, v117
    v_bitop3_b32 v28, v121, v125, v28 bitop3:0x80
    v_and_b32 v28, 1, v28
    v_cmp_ne_u32 vcc, 1, v28
    s_add_u32 s100, s100, 1
    s_cmp_ge_u32 s100, 262144
    s_cbranch_scc1 Lz18_p_x
    s_cbranch_vccnz Lz18_p
Lz18_p_x:
    s_nop 1
    s_branch Lz18_ok
Lz19_r:
    s_nop 7
Lz19_p:
    global_load_dwordx4 v[126:129], v30, s[60:61] offset:1024 sc1
    global_load_dwordx4 v[130:133], v31, s[60:61] offset:1024 sc1
    global_load_dwordx4 v[134:137], v30, s[62:63] offset:1024 sc1
    global_load_dwordx4 v[138:141], v31, s[62:63] offset:1024 sc1
    s_waitcnt vmcnt(0)
    v_and_b32 v28, v129, v133
    v_bitop3_b32 v28, v137, v141, v28 bitop3:0x80
    v_and_b32 v28, 1, v28
    v_cmp_ne_u32 vcc, 1, v28
    s_add_u32 s100, s100, 1
    s_cmp_ge_u32 s100, 262144
    s_cbranch_scc1 Lz19_p_x
    s_cbranch_vccnz Lz19_p
Lz19_p_x:
    s_nop 1
    s_branch Lz19_ok
Lz20_r:
    s_nop 7
Lz20_p:
    global_load_dwordx4 v[62:65], v30, s[52:53] offset:1024 sc1
    global_load_dwordx4 v[66:69], v31, s[52:53] offset:1024 sc1
    global_load_dwordx4 v[70:73], v30, s[54:55] offset:1024 sc1
    global_load_dwordx4 v[74:77], v31, s[54:55] offset:1024 sc1
    s_waitcnt vmcnt(0)
    v_and_b32 v28, v65, v69
    v_bitop3_b32 v28, v73, v77, v28 bitop3:0x80
    v_and_b32 v28, 1, v28
    v_cmp_ne_u32 vcc, 1, v28
    s_add_u32 s100, s100, 1
    s_cmp_ge_u32 s100, 262144
    s_cbranch_scc1 Lz20_p_x
    s_cbranch_vccnz Lz20_p
Lz20_p_x:
    s_nop 1
    s_branch Lz20_ok
Lz21_r:
    s_nop 7
Lz21_p:
    global_load_dwordx4 v[78:81], v30, s[64:65] offset:1024 sc1
    global_load_dwordx4 v[82:85], v31, s[64:65] offset:1024 sc1
    global_load_dwordx4 v[86:89], v30, s[66:67] offset:1024 sc1
    global_load_dwordx4 v[90:93], v31, s[66:67] offset:1024 sc1
    s_waitcnt vmcnt(0)
    v_and_b32 v28, v81, v85
    v_bitop3_b32 v28, v89, v93, v28 bitop3:0x80
    v_and_b32 v28, 1, v28
    v_cmp_ne_u32 vcc, 1, v28
    s_add_u32 s100, s100, 1
    s_cmp_ge_u32 s100, 262144
    s_cbranch_scc1 Lz21_p_x
    s_cbranch_vccnz Lz21_p
Lz21_p_x:
    s_nop 1
    s_branch Lz21_ok
Lz22_r:
    s_nop 7
Lz22_p:
    global_load_dwordx4 v[94:97], v30, s[60:61] offset:2048 sc1
    global_load_dwordx4 v[98:101], v31, s[60:61] offset:2048 sc1
    global_load_dwordx4 v[102:105], v30, s[62:63] offset:2048 sc1
    global_load_dwordx4 v[106:109], v31, s[62:63] offset:2048 sc1
    s_waitcnt vmcnt(0)
    v_and_b32 v28, v97, v101
    v_bitop3_b32 v28, v105, v109, v28 bitop3:0x80
    v_and_b32 v28, 1, v28
    v_cmp_ne_u32 vcc, 1, v28
    s_add_u32 s100, s100, 1
    s_cmp_ge_u32 s100, 262144
    s_cbranch_scc1 Lz22_p_x
    s_cbranch_vccnz Lz22_p
Lz22_p_x:
    s_nop 1
    s_branch Lz22_ok
Lz23_r:
    s_nop 7
Lz23_p:
    global_load_dwordx4 v[110:113], v30, s[52:53] offset:2048 sc1
    global_load_dwordx4 v[114:117], v31, s[52:53] offset:2048 sc1
    global_load_dwordx4 v[118:121], v30, s[54:55] offset:2048 sc1
    global_load_dwordx4 v[122:125], v31, s[54:55] offset:2048 sc1
    s_waitcnt vmcnt(0)
    v_and_b32 v28, v113, v117
    v_bitop3_b32 v28, v121, v125, v28 bitop3:0x80
    v_and_b32 v28, 1, v28
    v_cmp_ne_u32 vcc, 1, v28
    s_add_u32 s100, s100, 1
    s_cmp_ge_u32 s100, 262144
    s_cbranch_scc1 Lz23_p_x
    s_cbranch_vccnz Lz23_p
Lz23_p_x:
    s_nop 1
    s_branch Lz23_ok
Lz24_r:
    s_nop 7
Lz24_p:
    global_load_dwordx4 v[126:129], v30, s[64:65] offset:2048 sc1
    global_load_dwordx4 v[130:133], v31, s[64:65] offset:2048 sc1
    global_load_dwordx4 v[134:137], v30, s[66:67] offset:2048 sc1
    global_load_dwordx4 v[138:141], v31, s[66:67] offset:2048 sc1
    s_waitcnt vmcnt(0)
    v_and_b32 v28, v129, v133
    v_bitop3_b32 v28, v137, v141, v28 bitop3:0x80
    v_and_b32 v28, 1, v28
    v_cmp_ne_u32 vcc, 1, v28
    s_add_u32 s100, s100, 1
    s_cmp_ge_u32 s100, 262144
    s_cbranch_scc1 Lz24_p_x
    s_cbranch_vccnz Lz24_p
Lz24_p_x:
    s_nop 1
    s_branch Lz24_ok
Lz25_r:
    s_nop 7
Lz25_p:
    global_load_dwordx4 v[62:65], v30, s[60:61] offset:3072 sc1
    global_load_dwordx4 v[66:69], v31, s[60:61] offset:3072 sc1
    global_load_dwordx4 v[70:73], v30, s[62:63] offset:3072 sc1
    global_load_dwordx4 v[74:77], v31, s[62:63] offset:3072 sc1
    s_waitcnt vmcnt(0)
    v_and_b32 v28, v65, v69
    v_bitop3_b32 v28, v73, v77, v28 bitop3:0x80
    v_and_b32 v28, 1, v28
    v_cmp_ne_u32 vcc, 1, v28
    s_add_u32 s100, s100, 1
    s_cmp_ge_u32 s100, 262144
    s_cbranch_scc1 Lz25_p_x
    s_cbranch_vccnz Lz25_p
Lz25_p_x:
    s_nop 1
    s_branch Lz25_ok
Lz26_r:
    s_nop 7
Lz26_p:
    global_load_dwordx4 v[78:81], v30, s[52:53] offset:3072 sc1
    global_load_dwordx4 v[82:85], v31, s[52:53] offset:3072 sc1
    global_load_dwordx4 v[86:89], v30, s[54:55] offset:3072 sc1
    global_load_dwordx4 v[90:93], v31, s[54:55] offset:3072 sc1
    s_waitcnt vmcnt(0)
    v_and_b32 v28, v81, v85
    v_bitop3_b32 v28, v89, v93, v28 bitop3:0x80
    v_and_b32 v28, 1, v28
    v_cmp_ne_u32 vcc, 1, v28
    s_add_u32 s100, s100, 1
    s_cmp_ge_u32 s100, 262144
    s_cbranch_scc1 Lz26_p_x
    s_cbranch_vccnz Lz26_p
Lz26_p_x:
    s_nop 1
    s_branch Lz26_ok
Lz27_r:
    s_nop 7
Lz27_p:
    global_load_dwordx4 v[94:97], v30, s[64:65] offset:3072 sc1
    global_load_dwordx4 v[98:101], v31, s[64:65] offset:3072 sc1
    global_load_dwordx4 v[102:105], v30, s[66:67] offset:3072 sc1
    global_load_dwordx4 v[106:109], v31, s[66:67] offset:3072 sc1
    s_waitcnt vmcnt(0)
    v_and_b32 v28, v97, v101
    v_bitop3_b32 v28, v105, v109, v28 bitop3:0x80
    v_and_b32 v28, 1, v28
    v_cmp_ne_u32 vcc, 1, v28
    s_add_u32 s100, s100, 1
    s_cmp_ge_u32 s100, 262144
    s_cbranch_scc1 Lz27_p_x
    s_cbranch_vccnz Lz27_p
Lz27_p_x:
    s_nop 1
    s_branch Lz27_ok
Lp0_r:
    s_nop 7
Lp0_p:
    global_load_dwordx4 v[142:145], v6, s[38:39] offset:-4096 sc1
    global_load_dwordx4 v[146:149], v6, s[38:39] offset:-3072 sc1
    global_load_dwordx4 v[150:153], v6, s[38:39] offset:-2048 sc1
    global_load_dwordx4 v[154:157], v6, s[38:39] offset:-1024 sc1
    global_load_dwordx4 v[158:161], v6, s[38:39] offset:0 sc1
    global_load_dwordx4 v[162:165], v6, s[38:39] offset:1024 sc1
    global_load_dwordx4 v[166:169], v6, s[38:39] offset:2048 sc1
    global_load_dwordx4 v[170:173], v6, s[38:39] offset:3072 sc1
    s_waitcnt vmcnt(0)
    v_or_b32 v28, v145, v149
    v_or3_b32 v28, v153, v157, v28
    v_or3_b32 v28, v161, v165, v28
    v_or3_b32 v28, v169, v173, v28
    v_and_b32 v28, 1, v28
    v_cmp_ne_u32 vcc, 0, v28
    s_add_u32 s100, s100, 1
    s_cmp_ge_u32 s100, 262144
    s_cbranch_scc1 Lp0_p_x
    s_cbranch_vccnz Lp0_p
Lp0_p_x:
    s_nop 1
    s_branch Lp0_ok
Lp1_r:
    s_nop 7
Lp1_p:
    global_load_dwordx4 v[174:177], v7, s[38:39] offset:-4096 sc1
    global_load_dwordx4 v[178:181], v7, s[38:39] offset:-3072 sc1
    global_load_dwordx4 v[182:185], v7, s[38:39] offset:-2048 sc1
    global_load_dwordx4 v[186:189], v7, s[38:39] offset:-1024 sc1
    global_load_dwordx4 v[190:193], v7, s[38:39] offset:0 sc1
    global_load_dwordx4 v[194:197], v7, s[38:39] offset:1024 sc1
    global_load_dwordx4 v[198:201], v7, s[38:39] offset:2048 sc1
    global_load_dwordx4 v[202:205], v7, s[38:39] offset:3072 sc1
    s_waitcnt vmcnt(0)
    v_or_b32 v28, v177, v181
    v_or3_b32 v28, v185, v189, v28
    v_or3_b32 v28, v193, v197, v28
    v_or3_b32 v28, v201, v205, v28
    v_and_b32 v28, 1, v28
    v_cmp_ne_u32 vcc, 0, v28
    s_add_u32 s100, s100, 1
    s_cmp_ge_u32 s100, 262144
    s_cbranch_scc1 Lp1_p_x
    s_cbranch_vccnz Lp1_p
Lp1_p_x:
    s_nop 1
    s_branch Lp1_ok
Lp2_r:
    s_nop 7
Lp2_p:
    global_load_dwordx4 v[206:209], v26, s[38:39] offset:-4096 sc1
    global_load_dwordx4 v[210:213], v26, s[38:39] offset:-3072 sc1
    global_load_dwordx4 v[214:217], v26, s[38:39] offset:-2048 sc1
    global_load_dwordx4 v[218:221], v26, s[38:39] offset:-1024 sc1
    global_load_dwordx4 v[222:225], v26, s[38:39] offset:0 sc1
    global_load_dwordx4 v[226:229], v26, s[38:39] offset:1024 sc1
    global_load_dwordx4 v[230:233], v26, s[38:39] offset:2048 sc1
    s_waitcnt vmcnt(0)
    v_or3_b32 v28, v209, v213, v217
    v_or3_b32 v28, v221, v225, v28
    v_or3_b32 v28, v229, v233, v28
    v_and_b32 v28, 1, v28
    v_cmp_ne_u32 vcc, 0, v28
    s_add_u32 s100, s100, 1
    s_cmp_ge_u32 s100, 262144
    s_cbranch_scc1 Lp2_p_x
    s_cbranch_vccnz Lp2_p
Lp2_p_x:
    s_nop 1
    s_branch Lp2_ok
Lp3_r:
    s_nop 7
Lp3_p:
    global_load_dwordx4 v[238:241], v27, s[38:39] offset:-4096 sc1
    global_load_dwordx4 v[242:245], v27, s[38:39] offset:-3072 sc1
    global_load_dwordx4 v[246:249], v27, s[38:39] offset:-2048 sc1
    global_load_dwordx4 v[250:253], v27, s[38:39] offset:-1024 sc1
    s_waitcnt vmcnt(0)
    v_or_b32 v28, v239, v241
    v_or3_b32 v28, v243, v245, v28
    v_or3_b32 v28, v247, v249, v28
    v_or3_b32 v28, v251, v253, v28
    v_and_b32 v28, 1, v28
    v_cmp_ne_u32 vcc, 0, v28
    s_add_u32 s100, s100, 1
    s_cmp_ge_u32 s100, 262144
    s_cbranch_scc1 Lp3_p_x
    s_cbranch_vccnz Lp3_p
Lp3_p_x:
    s_nop 1
    s_branch Lp3_ok
Lcode_end:
    s_endpgm
.section .rodata,"a"
.p2align 6
.amdhsa_kernel adaLN_cond__ssm_conv_h3__mixer_gmlp__prompt_kernel
  .amdhsa_next_free_vgpr 512
  .amdhsa_next_free_sgpr 102
  .amdhsa_accum_offset 256
  .amdhsa_group_segment_fixed_size 0
  .amdhsa_kernarg_size 128
  .amdhsa_user_sgpr_count 2
  .amdhsa_user_sgpr_kernarg_segment_ptr 1
  .amdhsa_system_sgpr_workgroup_id_x 1
  .amdhsa_float_denorm_mode_32 3
.end_amdhsa_kernel
```

```asm
; @launch grid=(256,1,1) block=(256,1,1) lds=163840
.amdgcn_target "amdgcn-amd-amdhsa--gfx950"
.text
.p2align 8
.globl adaLN_cond__ssm_conv_h3__mixer_gmlp__prompt_kernel
.type adaLN_cond__ssm_conv_h3__mixer_gmlp__prompt_kernel,@function
adaLN_cond__ssm_conv_h3__mixer_gmlp__prompt_kernel:
    s_cmp_ge_u32 s2, 256
    s_cbranch_scc1 Lend
    s_load_dwordx16 s[8:23], s[0:1], 0
    s_load_dwordx16 s[24:39], s[0:1], 64
    v_lshrrev_b32 v2, 6, v0
    v_and_b32 v1, 63, v0
    v_readfirstlane_b32 s3, v2
    s_getpc_b64 s[4:5]
Lpf_adaLN_cond__ssm_conv_h3__mixer_gmlp__prompt_kernel_9:
    s_add_u32 s4, s4, adaLN_cond__ssm_conv_h3__mixer_gmlp__prompt_kernel-Lpf_adaLN_cond__ssm_conv_h3__mixer_gmlp__prompt_kernel_9
    s_addc_u32 s5, s5, -1
    s_lshr_b32 s6, s2, 3
    s_and_b32 s6, s6, 31
    v_mul_u32_u24 v254, 32, v0
    v_add_lshl_u32 v254, v254, s6, 7
    v_min_u32 v254, (Lcode_end-adaLN_cond__ssm_conv_h3__mixer_gmlp__prompt_kernel-4), v254
    global_load_dword v254, v254, s[4:5]
    s_mov_b64 s[58:59], s[4:5]
    v_and_b32 v2, 15, v1
    v_lshrrev_b32 v3, 4, v1
    v_lshlrev_b32 v4, 4, v1
    v_lshrrev_b32 v6, 2, v2
    v_and_b32 v5, 3, v2
    v_lshl_add_u32 v5, v6, 3, v5
    s_mov_b32 s100, 0
    s_and_b32 s4, s2, 7
    s_lshr_b32 s5, s2, 3
    s_lshr_b32 s43, s5, 2
    s_lshr_b32 s6, s43, 1
    s_lshl_b32 s6, s6, 3
    s_and_b32 s7, s4, 6
    s_add_u32 s6, s6, s7
    s_and_b32 s7, s43, 1
    s_add_u32 s40, s6, s7
    s_and_b32 s6, s4, 1
    s_lshl_b32 s6, s6, 2
    s_and_b32 s7, s5, 3
    s_add_u32 s41, s6, s7
    s_mul_i32 s4, s4, 20
    s_add_u32 s42, s4, s5
    s_waitcnt lgkmcnt(0)
    s_mov_b64 s[0:1], s[58:59]
    s_cmp_ge_u32 s2, 160
    s_cbranch_scc1 Lspare
Lconv:
    s_and_b32 s4, s42, 15
    s_lshl_b32 s4, s4, 2
    s_add_u32 s4, s4, s3
    s_mul_i32 s4, s4, 40960
    s_lshr_b32 s5, s42, 4
    s_lshl_b32 s6, s5, 7
    s_add_u32 s4, s4, s6
    v_mul_u32_u24 v38, 10240, v3
    v_lshl_add_u32 v38, v2, 3, v38
    v_add_u32 v38, s4, v38
    v_add_u32 v39, 5120, v38
    global_load_dwordx2 v[48:49], v38, s[10:11] offset:0
    global_load_dwordx2 v[50:51], v38, s[10:11] offset:1280
    global_load_dwordx2 v[52:53], v38, s[10:11] offset:2560
    global_load_dwordx2 v[54:55], v38, s[10:11] offset:3840
    global_load_dwordx2 v[56:57], v39, s[10:11] offset:0
    global_load_dwordx2 v[58:59], v39, s[10:11] offset:1280
    global_load_dwordx2 v[60:61], v39, s[10:11] offset:2560
    global_load_dwordx2 v[62:63], v39, s[10:11] offset:3840
    v_max_u32 v40, 3840, v38
    global_load_dwordx2 v[42:43], v40, s[10:11] offset:-3840
    global_load_dwordx2 v[44:45], v40, s[10:11] offset:-2560
    global_load_dwordx2 v[46:47], v40, s[10:11] offset:-1280
    s_lshl_b32 s5, s5, 9
    v_lshl_add_u32 v40, v2, 5, s5
    global_load_dwordx4 v[80:83], v40, s[14:15] offset:0
    global_load_dwordx4 v[84:87], v40, s[14:15] offset:16
    global_load_dwordx2 v[64:65], v38, s[12:13] offset:0 nt
    global_load_dwordx2 v[66:67], v38, s[12:13] offset:1280 nt
    global_load_dwordx2 v[68:69], v38, s[12:13] offset:2560 nt
    global_load_dwordx2 v[70:71], v38, s[12:13] offset:3840 nt
    global_load_dwordx2 v[72:73], v39, s[12:13] offset:0 nt
    global_load_dwordx2 v[74:75], v39, s[12:13] offset:1280 nt
    global_load_dwordx2 v[76:77], v39, s[12:13] offset:2560 nt
    global_load_dwordx2 v[78:79], v39, s[12:13] offset:3840 nt
    s_lshl_b32 s7, s42, 3
    s_load_dwordx2 s[92:93], s[18:19], s7
    v_mov_b32 v148, 0
    v_mov_b32 v149, 0
    v_mov_b32 v150, 0
    v_mov_b32 v151, 0
    s_mul_i32 s5, s3, 8448
    v_and_b32 v28, 48, v4
    v_add_u32 v28, s5, v28
    ds_write_b128 v28, v[148:151] offset:0
    ds_write_b128 v28, v[148:151] offset:4224
    v_min_u32 v28, 448, v4
    s_mul_i32 s4, s3, 9280
    v_add_u32 v28, s4, v28
    ds_write_b128 v28, v[148:151] offset:37888
    ds_write_b128 v28, v[148:151] offset:42528
    v_add_u32 v31, s5, v4
    v_and_b32 v28, 1, v2
    v_lshrrev_b32 v29, 1, v2
    v_mul_u32_u24 v30, 4224, v28
    v_lshl_add_u32 v30, v29, 3, v30
    v_lshl_add_u32 v30, v3, 4, v30
    v_add_u32 v30, s5, v30
    v_mul_u32_u24 v32, 4640, v28
    v_lshlrev_b32 v29, 6, v29
    v_sub_u32 v32, v32, v29
    v_lshl_add_u32 v32, v3, 4, v32
    s_add_u32 s4, s4, 34256
    v_add_u32 v32, s4, v32
    v_lshl_add_u32 v34, v28, 2, v29
    v_lshl_add_u32 v34, v3, 4, v34
    s_mul_i32 s4, s3, 1056
    s_add_u32 s4, s4, 0
    v_add_u32 v34, s4, v34
    v_lshlrev_b32 v28, 2, v0
    v_sub_u32 v33, 34824, v28
    v_add_u32 v35, 0, v28
    v_lshrrev_b32 v28, 5, v0
    v_mul_u32_u24 v37, 114688, v28
    v_and_b32 v28, 31, v0
    v_lshl_add_u32 v37, v28, 4, v37
    s_lshl_b32 s4, s42, 9
    s_add_u32 s4, s4, 1048576
    v_add_u32 v37, s4, v37
    s_waitcnt lgkmcnt(0)
    s_lshl_b32 s52, s92, 16
    s_lshr_b32 s56, s52, 16
    s_and_b32 s53, s92, 0xffff0000
    s_lshr_b32 s57, s53, 16
    s_lshl_b32 s54, s93, 16
    s_lshr_b32 s58, s54, 16
    s_and_b32 s55, s93, 0xffff0000
    s_lshr_b32 s59, s55, 16
    v_and_b32 v203, 7, v1
    v_lshrrev_b32 v204, 3, v1
    s_lshl_b32 s4, s42, 2
    s_add_u32 s4, s4, s3
    s_lshl_b32 s94, s4, 12
    v_add_u32 v28, s94, v4
    s_mul_i32 s5, s3, 8448
    s_add_u32 m0, s5, 4288
    s_nop 0
    global_load_lds_dwordx4 v28, s[16:17] offset:0 nt
    global_load_lds_dwordx4 v28, s[16:17] offset:1024 nt
    global_load_lds_dwordx4 v28, s[16:17] offset:2048 nt
    global_load_lds_dwordx4 v28, s[16:17] offset:3072 nt
    s_lshr_b32 s5, s3, 1
    s_lshl_b32 s5, s5, 5
    s_and_b32 s6, s3, 1
    s_lshl_b32 s6, s6, 2
    s_add_u32 s6, s6, s5
    s_lshl_b32 s5, s40, 6
    s_add_u32 s90, s6, s5
    v_add_lshl_u32 v27, v5, s90, 1
    global_load_ushort v27, v27, s[26:27]
    s_waitcnt vmcnt(25)
    v_lshlrev_b32 v116, 16, v48
    v_and_b32 v117, 0xffff0000, v48
    v_lshlrev_b32 v118, 16, v49
    v_and_b32 v119, 0xffff0000, v49
    s_waitcnt vmcnt(24)
    v_lshlrev_b32 v120, 16, v50
    v_and_b32 v121, 0xffff0000, v50
    v_lshlrev_b32 v122, 16, v51
    v_and_b32 v123, 0xffff0000, v51
    s_waitcnt vmcnt(23)
    v_lshlrev_b32 v124, 16, v52
    v_and_b32 v125, 0xffff0000, v52
    v_lshlrev_b32 v126, 16, v53
    v_and_b32 v127, 0xffff0000, v53
    s_waitcnt vmcnt(22)
    v_lshlrev_b32 v128, 16, v54
    v_and_b32 v129, 0xffff0000, v54
    v_lshlrev_b32 v130, 16, v55
    v_and_b32 v131, 0xffff0000, v55
    s_waitcnt vmcnt(21)
    v_lshlrev_b32 v132, 16, v56
    v_and_b32 v133, 0xffff0000, v56
    v_lshlrev_b32 v134, 16, v57
    v_and_b32 v135, 0xffff0000, v57
    s_waitcnt vmcnt(20)
    v_lshlrev_b32 v136, 16, v58
    v_and_b32 v137, 0xffff0000, v58
    v_lshlrev_b32 v138, 16, v59
    v_and_b32 v139, 0xffff0000, v59
    s_waitcnt vmcnt(19)
    v_lshlrev_b32 v140, 16, v60
    v_and_b32 v141, 0xffff0000, v60
    v_lshlrev_b32 v142, 16, v61
    v_and_b32 v143, 0xffff0000, v61
    s_waitcnt vmcnt(18)
    v_lshlrev_b32 v144, 16, v62
    v_and_b32 v145, 0xffff0000, v62
    v_lshlrev_b32 v146, 16, v63
    v_and_b32 v147, 0xffff0000, v63
    s_lshl_b32 s4, s42, 2
    s_add_u32 s4, s4, s3
    s_mul_i32 s4, s4, 5120
    s_cmp_lt_u32 s42, 128
    s_cselect_b32 s5, -1, 0
    v_add_u32 v201, s4, v4
    v_and_b32 v201, s5, v201
    v_add_u32 v201, 2048, v201
    global_load_dwordx4 v[180:183], v201, s[8:9] offset:-2048 nt
    global_load_dwordx4 v[184:187], v201, s[8:9] offset:-1024 nt
    global_load_dwordx4 v[188:191], v201, s[8:9] offset:0 nt
    global_load_dwordx4 v[192:195], v201, s[8:9] offset:1024 nt
    global_load_dwordx4 v[196:199], v201, s[8:9] offset:2048 nt
    v_cmp_le_u32 vcc, 1280, v38
    s_waitcnt vmcnt(22)
    s_nop 0
    v_cndmask_b32 v42, 0, v42, vcc
    v_cndmask_b32 v43, 0, v43, vcc
    s_waitcnt vmcnt(21)
    v_cndmask_b32 v44, 0, v44, vcc
    v_cndmask_b32 v45, 0, v45, vcc
    s_waitcnt vmcnt(20)
    v_cndmask_b32 v46, 0, v46, vcc
    v_cndmask_b32 v47, 0, v47, vcc
    v_lshlrev_b32 v104, 16, v42
    v_and_b32 v105, 0xffff0000, v42
    v_lshlrev_b32 v106, 16, v43
    v_and_b32 v107, 0xffff0000, v43
    v_lshlrev_b32 v108, 16, v44
    v_and_b32 v109, 0xffff0000, v44
    v_lshlrev_b32 v110, 16, v45
    v_and_b32 v111, 0xffff0000, v45
    v_lshlrev_b32 v112, 16, v46
    v_and_b32 v113, 0xffff0000, v46
    v_lshlrev_b32 v114, 16, v47
    v_and_b32 v115, 0xffff0000, v47
    s_waitcnt vmcnt(19)
    v_lshlrev_b32 v88, 16, v80
    v_and_b32 v92, 0xffff0000, v80
    v_lshlrev_b32 v96, 16, v81
    v_and_b32 v100, 0xffff0000, v81
    v_lshlrev_b32 v89, 16, v82
    v_and_b32 v93, 0xffff0000, v82
    v_lshlrev_b32 v97, 16, v83
    v_and_b32 v101, 0xffff0000, v83
    s_waitcnt vmcnt(18)
    v_lshlrev_b32 v90, 16, v84
    v_and_b32 v94, 0xffff0000, v84
    v_lshlrev_b32 v98, 16, v85
    v_and_b32 v102, 0xffff0000, v85
    v_lshlrev_b32 v91, 16, v86
    v_and_b32 v95, 0xffff0000, v86
    v_lshlrev_b32 v99, 16, v87
    v_and_b32 v103, 0xffff0000, v87
    v_pk_mul_f32 v[148:149], v[116:117], v[88:89] op_sel:[0,0] op_sel_hi:[1,1]
    v_pk_mul_f32 v[150:151], v[118:119], v[90:91] op_sel:[0,0] op_sel_hi:[1,1]
    v_pk_mul_f32 v[152:153], v[120:121], v[88:89] op_sel:[0,0] op_sel_hi:[1,1]
    v_pk_mul_f32 v[154:155], v[122:123], v[90:91] op_sel:[0,0] op_sel_hi:[1,1]
    v_pk_mul_f32 v[156:157], v[124:125], v[88:89] op_sel:[0,0] op_sel_hi:[1,1]
    v_pk_mul_f32 v[158:159], v[126:127], v[90:91] op_sel:[0,0] op_sel_hi:[1,1]
    v_pk_mul_f32 v[160:161], v[128:129], v[88:89] op_sel:[0,0] op_sel_hi:[1,1]
    v_pk_mul_f32 v[162:163], v[130:131], v[90:91] op_sel:[0,0] op_sel_hi:[1,1]
    v_pk_mul_f32 v[164:165], v[132:133], v[88:89] op_sel:[0,0] op_sel_hi:[1,1]
    v_pk_mul_f32 v[166:167], v[134:135], v[90:91] op_sel:[0,0] op_sel_hi:[1,1]
    v_pk_mul_f32 v[168:169], v[136:137], v[88:89] op_sel:[0,0] op_sel_hi:[1,1]
    v_pk_mul_f32 v[170:171], v[138:139], v[90:91] op_sel:[0,0] op_sel_hi:[1,1]
    v_pk_mul_f32 v[172:173], v[140:141], v[88:89] op_sel:[0,0] op_sel_hi:[1,1]
    v_pk_mul_f32 v[174:175], v[142:143], v[90:91] op_sel:[0,0] op_sel_hi:[1,1]
    v_pk_mul_f32 v[176:177], v[144:145], v[88:89] op_sel:[0,0] op_sel_hi:[1,1]
    v_pk_mul_f32 v[178:179], v[146:147], v[90:91] op_sel:[0,0] op_sel_hi:[1,1]
    v_pk_fma_f32 v[148:149], v[112:113], v[92:93], v[148:149] op_sel:[0,0,0] op_sel_hi:[1,1,1]
    v_pk_fma_f32 v[150:151], v[114:115], v[94:95], v[150:151] op_sel:[0,0,0] op_sel_hi:[1,1,1]
    v_pk_fma_f32 v[152:153], v[116:117], v[92:93], v[152:153] op_sel:[0,0,0] op_sel_hi:[1,1,1]
    v_pk_fma_f32 v[154:155], v[118:119], v[94:95], v[154:155] op_sel:[0,0,0] op_sel_hi:[1,1,1]
    v_pk_fma_f32 v[156:157], v[120:121], v[92:93], v[156:157] op_sel:[0,0,0] op_sel_hi:[1,1,1]
    v_pk_fma_f32 v[158:159], v[122:123], v[94:95], v[158:159] op_sel:[0,0,0] op_sel_hi:[1,1,1]
    v_pk_fma_f32 v[160:161], v[124:125], v[92:93], v[160:161] op_sel:[0,0,0] op_sel_hi:[1,1,1]
    v_pk_fma_f32 v[162:163], v[126:127], v[94:95], v[162:163] op_sel:[0,0,0] op_sel_hi:[1,1,1]
    v_pk_fma_f32 v[164:165], v[128:129], v[92:93], v[164:165] op_sel:[0,0,0] op_sel_hi:[1,1,1]
    v_pk_fma_f32 v[166:167], v[130:131], v[94:95], v[166:167] op_sel:[0,0,0] op_sel_hi:[1,1,1]
    v_pk_fma_f32 v[168:169], v[132:133], v[92:93], v[168:169] op_sel:[0,0,0] op_sel_hi:[1,1,1]
    v_pk_fma_f32 v[170:171], v[134:135], v[94:95], v[170:171] op_sel:[0,0,0] op_sel_hi:[1,1,1]
    v_pk_fma_f32 v[172:173], v[136:137], v[92:93], v[172:173] op_sel:[0,0,0] op_sel_hi:[1,1,1]
    v_pk_fma_f32 v[174:175], v[138:139], v[94:95], v[174:175] op_sel:[0,0,0] op_sel_hi:[1,1,1]
    v_pk_fma_f32 v[176:177], v[140:141], v[92:93], v[176:177] op_sel:[0,0,0] op_sel_hi:[1,1,1]
    v_pk_fma_f32 v[178:179], v[142:143], v[94:95], v[178:179] op_sel:[0,0,0] op_sel_hi:[1,1,1]
    v_pk_fma_f32 v[148:149], v[108:109], v[96:97], v[148:149] op_sel:[0,0,0] op_sel_hi:[1,1,1]
    v_pk_fma_f32 v[150:151], v[110:111], v[98:99], v[150:151] op_sel:[0,0,0] op_sel_hi:[1,1,1]
    v_pk_fma_f32 v[152:153], v[112:113], v[96:97], v[152:153] op_sel:[0,0,0] op_sel_hi:[1,1,1]
    v_pk_fma_f32 v[154:155], v[114:115], v[98:99], v[154:155] op_sel:[0,0,0] op_sel_hi:[1,1,1]
    v_pk_fma_f32 v[156:157], v[116:117], v[96:97], v[156:157] op_sel:[0,0,0] op_sel_hi:[1,1,1]
    v_pk_fma_f32 v[158:159], v[118:119], v[98:99], v[158:159] op_sel:[0,0,0] op_sel_hi:[1,1,1]
    v_pk_fma_f32 v[160:161], v[120:121], v[96:97], v[160:161] op_sel:[0,0,0] op_sel_hi:[1,1,1]
    v_pk_fma_f32 v[162:163], v[122:123], v[98:99], v[162:163] op_sel:[0,0,0] op_sel_hi:[1,1,1]
    v_pk_fma_f32 v[164:165], v[124:125], v[96:97], v[164:165] op_sel:[0,0,0] op_sel_hi:[1,1,1]
    v_pk_fma_f32 v[166:167], v[126:127], v[98:99], v[166:167] op_sel:[0,0,0] op_sel_hi:[1,1,1]
    v_pk_fma_f32 v[168:169], v[128:129], v[96:97], v[168:169] op_sel:[0,0,0] op_sel_hi:[1,1,1]
    v_pk_fma_f32 v[170:171], v[130:131], v[98:99], v[170:171] op_sel:[0,0,0] op_sel_hi:[1,1,1]
    v_pk_fma_f32 v[172:173], v[132:133], v[96:97], v[172:173] op_sel:[0,0,0] op_sel_hi:[1,1,1]
    v_pk_fma_f32 v[174:175], v[134:135], v[98:99], v[174:175] op_sel:[0,0,0] op_sel_hi:[1,1,1]
    v_pk_fma_f32 v[176:177], v[136:137], v[96:97], v[176:177] op_sel:[0,0,0] op_sel_hi:[1,1,1]
    v_pk_fma_f32 v[178:179], v[138:139], v[98:99], v[178:179] op_sel:[0,0,0] op_sel_hi:[1,1,1]
    v_pk_fma_f32 v[148:149], v[104:105], v[100:101], v[148:149] op_sel:[0,0,0] op_sel_hi:[1,1,1]
    v_pk_fma_f32 v[150:151], v[106:107], v[102:103], v[150:151] op_sel:[0,0,0] op_sel_hi:[1,1,1]
    v_pk_fma_f32 v[152:153], v[108:109], v[100:101], v[152:153] op_sel:[0,0,0] op_sel_hi:[1,1,1]
    v_pk_fma_f32 v[154:155], v[110:111], v[102:103], v[154:155] op_sel:[0,0,0] op_sel_hi:[1,1,1]
    v_pk_fma_f32 v[156:157], v[112:113], v[100:101], v[156:157] op_sel:[0,0,0] op_sel_hi:[1,1,1]
    v_pk_fma_f32 v[158:159], v[114:115], v[102:103], v[158:159] op_sel:[0,0,0] op_sel_hi:[1,1,1]
    v_pk_fma_f32 v[160:161], v[116:117], v[100:101], v[160:161] op_sel:[0,0,0] op_sel_hi:[1,1,1]
    v_pk_fma_f32 v[162:163], v[118:119], v[102:103], v[162:163] op_sel:[0,0,0] op_sel_hi:[1,1,1]
    v_pk_fma_f32 v[164:165], v[120:121], v[100:101], v[164:165] op_sel:[0,0,0] op_sel_hi:[1,1,1]
    v_pk_fma_f32 v[166:167], v[122:123], v[102:103], v[166:167] op_sel:[0,0,0] op_sel_hi:[1,1,1]
    v_pk_fma_f32 v[168:169], v[124:125], v[100:101], v[168:169] op_sel:[0,0,0] op_sel_hi:[1,1,1]
    v_pk_fma_f32 v[170:171], v[126:127], v[102:103], v[170:171] op_sel:[0,0,0] op_sel_hi:[1,1,1]
    v_pk_fma_f32 v[172:173], v[128:129], v[100:101], v[172:173] op_sel:[0,0,0] op_sel_hi:[1,1,1]
    v_pk_fma_f32 v[174:175], v[130:131], v[102:103], v[174:175] op_sel:[0,0,0] op_sel_hi:[1,1,1]
    v_pk_fma_f32 v[176:177], v[132:133], v[100:101], v[176:177] op_sel:[0,0,0] op_sel_hi:[1,1,1]
    v_pk_fma_f32 v[178:179], v[134:135], v[102:103], v[178:179] op_sel:[0,0,0] op_sel_hi:[1,1,1]
    s_lshl_b32 s4, s3, 6
    s_sub_u32 s4, 104688, s4
    v_mul_u32_u24 v40, 272, v2
    v_add_u32 v40, s4, v40
    v_lshlrev_b32 v39, 4, v3
    v_sub_u32 v40, v40, v39
    s_waitcnt vmcnt(17)
    v_lshlrev_b32 v104, 16, v64
    v_and_b32 v105, 0xffff0000, v64
    v_lshlrev_b32 v106, 16, v65
    v_and_b32 v107, 0xffff0000, v65
    v_pk_mul_f32 v[148:149], v[148:149], v[104:105] op_sel:[0,0] op_sel_hi:[1,1]
    v_pk_mul_f32 v[150:151], v[150:151], v[106:107] op_sel:[0,0] op_sel_hi:[1,1]
    s_waitcnt vmcnt(16)
    v_lshlrev_b32 v108, 16, v66
    v_and_b32 v109, 0xffff0000, v66
    v_lshlrev_b32 v110, 16, v67
    v_and_b32 v111, 0xffff0000, v67
    v_pk_mul_f32 v[152:153], v[152:153], v[108:109] op_sel:[0,0] op_sel_hi:[1,1]
    v_pk_mul_f32 v[154:155], v[154:155], v[110:111] op_sel:[0,0] op_sel_hi:[1,1]
    s_waitcnt vmcnt(15)
    v_lshlrev_b32 v112, 16, v68
    v_and_b32 v113, 0xffff0000, v68
    v_lshlrev_b32 v114, 16, v69
    v_and_b32 v115, 0xffff0000, v69
    v_pk_mul_f32 v[156:157], v[156:157], v[112:113] op_sel:[0,0] op_sel_hi:[1,1]
    v_pk_mul_f32 v[158:159], v[158:159], v[114:115] op_sel:[0,0] op_sel_hi:[1,1]
    s_waitcnt vmcnt(14)
    v_lshlrev_b32 v116, 16, v70
    v_and_b32 v117, 0xffff0000, v70
    v_lshlrev_b32 v118, 16, v71
    v_and_b32 v119, 0xffff0000, v71
    v_pk_mul_f32 v[160:161], v[160:161], v[116:117] op_sel:[0,0] op_sel_hi:[1,1]
    v_pk_mul_f32 v[162:163], v[162:163], v[118:119] op_sel:[0,0] op_sel_hi:[1,1]
    s_waitcnt vmcnt(13)
    v_lshlrev_b32 v120, 16, v72
    v_and_b32 v121, 0xffff0000, v72
    v_lshlrev_b32 v122, 16, v73
    v_and_b32 v123, 0xffff0000, v73
    v_pk_mul_f32 v[164:165], v[164:165], v[120:121] op_sel:[0,0] op_sel_hi:[1,1]
    v_pk_mul_f32 v[166:167], v[166:167], v[122:123] op_sel:[0,0] op_sel_hi:[1,1]
    s_waitcnt vmcnt(12)
    v_lshlrev_b32 v124, 16, v74
    v_and_b32 v125, 0xffff0000, v74
    v_lshlrev_b32 v126, 16, v75
    v_and_b32 v127, 0xffff0000, v75
    v_pk_mul_f32 v[168:169], v[168:169], v[124:125] op_sel:[0,0] op_sel_hi:[1,1]
    v_pk_mul_f32 v[170:171], v[170:171], v[126:127] op_sel:[0,0] op_sel_hi:[1,1]
    s_waitcnt vmcnt(11)
    v_lshlrev_b32 v128, 16, v76
    v_and_b32 v129, 0xffff0000, v76
    v_lshlrev_b32 v130, 16, v77
    v_and_b32 v131, 0xffff0000, v77
    v_pk_mul_f32 v[172:173], v[172:173], v[128:129] op_sel:[0,0] op_sel_hi:[1,1]
    v_pk_mul_f32 v[174:175], v[174:175], v[130:131] op_sel:[0,0] op_sel_hi:[1,1]
    s_waitcnt vmcnt(10)
    v_lshlrev_b32 v132, 16, v78
    v_and_b32 v133, 0xffff0000, v78
    v_lshlrev_b32 v134, 16, v79
    v_and_b32 v135, 0xffff0000, v79
    v_pk_mul_f32 v[176:177], v[176:177], v[132:133] op_sel:[0,0] op_sel_hi:[1,1]
    v_pk_mul_f32 v[178:179], v[178:179], v[134:135] op_sel:[0,0] op_sel_hi:[1,1]
    v_cvt_pk_bf16_f32 v88, v176, v172
    v_cvt_pk_bf16_f32 v89, v168, v164
    v_cvt_pk_bf16_f32 v90, v160, v156
    v_cvt_pk_bf16_f32 v91, v152, v148
    v_and_b32 v91, -2, v91
    ds_write_b128 v40, v[88:91] offset:0
    v_cvt_pk_bf16_f32 v92, v177, v173
    v_cvt_pk_bf16_f32 v93, v169, v165
    v_cvt_pk_bf16_f32 v94, v161, v157
    v_cvt_pk_bf16_f32 v95, v153, v149
    v_and_b32 v95, -2, v95
    ds_write_b128 v40, v[92:95] offset:4352
    v_cvt_pk_bf16_f32 v96, v178, v174
    v_cvt_pk_bf16_f32 v97, v170, v166
    v_cvt_pk_bf16_f32 v98, v162, v158
    v_cvt_pk_bf16_f32 v99, v154, v150
    v_and_b32 v99, -2, v99
    ds_write_b128 v40, v[96:99] offset:8704
    v_cvt_pk_bf16_f32 v100, v179, v175
    v_cvt_pk_bf16_f32 v101, v171, v167
    v_cvt_pk_bf16_f32 v102, v163, v159
    v_cvt_pk_bf16_f32 v103, v155, v151
    v_and_b32 v103, -2, v103
    ds_write_b128 v40, v[100:103] offset:13056
    s_waitcnt lgkmcnt(0)
    s_barrier
    s_mul_i32 s4, s3, 4352
    s_add_u32 s4, s4, 104448
    v_mul_u32_u24 v40, 272, v3
    v_lshl_add_u32 v40, v2, 4, v40
    v_add_u32 v40, s4, v40
    ds_read_b128 v[148:151], v40 offset:0
    ds_read_b128 v[152:155], v40 offset:1088
    ds_read_b128 v[156:159], v40 offset:2176
    ds_read_b128 v[160:163], v40 offset:3264
    s_lshr_b32 s4, s42, 4
    s_lshl_b32 s4, s4, 6
    s_add_u32 s4, s4, s3
    s_lshl_b32 s4, s4, 12
    s_and_b32 s5, s42, 15
    s_lshl_b32 s5, s5, 8
    s_sub_u32 s4, s4, s5
    s_add_u32 s4, s4, 12586752
    v_lshl_add_u32 v38, v3, 14, s4
    v_lshl_add_u32 v38, v2, 4, v38
    s_waitcnt lgkmcnt(3)
    global_store_dwordx4 v38, v[148:151], s[38:39] sc1
    v_add_u32 v38, 65536, v38
    s_waitcnt lgkmcnt(2)
    global_store_dwordx4 v38, v[152:155], s[38:39] sc1
    v_add_u32 v38, 65536, v38
    s_waitcnt lgkmcnt(1)
    global_store_dwordx4 v38, v[156:159], s[38:39] sc1
    v_add_u32 v38, 65536, v38
    s_waitcnt lgkmcnt(0)
    global_store_dwordx4 v38, v[160:163], s[38:39] sc1
    v_min_u32 v212, 7, v1
    v_add_u32 v212, 56, v212
    v_lshlrev_b32 v212, 1, v212
    v_mov_b32 v213, 1
    s_cmp_lg_u32 s3, 0
    s_cbranch_scc1 Ldb1
    global_load_ushort v213, v212, s[36:37] sc1
Ldb1:
    s_waitcnt vmcnt(10)
    ds_read_b128 v[74:77], v31 offset:4288
    ds_read_b32 v73, v31 offset:4284
    ds_read_b128 v[82:85], v31 offset:5312
    ds_read_b32 v81, v31 offset:5308
    ds_read_b128 v[90:93], v31 offset:6336
    ds_read_b32 v89, v31 offset:6332
    ds_read_b128 v[98:101], v31 offset:7360
    ds_read_b32 v97, v31 offset:7356
    s_waitcnt lgkmcnt(6)
    v_alignbit_b32 v104, v74, v73, 16
    v_alignbit_b32 v105, v75, v74, 16
    v_alignbit_b32 v106, v76, v75, 16
    v_alignbit_b32 v107, v77, v76, 16
    ds_write_b128 v31, v[104:107] offset:64
    s_waitcnt lgkmcnt(5)
    v_alignbit_b32 v108, v82, v81, 16
    v_alignbit_b32 v109, v83, v82, 16
    v_alignbit_b32 v110, v84, v83, 16
    v_alignbit_b32 v111, v85, v84, 16
    ds_write_b128 v31, v[108:111] offset:1088
    s_waitcnt lgkmcnt(4)
    v_alignbit_b32 v112, v90, v89, 16
    v_alignbit_b32 v113, v91, v90, 16
    v_alignbit_b32 v114, v92, v91, 16
    v_alignbit_b32 v115, v93, v92, 16
    ds_write_b128 v31, v[112:115] offset:2112
    s_waitcnt lgkmcnt(3)
    v_alignbit_b32 v116, v98, v97, 16
    v_alignbit_b32 v117, v99, v98, 16
    v_alignbit_b32 v118, v100, v99, 16
    v_alignbit_b32 v119, v101, v100, 16
    ds_write_b128 v31, v[116:119] offset:3136
    ds_read_b64 a[0:1], v30 offset:8
    ds_read_b64 a[2:3], v30 offset:16
    ds_read_b64 a[4:5], v30 offset:72
    ds_read_b64 a[6:7], v30 offset:80
    ds_read_b64 a[8:9], v30 offset:136
    ds_read_b64 a[10:11], v30 offset:144
    ds_read_b64 a[12:13], v30 offset:200
    ds_read_b64 a[14:15], v30 offset:208
    ds_read_b64 a[16:17], v30 offset:264
    ds_read_b64 a[18:19], v30 offset:272
    ds_read_b64 a[20:21], v30 offset:328
    ds_read_b64 a[22:23], v30 offset:336
    ds_read_b64 a[24:25], v30 offset:392
    ds_read_b64 a[26:27], v30 offset:400
    ds_read_b64 a[28:29], v30 offset:456
    ds_read_b64 a[30:31], v30 offset:464
    ds_read_b64 a[32:33], v30 offset:520
    ds_read_b64 a[34:35], v30 offset:528
    ds_read_b64 a[36:37], v30 offset:584
    ds_read_b64 a[38:39], v30 offset:592
    ds_read_b64 a[40:41], v30 offset:648
    ds_read_b64 a[42:43], v30 offset:656
    ds_read_b64 a[44:45], v30 offset:712
    ds_read_b64 a[46:47], v30 offset:720
    ds_read_b64 a[48:49], v30 offset:776
    ds_read_b64 a[50:51], v30 offset:784
    ds_read_b64 a[52:53], v30 offset:840
    ds_read_b64 a[54:55], v30 offset:848
    ds_read_b64 a[56:57], v30 offset:904
    ds_read_b64 a[58:59], v30 offset:912
    ds_read_b64 a[60:61], v30 offset:968
    ds_read_b64 a[62:63], v30 offset:976
    ds_read_b64 a[64:65], v30 offset:1032
    ds_read_b64 a[66:67], v30 offset:1040
    ds_read_b64 a[68:69], v30 offset:1096
    ds_read_b64 a[70:71], v30 offset:1104
    ds_read_b64 a[72:73], v30 offset:1160
    ds_read_b64 a[74:75], v30 offset:1168
    ds_read_b64 a[76:77], v30 offset:1224
    ds_read_b64 a[78:79], v30 offset:1232
    ds_read_b64 a[80:81], v30 offset:1288
    ds_read_b64 a[82:83], v30 offset:1296
    ds_read_b64 a[84:85], v30 offset:1352
    ds_read_b64 a[86:87], v30 offset:1360
    ds_read_b64 a[88:89], v30 offset:1416
    ds_read_b64 a[90:91], v30 offset:1424
    ds_read_b64 a[92:93], v30 offset:1480
    ds_read_b64 a[94:95], v30 offset:1488
    s_mul_i32 s5, s3, 5152
    s_add_u32 s5, s5, 122880
    v_add_u32 v201, s5, v4
    v_lshrrev_b32 v202, 5, v1
    v_lshl_add_u32 v202, v202, 4, v201
    s_waitcnt vmcnt(8)
    ds_write_b128 v201, v[180:183] offset:0
    s_waitcnt vmcnt(7)
    ds_write_b128 v201, v[184:187] offset:1024
    s_waitcnt vmcnt(6)
    ds_write_b128 v202, v[188:191] offset:2048
    s_waitcnt vmcnt(5)
    ds_write_b128 v201, v[192:195] offset:3088
    s_waitcnt vmcnt(4)
    ds_write_b128 v201, v[196:199] offset:4112
    s_lshl_b32 s95, s42, 7
    s_add_u32 s95, s95, 77824
    s_waitcnt vmcnt(0)
    v_cmp_eq_u32 vcc, 0, v213
    s_nop 0
    s_cbranch_vccnz Lic_r
Lic_ok:
    s_waitcnt lgkmcnt(0)
    s_barrier
    v_mov_b32 v29, s95
    s_cmp_lg_u32 s3, 0
    s_cbranch_scc1 Lkf_skip
    global_store_dword v29, v29, s[38:39] sc1
Lkf_skip:
    s_cmp_ge_u32 s42, 128
    s_cbranch_scc1 Lc_j3
    v_mul_u32_u24 v201, 2576, v203
    v_lshl_add_u32 v201, v204, 3, v201
    s_mul_i32 s5, s3, 320
    s_add_u32 s5, s5, 122880
    v_add_u32 v201, s5, v201
    ds_read2_b64 v[180:183], v201 offset0:0 offset1:160
    ds_read2_b64 v[184:187], v201 offset0:8 offset1:168
    ds_read2_b64 v[188:191], v201 offset0:16 offset1:176
    ds_read2_b64 v[192:195], v201 offset0:24 offset1:184
    ds_read2_b64 v[196:199], v201 offset0:32 offset1:192
    s_lshr_b32 s4, s42, 2
    s_mul_i32 s4, s4, 114688
    s_and_b32 s5, s42, 3
    s_lshl_b32 s5, s5, 7
    s_add_u32 s4, s4, s5
    s_mul_i32 s5, s3, 20480
    s_add_u32 s4, s4, s5
    s_add_u32 s4, s4, 1052672
    v_lshl_add_u32 v200, v204, 9, s4
    v_lshl_add_u32 v200, v203, 4, v200
    s_mov_b32 s7, 0x3f803f80
    v_mov_b32 v208, 0
    v_mov_b32 v209, 0
    v_mov_b32 v210, 0
    v_mov_b32 v211, 0
    s_waitcnt lgkmcnt(4)
    v_and_b32 v183, -2, v183
    global_store_dwordx4 v200, v[180:183], s[38:39] offset:-4096 sc1
    s_waitcnt lgkmcnt(3)
    v_and_b32 v187, -2, v187
    global_store_dwordx4 v200, v[184:187], s[38:39] offset:0 sc1
    v_add_u32 v200, 8192, v200
    s_waitcnt lgkmcnt(2)
    v_and_b32 v191, -2, v191
    global_store_dwordx4 v200, v[188:191], s[38:39] offset:-4096 sc1
    s_waitcnt lgkmcnt(1)
    v_and_b32 v195, -2, v195
    global_store_dwordx4 v200, v[192:195], s[38:39] offset:0 sc1
    v_add_u32 v200, 8192, v200
    s_waitcnt lgkmcnt(0)
    v_and_b32 v199, -2, v199
    global_store_dwordx4 v200, v[196:199], s[38:39] offset:-4096 sc1
    v_dot2_f32_bf16 v208, v180, s7, v208
    v_dot2_f32_bf16 v209, v180, v180, v209
    v_dot2_f32_bf16 v210, v182, s7, v210
    v_dot2_f32_bf16 v211, v182, v182, v211
    v_dot2_f32_bf16 v208, v181, s7, v208
    v_dot2_f32_bf16 v209, v181, v181, v209
    v_dot2_f32_bf16 v210, v183, s7, v210
    v_dot2_f32_bf16 v211, v183, v183, v211
    v_dot2_f32_bf16 v208, v184, s7, v208
    v_dot2_f32_bf16 v209, v184, v184, v209
    v_dot2_f32_bf16 v210, v186, s7, v210
    v_dot2_f32_bf16 v211, v186, v186, v211
    v_dot2_f32_bf16 v208, v185, s7, v208
    v_dot2_f32_bf16 v209, v185, v185, v209
    v_dot2_f32_bf16 v210, v187, s7, v210
    v_dot2_f32_bf16 v211, v187, v187, v211
    v_dot2_f32_bf16 v208, v188, s7, v208
    v_dot2_f32_bf16 v209, v188, v188, v209
    v_dot2_f32_bf16 v210, v190, s7, v210
    v_dot2_f32_bf16 v211, v190, v190, v211
    v_dot2_f32_bf16 v208, v189, s7, v208
    v_dot2_f32_bf16 v209, v189, v189, v209
    v_dot2_f32_bf16 v210, v191, s7, v210
    v_dot2_f32_bf16 v211, v191, v191, v211
    v_dot2_f32_bf16 v208, v192, s7, v208
    v_dot2_f32_bf16 v209, v192, v192, v209
    v_dot2_f32_bf16 v210, v194, s7, v210
    v_dot2_f32_bf16 v211, v194, v194, v211
    v_dot2_f32_bf16 v208, v193, s7, v208
    v_dot2_f32_bf16 v209, v193, v193, v209
    v_dot2_f32_bf16 v210, v195, s7, v210
    v_dot2_f32_bf16 v211, v195, v195, v211
    v_dot2_f32_bf16 v208, v196, s7, v208
    v_dot2_f32_bf16 v209, v196, v196, v209
    v_dot2_f32_bf16 v210, v198, s7, v210
    v_dot2_f32_bf16 v211, v198, v198, v211
    v_dot2_f32_bf16 v208, v197, s7, v208
    v_dot2_f32_bf16 v209, v197, v197, v209
    v_dot2_f32_bf16 v210, v199, s7, v210
    v_dot2_f32_bf16 v211, v199, v199, v211
    s_nop 1
    v_permlane32_swap_b32 v208, v210
    v_permlane32_swap_b32 v209, v211
    v_add_f32 v208, v208, v210
    v_add_f32 v209, v209, v211
    s_nop 1
    v_permlane16_swap_b32 v208, v209
    v_add_f32 v208, v208, v209
    v_lshlrev_b32 v201, 4, v203
    v_lshl_add_u32 v201, v3, 2, v201
    v_add_f32_dpp v208, v208, v208 row_ror:8 row_mask:0xf bank_mask:0xf
    s_lshl_b32 s5, s3, 7
    s_add_u32 s5, s5, 143616
    v_add_u32 v201, s5, v201
    ds_write_b32 v201, v208
Lc_j3:
    s_and_b32 s4, s42, -16
    s_lshl_b32 s4, s4, 7
    s_add_u32 s4, s4, 77824
    v_lshl_add_u32 v136, v2, 7, s4
    ds_read_b64 a[96:97], v30 offset:1544
    ds_read_b64 a[98:99], v30 offset:1552
    ds_read_b64 a[100:101], v30 offset:1608
    ds_read_b64 a[102:103], v30 offset:1616
    ds_read_b64 a[104:105], v30 offset:1672
    ds_read_b64 a[106:107], v30 offset:1680
    ds_read_b64 a[108:109], v30 offset:1736
    ds_read_b64 a[110:111], v30 offset:1744
    ds_read_b64 a[112:113], v30 offset:1800
    ds_read_b64 a[114:115], v30 offset:1808
    ds_read_b64 a[116:117], v30 offset:1864
    ds_read_b64 a[118:119], v30 offset:1872
    ds_read_b64 a[120:121], v30 offset:1928
    ds_read_b64 a[122:123], v30 offset:1936
    ds_read_b64 a[124:125], v30 offset:1992
    ds_read_b64 a[126:127], v30 offset:2000
    ds_read_b64 a[128:129], v30 offset:2056
    ds_read_b64 a[130:131], v30 offset:2064
    ds_read_b64 a[132:133], v30 offset:2120
    ds_read_b64 a[134:135], v30 offset:2128
    ds_read_b64 a[136:137], v30 offset:2184
    ds_read_b64 a[138:139], v30 offset:2192
    ds_read_b64 a[140:141], v30 offset:2248
    ds_read_b64 a[142:143], v30 offset:2256
    ds_read_b64 a[144:145], v30 offset:2312
    ds_read_b64 a[146:147], v30 offset:2320
    ds_read_b64 a[148:149], v30 offset:2376
    ds_read_b64 a[150:151], v30 offset:2384
    ds_read_b64 a[152:153], v30 offset:2440
    ds_read_b64 a[154:155], v30 offset:2448
    ds_read_b64 a[156:157], v30 offset:2504
    ds_read_b64 a[158:159], v30 offset:2512
    ds_read_b64 a[160:161], v30 offset:2568
    ds_read_b64 a[162:163], v30 offset:2576
    ds_read_b64 a[164:165], v30 offset:2632
    ds_read_b64 a[166:167], v30 offset:2640
    ds_read_b64 a[168:169], v30 offset:2696
    ds_read_b64 a[170:171], v30 offset:2704
    ds_read_b64 a[172:173], v30 offset:2760
    ds_read_b64 a[174:175], v30 offset:2768
    global_load_dword v137, v136, s[38:39] sc1
    v_min_u32 v41, 49, v1
    v_add_u32 v41, 56, v41
    v_lshlrev_b32 v41, 1, v41
    v_mov_b32 v42, 1
    s_cmp_lg_u32 s3, 0
    s_cbranch_scc1 Ldb2
    global_load_ushort v42, v41, s[36:37] sc1
Ldb2:
    ds_read_b64 a[176:177], v30 offset:2824
    ds_read_b64 a[178:179], v30 offset:2832
    ds_read_b64 a[180:181], v30 offset:2888
    ds_read_b64 a[182:183], v30 offset:2896
    ds_read_b64 a[184:185], v30 offset:2952
    ds_read_b64 a[186:187], v30 offset:2960
    ds_read_b64 a[188:189], v30 offset:3016
    ds_read_b64 a[190:191], v30 offset:3024
    ds_read_b64 a[192:193], v30 offset:3080
    ds_read_b64 a[194:195], v30 offset:3088
    ds_read_b64 a[196:197], v30 offset:3144
    ds_read_b64 a[198:199], v30 offset:3152
    ds_read_b64 a[200:201], v30 offset:3208
    ds_read_b64 a[202:203], v30 offset:3216
    ds_read_b64 a[204:205], v30 offset:3272
    ds_read_b64 a[206:207], v30 offset:3280
    ds_read_b64 a[208:209], v30 offset:3336
    ds_read_b64 a[210:211], v30 offset:3344
    ds_read_b64 a[212:213], v30 offset:3400
    ds_read_b64 a[214:215], v30 offset:3408
    ds_read_b64 a[216:217], v30 offset:3464
    ds_read_b64 a[218:219], v30 offset:3472
    ds_read_b64 a[220:221], v30 offset:3528
    ds_read_b64 a[222:223], v30 offset:3536
    ds_read_b64 a[224:225], v30 offset:3592
    ds_read_b64 a[226:227], v30 offset:3600
    ds_read_b64 a[228:229], v30 offset:3656
    ds_read_b64 a[230:231], v30 offset:3664
    ds_read_b64 a[232:233], v30 offset:3720
    ds_read_b64 a[234:235], v30 offset:3728
    ds_read_b64 a[236:237], v30 offset:3784
    ds_read_b64 a[238:239], v30 offset:3792
    ds_read_b64 a[240:241], v30 offset:3848
    ds_read_b64 a[242:243], v30 offset:3856
    ds_read_b64 a[244:245], v30 offset:3912
    ds_read_b64 a[246:247], v30 offset:3920
    ds_read_b64 a[248:249], v30 offset:3976
    ds_read_b64 a[250:251], v30 offset:3984
    ds_read_b64 a[252:253], v30 offset:4040
    ds_read_b64 a[254:255], v30 offset:4048
    s_add_u32 s4, s94, 12582912
    v_add_u32 v28, s4, v4
    s_waitcnt vmcnt(0) lgkmcnt(0)
    v_cmp_eq_u32 vcc, 0, v42
    s_nop 0
    s_cbranch_vccnz Lic2_r
Lic2_ok:
    s_barrier
    s_cmp_ge_u32 s42, 128
    s_cbranch_scc1 Lc_j5
    s_cmp_lg_u32 s3, 0
    s_cbranch_scc1 Lc_j5
    v_lshlrev_b32 v201, 3, v2
    v_add_u32 v202, 143616, v201
    ds_read_b64 v[212:213], v202 offset:0
    ds_read_b64 v[214:215], v202 offset:128
    ds_read_b64 v[216:217], v202 offset:256
    ds_read_b64 v[218:219], v202 offset:384
    s_waitcnt lgkmcnt(2)
    v_pk_add_f32 v[212:213], v[212:213], v[214:215] op_sel:[0,0] op_sel_hi:[1,1]
    s_waitcnt lgkmcnt(0)
    v_pk_add_f32 v[216:217], v[216:217], v[218:219] op_sel:[0,0] op_sel_hi:[1,1]
    v_pk_add_f32 v[212:213], v[212:213], v[216:217] op_sel:[0,0] op_sel_hi:[1,1]
    v_mul_f32 v212, 0x3acccccd, v212
    v_mul_f32 v213, 0x3acccccd, v213
    v_fma_f32 v213, -v212, v212, v213
    v_max_f32 v213, 0, v213
    v_add_f32 v213, 0x3727c5ac, v213
    v_rsq_f32 v214, v213
    s_nop 0
    v_mul_f32_e64 v213, -v212, v214
    v_mov_b32 v212, v214
    v_min_u32 v212, -2, v212
    v_min_u32 v213, -2, v213
    s_lshl_b32 s5, s42, 7
    s_add_u32 s5, s5, 32768
    v_add_u32 v201, s5, v201
    global_store_dwordx2 v201, v[212:213], s[38:39] sc1
Lc_j5:
    v_cmp_eq_u32 vcc, -1, v137
    s_nop 0
    s_cbranch_vccnz Lkf_r
Lkf_ok:
    s_mul_i32 s5, s3, 9280
    s_add_u32 m0, s5, 33804
    s_nop 0
    global_load_lds_dwordx4 v28, s[38:39] offset:3072 sc1
    s_add_u32 m0, s5, 38448
    s_nop 0
    global_load_lds_dwordx4 v28, s[38:39] offset:3072 sc1
    s_add_u32 m0, s5, 33804
    s_nop 0
    global_load_lds_dwordx4 v28, s[38:39] offset:2048 sc1
    s_add_u32 m0, s5, 38448
    s_nop 0
    global_load_lds_dwordx4 v28, s[38:39] offset:2048 sc1
    s_add_u32 m0, s5, 33804
    s_nop 0
    global_load_lds_dwordx4 v28, s[38:39] offset:1024 sc1
    s_add_u32 m0, s5, 38448
    s_nop 0
    global_load_lds_dwordx4 v28, s[38:39] offset:1024 sc1
    s_add_u32 m0, s5, 33804
    s_nop 0
    global_load_lds_dwordx4 v28, s[38:39] offset:0 sc1
    s_add_u32 m0, s5, 38448
    s_nop 0
    global_load_lds_dwordx4 v28, s[38:39] offset:0 sc1
    s_and_b32 s4, s41, 1
    s_lshl_b32 s5, s3, 1
    s_add_u32 s5, s5, s4
    s_cmp_eq_u32 s5, 7
    s_cselect_b32 s5, 0, s5
    s_mul_i32 s96, s41, 7
    s_add_u32 s96, s96, s5
    s_cmp_lt_u32 s96, 54
    s_cselect_b32 s101, 2, 0
    s_min_u32 s96, s96, 53
    s_cmp_eq_u32 s3, 3
    s_cselect_b32 s101, 1, s101
    s_lshr_b32 s97, s101, 1
    s_cselect_b32 s5, -1, 0
    v_and_b32 v7, s5, v4
    s_add_u32 s97, s97, s96
    s_mul_i32 s4, s96, 20480
    s_add_u32 s5, s4, 7344128
    s_add_u32 s8, s38, s5
    s_addc_u32 s9, s39, 0
    s_add_u32 s5, s4, 7352320
    s_add_u32 s10, s38, s5
    s_addc_u32 s11, s39, 0
    s_add_u32 s5, s4, 7360512
    s_add_u32 s12, s38, s5
    s_addc_u32 s13, s39, 0
    s_mul_i32 s4, s97, 20480
    s_add_u32 s5, s4, 7344128
    s_add_u32 s14, s38, s5
    s_addc_u32 s15, s39, 0
    s_add_u32 s5, s4, 7352320
    s_add_u32 s16, s38, s5
    s_addc_u32 s17, s39, 0
    s_add_u32 s5, s4, 7360512
    s_add_u32 s18, s38, s5
    s_addc_u32 s19, s39, 0
    s_and_b32 s4, s41, 3
    s_cmp_eq_u32 s4, 0
    s_cselect_b32 s5, 8, 0
    s_cmp_le_u32 s4, 1
    s_cselect_b32 s6, 16, 8
    s_cmp_eq_u32 s4, 3
    s_cselect_b32 s50, 16, 24
    s_lshl_b32 s44, s4, 3
    s_bitcmp1_b32 s43, 0
    s_cselect_b32 s46, s6, s5
    s_cselect_b32 s48, s5, s6
    s_lshl_b32 s5, s3, 1
    s_add_u32 s44, s44, s5
    s_add_u32 s45, s44, 1
    s_add_u32 s46, s46, s5
    s_add_u32 s47, s46, 1
    s_add_u32 s48, s48, s5
    s_add_u32 s49, s48, 1
    s_add_u32 s50, s50, s5
    s_add_u32 s51, s50, 1
    s_lshl_b32 s5, s40, 18
    s_lshl_b32 s6, s44, 7
    s_add_u32 s6, s6, s5
    s_add_u32 s68, s24, s6
    s_addc_u32 s69, s25, 0
    s_lshl_b32 s6, s45, 7
    s_add_u32 s6, s6, s5
    s_add_u32 s70, s24, s6
    s_addc_u32 s71, s25, 0
    s_lshl_b32 s6, s46, 7
    s_add_u32 s6, s6, s5
    s_add_u32 s72, s24, s6
    s_addc_u32 s73, s25, 0
    s_lshl_b32 s6, s47, 7
    s_add_u32 s6, s6, s5
    s_add_u32 s74, s24, s6
    s_addc_u32 s75, s25, 0
    s_lshl_b32 s6, s48, 7
    s_add_u32 s6, s6, s5
    s_add_u32 s76, s24, s6
    s_addc_u32 s77, s25, 0
    s_lshl_b32 s6, s49, 7
    s_add_u32 s6, s6, s5
    s_add_u32 s78, s24, s6
    s_addc_u32 s79, s25, 0
    s_lshl_b32 s6, s50, 7
    s_add_u32 s6, s6, s5
    s_add_u32 s80, s24, s6
    s_addc_u32 s81, s25, 0
    s_lshl_b32 s6, s51, 7
    s_add_u32 s6, s6, s5
    s_add_u32 s82, s24, s6
    s_addc_u32 s83, s25, 0
    s_lshl_b32 s89, s3, 14
    s_add_u32 s89, s89, 83200
    v_bfe_u32 v223, v1, 3, 1
    s_sub_u32 s4, s97, s96
    v_mul_u32_u24 v223, s4, v223
    v_add_lshl_u32 v223, v223, s96, 7
    v_mul_u32_u24 v170, 7168, v3
    v_add_u32 v223, v223, v170
    v_and_b32 v170, 112, v4
    v_add_u32 v223, v223, v170
    v_add_u32 v223, 49152, v223
    v_and_b32 v137, 1, v3
    v_mul_u32_u24 v137, 7168, v137
    v_sub_u32 v137, v223, v137
    v_lshrrev_b32 v170, 3, v1
    v_lshlrev_b32 v170, 12, v170
    v_bfe_u32 v171, v1, 4, 1
    v_xor_b32 v171, v171, v1
    v_and_b32 v171, 7, v171
    v_xor_b32 v8, 0, v171
    v_lshl_add_u32 v8, v8, 4, v170
    v_add_u32 v12, 131072, v8
    v_xor_b32 v9, 2, v171
    v_lshl_add_u32 v9, v9, 4, v170
    v_add_u32 v9, 31744, v9
    v_add_u32 v13, 131072, v9
    v_xor_b32 v10, 4, v171
    v_lshl_add_u32 v10, v10, 4, v170
    v_add_u32 v10, 63488, v10
    v_add_u32 v14, 131072, v10
    v_xor_b32 v11, 6, v171
    v_lshl_add_u32 v11, v11, 4, v170
    v_add_u32 v11, 95232, v11
    v_add_u32 v15, 131072, v11
    s_barrier
    s_waitcnt vmcnt(6)
    ds_read_b128 v[72:75], v32 offset:3584
    ds_read_b128 v[76:79], v32 offset:3648
    ds_read_b128 v[80:83], v32 offset:3712
    ds_read_b128 v[84:87], v32 offset:3776
    ds_read_b128 v[88:91], v32 offset:3840
    ds_read_b128 v[92:95], v32 offset:3904
    ds_read_b128 v[96:99], v32 offset:3968
    ds_read_b128 v[100:103], v32 offset:4032
    s_waitcnt lgkmcnt(7)
    v_mfma_f32_16x16x32_bf16 v[40:43], a[0:3], v[72:75], 0
    ds_read_b128 v[104:107], v32 offset:3072
    v_mfma_f32_16x16x32_bf16 v[44:47], a[32:35], v[72:75], 0
    ds_read_b128 v[108:111], v32 offset:3136
    s_waitcnt lgkmcnt(8)
    v_mfma_f32_16x16x32_bf16 v[40:43], a[4:7], v[76:79], v[40:43]
    ds_read_b128 v[112:115], v32 offset:3200
    v_mfma_f32_16x16x32_bf16 v[44:47], a[36:39], v[76:79], v[44:47]
    ds_read_b128 v[116:119], v32 offset:3264
    s_waitcnt lgkmcnt(9)
    v_mfma_f32_16x16x32_bf16 v[40:43], a[8:11], v[80:83], v[40:43]
    ds_read_b128 v[120:123], v32 offset:3328
    v_mfma_f32_16x16x32_bf16 v[44:47], a[40:43], v[80:83], v[44:47]
    ds_read_b128 v[124:127], v32 offset:3392
    s_waitcnt lgkmcnt(10)
    v_mfma_f32_16x16x32_bf16 v[40:43], a[12:15], v[84:87], v[40:43]
    ds_read_b128 v[128:131], v32 offset:3456
    v_mfma_f32_16x16x32_bf16 v[44:47], a[44:47], v[84:87], v[44:47]
    ds_read_b128 v[132:135], v32 offset:3520
    s_waitcnt lgkmcnt(11)
    v_mfma_f32_16x16x32_bf16 v[40:43], a[16:19], v[88:91], v[40:43]
    v_mfma_f32_16x16x32_bf16 v[44:47], a[48:51], v[88:91], v[44:47]
    s_waitcnt lgkmcnt(10)
    v_mfma_f32_16x16x32_bf16 v[40:43], a[20:23], v[92:95], v[40:43]
    v_mfma_f32_16x16x32_bf16 v[44:47], a[52:55], v[92:95], v[44:47]
    s_waitcnt lgkmcnt(9)
    v_mfma_f32_16x16x32_bf16 v[40:43], a[24:27], v[96:99], v[40:43]
    v_mfma_f32_16x16x32_bf16 v[44:47], a[56:59], v[96:99], v[44:47]
    s_waitcnt lgkmcnt(8)
    v_mfma_f32_16x16x32_bf16 v[40:43], a[28:31], v[100:103], v[40:43]
    v_mfma_f32_16x16x32_bf16 v[44:47], a[60:63], v[100:103], v[44:47]
    s_waitcnt lgkmcnt(7)
    v_mfma_f32_16x16x32_bf16 v[44:47], a[0:3], v[104:107], v[44:47]
    s_waitcnt lgkmcnt(6)
    v_mfma_f32_16x16x32_bf16 v[44:47], a[4:7], v[108:111], v[44:47]
    s_waitcnt lgkmcnt(5)
    v_mfma_f32_16x16x32_bf16 v[44:47], a[8:11], v[112:115], v[44:47]
    s_waitcnt lgkmcnt(4)
    v_mfma_f32_16x16x32_bf16 v[44:47], a[12:15], v[116:119], v[44:47]
    s_waitcnt lgkmcnt(3)
    v_mfma_f32_16x16x32_bf16 v[44:47], a[16:19], v[120:123], v[44:47]
    v_mov_b32 v162, 0
    s_waitcnt lgkmcnt(2)
    v_mfma_f32_16x16x32_bf16 v[44:47], a[20:23], v[124:127], v[44:47]
    v_mov_b32 v163, 0
    s_waitcnt lgkmcnt(1)
    v_mfma_f32_16x16x32_bf16 v[44:47], a[24:27], v[128:131], v[44:47]
    v_mov_b32 v164, 0
    s_waitcnt lgkmcnt(0)
    v_mfma_f32_16x16x32_bf16 v[44:47], a[28:31], v[132:135], v[44:47]
    v_mfma_f32_16x16x32_bf16 v[48:51], a[64:67], v[72:75], 0
    v_mov_b32 v165, 0
    v_mfma_f32_16x16x32_bf16 v[52:55], a[96:99], v[72:75], 0
    s_min_u32 s5, s42, 127
    v_mfma_f32_16x16x32_bf16 v[56:59], a[128:131], v[72:75], 0
    v_mfma_f32_16x16x32_bf16 v[60:63], a[160:163], v[72:75], 0
    s_lshl_b32 s4, s5, 13
    v_mfma_f32_16x16x32_bf16 v[64:67], a[192:195], v[72:75], 0
    s_add_u32 s4, s4, 15208448
    v_mfma_f32_16x16x32_bf16 v[68:71], a[224:227], v[72:75], 0
    v_mfma_f32_16x16x32_bf16 v[48:51], a[68:71], v[76:79], v[48:51]
    v_lshl_add_u32 v224, v0, 4, s4
    v_mfma_f32_16x16x32_bf16 v[52:55], a[100:103], v[76:79], v[52:55]
    global_store_dwordx4 v224, v[162:165], s[38:39] offset:-4096 sc1
    v_mfma_f32_16x16x32_bf16 v[56:59], a[132:135], v[76:79], v[56:59]
    v_mfma_f32_16x16x32_bf16 v[60:63], a[164:167], v[76:79], v[60:63]
    global_store_dwordx4 v224, v[162:165], s[38:39] offset:0 sc1
    v_mfma_f32_16x16x32_bf16 v[64:67], a[196:199], v[76:79], v[64:67]
    v_mov_b32 v158, -1
    v_mfma_f32_16x16x32_bf16 v[68:71], a[228:231], v[76:79], v[68:71]
    v_mfma_f32_16x16x32_bf16 v[48:51], a[72:75], v[80:83], v[48:51]
    v_mov_b32 v159, -1
    v_mfma_f32_16x16x32_bf16 v[52:55], a[104:107], v[80:83], v[52:55]
    v_mov_b32 v160, -1
    v_mfma_f32_16x16x32_bf16 v[56:59], a[136:139], v[80:83], v[56:59]
    v_mfma_f32_16x16x32_bf16 v[60:63], a[168:171], v[80:83], v[60:63]
    v_mov_b32 v161, -1
    v_mfma_f32_16x16x32_bf16 v[64:67], a[200:203], v[80:83], v[64:67]
    s_lshr_b32 s4, s5, 2
    v_mfma_f32_16x16x32_bf16 v[68:71], a[232:235], v[80:83], v[68:71]
    s_mul_i32 s4, s4, 114688
    v_mfma_f32_16x16x32_bf16 v[48:51], a[76:79], v[84:87], v[48:51]
    v_mfma_f32_16x16x32_bf16 v[52:55], a[108:111], v[84:87], v[52:55]
    s_and_b32 s5, s5, 3
    v_mfma_f32_16x16x32_bf16 v[56:59], a[140:143], v[84:87], v[56:59]
    s_lshl_b32 s5, s5, 13
    v_mfma_f32_16x16x32_bf16 v[60:63], a[172:175], v[84:87], v[60:63]
    v_mfma_f32_16x16x32_bf16 v[64:67], a[204:207], v[84:87], v[64:67]
    s_add_u32 s4, s4, s5
    v_mfma_f32_16x16x32_bf16 v[68:71], a[236:239], v[84:87], v[68:71]
    s_add_u32 s4, s4, 1134592
    v_mfma_f32_16x16x32_bf16 v[48:51], a[80:83], v[88:91], v[48:51]
    v_mfma_f32_16x16x32_bf16 v[52:55], a[112:115], v[88:91], v[52:55]
    v_lshl_add_u32 v224, v0, 4, s4
    v_mfma_f32_16x16x32_bf16 v[56:59], a[144:147], v[88:91], v[56:59]
    global_store_dwordx4 v224, v[158:161], s[38:39] offset:-4096 sc1
    v_mfma_f32_16x16x32_bf16 v[60:63], a[176:179], v[88:91], v[60:63]
    v_mfma_f32_16x16x32_bf16 v[64:67], a[208:211], v[88:91], v[64:67]
    global_store_dwordx4 v224, v[158:161], s[38:39] offset:0 sc1
    v_mfma_f32_16x16x32_bf16 v[68:71], a[240:243], v[88:91], v[68:71]
    s_min_u32 s4, s42, 127
    v_mfma_f32_16x16x32_bf16 v[48:51], a[84:87], v[92:95], v[48:51]
    v_mfma_f32_16x16x32_bf16 v[52:55], a[116:119], v[92:95], v[52:55]
    s_lshl_b32 s4, s4, 10
    v_mfma_f32_16x16x32_bf16 v[56:59], a[148:151], v[92:95], v[56:59]
    s_add_u32 s4, s4, 12451840
    v_mfma_f32_16x16x32_bf16 v[60:63], a[180:183], v[92:95], v[60:63]
    v_mfma_f32_16x16x32_bf16 v[64:67], a[212:215], v[92:95], v[64:67]
    v_lshl_add_u32 v224, v0, 2, s4
    v_mfma_f32_16x16x32_bf16 v[68:71], a[244:247], v[92:95], v[68:71]
    global_store_dword v224, v158, s[38:39] sc1
    v_mfma_f32_16x16x32_bf16 v[48:51], a[88:91], v[96:99], v[48:51]
    v_mfma_f32_16x16x32_bf16 v[52:55], a[120:123], v[96:99], v[52:55]
    v_mfma_f32_16x16x32_bf16 v[56:59], a[152:155], v[96:99], v[56:59]
    v_mfma_f32_16x16x32_bf16 v[60:63], a[184:187], v[96:99], v[60:63]
    v_mfma_f32_16x16x32_bf16 v[64:67], a[216:219], v[96:99], v[64:67]
    v_mfma_f32_16x16x32_bf16 v[68:71], a[248:251], v[96:99], v[68:71]
    v_mfma_f32_16x16x32_bf16 v[48:51], a[92:95], v[100:103], v[48:51]
    v_mfma_f32_16x16x32_bf16 v[52:55], a[124:127], v[100:103], v[52:55]
    v_mfma_f32_16x16x32_bf16 v[56:59], a[156:159], v[100:103], v[56:59]
    v_mfma_f32_16x16x32_bf16 v[60:63], a[188:191], v[100:103], v[60:63]
    v_mfma_f32_16x16x32_bf16 v[64:67], a[220:223], v[100:103], v[64:67]
    v_mfma_f32_16x16x32_bf16 v[68:71], a[252:255], v[100:103], v[68:71]
    v_mfma_f32_16x16x32_bf16 v[48:51], a[32:35], v[104:107], v[48:51]
    v_mfma_f32_16x16x32_bf16 v[52:55], a[64:67], v[104:107], v[52:55]
    v_mfma_f32_16x16x32_bf16 v[56:59], a[96:99], v[104:107], v[56:59]
    v_mfma_f32_16x16x32_bf16 v[60:63], a[128:131], v[104:107], v[60:63]
    v_mfma_f32_16x16x32_bf16 v[64:67], a[160:163], v[104:107], v[64:67]
    v_mfma_f32_16x16x32_bf16 v[68:71], a[192:195], v[104:107], v[68:71]
    v_mfma_f32_16x16x32_bf16 v[48:51], a[36:39], v[108:111], v[48:51]
    v_mfma_f32_16x16x32_bf16 v[52:55], a[68:71], v[108:111], v[52:55]
    v_mfma_f32_16x16x32_bf16 v[56:59], a[100:103], v[108:111], v[56:59]
    v_mfma_f32_16x16x32_bf16 v[60:63], a[132:135], v[108:111], v[60:63]
    v_mfma_f32_16x16x32_bf16 v[64:67], a[164:167], v[108:111], v[64:67]
    v_mfma_f32_16x16x32_bf16 v[68:71], a[196:199], v[108:111], v[68:71]
    v_mfma_f32_16x16x32_bf16 v[48:51], a[40:43], v[112:115], v[48:51]
    v_mfma_f32_16x16x32_bf16 v[52:55], a[72:75], v[112:115], v[52:55]
    v_mfma_f32_16x16x32_bf16 v[56:59], a[104:107], v[112:115], v[56:59]
    v_mfma_f32_16x16x32_bf16 v[60:63], a[136:139], v[112:115], v[60:63]
    v_mfma_f32_16x16x32_bf16 v[64:67], a[168:171], v[112:115], v[64:67]
    v_mfma_f32_16x16x32_bf16 v[68:71], a[200:203], v[112:115], v[68:71]
    v_mfma_f32_16x16x32_bf16 v[48:51], a[44:47], v[116:119], v[48:51]
    v_mfma_f32_16x16x32_bf16 v[52:55], a[76:79], v[116:119], v[52:55]
    v_mfma_f32_16x16x32_bf16 v[56:59], a[108:111], v[116:119], v[56:59]
    v_mfma_f32_16x16x32_bf16 v[60:63], a[140:143], v[116:119], v[60:63]
    v_mfma_f32_16x16x32_bf16 v[64:67], a[172:175], v[116:119], v[64:67]
    v_mfma_f32_16x16x32_bf16 v[68:71], a[204:207], v[116:119], v[68:71]
    v_mfma_f32_16x16x32_bf16 v[48:51], a[48:51], v[120:123], v[48:51]
    v_mfma_f32_16x16x32_bf16 v[52:55], a[80:83], v[120:123], v[52:55]
    v_mfma_f32_16x16x32_bf16 v[56:59], a[112:115], v[120:123], v[56:59]
    v_mfma_f32_16x16x32_bf16 v[60:63], a[144:147], v[120:123], v[60:63]
    v_mfma_f32_16x16x32_bf16 v[64:67], a[176:179], v[120:123], v[64:67]
    v_mfma_f32_16x16x32_bf16 v[68:71], a[208:211], v[120:123], v[68:71]
    v_mfma_f32_16x16x32_bf16 v[48:51], a[52:55], v[124:127], v[48:51]
    v_mfma_f32_16x16x32_bf16 v[52:55], a[84:87], v[124:127], v[52:55]
    v_mfma_f32_16x16x32_bf16 v[56:59], a[116:119], v[124:127], v[56:59]
    v_lshlrev_b32 v28, 4, v0
    v_add_u32 v28, 36864, v28
    v_mfma_f32_16x16x32_bf16 v[60:63], a[148:151], v[124:127], v[60:63]
    global_load_dwordx4 v[202:205], v28, s[38:39] offset:-4096 sc1
    v_mfma_f32_16x16x32_bf16 v[64:67], a[180:183], v[124:127], v[64:67]
    global_load_dwordx4 v[206:209], v28, s[38:39] offset:0 sc1
    v_mfma_f32_16x16x32_bf16 v[68:71], a[212:215], v[124:127], v[68:71]
    v_add_u32 v28, 8192, v28
    global_load_dwordx4 v[210:213], v28, s[38:39] offset:-4096 sc1
    v_mfma_f32_16x16x32_bf16 v[48:51], a[56:59], v[128:131], v[48:51]
    s_waitcnt vmcnt(12)
    ds_read_b128 v[72:75], v32 offset:2560
    global_load_dwordx4 v[214:217], v28, s[38:39] offset:0 sc1
    v_mfma_f32_16x16x32_bf16 v[52:55], a[88:91], v[128:131], v[52:55]
    v_min_u32 v28, 11, v1
    ds_read_b128 v[76:79], v32 offset:2624
    v_mfma_f32_16x16x32_bf16 v[56:59], a[120:123], v[128:131], v[56:59]
    v_lshrrev_b32 v29, 2, v28
    ds_read_b128 v[80:83], v32 offset:2688
    v_mfma_f32_16x16x32_bf16 v[60:63], a[152:155], v[128:131], v[60:63]
    v_mul_u32_u24 v29, 2544, v29
    ds_read_b128 v[84:87], v32 offset:2752
    v_mfma_f32_16x16x32_bf16 v[64:67], a[184:187], v[128:131], v[64:67]
    v_lshl_add_u32 v28, v28, 2, v29
    ds_read_b128 v[88:91], v32 offset:2816
    s_lshl_b32 s4, s42, 4
    v_mfma_f32_16x16x32_bf16 v[68:71], a[216:219], v[128:131], v[68:71]
    ds_read_b128 v[92:95], v32 offset:2880
    s_add_u32 s4, s4, 0
    v_add_u32 v28, s4, v28
    v_mfma_f32_16x16x32_bf16 v[48:51], a[60:63], v[132:135], v[48:51]
    ds_read_b128 v[96:99], v32 offset:2944
    global_load_dword v182, v28, s[38:39] sc1
    v_mfma_f32_16x16x32_bf16 v[52:55], a[92:95], v[132:135], v[52:55]
    ds_read_b128 v[100:103], v32 offset:3008
    v_add_u32 v28, 15360, v28
    v_mfma_f32_16x16x32_bf16 v[56:59], a[124:127], v[132:135], v[56:59]
    global_load_dword v183, v28, s[38:39] sc1
    v_mfma_f32_16x16x32_bf16 v[60:63], a[156:159], v[132:135], v[60:63]
    v_mfma_f32_16x16x32_bf16 v[64:67], a[188:191], v[132:135], v[64:67]
    global_load_dword v222, v137, s[38:39] sc1
    v_mfma_f32_16x16x32_bf16 v[68:71], a[220:223], v[132:135], v[68:71]
    s_waitcnt lgkmcnt(7)
    v_mfma_f32_16x16x32_bf16 v[48:51], a[0:3], v[72:75], v[48:51]
    ds_read_b128 v[104:107], v32 offset:2048
    v_mfma_f32_16x16x32_bf16 v[52:55], a[32:35], v[72:75], v[52:55]
    ds_read_b128 v[108:111], v32 offset:2112
    s_waitcnt lgkmcnt(8)
    v_mfma_f32_16x16x32_bf16 v[48:51], a[4:7], v[76:79], v[48:51]
    ds_read_b128 v[112:115], v32 offset:2176
    v_mfma_f32_16x16x32_bf16 v[52:55], a[36:39], v[76:79], v[52:55]
    ds_read_b128 v[116:119], v32 offset:2240
    s_waitcnt lgkmcnt(9)
    v_mfma_f32_16x16x32_bf16 v[48:51], a[8:11], v[80:83], v[48:51]
    ds_read_b128 v[120:123], v32 offset:2304
    v_mfma_f32_16x16x32_bf16 v[52:55], a[40:43], v[80:83], v[52:55]
    ds_read_b128 v[124:127], v32 offset:2368
    s_waitcnt lgkmcnt(10)
    v_mfma_f32_16x16x32_bf16 v[48:51], a[12:15], v[84:87], v[48:51]
    ds_read_b128 v[128:131], v32 offset:2432
    v_mfma_f32_16x16x32_bf16 v[52:55], a[44:47], v[84:87], v[52:55]
    ds_read_b128 v[132:135], v32 offset:2496
    s_waitcnt lgkmcnt(11)
    v_mfma_f32_16x16x32_bf16 v[48:51], a[16:19], v[88:91], v[48:51]
    v_mfma_f32_16x16x32_bf16 v[52:55], a[48:51], v[88:91], v[52:55]
    s_waitcnt lgkmcnt(10)
    v_mfma_f32_16x16x32_bf16 v[48:51], a[20:23], v[92:95], v[48:51]
    v_mfma_f32_16x16x32_bf16 v[52:55], a[52:55], v[92:95], v[52:55]
    s_waitcnt lgkmcnt(9)
    v_mfma_f32_16x16x32_bf16 v[48:51], a[24:27], v[96:99], v[48:51]
    v_mfma_f32_16x16x32_bf16 v[52:55], a[56:59], v[96:99], v[52:55]
    s_waitcnt lgkmcnt(8)
    v_mfma_f32_16x16x32_bf16 v[48:51], a[28:31], v[100:103], v[48:51]
    v_mfma_f32_16x16x32_bf16 v[52:55], a[60:63], v[100:103], v[52:55]
    s_waitcnt lgkmcnt(7)
    v_mfma_f32_16x16x32_bf16 v[52:55], a[0:3], v[104:107], v[52:55]
    s_waitcnt lgkmcnt(6)
    v_mfma_f32_16x16x32_bf16 v[52:55], a[4:7], v[108:111], v[52:55]
    s_waitcnt lgkmcnt(5)
    v_mfma_f32_16x16x32_bf16 v[52:55], a[8:11], v[112:115], v[52:55]
    s_waitcnt lgkmcnt(4)
    v_mfma_f32_16x16x32_bf16 v[52:55], a[12:15], v[116:119], v[52:55]
    s_waitcnt lgkmcnt(3)
    v_mfma_f32_16x16x32_bf16 v[52:55], a[16:19], v[120:123], v[52:55]
    s_waitcnt lgkmcnt(2)
    v_mfma_f32_16x16x32_bf16 v[52:55], a[20:23], v[124:127], v[52:55]
    s_waitcnt lgkmcnt(1)
    v_mfma_f32_16x16x32_bf16 v[52:55], a[24:27], v[128:131], v[52:55]
    s_waitcnt lgkmcnt(0)
    v_mfma_f32_16x16x32_bf16 v[52:55], a[28:31], v[132:135], v[52:55]
    v_mfma_f32_16x16x32_bf16 v[56:59], a[64:67], v[72:75], v[56:59]
    v_mfma_f32_16x16x32_bf16 v[60:63], a[96:99], v[72:75], v[60:63]
    v_mfma_f32_16x16x32_bf16 v[64:67], a[128:131], v[72:75], v[64:67]
    v_mfma_f32_16x16x32_bf16 v[68:71], a[160:163], v[72:75], v[68:71]
    v_mfma_f32_16x16x32_bf16 v[56:59], a[68:71], v[76:79], v[56:59]
    v_mfma_f32_16x16x32_bf16 v[60:63], a[100:103], v[76:79], v[60:63]
    v_mfma_f32_16x16x32_bf16 v[64:67], a[132:135], v[76:79], v[64:67]
    v_mfma_f32_16x16x32_bf16 v[68:71], a[164:167], v[76:79], v[68:71]
    v_mfma_f32_16x16x32_bf16 v[56:59], a[72:75], v[80:83], v[56:59]
    s_waitcnt vmcnt(0)
    v_cmp_eq_u32 vcc, -1, v222
    v_mfma_f32_16x16x32_bf16 v[60:63], a[104:107], v[80:83], v[60:63]
    v_mfma_f32_16x16x32_bf16 v[64:67], a[136:139], v[80:83], v[64:67]
    s_cbranch_vccnz Lcu_r
Lcu_ok:
    v_mfma_f32_16x16x32_bf16 v[68:71], a[168:171], v[80:83], v[68:71]
    v_mfma_f32_16x16x32_bf16 v[56:59], a[76:79], v[84:87], v[56:59]
    v_cvt_pk_bf16_f32 v138, v40, v41
    global_load_dwordx4 a[248:251], v4, s[12:13] offset:-1024 sc1
    v_mfma_f32_16x16x32_bf16 v[60:63], a[108:111], v[84:87], v[60:63]
    v_mfma_f32_16x16x32_bf16 v[64:67], a[140:143], v[84:87], v[64:67]
    v_cvt_pk_bf16_f32 v139, v42, v43
    v_mfma_f32_16x16x32_bf16 v[68:71], a[172:175], v[84:87], v[68:71]
    ds_write2_b32 v34, v138, v139 offset0:0 offset1:2
    v_mfma_f32_16x16x32_bf16 v[56:59], a[80:83], v[88:91], v[56:59]
    v_cvt_pk_bf16_f32 v140, v44, v45
    v_max_u32 v224, v203, v205
    v_mfma_f32_16x16x32_bf16 v[60:63], a[112:115], v[88:91], v[60:63]
    v_cvt_pk_bf16_f32 v141, v46, v47
    v_max3_u32 v224, v207, v209, v224
    v_mfma_f32_16x16x32_bf16 v[64:67], a[144:147], v[88:91], v[64:67]
    v_max3_u32 v224, v211, v213, v224
    ds_write2_b32 v34, v140, v141 offset0:128 offset1:130
    v_mfma_f32_16x16x32_bf16 v[68:71], a[176:179], v[88:91], v[68:71]
    v_max3_u32 v224, v215, v217, v224
    v_add_u32 v34, 4224, v34
    v_mfma_f32_16x16x32_bf16 v[56:59], a[84:87], v[92:95], v[56:59]
    v_max3_u32 v224, v182, v183, v224
    v_cmp_eq_u32 vcc, -1, v224
    s_nop 0
    s_cbranch_vccnz Lax_r
Lax_ok:
    v_mfma_f32_16x16x32_bf16 v[60:63], a[116:119], v[92:95], v[60:63]
    v_cvt_pk_bf16_f32 v138, v48, v49
    v_cvt_pk_bf16_f32 v139, v50, v51
    v_mfma_f32_16x16x32_bf16 v[64:67], a[148:151], v[92:95], v[64:67]
    v_add_u32 v36, 0, v37
    ds_write2_b32 v34, v138, v139 offset0:0 offset1:2
    s_add_u32 m0, s89, 0
    v_mfma_f32_16x16x32_bf16 v[68:71], a[180:183], v[92:95], v[68:71]
    global_load_dwordx4 v[186:189], v36, s[38:39] sc1
    v_add_u32 v36, 917504, v37
    v_mfma_f32_16x16x32_bf16 v[56:59], a[88:91], v[96:99], v[56:59]
    v_cvt_pk_bf16_f32 v140, v52, v53
    global_load_dwordx4 v[190:193], v36, s[38:39] sc1
    v_mfma_f32_16x16x32_bf16 v[60:63], a[120:123], v[96:99], v[60:63]
    v_cvt_pk_bf16_f32 v141, v54, v55
    v_add_u32 v36, 1835008, v37
    v_mfma_f32_16x16x32_bf16 v[64:67], a[152:155], v[96:99], v[64:67]
    ds_write2_b32 v34, v140, v141 offset0:128 offset1:130
    global_load_dwordx4 v[194:197], v36, s[38:39] sc1
    v_mfma_f32_16x16x32_bf16 v[68:71], a[184:187], v[96:99], v[68:71]
    v_add_u32 v36, 2752512, v37
    v_add_u32 v34, 4224, v34
    v_mfma_f32_16x16x32_bf16 v[56:59], a[92:95], v[100:103], v[56:59]
    s_waitcnt lgkmcnt(0)
    s_barrier
    global_load_dwordx4 v[198:201], v36, s[38:39] sc1
    v_mfma_f32_16x16x32_bf16 v[60:63], a[124:127], v[100:103], v[60:63]
    v_add_f32 v182, v182, v183
    v_cvt_pk_bf16_f32 v182, v182, v182
    v_mfma_f32_16x16x32_bf16 v[64:67], a[156:159], v[100:103], v[64:67]
    v_lshlrev_b32 v182, 16, v182
    global_load_dwordx4 a[252:255], v7, s[18:19] offset:-1024 sc1
    v_mfma_f32_16x16x32_bf16 v[68:71], a[188:191], v[100:103], v[68:71]
    v_mov_b32 v29, 1.0
    s_nop 1
    v_add_f32_dpp v182, v182, v29 quad_perm:[0,1,2,3] row_mask:0xf bank_mask:0x2
    v_mfma_f32_16x16x32_bf16 v[56:59], a[32:35], v[104:107], v[56:59]
    v_cvt_pk_bf16_f32 v182, v182, v182
    v_lshlrev_b32 v182, 16, v182
    v_mfma_f32_16x16x32_bf16 v[60:63], a[64:67], v[104:107], v[60:63]
    s_nop 0
    v_mul_f32_dpp v183, v182, v182 row_shl:8 row_mask:0xf bank_mask:0x1
    s_nop 1
    v_mul_f32_dpp v183, v182, v182 row_shl:4 row_mask:0xf bank_mask:0x2
    v_mfma_f32_16x16x32_bf16 v[64:67], a[96:99], v[104:107], v[64:67]
    v_readlane_b32 s64, v183, 0
    global_load_lds_dwordx4 v8, s[68:69] offset:0
    v_mfma_f32_16x16x32_bf16 v[68:71], a[128:131], v[104:107], v[68:71]
    v_readlane_b32 s65, v183, 1
    v_readlane_b32 s66, v183, 2
    v_mfma_f32_16x16x32_bf16 v[56:59], a[36:39], v[108:111], v[56:59]
    v_readlane_b32 s67, v183, 3
    v_readlane_b32 s60, v183, 4
    v_mfma_f32_16x16x32_bf16 v[60:63], a[68:71], v[108:111], v[60:63]
    v_readlane_b32 s61, v183, 5
    v_readlane_b32 s62, v183, 6
    v_mfma_f32_16x16x32_bf16 v[64:67], a[100:103], v[108:111], v[64:67]
    v_readlane_b32 s63, v183, 7
    v_mov_b32 v178, s64
    v_mfma_f32_16x16x32_bf16 v[68:71], a[132:135], v[108:111], v[68:71]
    v_mov_b32 v179, s65
    global_load_lds_dwordx4 v9, s[68:69] offset:1024
    v_mfma_f32_16x16x32_bf16 v[56:59], a[40:43], v[112:115], v[56:59]
    v_mov_b32 v180, s66
    v_mov_b32 v181, s67
    v_mfma_f32_16x16x32_bf16 v[60:63], a[72:75], v[112:115], v[60:63]
    global_load_dwordx4 a[240:243], v4, s[12:13] offset:-2048 sc1
    v_mfma_f32_16x16x32_bf16 v[64:67], a[104:107], v[112:115], v[64:67]
    v_mfma_f32_16x16x32_bf16 v[68:71], a[136:139], v[112:115], v[68:71]
    v_mfma_f32_16x16x32_bf16 v[56:59], a[44:47], v[116:119], v[56:59]
    global_load_lds_dwordx4 v10, s[68:69] offset:2048
    v_mfma_f32_16x16x32_bf16 v[60:63], a[76:79], v[116:119], v[60:63]
    v_mfma_f32_16x16x32_bf16 v[64:67], a[108:111], v[116:119], v[64:67]
    v_mfma_f32_16x16x32_bf16 v[68:71], a[140:143], v[116:119], v[68:71]
    v_mfma_f32_16x16x32_bf16 v[56:59], a[48:51], v[120:123], v[56:59]
    v_mfma_f32_16x16x32_bf16 v[60:63], a[80:83], v[120:123], v[60:63]
    v_mfma_f32_16x16x32_bf16 v[64:67], a[112:115], v[120:123], v[64:67]
    v_mfma_f32_16x16x32_bf16 v[68:71], a[144:147], v[120:123], v[68:71]
    global_load_dwordx4 a[244:247], v7, s[18:19] offset:-2048 sc1
    v_mfma_f32_16x16x32_bf16 v[56:59], a[52:55], v[124:127], v[56:59]
    ds_read_b128 v[72:75], v32 offset:1536
    global_load_lds_dwordx4 v11, s[68:69] offset:3072
    v_mfma_f32_16x16x32_bf16 v[60:63], a[84:87], v[124:127], v[60:63]
    ds_read_b128 v[76:79], v32 offset:1600
    v_mfma_f32_16x16x32_bf16 v[64:67], a[116:119], v[124:127], v[64:67]
    ds_read_b128 v[80:83], v32 offset:1664
    v_mfma_f32_16x16x32_bf16 v[68:71], a[148:151], v[124:127], v[68:71]
    ds_read_b128 v[84:87], v32 offset:1728
    v_mfma_f32_16x16x32_bf16 v[56:59], a[56:59], v[128:131], v[56:59]
    ds_read_b128 v[88:91], v32 offset:1792
    v_mfma_f32_16x16x32_bf16 v[60:63], a[88:91], v[128:131], v[60:63]
    ds_read_b128 v[92:95], v32 offset:1856
    v_mfma_f32_16x16x32_bf16 v[64:67], a[120:123], v[128:131], v[64:67]
    ds_read_b128 v[96:99], v32 offset:1920
    v_mfma_f32_16x16x32_bf16 v[68:71], a[152:155], v[128:131], v[68:71]
    ds_read_b128 v[100:103], v32 offset:1984
    s_add_u32 m0, s89, 4096
    v_mfma_f32_16x16x32_bf16 v[56:59], a[60:63], v[132:135], v[56:59]
    v_mfma_f32_16x16x32_bf16 v[60:63], a[92:95], v[132:135], v[60:63]
    v_mfma_f32_16x16x32_bf16 v[64:67], a[124:127], v[132:135], v[64:67]
    v_mfma_f32_16x16x32_bf16 v[68:71], a[156:159], v[132:135], v[68:71]
    s_waitcnt lgkmcnt(7)
    v_mfma_f32_16x16x32_bf16 v[56:59], a[0:3], v[72:75], v[56:59]
    ds_read_b128 v[104:107], v32 offset:1024
    global_load_dwordx4 a[232:235], v4, s[12:13] offset:-3072 sc1
    v_mfma_f32_16x16x32_bf16 v[60:63], a[32:35], v[72:75], v[60:63]
    ds_read_b128 v[108:111], v32 offset:1088
    s_waitcnt lgkmcnt(8)
    v_mfma_f32_16x16x32_bf16 v[56:59], a[4:7], v[76:79], v[56:59]
    ds_read_b128 v[112:115], v32 offset:1152
    v_mfma_f32_16x16x32_bf16 v[60:63], a[36:39], v[76:79], v[60:63]
    ds_read_b128 v[116:119], v32 offset:1216
    global_load_lds_dwordx4 v12, s[68:69] offset:0
    s_waitcnt lgkmcnt(9)
    v_mfma_f32_16x16x32_bf16 v[56:59], a[8:11], v[80:83], v[56:59]
    ds_read_b128 v[120:123], v32 offset:1280
    ds_read_b32 v150, v35 offset:0
    v_mfma_f32_16x16x32_bf16 v[60:63], a[40:43], v[80:83], v[60:63]
    ds_read_b128 v[124:127], v32 offset:1344
    ds_read_b32 v151, v35 offset:1056
    s_waitcnt lgkmcnt(12)
    v_mfma_f32_16x16x32_bf16 v[56:59], a[12:15], v[84:87], v[56:59]
    ds_read_b128 v[128:131], v32 offset:1408
    ds_read_b32 v152, v35 offset:2112
    v_mfma_f32_16x16x32_bf16 v[60:63], a[44:47], v[84:87], v[60:63]
    ds_read_b128 v[132:135], v32 offset:1472
    ds_read_b32 v153, v35 offset:3168
    s_waitcnt lgkmcnt(15)
    v_mfma_f32_16x16x32_bf16 v[56:59], a[16:19], v[88:91], v[56:59]
    ds_read_b32 v154, v33 offset:3072
    ds_read_b32 v155, v33 offset:12352
    v_mfma_f32_16x16x32_bf16 v[60:63], a[48:51], v[88:91], v[60:63]
    ds_read_b32 v156, v33 offset:21632
    ds_read_b32 v157, v33 offset:30912
    s_waitcnt lgkmcnt(15)
    v_mfma_f32_16x16x32_bf16 v[56:59], a[20:23], v[92:95], v[56:59]
    s_waitcnt vmcnt(12)
    v_lshlrev_b32 v158, 16, v186
    v_and_b32 v159, 0xffff0000, v186
    v_mfma_f32_16x16x32_bf16 v[60:63], a[52:55], v[92:95], v[60:63]
    v_lshlrev_b32 v160, 16, v187
    v_and_b32 v161, 0xffff0000, v187
    v_mfma_f32_16x16x32_bf16 v[56:59], a[24:27], v[96:99], v[56:59]
    v_lshlrev_b32 v162, 16, v188
    v_and_b32 v163, 0xffff0000, v188
    v_mfma_f32_16x16x32_bf16 v[60:63], a[56:59], v[96:99], v[60:63]
    v_lshlrev_b32 v164, 16, v189
    global_load_lds_dwordx4 v13, s[68:69] offset:1024
    v_mfma_f32_16x16x32_bf16 v[56:59], a[28:31], v[100:103], v[56:59]
    v_and_b32 v165, 0xffff0000, v189
    v_fma_f32 v166, v158, v202, v203
    v_mfma_f32_16x16x32_bf16 v[60:63], a[60:63], v[100:103], v[60:63]
    v_fma_f32 v167, v159, v202, v203
    v_fma_f32 v168, v160, v202, v203
    v_mfma_f32_16x16x32_bf16 v[60:63], a[0:3], v[104:107], v[60:63]
    global_load_dwordx4 a[236:239], v7, s[18:19] offset:-3072 sc1
    v_fma_f32 v169, v161, v202, v203
    s_waitcnt lgkmcnt(14)
    v_mfma_f32_16x16x32_bf16 v[60:63], a[4:7], v[108:111], v[60:63]
    v_fma_f32 v170, v162, v204, v205
    v_fma_f32 v171, v163, v204, v205
    s_waitcnt lgkmcnt(13)
    v_mfma_f32_16x16x32_bf16 v[60:63], a[8:11], v[112:115], v[60:63]
    v_fma_f32 v172, v164, v204, v205
    v_fma_f32 v173, v165, v204, v205
    s_waitcnt lgkmcnt(12)
    v_mfma_f32_16x16x32_bf16 v[60:63], a[12:15], v[116:119], v[60:63]
    v_fma_f32 v166, v166, s60, v178
    v_fma_f32 v167, v167, s61, v179
    s_waitcnt lgkmcnt(11)
    v_mfma_f32_16x16x32_bf16 v[60:63], a[16:19], v[120:123], v[60:63]
    v_fma_f32 v168, v168, s62, v180
    global_load_lds_dwordx4 v14, s[68:69] offset:2048
    s_waitcnt lgkmcnt(9)
    v_mfma_f32_16x16x32_bf16 v[60:63], a[20:23], v[124:127], v[60:63]
    v_fma_f32 v169, v169, s63, v181
    v_fma_f32 v170, v170, s60, v178
    s_waitcnt lgkmcnt(7)
    v_mfma_f32_16x16x32_bf16 v[60:63], a[24:27], v[128:131], v[60:63]
    v_fma_f32 v171, v171, s61, v179
    v_fma_f32 v172, v172, s62, v180
    s_waitcnt lgkmcnt(5)
    v_mfma_f32_16x16x32_bf16 v[60:63], a[28:31], v[132:135], v[60:63]
    v_fma_f32 v173, v173, s63, v181
    v_lshlrev_b32 v142, 16, v150
    v_mfma_f32_16x16x32_bf16 v[64:67], a[64:67], v[72:75], v[64:67]
    v_and_b32 v146, 0xffff0000, v150
    v_lshlrev_b32 v143, 16, v151
    v_mfma_f32_16x16x32_bf16 v[68:71], a[96:99], v[72:75], v[68:71]
    v_and_b32 v147, 0xffff0000, v151
    v_lshlrev_b32 v144, 16, v152
    v_mfma_f32_16x16x32_bf16 v[64:67], a[68:71], v[76:79], v[64:67]
    v_and_b32 v148, 0xffff0000, v152
    s_waitcnt lgkmcnt(4)
    v_lshlrev_b32 v145, 16, v153
    v_mfma_f32_16x16x32_bf16 v[68:71], a[100:103], v[76:79], v[68:71]
    v_and_b32 v149, 0xffff0000, v153
    global_load_lds_dwordx4 v15, s[68:69] offset:3072
    v_mfma_f32_16x16x32_bf16 v[64:67], a[72:75], v[80:83], v[64:67]
    s_waitcnt lgkmcnt(3)
    v_and_b32 v174, 0xffff0000, v154
    s_waitcnt lgkmcnt(2)
    v_and_b32 v175, 0xffff0000, v155
    v_mfma_f32_16x16x32_bf16 v[68:71], a[104:107], v[80:83], v[68:71]
    s_waitcnt lgkmcnt(1)
    v_and_b32 v176, 0xffff0000, v156
    global_load_dwordx4 a[224:227], v4, s[12:13] offset:-4096 sc1
    v_mfma_f32_16x16x32_bf16 v[64:67], a[76:79], v[84:87], v[64:67]
    s_waitcnt lgkmcnt(0)
    v_and_b32 v177, 0xffff0000, v157
    v_fmac_f32 v142, s52, v174
    v_mfma_f32_16x16x32_bf16 v[68:71], a[108:111], v[84:87], v[68:71]
    v_fmac_f32 v143, s53, v175
    v_fmac_f32 v144, s54, v176
    v_mfma_f32_16x16x32_bf16 v[64:67], a[80:83], v[88:91], v[64:67]
    v_fmac_f32 v145, s55, v177
    v_lshlrev_b32 v174, 16, v154
    v_mfma_f32_16x16x32_bf16 v[68:71], a[112:115], v[88:91], v[68:71]
    v_lshlrev_b32 v175, 16, v155
    v_lshlrev_b32 v176, 16, v156
    v_mfma_f32_16x16x32_bf16 v[64:67], a[84:87], v[92:95], v[64:67]
    v_lshlrev_b32 v177, 16, v157
    v_fmac_f32 v146, s52, v174
    v_mfma_f32_16x16x32_bf16 v[68:71], a[116:119], v[92:95], v[68:71]
    v_fmac_f32 v147, s53, v175
    v_fmac_f32 v148, s54, v176
    v_mfma_f32_16x16x32_bf16 v[64:67], a[88:91], v[96:99], v[64:67]
    v_fmac_f32 v149, s55, v177
    v_fma_f32 v158, v166, v142, v158
    v_mfma_f32_16x16x32_bf16 v[68:71], a[120:123], v[96:99], v[68:71]
    v_fma_f32 v159, v167, v143, v159
    v_fma_f32 v160, v168, v144, v160
    v_mfma_f32_16x16x32_bf16 v[64:67], a[92:95], v[100:103], v[64:67]
    v_fma_f32 v161, v169, v145, v161
    v_fma_f32 v162, v170, v146, v162
    v_mfma_f32_16x16x32_bf16 v[68:71], a[124:127], v[100:103], v[68:71]
    v_fma_f32 v163, v171, v147, v163
    v_fma_f32 v164, v172, v148, v164
    v_mfma_f32_16x16x32_bf16 v[64:67], a[32:35], v[104:107], v[64:67]
    v_fma_f32 v165, v173, v149, v165
    v_cvt_pk_bf16_f32 v186, v158, v159
    v_mfma_f32_16x16x32_bf16 v[68:71], a[64:67], v[104:107], v[68:71]
    v_cvt_pk_bf16_f32 v187, v160, v161
    v_mfma_f32_16x16x32_bf16 v[64:67], a[36:39], v[108:111], v[64:67]
    v_cvt_pk_bf16_f32 v188, v162, v163
    global_load_dwordx4 a[228:231], v7, s[18:19] offset:-4096 sc1
    v_mfma_f32_16x16x32_bf16 v[68:71], a[68:71], v[108:111], v[68:71]
    v_cvt_pk_bf16_f32 v189, v164, v165
    v_or_b32 v189, 1, v189
    v_mfma_f32_16x16x32_bf16 v[64:67], a[40:43], v[112:115], v[64:67]
    v_add_u32 v136, 0, v37
    global_store_dwordx4 v136, v[186:189], s[38:39] sc1
    v_mfma_f32_16x16x32_bf16 v[68:71], a[72:75], v[112:115], v[68:71]
    ds_read_b128 v[72:75], v32 offset:512
    ds_read_b128 v[76:79], v32 offset:576
    v_mfma_f32_16x16x32_bf16 v[64:67], a[44:47], v[116:119], v[64:67]
    v_cvt_pk_bf16_f32 v138, v56, v57
    ds_read_b128 v[80:83], v32 offset:640
    v_mfma_f32_16x16x32_bf16 v[68:71], a[76:79], v[116:119], v[68:71]
    v_cvt_pk_bf16_f32 v139, v58, v59
    ds_read_b128 v[84:87], v32 offset:704
    v_mfma_f32_16x16x32_bf16 v[64:67], a[48:51], v[120:123], v[64:67]
    ds_write2_b32 v34, v138, v139 offset0:0 offset1:2
    ds_read_b128 v[88:91], v32 offset:768
    v_mfma_f32_16x16x32_bf16 v[68:71], a[80:83], v[120:123], v[68:71]
    v_cvt_pk_bf16_f32 v140, v60, v61
    ds_read_b128 v[92:95], v32 offset:832
    v_mfma_f32_16x16x32_bf16 v[64:67], a[52:55], v[124:127], v[64:67]
    v_cvt_pk_bf16_f32 v141, v62, v63
    ds_read_b128 v[96:99], v32 offset:896
    v_mfma_f32_16x16x32_bf16 v[68:71], a[84:87], v[124:127], v[68:71]
    ds_read_b128 v[100:103], v32 offset:960
    ds_write2_b32 v34, v140, v141 offset0:128 offset1:130
    v_mfma_f32_16x16x32_bf16 v[64:67], a[56:59], v[128:131], v[64:67]
    v_add_u32 v34, 4224, v34
    s_waitcnt lgkmcnt(0)
    s_barrier
    v_mfma_f32_16x16x32_bf16 v[68:71], a[88:91], v[128:131], v[68:71]
    v_mfma_f32_16x16x32_bf16 v[64:67], a[60:63], v[132:135], v[64:67]
    v_mfma_f32_16x16x32_bf16 v[68:71], a[92:95], v[132:135], v[68:71]
    global_load_dwordx4 v[218:221], v223, s[38:39] sc1
    global_load_dwordx4 a[216:219], v4, s[10:11] offset:3072 sc1
    ds_read_b128 v[104:107], v32 offset:0
    ds_read_b128 v[108:111], v32 offset:64
    ds_read_b128 v[112:115], v32 offset:128
    ds_read_b128 v[116:119], v32 offset:192
    ds_read_b128 v[120:123], v32 offset:256
    ds_read_b128 v[124:127], v32 offset:320
    ds_read_b128 v[128:131], v32 offset:384
    ds_read_b128 v[132:135], v32 offset:448
    ds_read_b32 v150, v35 offset:4224
    ds_read_b32 v151, v35 offset:5280
    ds_read_b32 v152, v35 offset:6336
    ds_read_b32 v153, v35 offset:7392
    ds_read_b32 v154, v33 offset:2048
    ds_read_b32 v155, v33 offset:11328
    ds_read_b32 v156, v33 offset:20608
    ds_read_b32 v157, v33 offset:29888
    s_waitcnt vmcnt(20)
    v_lshlrev_b32 v158, 16, v190
    global_load_dwordx4 a[220:223], v7, s[16:17] offset:3072 sc1
    v_and_b32 v159, 0xffff0000, v190
    v_lshlrev_b32 v160, 16, v191
    v_and_b32 v161, 0xffff0000, v191
    v_lshlrev_b32 v162, 16, v192
    v_and_b32 v163, 0xffff0000, v192
    v_lshlrev_b32 v164, 16, v193
    v_and_b32 v165, 0xffff0000, v193
    v_pk_fma_f32 v[166:167], v[206:207], v[158:159], v[206:207] op_sel:[0,0,1] op_sel_hi:[0,1,1]
    v_pk_fma_f32 v[168:169], v[206:207], v[160:161], v[206:207] op_sel:[0,0,1] op_sel_hi:[0,1,1]
    v_pk_fma_f32 v[170:171], v[208:209], v[162:163], v[208:209] op_sel:[0,0,1] op_sel_hi:[0,1,1]
    v_pk_fma_f32 v[172:173], v[208:209], v[164:165], v[208:209] op_sel:[0,0,1] op_sel_hi:[0,1,1]
    v_pk_fma_f32 v[166:167], v[166:167], s[60:61], v[178:179] op_sel:[0,0,0] op_sel_hi:[1,1,1]
    v_pk_fma_f32 v[168:169], v[168:169], s[62:63], v[180:181] op_sel:[0,0,0] op_sel_hi:[1,1,1]
    v_pk_fma_f32 v[170:171], v[170:171], s[60:61], v[178:179] op_sel:[0,0,0] op_sel_hi:[1,1,1]
    v_pk_fma_f32 v[172:173], v[172:173], s[62:63], v[180:181] op_sel:[0,0,0] op_sel_hi:[1,1,1]
    s_waitcnt lgkmcnt(7)
    v_lshlrev_b32 v142, 16, v150
    v_and_b32 v146, 0xffff0000, v150
    global_load_dwordx4 a[208:211], v4, s[10:11] offset:2048 sc1
    s_waitcnt lgkmcnt(6)
    v_lshlrev_b32 v143, 16, v151
    v_and_b32 v147, 0xffff0000, v151
    s_waitcnt lgkmcnt(5)
    v_lshlrev_b32 v144, 16, v152
    v_and_b32 v148, 0xffff0000, v152
    s_waitcnt lgkmcnt(4)
    v_lshlrev_b32 v145, 16, v153
    v_and_b32 v149, 0xffff0000, v153
    s_waitcnt lgkmcnt(3)
    v_dot2_f32_bf16 v142, v154, s52, v142
    s_waitcnt lgkmcnt(2)
    v_dot2_f32_bf16 v143, v155, s53, v143
    s_waitcnt lgkmcnt(1)
    v_dot2_f32_bf16 v144, v156, s54, v144
    s_waitcnt lgkmcnt(0)
    v_dot2_f32_bf16 v145, v157, s55, v145
    v_dot2_f32_bf16 v146, v154, s56, v146
    v_dot2_f32_bf16 v147, v155, s57, v147
    v_dot2_f32_bf16 v148, v156, s58, v148
    v_dot2_f32_bf16 v149, v157, s59, v149
    v_pk_fma_f32 v[158:159], v[166:167], v[142:143], v[158:159] op_sel:[0,0,0] op_sel_hi:[1,1,1]
    v_pk_fma_f32 v[160:161], v[168:169], v[144:145], v[160:161] op_sel:[0,0,0] op_sel_hi:[1,1,1]
    v_pk_fma_f32 v[162:163], v[170:171], v[146:147], v[162:163] op_sel:[0,0,0] op_sel_hi:[1,1,1]
    global_load_dwordx4 a[212:215], v7, s[16:17] offset:2048 sc1
    v_pk_fma_f32 v[164:165], v[172:173], v[148:149], v[164:165] op_sel:[0,0,0] op_sel_hi:[1,1,1]
    v_cvt_pk_bf16_f32 v190, v158, v159
    v_cvt_pk_bf16_f32 v191, v160, v161
    v_cvt_pk_bf16_f32 v192, v162, v163
    v_cvt_pk_bf16_f32 v193, v164, v165
    v_or_b32 v193, 1, v193
    v_add_u32 v136, 917504, v37
    global_store_dwordx4 v136, v[190:193], s[38:39] sc1
    ds_read_b32 v150, v35 offset:8448
    ds_read_b32 v151, v35 offset:9504
    ds_read_b32 v152, v35 offset:10560
    ds_read_b32 v153, v35 offset:11616
    ds_read_b32 v154, v33 offset:1024
    ds_read_b32 v155, v33 offset:10304
    ds_read_b32 v156, v33 offset:19584
    ds_read_b32 v157, v33 offset:28864
    s_waitcnt vmcnt(23)
    v_lshlrev_b32 v158, 16, v194
    v_and_b32 v159, 0xffff0000, v194
    global_load_dwordx4 a[200:203], v4, s[10:11] offset:1024 sc1
    v_lshlrev_b32 v160, 16, v195
    v_and_b32 v161, 0xffff0000, v195
    v_lshlrev_b32 v162, 16, v196
    v_and_b32 v163, 0xffff0000, v196
    v_lshlrev_b32 v164, 16, v197
    v_and_b32 v165, 0xffff0000, v197
    v_pk_fma_f32 v[166:167], v[210:211], v[158:159], v[210:211] op_sel:[0,0,1] op_sel_hi:[0,1,1]
    v_pk_fma_f32 v[168:169], v[210:211], v[160:161], v[210:211] op_sel:[0,0,1] op_sel_hi:[0,1,1]
    v_pk_fma_f32 v[170:171], v[212:213], v[162:163], v[212:213] op_sel:[0,0,1] op_sel_hi:[0,1,1]
    v_pk_fma_f32 v[172:173], v[212:213], v[164:165], v[212:213] op_sel:[0,0,1] op_sel_hi:[0,1,1]
    v_pk_fma_f32 v[166:167], v[166:167], s[60:61], v[178:179] op_sel:[0,0,0] op_sel_hi:[1,1,1]
    v_pk_fma_f32 v[168:169], v[168:169], s[62:63], v[180:181] op_sel:[0,0,0] op_sel_hi:[1,1,1]
    v_pk_fma_f32 v[170:171], v[170:171], s[60:61], v[178:179] op_sel:[0,0,0] op_sel_hi:[1,1,1]
    v_pk_fma_f32 v[172:173], v[172:173], s[62:63], v[180:181] op_sel:[0,0,0] op_sel_hi:[1,1,1]
    s_waitcnt lgkmcnt(7)
    v_lshlrev_b32 v142, 16, v150
    v_and_b32 v146, 0xffff0000, v150
    s_waitcnt lgkmcnt(6)
    v_lshlrev_b32 v143, 16, v151
    global_load_dwordx4 a[204:207], v7, s[16:17] offset:1024 sc1
    v_and_b32 v147, 0xffff0000, v151
    s_waitcnt lgkmcnt(5)
    v_lshlrev_b32 v144, 16, v152
    v_and_b32 v148, 0xffff0000, v152
    s_waitcnt lgkmcnt(4)
    v_lshlrev_b32 v145, 16, v153
    v_and_b32 v149, 0xffff0000, v153
    s_waitcnt lgkmcnt(3)
    v_dot2_f32_bf16 v142, v154, s52, v142
    s_waitcnt lgkmcnt(2)
    v_dot2_f32_bf16 v143, v155, s53, v143
    s_waitcnt lgkmcnt(1)
    v_dot2_f32_bf16 v144, v156, s54, v144
    s_waitcnt lgkmcnt(0)
    v_dot2_f32_bf16 v145, v157, s55, v145
    v_dot2_f32_bf16 v146, v154, s56, v146
    v_dot2_f32_bf16 v147, v155, s57, v147
    v_dot2_f32_bf16 v148, v156, s58, v148
    v_dot2_f32_bf16 v149, v157, s59, v149
    v_pk_fma_f32 v[158:159], v[166:167], v[142:143], v[158:159] op_sel:[0,0,0] op_sel_hi:[1,1,1]
    v_pk_fma_f32 v[160:161], v[168:169], v[144:145], v[160:161] op_sel:[0,0,0] op_sel_hi:[1,1,1]
    v_pk_fma_f32 v[162:163], v[170:171], v[146:147], v[162:163] op_sel:[0,0,0] op_sel_hi:[1,1,1]
    v_pk_fma_f32 v[164:165], v[172:173], v[148:149], v[164:165] op_sel:[0,0,0] op_sel_hi:[1,1,1]
    global_load_dwordx4 a[192:195], v4, s[10:11] offset:0 sc1
    v_cvt_pk_bf16_f32 v194, v158, v159
    v_cvt_pk_bf16_f32 v195, v160, v161
    v_cvt_pk_bf16_f32 v196, v162, v163
    v_cvt_pk_bf16_f32 v197, v164, v165
    v_or_b32 v197, 1, v197
    v_add_u32 v136, 1835008, v37
    global_store_dwordx4 v136, v[194:197], s[38:39] sc1
    v_mfma_f32_16x16x32_bf16 v[64:67], a[0:3], v[72:75], v[64:67]
    v_mfma_f32_16x16x32_bf16 v[68:71], a[32:35], v[72:75], v[68:71]
    v_mfma_f32_16x16x32_bf16 v[64:67], a[4:7], v[76:79], v[64:67]
    v_mfma_f32_16x16x32_bf16 v[68:71], a[36:39], v[76:79], v[68:71]
    v_mfma_f32_16x16x32_bf16 v[64:67], a[8:11], v[80:83], v[64:67]
    v_mfma_f32_16x16x32_bf16 v[68:71], a[40:43], v[80:83], v[68:71]
    v_mfma_f32_16x16x32_bf16 v[64:67], a[12:15], v[84:87], v[64:67]
    v_mfma_f32_16x16x32_bf16 v[68:71], a[44:47], v[84:87], v[68:71]
    v_mfma_f32_16x16x32_bf16 v[64:67], a[16:19], v[88:91], v[64:67]
    v_mfma_f32_16x16x32_bf16 v[68:71], a[48:51], v[88:91], v[68:71]
    v_mfma_f32_16x16x32_bf16 v[64:67], a[20:23], v[92:95], v[64:67]
    global_load_dwordx4 a[196:199], v7, s[16:17] offset:0 sc1
    v_mfma_f32_16x16x32_bf16 v[68:71], a[52:55], v[92:95], v[68:71]
    v_mfma_f32_16x16x32_bf16 v[64:67], a[24:27], v[96:99], v[64:67]
    v_mfma_f32_16x16x32_bf16 v[68:71], a[56:59], v[96:99], v[68:71]
    v_mfma_f32_16x16x32_bf16 v[64:67], a[28:31], v[100:103], v[64:67]
    v_mfma_f32_16x16x32_bf16 v[68:71], a[60:63], v[100:103], v[68:71]
    v_mfma_f32_16x16x32_bf16 v[68:71], a[0:3], v[104:107], v[68:71]
    v_mfma_f32_16x16x32_bf16 v[68:71], a[4:7], v[108:111], v[68:71]
    v_mfma_f32_16x16x32_bf16 v[68:71], a[8:11], v[112:115], v[68:71]
    v_mfma_f32_16x16x32_bf16 v[68:71], a[12:15], v[116:119], v[68:71]
    v_mfma_f32_16x16x32_bf16 v[68:71], a[16:19], v[120:123], v[68:71]
    v_mfma_f32_16x16x32_bf16 v[68:71], a[20:23], v[124:127], v[68:71]
    v_mfma_f32_16x16x32_bf16 v[68:71], a[24:27], v[128:131], v[68:71]
    v_mfma_f32_16x16x32_bf16 v[68:71], a[28:31], v[132:135], v[68:71]
    v_cvt_pk_bf16_f32 v138, v64, v65
    v_cvt_pk_bf16_f32 v139, v66, v67
    ds_write2_b32 v34, v138, v139 offset0:0 offset1:2
    s_nop 4
    v_cvt_pk_bf16_f32 v140, v68, v69
    global_load_dwordx4 a[184:187], v4, s[10:11] offset:-1024 sc1
    v_cvt_pk_bf16_f32 v141, v70, v71
    ds_write2_b32 v34, v140, v141 offset0:128 offset1:130
    s_waitcnt lgkmcnt(0)
    s_barrier
    ds_read_b32 v150, v35 offset:12672
    ds_read_b32 v151, v35 offset:13728
    ds_read_b32 v152, v35 offset:14784
    ds_read_b32 v153, v35 offset:15840
    ds_read_b32 v154, v33 offset:0
    ds_read_b32 v155, v33 offset:9280
    ds_read_b32 v156, v33 offset:18560
    ds_read_b32 v157, v33 offset:27840
    s_waitcnt vmcnt(28)
    v_lshlrev_b32 v158, 16, v198
    v_and_b32 v159, 0xffff0000, v198
    v_lshlrev_b32 v160, 16, v199
    v_and_b32 v161, 0xffff0000, v199
    v_lshlrev_b32 v162, 16, v200
    global_load_dwordx4 a[188:191], v7, s[16:17] offset:-1024 sc1
    v_and_b32 v163, 0xffff0000, v200
    v_lshlrev_b32 v164, 16, v201
    v_and_b32 v165, 0xffff0000, v201
    v_pk_fma_f32 v[166:167], v[214:215], v[158:159], v[214:215] op_sel:[0,0,1] op_sel_hi:[0,1,1]
    v_pk_fma_f32 v[168:169], v[214:215], v[160:161], v[214:215] op_sel:[0,0,1] op_sel_hi:[0,1,1]
    v_pk_fma_f32 v[170:171], v[216:217], v[162:163], v[216:217] op_sel:[0,0,1] op_sel_hi:[0,1,1]
    v_pk_fma_f32 v[172:173], v[216:217], v[164:165], v[216:217] op_sel:[0,0,1] op_sel_hi:[0,1,1]
    v_pk_fma_f32 v[166:167], v[166:167], s[60:61], v[178:179] op_sel:[0,0,0] op_sel_hi:[1,1,1]
    v_pk_fma_f32 v[168:169], v[168:169], s[62:63], v[180:181] op_sel:[0,0,0] op_sel_hi:[1,1,1]
    v_pk_fma_f32 v[170:171], v[170:171], s[60:61], v[178:179] op_sel:[0,0,0] op_sel_hi:[1,1,1]
    v_pk_fma_f32 v[172:173], v[172:173], s[62:63], v[180:181] op_sel:[0,0,0] op_sel_hi:[1,1,1]
    s_waitcnt lgkmcnt(7)
    v_lshlrev_b32 v142, 16, v150
    v_and_b32 v146, 0xffff0000, v150
    s_waitcnt lgkmcnt(6)
    v_lshlrev_b32 v143, 16, v151
    v_and_b32 v147, 0xffff0000, v151
    s_waitcnt lgkmcnt(5)
    v_lshlrev_b32 v144, 16, v152
    v_and_b32 v148, 0xffff0000, v152
    s_waitcnt lgkmcnt(4)
    v_lshlrev_b32 v145, 16, v153
    v_and_b32 v149, 0xffff0000, v153
    s_waitcnt lgkmcnt(3)
    v_dot2_f32_bf16 v142, v154, s52, v142
    s_waitcnt lgkmcnt(2)
    v_dot2_f32_bf16 v143, v155, s53, v143
    s_waitcnt lgkmcnt(1)
    v_dot2_f32_bf16 v144, v156, s54, v144
    s_waitcnt lgkmcnt(0)
    v_dot2_f32_bf16 v145, v157, s55, v145
    v_dot2_f32_bf16 v146, v154, s56, v146
    v_dot2_f32_bf16 v147, v155, s57, v147
    v_dot2_f32_bf16 v148, v156, s58, v148
    v_dot2_f32_bf16 v149, v157, s59, v149
    v_pk_fma_f32 v[158:159], v[166:167], v[142:143], v[158:159] op_sel:[0,0,0] op_sel_hi:[1,1,1]
    v_pk_fma_f32 v[160:161], v[168:169], v[144:145], v[160:161] op_sel:[0,0,0] op_sel_hi:[1,1,1]
    v_pk_fma_f32 v[162:163], v[170:171], v[146:147], v[162:163] op_sel:[0,0,0] op_sel_hi:[1,1,1]
    v_pk_fma_f32 v[164:165], v[172:173], v[148:149], v[164:165] op_sel:[0,0,0] op_sel_hi:[1,1,1]
    v_cvt_pk_bf16_f32 v198, v158, v159
    v_cvt_pk_bf16_f32 v199, v160, v161
    v_cvt_pk_bf16_f32 v200, v162, v163
    v_cvt_pk_bf16_f32 v201, v164, v165
    v_or_b32 v201, 1, v201
    v_add_u32 v136, 2752512, v37
    global_store_dwordx4 v136, v[198:201], s[38:39] sc1
    s_waitcnt lgkmcnt(0)
    s_barrier
    s_waitcnt vmcnt(13)
    v_max_u32 v224, v218, v219
    v_max3_u32 v224, v220, v221, v224
    v_cmp_eq_u32 vcc, -1, v224
    s_nop 0
    s_cbranch_vccnz Lcv_r
Lcv_ok:
    v_permlane32_swap_b32 v218, v220
    v_permlane32_swap_b32 v219, v221
    s_lshl_b32 s4, s3, 9
    s_add_u32 s4, s4, 156672
    v_and_b32 v223, 496, v4
    v_add_f32 v218, v218, v220
    v_add_f32 v219, v219, v221
    v_bfe_u32 v220, v1, 3, 1
    v_cmp_gt_u32 vcc, s101, v220
    v_lshrrev_b32 v220, 5, v1
    v_lshl_add_u32 v223, v220, 3, v223
    v_cndmask_b32 v218, 0, v218, vcc
    v_cndmask_b32 v219, 0, v219, vcc
    v_add_u32 v223, s4, v223
    ds_write_b64 v223, v[218:219]
    global_load_dwordx4 a[176:179], v4, s[10:11] offset:-2048 sc1
    global_load_dwordx4 a[180:183], v7, s[16:17] offset:-2048 sc1
    global_load_dwordx4 a[168:171], v4, s[10:11] offset:-3072 sc1
    global_load_dwordx4 a[172:175], v7, s[16:17] offset:-3072 sc1
    global_load_dwordx4 a[160:163], v4, s[10:11] offset:-4096 sc1
    global_load_dwordx4 a[164:167], v7, s[16:17] offset:-4096 sc1
    global_load_dwordx4 a[152:155], v4, s[8:9] offset:3072 sc1
    global_load_dwordx4 a[156:159], v7, s[14:15] offset:3072 sc1
    global_load_dwordx4 a[144:147], v4, s[8:9] offset:2048 sc1
    global_load_dwordx4 a[148:151], v7, s[14:15] offset:2048 sc1
    global_load_dwordx4 a[136:139], v4, s[8:9] offset:1024 sc1
    global_load_dwordx4 a[140:143], v7, s[14:15] offset:1024 sc1
    global_load_dwordx4 a[128:131], v4, s[8:9] offset:0 sc1
    global_load_dwordx4 a[132:135], v7, s[14:15] offset:0 sc1
Ljoin:
    v_and_b32 v28, 7, v1
    v_lshl_add_u32 v28, v3, 3, v28
    v_bfe_u32 v29, v1, 3, 1
    v_lshlrev_b32 v66, 9, v29
    v_lshl_add_u32 v66, v28, 4, v66
    s_mul_i32 s4, s3, 20480
    s_mul_i32 s5, s40, 114688
    s_add_u32 s4, s4, s5
    s_add_u32 s4, s4, 1048576
    v_add_u32 v66, s4, v66
    v_lshl_add_u32 v70, v28, 1, v29
    v_min_u32 v72, 39, v1
    v_lshl_add_u32 v72, v72, 9, s4
    s_bfe_u32 s6, s2, 0x30003
    v_mul_u32_u24 v254, 8, v0
    v_add_lshl_u32 v254, v254, s6, 7
    v_min_u32 v254, (Lmid-Lx_go-4), v254
    v_add_u32 v254, (Lx_go-adaLN_cond__ssm_conv_h3__mixer_gmlp__prompt_kernel), v254
    global_load_dword v254, v254, s[0:1]
    s_cmp_lt_u32 s43, 4
    s_cbranch_scc1 Lx_first
Lx_redo:
    s_branch Lxp_f
Lxp:
    s_sleep 1
Lxp_f:
    global_load_dword v71, v72, s[38:39] offset:508 sc1
    s_waitcnt vmcnt(0)
    v_and_b32 v71, 1, v71
    v_cmp_ne_u32 vcc, 1, v71
    s_add_u32 s100, s100, 1
    s_cmp_ge_u32 s100, 262144
    s_cbranch_scc1 Lxp_x
    s_cbranch_vccnz Lxp
Lxp_x:
Lx_first:
    s_mov_b32 s7, 0x3f803f80
    v_add_u32 v67, 4096, v66
    global_load_dwordx4 v[98:101], v67, s[38:39] offset:-4096 sc1
    global_load_dwordx4 v[102:105], v67, s[38:39] offset:-3072 sc1
    global_load_dwordx4 v[106:109], v67, s[38:39] offset:-2048 sc1
    global_load_dwordx4 v[110:113], v67, s[38:39] offset:-1024 sc1
    global_load_dwordx4 v[114:117], v67, s[38:39] offset:0 sc1
    global_load_dwordx4 v[118:121], v67, s[38:39] offset:1024 sc1
    global_load_dwordx4 v[122:125], v67, s[38:39] offset:2048 sc1
    global_load_dwordx4 v[126:129], v67, s[38:39] offset:3072 sc1
    v_add_u32 v67, 8192, v67
    global_load_dwordx4 v[130:133], v67, s[38:39] offset:-4096 sc1
    global_load_dwordx4 v[134:137], v67, s[38:39] offset:-3072 sc1
    v_lshrrev_b32 v28, 5, v1
    v_bfe_u32 v68, v1, 1, 1
    v_lshl_add_u32 v28, v28, 1, v68
    v_mul_u32_u24 v68, 1040, v28
    v_bfe_u32 v28, v1, 3, 1
    v_lshl_add_u32 v68, v28, 3, v68
    v_bfe_u32 v28, v1, 2, 1
    v_lshl_add_u32 v68, v28, 6, v68
    v_bfe_u32 v28, v1, 4, 1
    v_lshl_add_u32 v68, v28, 7, v68
    v_bfe_u32 v28, v1, 0, 1
    v_lshl_add_u32 v68, v28, 5, v68
    s_mul_i32 s5, s3, 20800
    v_add_u32 v68, s5, v68
    v_lshlrev_b32 v30, 3, v1
    s_lshl_b32 s88, s3, 9
    v_lshrrev_b32 v28, 3, v1
    v_lshlrev_b32 v28, 12, v28
    v_bfe_u32 v29, v1, 4, 1
    v_xor_b32 v29, v29, v1
    v_and_b32 v29, 7, v29
    v_xor_b32 v74, 0, v29
    v_lshl_add_u32 v74, v74, 4, v28
    v_add_u32 v78, 131072, v74
    v_xor_b32 v75, 2, v29
    v_lshl_add_u32 v75, v75, 4, v28
    v_add_u32 v75, 31744, v75
    v_add_u32 v79, 131072, v75
    v_xor_b32 v76, 4, v29
    v_lshl_add_u32 v76, v76, 4, v28
    v_add_u32 v76, 63488, v76
    v_add_u32 v80, 131072, v76
    v_xor_b32 v77, 6, v29
    v_lshl_add_u32 v77, v77, 4, v28
    v_add_u32 v77, 95232, v77
    v_add_u32 v81, 131072, v77
    v_lshrrev_b32 v29, 1, v2
    v_xor_b32 v29, v29, v3
    v_lshlrev_b32 v29, 4, v29
    v_lshl_add_u32 v29, v5, 7, v29
    s_xor_b32 s4, s3, 0
    s_lshr_b32 s5, s4, 1
    s_lshl_b32 s5, s5, 12
    s_and_b32 s4, s4, 1
    s_lshl_b32 s4, s4, 9
    s_add_u32 s4, s4, s5
    s_add_u32 s4, s4, s89
    v_add_u32 v82, s4, v29
    v_xor_b32 v83, 64, v82
    s_xor_b32 s4, s3, 1
    s_lshr_b32 s5, s4, 1
    s_lshl_b32 s5, s5, 12
    s_and_b32 s4, s4, 1
    s_lshl_b32 s4, s4, 9
    s_add_u32 s4, s4, s5
    s_add_u32 s4, s4, s89
    v_add_u32 v84, s4, v29
    v_xor_b32 v85, 64, v84
    s_xor_b32 s4, s3, 2
    s_lshr_b32 s5, s4, 1
    s_lshl_b32 s5, s5, 12
    s_and_b32 s4, s4, 1
    s_lshl_b32 s4, s4, 9
    s_add_u32 s4, s4, s5
    s_add_u32 s4, s4, s89
    v_add_u32 v86, s4, v29
    v_xor_b32 v87, 64, v86
    s_xor_b32 s4, s3, 3
    s_lshr_b32 s5, s4, 1
    s_lshl_b32 s5, s5, 12
    s_and_b32 s4, s4, 1
    s_lshl_b32 s4, s4, 9
    s_add_u32 s4, s4, s5
    s_add_u32 s4, s4, s89
    v_add_u32 v88, s4, v29
    v_xor_b32 v89, 64, v88
    s_add_u32 s52, s8, 1146880
    s_addc_u32 s53, s9, 0
    s_add_u32 s54, s10, 1146880
    s_addc_u32 s55, s11, 0
    s_add_u32 s56, s12, 1146880
    s_addc_u32 s57, s13, 0
    s_add_u32 s58, s14, 1146880
    s_addc_u32 s59, s15, 0
    s_add_u32 s60, s16, 1146880
    s_addc_u32 s61, s17, 0
    s_add_u32 s62, s18, 1146880
    s_addc_u32 s63, s19, 0
    s_mov_b32 s84, 0xc0135761
    s_mov_b32 s85, 0xbdd2d3e8
    v_lshlrev_b32 v32, 16, v27
    v_lshlrev_b32 v33, 16, v27
    v_lshlrev_b32 v34, 16, v27
    v_lshlrev_b32 v35, 16, v27
    s_mul_i32 s5, s41, 10
    s_mul_i32 s6, s3, 1040
    v_add_u32 v28, s5, v3
    v_lshrrev_b32 v29, 2, v28
    v_mul_u32_u24 v29, 3136, v29
    v_lshl_add_u32 v29, v28, 8, v29
    v_lshl_add_u32 v29, v2, 4, v29
    v_add_u32 v46, s6, v29
    v_lshrrev_b32 v28, 1, v3
    v_add_u32 v28, s5, v28
    v_lshrrev_b32 v29, 2, v28
    v_mul_u32_u24 v29, 3136, v29
    v_lshl_add_u32 v29, v28, 8, v29
    v_lshl_add_u32 v29, v2, 4, v29
    v_add_u32 v47, s6, v29
    v_and_b32 v28, 1, v3
    v_lshl_add_u32 v47, v28, 3, v47
    v_mov_b32 v62, 0
    v_mov_b32 v63, 0
    v_mov_b32 v64, 0
    v_mov_b32 v65, 0
    v_mov_b32 v71, -1
    global_load_dwordx4 v[138:141], v67, s[38:39] offset:-2048 sc1
    v_add_u32 v69, 0, v68
    s_waitcnt vmcnt(10)
    ds_write2_b64 v69, v[98:99], v[100:101] offset0:0 offset1:2
    v_dot2_f32_bf16 v62, v98, s7, v62
    v_dot2_f32_bf16 v63, v98, v98, v63
    v_dot2_f32_bf16 v64, v100, s7, v64
    v_dot2_f32_bf16 v65, v100, v100, v65
    v_dot2_f32_bf16 v62, v99, s7, v62
    v_dot2_f32_bf16 v63, v99, v99, v63
    v_dot2_f32_bf16 v64, v101, s7, v64
    v_dot2_f32_bf16 v65, v101, v101, v65
    global_load_dwordx4 v[142:145], v67, s[38:39] offset:-1024 sc1
    s_waitcnt vmcnt(10)
    ds_write2_b64 v69, v[102:103], v[104:105] offset0:32 offset1:34
    v_bitop3_b32 v71, v101, v105, v71 bitop3:0x80
    v_dot2_f32_bf16 v62, v102, s7, v62
    v_dot2_f32_bf16 v63, v102, v102, v63
    v_dot2_f32_bf16 v64, v104, s7, v64
    v_dot2_f32_bf16 v65, v104, v104, v65
    v_dot2_f32_bf16 v62, v103, s7, v62
    v_dot2_f32_bf16 v63, v103, v103, v63
    v_dot2_f32_bf16 v64, v105, s7, v64
    v_dot2_f32_bf16 v65, v105, v105, v65
    global_load_dwordx4 v[146:149], v67, s[38:39] offset:0 sc1
    s_waitcnt vmcnt(10)
    ds_write2_b64 v69, v[106:107], v[108:109] offset0:64 offset1:66
    v_dot2_f32_bf16 v62, v106, s7, v62
    v_dot2_f32_bf16 v63, v106, v106, v63
    v_dot2_f32_bf16 v64, v108, s7, v64
    v_dot2_f32_bf16 v65, v108, v108, v65
    v_dot2_f32_bf16 v62, v107, s7, v62
    v_dot2_f32_bf16 v63, v107, v107, v63
    v_dot2_f32_bf16 v64, v109, s7, v64
    v_dot2_f32_bf16 v65, v109, v109, v65
    global_load_dwordx4 v[150:153], v67, s[38:39] offset:1024 sc1
    s_waitcnt vmcnt(10)
    ds_write2_b64 v69, v[110:111], v[112:113] offset0:96 offset1:98
    v_bitop3_b32 v71, v109, v113, v71 bitop3:0x80
    v_dot2_f32_bf16 v62, v110, s7, v62
    v_dot2_f32_bf16 v63, v110, v110, v63
    v_dot2_f32_bf16 v64, v112, s7, v64
    v_dot2_f32_bf16 v65, v112, v112, v65
    v_dot2_f32_bf16 v62, v111, s7, v62
    v_dot2_f32_bf16 v63, v111, v111, v63
    v_dot2_f32_bf16 v64, v113, s7, v64
    v_dot2_f32_bf16 v65, v113, v113, v65
    global_load_dwordx4 v[154:157], v67, s[38:39] offset:2048 sc1
    v_add_u32 v69, 4160, v68
    s_waitcnt vmcnt(10)
    ds_write2_b64 v69, v[114:115], v[116:117] offset0:0 offset1:2
    v_dot2_f32_bf16 v62, v114, s7, v62
    v_dot2_f32_bf16 v63, v114, v114, v63
    v_dot2_f32_bf16 v64, v116, s7, v64
    v_dot2_f32_bf16 v65, v116, v116, v65
    v_dot2_f32_bf16 v62, v115, s7, v62
    v_dot2_f32_bf16 v63, v115, v115, v63
    v_dot2_f32_bf16 v64, v117, s7, v64
    v_dot2_f32_bf16 v65, v117, v117, v65
    global_load_dwordx4 v[158:161], v67, s[38:39] offset:3072 sc1
    v_add_u32 v67, 8192, v67
    s_waitcnt vmcnt(10)
    ds_write2_b64 v69, v[118:119], v[120:121] offset0:32 offset1:34
    v_bitop3_b32 v71, v117, v121, v71 bitop3:0x80
    v_dot2_f32_bf16 v62, v118, s7, v62
    v_dot2_f32_bf16 v63, v118, v118, v63
    v_dot2_f32_bf16 v64, v120, s7, v64
    v_dot2_f32_bf16 v65, v120, v120, v65
    v_dot2_f32_bf16 v62, v119, s7, v62
    v_dot2_f32_bf16 v63, v119, v119, v63
    v_dot2_f32_bf16 v64, v121, s7, v64
    v_dot2_f32_bf16 v65, v121, v121, v65
    global_load_dwordx4 v[162:165], v67, s[38:39] offset:-4096 sc1
    s_waitcnt vmcnt(10)
    ds_write2_b64 v69, v[122:123], v[124:125] offset0:64 offset1:66
    v_dot2_f32_bf16 v62, v122, s7, v62
    v_dot2_f32_bf16 v63, v122, v122, v63
    v_dot2_f32_bf16 v64, v124, s7, v64
    v_dot2_f32_bf16 v65, v124, v124, v65
    v_dot2_f32_bf16 v62, v123, s7, v62
    v_dot2_f32_bf16 v63, v123, v123, v63
    v_dot2_f32_bf16 v64, v125, s7, v64
    v_dot2_f32_bf16 v65, v125, v125, v65
    global_load_dwordx4 v[166:169], v67, s[38:39] offset:-3072 sc1
    s_waitcnt vmcnt(10)
    ds_write2_b64 v69, v[126:127], v[128:129] offset0:96 offset1:98
    v_bitop3_b32 v71, v125, v129, v71 bitop3:0x80
    v_dot2_f32_bf16 v62, v126, s7, v62
    v_dot2_f32_bf16 v63, v126, v126, v63
    v_dot2_f32_bf16 v64, v128, s7, v64
    v_dot2_f32_bf16 v65, v128, v128, v65
    v_dot2_f32_bf16 v62, v127, s7, v62
    v_dot2_f32_bf16 v63, v127, v127, v63
    v_dot2_f32_bf16 v64, v129, s7, v64
    v_dot2_f32_bf16 v65, v129, v129, v65
    global_load_dwordx4 v[170:173], v67, s[38:39] offset:-2048 sc1
    v_add_u32 v69, 8320, v68
    s_waitcnt vmcnt(10)
    ds_write2_b64 v69, v[130:131], v[132:133] offset0:0 offset1:2
    v_dot2_f32_bf16 v62, v130, s7, v62
    v_dot2_f32_bf16 v63, v130, v130, v63
    v_dot2_f32_bf16 v64, v132, s7, v64
    v_dot2_f32_bf16 v65, v132, v132, v65
    v_dot2_f32_bf16 v62, v131, s7, v62
    v_dot2_f32_bf16 v63, v131, v131, v63
    v_dot2_f32_bf16 v64, v133, s7, v64
    v_dot2_f32_bf16 v65, v133, v133, v65
    global_load_dwordx4 v[174:177], v67, s[38:39] offset:-1024 sc1
    s_waitcnt vmcnt(10)
    ds_write2_b64 v69, v[134:135], v[136:137] offset0:32 offset1:34
    v_bitop3_b32 v71, v133, v137, v71 bitop3:0x80
    v_dot2_f32_bf16 v62, v134, s7, v62
    v_dot2_f32_bf16 v63, v134, v134, v63
    v_dot2_f32_bf16 v64, v136, s7, v64
    v_dot2_f32_bf16 v65, v136, v136, v65
    v_dot2_f32_bf16 v62, v135, s7, v62
    v_dot2_f32_bf16 v63, v135, v135, v63
    v_dot2_f32_bf16 v64, v137, s7, v64
    v_dot2_f32_bf16 v65, v137, v137, v65
    global_load_dwordx4 a[96:99], v4, s[8:9] offset:-4096 sc1
    s_waitcnt vmcnt(10)
    ds_write2_b64 v69, v[138:139], v[140:141] offset0:64 offset1:66
    v_dot2_f32_bf16 v62, v138, s7, v62
    v_dot2_f32_bf16 v63, v138, v138, v63
    v_dot2_f32_bf16 v64, v140, s7, v64
    v_dot2_f32_bf16 v65, v140, v140, v65
    v_dot2_f32_bf16 v62, v139, s7, v62
    v_dot2_f32_bf16 v63, v139, v139, v63
    v_dot2_f32_bf16 v64, v141, s7, v64
    v_dot2_f32_bf16 v65, v141, v141, v65
    global_load_dwordx4 a[100:103], v7, s[14:15] offset:-4096 sc1
    s_waitcnt vmcnt(10)
    ds_write2_b64 v69, v[142:143], v[144:145] offset0:96 offset1:98
    v_bitop3_b32 v71, v141, v145, v71 bitop3:0x80
    v_dot2_f32_bf16 v62, v142, s7, v62
    v_dot2_f32_bf16 v63, v142, v142, v63
    v_dot2_f32_bf16 v64, v144, s7, v64
    v_dot2_f32_bf16 v65, v144, v144, v65
    v_dot2_f32_bf16 v62, v143, s7, v62
    v_dot2_f32_bf16 v63, v143, v143, v63
    v_dot2_f32_bf16 v64, v145, s7, v64
    v_dot2_f32_bf16 v65, v145, v145, v65
    global_load_dwordx4 a[104:107], v4, s[8:9] offset:-3072 sc1
    v_add_u32 v69, 12480, v68
    s_waitcnt vmcnt(10)
    ds_write2_b64 v69, v[146:147], v[148:149] offset0:0 offset1:2
    v_dot2_f32_bf16 v62, v146, s7, v62
    v_dot2_f32_bf16 v63, v146, v146, v63
    v_dot2_f32_bf16 v64, v148, s7, v64
    v_dot2_f32_bf16 v65, v148, v148, v65
    v_dot2_f32_bf16 v62, v147, s7, v62
    v_dot2_f32_bf16 v63, v147, v147, v63
    v_dot2_f32_bf16 v64, v149, s7, v64
    v_dot2_f32_bf16 v65, v149, v149, v65
    global_load_dwordx4 a[108:111], v7, s[14:15] offset:-3072 sc1
    s_waitcnt vmcnt(10)
    ds_write2_b64 v69, v[150:151], v[152:153] offset0:32 offset1:34
    v_bitop3_b32 v71, v149, v153, v71 bitop3:0x80
    v_dot2_f32_bf16 v62, v150, s7, v62
    v_dot2_f32_bf16 v63, v150, v150, v63
    v_dot2_f32_bf16 v64, v152, s7, v64
    v_dot2_f32_bf16 v65, v152, v152, v65
    v_dot2_f32_bf16 v62, v151, s7, v62
    v_dot2_f32_bf16 v63, v151, v151, v63
    v_dot2_f32_bf16 v64, v153, s7, v64
    v_dot2_f32_bf16 v65, v153, v153, v65
    global_load_dwordx4 a[112:115], v4, s[8:9] offset:-2048 sc1
    s_waitcnt vmcnt(10)
    ds_write2_b64 v69, v[154:155], v[156:157] offset0:64 offset1:66
    v_dot2_f32_bf16 v62, v154, s7, v62
    v_dot2_f32_bf16 v63, v154, v154, v63
    v_dot2_f32_bf16 v64, v156, s7, v64
    v_dot2_f32_bf16 v65, v156, v156, v65
    v_dot2_f32_bf16 v62, v155, s7, v62
    v_dot2_f32_bf16 v63, v155, v155, v63
    v_dot2_f32_bf16 v64, v157, s7, v64
    v_dot2_f32_bf16 v65, v157, v157, v65
    global_load_dwordx4 a[116:119], v7, s[14:15] offset:-2048 sc1
    s_waitcnt vmcnt(10)
    ds_write2_b64 v69, v[158:159], v[160:161] offset0:96 offset1:98
    v_bitop3_b32 v71, v157, v161, v71 bitop3:0x80
    v_dot2_f32_bf16 v62, v158, s7, v62
    v_dot2_f32_bf16 v63, v158, v158, v63
    v_dot2_f32_bf16 v64, v160, s7, v64
    v_dot2_f32_bf16 v65, v160, v160, v65
    v_dot2_f32_bf16 v62, v159, s7, v62
    v_dot2_f32_bf16 v63, v159, v159, v63
    v_dot2_f32_bf16 v64, v161, s7, v64
    v_dot2_f32_bf16 v65, v161, v161, v65
    global_load_dwordx4 a[120:123], v4, s[8:9] offset:-1024 sc1
    v_add_u32 v69, 16640, v68
    s_waitcnt vmcnt(10)
    ds_write2_b64 v69, v[162:163], v[164:165] offset0:0 offset1:2
    v_dot2_f32_bf16 v62, v162, s7, v62
    v_dot2_f32_bf16 v63, v162, v162, v63
    v_dot2_f32_bf16 v64, v164, s7, v64
    v_dot2_f32_bf16 v65, v164, v164, v65
    v_dot2_f32_bf16 v62, v163, s7, v62
    v_dot2_f32_bf16 v63, v163, v163, v63
    v_dot2_f32_bf16 v64, v165, s7, v64
    v_dot2_f32_bf16 v65, v165, v165, v65
    global_load_dwordx4 a[124:127], v7, s[14:15] offset:-1024 sc1
    s_waitcnt vmcnt(10)
    ds_write2_b64 v69, v[166:167], v[168:169] offset0:32 offset1:34
    v_bitop3_b32 v71, v165, v169, v71 bitop3:0x80
    v_dot2_f32_bf16 v62, v166, s7, v62
    v_dot2_f32_bf16 v63, v166, v166, v63
    v_dot2_f32_bf16 v64, v168, s7, v64
    v_dot2_f32_bf16 v65, v168, v168, v65
    v_dot2_f32_bf16 v62, v167, s7, v62
    v_dot2_f32_bf16 v63, v167, v167, v63
    v_dot2_f32_bf16 v64, v169, s7, v64
    v_dot2_f32_bf16 v65, v169, v169, v65
    s_waitcnt vmcnt(9)
    ds_write2_b64 v69, v[170:171], v[172:173] offset0:64 offset1:66
    v_dot2_f32_bf16 v62, v170, s7, v62
    v_dot2_f32_bf16 v63, v170, v170, v63
    v_dot2_f32_bf16 v64, v172, s7, v64
    v_dot2_f32_bf16 v65, v172, v172, v65
    v_dot2_f32_bf16 v62, v171, s7, v62
    v_dot2_f32_bf16 v63, v171, v171, v63
    v_dot2_f32_bf16 v64, v173, s7, v64
    v_dot2_f32_bf16 v65, v173, v173, v65
    s_waitcnt vmcnt(8)
    ds_write2_b64 v69, v[174:175], v[176:177] offset0:96 offset1:98
    v_bitop3_b32 v71, v173, v177, v71 bitop3:0x80
    v_dot2_f32_bf16 v62, v174, s7, v62
    v_dot2_f32_bf16 v63, v174, v174, v63
    v_dot2_f32_bf16 v64, v176, s7, v64
    v_dot2_f32_bf16 v65, v176, v176, v65
    v_dot2_f32_bf16 v62, v175, s7, v62
    v_dot2_f32_bf16 v63, v175, v175, v63
    v_dot2_f32_bf16 v64, v177, s7, v64
    v_dot2_f32_bf16 v65, v177, v177, v65
    v_and_b32 v71, 1, v71
    v_cmp_ne_u32 vcc, 1, v71
    s_cmp_ge_u32 s100, 262144
    s_cbranch_scc1 Lx_go
    s_cbranch_vccnz Lx_redo
Lx_go:
    v_add_f32_dpp v90, v62, v62 row_ror:8 row_mask:0xf bank_mask:0x3
    s_nop 1
    v_add_f32_dpp v90, v64, v64 row_ror:8 row_mask:0xf bank_mask:0xc
    v_add_f32_dpp v91, v63, v63 row_ror:8 row_mask:0xf bank_mask:0x3
    s_nop 1
    v_add_f32_dpp v91, v65, v65 row_ror:8 row_mask:0xf bank_mask:0xc
    s_add_u32 s4, s88, 148736
    v_lshl_add_u32 v28, v70, 3, s4
    ds_write_b64 v28, v[90:91]
    s_waitcnt lgkmcnt(0)
    s_barrier
    v_add_u32 v173, 41600, v4
    ds_read_b128 v[48:51], v173 offset:37440
    ds_read_b128 v[52:55], v173 offset:38480
    ds_read_b128 v[56:59], v173 offset:39520
    ds_read_b128 v[60:63], v173 offset:40560
    ds_read_b128 v[64:67], v173 offset:33280
    s_waitcnt lgkmcnt(3)
    v_mfma_f32_16x16x32_bf16 v[178:181], v[48:51], a[248:251], 0
    ds_read_b128 v[68:71], v173 offset:34320
    s_add_u32 m0, s89, 8192
    v_mfma_f32_16x16x32_bf16 v[194:197], v[48:51], a[252:255], 0
    v_mfma_f32_16x16x32_bf16 v[182:185], v[52:55], a[248:251], 0
    ds_read_b128 v[48:51], v173 offset:35360
    v_mfma_f32_16x16x32_bf16 v[198:201], v[52:55], a[252:255], 0
    s_waitcnt lgkmcnt(3)
    v_mfma_f32_16x16x32_bf16 v[186:189], v[56:59], a[248:251], 0
    ds_read_b128 v[52:55], v173 offset:36400
    v_add_u32 v28, 148736, v30
    v_mfma_f32_16x16x32_bf16 v[202:205], v[56:59], a[252:255], 0
    global_load_lds_dwordx4 v74, s[70:71] offset:0
    ds_read_b64 v[90:91], v28 offset:0
    v_mfma_f32_16x16x32_bf16 v[190:193], v[60:63], a[248:251], 0
    ds_read_b128 v[56:59], v173 offset:29120
    v_mfma_f32_16x16x32_bf16 v[206:209], v[60:63], a[252:255], 0
    ds_read_b64 v[92:93], v28 offset:512
    s_waitcnt lgkmcnt(5)
    v_mfma_f32_16x16x32_bf16 v[178:181], v[64:67], a[240:243], v[178:181]
    ds_read_b128 v[60:63], v173 offset:30160
    v_mfma_f32_16x16x32_bf16 v[194:197], v[64:67], a[244:247], v[194:197]
    ds_read_b64 v[94:95], v28 offset:1024
    v_mfma_f32_16x16x32_bf16 v[182:185], v[68:71], a[240:243], v[182:185]
    ds_read_b128 v[64:67], v173 offset:31200
    global_load_lds_dwordx4 v75, s[70:71] offset:1024
    v_mfma_f32_16x16x32_bf16 v[198:201], v[68:71], a[244:247], v[198:201]
    ds_read_b64 v[96:97], v28 offset:1536
    s_waitcnt lgkmcnt(7)
    v_mfma_f32_16x16x32_bf16 v[186:189], v[48:51], a[240:243], v[186:189]
    ds_read_b128 v[68:71], v173 offset:32240
    v_mfma_f32_16x16x32_bf16 v[202:205], v[48:51], a[244:247], v[202:205]
    s_add_u32 s4, s88, 150784
    v_mfma_f32_16x16x32_bf16 v[190:193], v[52:55], a[240:243], v[190:193]
    ds_read_b128 v[48:51], v173 offset:24960
    v_mfma_f32_16x16x32_bf16 v[206:209], v[52:55], a[244:247], v[206:209]
    v_lshl_add_u32 v170, v1, 2, s4
    s_waitcnt lgkmcnt(5)
    v_mfma_f32_16x16x32_bf16 v[178:181], v[56:59], a[232:235], v[178:181]
    ds_read_b128 v[52:55], v173 offset:26000
    global_load_lds_dwordx4 v76, s[70:71] offset:2048
    v_mfma_f32_16x16x32_bf16 v[194:197], v[56:59], a[236:239], v[194:197]
    v_lshl_add_u32 v171, v3, 5, s4
    v_mfma_f32_16x16x32_bf16 v[182:185], v[60:63], a[232:235], v[182:185]
    ds_read_b128 v[56:59], v173 offset:27040
    v_lshl_add_u32 v172, v5, 2, s4
    v_mfma_f32_16x16x32_bf16 v[198:201], v[60:63], a[236:239], v[198:201]
    s_waitcnt lgkmcnt(3)
    v_mfma_f32_16x16x32_bf16 v[186:189], v[64:67], a[232:235], v[186:189]
    ds_read_b128 v[60:63], v173 offset:28080
    v_add_f32 v90, v90, v92
    v_mfma_f32_16x16x32_bf16 v[202:205], v[64:67], a[236:239], v[202:205]
    global_load_lds_dwordx4 v77, s[70:71] offset:3072
    v_mfma_f32_16x16x32_bf16 v[190:193], v[68:71], a[232:235], v[190:193]
    ds_read_b128 v[64:67], v173 offset:20800
    v_add_f32 v91, v91, v93
    v_mfma_f32_16x16x32_bf16 v[206:209], v[68:71], a[236:239], v[206:209]
    s_waitcnt lgkmcnt(3)
    v_mfma_f32_16x16x32_bf16 v[178:181], v[48:51], a[224:227], v[178:181]
    ds_read_b128 v[68:71], v173 offset:21840
    v_add_f32 v94, v94, v96
    v_mfma_f32_16x16x32_bf16 v[194:197], v[48:51], a[228:231], v[194:197]
    v_mfma_f32_16x16x32_bf16 v[182:185], v[52:55], a[224:227], v[182:185]
    ds_read_b128 v[48:51], v173 offset:22880
    v_add_f32 v95, v95, v97
    s_add_u32 m0, s89, 12288
    v_mfma_f32_16x16x32_bf16 v[198:201], v[52:55], a[228:231], v[198:201]
    s_waitcnt lgkmcnt(3)
    v_mfma_f32_16x16x32_bf16 v[186:189], v[56:59], a[224:227], v[186:189]
    ds_read_b128 v[52:55], v173 offset:23920
    v_add_f32 v90, v90, v94
    v_mfma_f32_16x16x32_bf16 v[202:205], v[56:59], a[228:231], v[202:205]
    v_add_f32 v91, v91, v95
    v_mfma_f32_16x16x32_bf16 v[190:193], v[60:63], a[224:227], v[190:193]
    ds_read_b128 v[56:59], v173 offset:16640
    v_mfma_f32_16x16x32_bf16 v[206:209], v[60:63], a[228:231], v[206:209]
    v_mul_f32 v90, 0x3acccccd, v90
    s_waitcnt lgkmcnt(3)
    v_mfma_f32_16x16x32_bf16 v[178:181], v[64:67], a[216:219], v[178:181]
    ds_read_b128 v[60:63], v173 offset:17680
    global_load_lds_dwordx4 v78, s[70:71] offset:0
    v_mfma_f32_16x16x32_bf16 v[194:197], v[64:67], a[220:223], v[194:197]
    v_mul_f32 v91, 0x3acccccd, v91
    v_mfma_f32_16x16x32_bf16 v[182:185], v[68:71], a[216:219], v[182:185]
    ds_read_b128 v[64:67], v173 offset:18720
    v_mfma_f32_16x16x32_bf16 v[198:201], v[68:71], a[220:223], v[198:201]
    v_fma_f32 v91, -v90, v90, v91
    s_waitcnt lgkmcnt(3)
    v_mfma_f32_16x16x32_bf16 v[186:189], v[48:51], a[216:219], v[186:189]
    ds_read_b128 v[68:71], v173 offset:19760
    v_mfma_f32_16x16x32_bf16 v[202:205], v[48:51], a[220:223], v[202:205]
    v_max_f32 v91, 0, v91
    global_load_lds_dwordx4 v79, s[70:71] offset:1024
    v_mfma_f32_16x16x32_bf16 v[190:193], v[52:55], a[216:219], v[190:193]
    ds_read_b128 v[48:51], v173 offset:12480
    v_mfma_f32_16x16x32_bf16 v[206:209], v[52:55], a[220:223], v[206:209]
    v_add_f32 v91, 0x3727c5ac, v91
    s_waitcnt lgkmcnt(3)
    v_mfma_f32_16x16x32_bf16 v[178:181], v[56:59], a[208:211], v[178:181]
    ds_read_b128 v[52:55], v173 offset:13520
    v_mfma_f32_16x16x32_bf16 v[194:197], v[56:59], a[212:215], v[194:197]
    v_rsq_f32 v92, v91
    v_mfma_f32_16x16x32_bf16 v[182:185], v[60:63], a[208:211], v[182:185]
    ds_read_b128 v[56:59], v173 offset:14560
    global_load_lds_dwordx4 v80, s[70:71] offset:2048
    v_mfma_f32_16x16x32_bf16 v[198:201], v[60:63], a[212:215], v[198:201]
    s_waitcnt lgkmcnt(3)
    v_mfma_f32_16x16x32_bf16 v[186:189], v[64:67], a[208:211], v[186:189]
    ds_read_b128 v[60:63], v173 offset:15600
    v_mul_f32_e64 v91, -v90, v92
    v_mfma_f32_16x16x32_bf16 v[202:205], v[64:67], a[212:215], v[202:205]
    v_mfma_f32_16x16x32_bf16 v[190:193], v[68:71], a[208:211], v[190:193]
    ds_read_b128 v[64:67], v173 offset:8320
    v_mov_b32 v90, v92
    v_mfma_f32_16x16x32_bf16 v[206:209], v[68:71], a[212:215], v[206:209]
    s_waitcnt lgkmcnt(3)
    v_mfma_f32_16x16x32_bf16 v[178:181], v[48:51], a[200:203], v[178:181]
    ds_read_b128 v[68:71], v173 offset:9360
    global_load_lds_dwordx4 v81, s[70:71] offset:3072
    v_mfma_f32_16x16x32_bf16 v[194:197], v[48:51], a[204:207], v[194:197]
    ds_write2st64_b32 v170, v90, v91 offset0:0 offset1:1
    v_mfma_f32_16x16x32_bf16 v[182:185], v[52:55], a[200:203], v[182:185]
    ds_read_b128 v[48:51], v173 offset:10400
    ds_read_b128 v[98:101], v171 offset:0
    v_mfma_f32_16x16x32_bf16 v[198:201], v[52:55], a[204:207], v[198:201]
    s_waitcnt lgkmcnt(5)
    v_mfma_f32_16x16x32_bf16 v[186:189], v[56:59], a[200:203], v[186:189]
    ds_read_b128 v[52:55], v173 offset:11440
    ds_read_b128 v[102:105], v171 offset:16
    v_mfma_f32_16x16x32_bf16 v[202:205], v[56:59], a[204:207], v[202:205]
    global_load_dwordx4 a[0:3], v4, s[52:53] offset:-4096 sc1
    v_mfma_f32_16x16x32_bf16 v[190:193], v[60:63], a[200:203], v[190:193]
    ds_read_b128 v[56:59], v173 offset:4160
    ds_read_b128 v[106:109], v171 offset:128
    v_mfma_f32_16x16x32_bf16 v[206:209], v[60:63], a[204:207], v[206:209]
    ds_read_b128 v[110:113], v171 offset:144
    s_waitcnt lgkmcnt(8)
    v_mfma_f32_16x16x32_bf16 v[178:181], v[64:67], a[192:195], v[178:181]
    ds_read_b128 v[60:63], v173 offset:5200
    v_mfma_f32_16x16x32_bf16 v[194:197], v[64:67], a[196:199], v[194:197]
    ds_read_b128 v[114:117], v171 offset:256
    v_mfma_f32_16x16x32_bf16 v[182:185], v[68:71], a[192:195], v[182:185]
    ds_read_b128 v[64:67], v173 offset:6240
    global_load_dwordx4 a[4:7], v7, s[58:59] offset:-4096 sc1
    v_mfma_f32_16x16x32_bf16 v[198:201], v[68:71], a[196:199], v[198:201]
    ds_read_b128 v[118:121], v171 offset:272
    s_waitcnt lgkmcnt(8)
    v_mfma_f32_16x16x32_bf16 v[186:189], v[48:51], a[192:195], v[186:189]
    ds_read_b128 v[68:71], v173 offset:7280
    v_mfma_f32_16x16x32_bf16 v[202:205], v[48:51], a[196:199], v[202:205]
    ds_read_b128 v[122:125], v171 offset:384
    v_mfma_f32_16x16x32_bf16 v[190:193], v[52:55], a[192:195], v[190:193]
    ds_read_b128 v[48:51], v173 offset:0
    v_mfma_f32_16x16x32_bf16 v[206:209], v[52:55], a[196:199], v[206:209]
    ds_read_b128 v[126:129], v171 offset:400
    s_waitcnt lgkmcnt(7)
    v_mfma_f32_16x16x32_bf16 v[178:181], v[56:59], a[184:187], v[178:181]
    ds_read_b128 v[52:55], v173 offset:1040
    global_load_dwordx4 a[8:11], v4, s[52:53] offset:-3072 sc1
    v_mfma_f32_16x16x32_bf16 v[194:197], v[56:59], a[188:191], v[194:197]
    ds_read_b32 v162, v172 offset:0
    v_mfma_f32_16x16x32_bf16 v[182:185], v[60:63], a[184:187], v[182:185]
    ds_read_b128 v[56:59], v173 offset:2080
    v_mfma_f32_16x16x32_bf16 v[198:201], v[60:63], a[188:191], v[198:201]
    ds_read_b32 v163, v172 offset:256
    s_waitcnt lgkmcnt(7)
    v_mfma_f32_16x16x32_bf16 v[186:189], v[64:67], a[184:187], v[186:189]
    ds_read_b128 v[60:63], v173 offset:3120
    ds_read_b32 v164, v172 offset:16
    v_mfma_f32_16x16x32_bf16 v[202:205], v[64:67], a[188:191], v[202:205]
    global_load_dwordx4 a[12:15], v7, s[58:59] offset:-3072 sc1
    v_mfma_f32_16x16x32_bf16 v[190:193], v[68:71], a[184:187], v[190:193]
    ds_read_b128 v[64:67], v4 offset:37440
    ds_read_b32 v165, v172 offset:272
    v_mfma_f32_16x16x32_bf16 v[206:209], v[68:71], a[188:191], v[206:209]
    s_waitcnt lgkmcnt(7)
    v_mfma_f32_16x16x32_bf16 v[178:181], v[48:51], a[176:179], v[178:181]
    ds_read_b128 v[68:71], v4 offset:38480
    ds_read_b32 v166, v172 offset:128
    v_mfma_f32_16x16x32_bf16 v[194:197], v[48:51], a[180:183], v[194:197]
    v_mfma_f32_16x16x32_bf16 v[182:185], v[52:55], a[176:179], v[182:185]
    ds_read_b128 v[48:51], v4 offset:39520
    ds_read_b32 v167, v172 offset:384
    v_mfma_f32_16x16x32_bf16 v[198:201], v[52:55], a[180:183], v[198:201]
    global_load_dwordx4 a[16:19], v4, s[52:53] offset:-2048 sc1
    s_waitcnt lgkmcnt(7)
    v_mfma_f32_16x16x32_bf16 v[186:189], v[56:59], a[176:179], v[186:189]
    ds_read_b128 v[52:55], v4 offset:40560
    ds_read_b32 v168, v172 offset:144
    v_mfma_f32_16x16x32_bf16 v[202:205], v[56:59], a[180:183], v[202:205]
    v_mfma_f32_16x16x32_bf16 v[190:193], v[60:63], a[176:179], v[190:193]
    ds_read_b128 v[56:59], v4 offset:33280
    ds_read_b32 v169, v172 offset:400
    v_mfma_f32_16x16x32_bf16 v[206:209], v[60:63], a[180:183], v[206:209]
    s_waitcnt lgkmcnt(7)
    v_mfma_f32_16x16x32_bf16 v[178:181], v[64:67], a[168:171], v[178:181]
    ds_read_b128 v[60:63], v4 offset:34320
    s_add_u32 s4, s88, 156672
    global_load_dwordx4 a[20:23], v7, s[58:59] offset:-2048 sc1
    v_mfma_f32_16x16x32_bf16 v[194:197], v[64:67], a[172:175], v[194:197]
    v_lshl_add_u32 v28, v2, 2, s4
    v_mfma_f32_16x16x32_bf16 v[182:185], v[68:71], a[168:171], v[182:185]
    ds_read_b128 v[64:67], v4 offset:35360
    v_mfma_f32_16x16x32_bf16 v[198:201], v[68:71], a[172:175], v[198:201]
    ds_read2_b32 v[8:9], v28 offset0:0 offset1:16
    s_waitcnt lgkmcnt(6)
    v_mfma_f32_16x16x32_bf16 v[186:189], v[48:51], a[168:171], v[186:189]
    ds_read_b128 v[68:71], v4 offset:36400
    v_mfma_f32_16x16x32_bf16 v[202:205], v[48:51], a[172:175], v[202:205]
    global_load_dwordx4 a[24:27], v4, s[52:53] offset:-1024 sc1
    ds_read2_b32 v[10:11], v28 offset0:32 offset1:48
    v_mfma_f32_16x16x32_bf16 v[190:193], v[52:55], a[168:171], v[190:193]
    ds_read_b128 v[48:51], v4 offset:29120
    v_mfma_f32_16x16x32_bf16 v[206:209], v[52:55], a[172:175], v[206:209]
    v_lshl_add_u32 v28, v3, 4, s4
    s_waitcnt lgkmcnt(5)
    v_mfma_f32_16x16x32_bf16 v[178:181], v[56:59], a[160:163], v[178:181]
    ds_read_b128 v[52:55], v4 offset:30160
    v_mfma_f32_16x16x32_bf16 v[194:197], v[56:59], a[164:167], v[194:197]
    ds_read_b128 v[12:15], v28 offset:256
    v_mfma_f32_16x16x32_bf16 v[182:185], v[60:63], a[160:163], v[182:185]
    ds_read_b128 v[56:59], v4 offset:31200
    global_load_dwordx4 a[28:31], v7, s[58:59] offset:-1024 sc1
    v_mfma_f32_16x16x32_bf16 v[198:201], v[60:63], a[164:167], v[198:201]
    ds_read_b128 v[16:19], v28 offset:320
    s_waitcnt lgkmcnt(6)
    v_mfma_f32_16x16x32_bf16 v[186:189], v[64:67], a[160:163], v[186:189]
    ds_read_b128 v[60:63], v4 offset:32240
    ds_read_b128 v[20:23], v28 offset:384
    v_mfma_f32_16x16x32_bf16 v[202:205], v[64:67], a[164:167], v[202:205]
    v_mfma_f32_16x16x32_bf16 v[190:193], v[68:71], a[160:163], v[190:193]
    ds_read_b128 v[64:67], v4 offset:24960
    ds_read_b128 v[24:27], v28 offset:448
    v_mfma_f32_16x16x32_bf16 v[206:209], v[68:71], a[164:167], v[206:209]
    s_waitcnt lgkmcnt(7)
    v_mfma_f32_16x16x32_bf16 v[178:181], v[48:51], a[152:155], v[178:181]
    ds_read_b128 v[68:71], v4 offset:26000
    global_load_dwordx4 a[32:35], v4, s[52:53] offset:0 sc1
    v_mfma_f32_16x16x32_bf16 v[194:197], v[48:51], a[156:159], v[194:197]
    v_fma_f32 v130, v114, v8, v9
    v_mfma_f32_16x16x32_bf16 v[182:185], v[52:55], a[152:155], v[182:185]
    ds_read_b128 v[48:51], v4 offset:27040
    v_fma_f32 v131, v115, v8, v9
    v_mfma_f32_16x16x32_bf16 v[198:201], v[52:55], a[156:159], v[198:201]
    s_waitcnt lgkmcnt(5)
    v_mfma_f32_16x16x32_bf16 v[186:189], v[56:59], a[152:155], v[186:189]
    ds_read_b128 v[52:55], v4 offset:28080
    v_fma_f32 v132, v116, v8, v9
    v_mfma_f32_16x16x32_bf16 v[202:205], v[56:59], a[156:159], v[202:205]
    global_load_dwordx4 a[36:39], v7, s[58:59] offset:0 sc1
    v_mfma_f32_16x16x32_bf16 v[190:193], v[60:63], a[152:155], v[190:193]
    ds_read_b128 v[56:59], v4 offset:20800
    v_fma_f32 v133, v117, v8, v9
    v_mfma_f32_16x16x32_bf16 v[206:209], v[60:63], a[156:159], v[206:209]
    s_waitcnt lgkmcnt(3)
    v_mfma_f32_16x16x32_bf16 v[178:181], v[64:67], a[144:147], v[178:181]
    ds_read_b128 v[60:63], v4 offset:21840
    v_fma_f32 v134, v118, v8, v9
    v_mfma_f32_16x16x32_bf16 v[194:197], v[64:67], a[148:151], v[194:197]
    v_fma_f32 v135, v119, v8, v9
    v_mfma_f32_16x16x32_bf16 v[182:185], v[68:71], a[144:147], v[182:185]
    ds_read_b128 v[64:67], v4 offset:22880
    global_load_dwordx4 a[40:43], v4, s[52:53] offset:1024 sc1
    v_mfma_f32_16x16x32_bf16 v[198:201], v[68:71], a[148:151], v[198:201]
    v_fma_f32 v136, v120, v8, v9
    s_waitcnt lgkmcnt(3)
    v_mfma_f32_16x16x32_bf16 v[186:189], v[48:51], a[144:147], v[186:189]
    ds_read_b128 v[68:71], v4 offset:23920
    v_mfma_f32_16x16x32_bf16 v[202:205], v[48:51], a[148:151], v[202:205]
    v_fma_f32 v137, v121, v8, v9
    v_mfma_f32_16x16x32_bf16 v[190:193], v[52:55], a[144:147], v[190:193]
    ds_read_b128 v[48:51], v4 offset:16640
    v_mfma_f32_16x16x32_bf16 v[206:209], v[52:55], a[148:151], v[206:209]
    v_fma_f32 v138, v122, v8, v9
    s_waitcnt lgkmcnt(3)
    v_mfma_f32_16x16x32_bf16 v[178:181], v[56:59], a[136:139], v[178:181]
    ds_read_b128 v[52:55], v4 offset:17680
    global_load_dwordx4 a[44:47], v7, s[58:59] offset:1024 sc1
    v_mfma_f32_16x16x32_bf16 v[194:197], v[56:59], a[140:143], v[194:197]
    v_fma_f32 v139, v123, v8, v9
    v_mfma_f32_16x16x32_bf16 v[182:185], v[60:63], a[136:139], v[182:185]
    ds_read_b128 v[56:59], v4 offset:18720
    v_mfma_f32_16x16x32_bf16 v[198:201], v[60:63], a[140:143], v[198:201]
    v_fma_f32 v140, v124, v8, v9
    s_waitcnt lgkmcnt(3)
    v_mfma_f32_16x16x32_bf16 v[186:189], v[64:67], a[136:139], v[186:189]
    ds_read_b128 v[60:63], v4 offset:19760
    v_mfma_f32_16x16x32_bf16 v[202:205], v[64:67], a[140:143], v[202:205]
    v_fma_f32 v141, v125, v8, v9
    global_load_dwordx4 a[48:51], v4, s[52:53] offset:2048 sc1
    v_mfma_f32_16x16x32_bf16 v[190:193], v[68:71], a[136:139], v[190:193]
    ds_read_b128 v[64:67], v4 offset:0
    v_fma_f32 v142, v126, v8, v9
    v_mfma_f32_16x16x32_bf16 v[206:209], v[68:71], a[140:143], v[206:209]
    s_waitcnt lgkmcnt(3)
    v_mfma_f32_16x16x32_bf16 v[178:181], v[48:51], a[128:131], v[178:181]
    ds_read_b128 v[68:71], v4 offset:1040
    v_fma_f32 v143, v127, v8, v9
    v_mfma_f32_16x16x32_bf16 v[194:197], v[48:51], a[132:135], v[194:197]
    v_mfma_f32_16x16x32_bf16 v[182:185], v[52:55], a[128:131], v[182:185]
    ds_read_b128 v[48:51], v4 offset:2080
    v_fma_f32 v144, v128, v8, v9
    v_mfma_f32_16x16x32_bf16 v[198:201], v[52:55], a[132:135], v[198:201]
    global_load_dwordx4 a[52:55], v7, s[58:59] offset:2048 sc1
    s_waitcnt lgkmcnt(3)
    v_mfma_f32_16x16x32_bf16 v[186:189], v[56:59], a[128:131], v[186:189]
    ds_read_b128 v[52:55], v4 offset:3120
    v_fma_f32 v145, v129, v8, v9
    v_mfma_f32_16x16x32_bf16 v[202:205], v[56:59], a[132:135], v[202:205]
    v_mfma_f32_16x16x32_bf16 v[190:193], v[60:63], a[128:131], v[190:193]
    ds_read_b128 v[56:59], v4 offset:4160
    v_fma_f32 v146, v114, v10, v11
    v_mfma_f32_16x16x32_bf16 v[206:209], v[60:63], a[132:135], v[206:209]
    s_waitcnt lgkmcnt(3)
    s_waitcnt vmcnt(29)
    v_mfma_f32_16x16x32_bf16 v[178:181], v[64:67], a[96:99], v[178:181]
    ds_read_b128 v[60:63], v4 offset:5200
    global_load_dwordx4 a[56:59], v4, s[52:53] offset:3072 sc1
    s_waitcnt vmcnt(29)
    v_mfma_f32_16x16x32_bf16 v[194:197], v[64:67], a[100:103], v[194:197]
    v_fma_f32 v147, v115, v10, v11
    v_mfma_f32_16x16x32_bf16 v[182:185], v[68:71], a[96:99], v[182:185]
    ds_read_b128 v[64:67], v4 offset:6240
    v_fma_f32 v148, v116, v10, v11
    v_mfma_f32_16x16x32_bf16 v[198:201], v[68:71], a[100:103], v[198:201]
    v_fma_f32 v149, v117, v10, v11
    s_waitcnt lgkmcnt(3)
    v_mfma_f32_16x16x32_bf16 v[186:189], v[48:51], a[96:99], v[186:189]
    ds_read_b128 v[68:71], v4 offset:7280
    v_mfma_f32_16x16x32_bf16 v[202:205], v[48:51], a[100:103], v[202:205]
    global_load_dwordx4 a[60:63], v7, s[58:59] offset:3072 sc1
    v_fma_f32 v150, v118, v10, v11
    v_mfma_f32_16x16x32_bf16 v[190:193], v[52:55], a[96:99], v[190:193]
    ds_read_b128 v[48:51], v4 offset:8320
    v_mfma_f32_16x16x32_bf16 v[206:209], v[52:55], a[100:103], v[206:209]
    v_fma_f32 v151, v119, v10, v11
    s_waitcnt lgkmcnt(3)
    s_waitcnt vmcnt(29)
    v_mfma_f32_16x16x32_bf16 v[178:181], v[56:59], a[104:107], v[178:181]
    ds_read_b128 v[52:55], v4 offset:9360
    s_waitcnt vmcnt(28)
    v_mfma_f32_16x16x32_bf16 v[194:197], v[56:59], a[108:111], v[194:197]
    v_fma_f32 v152, v120, v10, v11
    v_mfma_f32_16x16x32_bf16 v[182:185], v[60:63], a[104:107], v[182:185]
    ds_read_b128 v[56:59], v4 offset:10400
    global_load_dwordx4 a[64:67], v4, s[54:55] offset:-4096 sc1
    v_mfma_f32_16x16x32_bf16 v[198:201], v[60:63], a[108:111], v[198:201]
    v_fma_f32 v153, v121, v10, v11
    s_waitcnt lgkmcnt(3)
    v_mfma_f32_16x16x32_bf16 v[186:189], v[64:67], a[104:107], v[186:189]
    ds_read_b128 v[60:63], v4 offset:11440
    v_mfma_f32_16x16x32_bf16 v[202:205], v[64:67], a[108:111], v[202:205]
    v_fma_f32 v154, v122, v10, v11
    v_mfma_f32_16x16x32_bf16 v[190:193], v[68:71], a[104:107], v[190:193]
    ds_read_b128 v[64:67], v4 offset:12480
    v_mfma_f32_16x16x32_bf16 v[206:209], v[68:71], a[108:111], v[206:209]
    v_fma_f32 v155, v123, v10, v11
    s_waitcnt lgkmcnt(3)
    s_waitcnt vmcnt(28)
    v_mfma_f32_16x16x32_bf16 v[178:181], v[48:51], a[112:115], v[178:181]
    ds_read_b128 v[68:71], v4 offset:13520
    global_load_dwordx4 a[68:71], v7, s[60:61] offset:-4096 sc1
    s_waitcnt vmcnt(28)
    v_mfma_f32_16x16x32_bf16 v[194:197], v[48:51], a[116:119], v[194:197]
    v_fma_f32 v156, v124, v10, v11
    v_mfma_f32_16x16x32_bf16 v[182:185], v[52:55], a[112:115], v[182:185]
    ds_read_b128 v[48:51], v4 offset:14560
    v_fma_f32 v157, v125, v10, v11
    v_mfma_f32_16x16x32_bf16 v[198:201], v[52:55], a[116:119], v[198:201]
    s_waitcnt lgkmcnt(3)
    v_mfma_f32_16x16x32_bf16 v[186:189], v[56:59], a[112:115], v[186:189]
    ds_read_b128 v[52:55], v4 offset:15600
    v_fma_f32 v158, v126, v10, v11
    v_mfma_f32_16x16x32_bf16 v[202:205], v[56:59], a[116:119], v[202:205]
    global_load_dwordx4 a[72:75], v4, s[54:55] offset:-3072 sc1
    v_mfma_f32_16x16x32_bf16 v[190:193], v[60:63], a[112:115], v[190:193]
    v_fma_f32 v159, v127, v10, v11
    v_mfma_f32_16x16x32_bf16 v[206:209], v[60:63], a[116:119], v[206:209]
    s_waitcnt lgkmcnt(2)
    s_waitcnt vmcnt(28)
    v_mfma_f32_16x16x32_bf16 v[178:181], v[64:67], a[120:123], v[178:181]
    v_fma_f32 v160, v128, v10, v11
    s_waitcnt vmcnt(27)
    v_mfma_f32_16x16x32_bf16 v[194:197], v[64:67], a[124:127], v[194:197]
    v_mfma_f32_16x16x32_bf16 v[182:185], v[68:71], a[120:123], v[182:185]
    v_fma_f32 v161, v129, v10, v11
    global_load_dwordx4 a[76:79], v7, s[60:61] offset:-3072 sc1
    v_mfma_f32_16x16x32_bf16 v[198:201], v[68:71], a[124:127], v[198:201]
    s_waitcnt lgkmcnt(0)
    v_mfma_f32_16x16x32_bf16 v[186:189], v[48:51], a[120:123], v[186:189]
    v_mfma_f32_16x16x32_bf16 v[202:205], v[48:51], a[124:127], v[202:205]
    v_mfma_f32_16x16x32_bf16 v[190:193], v[52:55], a[120:123], v[190:193]
    v_mfma_f32_16x16x32_bf16 v[206:209], v[52:55], a[124:127], v[206:209]
    s_nop 7
    s_cmp_eq_u32 s101, 2
    s_cbranch_scc1 Lz_keep
    v_mov_b32 v194, 0
    v_mov_b32 v195, 0
    v_mov_b32 v196, 0
    v_mov_b32 v197, 0
    v_mov_b32 v198, 0
    v_mov_b32 v199, 0
    v_mov_b32 v200, 0
    v_mov_b32 v201, 0
    v_mov_b32 v202, 0
    v_mov_b32 v203, 0
    v_mov_b32 v204, 0
    v_mov_b32 v205, 0
    v_mov_b32 v206, 0
    v_mov_b32 v207, 0
    v_mov_b32 v208, 0
    v_mov_b32 v209, 0
    s_cmp_eq_u32 s101, 1
    s_cbranch_scc1 Lz_keep
    v_mov_b32 v178, 0
    v_mov_b32 v179, 0
    v_mov_b32 v180, 0
    v_mov_b32 v181, 0
    v_mov_b32 v182, 0
    v_mov_b32 v183, 0
    v_mov_b32 v184, 0
    v_mov_b32 v185, 0
    v_mov_b32 v186, 0
    v_mov_b32 v187, 0
    v_mov_b32 v188, 0
    v_mov_b32 v189, 0
    v_mov_b32 v190, 0
    v_mov_b32 v191, 0
    v_mov_b32 v192, 0
    v_mov_b32 v193, 0
Lz_keep:
    global_load_dwordx4 a[80:83], v4, s[54:55] offset:-2048 sc1
    v_pk_fma_f32 v[178:179], v[178:179], v[98:99], v[130:131] op_sel:[0,0,0] op_sel_hi:[1,1,1]
    v_pk_fma_f32 v[180:181], v[180:181], v[100:101], v[132:133] op_sel:[0,0,0] op_sel_hi:[1,1,1]
    v_pk_fma_f32 v[182:183], v[182:183], v[102:103], v[134:135] op_sel:[0,0,0] op_sel_hi:[1,1,1]
    v_pk_fma_f32 v[184:185], v[184:185], v[104:105], v[136:137] op_sel:[0,0,0] op_sel_hi:[1,1,1]
    global_load_dwordx4 a[84:87], v7, s[60:61] offset:-2048 sc1
    v_pk_fma_f32 v[186:187], v[186:187], v[106:107], v[138:139] op_sel:[0,0,0] op_sel_hi:[1,1,1]
    v_pk_fma_f32 v[188:189], v[188:189], v[108:109], v[140:141] op_sel:[0,0,0] op_sel_hi:[1,1,1]
    v_pk_fma_f32 v[190:191], v[190:191], v[110:111], v[142:143] op_sel:[0,0,0] op_sel_hi:[1,1,1]
    v_pk_fma_f32 v[192:193], v[192:193], v[112:113], v[144:145] op_sel:[0,0,0] op_sel_hi:[1,1,1]
    global_load_dwordx4 a[88:91], v4, s[54:55] offset:-1024 sc1
    v_pk_fma_f32 v[194:195], v[194:195], v[98:99], v[146:147] op_sel:[0,0,0] op_sel_hi:[1,1,1]
    v_pk_fma_f32 v[196:197], v[196:197], v[100:101], v[148:149] op_sel:[0,0,0] op_sel_hi:[1,1,1]
    v_pk_fma_f32 v[198:199], v[198:199], v[102:103], v[150:151] op_sel:[0,0,0] op_sel_hi:[1,1,1]
    v_pk_fma_f32 v[200:201], v[200:201], v[104:105], v[152:153] op_sel:[0,0,0] op_sel_hi:[1,1,1]
    v_pk_fma_f32 v[202:203], v[202:203], v[106:107], v[154:155] op_sel:[0,0,0] op_sel_hi:[1,1,1]
    global_load_dwordx4 a[92:95], v7, s[60:61] offset:-1024 sc1
    v_pk_fma_f32 v[204:205], v[204:205], v[108:109], v[156:157] op_sel:[0,0,0] op_sel_hi:[1,1,1]
    v_pk_fma_f32 v[206:207], v[206:207], v[110:111], v[158:159] op_sel:[0,0,0] op_sel_hi:[1,1,1]
    v_pk_fma_f32 v[208:209], v[208:209], v[112:113], v[160:161] op_sel:[0,0,0] op_sel_hi:[1,1,1]
    v_pk_mul_f32 v[130:131], v[178:179], v[178:179] op_sel:[0,0] op_sel_hi:[1,1]
    global_load_dwordx4 a[96:99], v4, s[54:55] offset:0 sc1
    v_pk_mul_f32 v[132:133], v[180:181], v[180:181] op_sel:[0,0] op_sel_hi:[1,1]
    v_pk_mul_f32 v[134:135], v[182:183], v[182:183] op_sel:[0,0] op_sel_hi:[1,1]
    v_pk_mul_f32 v[136:137], v[184:185], v[184:185] op_sel:[0,0] op_sel_hi:[1,1]
    v_pk_mul_f32 v[138:139], v[186:187], v[186:187] op_sel:[0,0] op_sel_hi:[1,1]
    global_load_dwordx4 a[100:103], v7, s[60:61] offset:0 sc1
    v_pk_mul_f32 v[140:141], v[188:189], v[188:189] op_sel:[0,0] op_sel_hi:[1,1]
    v_pk_mul_f32 v[142:143], v[190:191], v[190:191] op_sel:[0,0] op_sel_hi:[1,1]
    v_pk_mul_f32 v[144:145], v[192:193], v[192:193] op_sel:[0,0] op_sel_hi:[1,1]
    v_pk_mul_f32 v[146:147], v[194:195], v[194:195] op_sel:[0,0] op_sel_hi:[1,1]
    v_pk_mul_f32 v[148:149], v[196:197], v[196:197] op_sel:[0,0] op_sel_hi:[1,1]
    global_load_dwordx4 a[104:107], v4, s[54:55] offset:1024 sc1
    v_pk_mul_f32 v[150:151], v[198:199], v[198:199] op_sel:[0,0] op_sel_hi:[1,1]
    v_pk_mul_f32 v[152:153], v[200:201], v[200:201] op_sel:[0,0] op_sel_hi:[1,1]
    v_pk_mul_f32 v[154:155], v[202:203], v[202:203] op_sel:[0,0] op_sel_hi:[1,1]
    v_pk_mul_f32 v[156:157], v[204:205], v[204:205] op_sel:[0,0] op_sel_hi:[1,1]
    global_load_dwordx4 a[108:111], v7, s[60:61] offset:1024 sc1
    v_pk_mul_f32 v[158:159], v[206:207], v[206:207] op_sel:[0,0] op_sel_hi:[1,1]
    v_pk_mul_f32 v[160:161], v[208:209], v[208:209] op_sel:[0,0] op_sel_hi:[1,1]
    v_pk_fma_f32 v[130:131], v[130:131], s[84:85], s[84:85] op_sel:[0,1,0] op_sel_hi:[1,1,0]
    v_pk_fma_f32 v[132:133], v[132:133], s[84:85], s[84:85] op_sel:[0,1,0] op_sel_hi:[1,1,0]
    global_load_dwordx4 a[112:115], v4, s[54:55] offset:2048 sc1
    v_pk_fma_f32 v[134:135], v[134:135], s[84:85], s[84:85] op_sel:[0,1,0] op_sel_hi:[1,1,0]
    v_pk_fma_f32 v[136:137], v[136:137], s[84:85], s[84:85] op_sel:[0,1,0] op_sel_hi:[1,1,0]
    v_pk_fma_f32 v[138:139], v[138:139], s[84:85], s[84:85] op_sel:[0,1,0] op_sel_hi:[1,1,0]
    v_pk_fma_f32 v[140:141], v[140:141], s[84:85], s[84:85] op_sel:[0,1,0] op_sel_hi:[1,1,0]
    v_pk_fma_f32 v[142:143], v[142:143], s[84:85], s[84:85] op_sel:[0,1,0] op_sel_hi:[1,1,0]
    global_load_dwordx4 a[116:119], v7, s[60:61] offset:2048 sc1
    v_pk_fma_f32 v[144:145], v[144:145], s[84:85], s[84:85] op_sel:[0,1,0] op_sel_hi:[1,1,0]
    v_pk_fma_f32 v[146:147], v[146:147], s[84:85], s[84:85] op_sel:[0,1,0] op_sel_hi:[1,1,0]
    v_pk_fma_f32 v[148:149], v[148:149], s[84:85], s[84:85] op_sel:[0,1,0] op_sel_hi:[1,1,0]
    v_pk_fma_f32 v[150:151], v[150:151], s[84:85], s[84:85] op_sel:[0,1,0] op_sel_hi:[1,1,0]
    global_load_dwordx4 a[120:123], v4, s[54:55] offset:3072 sc1
    v_pk_fma_f32 v[152:153], v[152:153], s[84:85], s[84:85] op_sel:[0,1,0] op_sel_hi:[1,1,0]
    v_pk_fma_f32 v[154:155], v[154:155], s[84:85], s[84:85] op_sel:[0,1,0] op_sel_hi:[1,1,0]
    v_pk_fma_f32 v[156:157], v[156:157], s[84:85], s[84:85] op_sel:[0,1,0] op_sel_hi:[1,1,0]
    v_pk_fma_f32 v[158:159], v[158:159], s[84:85], s[84:85] op_sel:[0,1,0] op_sel_hi:[1,1,0]
    global_load_dwordx4 a[124:127], v7, s[60:61] offset:3072 sc1
    v_pk_fma_f32 v[160:161], v[160:161], s[84:85], s[84:85] op_sel:[0,1,0] op_sel_hi:[1,1,0]
    v_pk_mul_f32 v[130:131], v[130:131], v[178:179] op_sel:[0,0] op_sel_hi:[1,1]
    v_pk_mul_f32 v[132:133], v[132:133], v[180:181] op_sel:[0,0] op_sel_hi:[1,1]
    v_pk_mul_f32 v[134:135], v[134:135], v[182:183] op_sel:[0,0] op_sel_hi:[1,1]
    v_pk_mul_f32 v[136:137], v[136:137], v[184:185] op_sel:[0,0] op_sel_hi:[1,1]
    global_load_dwordx4 a[128:131], v4, s[56:57] offset:-4096 sc1
    v_pk_mul_f32 v[138:139], v[138:139], v[186:187] op_sel:[0,0] op_sel_hi:[1,1]
    v_pk_mul_f32 v[140:141], v[140:141], v[188:189] op_sel:[0,0] op_sel_hi:[1,1]
    v_pk_mul_f32 v[142:143], v[142:143], v[190:191] op_sel:[0,0] op_sel_hi:[1,1]
    v_pk_mul_f32 v[144:145], v[144:145], v[192:193] op_sel:[0,0] op_sel_hi:[1,1]
    global_load_dwordx4 a[132:135], v7, s[62:63] offset:-4096 sc1
    v_pk_mul_f32 v[146:147], v[146:147], v[194:195] op_sel:[0,0] op_sel_hi:[1,1]
    v_pk_mul_f32 v[148:149], v[148:149], v[196:197] op_sel:[0,0] op_sel_hi:[1,1]
    v_pk_mul_f32 v[150:151], v[150:151], v[198:199] op_sel:[0,0] op_sel_hi:[1,1]
    v_pk_mul_f32 v[152:153], v[152:153], v[200:201] op_sel:[0,0] op_sel_hi:[1,1]
    global_load_dwordx4 a[136:139], v4, s[56:57] offset:-3072 sc1
    v_pk_mul_f32 v[154:155], v[154:155], v[202:203] op_sel:[0,0] op_sel_hi:[1,1]
    v_pk_mul_f32 v[156:157], v[156:157], v[204:205] op_sel:[0,0] op_sel_hi:[1,1]
    v_pk_mul_f32 v[158:159], v[158:159], v[206:207] op_sel:[0,0] op_sel_hi:[1,1]
    v_pk_mul_f32 v[160:161], v[160:161], v[208:209] op_sel:[0,0] op_sel_hi:[1,1]
    v_exp_f32 v130, v130
    global_load_dwordx4 a[140:143], v7, s[62:63] offset:-3072 sc1
    v_exp_f32 v131, v131
    v_exp_f32 v132, v132
    v_exp_f32 v133, v133
    v_exp_f32 v134, v134
    global_load_dwordx4 a[144:147], v4, s[56:57] offset:-2048 sc1
    v_exp_f32 v135, v135
    v_exp_f32 v136, v136
    v_exp_f32 v137, v137
    v_exp_f32 v138, v138
    global_load_dwordx4 a[148:151], v7, s[62:63] offset:-2048 sc1
    v_exp_f32 v139, v139
    v_exp_f32 v140, v140
    v_exp_f32 v141, v141
    v_exp_f32 v142, v142
    v_exp_f32 v143, v143
    global_load_dwordx4 a[152:155], v4, s[56:57] offset:-1024 sc1
    v_exp_f32 v144, v144
    v_exp_f32 v145, v145
    v_exp_f32 v146, v146
    v_exp_f32 v147, v147
    global_load_dwordx4 a[156:159], v7, s[62:63] offset:-1024 sc1
    v_exp_f32 v148, v148
    v_exp_f32 v149, v149
    v_exp_f32 v150, v150
    v_exp_f32 v151, v151
    ds_read_b128 a[224:227], v82 offset:0
    v_exp_f32 v152, v152
    v_exp_f32 v153, v153
    v_exp_f32 v154, v154
    v_exp_f32 v155, v155
    v_exp_f32 v156, v156
    ds_read_b128 a[228:231], v84 offset:0
    v_exp_f32 v157, v157
    v_exp_f32 v158, v158
    v_exp_f32 v159, v159
    v_exp_f32 v160, v160
    ds_read_b128 a[232:235], v86 offset:0
    v_exp_f32 v161, v161
    v_pk_add_f32 v[130:131], v[130:131], 1.0 op_sel:[0,0] op_sel_hi:[1,0]
    v_pk_add_f32 v[132:133], v[132:133], 1.0 op_sel:[0,0] op_sel_hi:[1,0]
    v_pk_add_f32 v[134:135], v[134:135], 1.0 op_sel:[0,0] op_sel_hi:[1,0]
    ds_read_b128 a[236:239], v88 offset:0
    v_pk_add_f32 v[136:137], v[136:137], 1.0 op_sel:[0,0] op_sel_hi:[1,0]
    v_pk_add_f32 v[138:139], v[138:139], 1.0 op_sel:[0,0] op_sel_hi:[1,0]
    v_pk_add_f32 v[140:141], v[140:141], 1.0 op_sel:[0,0] op_sel_hi:[1,0]
    v_pk_add_f32 v[142:143], v[142:143], 1.0 op_sel:[0,0] op_sel_hi:[1,0]
    v_pk_add_f32 v[144:145], v[144:145], 1.0 op_sel:[0,0] op_sel_hi:[1,0]
    ds_read_b128 a[240:243], v83 offset:0
    v_pk_add_f32 v[146:147], v[146:147], 1.0 op_sel:[0,0] op_sel_hi:[1,0]
    v_pk_add_f32 v[148:149], v[148:149], 1.0 op_sel:[0,0] op_sel_hi:[1,0]
    v_pk_add_f32 v[150:151], v[150:151], 1.0 op_sel:[0,0] op_sel_hi:[1,0]
    v_pk_add_f32 v[152:153], v[152:153], 1.0 op_sel:[0,0] op_sel_hi:[1,0]
    ds_read_b128 a[244:247], v85 offset:0
    v_pk_add_f32 v[154:155], v[154:155], 1.0 op_sel:[0,0] op_sel_hi:[1,0]
    v_pk_add_f32 v[156:157], v[156:157], 1.0 op_sel:[0,0] op_sel_hi:[1,0]
    v_pk_add_f32 v[158:159], v[158:159], 1.0 op_sel:[0,0] op_sel_hi:[1,0]
    v_pk_add_f32 v[160:161], v[160:161], 1.0 op_sel:[0,0] op_sel_hi:[1,0]
    v_rcp_f32 v130, v130
    ds_read_b128 a[248:251], v87 offset:0
    v_rcp_f32 v131, v131
    v_rcp_f32 v132, v132
    v_rcp_f32 v133, v133
    v_rcp_f32 v134, v134
    ds_read_b128 a[252:255], v89 offset:0
    v_rcp_f32 v135, v135
    v_rcp_f32 v136, v136
    v_rcp_f32 v137, v137
    v_rcp_f32 v138, v138
    s_waitcnt lgkmcnt(0)
    s_add_u32 m0, s89, 0
    s_nop 0
    global_load_lds_dwordx4 v74, s[72:73] offset:0
    v_rcp_f32 v139, v139
    v_rcp_f32 v140, v140
    v_rcp_f32 v141, v141
    v_rcp_f32 v142, v142
    v_rcp_f32 v143, v143
    global_load_lds_dwordx4 v75, s[72:73] offset:1024
    v_rcp_f32 v144, v144
    v_rcp_f32 v145, v145
    v_rcp_f32 v146, v146
    v_rcp_f32 v147, v147
    global_load_lds_dwordx4 v76, s[72:73] offset:2048
    v_rcp_f32 v148, v148
    v_rcp_f32 v149, v149
    v_rcp_f32 v150, v150
    v_rcp_f32 v151, v151
    global_load_lds_dwordx4 v77, s[72:73] offset:3072
    v_rcp_f32 v152, v152
    v_rcp_f32 v153, v153
    v_rcp_f32 v154, v154
    v_rcp_f32 v155, v155
    v_rcp_f32 v156, v156
    s_add_u32 m0, s89, 4096
    s_nop 0
    global_load_lds_dwordx4 v78, s[72:73] offset:0
    v_rcp_f32 v157, v157
    v_rcp_f32 v158, v158
    v_rcp_f32 v159, v159
    v_rcp_f32 v160, v160
    global_load_lds_dwordx4 v79, s[72:73] offset:1024
    v_rcp_f32 v161, v161
    v_pk_mul_f32 v[178:179], v[178:179], v[130:131] op_sel:[0,0] op_sel_hi:[1,1]
    v_pk_mul_f32 v[180:181], v[180:181], v[132:133] op_sel:[0,0] op_sel_hi:[1,1]
    v_pk_mul_f32 v[182:183], v[182:183], v[134:135] op_sel:[0,0] op_sel_hi:[1,1]
    global_load_lds_dwordx4 v80, s[72:73] offset:2048
    v_pk_mul_f32 v[184:185], v[184:185], v[136:137] op_sel:[0,0] op_sel_hi:[1,1]
    v_pk_mul_f32 v[186:187], v[186:187], v[138:139] op_sel:[0,0] op_sel_hi:[1,1]
    v_pk_mul_f32 v[188:189], v[188:189], v[140:141] op_sel:[0,0] op_sel_hi:[1,1]
    v_pk_mul_f32 v[190:191], v[190:191], v[142:143] op_sel:[0,0] op_sel_hi:[1,1]
    v_pk_mul_f32 v[192:193], v[192:193], v[144:145] op_sel:[0,0] op_sel_hi:[1,1]
    global_load_lds_dwordx4 v81, s[72:73] offset:3072
    v_pk_mul_f32 v[194:195], v[194:195], v[146:147] op_sel:[0,0] op_sel_hi:[1,1]
    v_pk_mul_f32 v[196:197], v[196:197], v[148:149] op_sel:[0,0] op_sel_hi:[1,1]
    v_pk_mul_f32 v[198:199], v[198:199], v[150:151] op_sel:[0,0] op_sel_hi:[1,1]
    v_pk_mul_f32 v[200:201], v[200:201], v[152:153] op_sel:[0,0] op_sel_hi:[1,1]
    s_waitcnt vmcnt(48)
    ds_read_b128 a[192:195], v82 offset:8192
    v_pk_mul_f32 v[202:203], v[202:203], v[154:155] op_sel:[0,0] op_sel_hi:[1,1]
    v_pk_mul_f32 v[204:205], v[204:205], v[156:157] op_sel:[0,0] op_sel_hi:[1,1]
    v_pk_mul_f32 v[206:207], v[206:207], v[158:159] op_sel:[0,0] op_sel_hi:[1,1]
    v_pk_mul_f32 v[208:209], v[208:209], v[160:161] op_sel:[0,0] op_sel_hi:[1,1]
    ds_read_b128 a[196:199], v84 offset:8192
    v_pk_add_f32 v[130:131], v[178:179], v[194:195] op_sel:[0,0] op_sel_hi:[1,1]
    v_pk_mul_f32 v[146:147], v[178:179], v[178:179] op_sel:[0,0] op_sel_hi:[1,1]
    v_pk_add_f32 v[132:133], v[180:181], v[196:197] op_sel:[0,0] op_sel_hi:[1,1]
    v_pk_mul_f32 v[148:149], v[180:181], v[180:181] op_sel:[0,0] op_sel_hi:[1,1]
    v_pk_add_f32 v[134:135], v[182:183], v[198:199] op_sel:[0,0] op_sel_hi:[1,1]
    ds_read_b128 a[200:203], v86 offset:8192
    v_pk_mul_f32 v[150:151], v[182:183], v[182:183] op_sel:[0,0] op_sel_hi:[1,1]
    v_pk_add_f32 v[136:137], v[184:185], v[200:201] op_sel:[0,0] op_sel_hi:[1,1]
    v_pk_mul_f32 v[152:153], v[184:185], v[184:185] op_sel:[0,0] op_sel_hi:[1,1]
    v_pk_add_f32 v[138:139], v[186:187], v[202:203] op_sel:[0,0] op_sel_hi:[1,1]
    ds_read_b128 a[204:207], v88 offset:8192
    v_pk_mul_f32 v[154:155], v[186:187], v[186:187] op_sel:[0,0] op_sel_hi:[1,1]
    v_pk_add_f32 v[140:141], v[188:189], v[204:205] op_sel:[0,0] op_sel_hi:[1,1]
    v_pk_mul_f32 v[156:157], v[188:189], v[188:189] op_sel:[0,0] op_sel_hi:[1,1]
    v_pk_add_f32 v[142:143], v[190:191], v[206:207] op_sel:[0,0] op_sel_hi:[1,1]
    ds_read_b128 a[208:211], v83 offset:8192
    v_pk_mul_f32 v[158:159], v[190:191], v[190:191] op_sel:[0,0] op_sel_hi:[1,1]
    v_pk_add_f32 v[144:145], v[192:193], v[208:209] op_sel:[0,0] op_sel_hi:[1,1]
    v_pk_mul_f32 v[160:161], v[192:193], v[192:193] op_sel:[0,0] op_sel_hi:[1,1]
    v_pk_fma_f32 v[146:147], v[194:195], v[194:195], v[146:147] op_sel:[0,0,0] op_sel_hi:[1,1,1]
    v_pk_fma_f32 v[148:149], v[196:197], v[196:197], v[148:149] op_sel:[0,0,0] op_sel_hi:[1,1,1]
    ds_read_b128 a[212:215], v85 offset:8192
    v_pk_fma_f32 v[150:151], v[198:199], v[198:199], v[150:151] op_sel:[0,0,0] op_sel_hi:[1,1,1]
    v_pk_fma_f32 v[152:153], v[200:201], v[200:201], v[152:153] op_sel:[0,0,0] op_sel_hi:[1,1,1]
    v_pk_fma_f32 v[154:155], v[202:203], v[202:203], v[154:155] op_sel:[0,0,0] op_sel_hi:[1,1,1]
    v_pk_fma_f32 v[156:157], v[204:205], v[204:205], v[156:157] op_sel:[0,0,0] op_sel_hi:[1,1,1]
    ds_read_b128 a[216:219], v87 offset:8192
    v_pk_fma_f32 v[158:159], v[206:207], v[206:207], v[158:159] op_sel:[0,0,0] op_sel_hi:[1,1,1]
    v_pk_fma_f32 v[160:161], v[208:209], v[208:209], v[160:161] op_sel:[0,0,0] op_sel_hi:[1,1,1]
    v_add_f32_dpp v98, v130, v130 row_ror:8 row_mask:0xf bank_mask:0x3
    v_add_f32_dpp v99, v131, v131 row_ror:8 row_mask:0xf bank_mask:0x3
    ds_read_b128 a[220:223], v89 offset:8192
    v_add_f32_dpp v100, v132, v132 row_ror:8 row_mask:0xf bank_mask:0x3
    v_add_f32_dpp v101, v133, v133 row_ror:8 row_mask:0xf bank_mask:0x3
    v_add_f32_dpp v102, v134, v134 row_ror:8 row_mask:0xf bank_mask:0x3
    v_add_f32_dpp v103, v135, v135 row_ror:8 row_mask:0xf bank_mask:0x3
    v_add_f32_dpp v104, v136, v136 row_ror:8 row_mask:0xf bank_mask:0x3
    s_waitcnt lgkmcnt(0)
    s_add_u32 m0, s89, 8192
    s_nop 0
    global_load_lds_dwordx4 v74, s[74:75] offset:0
    v_add_f32_dpp v105, v137, v137 row_ror:8 row_mask:0xf bank_mask:0x3
    v_add_f32_dpp v106, v138, v138 row_ror:8 row_mask:0xf bank_mask:0x3
    v_add_f32_dpp v107, v139, v139 row_ror:8 row_mask:0xf bank_mask:0x3
    v_add_f32_dpp v108, v140, v140 row_ror:8 row_mask:0xf bank_mask:0x3
    global_load_lds_dwordx4 v75, s[74:75] offset:1024
    v_add_f32_dpp v109, v141, v141 row_ror:8 row_mask:0xf bank_mask:0x3
    v_add_f32_dpp v110, v142, v142 row_ror:8 row_mask:0xf bank_mask:0x3
    v_add_f32_dpp v111, v143, v143 row_ror:8 row_mask:0xf bank_mask:0x3
    v_add_f32_dpp v112, v144, v144 row_ror:8 row_mask:0xf bank_mask:0x3
    global_load_lds_dwordx4 v76, s[74:75] offset:2048
    v_add_f32_dpp v113, v145, v145 row_ror:8 row_mask:0xf bank_mask:0x3
    v_add_f32_dpp v98, v146, v146 row_ror:8 row_mask:0xf bank_mask:0xc
    v_add_f32_dpp v99, v147, v147 row_ror:8 row_mask:0xf bank_mask:0xc
    v_add_f32_dpp v100, v148, v148 row_ror:8 row_mask:0xf bank_mask:0xc
    v_add_f32_dpp v101, v149, v149 row_ror:8 row_mask:0xf bank_mask:0xc
    global_load_lds_dwordx4 v77, s[74:75] offset:3072
    v_add_f32_dpp v102, v150, v150 row_ror:8 row_mask:0xf bank_mask:0xc
    v_add_f32_dpp v103, v151, v151 row_ror:8 row_mask:0xf bank_mask:0xc
    v_add_f32_dpp v104, v152, v152 row_ror:8 row_mask:0xf bank_mask:0xc
    v_add_f32_dpp v105, v153, v153 row_ror:8 row_mask:0xf bank_mask:0xc
    s_add_u32 m0, s89, 12288
    s_nop 0
    global_load_lds_dwordx4 v78, s[74:75] offset:0
    v_add_f32_dpp v106, v154, v154 row_ror:8 row_mask:0xf bank_mask:0xc
    v_add_f32_dpp v107, v155, v155 row_ror:8 row_mask:0xf bank_mask:0xc
    v_add_f32_dpp v108, v156, v156 row_ror:8 row_mask:0xf bank_mask:0xc
    v_add_f32_dpp v109, v157, v157 row_ror:8 row_mask:0xf bank_mask:0xc
    global_load_lds_dwordx4 v79, s[74:75] offset:1024
    v_add_f32_dpp v110, v158, v158 row_ror:8 row_mask:0xf bank_mask:0xc
    v_add_f32_dpp v111, v159, v159 row_ror:8 row_mask:0xf bank_mask:0xc
    v_add_f32_dpp v112, v160, v160 row_ror:8 row_mask:0xf bank_mask:0xc
    v_add_f32_dpp v113, v161, v161 row_ror:8 row_mask:0xf bank_mask:0xc
    v_add_f32_dpp v130, v98, v98 row_half_mirror row_mask:0xf bank_mask:0x5
    global_load_lds_dwordx4 v80, s[74:75] offset:2048
    v_add_f32_dpp v131, v99, v99 row_half_mirror row_mask:0xf bank_mask:0x5
    v_add_f32_dpp v132, v100, v100 row_half_mirror row_mask:0xf bank_mask:0x5
    v_add_f32_dpp v133, v101, v101 row_half_mirror row_mask:0xf bank_mask:0x5
    v_add_f32_dpp v134, v102, v102 row_half_mirror row_mask:0xf bank_mask:0x5
    global_load_lds_dwordx4 v81, s[74:75] offset:3072
    v_add_f32_dpp v135, v103, v103 row_half_mirror row_mask:0xf bank_mask:0x5
    v_add_f32_dpp v136, v104, v104 row_half_mirror row_mask:0xf bank_mask:0x5
    v_add_f32_dpp v137, v105, v105 row_half_mirror row_mask:0xf bank_mask:0x5
    v_add_f32_dpp v130, v106, v106 row_half_mirror row_mask:0xf bank_mask:0xa
    v_add_f32_dpp v131, v107, v107 row_half_mirror row_mask:0xf bank_mask:0xa
    v_add_f32_dpp v132, v108, v108 row_half_mirror row_mask:0xf bank_mask:0xa
    v_add_f32_dpp v133, v109, v109 row_half_mirror row_mask:0xf bank_mask:0xa
    v_add_f32_dpp v134, v110, v110 row_half_mirror row_mask:0xf bank_mask:0xa
    v_add_f32_dpp v135, v111, v111 row_half_mirror row_mask:0xf bank_mask:0xa
    v_add_f32_dpp v136, v112, v112 row_half_mirror row_mask:0xf bank_mask:0xa
    v_add_f32_dpp v137, v113, v113 row_half_mirror row_mask:0xf bank_mask:0xa
    v_add_f32_dpp v130, v130, v130 quad_perm:[1,0,3,2] row_mask:0xf bank_mask:0xf
    v_add_f32_dpp v131, v131, v131 quad_perm:[1,0,3,2] row_mask:0xf bank_mask:0xf
    v_add_f32_dpp v132, v132, v132 quad_perm:[1,0,3,2] row_mask:0xf bank_mask:0xf
    v_add_f32_dpp v133, v133, v133 quad_perm:[1,0,3,2] row_mask:0xf bank_mask:0xf
    v_add_f32_dpp v134, v134, v134 quad_perm:[1,0,3,2] row_mask:0xf bank_mask:0xf
    v_add_f32_dpp v135, v135, v135 quad_perm:[1,0,3,2] row_mask:0xf bank_mask:0xf
    v_add_f32_dpp v136, v136, v136 quad_perm:[1,0,3,2] row_mask:0xf bank_mask:0xf
    v_add_f32_dpp v137, v137, v137 quad_perm:[1,0,3,2] row_mask:0xf bank_mask:0xf
    v_add_f32_dpp v130, v130, v130 quad_perm:[2,3,0,1] row_mask:0xf bank_mask:0xf
    v_add_f32_dpp v131, v131, v131 quad_perm:[2,3,0,1] row_mask:0xf bank_mask:0xf
    v_add_f32_dpp v132, v132, v132 quad_perm:[2,3,0,1] row_mask:0xf bank_mask:0xf
    v_add_f32_dpp v133, v133, v133 quad_perm:[2,3,0,1] row_mask:0xf bank_mask:0xf
    v_add_f32_dpp v134, v134, v134 quad_perm:[2,3,0,1] row_mask:0xf bank_mask:0xf
    v_add_f32_dpp v135, v135, v135 quad_perm:[2,3,0,1] row_mask:0xf bank_mask:0xf
    v_add_f32_dpp v136, v136, v136 quad_perm:[2,3,0,1] row_mask:0xf bank_mask:0xf
    v_add_f32_dpp v137, v137, v137 quad_perm:[2,3,0,1] row_mask:0xf bank_mask:0xf
    v_lshrrev_b32 v28, 2, v2
    v_lshl_add_u32 v28, v28, 7, v171
    ds_write_b128 v28, v[130:133]
    ds_write_b128 v28, v[134:137] offset:16
    s_waitcnt lgkmcnt(0)
    s_barrier
    v_lshlrev_b32 v28, 2, v1
    v_add_u32 v28, 150784, v28
    ds_read2st64_b32 v[90:91], v28 offset0:0 offset1:1
    ds_read2st64_b32 v[92:93], v28 offset0:2 offset1:3
    ds_read2st64_b32 v[94:95], v28 offset0:4 offset1:5
    ds_read2st64_b32 v[96:97], v28 offset0:6 offset1:7
    s_lshl_b32 s4, s40, 12
    s_add_u32 s4, s4, 12451840
    v_add_u32 v174, s4, v30
    s_lshl_b32 s4, s41, 9
    v_add_u32 v28, s4, v174
    v_subrev_u32 v170, 2048, v170
    v_subrev_u32 v171, 2048, v171
    s_waitcnt lgkmcnt(2)
    v_pk_add_f32 v[90:91], v[90:91], v[92:93] op_sel:[0,0] op_sel_hi:[1,1]
    s_waitcnt lgkmcnt(0)
    v_pk_add_f32 v[94:95], v[94:95], v[96:97] op_sel:[0,0] op_sel_hi:[1,1]
    v_pk_add_f32 v[90:91], v[90:91], v[94:95] op_sel:[0,0] op_sel_hi:[1,1]
    v_min_u32 v90, -2, v90
    v_min_u32 v91, -2, v91
    s_lshl_b32 s4, s3, 4
    s_lshl_b64 exec, 0xffff, s4
    global_store_dwordx2 v28, v[90:91], s[38:39] sc1
    s_mov_b64 exec, -1
    ds_read_b128 v[48:51], v4 offset:0
    ds_read_b128 v[52:55], v4 offset:1040
    ds_read_b128 v[56:59], v4 offset:2080
    ds_read_b128 v[60:63], v4 offset:3120
    ds_read_b128 v[64:67], v4 offset:4160
    s_waitcnt lgkmcnt(3)
    s_waitcnt vmcnt(56)
    v_mfma_f32_16x16x32_bf16 v[210:213], a[0:3], v[48:51], 0
    ds_read_b128 v[68:71], v4 offset:5200
    s_waitcnt vmcnt(55)
    v_mfma_f32_16x16x32_bf16 v[226:229], a[4:7], v[48:51], 0
    v_mfma_f32_16x16x32_bf16 v[214:217], a[0:3], v[52:55], 0
    ds_read_b128 v[48:51], v4 offset:6240
    s_waitcnt vmcnt(9)
    ds_read_b128 a[160:163], v82 offset:0
    v_mfma_f32_16x16x32_bf16 v[230:233], a[4:7], v[52:55], 0
    v_min_u32 v175, 26, v1
    s_waitcnt lgkmcnt(4)
    v_mfma_f32_16x16x32_bf16 v[218:221], a[0:3], v[56:59], 0
    ds_read_b128 v[52:55], v4 offset:7280
    v_lshlrev_b32 v175, 7, v175
    v_mfma_f32_16x16x32_bf16 v[234:237], a[4:7], v[56:59], 0
    ds_read_b128 a[164:167], v84 offset:0
    v_mfma_f32_16x16x32_bf16 v[222:225], a[0:3], v[60:63], 0
    ds_read_b128 v[56:59], v4 offset:8320
    v_add_u32 v175, 98304, v175
    v_mfma_f32_16x16x32_bf16 v[238:241], a[4:7], v[60:63], 0
    ds_read_b128 a[168:171], v86 offset:0
    s_waitcnt lgkmcnt(6)
    v_mfma_f32_16x16x32_bf16 v[210:213], a[8:11], v[64:67], v[210:213]
    ds_read_b128 v[60:63], v4 offset:9360
    ds_read_b128 a[172:175], v88 offset:0
    v_mfma_f32_16x16x32_bf16 v[226:229], a[12:15], v[64:67], v[226:229]
    global_load_dword v250, v175, s[38:39] sc1
    v_mfma_f32_16x16x32_bf16 v[214:217], a[8:11], v[68:71], v[214:217]
    ds_read_b128 v[64:67], v4 offset:10400
    ds_read_b128 a[176:179], v83 offset:0
    s_mul_i32 s7, s41, 320
    v_mfma_f32_16x16x32_bf16 v[230:233], a[12:15], v[68:71], v[230:233]
    ds_read_b128 a[180:183], v85 offset:0
    s_waitcnt lgkmcnt(8)
    v_mfma_f32_16x16x32_bf16 v[218:221], a[8:11], v[48:51], v[218:221]
    ds_read_b128 v[68:71], v4 offset:11440
    s_add_u32 s7, s7, 12800
    v_mfma_f32_16x16x32_bf16 v[234:237], a[12:15], v[48:51], v[234:237]
    ds_read_b128 a[184:187], v87 offset:0
    v_mfma_f32_16x16x32_bf16 v[222:225], a[8:11], v[52:55], v[222:225]
    ds_read_b128 v[48:51], v4 offset:12480
    v_min_u32 v175, 304, v4
    v_mfma_f32_16x16x32_bf16 v[238:241], a[12:15], v[52:55], v[238:241]
    ds_read_b128 a[188:191], v89 offset:0
    s_waitcnt lgkmcnt(8)
    v_mfma_f32_16x16x32_bf16 v[210:213], a[16:19], v[56:59], v[210:213]
    ds_read_b128 v[52:55], v4 offset:13520
    s_waitcnt lgkmcnt(1)
    s_add_u32 m0, s89, 0
    v_mfma_f32_16x16x32_bf16 v[226:229], a[20:23], v[56:59], v[226:229]
    v_add_u32 v175, s7, v175
    v_mfma_f32_16x16x32_bf16 v[214:217], a[16:19], v[60:63], v[214:217]
    ds_read_b128 v[56:59], v4 offset:14560
    global_load_dwordx4 v[242:245], v175, s[38:39] sc1
    v_mfma_f32_16x16x32_bf16 v[230:233], a[20:23], v[60:63], v[230:233]
    global_load_lds_dwordx4 v74, s[76:77] offset:0
    v_mfma_f32_16x16x32_bf16 v[218:221], a[16:19], v[64:67], v[218:221]
    ds_read_b128 v[60:63], v4 offset:15600
    v_add_u32 v175, 15360, v175
    v_mfma_f32_16x16x32_bf16 v[234:237], a[20:23], v[64:67], v[234:237]
    global_load_lds_dwordx4 v75, s[76:77] offset:1024
    v_mfma_f32_16x16x32_bf16 v[222:225], a[16:19], v[68:71], v[222:225]
    ds_read_b128 v[64:67], v4 offset:16640
    global_load_lds_dwordx4 v76, s[76:77] offset:2048
    v_mfma_f32_16x16x32_bf16 v[238:241], a[20:23], v[68:71], v[238:241]
    global_load_dwordx4 v[246:249], v175, s[38:39] sc1
    s_waitcnt lgkmcnt(3)
    v_mfma_f32_16x16x32_bf16 v[210:213], a[24:27], v[48:51], v[210:213]
    ds_read_b128 v[68:71], v4 offset:17680
    global_load_lds_dwordx4 v77, s[76:77] offset:3072
    v_mfma_f32_16x16x32_bf16 v[226:229], a[28:31], v[48:51], v[226:229]
    ds_read_b128 v[36:39], v46 offset:0
    v_mfma_f32_16x16x32_bf16 v[214:217], a[24:27], v[52:55], v[214:217]
    ds_read_b128 v[48:51], v4 offset:18720
    s_add_u32 m0, s89, 4096
    ds_read_b128 v[40:43], v46 offset:4160
    v_mfma_f32_16x16x32_bf16 v[230:233], a[28:31], v[52:55], v[230:233]
    global_load_lds_dwordx4 v78, s[76:77] offset:0
    s_waitcnt lgkmcnt(5)
    v_mfma_f32_16x16x32_bf16 v[218:221], a[24:27], v[56:59], v[218:221]
    ds_read_b128 v[52:55], v4 offset:19760
    ds_read_b64 v[44:45], v47 offset:8320
    v_mfma_f32_16x16x32_bf16 v[234:237], a[28:31], v[56:59], v[234:237]
    global_load_lds_dwordx4 v79, s[76:77] offset:1024
    v_mfma_f32_16x16x32_bf16 v[222:225], a[24:27], v[60:63], v[222:225]
    ds_read_b128 v[56:59], v4 offset:20800
    global_load_lds_dwordx4 v80, s[76:77] offset:2048
    v_mfma_f32_16x16x32_bf16 v[238:241], a[28:31], v[60:63], v[238:241]
    s_waitcnt vmcnt(8)
    v_max3_u32 v28, v242, v243, v244
    s_waitcnt lgkmcnt(6)
    v_mfma_f32_16x16x32_bf16 v[210:213], a[32:35], v[64:67], v[210:213]
    ds_read_b128 v[60:63], v4 offset:21840
    global_load_lds_dwordx4 v81, s[76:77] offset:3072
    v_mfma_f32_16x16x32_bf16 v[226:229], a[36:39], v[64:67], v[226:229]
    s_waitcnt vmcnt(5)
    v_max3_u32 v28, v245, v246, v28
    v_mfma_f32_16x16x32_bf16 v[214:217], a[32:35], v[68:71], v[214:217]
    ds_read_b128 v[64:67], v4 offset:22880
    ds_read_b128 a[0:3], v82 offset:8192
    v_mfma_f32_16x16x32_bf16 v[230:233], a[36:39], v[68:71], v[230:233]
    v_max3_u32 v28, v247, v248, v28
    s_waitcnt lgkmcnt(5)
    v_mfma_f32_16x16x32_bf16 v[218:221], a[32:35], v[48:51], v[218:221]
    ds_read_b128 v[68:71], v4 offset:23920
    v_max3_u32 v28, v249, v250, v28
    v_mfma_f32_16x16x32_bf16 v[234:237], a[36:39], v[48:51], v[234:237]
    ds_read_b128 a[4:7], v84 offset:8192
    v_mfma_f32_16x16x32_bf16 v[222:225], a[32:35], v[52:55], v[222:225]
    ds_read_b128 v[48:51], v4 offset:24960
    ds_read_b128 a[8:11], v86 offset:8192
    v_mfma_f32_16x16x32_bf16 v[238:241], a[36:39], v[52:55], v[238:241]
    v_cmp_eq_u32 vcc, -1, v28
    s_waitcnt lgkmcnt(6)
    v_mfma_f32_16x16x32_bf16 v[210:213], a[40:43], v[56:59], v[210:213]
    ds_read_b128 v[52:55], v4 offset:26000
    ds_read_b128 a[12:15], v88 offset:8192
    v_mfma_f32_16x16x32_bf16 v[226:229], a[44:47], v[56:59], v[226:229]
    s_cbranch_vccnz Lgb_r
Lgb_ok:
    v_mfma_f32_16x16x32_bf16 v[214:217], a[40:43], v[60:63], v[214:217]
    ds_read_b128 v[56:59], v4 offset:27040
    ds_read_b128 a[16:19], v83 offset:8192
    v_mfma_f32_16x16x32_bf16 v[230:233], a[44:47], v[60:63], v[230:233]
    ds_read_b128 a[20:23], v85 offset:8192
    v_add_f32 v242, v242, v246
    s_waitcnt lgkmcnt(8)
    v_mfma_f32_16x16x32_bf16 v[218:221], a[40:43], v[64:67], v[218:221]
    ds_read_b128 v[60:63], v4 offset:28080
    v_mfma_f32_16x16x32_bf16 v[234:237], a[44:47], v[64:67], v[234:237]
    ds_read_b128 a[24:27], v87 offset:8192
    v_add_f32 v243, v243, v247
    v_mfma_f32_16x16x32_bf16 v[222:225], a[40:43], v[68:71], v[222:225]
    ds_read_b128 v[64:67], v4 offset:29120
    ds_read_b128 a[28:31], v89 offset:8192
    v_mfma_f32_16x16x32_bf16 v[238:241], a[44:47], v[68:71], v[238:241]
    v_add_f32 v244, v244, v248
    s_waitcnt lgkmcnt(8)
    v_mfma_f32_16x16x32_bf16 v[210:213], a[48:51], v[48:51], v[210:213]
    ds_read_b128 v[68:71], v4 offset:30160
    s_waitcnt lgkmcnt(1)
    s_add_u32 m0, s89, 8192
    v_mfma_f32_16x16x32_bf16 v[226:229], a[52:55], v[48:51], v[226:229]
    v_add_f32 v245, v245, v249
    v_mfma_f32_16x16x32_bf16 v[214:217], a[48:51], v[52:55], v[214:217]
    ds_read_b128 v[48:51], v4 offset:31200
    v_mfma_f32_16x16x32_bf16 v[230:233], a[52:55], v[52:55], v[230:233]
    global_load_lds_dwordx4 v74, s[78:79] offset:0
    v_cvt_pk_bf16_f32 v242, v242, v242
    v_mfma_f32_16x16x32_bf16 v[218:221], a[48:51], v[56:59], v[218:221]
    ds_read_b128 v[52:55], v4 offset:32240
    v_mfma_f32_16x16x32_bf16 v[234:237], a[52:55], v[56:59], v[234:237]
    global_load_lds_dwordx4 v75, s[78:79] offset:1024
    v_lshlrev_b32 v242, 16, v242
    v_mfma_f32_16x16x32_bf16 v[222:225], a[48:51], v[60:63], v[222:225]
    ds_read_b128 v[56:59], v4 offset:33280
    global_load_lds_dwordx4 v76, s[78:79] offset:2048
    v_mfma_f32_16x16x32_bf16 v[238:241], a[52:55], v[60:63], v[238:241]
    v_cvt_pk_bf16_f32 v243, v243, v243
    s_waitcnt lgkmcnt(3)
    v_mfma_f32_16x16x32_bf16 v[210:213], a[56:59], v[64:67], v[210:213]
    ds_read_b128 v[60:63], v4 offset:34320
    global_load_lds_dwordx4 v77, s[78:79] offset:3072
    v_mfma_f32_16x16x32_bf16 v[226:229], a[60:63], v[64:67], v[226:229]
    v_lshlrev_b32 v243, 16, v243
    v_mfma_f32_16x16x32_bf16 v[214:217], a[56:59], v[68:71], v[214:217]
    ds_read_b128 v[64:67], v4 offset:35360
    s_add_u32 m0, s89, 12288
    v_mfma_f32_16x16x32_bf16 v[230:233], a[60:63], v[68:71], v[230:233]
    global_load_lds_dwordx4 v78, s[78:79] offset:0
    v_cvt_pk_bf16_f32 v244, v244, v244
    s_waitcnt lgkmcnt(3)
    v_mfma_f32_16x16x32_bf16 v[218:221], a[56:59], v[48:51], v[218:221]
    ds_read_b128 v[68:71], v4 offset:36400
    v_mfma_f32_16x16x32_bf16 v[234:237], a[60:63], v[48:51], v[234:237]
    global_load_lds_dwordx4 v79, s[78:79] offset:1024
    v_lshlrev_b32 v244, 16, v244
    v_mfma_f32_16x16x32_bf16 v[222:225], a[56:59], v[52:55], v[222:225]
    ds_read_b128 v[48:51], v4 offset:37440
    global_load_lds_dwordx4 v80, s[78:79] offset:2048
    v_mfma_f32_16x16x32_bf16 v[238:241], a[60:63], v[52:55], v[238:241]
    v_cvt_pk_bf16_f32 v245, v245, v245
    s_waitcnt lgkmcnt(3)
    v_mfma_f32_16x16x32_bf16 v[210:213], a[64:67], v[56:59], v[210:213]
    ds_read_b128 v[52:55], v4 offset:38480
    global_load_lds_dwordx4 v81, s[78:79] offset:3072
    v_mfma_f32_16x16x32_bf16 v[226:229], a[68:71], v[56:59], v[226:229]
    v_lshlrev_b32 v245, 16, v245
    v_mfma_f32_16x16x32_bf16 v[214:217], a[64:67], v[60:63], v[214:217]
    ds_read_b128 v[56:59], v4 offset:39520
    s_waitcnt vmcnt(8)
    ds_read_b128 a[32:35], v82 offset:0
    v_mfma_f32_16x16x32_bf16 v[230:233], a[68:71], v[60:63], v[230:233]
    v_min_u32 v175, 304, v4
    s_waitcnt lgkmcnt(4)
    v_mfma_f32_16x16x32_bf16 v[218:221], a[64:67], v[64:67], v[218:221]
    ds_read_b128 v[60:63], v4 offset:40560
    v_mfma_f32_16x16x32_bf16 v[234:237], a[68:71], v[64:67], v[234:237]
    ds_read_b128 a[36:39], v84 offset:0
    v_add_u32 v175, 162816, v175
    v_mfma_f32_16x16x32_bf16 v[222:225], a[64:67], v[68:71], v[222:225]
    ds_read_b128 v[64:67], v173 offset:0
    ds_read_b128 a[40:43], v86 offset:0
    v_mfma_f32_16x16x32_bf16 v[238:241], a[68:71], v[68:71], v[238:241]
    s_waitcnt lgkmcnt(6)
    v_mfma_f32_16x16x32_bf16 v[210:213], a[72:75], v[48:51], v[210:213]
    ds_read_b128 v[68:71], v173 offset:1040
    ds_read_b128 a[44:47], v88 offset:0
    v_mfma_f32_16x16x32_bf16 v[226:229], a[76:79], v[48:51], v[226:229]
    ds_write_b128 v175, v[242:245]
    v_mfma_f32_16x16x32_bf16 v[214:217], a[72:75], v[52:55], v[214:217]
    ds_read_b128 v[48:51], v173 offset:2080
    ds_read_b128 a[48:51], v83 offset:0
    v_mfma_f32_16x16x32_bf16 v[230:233], a[76:79], v[52:55], v[230:233]
    ds_read_b128 a[52:55], v85 offset:0
    s_waitcnt lgkmcnt(9)
    v_mfma_f32_16x16x32_bf16 v[218:221], a[72:75], v[56:59], v[218:221]
    ds_read_b128 v[52:55], v173 offset:3120
    v_mfma_f32_16x16x32_bf16 v[234:237], a[76:79], v[56:59], v[234:237]
    ds_read_b128 a[56:59], v87 offset:0
    v_mfma_f32_16x16x32_bf16 v[222:225], a[72:75], v[60:63], v[222:225]
    ds_read_b128 v[56:59], v173 offset:4160
    global_load_dwordx2 v[130:131], v174, s[38:39] offset:0 sc1
    v_mfma_f32_16x16x32_bf16 v[238:241], a[76:79], v[60:63], v[238:241]
    global_load_dwordx2 v[132:133], v174, s[38:39] offset:512 sc1
    ds_read_b128 a[60:63], v89 offset:0
    s_waitcnt lgkmcnt(9)
    v_mfma_f32_16x16x32_bf16 v[210:213], a[80:83], v[64:67], v[210:213]
    ds_read_b128 v[60:63], v173 offset:5200
    global_load_dwordx2 v[134:135], v174, s[38:39] offset:1024 sc1
    v_mfma_f32_16x16x32_bf16 v[226:229], a[84:87], v[64:67], v[226:229]
    global_load_dwordx2 v[136:137], v174, s[38:39] offset:1536 sc1
    s_waitcnt lgkmcnt(1)
    s_add_u32 m0, s89, 0
    v_mfma_f32_16x16x32_bf16 v[214:217], a[80:83], v[68:71], v[214:217]
    ds_read_b128 v[64:67], v173 offset:6240
    global_load_dwordx2 v[138:139], v174, s[38:39] offset:2048 sc1
    v_mfma_f32_16x16x32_bf16 v[230:233], a[84:87], v[68:71], v[230:233]
    global_load_dwordx2 v[140:141], v174, s[38:39] offset:2560 sc1
    global_load_dwordx2 v[142:143], v174, s[38:39] offset:3072 sc1
    v_mfma_f32_16x16x32_bf16 v[218:221], a[80:83], v[48:51], v[218:221]
    ds_read_b128 v[68:71], v173 offset:7280
    global_load_lds_dwordx4 v74, s[80:81] offset:0
    v_mfma_f32_16x16x32_bf16 v[234:237], a[84:87], v[48:51], v[234:237]
    global_load_dwordx2 v[144:145], v174, s[38:39] offset:3584 sc1
    s_bfe_u32 s6, s2, 0x30003
    global_load_lds_dwordx4 v75, s[80:81] offset:1024
    v_mfma_f32_16x16x32_bf16 v[222:225], a[80:83], v[52:55], v[222:225]
    ds_read_b128 v[48:51], v173 offset:8320
    v_mul_u32_u24 v254, 8, v0
    v_mfma_f32_16x16x32_bf16 v[238:241], a[84:87], v[52:55], v[238:241]
    v_add_lshl_u32 v254, v254, s6, 7
    global_load_lds_dwordx4 v76, s[80:81] offset:2048
    s_waitcnt lgkmcnt(3)
    v_mfma_f32_16x16x32_bf16 v[210:213], a[88:91], v[56:59], v[210:213]
    ds_read_b128 v[52:55], v173 offset:9360
    v_min_u32 v254, (Lend-Lmid-4), v254
    v_mfma_f32_16x16x32_bf16 v[226:229], a[92:95], v[56:59], v[226:229]
    v_add_u32 v254, (Lmid-adaLN_cond__ssm_conv_h3__mixer_gmlp__prompt_kernel), v254
    global_load_lds_dwordx4 v77, s[80:81] offset:3072
    v_mfma_f32_16x16x32_bf16 v[214:217], a[88:91], v[60:63], v[214:217]
    ds_read_b128 v[56:59], v173 offset:10400
    global_load_dword v254, v254, s[0:1]
    s_add_u32 m0, s89, 4096
    v_mfma_f32_16x16x32_bf16 v[230:233], a[92:95], v[60:63], v[230:233]
    global_load_lds_dwordx4 v78, s[80:81] offset:0
    s_waitcnt lgkmcnt(3)
    v_mfma_f32_16x16x32_bf16 v[218:221], a[88:91], v[64:67], v[218:221]
    ds_read_b128 v[60:63], v173 offset:11440
    v_mfma_f32_16x16x32_bf16 v[234:237], a[92:95], v[64:67], v[234:237]
    global_load_lds_dwordx4 v79, s[80:81] offset:1024
    v_mfma_f32_16x16x32_bf16 v[222:225], a[88:91], v[68:71], v[222:225]
    ds_read_b128 v[64:67], v173 offset:12480
    global_load_lds_dwordx4 v80, s[80:81] offset:2048
    v_mfma_f32_16x16x32_bf16 v[238:241], a[92:95], v[68:71], v[238:241]
    s_waitcnt lgkmcnt(3)
    v_mfma_f32_16x16x32_bf16 v[210:213], a[96:99], v[48:51], v[210:213]
    ds_read_b128 v[68:71], v173 offset:13520
    global_load_lds_dwordx4 v81, s[80:81] offset:3072
    v_mfma_f32_16x16x32_bf16 v[226:229], a[100:103], v[48:51], v[226:229]
    v_mfma_f32_16x16x32_bf16 v[214:217], a[96:99], v[52:55], v[214:217]
    ds_read_b128 v[48:51], v173 offset:14560
    s_waitcnt vmcnt(17)
    ds_read_b128 a[64:67], v82 offset:8192
    v_mfma_f32_16x16x32_bf16 v[230:233], a[100:103], v[52:55], v[230:233]
    s_waitcnt lgkmcnt(4)
    v_mfma_f32_16x16x32_bf16 v[218:221], a[96:99], v[56:59], v[218:221]
    ds_read_b128 v[52:55], v173 offset:15600
    v_mfma_f32_16x16x32_bf16 v[234:237], a[100:103], v[56:59], v[234:237]
    ds_read_b128 a[68:71], v84 offset:8192
    v_mfma_f32_16x16x32_bf16 v[222:225], a[96:99], v[60:63], v[222:225]
    ds_read_b128 v[56:59], v173 offset:16640
    ds_read_b128 a[72:75], v86 offset:8192
    v_mfma_f32_16x16x32_bf16 v[238:241], a[100:103], v[60:63], v[238:241]
    s_waitcnt lgkmcnt(6)
    v_mfma_f32_16x16x32_bf16 v[210:213], a[104:107], v[64:67], v[210:213]
    ds_read_b128 v[60:63], v173 offset:17680
    ds_read_b128 a[76:79], v88 offset:8192
    v_mfma_f32_16x16x32_bf16 v[226:229], a[108:111], v[64:67], v[226:229]
    v_mfma_f32_16x16x32_bf16 v[214:217], a[104:107], v[68:71], v[214:217]
    ds_read_b128 v[64:67], v173 offset:18720
    ds_read_b128 a[80:83], v83 offset:8192
    v_mfma_f32_16x16x32_bf16 v[230:233], a[108:111], v[68:71], v[230:233]
    ds_read_b128 a[84:87], v85 offset:8192
    s_waitcnt lgkmcnt(8)
    s_waitcnt vmcnt(15)
    v_max_u32 v28, v131, v133
    s_waitcnt vmcnt(13)
    v_max3_u32 v28, v135, v137, v28
    s_waitcnt vmcnt(11)
    v_max3_u32 v28, v139, v141, v28
    s_waitcnt vmcnt(8)
    v_max3_u32 v28, v143, v145, v28
    v_cmp_eq_u32 vcc, -1, v28
    s_nop 0
    s_cbranch_vccnz Ls3_r
Ls3_ok:
    v_pk_add_f32 v[130:131], v[130:131], v[132:133] op_sel:[0,0] op_sel_hi:[1,1]
    v_pk_add_f32 v[134:135], v[134:135], v[136:137] op_sel:[0,0] op_sel_hi:[1,1]
    v_pk_add_f32 v[138:139], v[138:139], v[140:141] op_sel:[0,0] op_sel_hi:[1,1]
    v_pk_add_f32 v[142:143], v[142:143], v[144:145] op_sel:[0,0] op_sel_hi:[1,1]
    v_pk_add_f32 v[130:131], v[130:131], v[134:135] op_sel:[0,0] op_sel_hi:[1,1]
    v_pk_add_f32 v[138:139], v[138:139], v[142:143] op_sel:[0,0] op_sel_hi:[1,1]
    v_pk_add_f32 v[130:131], v[130:131], v[138:139] op_sel:[0,0] op_sel_hi:[1,1]
    v_mul_f32 v130, 0x3a97b426, v130
    v_mul_f32 v131, 0x3a97b426, v131
    v_fma_f32 v131, -v130, v130, v131
    v_max_f32 v131, 0, v131
    v_add_f32 v131, 0x3727c5ac, v131
    v_rsq_f32 v132, v131
    s_nop 0
    v_mul_f32_e64 v131, -v130, v132
    v_mov_b32 v130, v132
    ds_write2st64_b32 v170, v130, v131 offset0:0 offset1:1
    ds_read_b128 v[98:101], v171 offset:0
    ds_read_b128 v[102:105], v171 offset:16
    ds_read_b128 v[106:109], v171 offset:128
    ds_read_b128 v[110:113], v171 offset:144
    ds_read_b128 v[114:117], v171 offset:256
    ds_read_b128 v[118:121], v171 offset:272
    ds_read_b128 v[122:125], v171 offset:384
    ds_read_b128 v[126:129], v171 offset:400
    s_lshl_b32 s4, s41, 6
    s_lshl_b32 s5, s40, 1
    s_add_u32 s4, s4, s5
    s_mul_i32 s4, s4, 7168
    s_lshl_b32 s5, s3, 11
    s_add_u32 s4, s4, s5
    s_add_u32 s4, s4, 12582912
    v_add_u32 v28, s4, v4
    v_add_u32 v29, 7168, v28
    s_waitcnt lgkmcnt(3)
    v_pk_fma_f32 v[178:179], v[178:179], v[98:99], v[114:115] op_sel:[0,0,0] op_sel_hi:[1,1,1]
    v_pk_fma_f32 v[180:181], v[180:181], v[100:101], v[116:117] op_sel:[0,0,0] op_sel_hi:[1,1,1]
    s_waitcnt lgkmcnt(2)
    v_pk_fma_f32 v[182:183], v[182:183], v[102:103], v[118:119] op_sel:[0,0,0] op_sel_hi:[1,1,1]
    v_pk_fma_f32 v[184:185], v[184:185], v[104:105], v[120:121] op_sel:[0,0,0] op_sel_hi:[1,1,1]
    v_cvt_pk_bf16_f32 v130, v178, v179
    v_cvt_pk_bf16_f32 v131, v180, v181
    v_cvt_pk_bf16_f32 v132, v182, v183
    v_cvt_pk_bf16_f32 v133, v184, v185
    v_or_b32 v133, 1, v133
    global_store_dwordx4 v28, v[130:133], s[38:39] offset:0 sc1
    s_waitcnt lgkmcnt(1)
    v_pk_fma_f32 v[186:187], v[186:187], v[106:107], v[122:123] op_sel:[0,0,0] op_sel_hi:[1,1,1]
    v_pk_fma_f32 v[188:189], v[188:189], v[108:109], v[124:125] op_sel:[0,0,0] op_sel_hi:[1,1,1]
    s_waitcnt lgkmcnt(0)
    v_pk_fma_f32 v[190:191], v[190:191], v[110:111], v[126:127] op_sel:[0,0,0] op_sel_hi:[1,1,1]
    v_pk_fma_f32 v[192:193], v[192:193], v[112:113], v[128:129] op_sel:[0,0,0] op_sel_hi:[1,1,1]
    v_cvt_pk_bf16_f32 v134, v186, v187
    v_cvt_pk_bf16_f32 v135, v188, v189
    v_cvt_pk_bf16_f32 v136, v190, v191
    v_cvt_pk_bf16_f32 v137, v192, v193
    v_or_b32 v137, 1, v137
    global_store_dwordx4 v29, v[134:137], s[38:39] offset:0 sc1
    v_pk_fma_f32 v[194:195], v[194:195], v[98:99], v[114:115] op_sel:[0,0,0] op_sel_hi:[1,1,1]
    v_pk_fma_f32 v[196:197], v[196:197], v[100:101], v[116:117] op_sel:[0,0,0] op_sel_hi:[1,1,1]
    v_pk_fma_f32 v[198:199], v[198:199], v[102:103], v[118:119] op_sel:[0,0,0] op_sel_hi:[1,1,1]
    v_pk_fma_f32 v[200:201], v[200:201], v[104:105], v[120:121] op_sel:[0,0,0] op_sel_hi:[1,1,1]
    v_cvt_pk_bf16_f32 v138, v194, v195
    v_cvt_pk_bf16_f32 v139, v196, v197
    v_cvt_pk_bf16_f32 v140, v198, v199
    v_cvt_pk_bf16_f32 v141, v200, v201
    v_or_b32 v141, 1, v141
    s_cmp_eq_u32 s3, 3
    s_cbranch_scc1 Lzs_0
    global_store_dwordx4 v28, v[138:141], s[38:39] offset:1024 sc1
Lzs_0:
    v_pk_fma_f32 v[202:203], v[202:203], v[106:107], v[122:123] op_sel:[0,0,0] op_sel_hi:[1,1,1]
    v_pk_fma_f32 v[204:205], v[204:205], v[108:109], v[124:125] op_sel:[0,0,0] op_sel_hi:[1,1,1]
    v_pk_fma_f32 v[206:207], v[206:207], v[110:111], v[126:127] op_sel:[0,0,0] op_sel_hi:[1,1,1]
    v_pk_fma_f32 v[208:209], v[208:209], v[112:113], v[128:129] op_sel:[0,0,0] op_sel_hi:[1,1,1]
    v_cvt_pk_bf16_f32 v142, v202, v203
    v_cvt_pk_bf16_f32 v143, v204, v205
    v_cvt_pk_bf16_f32 v144, v206, v207
    v_cvt_pk_bf16_f32 v145, v208, v209
    v_or_b32 v145, 1, v145
    s_cmp_eq_u32 s3, 3
    s_cbranch_scc1 Lzs_1
    global_store_dwordx4 v29, v[142:145], s[38:39] offset:1024 sc1
Lzs_1:
    v_mfma_f32_16x16x32_bf16 v[218:221], a[104:107], v[48:51], v[218:221]
    ds_read_b128 v[68:71], v173 offset:19760
    v_mfma_f32_16x16x32_bf16 v[234:237], a[108:111], v[48:51], v[234:237]
    ds_read_b128 a[88:91], v87 offset:8192
    s_mul_i32 s91, s41, 458752
    v_mfma_f32_16x16x32_bf16 v[222:225], a[104:107], v[52:55], v[222:225]
    ds_read_b128 v[48:51], v173 offset:20800
    ds_read_b128 a[92:95], v89 offset:8192
    s_add_u32 s91, s91, 12582912
    v_mfma_f32_16x16x32_bf16 v[238:241], a[108:111], v[52:55], v[238:241]
    v_mfma_f32_16x16x32_bf16 v[210:213], a[112:115], v[56:59], v[210:213]
    ds_read_b128 v[52:55], v173 offset:21840
    s_waitcnt lgkmcnt(1)
    s_add_u32 m0, s89, 8192
    v_mfma_f32_16x16x32_bf16 v[226:229], a[116:119], v[56:59], v[226:229]
    s_mul_i32 s6, s44, 14336
    v_mfma_f32_16x16x32_bf16 v[214:217], a[112:115], v[60:63], v[214:217]
    ds_read_b128 v[56:59], v173 offset:22880
    s_add_u32 s6, s6, s91
    v_mfma_f32_16x16x32_bf16 v[230:233], a[116:119], v[60:63], v[230:233]
    global_load_lds_dwordx4 v74, s[82:83] offset:0
    v_mfma_f32_16x16x32_bf16 v[218:221], a[112:115], v[64:67], v[218:221]
    ds_read_b128 v[60:63], v173 offset:23920
    s_add_u32 s52, s38, s6
    s_addc_u32 s53, s39, 0
    v_mfma_f32_16x16x32_bf16 v[234:237], a[116:119], v[64:67], v[234:237]
    global_load_lds_dwordx4 v75, s[82:83] offset:1024
    v_mfma_f32_16x16x32_bf16 v[222:225], a[112:115], v[68:71], v[222:225]
    ds_read_b128 v[64:67], v173 offset:24960
    global_load_lds_dwordx4 v76, s[82:83] offset:2048
    v_mfma_f32_16x16x32_bf16 v[238:241], a[116:119], v[68:71], v[238:241]
    s_waitcnt lgkmcnt(3)
    v_mfma_f32_16x16x32_bf16 v[210:213], a[120:123], v[48:51], v[210:213]
    ds_read_b128 v[68:71], v173 offset:26000
    global_load_lds_dwordx4 v77, s[82:83] offset:3072
    v_mfma_f32_16x16x32_bf16 v[226:229], a[124:127], v[48:51], v[226:229]
    s_add_u32 s54, s52, 14336
    s_addc_u32 s55, s53, 0
    v_mfma_f32_16x16x32_bf16 v[214:217], a[120:123], v[52:55], v[214:217]
    ds_read_b128 v[48:51], v173 offset:27040
    s_add_u32 m0, s89, 12288
    v_mfma_f32_16x16x32_bf16 v[230:233], a[124:127], v[52:55], v[230:233]
    global_load_lds_dwordx4 v78, s[82:83] offset:0
    s_waitcnt lgkmcnt(3)
    v_mfma_f32_16x16x32_bf16 v[218:221], a[120:123], v[56:59], v[218:221]
    ds_read_b128 v[52:55], v173 offset:28080
    s_mul_i32 s6, s46, 14336
    v_mfma_f32_16x16x32_bf16 v[234:237], a[124:127], v[56:59], v[234:237]
    global_load_lds_dwordx4 v79, s[82:83] offset:1024
    v_mfma_f32_16x16x32_bf16 v[222:225], a[120:123], v[60:63], v[222:225]
    ds_read_b128 v[56:59], v173 offset:29120
    s_add_u32 s6, s6, s91
    global_load_lds_dwordx4 v80, s[82:83] offset:2048
    v_mfma_f32_16x16x32_bf16 v[238:241], a[124:127], v[60:63], v[238:241]
    s_waitcnt lgkmcnt(3)
    v_mfma_f32_16x16x32_bf16 v[210:213], a[128:131], v[64:67], v[210:213]
    ds_read_b128 v[60:63], v173 offset:30160
    global_load_lds_dwordx4 v81, s[82:83] offset:3072
    v_mfma_f32_16x16x32_bf16 v[226:229], a[132:135], v[64:67], v[226:229]
    s_add_u32 s56, s38, s6
    s_addc_u32 s57, s39, 0
    v_mfma_f32_16x16x32_bf16 v[214:217], a[128:131], v[68:71], v[214:217]
    ds_read_b128 v[64:67], v173 offset:31200
    s_waitcnt vmcnt(10)
    ds_read_b128 a[96:99], v82 offset:0
    v_mfma_f32_16x16x32_bf16 v[230:233], a[132:135], v[68:71], v[230:233]
    s_waitcnt lgkmcnt(4)
    v_mfma_f32_16x16x32_bf16 v[218:221], a[128:131], v[48:51], v[218:221]
    ds_read_b128 v[68:71], v173 offset:32240
    s_add_u32 s58, s56, 14336
    s_addc_u32 s59, s57, 0
    v_mfma_f32_16x16x32_bf16 v[234:237], a[132:135], v[48:51], v[234:237]
    v_mfma_f32_16x16x32_bf16 v[222:225], a[128:131], v[52:55], v[222:225]
    ds_read_b128 v[48:51], v173 offset:33280
    ds_read_b128 a[100:103], v84 offset:0
    v_mfma_f32_16x16x32_bf16 v[238:241], a[132:135], v[52:55], v[238:241]
    s_mul_i32 s6, s48, 14336
    s_waitcnt lgkmcnt(5)
    v_mfma_f32_16x16x32_bf16 v[210:213], a[136:139], v[56:59], v[210:213]
    ds_read_b128 v[52:55], v173 offset:34320
    v_mfma_f32_16x16x32_bf16 v[226:229], a[140:143], v[56:59], v[226:229]
    ds_read_b128 a[104:107], v86 offset:0
    s_add_u32 s6, s6, s91
    v_mfma_f32_16x16x32_bf16 v[214:217], a[136:139], v[60:63], v[214:217]
    ds_read_b128 v[56:59], v173 offset:35360
    v_mfma_f32_16x16x32_bf16 v[230:233], a[140:143], v[60:63], v[230:233]
    ds_read_b128 a[108:111], v88 offset:0
    s_waitcnt lgkmcnt(6)
    v_mfma_f32_16x16x32_bf16 v[218:221], a[136:139], v[64:67], v[218:221]
    ds_read_b128 v[60:63], v173 offset:36400
    s_add_u32 s60, s38, s6
    s_addc_u32 s61, s39, 0
    v_mfma_f32_16x16x32_bf16 v[234:237], a[140:143], v[64:67], v[234:237]
    ds_read_b128 a[112:115], v83 offset:0
    v_mfma_f32_16x16x32_bf16 v[222:225], a[136:139], v[68:71], v[222:225]
    ds_read_b128 v[64:67], v173 offset:37440
    v_mfma_f32_16x16x32_bf16 v[238:241], a[140:143], v[68:71], v[238:241]
    s_add_u32 s62, s60, 14336
    s_addc_u32 s63, s61, 0
    s_waitcnt lgkmcnt(6)
    v_mfma_f32_16x16x32_bf16 v[210:213], a[144:147], v[48:51], v[210:213]
    ds_read_b128 v[68:71], v173 offset:38480
    ds_read_b128 a[116:119], v85 offset:0
    v_mfma_f32_16x16x32_bf16 v[226:229], a[148:151], v[48:51], v[226:229]
    v_mfma_f32_16x16x32_bf16 v[214:217], a[144:147], v[52:55], v[214:217]
    ds_read_b128 v[48:51], v173 offset:39520
    ds_read_b128 a[120:123], v87 offset:0
    v_mfma_f32_16x16x32_bf16 v[230:233], a[148:151], v[52:55], v[230:233]
    s_mul_i32 s6, s50, 14336
    s_waitcnt lgkmcnt(6)
    v_mfma_f32_16x16x32_bf16 v[218:221], a[144:147], v[56:59], v[218:221]
    ds_read_b128 v[52:55], v173 offset:40560
    ds_read_b128 a[124:127], v89 offset:0
    v_mfma_f32_16x16x32_bf16 v[234:237], a[148:151], v[56:59], v[234:237]
    s_add_u32 s6, s6, s91
    v_mfma_f32_16x16x32_bf16 v[222:225], a[144:147], v[60:63], v[222:225]
    v_mfma_f32_16x16x32_bf16 v[238:241], a[148:151], v[60:63], v[238:241]
    s_add_u32 s64, s38, s6
    s_addc_u32 s65, s39, 0
    s_waitcnt lgkmcnt(5)
    v_mfma_f32_16x16x32_bf16 v[210:213], a[152:155], v[64:67], v[210:213]
    v_mfma_f32_16x16x32_bf16 v[226:229], a[156:159], v[64:67], v[226:229]
    v_mfma_f32_16x16x32_bf16 v[214:217], a[152:155], v[68:71], v[214:217]
    v_mfma_f32_16x16x32_bf16 v[230:233], a[156:159], v[68:71], v[230:233]
    s_add_u32 s66, s64, 14336
    s_addc_u32 s67, s65, 0
    s_waitcnt lgkmcnt(1)
    v_mfma_f32_16x16x32_bf16 v[218:221], a[152:155], v[48:51], v[218:221]
    v_mfma_f32_16x16x32_bf16 v[234:237], a[156:159], v[48:51], v[234:237]
    v_mfma_f32_16x16x32_bf16 v[222:225], a[152:155], v[52:55], v[222:225]
    v_mfma_f32_16x16x32_bf16 v[238:241], a[156:159], v[52:55], v[238:241]
    s_waitcnt vmcnt(0)
    ds_read_b128 a[128:131], v82 offset:8192
    ds_read_b128 a[132:135], v84 offset:8192
    ds_read_b128 a[136:139], v86 offset:8192
    ds_read_b128 a[140:143], v88 offset:8192
    ds_read_b128 a[144:147], v83 offset:8192
    ds_read_b128 a[148:151], v85 offset:8192
    ds_read_b128 a[152:155], v87 offset:8192
    ds_read_b128 a[156:159], v89 offset:8192
    s_waitcnt lgkmcnt(0)
    s_barrier
    s_mul_i32 s5, s41, 138240
    s_add_u32 s5, s5, 10485760
    s_add_u32 s92, s38, s5
    s_addc_u32 s93, s39, 0
    s_mul_i32 s95, s3, 34816
    s_min_u32 s95, s95, 103424
    s_add_u32 s92, s92, s95
    s_addc_u32 s93, s93, 0
    s_add_u32 m0, s95, 0
    s_nop 0
    global_load_lds_dwordx4 v4, s[92:93] offset:0 sc1
    s_lshl_b32 s4, s3, 10
    s_add_u32 s4, s4, 138240
    v_add_u32 v170, s4, v30
    s_lshl_b32 s4, s3, 12
    s_add_u32 s4, s4, 138240
    v_add_u32 v171, s4, v30
    v_add_u32 v30, 3072, v4
    v_add_u32 v31, 10240, v4
    v_min_u32 v29, 27, v1
    v_lshlrev_b32 v29, 10, v29
    v_pk_fma_f32 v[178:179], v[162:163], v[12:13], v[16:17] op_sel:[1,0,0] op_sel_hi:[1,1,1]
    v_pk_fma_f32 v[180:181], v[162:163], v[14:15], v[18:19] op_sel:[1,0,0] op_sel_hi:[1,1,1]
    v_pk_fma_f32 v[182:183], v[164:165], v[12:13], v[16:17] op_sel:[1,0,0] op_sel_hi:[1,1,1]
    v_pk_fma_f32 v[184:185], v[164:165], v[14:15], v[18:19] op_sel:[1,0,0] op_sel_hi:[1,1,1]
    v_pk_fma_f32 v[186:187], v[166:167], v[12:13], v[16:17] op_sel:[1,0,0] op_sel_hi:[1,1,1]
    v_pk_fma_f32 v[188:189], v[166:167], v[14:15], v[18:19] op_sel:[1,0,0] op_sel_hi:[1,1,1]
    v_pk_fma_f32 v[190:191], v[168:169], v[12:13], v[16:17] op_sel:[1,0,0] op_sel_hi:[1,1,1]
    v_pk_fma_f32 v[192:193], v[168:169], v[14:15], v[18:19] op_sel:[1,0,0] op_sel_hi:[1,1,1]
    v_pk_fma_f32 v[210:211], v[162:163], v[210:211], v[178:179] op_sel:[0,0,0] op_sel_hi:[0,1,1]
    global_load_lds_dwordx4 v4, s[92:93] offset:1024 sc1
    v_pk_fma_f32 v[212:213], v[162:163], v[212:213], v[180:181] op_sel:[0,0,0] op_sel_hi:[0,1,1]
    v_pk_fma_f32 v[214:215], v[164:165], v[214:215], v[182:183] op_sel:[0,0,0] op_sel_hi:[0,1,1]
    v_pk_fma_f32 v[216:217], v[164:165], v[216:217], v[184:185] op_sel:[0,0,0] op_sel_hi:[0,1,1]
    v_pk_fma_f32 v[218:219], v[166:167], v[218:219], v[186:187] op_sel:[0,0,0] op_sel_hi:[0,1,1]
    v_pk_fma_f32 v[220:221], v[166:167], v[220:221], v[188:189] op_sel:[0,0,0] op_sel_hi:[0,1,1]
    v_pk_fma_f32 v[222:223], v[168:169], v[222:223], v[190:191] op_sel:[0,0,0] op_sel_hi:[0,1,1]
    v_pk_fma_f32 v[224:225], v[168:169], v[224:225], v[192:193] op_sel:[0,0,0] op_sel_hi:[0,1,1]
    v_pk_fma_f32 v[178:179], v[162:163], v[20:21], v[24:25] op_sel:[1,0,0] op_sel_hi:[1,1,1]
    v_pk_fma_f32 v[180:181], v[162:163], v[22:23], v[26:27] op_sel:[1,0,0] op_sel_hi:[1,1,1]
    v_pk_fma_f32 v[182:183], v[164:165], v[20:21], v[24:25] op_sel:[1,0,0] op_sel_hi:[1,1,1]
    v_pk_fma_f32 v[184:185], v[164:165], v[22:23], v[26:27] op_sel:[1,0,0] op_sel_hi:[1,1,1]
    v_pk_fma_f32 v[186:187], v[166:167], v[20:21], v[24:25] op_sel:[1,0,0] op_sel_hi:[1,1,1]
    v_pk_fma_f32 v[188:189], v[166:167], v[22:23], v[26:27] op_sel:[1,0,0] op_sel_hi:[1,1,1]
    v_pk_fma_f32 v[190:191], v[168:169], v[20:21], v[24:25] op_sel:[1,0,0] op_sel_hi:[1,1,1]
    v_pk_fma_f32 v[192:193], v[168:169], v[22:23], v[26:27] op_sel:[1,0,0] op_sel_hi:[1,1,1]
    v_pk_fma_f32 v[226:227], v[162:163], v[226:227], v[178:179] op_sel:[0,0,0] op_sel_hi:[0,1,1]
    v_pk_fma_f32 v[228:229], v[162:163], v[228:229], v[180:181] op_sel:[0,0,0] op_sel_hi:[0,1,1]
    v_pk_fma_f32 v[230:231], v[164:165], v[230:231], v[182:183] op_sel:[0,0,0] op_sel_hi:[0,1,1]
    v_pk_fma_f32 v[232:233], v[164:165], v[232:233], v[184:185] op_sel:[0,0,0] op_sel_hi:[0,1,1]
    global_load_lds_dwordx4 v4, s[92:93] offset:2048 sc1
    v_pk_fma_f32 v[234:235], v[166:167], v[234:235], v[186:187] op_sel:[0,0,0] op_sel_hi:[0,1,1]
    v_pk_fma_f32 v[236:237], v[166:167], v[236:237], v[188:189] op_sel:[0,0,0] op_sel_hi:[0,1,1]
    v_pk_fma_f32 v[238:239], v[168:169], v[238:239], v[190:191] op_sel:[0,0,0] op_sel_hi:[0,1,1]
    v_pk_fma_f32 v[240:241], v[168:169], v[240:241], v[192:193] op_sel:[0,0,0] op_sel_hi:[0,1,1]
    v_pk_mul_f32 v[178:179], v[210:211], v[210:211] op_sel:[0,0] op_sel_hi:[1,1]
    v_pk_mul_f32 v[180:181], v[212:213], v[212:213] op_sel:[0,0] op_sel_hi:[1,1]
    v_pk_mul_f32 v[182:183], v[214:215], v[214:215] op_sel:[0,0] op_sel_hi:[1,1]
    v_pk_mul_f32 v[184:185], v[216:217], v[216:217] op_sel:[0,0] op_sel_hi:[1,1]
    v_pk_mul_f32 v[186:187], v[218:219], v[218:219] op_sel:[0,0] op_sel_hi:[1,1]
    v_pk_mul_f32 v[188:189], v[220:221], v[220:221] op_sel:[0,0] op_sel_hi:[1,1]
    v_pk_mul_f32 v[190:191], v[222:223], v[222:223] op_sel:[0,0] op_sel_hi:[1,1]
    v_pk_mul_f32 v[192:193], v[224:225], v[224:225] op_sel:[0,0] op_sel_hi:[1,1]
    v_pk_mul_f32 v[194:195], v[226:227], v[226:227] op_sel:[0,0] op_sel_hi:[1,1]
    v_pk_mul_f32 v[196:197], v[228:229], v[228:229] op_sel:[0,0] op_sel_hi:[1,1]
    v_pk_mul_f32 v[198:199], v[230:231], v[230:231] op_sel:[0,0] op_sel_hi:[1,1]
    v_pk_mul_f32 v[200:201], v[232:233], v[232:233] op_sel:[0,0] op_sel_hi:[1,1]
    v_pk_mul_f32 v[202:203], v[234:235], v[234:235] op_sel:[0,0] op_sel_hi:[1,1]
    v_pk_mul_f32 v[204:205], v[236:237], v[236:237] op_sel:[0,0] op_sel_hi:[1,1]
    v_pk_mul_f32 v[206:207], v[238:239], v[238:239] op_sel:[0,0] op_sel_hi:[1,1]
    global_load_lds_dwordx4 v4, s[92:93] offset:3072 sc1
    v_pk_mul_f32 v[208:209], v[240:241], v[240:241] op_sel:[0,0] op_sel_hi:[1,1]
    v_pk_fma_f32 v[178:179], v[178:179], s[84:85], s[84:85] op_sel:[0,1,0] op_sel_hi:[1,1,0]
    v_pk_fma_f32 v[180:181], v[180:181], s[84:85], s[84:85] op_sel:[0,1,0] op_sel_hi:[1,1,0]
    v_pk_fma_f32 v[182:183], v[182:183], s[84:85], s[84:85] op_sel:[0,1,0] op_sel_hi:[1,1,0]
    v_pk_fma_f32 v[184:185], v[184:185], s[84:85], s[84:85] op_sel:[0,1,0] op_sel_hi:[1,1,0]
    v_pk_fma_f32 v[186:187], v[186:187], s[84:85], s[84:85] op_sel:[0,1,0] op_sel_hi:[1,1,0]
    v_pk_fma_f32 v[188:189], v[188:189], s[84:85], s[84:85] op_sel:[0,1,0] op_sel_hi:[1,1,0]
    v_pk_fma_f32 v[190:191], v[190:191], s[84:85], s[84:85] op_sel:[0,1,0] op_sel_hi:[1,1,0]
    v_pk_fma_f32 v[192:193], v[192:193], s[84:85], s[84:85] op_sel:[0,1,0] op_sel_hi:[1,1,0]
    v_pk_fma_f32 v[194:195], v[194:195], s[84:85], s[84:85] op_sel:[0,1,0] op_sel_hi:[1,1,0]
    v_pk_fma_f32 v[196:197], v[196:197], s[84:85], s[84:85] op_sel:[0,1,0] op_sel_hi:[1,1,0]
    v_pk_fma_f32 v[198:199], v[198:199], s[84:85], s[84:85] op_sel:[0,1,0] op_sel_hi:[1,1,0]
    v_pk_fma_f32 v[200:201], v[200:201], s[84:85], s[84:85] op_sel:[0,1,0] op_sel_hi:[1,1,0]
    v_pk_fma_f32 v[202:203], v[202:203], s[84:85], s[84:85] op_sel:[0,1,0] op_sel_hi:[1,1,0]
    v_pk_fma_f32 v[204:205], v[204:205], s[84:85], s[84:85] op_sel:[0,1,0] op_sel_hi:[1,1,0]
    v_pk_fma_f32 v[206:207], v[206:207], s[84:85], s[84:85] op_sel:[0,1,0] op_sel_hi:[1,1,0]
    v_pk_fma_f32 v[208:209], v[208:209], s[84:85], s[84:85] op_sel:[0,1,0] op_sel_hi:[1,1,0]
    v_pk_mul_f32 v[178:179], v[178:179], v[210:211] op_sel:[0,0] op_sel_hi:[1,1]
    v_pk_mul_f32 v[180:181], v[180:181], v[212:213] op_sel:[0,0] op_sel_hi:[1,1]
    s_add_u32 m0, s95, 4096
    s_add_u32 s92, s92, 4096
    s_addc_u32 s93, s93, 0
    global_load_lds_dwordx4 v4, s[92:93] offset:0 sc1
    v_pk_mul_f32 v[182:183], v[182:183], v[214:215] op_sel:[0,0] op_sel_hi:[1,1]
    v_pk_mul_f32 v[184:185], v[184:185], v[216:217] op_sel:[0,0] op_sel_hi:[1,1]
    v_pk_mul_f32 v[186:187], v[186:187], v[218:219] op_sel:[0,0] op_sel_hi:[1,1]
    v_pk_mul_f32 v[188:189], v[188:189], v[220:221] op_sel:[0,0] op_sel_hi:[1,1]
    v_pk_mul_f32 v[190:191], v[190:191], v[222:223] op_sel:[0,0] op_sel_hi:[1,1]
    v_pk_mul_f32 v[192:193], v[192:193], v[224:225] op_sel:[0,0] op_sel_hi:[1,1]
    v_pk_mul_f32 v[194:195], v[194:195], v[226:227] op_sel:[0,0] op_sel_hi:[1,1]
    v_pk_mul_f32 v[196:197], v[196:197], v[228:229] op_sel:[0,0] op_sel_hi:[1,1]
    v_pk_mul_f32 v[198:199], v[198:199], v[230:231] op_sel:[0,0] op_sel_hi:[1,1]
    v_pk_mul_f32 v[200:201], v[200:201], v[232:233] op_sel:[0,0] op_sel_hi:[1,1]
    v_pk_mul_f32 v[202:203], v[202:203], v[234:235] op_sel:[0,0] op_sel_hi:[1,1]
    v_pk_mul_f32 v[204:205], v[204:205], v[236:237] op_sel:[0,0] op_sel_hi:[1,1]
    v_pk_mul_f32 v[206:207], v[206:207], v[238:239] op_sel:[0,0] op_sel_hi:[1,1]
    v_pk_mul_f32 v[208:209], v[208:209], v[240:241] op_sel:[0,0] op_sel_hi:[1,1]
    v_exp_f32 v178, v178
    v_exp_f32 v179, v179
    v_exp_f32 v180, v180
    v_exp_f32 v181, v181
    v_exp_f32 v182, v182
    global_load_lds_dwordx4 v4, s[92:93] offset:1024 sc1
    v_exp_f32 v183, v183
    v_exp_f32 v184, v184
    v_exp_f32 v185, v185
    v_exp_f32 v186, v186
    v_exp_f32 v187, v187
    v_exp_f32 v188, v188
    v_exp_f32 v189, v189
    v_exp_f32 v190, v190
    v_exp_f32 v191, v191
    v_exp_f32 v192, v192
    v_exp_f32 v193, v193
    v_exp_f32 v194, v194
    global_load_dword v46, v29, s[56:57] offset:1020 sc1
    v_exp_f32 v195, v195
    v_exp_f32 v196, v196
    v_exp_f32 v197, v197
    v_exp_f32 v198, v198
    v_exp_f32 v199, v199
    v_exp_f32 v200, v200
    global_load_dwordx4 v[62:65], v30, s[56:57] offset:-3072 sc1
    v_exp_f32 v201, v201
    v_exp_f32 v202, v202
    v_exp_f32 v203, v203
    v_exp_f32 v204, v204
    v_exp_f32 v205, v205
    v_exp_f32 v206, v206
    global_load_dwordx4 v[66:69], v30, s[56:57] offset:-2048 sc1
    v_exp_f32 v207, v207
    v_exp_f32 v208, v208
    v_exp_f32 v209, v209
    v_pk_add_f32 v[178:179], v[178:179], 1.0 op_sel:[0,0] op_sel_hi:[1,0]
    v_pk_add_f32 v[180:181], v[180:181], 1.0 op_sel:[0,0] op_sel_hi:[1,0]
    v_pk_add_f32 v[182:183], v[182:183], 1.0 op_sel:[0,0] op_sel_hi:[1,0]
    global_load_dwordx4 v[70:73], v30, s[56:57] offset:-1024 sc1
    v_pk_add_f32 v[184:185], v[184:185], 1.0 op_sel:[0,0] op_sel_hi:[1,0]
    v_pk_add_f32 v[186:187], v[186:187], 1.0 op_sel:[0,0] op_sel_hi:[1,0]
    v_pk_add_f32 v[188:189], v[188:189], 1.0 op_sel:[0,0] op_sel_hi:[1,0]
    v_pk_add_f32 v[190:191], v[190:191], 1.0 op_sel:[0,0] op_sel_hi:[1,0]
    v_pk_add_f32 v[192:193], v[192:193], 1.0 op_sel:[0,0] op_sel_hi:[1,0]
    v_pk_add_f32 v[194:195], v[194:195], 1.0 op_sel:[0,0] op_sel_hi:[1,0]
    global_load_dwordx4 v[74:77], v30, s[56:57] offset:0 sc1
    v_pk_add_f32 v[196:197], v[196:197], 1.0 op_sel:[0,0] op_sel_hi:[1,0]
    v_pk_add_f32 v[198:199], v[198:199], 1.0 op_sel:[0,0] op_sel_hi:[1,0]
    v_pk_add_f32 v[200:201], v[200:201], 1.0 op_sel:[0,0] op_sel_hi:[1,0]
    v_pk_add_f32 v[202:203], v[202:203], 1.0 op_sel:[0,0] op_sel_hi:[1,0]
    v_pk_add_f32 v[204:205], v[204:205], 1.0 op_sel:[0,0] op_sel_hi:[1,0]
    v_pk_add_f32 v[206:207], v[206:207], 1.0 op_sel:[0,0] op_sel_hi:[1,0]
    global_load_dwordx4 v[78:81], v30, s[56:57] offset:1024 sc1
    v_pk_add_f32 v[208:209], v[208:209], 1.0 op_sel:[0,0] op_sel_hi:[1,0]
    v_rcp_f32 v178, v178
    v_rcp_f32 v179, v179
    v_rcp_f32 v180, v180
    v_rcp_f32 v181, v181
    v_rcp_f32 v182, v182
    global_load_dwordx4 v[82:85], v30, s[56:57] offset:2048 sc1
    v_rcp_f32 v183, v183
    v_rcp_f32 v184, v184
    v_rcp_f32 v185, v185
    v_rcp_f32 v186, v186
    v_rcp_f32 v187, v187
    v_rcp_f32 v188, v188
    global_load_dwordx4 v[86:89], v30, s[56:57] offset:3072 sc1
    v_rcp_f32 v189, v189
    v_rcp_f32 v190, v190
    v_rcp_f32 v191, v191
    v_rcp_f32 v192, v192
    v_rcp_f32 v193, v193
    v_rcp_f32 v194, v194
    global_load_dwordx4 v[90:93], v31, s[56:57] offset:-3072 sc1
    v_rcp_f32 v195, v195
    v_rcp_f32 v196, v196
    v_rcp_f32 v197, v197
    v_rcp_f32 v198, v198
    v_rcp_f32 v199, v199
    v_rcp_f32 v200, v200
    global_load_dwordx4 v[94:97], v31, s[56:57] offset:-2048 sc1
    v_rcp_f32 v201, v201
    v_rcp_f32 v202, v202
    v_rcp_f32 v203, v203
    v_rcp_f32 v204, v204
    v_rcp_f32 v205, v205
    v_rcp_f32 v206, v206
    global_load_dwordx4 v[98:101], v31, s[56:57] offset:-1024 sc1
    v_rcp_f32 v207, v207
    v_rcp_f32 v208, v208
    v_rcp_f32 v209, v209
    v_pk_mul_f32 v[210:211], v[210:211], v[178:179] op_sel:[0,0] op_sel_hi:[1,1]
    v_pk_mul_f32 v[212:213], v[212:213], v[180:181] op_sel:[0,0] op_sel_hi:[1,1]
    v_pk_mul_f32 v[214:215], v[214:215], v[182:183] op_sel:[0,0] op_sel_hi:[1,1]
    global_load_dwordx4 v[102:105], v31, s[56:57] offset:0 sc1
    v_pk_mul_f32 v[216:217], v[216:217], v[184:185] op_sel:[0,0] op_sel_hi:[1,1]
    v_pk_mul_f32 v[218:219], v[218:219], v[186:187] op_sel:[0,0] op_sel_hi:[1,1]
    v_pk_mul_f32 v[220:221], v[220:221], v[188:189] op_sel:[0,0] op_sel_hi:[1,1]
    v_pk_mul_f32 v[222:223], v[222:223], v[190:191] op_sel:[0,0] op_sel_hi:[1,1]
    v_pk_mul_f32 v[224:225], v[224:225], v[192:193] op_sel:[0,0] op_sel_hi:[1,1]
    v_pk_mul_f32 v[226:227], v[226:227], v[194:195] op_sel:[0,0] op_sel_hi:[1,1]
    global_load_dwordx4 v[106:109], v31, s[56:57] offset:1024 sc1
    v_pk_mul_f32 v[228:229], v[228:229], v[196:197] op_sel:[0,0] op_sel_hi:[1,1]
    v_pk_mul_f32 v[230:231], v[230:231], v[198:199] op_sel:[0,0] op_sel_hi:[1,1]
    v_pk_mul_f32 v[232:233], v[232:233], v[200:201] op_sel:[0,0] op_sel_hi:[1,1]
    v_pk_mul_f32 v[234:235], v[234:235], v[202:203] op_sel:[0,0] op_sel_hi:[1,1]
    v_pk_mul_f32 v[236:237], v[236:237], v[204:205] op_sel:[0,0] op_sel_hi:[1,1]
    v_pk_mul_f32 v[238:239], v[238:239], v[206:207] op_sel:[0,0] op_sel_hi:[1,1]
    global_load_dwordx4 v[110:113], v31, s[56:57] offset:2048 sc1
    v_pk_mul_f32 v[240:241], v[240:241], v[208:209] op_sel:[0,0] op_sel_hi:[1,1]
    v_cvt_pk_bf16_f32 v178, v210, v211
    v_cvt_pk_bf16_f32 v179, v212, v213
    v_cvt_pk_bf16_f32 v180, v214, v215
    v_cvt_pk_bf16_f32 v181, v216, v217
    v_cvt_pk_bf16_f32 v182, v218, v219
    global_load_dwordx4 v[114:117], v31, s[56:57] offset:3072 sc1
    v_cvt_pk_bf16_f32 v183, v220, v221
    v_cvt_pk_bf16_f32 v184, v222, v223
    v_cvt_pk_bf16_f32 v185, v224, v225
    v_cvt_pk_bf16_f32 v186, v226, v227
    v_cvt_pk_bf16_f32 v187, v228, v229
    v_cvt_pk_bf16_f32 v188, v230, v231
    global_load_dwordx4 v[118:121], v30, s[58:59] offset:-3072 sc1
    v_cvt_pk_bf16_f32 v189, v232, v233
    v_cvt_pk_bf16_f32 v190, v234, v235
    v_cvt_pk_bf16_f32 v191, v236, v237
    v_cvt_pk_bf16_f32 v192, v238, v239
    v_cvt_pk_bf16_f32 v193, v240, v241
    ds_write_b64 v170, v[178:179] offset:0
    global_load_dwordx4 v[122:125], v30, s[58:59] offset:-2048 sc1
    ds_write_b64 v170, v[180:181] offset:4096
    ds_write_b64 v170, v[182:183] offset:8192
    ds_write_b64 v170, v[184:185] offset:12288
    ds_write_b64 v170, v[186:187] offset:512
    ds_write_b64 v170, v[188:189] offset:4608
    ds_write_b64 v170, v[190:191] offset:8704
    ds_write_b64 v170, v[192:193] offset:12800
    s_waitcnt lgkmcnt(0)
    s_barrier
    ds_read_b64 v[48:49], v171 offset:0
    ds_read_b64 v[50:51], v171 offset:512
    ds_read_b64 v[52:53], v171 offset:1024
    ds_read_b64 v[54:55], v171 offset:1536
    ds_read_b64 v[56:57], v171 offset:2048
    ds_read_b64 v[58:59], v171 offset:2560
    ds_read_b64 v[60:61], v171 offset:3072
Lmid:
    s_waitcnt vmcnt(14)
    v_bitop3_b32 v28, v46, v65, v69 bitop3:0x80
    s_waitcnt vmcnt(12)
    v_bitop3_b32 v28, v73, v77, v28 bitop3:0x80
    v_and_b32 v28, 1, v28
    v_cmp_ne_u32 vcc, 1, v28
    s_nop 0
    s_cbranch_vccnz Lz0_r
Lz0_ok:
    v_mfma_f32_16x16x32_bf16 v[142:145], v[62:65], a[160:163], v[32:35]
    global_load_dwordx4 v[126:129], v30, s[58:59] offset:-1024 sc1
    v_mfma_f32_16x16x32_bf16 v[146:149], v[62:65], a[164:167], 0
    v_mfma_f32_16x16x32_bf16 v[150:153], v[62:65], a[168:171], 0
    v_mfma_f32_16x16x32_bf16 v[154:157], v[62:65], a[172:175], 0
    v_mfma_f32_16x16x32_bf16 v[158:161], v[66:69], a[160:163], v[32:35]
    global_load_dwordx4 v[130:133], v30, s[58:59] offset:0 sc1
    v_mfma_f32_16x16x32_bf16 v[162:165], v[66:69], a[164:167], 0
    v_mfma_f32_16x16x32_bf16 v[166:169], v[66:69], a[168:171], 0
    v_mfma_f32_16x16x32_bf16 v[170:173], v[66:69], a[172:175], 0
    v_mfma_f32_16x16x32_bf16 v[174:177], v[70:73], a[160:163], v[32:35]
    global_load_dwordx4 v[134:137], v30, s[58:59] offset:1024 sc1
    v_mfma_f32_16x16x32_bf16 v[178:181], v[70:73], a[164:167], 0
    v_mfma_f32_16x16x32_bf16 v[182:185], v[70:73], a[168:171], 0
    s_waitcnt vmcnt(13)
    v_and_b32 v28, v81, v85
    v_mfma_f32_16x16x32_bf16 v[186:189], v[70:73], a[172:175], 0
    s_waitcnt vmcnt(11)
    v_bitop3_b32 v28, v89, v93, v28 bitop3:0x80
    v_mfma_f32_16x16x32_bf16 v[190:193], v[74:77], a[160:163], v[32:35]
    v_and_b32 v28, 1, v28
    global_load_dwordx4 v[138:141], v30, s[58:59] offset:2048 sc1
    v_mfma_f32_16x16x32_bf16 v[194:197], v[74:77], a[164:167], 0
    v_cmp_ne_u32 vcc, 1, v28
    v_mfma_f32_16x16x32_bf16 v[198:201], v[74:77], a[168:171], 0
    v_mfma_f32_16x16x32_bf16 v[202:205], v[74:77], a[172:175], 0
    s_cbranch_vccnz Lz1_r
Lz1_ok:
    v_mfma_f32_16x16x32_bf16 v[206:209], v[78:81], a[160:163], v[32:35]
    global_load_dwordx4 v[62:65], v30, s[58:59] offset:3072 sc1
    s_xor_b32 s4, s3, 1
    s_mul_i32 s4, s4, 3072
    v_mfma_f32_16x16x32_bf16 v[210:213], v[78:81], a[164:167], 0
    s_add_u32 s4, s4, 138240
    v_add_u32 v20, s4, v4
    s_xor_b32 s4, s3, 2
    v_mfma_f32_16x16x32_bf16 v[214:217], v[78:81], a[168:171], 0
    s_mul_i32 s4, s4, 3072
    s_add_u32 s4, s4, 139264
    v_add_u32 v21, s4, v4
    v_mfma_f32_16x16x32_bf16 v[218:221], v[78:81], a[172:175], 0
    s_xor_b32 s4, s3, 3
    s_mul_i32 s4, s4, 3072
    v_mfma_f32_16x16x32_bf16 v[222:225], v[82:85], a[160:163], v[32:35]
    global_load_dwordx4 v[66:69], v31, s[58:59] offset:-3072 sc1
    s_add_u32 s4, s4, 140288
    v_add_u32 v22, s4, v4
    v_mfma_f32_16x16x32_bf16 v[226:229], v[82:85], a[164:167], 0
    s_mul_i32 s4, s3, 3072
    s_add_u32 s4, s4, 138240
    v_add_u32 v23, s4, v4
    v_mfma_f32_16x16x32_bf16 v[230:233], v[82:85], a[168:171], 0
    s_mul_i32 s4, s40, 114688
    s_add_u32 s4, s4, 1052672
    v_mfma_f32_16x16x32_bf16 v[234:237], v[82:85], a[172:175], 0
    s_lshl_b32 s5, s3, 13
    s_add_u32 s5, s5, s4
    v_mfma_f32_16x16x32_bf16 v[238:241], v[86:89], a[160:163], v[32:35]
    global_load_dwordx4 v[70:73], v31, s[58:59] offset:-2048 sc1
    v_add_u32 v6, s5, v4
    v_mfma_f32_16x16x32_bf16 v[242:245], v[86:89], a[164:167], 0
    v_add_u32 v7, 32768, v6
    v_add_u32 v26, 65536, v6
    s_lshl_b32 s5, s3, 12
    v_mfma_f32_16x16x32_bf16 v[246:249], v[86:89], a[168:171], 0
    s_waitcnt vmcnt(13)
    v_and_b32 v28, v97, v101
    s_add_u32 s5, s5, s4
    s_add_u32 s5, s5, 98304
    v_mfma_f32_16x16x32_bf16 v[250:253], v[86:89], a[172:175], 0
    s_waitcnt vmcnt(11)
    v_bitop3_b32 v28, v105, v109, v28 bitop3:0x80
    v_add_u32 v27, s5, v4
    s_lshl_b32 s4, s41, 10
    v_mfma_f32_16x16x32_bf16 v[142:145], v[90:93], a[176:179], v[142:145]
    s_add_u32 s8, s38, s4
    s_addc_u32 s9, s39, 0
    v_and_b32 v28, 1, v28
    v_mfma_f32_16x16x32_bf16 v[146:149], v[90:93], a[180:183], v[146:149]
    global_load_dwordx4 v[74:77], v31, s[58:59] offset:-1024 sc1
    s_lshr_b32 s4, s41, 1
    s_lshl_b32 s4, s4, 10
    s_and_b32 s5, s41, 1
    v_mfma_f32_16x16x32_bf16 v[150:153], v[90:93], a[184:187], v[150:153]
    v_cmp_ne_u32 vcc, 1, v28
    s_lshl_b32 s5, s5, 3
    s_add_u32 s4, s4, s5
    s_add_u32 s10, s38, s4
    s_addc_u32 s11, s39, 0
    v_mfma_f32_16x16x32_bf16 v[154:157], v[90:93], a[188:191], v[154:157]
    s_waitcnt lgkmcnt(0)
    s_barrier
    s_cbranch_vccnz Lz2_r
Lz2_ok:
    v_mfma_f32_16x16x32_bf16 v[158:161], v[94:97], a[176:179], v[158:161]
    global_load_dwordx4 v[78:81], v31, s[58:59] offset:0 sc1
    v_mfma_f32_16x16x32_bf16 v[162:165], v[94:97], a[180:183], v[162:165]
    v_mfma_f32_16x16x32_bf16 v[166:169], v[94:97], a[184:187], v[166:169]
    v_mfma_f32_16x16x32_bf16 v[170:173], v[94:97], a[188:191], v[170:173]
    v_mfma_f32_16x16x32_bf16 v[174:177], v[98:101], a[176:179], v[174:177]
    global_load_dwordx4 v[82:85], v31, s[58:59] offset:1024 sc1
    v_mfma_f32_16x16x32_bf16 v[178:181], v[98:101], a[180:183], v[178:181]
    v_mfma_f32_16x16x32_bf16 v[182:185], v[98:101], a[184:187], v[182:185]
    v_mfma_f32_16x16x32_bf16 v[186:189], v[98:101], a[188:191], v[186:189]
    v_mfma_f32_16x16x32_bf16 v[190:193], v[102:105], a[176:179], v[190:193]
    global_load_dwordx4 v[86:89], v31, s[58:59] offset:2048 sc1
    v_mfma_f32_16x16x32_bf16 v[194:197], v[102:105], a[180:183], v[194:197]
    v_mfma_f32_16x16x32_bf16 v[198:201], v[102:105], a[184:187], v[198:201]
    s_waitcnt vmcnt(13)
    v_and_b32 v28, v113, v117
    v_mfma_f32_16x16x32_bf16 v[202:205], v[102:105], a[188:191], v[202:205]
    s_waitcnt vmcnt(11)
    v_bitop3_b32 v28, v121, v125, v28 bitop3:0x80
    v_mfma_f32_16x16x32_bf16 v[206:209], v[106:109], a[176:179], v[206:209]
    v_and_b32 v28, 1, v28
    global_load_dwordx4 v[90:93], v31, s[58:59] offset:3072 sc1
    v_mfma_f32_16x16x32_bf16 v[210:213], v[106:109], a[180:183], v[210:213]
    v_cmp_ne_u32 vcc, 1, v28
    v_mfma_f32_16x16x32_bf16 v[214:217], v[106:109], a[184:187], v[214:217]
    v_mfma_f32_16x16x32_bf16 v[218:221], v[106:109], a[188:191], v[218:221]
    s_cbranch_vccnz Lz3_r
Lz3_ok:
    v_mfma_f32_16x16x32_bf16 v[222:225], v[110:113], a[176:179], v[222:225]
    global_load_dwordx4 v[94:97], v30, s[60:61] offset:-3072 sc1
    v_mfma_f32_16x16x32_bf16 v[226:229], v[110:113], a[180:183], v[226:229]
    v_mfma_f32_16x16x32_bf16 v[230:233], v[110:113], a[184:187], v[230:233]
    v_mfma_f32_16x16x32_bf16 v[234:237], v[110:113], a[188:191], v[234:237]
    v_mfma_f32_16x16x32_bf16 v[238:241], v[114:117], a[176:179], v[238:241]
    global_load_dwordx4 v[98:101], v31, s[60:61] offset:-3072 sc1
    v_mfma_f32_16x16x32_bf16 v[242:245], v[114:117], a[180:183], v[242:245]
    v_mfma_f32_16x16x32_bf16 v[246:249], v[114:117], a[184:187], v[246:249]
    v_mfma_f32_16x16x32_bf16 v[250:253], v[114:117], a[188:191], v[250:253]
    v_mfma_f32_16x16x32_bf16 v[142:145], v[118:121], a[0:3], v[142:145]
    global_load_dwordx4 v[102:105], v30, s[62:63] offset:-3072 sc1
    v_mfma_f32_16x16x32_bf16 v[146:149], v[118:121], a[4:7], v[146:149]
    v_mfma_f32_16x16x32_bf16 v[150:153], v[118:121], a[8:11], v[150:153]
    s_waitcnt vmcnt(13)
    v_and_b32 v28, v129, v133
    v_mfma_f32_16x16x32_bf16 v[154:157], v[118:121], a[12:15], v[154:157]
    s_waitcnt vmcnt(11)
    v_bitop3_b32 v28, v137, v141, v28 bitop3:0x80
    v_mfma_f32_16x16x32_bf16 v[158:161], v[122:125], a[0:3], v[158:161]
    v_and_b32 v28, 1, v28
    global_load_dwordx4 v[106:109], v31, s[62:63] offset:-3072 sc1
    v_mfma_f32_16x16x32_bf16 v[162:165], v[122:125], a[4:7], v[162:165]
    v_cmp_ne_u32 vcc, 1, v28
    v_mfma_f32_16x16x32_bf16 v[166:169], v[122:125], a[8:11], v[166:169]
    v_mfma_f32_16x16x32_bf16 v[170:173], v[122:125], a[12:15], v[170:173]
    s_cbranch_vccnz Lz4_r
Lz4_ok:
    v_mfma_f32_16x16x32_bf16 v[174:177], v[126:129], a[0:3], v[174:177]
    global_load_dwordx4 v[110:113], v30, s[52:53] offset:-3072 sc1
    v_mfma_f32_16x16x32_bf16 v[178:181], v[126:129], a[4:7], v[178:181]
    v_mfma_f32_16x16x32_bf16 v[182:185], v[126:129], a[8:11], v[182:185]
    v_mfma_f32_16x16x32_bf16 v[186:189], v[126:129], a[12:15], v[186:189]
    v_mfma_f32_16x16x32_bf16 v[190:193], v[130:133], a[0:3], v[190:193]
    global_load_dwordx4 v[114:117], v31, s[52:53] offset:-3072 sc1
    v_mfma_f32_16x16x32_bf16 v[194:197], v[130:133], a[4:7], v[194:197]
    v_mfma_f32_16x16x32_bf16 v[198:201], v[130:133], a[8:11], v[198:201]
    v_mfma_f32_16x16x32_bf16 v[202:205], v[130:133], a[12:15], v[202:205]
    v_mfma_f32_16x16x32_bf16 v[206:209], v[134:137], a[0:3], v[206:209]
    global_load_dwordx4 v[118:121], v30, s[54:55] offset:-3072 sc1
    v_mfma_f32_16x16x32_bf16 v[210:213], v[134:137], a[4:7], v[210:213]
    v_mfma_f32_16x16x32_bf16 v[214:217], v[134:137], a[8:11], v[214:217]
    s_waitcnt vmcnt(13)
    v_and_b32 v28, v65, v69
    v_mfma_f32_16x16x32_bf16 v[218:221], v[134:137], a[12:15], v[218:221]
    s_waitcnt vmcnt(11)
    v_bitop3_b32 v28, v73, v77, v28 bitop3:0x80
    v_mfma_f32_16x16x32_bf16 v[222:225], v[138:141], a[0:3], v[222:225]
    v_and_b32 v28, 1, v28
    global_load_dwordx4 v[122:125], v31, s[54:55] offset:-3072 sc1
    v_mfma_f32_16x16x32_bf16 v[226:229], v[138:141], a[4:7], v[226:229]
    v_cmp_ne_u32 vcc, 1, v28
    v_mfma_f32_16x16x32_bf16 v[230:233], v[138:141], a[8:11], v[230:233]
    v_mfma_f32_16x16x32_bf16 v[234:237], v[138:141], a[12:15], v[234:237]
    s_cbranch_vccnz Lz5_r
Lz5_ok:
    v_mfma_f32_16x16x32_bf16 v[238:241], v[62:65], a[0:3], v[238:241]
    global_load_dwordx4 v[126:129], v30, s[64:65] offset:-3072 sc1
    v_mfma_f32_16x16x32_bf16 v[242:245], v[62:65], a[4:7], v[242:245]
    v_mfma_f32_16x16x32_bf16 v[246:249], v[62:65], a[8:11], v[246:249]
    v_mfma_f32_16x16x32_bf16 v[250:253], v[62:65], a[12:15], v[250:253]
    v_mfma_f32_16x16x32_bf16 v[142:145], v[66:69], a[16:19], v[142:145]
    global_load_dwordx4 v[130:133], v31, s[64:65] offset:-3072 sc1
    v_mfma_f32_16x16x32_bf16 v[146:149], v[66:69], a[20:23], v[146:149]
    v_mfma_f32_16x16x32_bf16 v[150:153], v[66:69], a[24:27], v[150:153]
    v_mfma_f32_16x16x32_bf16 v[154:157], v[66:69], a[28:31], v[154:157]
    v_mfma_f32_16x16x32_bf16 v[158:161], v[70:73], a[16:19], v[158:161]
    global_load_dwordx4 v[134:137], v30, s[66:67] offset:-3072 sc1
    v_mfma_f32_16x16x32_bf16 v[162:165], v[70:73], a[20:23], v[162:165]
    v_mfma_f32_16x16x32_bf16 v[166:169], v[70:73], a[24:27], v[166:169]
    s_waitcnt vmcnt(13)
    v_and_b32 v28, v81, v85
    v_mfma_f32_16x16x32_bf16 v[170:173], v[70:73], a[28:31], v[170:173]
    s_waitcnt vmcnt(11)
    v_bitop3_b32 v28, v89, v93, v28 bitop3:0x80
    v_mfma_f32_16x16x32_bf16 v[174:177], v[74:77], a[16:19], v[174:177]
    v_and_b32 v28, 1, v28
    global_load_dwordx4 v[138:141], v31, s[66:67] offset:-3072 sc1
    v_mfma_f32_16x16x32_bf16 v[178:181], v[74:77], a[20:23], v[178:181]
    v_cmp_ne_u32 vcc, 1, v28
    v_mfma_f32_16x16x32_bf16 v[182:185], v[74:77], a[24:27], v[182:185]
    v_mfma_f32_16x16x32_bf16 v[186:189], v[74:77], a[28:31], v[186:189]
    s_cbranch_vccnz Lz6_r
Lz6_ok:
    v_mfma_f32_16x16x32_bf16 v[190:193], v[78:81], a[16:19], v[190:193]
    global_load_dwordx4 v[62:65], v30, s[60:61] offset:-2048 sc1
    v_mfma_f32_16x16x32_bf16 v[194:197], v[78:81], a[20:23], v[194:197]
    v_mfma_f32_16x16x32_bf16 v[198:201], v[78:81], a[24:27], v[198:201]
    v_mfma_f32_16x16x32_bf16 v[202:205], v[78:81], a[28:31], v[202:205]
    v_mfma_f32_16x16x32_bf16 v[206:209], v[82:85], a[16:19], v[206:209]
    global_load_dwordx4 v[66:69], v31, s[60:61] offset:-2048 sc1
    v_mfma_f32_16x16x32_bf16 v[210:213], v[82:85], a[20:23], v[210:213]
    v_mfma_f32_16x16x32_bf16 v[214:217], v[82:85], a[24:27], v[214:217]
    v_mfma_f32_16x16x32_bf16 v[218:221], v[82:85], a[28:31], v[218:221]
    v_mfma_f32_16x16x32_bf16 v[222:225], v[86:89], a[16:19], v[222:225]
    global_load_dwordx4 v[70:73], v30, s[62:63] offset:-2048 sc1
    v_mfma_f32_16x16x32_bf16 v[226:229], v[86:89], a[20:23], v[226:229]
    v_mfma_f32_16x16x32_bf16 v[230:233], v[86:89], a[24:27], v[230:233]
    s_waitcnt vmcnt(13)
    v_and_b32 v28, v97, v101
    v_mfma_f32_16x16x32_bf16 v[234:237], v[86:89], a[28:31], v[234:237]
    s_waitcnt vmcnt(11)
    v_bitop3_b32 v28, v105, v109, v28 bitop3:0x80
    v_mfma_f32_16x16x32_bf16 v[238:241], v[90:93], a[16:19], v[238:241]
    v_and_b32 v28, 1, v28
    global_load_dwordx4 v[74:77], v31, s[62:63] offset:-2048 sc1
    v_mfma_f32_16x16x32_bf16 v[242:245], v[90:93], a[20:23], v[242:245]
    v_cmp_ne_u32 vcc, 1, v28
    v_mfma_f32_16x16x32_bf16 v[246:249], v[90:93], a[24:27], v[246:249]
    v_mfma_f32_16x16x32_bf16 v[250:253], v[90:93], a[28:31], v[250:253]
    s_cbranch_vccnz Lz7_r
Lz7_ok:
    v_mfma_f32_16x16x32_bf16 v[142:145], v[94:97], a[32:35], v[142:145]
    global_load_dwordx4 v[78:81], v30, s[52:53] offset:-2048 sc1
    v_mfma_f32_16x16x32_bf16 v[146:149], v[94:97], a[36:39], v[146:149]
    v_mfma_f32_16x16x32_bf16 v[150:153], v[94:97], a[40:43], v[150:153]
    v_mfma_f32_16x16x32_bf16 v[154:157], v[94:97], a[44:47], v[154:157]
    v_mfma_f32_16x16x32_bf16 v[142:145], v[98:101], a[48:51], v[142:145]
    global_load_dwordx4 v[82:85], v31, s[52:53] offset:-2048 sc1
    v_mfma_f32_16x16x32_bf16 v[146:149], v[98:101], a[52:55], v[146:149]
    v_mfma_f32_16x16x32_bf16 v[150:153], v[98:101], a[56:59], v[150:153]
    v_mfma_f32_16x16x32_bf16 v[154:157], v[98:101], a[60:63], v[154:157]
    v_mfma_f32_16x16x32_bf16 v[142:145], v[102:105], a[64:67], v[142:145]
    global_load_dwordx4 v[86:89], v30, s[54:55] offset:-2048 sc1
    v_mfma_f32_16x16x32_bf16 v[146:149], v[102:105], a[68:71], v[146:149]
    v_mfma_f32_16x16x32_bf16 v[150:153], v[102:105], a[72:75], v[150:153]
    s_waitcnt vmcnt(13)
    v_and_b32 v28, v113, v117
    v_mfma_f32_16x16x32_bf16 v[154:157], v[102:105], a[76:79], v[154:157]
    s_waitcnt vmcnt(11)
    v_bitop3_b32 v28, v121, v125, v28 bitop3:0x80
    v_mfma_f32_16x16x32_bf16 v[142:145], v[106:109], a[80:83], v[142:145]
    v_and_b32 v28, 1, v28
    global_load_dwordx4 v[90:93], v31, s[54:55] offset:-2048 sc1
    v_mfma_f32_16x16x32_bf16 v[146:149], v[106:109], a[84:87], v[146:149]
    v_cmp_ne_u32 vcc, 1, v28
    v_mfma_f32_16x16x32_bf16 v[150:153], v[106:109], a[88:91], v[150:153]
    v_mfma_f32_16x16x32_bf16 v[154:157], v[106:109], a[92:95], v[154:157]
    s_cbranch_vccnz Lz8_r
Lz8_ok:
    v_mfma_f32_16x16x32_bf16 v[142:145], v[110:113], a[224:227], v[142:145]
    global_load_dwordx4 v[94:97], v30, s[64:65] offset:-2048 sc1
    v_mfma_f32_16x16x32_bf16 v[146:149], v[110:113], a[228:231], v[146:149]
    v_mfma_f32_16x16x32_bf16 v[150:153], v[110:113], a[232:235], v[150:153]
    v_mfma_f32_16x16x32_bf16 v[154:157], v[110:113], a[236:239], v[154:157]
    v_mfma_f32_16x16x32_bf16 v[142:145], v[114:117], a[240:243], v[142:145]
    global_load_dwordx4 v[98:101], v31, s[64:65] offset:-2048 sc1
    v_mfma_f32_16x16x32_bf16 v[146:149], v[114:117], a[244:247], v[146:149]
    v_mfma_f32_16x16x32_bf16 v[150:153], v[114:117], a[248:251], v[150:153]
    v_mfma_f32_16x16x32_bf16 v[154:157], v[114:117], a[252:255], v[154:157]
    v_mfma_f32_16x16x32_bf16 v[142:145], v[118:121], a[192:195], v[142:145]
    global_load_dwordx4 v[102:105], v30, s[66:67] offset:-2048 sc1
    v_mfma_f32_16x16x32_bf16 v[146:149], v[118:121], a[196:199], v[146:149]
    v_mfma_f32_16x16x32_bf16 v[150:153], v[118:121], a[200:203], v[150:153]
    s_waitcnt vmcnt(13)
    v_and_b32 v28, v129, v133
    v_mfma_f32_16x16x32_bf16 v[154:157], v[118:121], a[204:207], v[154:157]
    s_waitcnt vmcnt(11)
    v_bitop3_b32 v28, v137, v141, v28 bitop3:0x80
    v_mfma_f32_16x16x32_bf16 v[142:145], v[122:125], a[208:211], v[142:145]
    v_and_b32 v28, 1, v28
    global_load_dwordx4 v[106:109], v31, s[66:67] offset:-2048 sc1
    v_mfma_f32_16x16x32_bf16 v[146:149], v[122:125], a[212:215], v[146:149]
    v_cmp_ne_u32 vcc, 1, v28
    v_mfma_f32_16x16x32_bf16 v[150:153], v[122:125], a[216:219], v[150:153]
    v_mfma_f32_16x16x32_bf16 v[154:157], v[122:125], a[220:223], v[154:157]
    s_cbranch_vccnz Lz9_r
Lz9_ok:
    v_mfma_f32_16x16x32_bf16 v[142:145], v[126:129], a[96:99], v[142:145]
    global_load_dwordx4 v[110:113], v30, s[60:61] offset:-1024 sc1
    v_mfma_f32_16x16x32_bf16 v[146:149], v[126:129], a[100:103], v[146:149]
    v_mfma_f32_16x16x32_bf16 v[150:153], v[126:129], a[104:107], v[150:153]
    v_mfma_f32_16x16x32_bf16 v[154:157], v[126:129], a[108:111], v[154:157]
    v_mfma_f32_16x16x32_bf16 v[142:145], v[130:133], a[112:115], v[142:145]
    global_load_dwordx4 v[114:117], v31, s[60:61] offset:-1024 sc1
    v_mfma_f32_16x16x32_bf16 v[146:149], v[130:133], a[116:119], v[146:149]
    v_mfma_f32_16x16x32_bf16 v[150:153], v[130:133], a[120:123], v[150:153]
    v_mfma_f32_16x16x32_bf16 v[154:157], v[130:133], a[124:127], v[154:157]
    v_mfma_f32_16x16x32_bf16 v[142:145], v[134:137], a[128:131], v[142:145]
    global_load_dwordx4 v[118:121], v30, s[62:63] offset:-1024 sc1
    v_mfma_f32_16x16x32_bf16 v[146:149], v[134:137], a[132:135], v[146:149]
    v_mfma_f32_16x16x32_bf16 v[150:153], v[134:137], a[136:139], v[150:153]
    s_waitcnt vmcnt(13)
    v_and_b32 v28, v65, v69
    v_mfma_f32_16x16x32_bf16 v[154:157], v[134:137], a[140:143], v[154:157]
    s_waitcnt vmcnt(11)
    v_bitop3_b32 v28, v73, v77, v28 bitop3:0x80
    v_mfma_f32_16x16x32_bf16 v[142:145], v[138:141], a[144:147], v[142:145]
    v_and_b32 v28, 1, v28
    global_load_dwordx4 v[122:125], v31, s[62:63] offset:-1024 sc1
    v_mfma_f32_16x16x32_bf16 v[146:149], v[138:141], a[148:151], v[146:149]
    v_cmp_ne_u32 vcc, 1, v28
    v_mfma_f32_16x16x32_bf16 v[150:153], v[138:141], a[152:155], v[150:153]
    v_mfma_f32_16x16x32_bf16 v[154:157], v[138:141], a[156:159], v[154:157]
    s_cbranch_vccnz Lz10_r
Lz10_ok:
    v_mfma_f32_16x16x32_bf16 v[158:161], v[62:65], a[32:35], v[158:161]
    global_load_dwordx4 v[126:129], v30, s[52:53] offset:-1024 sc1
    v_mfma_f32_16x16x32_bf16 v[162:165], v[62:65], a[36:39], v[162:165]
    v_mfma_f32_16x16x32_bf16 v[166:169], v[62:65], a[40:43], v[166:169]
    v_mfma_f32_16x16x32_bf16 v[170:173], v[62:65], a[44:47], v[170:173]
    ds_write_b128 v20, v[146:149] offset:0
    v_mfma_f32_16x16x32_bf16 v[158:161], v[66:69], a[48:51], v[158:161]
    global_load_dwordx4 v[130:133], v31, s[52:53] offset:-1024 sc1
    v_mfma_f32_16x16x32_bf16 v[162:165], v[66:69], a[52:55], v[162:165]
    v_mfma_f32_16x16x32_bf16 v[166:169], v[66:69], a[56:59], v[166:169]
    ds_write_b128 v21, v[150:153] offset:0
    v_mfma_f32_16x16x32_bf16 v[170:173], v[66:69], a[60:63], v[170:173]
    v_mfma_f32_16x16x32_bf16 v[158:161], v[70:73], a[64:67], v[158:161]
    global_load_dwordx4 v[134:137], v30, s[54:55] offset:-1024 sc1
    v_mfma_f32_16x16x32_bf16 v[162:165], v[70:73], a[68:71], v[162:165]
    ds_write_b128 v22, v[154:157] offset:0
    v_mfma_f32_16x16x32_bf16 v[166:169], v[70:73], a[72:75], v[166:169]
    s_waitcnt vmcnt(13)
    v_and_b32 v28, v81, v85
    v_mfma_f32_16x16x32_bf16 v[170:173], v[70:73], a[76:79], v[170:173]
    s_waitcnt vmcnt(11)
    v_bitop3_b32 v28, v89, v93, v28 bitop3:0x80
    v_mfma_f32_16x16x32_bf16 v[158:161], v[74:77], a[80:83], v[158:161]
    v_and_b32 v28, 1, v28
    global_load_dwordx4 v[138:141], v31, s[54:55] offset:-1024 sc1
    v_mfma_f32_16x16x32_bf16 v[162:165], v[74:77], a[84:87], v[162:165]
    s_waitcnt lgkmcnt(0)
    s_barrier
    v_cmp_ne_u32 vcc, 1, v28
    v_mfma_f32_16x16x32_bf16 v[166:169], v[74:77], a[88:91], v[166:169]
    v_mfma_f32_16x16x32_bf16 v[170:173], v[74:77], a[92:95], v[170:173]
    s_cbranch_vccnz Lz11_r
Lz11_ok:
    v_mfma_f32_16x16x32_bf16 v[158:161], v[78:81], a[224:227], v[158:161]
    global_load_dwordx4 v[62:65], v30, s[64:65] offset:-1024 sc1
    ds_read_b128 v[146:149], v23 offset:0
    v_mfma_f32_16x16x32_bf16 v[162:165], v[78:81], a[228:231], v[162:165]
    ds_read_b128 v[150:153], v23 offset:1024
    v_mfma_f32_16x16x32_bf16 v[166:169], v[78:81], a[232:235], v[166:169]
    ds_read_b128 v[154:157], v23 offset:2048
    v_mfma_f32_16x16x32_bf16 v[170:173], v[78:81], a[236:239], v[170:173]
    v_lshlrev_b32 v12, 16, v48
    v_mfma_f32_16x16x32_bf16 v[158:161], v[82:85], a[240:243], v[158:161]
    global_load_dwordx4 v[66:69], v31, s[64:65] offset:-1024 sc1
    v_and_b32 v13, 0xffff0000, v48
    v_mfma_f32_16x16x32_bf16 v[162:165], v[82:85], a[244:247], v[162:165]
    v_mfma_f32_16x16x32_bf16 v[166:169], v[82:85], a[248:251], v[166:169]
    v_lshlrev_b32 v14, 16, v49
    v_mfma_f32_16x16x32_bf16 v[170:173], v[82:85], a[252:255], v[170:173]
    v_and_b32 v15, 0xffff0000, v49
    v_mfma_f32_16x16x32_bf16 v[158:161], v[86:89], a[192:195], v[158:161]
    global_load_dwordx4 v[70:73], v30, s[66:67] offset:-1024 sc1
    s_waitcnt lgkmcnt(2)
    v_add_f32 v142, v142, v146
    v_mfma_f32_16x16x32_bf16 v[162:165], v[86:89], a[196:199], v[162:165]
    v_add_f32 v143, v143, v147
    v_mfma_f32_16x16x32_bf16 v[166:169], v[86:89], a[200:203], v[166:169]
    s_waitcnt vmcnt(13)
    v_and_b32 v28, v97, v101
    v_mfma_f32_16x16x32_bf16 v[170:173], v[86:89], a[204:207], v[170:173]
    s_waitcnt vmcnt(11)
    v_bitop3_b32 v28, v105, v109, v28 bitop3:0x80
    v_add_f32 v144, v144, v148
    v_mfma_f32_16x16x32_bf16 v[158:161], v[90:93], a[208:211], v[158:161]
    v_and_b32 v28, 1, v28
    global_load_dwordx4 v[74:77], v31, s[66:67] offset:-1024 sc1
    v_mfma_f32_16x16x32_bf16 v[162:165], v[90:93], a[212:215], v[162:165]
    v_add_f32 v145, v145, v149
    v_cmp_ne_u32 vcc, 1, v28
    v_mfma_f32_16x16x32_bf16 v[166:169], v[90:93], a[216:219], v[166:169]
    s_waitcnt lgkmcnt(1)
    v_add_f32 v142, v142, v150
    v_add_f32 v143, v143, v151
    v_mfma_f32_16x16x32_bf16 v[170:173], v[90:93], a[220:223], v[170:173]
    s_cbranch_vccnz Lz12_r
Lz12_ok:
    v_mfma_f32_16x16x32_bf16 v[158:161], v[94:97], a[96:99], v[158:161]
    global_load_dwordx4 v[78:81], v30, s[60:61] offset:0 sc1
    v_add_f32 v144, v144, v152
    v_mfma_f32_16x16x32_bf16 v[162:165], v[94:97], a[100:103], v[162:165]
    v_add_f32 v145, v145, v153
    v_mfma_f32_16x16x32_bf16 v[166:169], v[94:97], a[104:107], v[166:169]
    s_waitcnt lgkmcnt(0)
    v_add_f32 v142, v142, v154
    v_mfma_f32_16x16x32_bf16 v[170:173], v[94:97], a[108:111], v[170:173]
    v_mfma_f32_16x16x32_bf16 v[158:161], v[98:101], a[112:115], v[158:161]
    global_load_dwordx4 v[82:85], v31, s[60:61] offset:0 sc1
    v_add_f32 v143, v143, v155
    v_mfma_f32_16x16x32_bf16 v[162:165], v[98:101], a[116:119], v[162:165]
    v_add_f32 v144, v144, v156
    v_mfma_f32_16x16x32_bf16 v[166:169], v[98:101], a[120:123], v[166:169]
    v_add_f32 v145, v145, v157
    v_mfma_f32_16x16x32_bf16 v[170:173], v[98:101], a[124:127], v[170:173]
    v_mfma_f32_16x16x32_bf16 v[158:161], v[102:105], a[128:131], v[158:161]
    global_load_dwordx4 v[86:89], v30, s[62:63] offset:0 sc1
    v_mul_f32 v142, v142, v12
    v_mfma_f32_16x16x32_bf16 v[162:165], v[102:105], a[132:135], v[162:165]
    v_mul_f32 v143, v143, v13
    v_mfma_f32_16x16x32_bf16 v[166:169], v[102:105], a[136:139], v[166:169]
    s_waitcnt vmcnt(13)
    v_and_b32 v28, v113, v117
    v_mul_f32 v144, v144, v14
    v_mfma_f32_16x16x32_bf16 v[170:173], v[102:105], a[140:143], v[170:173]
    s_waitcnt vmcnt(11)
    v_bitop3_b32 v28, v121, v125, v28 bitop3:0x80
    v_mfma_f32_16x16x32_bf16 v[158:161], v[106:109], a[144:147], v[158:161]
    v_and_b32 v28, 1, v28
    global_load_dwordx4 v[90:93], v31, s[62:63] offset:0 sc1
    v_mfma_f32_16x16x32_bf16 v[162:165], v[106:109], a[148:151], v[162:165]
    v_mul_f32 v145, v145, v15
    v_cmp_ne_u32 vcc, 1, v28
    v_mfma_f32_16x16x32_bf16 v[166:169], v[106:109], a[152:155], v[166:169]
    v_cvt_pk_bf16_f32 v48, v142, v143
    v_cvt_pk_bf16_f32 v49, v144, v145
    v_mfma_f32_16x16x32_bf16 v[170:173], v[106:109], a[156:159], v[170:173]
    s_cbranch_vccnz Lz13_r
Lz13_ok:
    v_mfma_f32_16x16x32_bf16 v[174:177], v[110:113], a[32:35], v[174:177]
    global_load_dwordx4 v[94:97], v30, s[52:53] offset:0 sc1
    v_mfma_f32_16x16x32_bf16 v[178:181], v[110:113], a[36:39], v[178:181]
    v_mfma_f32_16x16x32_bf16 v[182:185], v[110:113], a[40:43], v[182:185]
    v_mfma_f32_16x16x32_bf16 v[186:189], v[110:113], a[44:47], v[186:189]
    ds_write_b128 v20, v[162:165] offset:12288
    v_mfma_f32_16x16x32_bf16 v[174:177], v[114:117], a[48:51], v[174:177]
    global_load_dwordx4 v[98:101], v31, s[52:53] offset:0 sc1
    v_mfma_f32_16x16x32_bf16 v[178:181], v[114:117], a[52:55], v[178:181]
    v_mfma_f32_16x16x32_bf16 v[182:185], v[114:117], a[56:59], v[182:185]
    ds_write_b128 v21, v[166:169] offset:12288
    v_mfma_f32_16x16x32_bf16 v[186:189], v[114:117], a[60:63], v[186:189]
    v_mfma_f32_16x16x32_bf16 v[174:177], v[118:121], a[64:67], v[174:177]
    global_load_dwordx4 v[102:105], v30, s[54:55] offset:0 sc1
    v_mfma_f32_16x16x32_bf16 v[178:181], v[118:121], a[68:71], v[178:181]
    ds_write_b128 v22, v[170:173] offset:12288
    v_mfma_f32_16x16x32_bf16 v[182:185], v[118:121], a[72:75], v[182:185]
    s_waitcnt vmcnt(13)
    v_and_b32 v28, v129, v133
    v_mfma_f32_16x16x32_bf16 v[186:189], v[118:121], a[76:79], v[186:189]
    s_waitcnt vmcnt(11)
    v_bitop3_b32 v28, v137, v141, v28 bitop3:0x80
    v_mfma_f32_16x16x32_bf16 v[174:177], v[122:125], a[80:83], v[174:177]
    v_and_b32 v28, 1, v28
    global_load_dwordx4 v[106:109], v31, s[54:55] offset:0 sc1
    v_mfma_f32_16x16x32_bf16 v[178:181], v[122:125], a[84:87], v[178:181]
    s_waitcnt lgkmcnt(0)
    s_barrier
    v_cmp_ne_u32 vcc, 1, v28
    v_mfma_f32_16x16x32_bf16 v[182:185], v[122:125], a[88:91], v[182:185]
    v_mfma_f32_16x16x32_bf16 v[186:189], v[122:125], a[92:95], v[186:189]
    s_cbranch_vccnz Lz14_r
Lz14_ok:
    v_mfma_f32_16x16x32_bf16 v[174:177], v[126:129], a[224:227], v[174:177]
    global_load_dwordx4 v[110:113], v30, s[64:65] offset:0 sc1
    ds_read_b128 v[162:165], v23 offset:12288
    v_mfma_f32_16x16x32_bf16 v[178:181], v[126:129], a[228:231], v[178:181]
    ds_read_b128 v[166:169], v23 offset:13312
    v_mfma_f32_16x16x32_bf16 v[182:185], v[126:129], a[232:235], v[182:185]
    ds_read_b128 v[170:173], v23 offset:14336
    global_load_dwordx4 v[114:117], v31, s[64:65] offset:0 sc1
    v_mfma_f32_16x16x32_bf16 v[186:189], v[126:129], a[236:239], v[186:189]
    v_lshlrev_b32 v12, 16, v50
    v_mfma_f32_16x16x32_bf16 v[174:177], v[130:133], a[240:243], v[174:177]
    v_and_b32 v13, 0xffff0000, v50
    v_mfma_f32_16x16x32_bf16 v[178:181], v[130:133], a[244:247], v[178:181]
    global_load_dwordx4 v[118:121], v30, s[66:67] offset:0 sc1
    v_mfma_f32_16x16x32_bf16 v[182:185], v[130:133], a[248:251], v[182:185]
    v_lshlrev_b32 v14, 16, v51
    v_mfma_f32_16x16x32_bf16 v[186:189], v[130:133], a[252:255], v[186:189]
    v_and_b32 v15, 0xffff0000, v51
    v_mfma_f32_16x16x32_bf16 v[174:177], v[134:137], a[192:195], v[174:177]
    global_load_dwordx4 v[122:125], v31, s[66:67] offset:0 sc1
    s_waitcnt lgkmcnt(2)
    v_add_f32 v158, v158, v162
    v_mfma_f32_16x16x32_bf16 v[178:181], v[134:137], a[196:199], v[178:181]
    v_add_f32 v159, v159, v163
    v_mfma_f32_16x16x32_bf16 v[182:185], v[134:137], a[200:203], v[182:185]
    s_waitcnt vmcnt(14)
    v_and_b32 v28, v65, v69
    global_load_lds_dwordx4 v4, s[92:93] offset:2048 sc1
    v_mfma_f32_16x16x32_bf16 v[186:189], v[134:137], a[204:207], v[186:189]
    s_waitcnt vmcnt(13)
    v_bitop3_b32 v28, v73, v77, v28 bitop3:0x80
    v_add_f32 v160, v160, v164
    v_mfma_f32_16x16x32_bf16 v[174:177], v[138:141], a[208:211], v[174:177]
    v_and_b32 v28, 1, v28
    v_add_f32 v161, v161, v165
    v_mfma_f32_16x16x32_bf16 v[178:181], v[138:141], a[212:215], v[178:181]
    v_cmp_ne_u32 vcc, 1, v28
    global_load_lds_dwordx4 v4, s[92:93] offset:3072 sc1
    v_mfma_f32_16x16x32_bf16 v[182:185], v[138:141], a[216:219], v[182:185]
    s_waitcnt lgkmcnt(1)
    v_add_f32 v158, v158, v166
    v_add_f32 v159, v159, v167
    v_mfma_f32_16x16x32_bf16 v[186:189], v[138:141], a[220:223], v[186:189]
    s_cbranch_vccnz Lz15_r
Lz15_ok:
    v_mfma_f32_16x16x32_bf16 v[174:177], v[62:65], a[96:99], v[174:177]
    global_load_dwordx4 v[126:129], v30, s[60:61] offset:1024 sc1
    v_add_f32 v160, v160, v168
    v_mfma_f32_16x16x32_bf16 v[178:181], v[62:65], a[100:103], v[178:181]
    v_add_f32 v161, v161, v169
    global_load_dwordx4 v[130:133], v31, s[60:61] offset:1024 sc1
    v_mfma_f32_16x16x32_bf16 v[182:185], v[62:65], a[104:107], v[182:185]
    s_waitcnt lgkmcnt(0)
    v_add_f32 v158, v158, v170
    v_mfma_f32_16x16x32_bf16 v[186:189], v[62:65], a[108:111], v[186:189]
    global_load_dwordx4 v[134:137], v30, s[62:63] offset:1024 sc1
    v_add_f32 v159, v159, v171
    v_mfma_f32_16x16x32_bf16 v[174:177], v[66:69], a[112:115], v[174:177]
    v_add_f32 v160, v160, v172
    v_mfma_f32_16x16x32_bf16 v[178:181], v[66:69], a[116:119], v[178:181]
    global_load_dwordx4 v[138:141], v31, s[62:63] offset:1024 sc1
    v_mfma_f32_16x16x32_bf16 v[182:185], v[66:69], a[120:123], v[182:185]
    v_add_f32 v161, v161, v173
    v_mfma_f32_16x16x32_bf16 v[186:189], v[66:69], a[124:127], v[186:189]
    s_add_u32 m0, s95, 8192
    v_mul_f32 v158, v158, v12
    v_mfma_f32_16x16x32_bf16 v[174:177], v[70:73], a[128:131], v[174:177]
    v_mul_f32 v159, v159, v13
    s_add_u32 s92, s92, 4096
    s_addc_u32 s93, s93, 0
    v_mfma_f32_16x16x32_bf16 v[178:181], v[70:73], a[132:135], v[178:181]
    v_mul_f32 v160, v160, v14
    v_mfma_f32_16x16x32_bf16 v[182:185], v[70:73], a[136:139], v[182:185]
    s_waitcnt vmcnt(16)
    v_and_b32 v28, v81, v85
    v_mfma_f32_16x16x32_bf16 v[186:189], v[70:73], a[140:143], v[186:189]
    s_waitcnt vmcnt(14)
    v_bitop3_b32 v28, v89, v93, v28 bitop3:0x80
    v_mul_f32 v161, v161, v15
    v_mfma_f32_16x16x32_bf16 v[174:177], v[74:77], a[144:147], v[174:177]
    v_and_b32 v28, 1, v28
    v_cvt_pk_bf16_f32 v50, v158, v159
    v_mfma_f32_16x16x32_bf16 v[178:181], v[74:77], a[148:151], v[178:181]
    global_load_lds_dwordx4 v4, s[92:93] offset:0 sc1
    v_cmp_ne_u32 vcc, 1, v28
    v_mfma_f32_16x16x32_bf16 v[182:185], v[74:77], a[152:155], v[182:185]
    v_cvt_pk_bf16_f32 v51, v160, v161
    global_load_lds_dwordx4 v4, s[92:93] offset:1024 sc1
    v_mfma_f32_16x16x32_bf16 v[186:189], v[74:77], a[156:159], v[186:189]
    v_and_b32 v51, -2, v51
    s_cbranch_vccnz Lz16_r
Lz16_ok:
    v_mfma_f32_16x16x32_bf16 v[190:193], v[78:81], a[32:35], v[190:193]
    global_load_dwordx4 v[62:65], v30, s[52:53] offset:1024 sc1
    v_mfma_f32_16x16x32_bf16 v[194:197], v[78:81], a[36:39], v[194:197]
    v_mfma_f32_16x16x32_bf16 v[198:201], v[78:81], a[40:43], v[198:201]
    global_load_dwordx4 v[66:69], v31, s[52:53] offset:1024 sc1
    v_mfma_f32_16x16x32_bf16 v[202:205], v[78:81], a[44:47], v[202:205]
    ds_write_b128 v20, v[178:181] offset:0
    v_mfma_f32_16x16x32_bf16 v[190:193], v[82:85], a[48:51], v[190:193]
    v_mfma_f32_16x16x32_bf16 v[194:197], v[82:85], a[52:55], v[194:197]
    global_load_dwordx4 v[70:73], v30, s[54:55] offset:1024 sc1
    v_mfma_f32_16x16x32_bf16 v[198:201], v[82:85], a[56:59], v[198:201]
    ds_write_b128 v21, v[182:185] offset:0
    v_mfma_f32_16x16x32_bf16 v[202:205], v[82:85], a[60:63], v[202:205]
    v_mfma_f32_16x16x32_bf16 v[190:193], v[86:89], a[64:67], v[190:193]
    global_load_dwordx4 v[74:77], v31, s[54:55] offset:1024 sc1
    v_mfma_f32_16x16x32_bf16 v[194:197], v[86:89], a[68:71], v[194:197]
    ds_write_b128 v22, v[186:189] offset:0
    v_mfma_f32_16x16x32_bf16 v[198:201], v[86:89], a[72:75], v[198:201]
    s_waitcnt vmcnt(18)
    v_and_b32 v28, v97, v101
    global_load_lds_dwordx4 v4, s[92:93] offset:2048 sc1
    v_mfma_f32_16x16x32_bf16 v[202:205], v[86:89], a[76:79], v[202:205]
    s_waitcnt vmcnt(17)
    v_bitop3_b32 v28, v105, v109, v28 bitop3:0x80
    v_mfma_f32_16x16x32_bf16 v[190:193], v[90:93], a[80:83], v[190:193]
    v_and_b32 v28, 1, v28
    s_waitcnt lgkmcnt(0)
    s_barrier
    v_mfma_f32_16x16x32_bf16 v[194:197], v[90:93], a[84:87], v[194:197]
    v_cmp_ne_u32 vcc, 1, v28
    global_load_lds_dwordx4 v4, s[92:93] offset:3072 sc1
    v_mfma_f32_16x16x32_bf16 v[198:201], v[90:93], a[88:91], v[198:201]
    v_mfma_f32_16x16x32_bf16 v[202:205], v[90:93], a[92:95], v[202:205]
    s_cbranch_vccnz Lz17_r
Lz17_ok:
    v_mfma_f32_16x16x32_bf16 v[190:193], v[94:97], a[224:227], v[190:193]
    global_load_dwordx4 v[78:81], v30, s[64:65] offset:1024 sc1
    ds_read_b128 v[178:181], v23 offset:0
    v_mfma_f32_16x16x32_bf16 v[194:197], v[94:97], a[228:231], v[194:197]
    ds_read_b128 v[182:185], v23 offset:1024
    global_load_dwordx4 v[82:85], v31, s[64:65] offset:1024 sc1
    v_mfma_f32_16x16x32_bf16 v[198:201], v[94:97], a[232:235], v[198:201]
    ds_read_b128 v[186:189], v23 offset:2048
    v_mfma_f32_16x16x32_bf16 v[202:205], v[94:97], a[236:239], v[202:205]
    global_load_dwordx4 v[86:89], v30, s[66:67] offset:1024 sc1
    v_lshlrev_b32 v12, 16, v52
    v_mfma_f32_16x16x32_bf16 v[190:193], v[98:101], a[240:243], v[190:193]
    v_and_b32 v13, 0xffff0000, v52
    v_mfma_f32_16x16x32_bf16 v[194:197], v[98:101], a[244:247], v[194:197]
    global_load_dwordx4 v[90:93], v31, s[66:67] offset:1024 sc1
    v_mfma_f32_16x16x32_bf16 v[198:201], v[98:101], a[248:251], v[198:201]
    v_lshlrev_b32 v14, 16, v53
    v_mfma_f32_16x16x32_bf16 v[202:205], v[98:101], a[252:255], v[202:205]
    s_add_u32 m0, s95, 12288
    v_and_b32 v15, 0xffff0000, v53
    v_mfma_f32_16x16x32_bf16 v[190:193], v[102:105], a[192:195], v[190:193]
    s_waitcnt lgkmcnt(2)
    v_add_f32 v174, v174, v178
    s_add_u32 s92, s92, 4096
    s_addc_u32 s93, s93, 0
    v_mfma_f32_16x16x32_bf16 v[194:197], v[102:105], a[196:199], v[194:197]
    v_add_f32 v175, v175, v179
    v_mfma_f32_16x16x32_bf16 v[198:201], v[102:105], a[200:203], v[198:201]
    s_waitcnt vmcnt(20)
    v_and_b32 v28, v113, v117
    v_mfma_f32_16x16x32_bf16 v[202:205], v[102:105], a[204:207], v[202:205]
    s_waitcnt vmcnt(18)
    v_bitop3_b32 v28, v121, v125, v28 bitop3:0x80
    v_add_f32 v176, v176, v180
    v_mfma_f32_16x16x32_bf16 v[190:193], v[106:109], a[208:211], v[190:193]
    v_and_b32 v28, 1, v28
    v_add_f32 v177, v177, v181
    v_mfma_f32_16x16x32_bf16 v[194:197], v[106:109], a[212:215], v[194:197]
    global_load_lds_dwordx4 v4, s[92:93] offset:0 sc1
    v_cmp_ne_u32 vcc, 1, v28
    v_mfma_f32_16x16x32_bf16 v[198:201], v[106:109], a[216:219], v[198:201]
    s_waitcnt lgkmcnt(1)
    v_add_f32 v174, v174, v182
    global_load_lds_dwordx4 v4, s[92:93] offset:1024 sc1
    v_mfma_f32_16x16x32_bf16 v[202:205], v[106:109], a[220:223], v[202:205]
    v_add_f32 v175, v175, v183
    s_cbranch_vccnz Lz18_r
Lz18_ok:
    v_mfma_f32_16x16x32_bf16 v[190:193], v[110:113], a[96:99], v[190:193]
    global_load_dwordx4 v[94:97], v30, s[60:61] offset:2048 sc1
    v_add_f32 v176, v176, v184
    v_mfma_f32_16x16x32_bf16 v[194:197], v[110:113], a[100:103], v[194:197]
    v_add_f32 v177, v177, v185
    v_mfma_f32_16x16x32_bf16 v[198:201], v[110:113], a[104:107], v[198:201]
    global_load_dwordx4 v[98:101], v31, s[60:61] offset:2048 sc1
    s_waitcnt lgkmcnt(0)
    v_add_f32 v174, v174, v186
    v_mfma_f32_16x16x32_bf16 v[202:205], v[110:113], a[108:111], v[202:205]
    v_mfma_f32_16x16x32_bf16 v[190:193], v[114:117], a[112:115], v[190:193]
    v_add_f32 v175, v175, v187
    v_mfma_f32_16x16x32_bf16 v[194:197], v[114:117], a[116:119], v[194:197]
    global_load_dwordx4 v[102:105], v30, s[62:63] offset:2048 sc1
    v_add_f32 v176, v176, v188
    v_mfma_f32_16x16x32_bf16 v[198:201], v[114:117], a[120:123], v[198:201]
    v_add_f32 v177, v177, v189
    v_mfma_f32_16x16x32_bf16 v[202:205], v[114:117], a[124:127], v[202:205]
    v_mfma_f32_16x16x32_bf16 v[190:193], v[118:121], a[128:131], v[190:193]
    global_load_dwordx4 v[106:109], v31, s[62:63] offset:2048 sc1
    v_mul_f32 v174, v174, v12
    v_mfma_f32_16x16x32_bf16 v[194:197], v[118:121], a[132:135], v[194:197]
    v_mul_f32 v175, v175, v13
    v_mfma_f32_16x16x32_bf16 v[198:201], v[118:121], a[136:139], v[198:201]
    s_waitcnt vmcnt(20)
    v_and_b32 v28, v129, v133
    global_load_lds_dwordx4 v4, s[92:93] offset:2048 sc1
    v_mfma_f32_16x16x32_bf16 v[202:205], v[118:121], a[140:143], v[202:205]
    s_waitcnt vmcnt(19)
    v_bitop3_b32 v28, v137, v141, v28 bitop3:0x80
    v_mul_f32 v176, v176, v14
    v_mfma_f32_16x16x32_bf16 v[190:193], v[122:125], a[144:147], v[190:193]
    v_and_b32 v28, 1, v28
    v_mul_f32 v177, v177, v15
    v_mfma_f32_16x16x32_bf16 v[194:197], v[122:125], a[148:151], v[194:197]
    v_cmp_ne_u32 vcc, 1, v28
    global_load_lds_dwordx4 v4, s[92:93] offset:3072 sc1
    v_mfma_f32_16x16x32_bf16 v[198:201], v[122:125], a[152:155], v[198:201]
    v_cvt_pk_bf16_f32 v52, v174, v175
    v_cvt_pk_bf16_f32 v53, v176, v177
    v_mfma_f32_16x16x32_bf16 v[202:205], v[122:125], a[156:159], v[202:205]
    s_cbranch_vccnz Lz19_r
Lz19_ok:
    v_mfma_f32_16x16x32_bf16 v[206:209], v[126:129], a[32:35], v[206:209]
    global_load_dwordx4 v[110:113], v30, s[52:53] offset:2048 sc1
    v_mfma_f32_16x16x32_bf16 v[210:213], v[126:129], a[36:39], v[210:213]
    global_load_dwordx4 v[114:117], v31, s[52:53] offset:2048 sc1
    v_mfma_f32_16x16x32_bf16 v[214:217], v[126:129], a[40:43], v[214:217]
    v_mfma_f32_16x16x32_bf16 v[218:221], v[126:129], a[44:47], v[218:221]
    ds_write_b128 v20, v[194:197] offset:12288
    v_mfma_f32_16x16x32_bf16 v[206:209], v[130:133], a[48:51], v[206:209]
    global_load_dwordx4 v[118:121], v30, s[54:55] offset:2048 sc1
    v_mfma_f32_16x16x32_bf16 v[210:213], v[130:133], a[52:55], v[210:213]
    global_load_dwordx4 v[122:125], v31, s[54:55] offset:2048 sc1
    v_mfma_f32_16x16x32_bf16 v[214:217], v[130:133], a[56:59], v[214:217]
    ds_write_b128 v21, v[198:201] offset:12288
    v_mfma_f32_16x16x32_bf16 v[218:221], v[130:133], a[60:63], v[218:221]
    s_add_u32 m0, s95, 16384
    v_mfma_f32_16x16x32_bf16 v[206:209], v[134:137], a[64:67], v[206:209]
    s_add_u32 s92, s92, 4096
    s_addc_u32 s93, s93, 0
    v_mfma_f32_16x16x32_bf16 v[210:213], v[134:137], a[68:71], v[210:213]
    ds_write_b128 v22, v[202:205] offset:12288
    v_mfma_f32_16x16x32_bf16 v[214:217], v[134:137], a[72:75], v[214:217]
    s_waitcnt vmcnt(20)
    v_and_b32 v28, v65, v69
    v_mfma_f32_16x16x32_bf16 v[218:221], v[134:137], a[76:79], v[218:221]
    s_waitcnt vmcnt(18)
    v_bitop3_b32 v28, v73, v77, v28 bitop3:0x80
    v_mfma_f32_16x16x32_bf16 v[206:209], v[138:141], a[80:83], v[206:209]
    v_and_b32 v28, 1, v28
    global_load_lds_dwordx4 v4, s[92:93] offset:0 sc1
    v_mfma_f32_16x16x32_bf16 v[210:213], v[138:141], a[84:87], v[210:213]
    s_waitcnt lgkmcnt(0)
    s_barrier
    v_cmp_ne_u32 vcc, 1, v28
    v_mfma_f32_16x16x32_bf16 v[214:217], v[138:141], a[88:91], v[214:217]
    global_load_lds_dwordx4 v4, s[92:93] offset:1024 sc1
    v_mfma_f32_16x16x32_bf16 v[218:221], v[138:141], a[92:95], v[218:221]
    s_cbranch_vccnz Lz20_r
Lz20_ok:
    v_mfma_f32_16x16x32_bf16 v[206:209], v[62:65], a[224:227], v[206:209]
    global_load_dwordx4 v[126:129], v30, s[64:65] offset:2048 sc1
    ds_read_b128 v[194:197], v23 offset:12288
    v_mfma_f32_16x16x32_bf16 v[210:213], v[62:65], a[228:231], v[210:213]
    ds_read_b128 v[198:201], v23 offset:13312
    v_mfma_f32_16x16x32_bf16 v[214:217], v[62:65], a[232:235], v[214:217]
    ds_read_b128 v[202:205], v23 offset:14336
    global_load_dwordx4 v[130:133], v31, s[64:65] offset:2048 sc1
    v_mfma_f32_16x16x32_bf16 v[218:221], v[62:65], a[236:239], v[218:221]
    v_lshlrev_b32 v12, 16, v54
    v_mfma_f32_16x16x32_bf16 v[206:209], v[66:69], a[240:243], v[206:209]
    v_and_b32 v13, 0xffff0000, v54
    v_mfma_f32_16x16x32_bf16 v[210:213], v[66:69], a[244:247], v[210:213]
    global_load_dwordx4 v[134:137], v30, s[66:67] offset:2048 sc1
    v_mfma_f32_16x16x32_bf16 v[214:217], v[66:69], a[248:251], v[214:217]
    v_lshlrev_b32 v14, 16, v55
    v_mfma_f32_16x16x32_bf16 v[218:221], v[66:69], a[252:255], v[218:221]
    v_and_b32 v15, 0xffff0000, v55
    v_mfma_f32_16x16x32_bf16 v[206:209], v[70:73], a[192:195], v[206:209]
    global_load_dwordx4 v[138:141], v31, s[66:67] offset:2048 sc1
    s_waitcnt lgkmcnt(2)
    v_add_f32 v190, v190, v194
    v_mfma_f32_16x16x32_bf16 v[210:213], v[70:73], a[196:199], v[210:213]
    v_add_f32 v191, v191, v195
    v_mfma_f32_16x16x32_bf16 v[214:217], v[70:73], a[200:203], v[214:217]
    s_waitcnt vmcnt(20)
    v_and_b32 v28, v81, v85
    global_load_lds_dwordx4 v4, s[92:93] offset:2048 sc1
    v_mfma_f32_16x16x32_bf16 v[218:221], v[70:73], a[204:207], v[218:221]
    s_waitcnt vmcnt(19)
    v_bitop3_b32 v28, v89, v93, v28 bitop3:0x80
    v_add_f32 v192, v192, v196
    v_mfma_f32_16x16x32_bf16 v[206:209], v[74:77], a[208:211], v[206:209]
    v_and_b32 v28, 1, v28
    v_add_f32 v193, v193, v197
    v_mfma_f32_16x16x32_bf16 v[210:213], v[74:77], a[212:215], v[210:213]
    v_cmp_ne_u32 vcc, 1, v28
    global_load_lds_dwordx4 v4, s[92:93] offset:3072 sc1
    v_mfma_f32_16x16x32_bf16 v[214:217], v[74:77], a[216:219], v[214:217]
    s_waitcnt lgkmcnt(1)
    v_add_f32 v190, v190, v198
    v_add_f32 v191, v191, v199
    v_mfma_f32_16x16x32_bf16 v[218:221], v[74:77], a[220:223], v[218:221]
    s_cbranch_vccnz Lz21_r
Lz21_ok:
    v_mfma_f32_16x16x32_bf16 v[206:209], v[78:81], a[96:99], v[206:209]
    global_load_dwordx4 v[62:65], v30, s[60:61] offset:3072 sc1
    v_add_f32 v192, v192, v200
    v_mfma_f32_16x16x32_bf16 v[210:213], v[78:81], a[100:103], v[210:213]
    v_add_f32 v193, v193, v201
    global_load_dwordx4 v[66:69], v31, s[60:61] offset:3072 sc1
    v_mfma_f32_16x16x32_bf16 v[214:217], v[78:81], a[104:107], v[214:217]
    s_waitcnt lgkmcnt(0)
    v_add_f32 v190, v190, v202
    v_mfma_f32_16x16x32_bf16 v[218:221], v[78:81], a[108:111], v[218:221]
    global_load_dwordx4 v[70:73], v30, s[62:63] offset:3072 sc1
    v_add_f32 v191, v191, v203
    v_mfma_f32_16x16x32_bf16 v[206:209], v[82:85], a[112:115], v[206:209]
    v_add_f32 v192, v192, v204
    v_mfma_f32_16x16x32_bf16 v[210:213], v[82:85], a[116:119], v[210:213]
    global_load_dwordx4 v[74:77], v31, s[62:63] offset:3072 sc1
    v_mfma_f32_16x16x32_bf16 v[214:217], v[82:85], a[120:123], v[214:217]
    v_add_f32 v193, v193, v205
    v_mfma_f32_16x16x32_bf16 v[218:221], v[82:85], a[124:127], v[218:221]
    s_add_u32 m0, s95, 20480
    v_mul_f32 v190, v190, v12
    v_mfma_f32_16x16x32_bf16 v[206:209], v[86:89], a[128:131], v[206:209]
    v_mul_f32 v191, v191, v13
    s_add_u32 s92, s92, 4096
    s_addc_u32 s93, s93, 0
    v_mfma_f32_16x16x32_bf16 v[210:213], v[86:89], a[132:135], v[210:213]
    v_mul_f32 v192, v192, v14
    v_mfma_f32_16x16x32_bf16 v[214:217], v[86:89], a[136:139], v[214:217]
    s_waitcnt vmcnt(20)
    v_and_b32 v28, v97, v101
    v_mfma_f32_16x16x32_bf16 v[218:221], v[86:89], a[140:143], v[218:221]
    s_waitcnt vmcnt(18)
    v_bitop3_b32 v28, v105, v109, v28 bitop3:0x80
    v_mul_f32 v193, v193, v15
    v_mfma_f32_16x16x32_bf16 v[206:209], v[90:93], a[144:147], v[206:209]
    v_and_b32 v28, 1, v28
    v_cvt_pk_bf16_f32 v54, v190, v191
    v_mfma_f32_16x16x32_bf16 v[210:213], v[90:93], a[148:151], v[210:213]
    global_load_lds_dwordx4 v4, s[92:93] offset:0 sc1
    v_cmp_ne_u32 vcc, 1, v28
    v_mfma_f32_16x16x32_bf16 v[214:217], v[90:93], a[152:155], v[214:217]
    v_cvt_pk_bf16_f32 v55, v192, v193
    global_load_lds_dwordx4 v4, s[92:93] offset:1024 sc1
    v_mfma_f32_16x16x32_bf16 v[218:221], v[90:93], a[156:159], v[218:221]
    v_and_b32 v55, -2, v55
    s_cbranch_vccnz Lz22_r
Lz22_ok:
    v_mfma_f32_16x16x32_bf16 v[222:225], v[94:97], a[32:35], v[222:225]
    global_load_dwordx4 v[78:81], v30, s[52:53] offset:3072 sc1
    v_mfma_f32_16x16x32_bf16 v[226:229], v[94:97], a[36:39], v[226:229]
    v_mfma_f32_16x16x32_bf16 v[230:233], v[94:97], a[40:43], v[230:233]
    global_load_dwordx4 v[82:85], v31, s[52:53] offset:3072 sc1
    v_mfma_f32_16x16x32_bf16 v[234:237], v[94:97], a[44:47], v[234:237]
    ds_write_b128 v20, v[210:213] offset:0
    v_mfma_f32_16x16x32_bf16 v[222:225], v[98:101], a[48:51], v[222:225]
    v_mfma_f32_16x16x32_bf16 v[226:229], v[98:101], a[52:55], v[226:229]
    global_load_dwordx4 v[86:89], v30, s[54:55] offset:3072 sc1
    v_mfma_f32_16x16x32_bf16 v[230:233], v[98:101], a[56:59], v[230:233]
    ds_write_b128 v21, v[214:217] offset:0
    v_mfma_f32_16x16x32_bf16 v[234:237], v[98:101], a[60:63], v[234:237]
    v_mfma_f32_16x16x32_bf16 v[222:225], v[102:105], a[64:67], v[222:225]
    global_load_dwordx4 v[90:93], v31, s[54:55] offset:3072 sc1
    v_mfma_f32_16x16x32_bf16 v[226:229], v[102:105], a[68:71], v[226:229]
    ds_write_b128 v22, v[218:221] offset:0
    v_mfma_f32_16x16x32_bf16 v[230:233], v[102:105], a[72:75], v[230:233]
    s_waitcnt vmcnt(20)
    v_and_b32 v28, v113, v117
    global_load_lds_dwordx4 v4, s[92:93] offset:2048 sc1
    v_mfma_f32_16x16x32_bf16 v[234:237], v[102:105], a[76:79], v[234:237]
    s_waitcnt vmcnt(19)
    v_bitop3_b32 v28, v121, v125, v28 bitop3:0x80
    v_mfma_f32_16x16x32_bf16 v[222:225], v[106:109], a[80:83], v[222:225]
    v_and_b32 v28, 1, v28
    s_waitcnt lgkmcnt(0)
    s_barrier
    v_mfma_f32_16x16x32_bf16 v[226:229], v[106:109], a[84:87], v[226:229]
    v_cmp_ne_u32 vcc, 1, v28
    global_load_lds_dwordx4 v4, s[92:93] offset:3072 sc1
    v_mfma_f32_16x16x32_bf16 v[230:233], v[106:109], a[88:91], v[230:233]
    v_mfma_f32_16x16x32_bf16 v[234:237], v[106:109], a[92:95], v[234:237]
    s_cbranch_vccnz Lz23_r
Lz23_ok:
    v_mfma_f32_16x16x32_bf16 v[222:225], v[110:113], a[224:227], v[222:225]
    global_load_dwordx4 v[94:97], v30, s[64:65] offset:3072 sc1
    ds_read_b128 v[210:213], v23 offset:0
    v_mfma_f32_16x16x32_bf16 v[226:229], v[110:113], a[228:231], v[226:229]
    ds_read_b128 v[214:217], v23 offset:1024
    global_load_dwordx4 v[98:101], v31, s[64:65] offset:3072 sc1
    v_mfma_f32_16x16x32_bf16 v[230:233], v[110:113], a[232:235], v[230:233]
    ds_read_b128 v[218:221], v23 offset:2048
    v_mfma_f32_16x16x32_bf16 v[234:237], v[110:113], a[236:239], v[234:237]
    global_load_dwordx4 v[102:105], v30, s[66:67] offset:3072 sc1
    v_lshlrev_b32 v12, 16, v56
    v_mfma_f32_16x16x32_bf16 v[222:225], v[114:117], a[240:243], v[222:225]
    v_and_b32 v13, 0xffff0000, v56
    v_mfma_f32_16x16x32_bf16 v[226:229], v[114:117], a[244:247], v[226:229]
    global_load_dwordx4 v[106:109], v31, s[66:67] offset:3072 sc1
    v_mfma_f32_16x16x32_bf16 v[230:233], v[114:117], a[248:251], v[230:233]
    v_lshlrev_b32 v14, 16, v57
    v_mfma_f32_16x16x32_bf16 v[234:237], v[114:117], a[252:255], v[234:237]
    s_add_u32 m0, s95, 24576
    v_and_b32 v15, 0xffff0000, v57
    v_mfma_f32_16x16x32_bf16 v[222:225], v[118:121], a[192:195], v[222:225]
    s_waitcnt lgkmcnt(2)
    v_add_f32 v206, v206, v210
    s_add_u32 s92, s92, 4096
    s_addc_u32 s93, s93, 0
    v_mfma_f32_16x16x32_bf16 v[226:229], v[118:121], a[196:199], v[226:229]
    v_add_f32 v207, v207, v211
    v_mfma_f32_16x16x32_bf16 v[230:233], v[118:121], a[200:203], v[230:233]
    s_waitcnt vmcnt(20)
    v_and_b32 v28, v129, v133
    v_mfma_f32_16x16x32_bf16 v[234:237], v[118:121], a[204:207], v[234:237]
    s_waitcnt vmcnt(18)
    v_bitop3_b32 v28, v137, v141, v28 bitop3:0x80
    v_add_f32 v208, v208, v212
    v_mfma_f32_16x16x32_bf16 v[222:225], v[122:125], a[208:211], v[222:225]
    v_and_b32 v28, 1, v28
    v_add_f32 v209, v209, v213
    v_mfma_f32_16x16x32_bf16 v[226:229], v[122:125], a[212:215], v[226:229]
    global_load_lds_dwordx4 v4, s[92:93] offset:0 sc1
    v_cmp_ne_u32 vcc, 1, v28
    v_mfma_f32_16x16x32_bf16 v[230:233], v[122:125], a[216:219], v[230:233]
    s_waitcnt lgkmcnt(1)
    v_add_f32 v206, v206, v214
    global_load_lds_dwordx4 v4, s[92:93] offset:1024 sc1
    v_mfma_f32_16x16x32_bf16 v[234:237], v[122:125], a[220:223], v[234:237]
    v_add_f32 v207, v207, v215
    s_cbranch_vccnz Lz24_r
Lz24_ok:
    v_mfma_f32_16x16x32_bf16 v[222:225], v[126:129], a[96:99], v[222:225]
    global_store_dwordx4 v6, v[48:51], s[8:9] offset:-4096 sc1
    v_add_f32 v208, v208, v216
    v_mfma_f32_16x16x32_bf16 v[226:229], v[126:129], a[100:103], v[226:229]
    v_add_f32 v209, v209, v217
    v_mfma_f32_16x16x32_bf16 v[230:233], v[126:129], a[104:107], v[230:233]
    s_waitcnt lgkmcnt(0)
    v_add_f32 v206, v206, v218
    v_mfma_f32_16x16x32_bf16 v[234:237], v[126:129], a[108:111], v[234:237]
    v_mfma_f32_16x16x32_bf16 v[222:225], v[130:133], a[112:115], v[222:225]
    global_store_dwordx4 v7, v[52:55], s[8:9] offset:-4096 sc1
    v_add_f32 v207, v207, v219
    v_mfma_f32_16x16x32_bf16 v[226:229], v[130:133], a[116:119], v[226:229]
    v_add_f32 v208, v208, v220
    v_mfma_f32_16x16x32_bf16 v[230:233], v[130:133], a[120:123], v[230:233]
    v_add_f32 v209, v209, v221
    v_mfma_f32_16x16x32_bf16 v[234:237], v[130:133], a[124:127], v[234:237]
    v_mfma_f32_16x16x32_bf16 v[222:225], v[134:137], a[128:131], v[222:225]
    global_load_lds_dwordx4 v4, s[92:93] offset:2048 sc1
    v_mul_f32 v206, v206, v12
    v_mfma_f32_16x16x32_bf16 v[226:229], v[134:137], a[132:135], v[226:229]
    v_mul_f32 v207, v207, v13
    v_mfma_f32_16x16x32_bf16 v[230:233], v[134:137], a[136:139], v[230:233]
    s_waitcnt vmcnt(19)
    v_and_b32 v28, v65, v69
    v_mul_f32 v208, v208, v14
    v_mfma_f32_16x16x32_bf16 v[234:237], v[134:137], a[140:143], v[234:237]
    s_waitcnt vmcnt(17)
    v_bitop3_b32 v28, v73, v77, v28 bitop3:0x80
    v_mfma_f32_16x16x32_bf16 v[222:225], v[138:141], a[144:147], v[222:225]
    v_and_b32 v28, 1, v28
    global_load_lds_dwordx4 v4, s[92:93] offset:3072 sc1
    v_mfma_f32_16x16x32_bf16 v[226:229], v[138:141], a[148:151], v[226:229]
    v_mul_f32 v209, v209, v15
    v_cmp_ne_u32 vcc, 1, v28
    v_mfma_f32_16x16x32_bf16 v[230:233], v[138:141], a[152:155], v[230:233]
    v_cvt_pk_bf16_f32 v56, v206, v207
    v_cvt_pk_bf16_f32 v57, v208, v209
    v_mfma_f32_16x16x32_bf16 v[234:237], v[138:141], a[156:159], v[234:237]
    s_cbranch_vccnz Lz25_r
Lz25_ok:
    v_mfma_f32_16x16x32_bf16 v[238:241], v[62:65], a[32:35], v[238:241]
    s_add_u32 m0, s95, 28672
    v_mfma_f32_16x16x32_bf16 v[242:245], v[62:65], a[36:39], v[242:245]
    v_mfma_f32_16x16x32_bf16 v[246:249], v[62:65], a[40:43], v[246:249]
    v_mfma_f32_16x16x32_bf16 v[250:253], v[62:65], a[44:47], v[250:253]
    ds_write_b128 v20, v[226:229] offset:12288
    v_mfma_f32_16x16x32_bf16 v[238:241], v[66:69], a[48:51], v[238:241]
    s_add_u32 s92, s92, 4096
    s_addc_u32 s93, s93, 0
    v_mfma_f32_16x16x32_bf16 v[242:245], v[66:69], a[52:55], v[242:245]
    v_mfma_f32_16x16x32_bf16 v[246:249], v[66:69], a[56:59], v[246:249]
    ds_write_b128 v21, v[230:233] offset:12288
    v_mfma_f32_16x16x32_bf16 v[250:253], v[66:69], a[60:63], v[250:253]
    v_mfma_f32_16x16x32_bf16 v[238:241], v[70:73], a[64:67], v[238:241]
    v_mfma_f32_16x16x32_bf16 v[242:245], v[70:73], a[68:71], v[242:245]
    ds_write_b128 v22, v[234:237] offset:12288
    v_mfma_f32_16x16x32_bf16 v[246:249], v[70:73], a[72:75], v[246:249]
    s_waitcnt vmcnt(14)
    v_and_b32 v28, v81, v85
    global_load_lds_dwordx4 v4, s[92:93] offset:0 sc1
    v_mfma_f32_16x16x32_bf16 v[250:253], v[70:73], a[76:79], v[250:253]
    s_waitcnt vmcnt(13)
    v_bitop3_b32 v28, v89, v93, v28 bitop3:0x80
    v_mfma_f32_16x16x32_bf16 v[238:241], v[74:77], a[80:83], v[238:241]
    v_and_b32 v28, 1, v28
    s_waitcnt lgkmcnt(0)
    s_barrier
    v_mfma_f32_16x16x32_bf16 v[242:245], v[74:77], a[84:87], v[242:245]
    global_load_lds_dwordx4 v4, s[92:93] offset:1024 sc1
    v_cmp_ne_u32 vcc, 1, v28
    v_mfma_f32_16x16x32_bf16 v[246:249], v[74:77], a[88:91], v[246:249]
    v_mfma_f32_16x16x32_bf16 v[250:253], v[74:77], a[92:95], v[250:253]
    s_cbranch_vccnz Lz26_r
Lz26_ok:
    v_mfma_f32_16x16x32_bf16 v[238:241], v[78:81], a[224:227], v[238:241]
    global_load_lds_dwordx4 v4, s[92:93] offset:2048 sc1
    ds_read_b128 v[226:229], v23 offset:12288
    v_mfma_f32_16x16x32_bf16 v[242:245], v[78:81], a[228:231], v[242:245]
    ds_read_b128 v[230:233], v23 offset:13312
    v_mfma_f32_16x16x32_bf16 v[246:249], v[78:81], a[232:235], v[246:249]
    ds_read_b128 v[234:237], v23 offset:14336
    v_mfma_f32_16x16x32_bf16 v[250:253], v[78:81], a[236:239], v[250:253]
    v_lshlrev_b32 v12, 16, v58
    v_mfma_f32_16x16x32_bf16 v[238:241], v[82:85], a[240:243], v[238:241]
    v_and_b32 v13, 0xffff0000, v58
    v_mfma_f32_16x16x32_bf16 v[242:245], v[82:85], a[244:247], v[242:245]
    v_mfma_f32_16x16x32_bf16 v[246:249], v[82:85], a[248:251], v[246:249]
    v_lshlrev_b32 v14, 16, v59
    v_mfma_f32_16x16x32_bf16 v[250:253], v[82:85], a[252:255], v[250:253]
    v_and_b32 v15, 0xffff0000, v59
    v_mfma_f32_16x16x32_bf16 v[238:241], v[86:89], a[192:195], v[238:241]
    global_load_lds_dwordx4 v4, s[92:93] offset:3072 sc1
    s_waitcnt lgkmcnt(2)
    v_add_f32 v222, v222, v226
    v_mfma_f32_16x16x32_bf16 v[242:245], v[86:89], a[196:199], v[242:245]
    v_add_f32 v223, v223, v227
    v_mfma_f32_16x16x32_bf16 v[246:249], v[86:89], a[200:203], v[246:249]
    s_waitcnt vmcnt(12)
    v_and_b32 v28, v97, v101
    v_mfma_f32_16x16x32_bf16 v[250:253], v[86:89], a[204:207], v[250:253]
    s_waitcnt vmcnt(10)
    v_bitop3_b32 v28, v105, v109, v28 bitop3:0x80
    v_add_f32 v224, v224, v228
    v_mfma_f32_16x16x32_bf16 v[238:241], v[90:93], a[208:211], v[238:241]
    v_and_b32 v28, 1, v28
    v_add_f32 v225, v225, v229
    v_mfma_f32_16x16x32_bf16 v[242:245], v[90:93], a[212:215], v[242:245]
    v_cmp_ne_u32 vcc, 1, v28
    s_waitcnt lgkmcnt(1)
    v_add_f32 v222, v222, v230
    v_mfma_f32_16x16x32_bf16 v[246:249], v[90:93], a[216:219], v[246:249]
    v_add_f32 v223, v223, v231
    v_mfma_f32_16x16x32_bf16 v[250:253], v[90:93], a[220:223], v[250:253]
    s_cbranch_vccnz Lz27_r
Lz27_ok:
    v_mfma_f32_16x16x32_bf16 v[238:241], v[94:97], a[96:99], v[238:241]
    s_add_u32 m0, s95, 32768
    v_add_f32 v224, v224, v232
    v_mfma_f32_16x16x32_bf16 v[242:245], v[94:97], a[100:103], v[242:245]
    v_add_f32 v225, v225, v233
    v_mfma_f32_16x16x32_bf16 v[246:249], v[94:97], a[104:107], v[246:249]
    s_waitcnt lgkmcnt(0)
    v_add_f32 v222, v222, v234
    v_mfma_f32_16x16x32_bf16 v[250:253], v[94:97], a[108:111], v[250:253]
    s_add_u32 s92, s92, 4096
    s_addc_u32 s93, s93, 0
    v_add_f32 v223, v223, v235
    v_mfma_f32_16x16x32_bf16 v[238:241], v[98:101], a[112:115], v[238:241]
    v_add_f32 v224, v224, v236
    v_mfma_f32_16x16x32_bf16 v[242:245], v[98:101], a[116:119], v[242:245]
    v_mfma_f32_16x16x32_bf16 v[246:249], v[98:101], a[120:123], v[246:249]
    v_add_f32 v225, v225, v237
    v_mfma_f32_16x16x32_bf16 v[250:253], v[98:101], a[124:127], v[250:253]
    v_mul_f32 v222, v222, v12
    v_mfma_f32_16x16x32_bf16 v[238:241], v[102:105], a[128:131], v[238:241]
    v_mul_f32 v223, v223, v13
    v_mfma_f32_16x16x32_bf16 v[242:245], v[102:105], a[132:135], v[242:245]
    global_load_lds_dwordx4 v4, s[92:93] offset:0 sc1
    v_mul_f32 v224, v224, v14
    v_mfma_f32_16x16x32_bf16 v[246:249], v[102:105], a[136:139], v[246:249]
    v_mfma_f32_16x16x32_bf16 v[250:253], v[102:105], a[140:143], v[250:253]
    v_mul_f32 v225, v225, v15
    v_mfma_f32_16x16x32_bf16 v[238:241], v[106:109], a[144:147], v[238:241]
    v_cvt_pk_bf16_f32 v58, v222, v223
    global_load_lds_dwordx4 v4, s[92:93] offset:1024 sc1
    v_mfma_f32_16x16x32_bf16 v[242:245], v[106:109], a[148:151], v[242:245]
    v_cvt_pk_bf16_f32 v59, v224, v225
    v_mfma_f32_16x16x32_bf16 v[246:249], v[106:109], a[152:155], v[246:249]
    v_and_b32 v59, -2, v59
    v_mfma_f32_16x16x32_bf16 v[250:253], v[106:109], a[156:159], v[250:253]
    global_load_dwordx4 v[142:145], v6, s[38:39] offset:-4096 sc1
    s_nop 2
    ds_write_b128 v20, v[242:245] offset:0
    s_nop 0
    ds_write_b128 v21, v[246:249] offset:0
    global_load_dwordx4 v[146:149], v6, s[38:39] offset:-3072 sc1
    ds_write_b128 v22, v[250:253] offset:0
    s_waitcnt lgkmcnt(0)
    s_barrier
    global_load_dwordx4 v[150:153], v6, s[38:39] offset:-2048 sc1
    ds_read_b128 v[242:245], v23 offset:0
    ds_read_b128 v[246:249], v23 offset:1024
    global_load_dwordx4 v[154:157], v6, s[38:39] offset:-1024 sc1
    ds_read_b128 v[250:253], v23 offset:2048
    v_lshlrev_b32 v12, 16, v60
    v_and_b32 v13, 0xffff0000, v60
    global_load_dwordx4 v[158:161], v6, s[38:39] offset:0 sc1
    v_lshlrev_b32 v14, 16, v61
    v_and_b32 v15, 0xffff0000, v61
    global_load_dwordx4 v[162:165], v6, s[38:39] offset:1024 sc1
    s_waitcnt lgkmcnt(2)
    v_pk_add_f32 v[238:239], v[238:239], v[242:243] op_sel:[0,0] op_sel_hi:[1,1]
    v_pk_add_f32 v[240:241], v[240:241], v[244:245] op_sel:[0,0] op_sel_hi:[1,1]
    s_waitcnt lgkmcnt(1)
    v_pk_add_f32 v[238:239], v[238:239], v[246:247] op_sel:[0,0] op_sel_hi:[1,1]
    global_load_dwordx4 v[166:169], v6, s[38:39] offset:2048 sc1
    v_pk_add_f32 v[240:241], v[240:241], v[248:249] op_sel:[0,0] op_sel_hi:[1,1]
    s_waitcnt lgkmcnt(0)
    v_pk_add_f32 v[238:239], v[238:239], v[250:251] op_sel:[0,0] op_sel_hi:[1,1]
    global_load_dwordx4 v[170:173], v6, s[38:39] offset:3072 sc1
    v_pk_add_f32 v[240:241], v[240:241], v[252:253] op_sel:[0,0] op_sel_hi:[1,1]
    v_pk_mul_f32 v[238:239], v[238:239], v[12:13] op_sel:[0,0] op_sel_hi:[1,1]
    v_pk_mul_f32 v[240:241], v[240:241], v[14:15] op_sel:[0,0] op_sel_hi:[1,1]
    v_cvt_pk_bf16_f32 v60, v238, v239
    v_cvt_pk_bf16_f32 v61, v240, v241
    v_and_b32 v61, -2, v61
    global_store_dwordx4 v26, v[56:59], s[8:9] offset:-4096 sc1
    global_store_dwordx2 v27, v[60:61], s[10:11] offset:-4096 sc1
    v_add_u32 v30, 61440, v4
    v_add_u32 v31, 122880, v4
    global_load_dwordx4 v[174:177], v7, s[38:39] offset:-4096 sc1
    global_load_dwordx4 v[178:181], v7, s[38:39] offset:-3072 sc1
    global_load_dwordx4 v[182:185], v7, s[38:39] offset:-2048 sc1
    global_load_dwordx4 v[186:189], v7, s[38:39] offset:-1024 sc1
    global_load_dwordx4 v[190:193], v7, s[38:39] offset:0 sc1
    global_load_dwordx4 v[194:197], v7, s[38:39] offset:1024 sc1
    global_load_dwordx4 v[198:201], v7, s[38:39] offset:2048 sc1
    global_load_dwordx4 v[202:205], v7, s[38:39] offset:3072 sc1
    s_waitcnt vmcnt(18)
    s_barrier
    ds_read_b128 v[82:85], v4 offset:0
    ds_read_b128 v[86:89], v4 offset:1024
    ds_read_b128 v[90:93], v4 offset:2048
    ds_read_b128 v[94:97], v4 offset:3072
    ds_read_b128 v[98:101], v4 offset:4096
    s_waitcnt vmcnt(16)
    v_or_b32 v28, v145, v149
    s_waitcnt vmcnt(14)
    v_or3_b32 v28, v153, v157, v28
    s_waitcnt vmcnt(12)
    v_or3_b32 v28, v161, v165, v28
    s_waitcnt vmcnt(10)
    v_or3_b32 v28, v169, v173, v28
    v_and_b32 v28, 1, v28
    v_cmp_ne_u32 vcc, 0, v28
    s_nop 0
    s_cbranch_vccnz Lp0_r
Lp0_ok:
    s_waitcnt lgkmcnt(4)
    v_mfma_f32_16x16x32_bf16 v[62:65], v[82:85], v[142:145], 0
    ds_read_b128 v[102:105], v4 offset:20480
    s_waitcnt lgkmcnt(4)
    v_mfma_f32_16x16x32_bf16 v[66:69], v[86:89], v[142:145], 0
    ds_read_b128 v[82:85], v4 offset:21504
    s_waitcnt lgkmcnt(4)
    v_mfma_f32_16x16x32_bf16 v[70:73], v[90:93], v[142:145], 0
    ds_read_b128 v[86:89], v4 offset:22528
    s_waitcnt lgkmcnt(4)
    v_mfma_f32_16x16x32_bf16 v[74:77], v[94:97], v[142:145], 0
    ds_read_b128 v[90:93], v4 offset:23552
    s_waitcnt lgkmcnt(4)
    v_mfma_f32_16x16x32_bf16 v[78:81], v[98:101], v[142:145], 0
    ds_read_b128 v[94:97], v4 offset:24576
    s_waitcnt lgkmcnt(4)
    v_mfma_f32_16x16x32_bf16 v[62:65], v[102:105], v[146:149], v[62:65]
    ds_read_b128 v[98:101], v4 offset:35840
    s_waitcnt lgkmcnt(4)
    v_mfma_f32_16x16x32_bf16 v[66:69], v[82:85], v[146:149], v[66:69]
    ds_read_b128 v[102:105], v4 offset:36864
    s_waitcnt lgkmcnt(4)
    v_mfma_f32_16x16x32_bf16 v[70:73], v[86:89], v[146:149], v[70:73]
    ds_read_b128 v[82:85], v4 offset:37888
    s_waitcnt lgkmcnt(4)
    v_mfma_f32_16x16x32_bf16 v[74:77], v[90:93], v[146:149], v[74:77]
    ds_read_b128 v[86:89], v4 offset:38912
    s_waitcnt lgkmcnt(4)
    v_mfma_f32_16x16x32_bf16 v[78:81], v[94:97], v[146:149], v[78:81]
    ds_read_b128 v[90:93], v4 offset:39936
    s_waitcnt lgkmcnt(4)
    v_mfma_f32_16x16x32_bf16 v[62:65], v[98:101], v[150:153], v[62:65]
    ds_read_b128 v[94:97], v4 offset:56320
    s_waitcnt lgkmcnt(4)
    v_mfma_f32_16x16x32_bf16 v[66:69], v[102:105], v[150:153], v[66:69]
    ds_read_b128 v[98:101], v4 offset:57344
    s_waitcnt lgkmcnt(4)
    v_mfma_f32_16x16x32_bf16 v[70:73], v[82:85], v[150:153], v[70:73]
    ds_read_b128 v[102:105], v4 offset:58368
    s_waitcnt lgkmcnt(4)
    v_mfma_f32_16x16x32_bf16 v[74:77], v[86:89], v[150:153], v[74:77]
    ds_read_b128 v[82:85], v4 offset:59392
    s_waitcnt lgkmcnt(4)
    v_mfma_f32_16x16x32_bf16 v[78:81], v[90:93], v[150:153], v[78:81]
    ds_read_b128 v[86:89], v4 offset:60416
    s_waitcnt lgkmcnt(4)
    v_mfma_f32_16x16x32_bf16 v[62:65], v[94:97], v[154:157], v[62:65]
    ds_read_b128 v[90:93], v30 offset:10240
    s_waitcnt lgkmcnt(4)
    v_mfma_f32_16x16x32_bf16 v[66:69], v[98:101], v[154:157], v[66:69]
    ds_read_b128 v[94:97], v30 offset:11264
    s_waitcnt lgkmcnt(4)
    v_mfma_f32_16x16x32_bf16 v[70:73], v[102:105], v[154:157], v[70:73]
    ds_read_b128 v[98:101], v30 offset:12288
    s_waitcnt lgkmcnt(4)
    v_mfma_f32_16x16x32_bf16 v[74:77], v[82:85], v[154:157], v[74:77]
    ds_read_b128 v[102:105], v30 offset:13312
    s_waitcnt lgkmcnt(4)
    v_mfma_f32_16x16x32_bf16 v[78:81], v[86:89], v[154:157], v[78:81]
    ds_read_b128 v[82:85], v30 offset:14336
    s_waitcnt lgkmcnt(4)
    v_mfma_f32_16x16x32_bf16 v[62:65], v[90:93], v[158:161], v[62:65]
    ds_read_b128 v[86:89], v30 offset:30720
    s_waitcnt lgkmcnt(4)
    v_mfma_f32_16x16x32_bf16 v[66:69], v[94:97], v[158:161], v[66:69]
    ds_read_b128 v[90:93], v30 offset:31744
    s_waitcnt lgkmcnt(4)
    v_mfma_f32_16x16x32_bf16 v[70:73], v[98:101], v[158:161], v[70:73]
    ds_read_b128 v[94:97], v30 offset:32768
    s_waitcnt lgkmcnt(4)
    v_mfma_f32_16x16x32_bf16 v[74:77], v[102:105], v[158:161], v[74:77]
    ds_read_b128 v[98:101], v30 offset:33792
    s_waitcnt lgkmcnt(4)
    v_mfma_f32_16x16x32_bf16 v[78:81], v[82:85], v[158:161], v[78:81]
    ds_read_b128 v[102:105], v30 offset:34816
    s_waitcnt lgkmcnt(4)
    v_mfma_f32_16x16x32_bf16 v[62:65], v[86:89], v[162:165], v[62:65]
    ds_read_b128 v[82:85], v30 offset:46080
    s_waitcnt lgkmcnt(4)
    v_mfma_f32_16x16x32_bf16 v[66:69], v[90:93], v[162:165], v[66:69]
    ds_read_b128 v[86:89], v30 offset:47104
    s_waitcnt lgkmcnt(4)
    v_mfma_f32_16x16x32_bf16 v[70:73], v[94:97], v[162:165], v[70:73]
    ds_read_b128 v[90:93], v30 offset:48128
    s_waitcnt lgkmcnt(4)
    v_mfma_f32_16x16x32_bf16 v[74:77], v[98:101], v[162:165], v[74:77]
    ds_read_b128 v[94:97], v30 offset:49152
    s_waitcnt lgkmcnt(4)
    v_mfma_f32_16x16x32_bf16 v[78:81], v[102:105], v[162:165], v[78:81]
    ds_read_b128 v[98:101], v30 offset:50176
    s_waitcnt lgkmcnt(4)
    v_mfma_f32_16x16x32_bf16 v[62:65], v[82:85], v[166:169], v[62:65]
    ds_read_b128 v[102:105], v31 offset:5120
    s_waitcnt lgkmcnt(4)
    v_mfma_f32_16x16x32_bf16 v[66:69], v[86:89], v[166:169], v[66:69]
    ds_read_b128 v[82:85], v31 offset:6144
    s_waitcnt lgkmcnt(4)
    v_mfma_f32_16x16x32_bf16 v[70:73], v[90:93], v[166:169], v[70:73]
    ds_read_b128 v[86:89], v31 offset:7168
    s_waitcnt lgkmcnt(4)
    v_mfma_f32_16x16x32_bf16 v[74:77], v[94:97], v[166:169], v[74:77]
    ds_read_b128 v[90:93], v31 offset:8192
    s_waitcnt lgkmcnt(4)
    v_mfma_f32_16x16x32_bf16 v[78:81], v[98:101], v[166:169], v[78:81]
    ds_read_b128 v[94:97], v31 offset:9216
    s_waitcnt lgkmcnt(4)
    v_mfma_f32_16x16x32_bf16 v[62:65], v[102:105], v[170:173], v[62:65]
    ds_read_b128 v[98:101], v4 offset:5120
    s_waitcnt lgkmcnt(4)
    v_mfma_f32_16x16x32_bf16 v[66:69], v[82:85], v[170:173], v[66:69]
    ds_read_b128 v[102:105], v4 offset:6144
    s_waitcnt lgkmcnt(4)
    v_mfma_f32_16x16x32_bf16 v[70:73], v[86:89], v[170:173], v[70:73]
    ds_read_b128 v[82:85], v4 offset:7168
    s_waitcnt lgkmcnt(4)
    v_mfma_f32_16x16x32_bf16 v[74:77], v[90:93], v[170:173], v[74:77]
    ds_read_b128 v[86:89], v4 offset:8192
    s_waitcnt lgkmcnt(4)
    v_mfma_f32_16x16x32_bf16 v[78:81], v[94:97], v[170:173], v[78:81]
    ds_read_b128 v[90:93], v4 offset:9216
    s_waitcnt vmcnt(6)
    v_or_b32 v28, v177, v181
    s_waitcnt vmcnt(4)
    v_or3_b32 v28, v185, v189, v28
    s_waitcnt vmcnt(2)
    v_or3_b32 v28, v193, v197, v28
    s_waitcnt vmcnt(0)
    v_or3_b32 v28, v201, v205, v28
    v_and_b32 v28, 1, v28
    v_cmp_ne_u32 vcc, 0, v28
    s_nop 0
    s_cbranch_vccnz Lp1_r
Lp1_ok:
    s_waitcnt lgkmcnt(4)
    v_mfma_f32_16x16x32_bf16 v[62:65], v[98:101], v[174:177], v[62:65]
    ds_read_b128 v[94:97], v4 offset:25600
    s_waitcnt lgkmcnt(4)
    v_mfma_f32_16x16x32_bf16 v[66:69], v[102:105], v[174:177], v[66:69]
    ds_read_b128 v[98:101], v4 offset:26624
    s_waitcnt lgkmcnt(4)
    v_mfma_f32_16x16x32_bf16 v[70:73], v[82:85], v[174:177], v[70:73]
    ds_read_b128 v[102:105], v4 offset:27648
    s_waitcnt lgkmcnt(4)
    v_mfma_f32_16x16x32_bf16 v[74:77], v[86:89], v[174:177], v[74:77]
    ds_read_b128 v[82:85], v4 offset:28672
    s_waitcnt lgkmcnt(4)
    v_mfma_f32_16x16x32_bf16 v[78:81], v[90:93], v[174:177], v[78:81]
    ds_read_b128 v[86:89], v4 offset:29696
    s_waitcnt lgkmcnt(4)
    v_mfma_f32_16x16x32_bf16 v[62:65], v[94:97], v[178:181], v[62:65]
    ds_read_b128 v[90:93], v4 offset:40960
    s_waitcnt lgkmcnt(4)
    v_mfma_f32_16x16x32_bf16 v[66:69], v[98:101], v[178:181], v[66:69]
    ds_read_b128 v[94:97], v4 offset:41984
    s_waitcnt lgkmcnt(4)
    v_mfma_f32_16x16x32_bf16 v[70:73], v[102:105], v[178:181], v[70:73]
    ds_read_b128 v[98:101], v4 offset:43008
    s_waitcnt lgkmcnt(4)
    v_mfma_f32_16x16x32_bf16 v[74:77], v[82:85], v[178:181], v[74:77]
    ds_read_b128 v[102:105], v4 offset:44032
    s_waitcnt lgkmcnt(4)
    v_mfma_f32_16x16x32_bf16 v[78:81], v[86:89], v[178:181], v[78:81]
    ds_read_b128 v[82:85], v4 offset:45056
    s_waitcnt lgkmcnt(4)
    v_mfma_f32_16x16x32_bf16 v[62:65], v[90:93], v[182:185], v[62:65]
    ds_read_b128 v[86:89], v30 offset:0
    global_load_dwordx4 v[206:209], v26, s[38:39] offset:-4096 sc1
    s_waitcnt lgkmcnt(4)
    v_mfma_f32_16x16x32_bf16 v[66:69], v[94:97], v[182:185], v[66:69]
    ds_read_b128 v[90:93], v30 offset:1024
    s_waitcnt lgkmcnt(4)
    v_mfma_f32_16x16x32_bf16 v[70:73], v[98:101], v[182:185], v[70:73]
    ds_read_b128 v[94:97], v30 offset:2048
    global_load_dwordx4 v[210:213], v26, s[38:39] offset:-3072 sc1
    s_waitcnt lgkmcnt(4)
    v_mfma_f32_16x16x32_bf16 v[74:77], v[102:105], v[182:185], v[74:77]
    ds_read_b128 v[98:101], v30 offset:3072
    s_waitcnt lgkmcnt(4)
    v_mfma_f32_16x16x32_bf16 v[78:81], v[82:85], v[182:185], v[78:81]
    ds_read_b128 v[102:105], v30 offset:4096
    s_waitcnt lgkmcnt(4)
    v_mfma_f32_16x16x32_bf16 v[62:65], v[86:89], v[186:189], v[62:65]
    ds_read_b128 v[82:85], v30 offset:15360
    global_load_dwordx4 v[214:217], v26, s[38:39] offset:-2048 sc1
    s_waitcnt lgkmcnt(4)
    v_mfma_f32_16x16x32_bf16 v[66:69], v[90:93], v[186:189], v[66:69]
    ds_read_b128 v[86:89], v30 offset:16384
    s_waitcnt lgkmcnt(4)
    v_mfma_f32_16x16x32_bf16 v[70:73], v[94:97], v[186:189], v[70:73]
    ds_read_b128 v[90:93], v30 offset:17408
    s_waitcnt lgkmcnt(4)
    v_mfma_f32_16x16x32_bf16 v[74:77], v[98:101], v[186:189], v[74:77]
    ds_read_b128 v[94:97], v30 offset:18432
    global_load_dwordx4 v[218:221], v26, s[38:39] offset:-1024 sc1
    s_waitcnt lgkmcnt(4)
    v_mfma_f32_16x16x32_bf16 v[78:81], v[102:105], v[186:189], v[78:81]
    ds_read_b128 v[98:101], v30 offset:19456
    s_waitcnt lgkmcnt(4)
    v_mfma_f32_16x16x32_bf16 v[62:65], v[82:85], v[190:193], v[62:65]
    ds_read_b128 v[102:105], v30 offset:35840
    global_load_dwordx4 v[222:225], v26, s[38:39] offset:0 sc1
    s_waitcnt lgkmcnt(4)
    v_mfma_f32_16x16x32_bf16 v[66:69], v[86:89], v[190:193], v[66:69]
    ds_read_b128 v[82:85], v30 offset:36864
    s_waitcnt lgkmcnt(4)
    v_mfma_f32_16x16x32_bf16 v[70:73], v[90:93], v[190:193], v[70:73]
    ds_read_b128 v[86:89], v30 offset:37888
    s_waitcnt lgkmcnt(4)
    v_mfma_f32_16x16x32_bf16 v[74:77], v[94:97], v[190:193], v[74:77]
    ds_read_b128 v[90:93], v30 offset:38912
    global_load_dwordx4 v[226:229], v26, s[38:39] offset:1024 sc1
    s_waitcnt lgkmcnt(4)
    v_mfma_f32_16x16x32_bf16 v[78:81], v[98:101], v[190:193], v[78:81]
    ds_read_b128 v[94:97], v30 offset:39936
    s_waitcnt lgkmcnt(4)
    v_mfma_f32_16x16x32_bf16 v[62:65], v[102:105], v[194:197], v[62:65]
    ds_read_b128 v[98:101], v30 offset:51200
    s_waitcnt lgkmcnt(4)
    v_mfma_f32_16x16x32_bf16 v[66:69], v[82:85], v[194:197], v[66:69]
    ds_read_b128 v[102:105], v30 offset:52224
    global_load_dwordx4 v[230:233], v26, s[38:39] offset:2048 sc1
    s_waitcnt lgkmcnt(4)
    v_mfma_f32_16x16x32_bf16 v[70:73], v[86:89], v[194:197], v[70:73]
    ds_read_b128 v[82:85], v30 offset:53248
    s_waitcnt lgkmcnt(4)
    v_mfma_f32_16x16x32_bf16 v[74:77], v[90:93], v[194:197], v[74:77]
    ds_read_b128 v[86:89], v30 offset:54272
    s_waitcnt lgkmcnt(4)
    v_mfma_f32_16x16x32_bf16 v[78:81], v[94:97], v[194:197], v[78:81]
    ds_read_b128 v[90:93], v30 offset:55296
    global_load_dwordx4 v[238:241], v27, s[38:39] offset:-4096 sc1
    s_waitcnt lgkmcnt(4)
    v_mfma_f32_16x16x32_bf16 v[62:65], v[98:101], v[198:201], v[62:65]
    ds_read_b128 v[94:97], v31 offset:10240
    s_waitcnt lgkmcnt(4)
    v_mfma_f32_16x16x32_bf16 v[66:69], v[102:105], v[198:201], v[66:69]
    ds_read_b128 v[98:101], v31 offset:11264
    global_load_dwordx4 v[242:245], v27, s[38:39] offset:-3072 sc1
    s_waitcnt lgkmcnt(4)
    v_mfma_f32_16x16x32_bf16 v[70:73], v[82:85], v[198:201], v[70:73]
    ds_read_b128 v[102:105], v31 offset:12288
    s_waitcnt lgkmcnt(4)
    v_mfma_f32_16x16x32_bf16 v[74:77], v[86:89], v[198:201], v[74:77]
    ds_read_b128 v[82:85], v31 offset:13312
    s_waitcnt lgkmcnt(4)
    v_mfma_f32_16x16x32_bf16 v[78:81], v[90:93], v[198:201], v[78:81]
    ds_read_b128 v[86:89], v31 offset:14336
    global_load_dwordx4 v[246:249], v27, s[38:39] offset:-2048 sc1
    s_waitcnt lgkmcnt(4)
    v_mfma_f32_16x16x32_bf16 v[62:65], v[94:97], v[202:205], v[62:65]
    ds_read_b128 v[90:93], v4 offset:10240
    s_waitcnt lgkmcnt(4)
    v_mfma_f32_16x16x32_bf16 v[66:69], v[98:101], v[202:205], v[66:69]
    ds_read_b128 v[94:97], v4 offset:11264
    s_waitcnt lgkmcnt(4)
    v_mfma_f32_16x16x32_bf16 v[70:73], v[102:105], v[202:205], v[70:73]
    ds_read_b128 v[98:101], v4 offset:12288
    global_load_dwordx4 v[250:253], v27, s[38:39] offset:-1024 sc1
    s_waitcnt lgkmcnt(4)
    v_mfma_f32_16x16x32_bf16 v[74:77], v[82:85], v[202:205], v[74:77]
    ds_read_b128 v[102:105], v4 offset:13312
    s_waitcnt lgkmcnt(4)
    v_mfma_f32_16x16x32_bf16 v[78:81], v[86:89], v[202:205], v[78:81]
    ds_read_b128 v[82:85], v4 offset:14336
    v_lshlrev_b32 v29, 5, v3
    v_add_u32 v29, 162816, v29
    ds_read_b128 v[106:109], v29 offset:0
    ds_read_b128 v[110:113], v29 offset:16
    ds_read_b128 v[114:117], v29 offset:128
    ds_read_b128 v[118:121], v29 offset:144
    v_lshlrev_b32 v29, 4, v3
    v_add_u32 v29, 162816, v29
    ds_read_b128 v[122:125], v29 offset:256
    v_lshlrev_b32 v126, 16, v36
    v_and_b32 v127, 0xffff0000, v36
    v_lshlrev_b32 v128, 16, v37
    v_and_b32 v129, 0xffff0000, v37
    v_lshlrev_b32 v130, 16, v38
    v_and_b32 v131, 0xffff0000, v38
    v_lshlrev_b32 v132, 16, v39
    v_and_b32 v133, 0xffff0000, v39
    v_lshlrev_b32 v134, 16, v40
    v_and_b32 v135, 0xffff0000, v40
    v_lshlrev_b32 v136, 16, v41
    v_and_b32 v137, 0xffff0000, v41
    v_lshlrev_b32 v138, 16, v42
    v_and_b32 v139, 0xffff0000, v42
    v_lshlrev_b32 v140, 16, v43
    v_and_b32 v141, 0xffff0000, v43
    v_lshlrev_b32 v12, 16, v44
    v_and_b32 v13, 0xffff0000, v44
    v_lshlrev_b32 v14, 16, v45
    v_and_b32 v15, 0xffff0000, v45
    v_add_u32 v46, s90, v5
    v_mul_u32_u24 v46, 1280, v46
    s_mul_i32 s4, s41, 160
    v_add_u32 v46, s4, v46
    v_lshl_add_u32 v47, v3, 4, v46
    v_lshl_add_u32 v46, v3, 3, v46
    s_waitcnt vmcnt(8)
    v_or3_b32 v28, v209, v213, v217
    s_waitcnt vmcnt(6)
    v_or3_b32 v28, v221, v225, v28
    s_waitcnt vmcnt(4)
    v_or3_b32 v28, v229, v233, v28
    v_and_b32 v28, 1, v28
    v_cmp_ne_u32 vcc, 0, v28
    s_nop 0
    s_cbranch_vccnz Lp2_r
Lp2_ok:
    s_waitcnt lgkmcnt(9)
    v_mfma_f32_16x16x32_bf16 v[62:65], v[90:93], v[206:209], v[62:65]
    ds_read_b128 v[86:89], v4 offset:30720
    s_waitcnt lgkmcnt(9)
    v_mfma_f32_16x16x32_bf16 v[66:69], v[94:97], v[206:209], v[66:69]
    ds_read_b128 v[90:93], v4 offset:31744
    s_waitcnt lgkmcnt(9)
    v_mfma_f32_16x16x32_bf16 v[70:73], v[98:101], v[206:209], v[70:73]
    ds_read_b128 v[94:97], v4 offset:32768
    s_waitcnt lgkmcnt(9)
    v_mfma_f32_16x16x32_bf16 v[74:77], v[102:105], v[206:209], v[74:77]
    ds_read_b128 v[98:101], v4 offset:33792
    s_waitcnt lgkmcnt(9)
    v_mfma_f32_16x16x32_bf16 v[78:81], v[82:85], v[206:209], v[78:81]
    ds_read_b128 v[102:105], v4 offset:34816
    s_waitcnt lgkmcnt(4)
    v_mfma_f32_16x16x32_bf16 v[62:65], v[86:89], v[210:213], v[62:65]
    ds_read_b128 v[82:85], v4 offset:46080
    s_waitcnt lgkmcnt(4)
    v_mfma_f32_16x16x32_bf16 v[66:69], v[90:93], v[210:213], v[66:69]
    ds_read_b128 v[86:89], v4 offset:47104
    s_waitcnt lgkmcnt(4)
    v_mfma_f32_16x16x32_bf16 v[70:73], v[94:97], v[210:213], v[70:73]
    ds_read_b128 v[90:93], v4 offset:48128
    s_waitcnt lgkmcnt(4)
    v_mfma_f32_16x16x32_bf16 v[74:77], v[98:101], v[210:213], v[74:77]
    ds_read_b128 v[94:97], v4 offset:49152
    s_waitcnt lgkmcnt(4)
    v_mfma_f32_16x16x32_bf16 v[78:81], v[102:105], v[210:213], v[78:81]
    ds_read_b128 v[98:101], v4 offset:50176
    s_waitcnt lgkmcnt(4)
    v_mfma_f32_16x16x32_bf16 v[62:65], v[82:85], v[214:217], v[62:65]
    ds_read_b128 v[102:105], v30 offset:5120
    s_waitcnt lgkmcnt(4)
    v_mfma_f32_16x16x32_bf16 v[66:69], v[86:89], v[214:217], v[66:69]
    ds_read_b128 v[82:85], v30 offset:6144
    s_waitcnt lgkmcnt(4)
    v_mfma_f32_16x16x32_bf16 v[70:73], v[90:93], v[214:217], v[70:73]
    ds_read_b128 v[86:89], v30 offset:7168
    s_waitcnt lgkmcnt(4)
    v_mfma_f32_16x16x32_bf16 v[74:77], v[94:97], v[214:217], v[74:77]
    ds_read_b128 v[90:93], v30 offset:8192
    s_waitcnt lgkmcnt(4)
    v_mfma_f32_16x16x32_bf16 v[78:81], v[98:101], v[214:217], v[78:81]
    ds_read_b128 v[94:97], v30 offset:9216
    s_waitcnt lgkmcnt(4)
    v_mfma_f32_16x16x32_bf16 v[62:65], v[102:105], v[218:221], v[62:65]
    ds_read_b128 v[98:101], v30 offset:20480
    s_waitcnt lgkmcnt(4)
    v_mfma_f32_16x16x32_bf16 v[66:69], v[82:85], v[218:221], v[66:69]
    ds_read_b128 v[102:105], v30 offset:21504
    s_waitcnt lgkmcnt(4)
    v_mfma_f32_16x16x32_bf16 v[70:73], v[86:89], v[218:221], v[70:73]
    ds_read_b128 v[82:85], v30 offset:22528
    s_waitcnt lgkmcnt(4)
    v_mfma_f32_16x16x32_bf16 v[74:77], v[90:93], v[218:221], v[74:77]
    ds_read_b128 v[86:89], v30 offset:23552
    s_waitcnt lgkmcnt(4)
    v_mfma_f32_16x16x32_bf16 v[78:81], v[94:97], v[218:221], v[78:81]
    ds_read_b128 v[90:93], v30 offset:24576
    s_waitcnt lgkmcnt(4)
    v_mfma_f32_16x16x32_bf16 v[62:65], v[98:101], v[222:225], v[62:65]
    ds_read_b128 v[94:97], v30 offset:40960
    s_waitcnt lgkmcnt(4)
    v_mfma_f32_16x16x32_bf16 v[66:69], v[102:105], v[222:225], v[66:69]
    ds_read_b128 v[98:101], v30 offset:41984
    s_waitcnt lgkmcnt(4)
    v_mfma_f32_16x16x32_bf16 v[70:73], v[82:85], v[222:225], v[70:73]
    ds_read_b128 v[102:105], v30 offset:43008
    s_waitcnt lgkmcnt(4)
    v_mfma_f32_16x16x32_bf16 v[74:77], v[86:89], v[222:225], v[74:77]
    ds_read_b128 v[82:85], v30 offset:44032
    s_waitcnt lgkmcnt(4)
    v_mfma_f32_16x16x32_bf16 v[78:81], v[90:93], v[222:225], v[78:81]
    ds_read_b128 v[86:89], v30 offset:45056
    s_waitcnt lgkmcnt(4)
    v_mfma_f32_16x16x32_bf16 v[62:65], v[94:97], v[226:229], v[62:65]
    ds_read_b128 v[90:93], v30 offset:56320
    s_waitcnt lgkmcnt(4)
    v_mfma_f32_16x16x32_bf16 v[66:69], v[98:101], v[226:229], v[66:69]
    ds_read_b128 v[94:97], v30 offset:57344
    s_waitcnt lgkmcnt(4)
    v_mfma_f32_16x16x32_bf16 v[70:73], v[102:105], v[226:229], v[70:73]
    ds_read_b128 v[98:101], v30 offset:58368
    s_waitcnt lgkmcnt(4)
    v_mfma_f32_16x16x32_bf16 v[74:77], v[82:85], v[226:229], v[74:77]
    ds_read_b128 v[102:105], v30 offset:59392
    s_waitcnt lgkmcnt(4)
    v_mfma_f32_16x16x32_bf16 v[78:81], v[86:89], v[226:229], v[78:81]
    ds_read_b128 v[82:85], v30 offset:60416
    s_waitcnt lgkmcnt(4)
    v_mfma_f32_16x16x32_bf16 v[62:65], v[90:93], v[230:233], v[62:65]
    ds_read_b128 v[86:89], v4 offset:15360
    s_waitcnt lgkmcnt(4)
    v_mfma_f32_16x16x32_bf16 v[66:69], v[94:97], v[230:233], v[66:69]
    ds_read_b128 v[90:93], v4 offset:16384
    s_waitcnt lgkmcnt(4)
    v_mfma_f32_16x16x32_bf16 v[70:73], v[98:101], v[230:233], v[70:73]
    ds_read_b128 v[94:97], v4 offset:17408
    s_waitcnt lgkmcnt(4)
    v_mfma_f32_16x16x32_bf16 v[74:77], v[102:105], v[230:233], v[74:77]
    ds_read_b128 v[98:101], v4 offset:18432
    s_waitcnt lgkmcnt(4)
    v_mfma_f32_16x16x32_bf16 v[78:81], v[82:85], v[230:233], v[78:81]
    ds_read_b128 v[102:105], v4 offset:19456
    s_waitcnt vmcnt(3)
    v_or_b32 v28, v239, v241
    s_waitcnt vmcnt(2)
    v_or3_b32 v28, v243, v245, v28
    s_waitcnt vmcnt(1)
    v_or3_b32 v28, v247, v249, v28
    s_waitcnt vmcnt(0)
    v_or3_b32 v28, v251, v253, v28
    v_and_b32 v28, 1, v28
    v_cmp_ne_u32 vcc, 0, v28
    s_nop 0
    s_cbranch_vccnz Lp3_r
Lp3_ok:
    s_waitcnt lgkmcnt(4)
    v_mfma_f32_16x16x32_bf16 v[62:65], v[86:89], v[238:241], v[62:65]
    ds_read_b128 v[82:85], v4 offset:51200
    s_waitcnt lgkmcnt(4)
    v_mfma_f32_16x16x32_bf16 v[66:69], v[90:93], v[238:241], v[66:69]
    ds_read_b128 v[86:89], v4 offset:52224
    s_waitcnt lgkmcnt(4)
    v_mfma_f32_16x16x32_bf16 v[70:73], v[94:97], v[238:241], v[70:73]
    ds_read_b128 v[90:93], v4 offset:53248
    s_waitcnt lgkmcnt(4)
    v_mfma_f32_16x16x32_bf16 v[74:77], v[98:101], v[238:241], v[74:77]
    ds_read_b128 v[94:97], v4 offset:54272
    s_waitcnt lgkmcnt(4)
    v_mfma_f32_16x16x32_bf16 v[78:81], v[102:105], v[238:241], v[78:81]
    ds_read_b128 v[98:101], v4 offset:55296
    s_waitcnt lgkmcnt(4)
    v_mfma_f32_16x16x32_bf16 v[62:65], v[82:85], v[242:245], v[62:65]
    ds_read_b128 v[102:105], v30 offset:25600
    s_waitcnt lgkmcnt(4)
    v_mfma_f32_16x16x32_bf16 v[66:69], v[86:89], v[242:245], v[66:69]
    ds_read_b128 v[82:85], v30 offset:26624
    s_waitcnt lgkmcnt(4)
    v_mfma_f32_16x16x32_bf16 v[70:73], v[90:93], v[242:245], v[70:73]
    ds_read_b128 v[86:89], v30 offset:27648
    s_waitcnt lgkmcnt(4)
    v_mfma_f32_16x16x32_bf16 v[74:77], v[94:97], v[242:245], v[74:77]
    ds_read_b128 v[90:93], v30 offset:28672
    s_waitcnt lgkmcnt(4)
    v_mfma_f32_16x16x32_bf16 v[78:81], v[98:101], v[242:245], v[78:81]
    ds_read_b128 v[94:97], v30 offset:29696
    s_waitcnt lgkmcnt(4)
    v_mfma_f32_16x16x32_bf16 v[62:65], v[102:105], v[246:249], v[62:65]
    ds_read_b128 v[98:101], v31 offset:0
    s_waitcnt lgkmcnt(4)
    v_mfma_f32_16x16x32_bf16 v[66:69], v[82:85], v[246:249], v[66:69]
    ds_read_b128 v[102:105], v31 offset:1024
    s_waitcnt lgkmcnt(4)
    v_mfma_f32_16x16x32_bf16 v[70:73], v[86:89], v[246:249], v[70:73]
    ds_read_b128 v[82:85], v31 offset:2048
    s_waitcnt lgkmcnt(4)
    v_mfma_f32_16x16x32_bf16 v[74:77], v[90:93], v[246:249], v[74:77]
    ds_read_b128 v[86:89], v31 offset:3072
    s_waitcnt lgkmcnt(4)
    v_mfma_f32_16x16x32_bf16 v[78:81], v[94:97], v[246:249], v[78:81]
    ds_read_b128 v[90:93], v31 offset:4096
    s_waitcnt lgkmcnt(4)
    v_mfma_f32_16x16x32_bf16 v[62:65], v[98:101], v[250:253], v[62:65]
    s_waitcnt lgkmcnt(3)
    v_mfma_f32_16x16x32_bf16 v[66:69], v[102:105], v[250:253], v[66:69]
    s_waitcnt lgkmcnt(2)
    v_mfma_f32_16x16x32_bf16 v[70:73], v[82:85], v[250:253], v[70:73]
    s_waitcnt lgkmcnt(1)
    v_mfma_f32_16x16x32_bf16 v[74:77], v[86:89], v[250:253], v[74:77]
    s_waitcnt lgkmcnt(0)
    v_mfma_f32_16x16x32_bf16 v[78:81], v[90:93], v[250:253], v[78:81]
    v_fmac_f32 v126, v62, v106
    s_nop 0
    v_fmac_f32 v127, v66, v107
    v_fmac_f32 v128, v63, v108
    v_fmac_f32 v129, v67, v109
    v_fmac_f32 v130, v64, v110
    v_fmac_f32 v131, v68, v111
    v_fmac_f32 v132, v65, v112
    v_fmac_f32 v133, v69, v113
    v_cvt_pk_bf16_f32 v142, v126, v127
    v_cvt_pk_bf16_f32 v143, v128, v129
    v_cvt_pk_bf16_f32 v144, v130, v131
    v_cvt_pk_bf16_f32 v145, v132, v133
    global_store_dwordx4 v47, v[142:145], s[34:35] offset:0
    v_fmac_f32 v134, v70, v114
    v_fmac_f32 v135, v74, v115
    v_fmac_f32 v136, v71, v116
    v_fmac_f32 v137, v75, v117
    v_fmac_f32 v138, v72, v118
    v_fmac_f32 v139, v76, v119
    v_fmac_f32 v140, v73, v120
    v_fmac_f32 v141, v77, v121
    v_cvt_pk_bf16_f32 v146, v134, v135
    v_cvt_pk_bf16_f32 v147, v136, v137
    v_cvt_pk_bf16_f32 v148, v138, v139
    v_cvt_pk_bf16_f32 v149, v140, v141
    global_store_dwordx4 v47, v[146:149], s[34:35] offset:64
    v_fmac_f32 v12, v78, v122
    v_fmac_f32 v13, v79, v123
    v_fmac_f32 v14, v80, v124
    v_fmac_f32 v15, v81, v125
    v_cvt_pk_bf16_f32 v150, v12, v13
    v_cvt_pk_bf16_f32 v151, v14, v15
    global_store_dwordx2 v46, v[150:151], s[34:35] offset:128
Lflush:
Lend:
    s_endpgm
Lspare:
    s_sub_u32 s42, s2, 160
    s_cmp_lt_u32 s42, 54
    s_cbranch_scc0 Lsp_b
    s_cmp_ge_u32 s42, 8
    s_cbranch_scc1 Lsp_a2
    s_mov_b32 s48, s42
    v_mov_b32 v8, -1
    v_mov_b32 v9, -1
    v_mov_b32 v10, -1
    v_mov_b32 v11, -1
    s_mul_i32 s4, s48, 9216
    s_mul_i32 s5, s3, 2304
    s_add_u32 s4, s4, s5
    s_add_u32 s4, s4, 32768
    v_add_u32 v6, s4, v4
    global_store_dwordx4 v6, v[8:11], s[38:39] offset:0 sc1
    global_store_dwordx4 v6, v[8:11], s[38:39] offset:1024 sc1
    global_store_dwordx4 v6, v[8:11], s[38:39] offset:1280 sc1
    s_lshl_b32 s4, s48, 1
    s_add_u32 s4, s4, 112
    v_mov_b32 v6, s4
    s_waitcnt vmcnt(0)
    s_barrier
    s_cmp_lg_u32 s3, 0
    s_cbranch_scc1 Linit_skip
    global_store_short v6, v8, s[36:37] sc1
Linit_skip:
    s_branch Lsp_a2
Lsp_b:
    s_sub_u32 s48, s42, 54
    s_add_u32 s49, s48, 42
    s_add_u32 s50, s48, 84
    s_cmp_ge_u32 s50, 120
    s_cselect_b32 s50, s49, s50
    s_cmp_eq_u32 s3, 1
    s_cselect_b32 s51, s49, s48
    s_cmp_eq_u32 s3, 2
    s_cselect_b32 s51, s50, s51
    s_lshr_b32 s4, s51, 1
    s_and_b32 s5, s51, 1
    s_cmp_lt_u32 s4, 50
    s_cselect_b32 s6, -20, 0
    s_cmp_lt_u32 s4, 20
    s_cselect_b32 s6, 30, s6
    s_add_u32 s4, s4, s6
    s_mul_i32 s6, s5, 15360
    s_lshl_b32 s7, s4, 8
    s_add_u32 s51, s6, s7
    v_lshl_add_u32 v164, v1, 2, s51
    v_mov_b32 v165, -1
    global_store_dword v164, v165, s[38:39] offset:0 sc1
    s_lshr_b32 s4, s48, 1
    s_and_b32 s5, s48, 1
    s_cmp_lt_u32 s4, 50
    s_cselect_b32 s6, -20, 0
    s_cmp_lt_u32 s4, 20
    s_cselect_b32 s6, 30, s6
    s_add_u32 s4, s4, s6
    s_mul_i32 s6, s5, 15360
    s_lshl_b32 s7, s4, 8
    s_add_u32 s44, s6, s7
    s_lshl_b32 s5, s5, 2
    s_add_u32 s5, s5, s3
    s_mul_i32 s5, s5, 80
    s_lshl_b32 s4, s4, 7
    s_mul_i32 s6, s5, 7680
    s_add_u32 s4, s4, s6
    v_min_u32 v28, 39, v1
    s_lshl_b32 s5, s5, 1
    v_lshl_add_u32 v28, v28, 2, s5
    global_load_dword v80, v28, s[30:31]
    v_lshrrev_b32 v29, 3, v1
    v_mul_u32_u24 v28, 15232, v29
    v_add3_u32 v28, v28, v4, s4
    global_load_dwordx4 v[40:43], v28, s[32:33] nt
    v_add_u32 v28, 7680, v28
    global_load_dwordx4 v[44:47], v28, s[32:33] nt
    v_add_u32 v28, 115200, v28
    global_load_dwordx4 v[48:51], v28, s[32:33] nt
    v_add_u32 v28, 7680, v28
    global_load_dwordx4 v[52:55], v28, s[32:33] nt
    v_add_u32 v28, 115200, v28
    global_load_dwordx4 v[56:59], v28, s[32:33] nt
    v_add_u32 v28, 7680, v28
    global_load_dwordx4 v[60:63], v28, s[32:33] nt
    v_add_u32 v28, 115200, v28
    global_load_dwordx4 v[64:67], v28, s[32:33] nt
    v_add_u32 v28, 7680, v28
    global_load_dwordx4 v[68:71], v28, s[32:33] nt
    v_add_u32 v28, 115200, v28
    global_load_dwordx4 v[72:75], v28, s[32:33] nt
    v_add_u32 v28, 7680, v28
    global_load_dwordx4 v[76:79], v28, s[32:33] nt
    s_lshl_b32 s4, s48, 1
    s_add_u32 s4, s4, 128
    v_mov_b32 v164, s4
    s_waitcnt vmcnt(10)
    s_barrier
    s_cmp_lg_u32 s3, 0
    s_cbranch_scc1 Lsb_skip
    global_store_short v164, v165, s[36:37] sc1
Lsb_skip:
    s_lshr_b32 s4, s49, 1
    s_and_b32 s5, s49, 1
    s_cmp_lt_u32 s4, 50
    s_cselect_b32 s6, -20, 0
    s_cmp_lt_u32 s4, 20
    s_cselect_b32 s6, 30, s6
    s_add_u32 s4, s4, s6
    s_mul_i32 s6, s5, 15360
    s_lshl_b32 s7, s4, 8
    s_add_u32 s45, s6, s7
    s_lshl_b32 s5, s5, 2
    s_add_u32 s5, s5, s3
    s_mul_i32 s5, s5, 80
    s_lshl_b32 s4, s4, 7
    s_mul_i32 s6, s5, 7680
    s_add_u32 s4, s4, s6
    v_min_u32 v96, 39, v1
    s_lshl_b32 s5, s5, 1
    v_lshl_add_u32 v96, v96, 2, s5
    global_load_dword v148, v96, s[30:31]
    v_lshrrev_b32 v97, 3, v1
    v_mul_u32_u24 v96, 15232, v97
    v_add3_u32 v96, v96, v4, s4
    global_load_dwordx4 v[108:111], v96, s[32:33] nt
    v_add_u32 v96, 7680, v96
    global_load_dwordx4 v[112:115], v96, s[32:33] nt
    v_add_u32 v96, 115200, v96
    global_load_dwordx4 v[116:119], v96, s[32:33] nt
    v_add_u32 v96, 7680, v96
    global_load_dwordx4 v[120:123], v96, s[32:33] nt
    v_add_u32 v96, 115200, v96
    global_load_dwordx4 v[124:127], v96, s[32:33] nt
    v_add_u32 v96, 7680, v96
    global_load_dwordx4 v[128:131], v96, s[32:33] nt
    v_add_u32 v96, 115200, v96
    v_lshlrev_b32 v82, 16, v80
    v_and_b32 v83, 0xffff0000, v80
    v_lshlrev_b32 v29, 2, v29
    v_mul_f32 v84, 0xbfb8aa3b, v82
    v_mul_f32 v85, 0xbfb8aa3b, v83
    v_exp_f32 v84, v84
    v_exp_f32 v85, v85
    v_add_f32 v84, 1.0, v84
    v_add_f32 v85, 1.0, v85
    v_rcp_f32 v84, v84
    v_rcp_f32 v85, v85
    v_mul_f32 v82, v82, v84
    v_mul_f32 v83, v83, v85
    v_cvt_pk_bf16_f32 v80, v82, v83
    ds_bpermute_b32 v88, v29, v80 offset:0
    ds_bpermute_b32 v89, v29, v80 offset:32
    ds_bpermute_b32 v90, v29, v80 offset:64
    ds_bpermute_b32 v91, v29, v80 offset:96
    ds_bpermute_b32 v92, v29, v80 offset:128
    s_waitcnt lgkmcnt(4)
    v_lshlrev_b32 v30, 16, v88
    v_and_b32 v31, 0xffff0000, v88
    s_waitcnt lgkmcnt(3)
    v_lshlrev_b32 v32, 16, v89
    v_and_b32 v33, 0xffff0000, v89
    s_waitcnt lgkmcnt(2)
    v_lshlrev_b32 v34, 16, v90
    v_and_b32 v35, 0xffff0000, v90
    s_waitcnt lgkmcnt(1)
    v_lshlrev_b32 v36, 16, v91
    v_and_b32 v37, 0xffff0000, v91
    s_waitcnt lgkmcnt(0)
    v_lshlrev_b32 v38, 16, v92
    v_and_b32 v39, 0xffff0000, v92
    s_waitcnt vmcnt(16)
    v_lshlrev_b32 v80, 16, v40
    v_and_b32 v81, 0xffff0000, v40
    v_lshlrev_b32 v82, 16, v41
    v_and_b32 v83, 0xffff0000, v41
    v_lshlrev_b32 v84, 16, v42
    v_and_b32 v85, 0xffff0000, v42
    v_lshlrev_b32 v86, 16, v43
    v_and_b32 v87, 0xffff0000, v43
    v_pk_mul_f32 v[88:89], v[30:31], v[80:81] op_sel:[0,0] op_sel_hi:[0,1]
    v_pk_mul_f32 v[90:91], v[30:31], v[82:83] op_sel:[0,0] op_sel_hi:[0,1]
    v_pk_mul_f32 v[92:93], v[30:31], v[84:85] op_sel:[0,0] op_sel_hi:[0,1]
    v_pk_mul_f32 v[94:95], v[30:31], v[86:87] op_sel:[0,0] op_sel_hi:[0,1]
    s_waitcnt vmcnt(15)
    v_lshlrev_b32 v80, 16, v44
    v_and_b32 v81, 0xffff0000, v44
    v_lshlrev_b32 v82, 16, v45
    v_and_b32 v83, 0xffff0000, v45
    v_lshlrev_b32 v84, 16, v46
    v_and_b32 v85, 0xffff0000, v46
    v_lshlrev_b32 v86, 16, v47
    v_and_b32 v87, 0xffff0000, v47
    v_pk_fma_f32 v[88:89], v[30:31], v[80:81], v[88:89] op_sel:[1,0,0] op_sel_hi:[1,1,1]
    v_pk_fma_f32 v[90:91], v[30:31], v[82:83], v[90:91] op_sel:[1,0,0] op_sel_hi:[1,1,1]
    v_pk_fma_f32 v[92:93], v[30:31], v[84:85], v[92:93] op_sel:[1,0,0] op_sel_hi:[1,1,1]
    v_pk_fma_f32 v[94:95], v[30:31], v[86:87], v[94:95] op_sel:[1,0,0] op_sel_hi:[1,1,1]
    s_waitcnt vmcnt(14)
    v_lshlrev_b32 v80, 16, v48
    v_and_b32 v81, 0xffff0000, v48
    v_lshlrev_b32 v82, 16, v49
    v_and_b32 v83, 0xffff0000, v49
    v_lshlrev_b32 v84, 16, v50
    v_and_b32 v85, 0xffff0000, v50
    v_lshlrev_b32 v86, 16, v51
    v_and_b32 v87, 0xffff0000, v51
    v_pk_fma_f32 v[88:89], v[32:33], v[80:81], v[88:89] op_sel:[0,0,0] op_sel_hi:[0,1,1]
    v_pk_fma_f32 v[90:91], v[32:33], v[82:83], v[90:91] op_sel:[0,0,0] op_sel_hi:[0,1,1]
    v_pk_fma_f32 v[92:93], v[32:33], v[84:85], v[92:93] op_sel:[0,0,0] op_sel_hi:[0,1,1]
    v_pk_fma_f32 v[94:95], v[32:33], v[86:87], v[94:95] op_sel:[0,0,0] op_sel_hi:[0,1,1]
    s_waitcnt vmcnt(13)
    v_lshlrev_b32 v80, 16, v52
    v_and_b32 v81, 0xffff0000, v52
    v_lshlrev_b32 v82, 16, v53
    v_and_b32 v83, 0xffff0000, v53
    v_lshlrev_b32 v84, 16, v54
    v_and_b32 v85, 0xffff0000, v54
    v_lshlrev_b32 v86, 16, v55
    v_and_b32 v87, 0xffff0000, v55
    v_pk_fma_f32 v[88:89], v[32:33], v[80:81], v[88:89] op_sel:[1,0,0] op_sel_hi:[1,1,1]
    v_pk_fma_f32 v[90:91], v[32:33], v[82:83], v[90:91] op_sel:[1,0,0] op_sel_hi:[1,1,1]
    v_pk_fma_f32 v[92:93], v[32:33], v[84:85], v[92:93] op_sel:[1,0,0] op_sel_hi:[1,1,1]
    v_pk_fma_f32 v[94:95], v[32:33], v[86:87], v[94:95] op_sel:[1,0,0] op_sel_hi:[1,1,1]
    s_waitcnt vmcnt(12)
    v_lshlrev_b32 v80, 16, v56
    v_and_b32 v81, 0xffff0000, v56
    v_lshlrev_b32 v82, 16, v57
    v_and_b32 v83, 0xffff0000, v57
    v_lshlrev_b32 v84, 16, v58
    v_and_b32 v85, 0xffff0000, v58
    v_lshlrev_b32 v86, 16, v59
    v_and_b32 v87, 0xffff0000, v59
    v_pk_fma_f32 v[88:89], v[34:35], v[80:81], v[88:89] op_sel:[0,0,0] op_sel_hi:[0,1,1]
    v_pk_fma_f32 v[90:91], v[34:35], v[82:83], v[90:91] op_sel:[0,0,0] op_sel_hi:[0,1,1]
    v_pk_fma_f32 v[92:93], v[34:35], v[84:85], v[92:93] op_sel:[0,0,0] op_sel_hi:[0,1,1]
    v_pk_fma_f32 v[94:95], v[34:35], v[86:87], v[94:95] op_sel:[0,0,0] op_sel_hi:[0,1,1]
    s_waitcnt vmcnt(11)
    v_lshlrev_b32 v80, 16, v60
    v_and_b32 v81, 0xffff0000, v60
    v_lshlrev_b32 v82, 16, v61
    v_and_b32 v83, 0xffff0000, v61
    v_lshlrev_b32 v84, 16, v62
    v_and_b32 v85, 0xffff0000, v62
    v_lshlrev_b32 v86, 16, v63
    v_and_b32 v87, 0xffff0000, v63
    v_pk_fma_f32 v[88:89], v[34:35], v[80:81], v[88:89] op_sel:[1,0,0] op_sel_hi:[1,1,1]
    v_pk_fma_f32 v[90:91], v[34:35], v[82:83], v[90:91] op_sel:[1,0,0] op_sel_hi:[1,1,1]
    v_pk_fma_f32 v[92:93], v[34:35], v[84:85], v[92:93] op_sel:[1,0,0] op_sel_hi:[1,1,1]
    v_pk_fma_f32 v[94:95], v[34:35], v[86:87], v[94:95] op_sel:[1,0,0] op_sel_hi:[1,1,1]
    s_waitcnt vmcnt(10)
    v_lshlrev_b32 v80, 16, v64
    v_and_b32 v81, 0xffff0000, v64
    v_lshlrev_b32 v82, 16, v65
    v_and_b32 v83, 0xffff0000, v65
    v_lshlrev_b32 v84, 16, v66
    v_and_b32 v85, 0xffff0000, v66
    v_lshlrev_b32 v86, 16, v67
    v_and_b32 v87, 0xffff0000, v67
    v_pk_fma_f32 v[88:89], v[36:37], v[80:81], v[88:89] op_sel:[0,0,0] op_sel_hi:[0,1,1]
    v_pk_fma_f32 v[90:91], v[36:37], v[82:83], v[90:91] op_sel:[0,0,0] op_sel_hi:[0,1,1]
    v_pk_fma_f32 v[92:93], v[36:37], v[84:85], v[92:93] op_sel:[0,0,0] op_sel_hi:[0,1,1]
    v_pk_fma_f32 v[94:95], v[36:37], v[86:87], v[94:95] op_sel:[0,0,0] op_sel_hi:[0,1,1]
    s_waitcnt vmcnt(9)
    v_lshlrev_b32 v80, 16, v68
    v_and_b32 v81, 0xffff0000, v68
    v_lshlrev_b32 v82, 16, v69
    v_and_b32 v83, 0xffff0000, v69
    v_lshlrev_b32 v84, 16, v70
    v_and_b32 v85, 0xffff0000, v70
    v_lshlrev_b32 v86, 16, v71
    v_and_b32 v87, 0xffff0000, v71
    v_pk_fma_f32 v[88:89], v[36:37], v[80:81], v[88:89] op_sel:[1,0,0] op_sel_hi:[1,1,1]
    v_pk_fma_f32 v[90:91], v[36:37], v[82:83], v[90:91] op_sel:[1,0,0] op_sel_hi:[1,1,1]
    v_pk_fma_f32 v[92:93], v[36:37], v[84:85], v[92:93] op_sel:[1,0,0] op_sel_hi:[1,1,1]
    v_pk_fma_f32 v[94:95], v[36:37], v[86:87], v[94:95] op_sel:[1,0,0] op_sel_hi:[1,1,1]
    s_waitcnt vmcnt(8)
    v_lshlrev_b32 v80, 16, v72
    v_and_b32 v81, 0xffff0000, v72
    v_lshlrev_b32 v82, 16, v73
    v_and_b32 v83, 0xffff0000, v73
    v_lshlrev_b32 v84, 16, v74
    v_and_b32 v85, 0xffff0000, v74
    v_lshlrev_b32 v86, 16, v75
    v_and_b32 v87, 0xffff0000, v75
    v_pk_fma_f32 v[88:89], v[38:39], v[80:81], v[88:89] op_sel:[0,0,0] op_sel_hi:[0,1,1]
    v_pk_fma_f32 v[90:91], v[38:39], v[82:83], v[90:91] op_sel:[0,0,0] op_sel_hi:[0,1,1]
    v_pk_fma_f32 v[92:93], v[38:39], v[84:85], v[92:93] op_sel:[0,0,0] op_sel_hi:[0,1,1]
    v_pk_fma_f32 v[94:95], v[38:39], v[86:87], v[94:95] op_sel:[0,0,0] op_sel_hi:[0,1,1]
    s_waitcnt vmcnt(7)
    v_lshlrev_b32 v80, 16, v76
    v_and_b32 v81, 0xffff0000, v76
    v_lshlrev_b32 v82, 16, v77
    v_and_b32 v83, 0xffff0000, v77
    v_lshlrev_b32 v84, 16, v78
    v_and_b32 v85, 0xffff0000, v78
    v_lshlrev_b32 v86, 16, v79
    v_and_b32 v87, 0xffff0000, v79
    v_pk_fma_f32 v[88:89], v[38:39], v[80:81], v[88:89] op_sel:[1,0,0] op_sel_hi:[1,1,1]
    v_pk_fma_f32 v[90:91], v[38:39], v[82:83], v[90:91] op_sel:[1,0,0] op_sel_hi:[1,1,1]
    v_pk_fma_f32 v[92:93], v[38:39], v[84:85], v[92:93] op_sel:[1,0,0] op_sel_hi:[1,1,1]
    v_pk_fma_f32 v[94:95], v[38:39], v[86:87], v[94:95] op_sel:[1,0,0] op_sel_hi:[1,1,1]
    s_nop 0
    v_permlane32_swap_b32 v88, v92
    v_permlane32_swap_b32 v89, v93
    v_permlane32_swap_b32 v90, v94
    v_permlane32_swap_b32 v91, v95
    v_add_f32 v88, v88, v92
    v_add_f32 v89, v89, v93
    v_add_f32 v90, v90, v94
    v_add_f32 v91, v91, v95
    s_nop 0
    v_permlane16_swap_b32 v88, v90
    v_permlane16_swap_b32 v89, v91
    v_add_f32 v88, v88, v90
    v_add_f32 v89, v89, v91
    v_and_b32 v81, 7, v1
    v_lshrrev_b32 v82, 3, v1
    v_add_f32_dpp v80, v88, v88 row_ror:8 row_mask:0xf bank_mask:0x3
    s_nop 1
    v_add_f32_dpp v80, v89, v89 row_ror:8 row_mask:0xf bank_mask:0xc
    v_lshl_add_u32 v81, v81, 3, v82
    s_lshl_b32 s7, s3, 8
    s_add_u32 s7, s7, 122880
    v_lshl_add_u32 v81, v81, 2, s7
    ds_write_b32 v81, v80
    s_waitcnt lgkmcnt(0)
    s_barrier
    v_lshlrev_b32 v81, 2, v1
    v_add_u32 v82, 122880, v81
    ds_read_b32 v88, v82 offset:0
    ds_read_b32 v89, v82 offset:256
    ds_read_b32 v90, v82 offset:512
    ds_read_b32 v91, v82 offset:768
    v_add_u32 v81, s44, v81
    s_waitcnt lgkmcnt(2)
    v_add_f32 v88, v88, v89
    s_waitcnt lgkmcnt(0)
    v_add_f32 v90, v90, v91
    v_add_f32 v88, v88, v90
    v_min_u32 v88, -2, v88
    s_cmp_lg_u32 s3, 0
    s_cbranch_scc1 Lmod_skip_s1
    global_store_dword v81, v88, s[38:39] offset:0 sc1
Lmod_skip_s1:
    global_load_dwordx4 v[132:135], v96, s[32:33] nt
    v_add_u32 v96, 7680, v96
    global_load_dwordx4 v[136:139], v96, s[32:33] nt
    v_add_u32 v96, 115200, v96
    global_load_dwordx4 v[140:143], v96, s[32:33] nt
    v_add_u32 v96, 7680, v96
    global_load_dwordx4 v[144:147], v96, s[32:33] nt
    s_cmp_ge_u32 s48, 27
    s_cbranch_scc1 Lsb_n3
    s_mul_i32 s4, s48, 40960
    s_mul_i32 s5, s3, 10240
    s_add_u32 s4, s4, s5
    v_lshl_add_u32 v164, v1, 4, s4
    s_add_u32 m0, s5, 0
    s_nop 0
    global_load_lds_dwordx4 v164, s[28:29] offset:0 nt
    global_load_lds_dwordx4 v164, s[28:29] offset:1024 nt
    global_load_lds_dwordx4 v164, s[28:29] offset:2048 nt
    global_load_lds_dwordx4 v164, s[28:29] offset:3072 nt
    s_add_u32 m0, s5, 4096
    v_add_u32 v164, 4096, v164
    global_load_lds_dwordx4 v164, s[28:29] offset:0 nt
    global_load_lds_dwordx4 v164, s[28:29] offset:1024 nt
    global_load_lds_dwordx4 v164, s[28:29] offset:2048 nt
    global_load_lds_dwordx4 v164, s[28:29] offset:3072 nt
    s_add_u32 m0, s5, 8192
    v_add_u32 v164, 4096, v164
    global_load_lds_dwordx4 v164, s[28:29] offset:0 nt
    global_load_lds_dwordx4 v164, s[28:29] offset:1024 nt
    s_waitcnt vmcnt(10)
    s_branch Lsb_n4
Lsb_n3:
    s_add_u32 s50, s48, 78
    s_lshr_b32 s4, s50, 1
    s_and_b32 s5, s50, 1
    s_cmp_lt_u32 s4, 50
    s_cselect_b32 s6, -20, 0
    s_cmp_lt_u32 s4, 20
    s_cselect_b32 s6, 30, s6
    s_add_u32 s4, s4, s6
    s_mul_i32 s6, s5, 15360
    s_lshl_b32 s7, s4, 8
    s_add_u32 s44, s6, s7
    s_lshl_b32 s5, s5, 2
    s_add_u32 s5, s5, s3
    s_mul_i32 s5, s5, 80
    s_lshl_b32 s4, s4, 7
    s_mul_i32 s6, s5, 7680
    s_add_u32 s4, s4, s6
    v_min_u32 v28, 39, v1
    s_lshl_b32 s5, s5, 1
    v_lshl_add_u32 v28, v28, 2, s5
    global_load_dword v80, v28, s[30:31]
    v_lshrrev_b32 v29, 3, v1
    v_mul_u32_u24 v28, 15232, v29
    v_add3_u32 v28, v28, v4, s4
    global_load_dwordx4 v[40:43], v28, s[32:33] nt
    v_add_u32 v28, 7680, v28
    global_load_dwordx4 v[44:47], v28, s[32:33] nt
    v_add_u32 v28, 115200, v28
    global_load_dwordx4 v[48:51], v28, s[32:33] nt
    v_add_u32 v28, 7680, v28
    global_load_dwordx4 v[52:55], v28, s[32:33] nt
    v_add_u32 v28, 115200, v28
    global_load_dwordx4 v[56:59], v28, s[32:33] nt
    v_add_u32 v28, 7680, v28
    global_load_dwordx4 v[60:63], v28, s[32:33] nt
    v_add_u32 v28, 115200, v28
    global_load_dwordx4 v[64:67], v28, s[32:33] nt
    v_add_u32 v28, 7680, v28
    global_load_dwordx4 v[68:71], v28, s[32:33] nt
    v_add_u32 v28, 115200, v28
    global_load_dwordx4 v[72:75], v28, s[32:33] nt
    v_add_u32 v28, 7680, v28
    global_load_dwordx4 v[76:79], v28, s[32:33] nt
    s_waitcnt vmcnt(11)
Lsb_n4:
    v_lshlrev_b32 v150, 16, v148
    v_and_b32 v151, 0xffff0000, v148
    v_lshlrev_b32 v97, 2, v97
    v_mul_f32 v152, 0xbfb8aa3b, v150
    v_mul_f32 v153, 0xbfb8aa3b, v151
    v_exp_f32 v152, v152
    v_exp_f32 v153, v153
    v_add_f32 v152, 1.0, v152
    v_add_f32 v153, 1.0, v153
    v_rcp_f32 v152, v152
    v_rcp_f32 v153, v153
    v_mul_f32 v150, v150, v152
    v_mul_f32 v151, v151, v153
    v_cvt_pk_bf16_f32 v148, v150, v151
    ds_bpermute_b32 v156, v97, v148 offset:0
    ds_bpermute_b32 v157, v97, v148 offset:32
    ds_bpermute_b32 v158, v97, v148 offset:64
    ds_bpermute_b32 v159, v97, v148 offset:96
    ds_bpermute_b32 v160, v97, v148 offset:128
    s_waitcnt lgkmcnt(4)
    v_lshlrev_b32 v98, 16, v156
    v_and_b32 v99, 0xffff0000, v156
    s_waitcnt lgkmcnt(3)
    v_lshlrev_b32 v100, 16, v157
    v_and_b32 v101, 0xffff0000, v157
    s_waitcnt lgkmcnt(2)
    v_lshlrev_b32 v102, 16, v158
    v_and_b32 v103, 0xffff0000, v158
    s_waitcnt lgkmcnt(1)
    v_lshlrev_b32 v104, 16, v159
    v_and_b32 v105, 0xffff0000, v159
    s_waitcnt lgkmcnt(0)
    v_lshlrev_b32 v106, 16, v160
    v_and_b32 v107, 0xffff0000, v160
    v_lshlrev_b32 v148, 16, v108
    v_and_b32 v149, 0xffff0000, v108
    v_lshlrev_b32 v150, 16, v109
    v_and_b32 v151, 0xffff0000, v109
    v_lshlrev_b32 v152, 16, v110
    v_and_b32 v153, 0xffff0000, v110
    v_lshlrev_b32 v154, 16, v111
    v_and_b32 v155, 0xffff0000, v111
    v_pk_mul_f32 v[156:157], v[98:99], v[148:149] op_sel:[0,0] op_sel_hi:[0,1]
    v_pk_mul_f32 v[158:159], v[98:99], v[150:151] op_sel:[0,0] op_sel_hi:[0,1]
    v_pk_mul_f32 v[160:161], v[98:99], v[152:153] op_sel:[0,0] op_sel_hi:[0,1]
    v_pk_mul_f32 v[162:163], v[98:99], v[154:155] op_sel:[0,0] op_sel_hi:[0,1]
    v_lshlrev_b32 v148, 16, v112
    v_and_b32 v149, 0xffff0000, v112
    v_lshlrev_b32 v150, 16, v113
    v_and_b32 v151, 0xffff0000, v113
    v_lshlrev_b32 v152, 16, v114
    v_and_b32 v153, 0xffff0000, v114
    v_lshlrev_b32 v154, 16, v115
    v_and_b32 v155, 0xffff0000, v115
    v_pk_fma_f32 v[156:157], v[98:99], v[148:149], v[156:157] op_sel:[1,0,0] op_sel_hi:[1,1,1]
    v_pk_fma_f32 v[158:159], v[98:99], v[150:151], v[158:159] op_sel:[1,0,0] op_sel_hi:[1,1,1]
    v_pk_fma_f32 v[160:161], v[98:99], v[152:153], v[160:161] op_sel:[1,0,0] op_sel_hi:[1,1,1]
    v_pk_fma_f32 v[162:163], v[98:99], v[154:155], v[162:163] op_sel:[1,0,0] op_sel_hi:[1,1,1]
    v_lshlrev_b32 v148, 16, v116
    v_and_b32 v149, 0xffff0000, v116
    v_lshlrev_b32 v150, 16, v117
    v_and_b32 v151, 0xffff0000, v117
    v_lshlrev_b32 v152, 16, v118
    v_and_b32 v153, 0xffff0000, v118
    v_lshlrev_b32 v154, 16, v119
    v_and_b32 v155, 0xffff0000, v119
    v_pk_fma_f32 v[156:157], v[100:101], v[148:149], v[156:157] op_sel:[0,0,0] op_sel_hi:[0,1,1]
    v_pk_fma_f32 v[158:159], v[100:101], v[150:151], v[158:159] op_sel:[0,0,0] op_sel_hi:[0,1,1]
    v_pk_fma_f32 v[160:161], v[100:101], v[152:153], v[160:161] op_sel:[0,0,0] op_sel_hi:[0,1,1]
    v_pk_fma_f32 v[162:163], v[100:101], v[154:155], v[162:163] op_sel:[0,0,0] op_sel_hi:[0,1,1]
    v_lshlrev_b32 v148, 16, v120
    v_and_b32 v149, 0xffff0000, v120
    v_lshlrev_b32 v150, 16, v121
    v_and_b32 v151, 0xffff0000, v121
    v_lshlrev_b32 v152, 16, v122
    v_and_b32 v153, 0xffff0000, v122
    v_lshlrev_b32 v154, 16, v123
    v_and_b32 v155, 0xffff0000, v123
    v_pk_fma_f32 v[156:157], v[100:101], v[148:149], v[156:157] op_sel:[1,0,0] op_sel_hi:[1,1,1]
    v_pk_fma_f32 v[158:159], v[100:101], v[150:151], v[158:159] op_sel:[1,0,0] op_sel_hi:[1,1,1]
    v_pk_fma_f32 v[160:161], v[100:101], v[152:153], v[160:161] op_sel:[1,0,0] op_sel_hi:[1,1,1]
    v_pk_fma_f32 v[162:163], v[100:101], v[154:155], v[162:163] op_sel:[1,0,0] op_sel_hi:[1,1,1]
    v_lshlrev_b32 v148, 16, v124
    v_and_b32 v149, 0xffff0000, v124
    v_lshlrev_b32 v150, 16, v125
    v_and_b32 v151, 0xffff0000, v125
    v_lshlrev_b32 v152, 16, v126
    v_and_b32 v153, 0xffff0000, v126
    v_lshlrev_b32 v154, 16, v127
    v_and_b32 v155, 0xffff0000, v127
    v_pk_fma_f32 v[156:157], v[102:103], v[148:149], v[156:157] op_sel:[0,0,0] op_sel_hi:[0,1,1]
    v_pk_fma_f32 v[158:159], v[102:103], v[150:151], v[158:159] op_sel:[0,0,0] op_sel_hi:[0,1,1]
    v_pk_fma_f32 v[160:161], v[102:103], v[152:153], v[160:161] op_sel:[0,0,0] op_sel_hi:[0,1,1]
    v_pk_fma_f32 v[162:163], v[102:103], v[154:155], v[162:163] op_sel:[0,0,0] op_sel_hi:[0,1,1]
    v_lshlrev_b32 v148, 16, v128
    v_and_b32 v149, 0xffff0000, v128
    v_lshlrev_b32 v150, 16, v129
    v_and_b32 v151, 0xffff0000, v129
    v_lshlrev_b32 v152, 16, v130
    v_and_b32 v153, 0xffff0000, v130
    v_lshlrev_b32 v154, 16, v131
    v_and_b32 v155, 0xffff0000, v131
    v_pk_fma_f32 v[156:157], v[102:103], v[148:149], v[156:157] op_sel:[1,0,0] op_sel_hi:[1,1,1]
    v_pk_fma_f32 v[158:159], v[102:103], v[150:151], v[158:159] op_sel:[1,0,0] op_sel_hi:[1,1,1]
    v_pk_fma_f32 v[160:161], v[102:103], v[152:153], v[160:161] op_sel:[1,0,0] op_sel_hi:[1,1,1]
    v_pk_fma_f32 v[162:163], v[102:103], v[154:155], v[162:163] op_sel:[1,0,0] op_sel_hi:[1,1,1]
    v_lshlrev_b32 v148, 16, v132
    v_and_b32 v149, 0xffff0000, v132
    v_lshlrev_b32 v150, 16, v133
    v_and_b32 v151, 0xffff0000, v133
    v_lshlrev_b32 v152, 16, v134
    v_and_b32 v153, 0xffff0000, v134
    v_lshlrev_b32 v154, 16, v135
    v_and_b32 v155, 0xffff0000, v135
    v_pk_fma_f32 v[156:157], v[104:105], v[148:149], v[156:157] op_sel:[0,0,0] op_sel_hi:[0,1,1]
    v_pk_fma_f32 v[158:159], v[104:105], v[150:151], v[158:159] op_sel:[0,0,0] op_sel_hi:[0,1,1]
    v_pk_fma_f32 v[160:161], v[104:105], v[152:153], v[160:161] op_sel:[0,0,0] op_sel_hi:[0,1,1]
    v_pk_fma_f32 v[162:163], v[104:105], v[154:155], v[162:163] op_sel:[0,0,0] op_sel_hi:[0,1,1]
    v_lshlrev_b32 v148, 16, v136
    v_and_b32 v149, 0xffff0000, v136
    v_lshlrev_b32 v150, 16, v137
    v_and_b32 v151, 0xffff0000, v137
    v_lshlrev_b32 v152, 16, v138
    v_and_b32 v153, 0xffff0000, v138
    v_lshlrev_b32 v154, 16, v139
    v_and_b32 v155, 0xffff0000, v139
    v_pk_fma_f32 v[156:157], v[104:105], v[148:149], v[156:157] op_sel:[1,0,0] op_sel_hi:[1,1,1]
    v_pk_fma_f32 v[158:159], v[104:105], v[150:151], v[158:159] op_sel:[1,0,0] op_sel_hi:[1,1,1]
    v_pk_fma_f32 v[160:161], v[104:105], v[152:153], v[160:161] op_sel:[1,0,0] op_sel_hi:[1,1,1]
    v_pk_fma_f32 v[162:163], v[104:105], v[154:155], v[162:163] op_sel:[1,0,0] op_sel_hi:[1,1,1]
    v_lshlrev_b32 v148, 16, v140
    v_and_b32 v149, 0xffff0000, v140
    v_lshlrev_b32 v150, 16, v141
    v_and_b32 v151, 0xffff0000, v141
    v_lshlrev_b32 v152, 16, v142
    v_and_b32 v153, 0xffff0000, v142
    v_lshlrev_b32 v154, 16, v143
    v_and_b32 v155, 0xffff0000, v143
    v_pk_fma_f32 v[156:157], v[106:107], v[148:149], v[156:157] op_sel:[0,0,0] op_sel_hi:[0,1,1]
    v_pk_fma_f32 v[158:159], v[106:107], v[150:151], v[158:159] op_sel:[0,0,0] op_sel_hi:[0,1,1]
    v_pk_fma_f32 v[160:161], v[106:107], v[152:153], v[160:161] op_sel:[0,0,0] op_sel_hi:[0,1,1]
    v_pk_fma_f32 v[162:163], v[106:107], v[154:155], v[162:163] op_sel:[0,0,0] op_sel_hi:[0,1,1]
    v_lshlrev_b32 v148, 16, v144
    v_and_b32 v149, 0xffff0000, v144
    v_lshlrev_b32 v150, 16, v145
    v_and_b32 v151, 0xffff0000, v145
    v_lshlrev_b32 v152, 16, v146
    v_and_b32 v153, 0xffff0000, v146
    v_lshlrev_b32 v154, 16, v147
    v_and_b32 v155, 0xffff0000, v147
    v_pk_fma_f32 v[156:157], v[106:107], v[148:149], v[156:157] op_sel:[1,0,0] op_sel_hi:[1,1,1]
    v_pk_fma_f32 v[158:159], v[106:107], v[150:151], v[158:159] op_sel:[1,0,0] op_sel_hi:[1,1,1]
    v_pk_fma_f32 v[160:161], v[106:107], v[152:153], v[160:161] op_sel:[1,0,0] op_sel_hi:[1,1,1]
    v_pk_fma_f32 v[162:163], v[106:107], v[154:155], v[162:163] op_sel:[1,0,0] op_sel_hi:[1,1,1]
    s_nop 0
    v_permlane32_swap_b32 v156, v160
    v_permlane32_swap_b32 v157, v161
    v_permlane32_swap_b32 v158, v162
    v_permlane32_swap_b32 v159, v163
    v_add_f32 v156, v156, v160
    v_add_f32 v157, v157, v161
    v_add_f32 v158, v158, v162
    v_add_f32 v159, v159, v163
    s_nop 0
    v_permlane16_swap_b32 v156, v158
    v_permlane16_swap_b32 v157, v159
    v_add_f32 v156, v156, v158
    v_add_f32 v157, v157, v159
    v_and_b32 v149, 7, v1
    v_lshrrev_b32 v150, 3, v1
    v_add_f32_dpp v148, v156, v156 row_ror:8 row_mask:0xf bank_mask:0x3
    s_nop 1
    v_add_f32_dpp v148, v157, v157 row_ror:8 row_mask:0xf bank_mask:0xc
    v_lshl_add_u32 v149, v149, 3, v150
    s_lshl_b32 s7, s3, 8
    s_add_u32 s7, s7, 123904
    v_lshl_add_u32 v149, v149, 2, s7
    ds_write_b32 v149, v148
    s_waitcnt lgkmcnt(0)
    s_barrier
    v_lshlrev_b32 v149, 2, v1
    v_add_u32 v150, 123904, v149
    ds_read_b32 v156, v150 offset:0
    ds_read_b32 v157, v150 offset:256
    ds_read_b32 v158, v150 offset:512
    ds_read_b32 v159, v150 offset:768
    v_add_u32 v149, s45, v149
    s_waitcnt lgkmcnt(2)
    v_add_f32 v156, v156, v157
    s_waitcnt lgkmcnt(0)
    v_add_f32 v158, v158, v159
    v_add_f32 v156, v156, v158
    v_min_u32 v156, -2, v156
    s_cmp_lg_u32 s3, 0
    s_cbranch_scc1 Lmod_skip_s2
    global_store_dword v149, v156, s[38:39] offset:0 sc1
Lmod_skip_s2:
    s_cmp_lg_u32 s3, 0
    s_cbranch_scc1 Lbic_x
    v_min_u32 v164, 49, v1
    v_add_u32 v164, 56, v164
    v_lshlrev_b32 v164, 1, v164
    s_branch Lbic_f
Lbic:
    s_sleep 4
Lbic_f:
    global_load_ushort v165, v164, s[36:37] sc1
    s_waitcnt vmcnt(0)
    v_cmp_eq_u32 vcc, 0, v165
    s_add_u32 s100, s100, 1
    s_cmp_ge_u32 s100, 262144
    s_cbranch_scc1 Lbic_x
    s_cbranch_vccnz Lbic
Lbic_x:
    s_waitcnt vmcnt(0)
    s_cmp_ge_u32 s48, 27
    s_cbranch_scc1 Lsp_b3
    s_barrier
    v_and_b32 v33, 15, v1
    v_lshrrev_b32 v34, 4, v1
    v_mul_u32_u24 v34, 10240, v34
    s_mul_i32 s5, s3, 320
    s_add_u32 s5, s5, 0
    v_add_u32 v34, s5, v34
    v_lshl_add_u32 v31, v33, 2, v34
    v_lshl_add_u32 v32, v33, 1, v34
    s_mul_i32 s5, s3, 276480
    s_mul_i32 s6, s48, 5120
    s_add_u32 s5, s5, s6
    s_add_u32 s5, s5, 10487808
    v_lshl_add_u32 v30, v1, 4, s5
    s_mov_b32 s6, 0x5040100
    s_mov_b32 s7, 0x7060302
    ds_read_b32 v36, v31 offset:0
    ds_read_b32 v37, v31 offset:2560
    ds_read_b32 v38, v31 offset:5120
    ds_read_b32 v39, v31 offset:7680
    ds_read_b32 v40, v31 offset:1280
    ds_read_b32 v41, v31 offset:3840
    ds_read_b32 v42, v31 offset:6400
    ds_read_b32 v43, v31 offset:8960
    ds_read_b32 v44, v31 offset:64
    ds_read_b32 v45, v31 offset:2624
    ds_read_b32 v46, v31 offset:5184
    ds_read_b32 v47, v31 offset:7744
    ds_read_b32 v48, v31 offset:1344
    ds_read_b32 v49, v31 offset:3904
    ds_read_b32 v50, v31 offset:6464
    ds_read_b32 v51, v31 offset:9024
    ds_read_u16 v52, v32 offset:128
    ds_read_u16 v53, v32 offset:2688
    ds_read_u16 v54, v32 offset:5248
    ds_read_u16 v55, v32 offset:7808
    ds_read_u16 v56, v32 offset:1408
    ds_read_u16 v57, v32 offset:3968
    ds_read_u16 v58, v32 offset:6528
    ds_read_u16 v59, v32 offset:9088
    s_waitcnt lgkmcnt(15)
    v_perm_b32 v60, v37, v36, s6
    v_perm_b32 v61, v39, v38, s6
    v_perm_b32 v62, v41, v40, s6
    v_perm_b32 v63, v43, v42, s6
    v_perm_b32 v64, v37, v36, s7
    v_perm_b32 v65, v39, v38, s7
    v_perm_b32 v66, v41, v40, s7
    v_perm_b32 v67, v43, v42, s7
    s_waitcnt lgkmcnt(14)
    v_perm_b32 v68, v45, v44, s6
    s_waitcnt lgkmcnt(12)
    v_perm_b32 v69, v47, v46, s6
    s_waitcnt lgkmcnt(10)
    v_perm_b32 v70, v49, v48, s6
    s_waitcnt lgkmcnt(8)
    v_perm_b32 v71, v51, v50, s6
    v_perm_b32 v72, v45, v44, s7
    v_perm_b32 v73, v47, v46, s7
    v_perm_b32 v74, v49, v48, s7
    v_perm_b32 v75, v51, v50, s7
    s_waitcnt lgkmcnt(6)
    v_perm_b32 v76, v53, v52, s6
    s_waitcnt lgkmcnt(4)
    v_perm_b32 v77, v55, v54, s6
    s_waitcnt lgkmcnt(2)
    v_perm_b32 v78, v57, v56, s6
    s_waitcnt lgkmcnt(0)
    v_perm_b32 v79, v59, v58, s6
    global_store_dwordx4 v30, v[60:63], s[38:39] offset:-2048 sc1
    global_store_dwordx4 v30, v[64:67], s[38:39] offset:-1024 sc1
    global_store_dwordx4 v30, v[68:71], s[38:39] offset:0 sc1
    global_store_dwordx4 v30, v[72:75], s[38:39] offset:1024 sc1
    global_store_dwordx4 v30, v[76:79], s[38:39] offset:2048 sc1
    v_add_u32 v30, 138240, v30
    ds_read_b32 v80, v31 offset:160
    ds_read_b32 v81, v31 offset:2720
    ds_read_b32 v82, v31 offset:5280
    ds_read_b32 v83, v31 offset:7840
    ds_read_b32 v84, v31 offset:1440
    ds_read_b32 v85, v31 offset:4000
    ds_read_b32 v86, v31 offset:6560
    ds_read_b32 v87, v31 offset:9120
    ds_read_b32 v88, v31 offset:224
    ds_read_b32 v89, v31 offset:2784
    ds_read_b32 v90, v31 offset:5344
    ds_read_b32 v91, v31 offset:7904
    ds_read_b32 v92, v31 offset:1504
    ds_read_b32 v93, v31 offset:4064
    ds_read_b32 v94, v31 offset:6624
    ds_read_b32 v95, v31 offset:9184
    ds_read_u16 v96, v32 offset:288
    ds_read_u16 v97, v32 offset:2848
    ds_read_u16 v98, v32 offset:5408
    ds_read_u16 v99, v32 offset:7968
    ds_read_u16 v100, v32 offset:1568
    ds_read_u16 v101, v32 offset:4128
    ds_read_u16 v102, v32 offset:6688
    ds_read_u16 v103, v32 offset:9248
    s_waitcnt lgkmcnt(15)
    v_perm_b32 v104, v81, v80, s6
    v_perm_b32 v105, v83, v82, s6
    v_perm_b32 v106, v85, v84, s6
    v_perm_b32 v107, v87, v86, s6
    v_perm_b32 v108, v81, v80, s7
    v_perm_b32 v109, v83, v82, s7
    v_perm_b32 v110, v85, v84, s7
    v_perm_b32 v111, v87, v86, s7
    s_waitcnt lgkmcnt(14)
    v_perm_b32 v112, v89, v88, s6
    s_waitcnt lgkmcnt(12)
    v_perm_b32 v113, v91, v90, s6
    s_waitcnt lgkmcnt(10)
    v_perm_b32 v114, v93, v92, s6
    s_waitcnt lgkmcnt(8)
    v_perm_b32 v115, v95, v94, s6
    v_perm_b32 v116, v89, v88, s7
    v_perm_b32 v117, v91, v90, s7
    v_perm_b32 v118, v93, v92, s7
    v_perm_b32 v119, v95, v94, s7
    s_waitcnt lgkmcnt(6)
    v_perm_b32 v120, v97, v96, s6
    s_waitcnt lgkmcnt(4)
    v_perm_b32 v121, v99, v98, s6
    s_waitcnt lgkmcnt(2)
    v_perm_b32 v122, v101, v100, s6
    s_waitcnt lgkmcnt(0)
    v_perm_b32 v123, v103, v102, s6
    global_store_dwordx4 v30, v[104:107], s[38:39] offset:-2048 sc1
    global_store_dwordx4 v30, v[108:111], s[38:39] offset:-1024 sc1
    global_store_dwordx4 v30, v[112:115], s[38:39] offset:0 sc1
    global_store_dwordx4 v30, v[116:119], s[38:39] offset:1024 sc1
    global_store_dwordx4 v30, v[120:123], s[38:39] offset:2048 sc1
    s_lshl_b32 s4, s48, 7
    s_add_u32 s51, s4, 98304
    s_branch Lsp_d
Lsp_a2:
    s_and_b32 s4, s42, 1
    s_lshl_b32 s4, s4, 1
    s_and_b32 s5, s3, 1
    s_add_u32 s44, s4, s5
    s_and_b32 s4, s42, -2
    s_lshr_b32 s5, s3, 1
    s_add_u32 s45, s4, s5
    s_and_b32 s4, s42, 1
    s_lshl_b32 s4, s4, 2
    s_add_u32 s4, s4, s3
    s_mul_i32 s4, s4, 276480
    s_lshr_b32 s5, s42, 1
    s_lshl_b32 s5, s5, 7
    s_add_u32 s4, s4, s5
    v_lshrrev_b32 v28, 3, v1
    v_mul_u32_u24 v28, 3328, v28
    v_add3_u32 v28, v28, v4, s4
    s_mul_i32 s5, s3, 10240
    s_add_u32 m0, s5, 0
    s_nop 0
    global_load_lds_dwordx4 v28, s[22:23] nt
    v_add_u32 v28, 27648, v28
    s_add_u32 m0, s5, 1024
    s_nop 0
    global_load_lds_dwordx4 v28, s[22:23] nt
    v_add_u32 v28, 27648, v28
    s_add_u32 m0, s5, 2048
    s_nop 0
    global_load_lds_dwordx4 v28, s[22:23] nt
    v_add_u32 v28, 27648, v28
    s_add_u32 m0, s5, 3072
    s_nop 0
    global_load_lds_dwordx4 v28, s[22:23] nt
    v_add_u32 v28, 27648, v28
    s_add_u32 m0, s5, 4096
    s_nop 0
    global_load_lds_dwordx4 v28, s[22:23] nt
    v_add_u32 v28, 27648, v28
    s_add_u32 m0, s5, 5120
    s_nop 0
    global_load_lds_dwordx4 v28, s[22:23] nt
    v_add_u32 v28, 27648, v28
    s_add_u32 m0, s5, 6144
    s_nop 0
    global_load_lds_dwordx4 v28, s[22:23] nt
    v_add_u32 v28, 27648, v28
    s_add_u32 m0, s5, 7168
    s_nop 0
    global_load_lds_dwordx4 v28, s[22:23] nt
    v_add_u32 v28, 27648, v28
    s_add_u32 m0, s5, 8192
    s_nop 0
    global_load_lds_dwordx4 v28, s[22:23] nt
    v_add_u32 v28, 27648, v28
    s_add_u32 m0, s5, 9216
    s_nop 0
    global_load_lds_dwordx4 v28, s[22:23] nt
    v_add_u32 v28, 27648, v28
    v_min_u32 v72, 624, v4
    s_mul_i32 s5, s44, 640
    s_add_u32 s5, s5, 7680
    v_add_u32 v73, s5, v72
    s_mul_i32 s5, s3, 1280
    s_add_u32 s5, s5, 124928
    v_add_u32 v72, s5, v72
    v_lshl_add_u32 v74, v3, 5, s5
    s_cmp_ge_u32 s45, 27
    s_cselect_b32 s6, -54, 56
    s_lshl_b32 s7, s45, 1
    s_add_u32 s46, s6, s7
    s_mul_i32 s4, s46, 20480
    s_mul_i32 s5, s44, 5120
    s_add_u32 s4, s4, s5
    s_add_u32 s4, s4, 7342080
    v_add_u32 v75, s4, v4
    v_add_u32 v76, 20480, v75
    s_and_b32 s4, s3, 1
    s_mul_i32 s4, s4, 20480
    s_lshr_b32 s5, s3, 1
    s_lshl_b32 s5, s5, 6
    s_add_u32 s4, s4, s5
    v_lshl_add_u32 v28, v3, 10, s4
    v_lshl_add_u32 v28, v2, 2, v28
    s_cmp_lt_u32 s42, 8
    s_cselect_b32 s48, 21, 0
    s_add_u32 s48, s48, s42
    s_add_u32 s48, s48, 76
    s_sub_u32 s4, s42, 5
    s_cmp_ge_u32 s4, 21
    s_cbranch_scc1 Lwp_n1
    s_lshr_b32 s4, s48, 1
    s_and_b32 s5, s48, 1
    s_cmp_lt_u32 s4, 50
    s_cselect_b32 s6, -20, 0
    s_cmp_lt_u32 s4, 20
    s_cselect_b32 s6, 30, s6
    s_add_u32 s4, s4, s6
    s_mul_i32 s6, s5, 15360
    s_lshl_b32 s7, s4, 8
    s_add_u32 s47, s6, s7
    s_lshl_b32 s5, s5, 2
    s_add_u32 s5, s5, s3
    s_mul_i32 s5, s5, 80
    s_lshl_b32 s4, s4, 7
    s_mul_i32 s6, s5, 7680
    s_add_u32 s4, s4, s6
    v_min_u32 v78, 39, v1
    s_lshl_b32 s5, s5, 1
    v_lshl_add_u32 v78, v78, 2, s5
    global_load_dword v132, v78, s[30:31]
    v_lshrrev_b32 v79, 3, v1
    v_mul_u32_u24 v78, 15232, v79
    v_add3_u32 v78, v78, v4, s4
    global_load_dwordx4 v[92:95], v78, s[32:33] nt
    v_add_u32 v78, 7680, v78
    global_load_dwordx4 v[96:99], v78, s[32:33] nt
    v_add_u32 v78, 115200, v78
    global_load_dwordx4 v[100:103], v78, s[32:33] nt
    v_add_u32 v78, 7680, v78
    global_load_dwordx4 v[104:107], v78, s[32:33] nt
    v_add_u32 v78, 115200, v78
    global_load_dwordx4 v[108:111], v78, s[32:33] nt
    v_add_u32 v78, 7680, v78
    global_load_dwordx4 v[112:115], v78, s[32:33] nt
    v_add_u32 v78, 115200, v78
    global_load_dwordx4 v[116:119], v78, s[32:33] nt
    v_add_u32 v78, 7680, v78
    global_load_dwordx4 v[120:123], v78, s[32:33] nt
    v_add_u32 v78, 115200, v78
    global_load_dwordx4 v[124:127], v78, s[32:33] nt
    v_add_u32 v78, 7680, v78
    global_load_dwordx4 v[128:131], v78, s[32:33] nt
    s_waitcnt vmcnt(11)
    s_branch Lwp_n2
Lwp_n1:
    s_waitcnt vmcnt(0)
Lwp_n2:
    s_barrier
    ds_read_b32 v32, v28 offset:0
    ds_read_b32 v33, v28 offset:128
    ds_read_b32 v34, v28 offset:256
    ds_read_b32 v35, v28 offset:384
    ds_read_b32 v36, v28 offset:512
    ds_read_b32 v37, v28 offset:640
    ds_read_b32 v38, v28 offset:768
    ds_read_b32 v39, v28 offset:896
    ds_read_b32 v40, v28 offset:4096
    ds_read_b32 v41, v28 offset:4224
    ds_read_b32 v42, v28 offset:4352
    ds_read_b32 v43, v28 offset:4480
    ds_read_b32 v44, v28 offset:4608
    ds_read_b32 v45, v28 offset:4736
    ds_read_b32 v46, v28 offset:4864
    ds_read_b32 v47, v28 offset:4992
    ds_read_b32 v48, v28 offset:8192
    ds_read_b32 v49, v28 offset:8320
    ds_read_b32 v50, v28 offset:8448
    ds_read_b32 v51, v28 offset:8576
    ds_read_b32 v52, v28 offset:8704
    ds_read_b32 v53, v28 offset:8832
    ds_read_b32 v54, v28 offset:8960
    ds_read_b32 v55, v28 offset:9088
    ds_read_b32 v56, v28 offset:12288
    ds_read_b32 v57, v28 offset:12416
    ds_read_b32 v58, v28 offset:12544
    ds_read_b32 v59, v28 offset:12672
    ds_read_b32 v60, v28 offset:12800
    ds_read_b32 v61, v28 offset:12928
    ds_read_b32 v62, v28 offset:13056
    ds_read_b32 v63, v28 offset:13184
    ds_read_b32 v64, v28 offset:16384
    ds_read_b32 v65, v28 offset:16512
    ds_read_b32 v66, v28 offset:16640
    ds_read_b32 v67, v28 offset:16768
    ds_read_b32 v68, v28 offset:16896
    ds_read_b32 v69, v28 offset:17024
    ds_read_b32 v70, v28 offset:17152
    ds_read_b32 v71, v28 offset:17280
    s_waitcnt lgkmcnt(15)
    v_lshlrev_b32 v152, 16, v32
    v_and_b32 v153, 0xffff0000, v32
    v_lshlrev_b32 v154, 16, v33
    v_and_b32 v155, 0xffff0000, v33
    v_lshlrev_b32 v156, 16, v34
    v_and_b32 v157, 0xffff0000, v34
    v_lshlrev_b32 v158, 16, v35
    v_and_b32 v159, 0xffff0000, v35
    v_lshlrev_b32 v160, 16, v36
    v_and_b32 v161, 0xffff0000, v36
    v_lshlrev_b32 v162, 16, v37
    v_and_b32 v163, 0xffff0000, v37
    v_lshlrev_b32 v164, 16, v38
    v_and_b32 v165, 0xffff0000, v38
    v_lshlrev_b32 v166, 16, v39
    v_and_b32 v167, 0xffff0000, v39
    v_lshlrev_b32 v168, 16, v40
    v_and_b32 v169, 0xffff0000, v40
    v_lshlrev_b32 v170, 16, v41
    v_and_b32 v171, 0xffff0000, v41
    v_lshlrev_b32 v172, 16, v42
    v_and_b32 v173, 0xffff0000, v42
    v_lshlrev_b32 v174, 16, v43
    v_and_b32 v175, 0xffff0000, v43
    v_lshlrev_b32 v176, 16, v44
    v_and_b32 v177, 0xffff0000, v44
    v_lshlrev_b32 v178, 16, v45
    v_and_b32 v179, 0xffff0000, v45
    v_lshlrev_b32 v180, 16, v46
    v_and_b32 v181, 0xffff0000, v46
    v_lshlrev_b32 v182, 16, v47
    v_and_b32 v183, 0xffff0000, v47
    v_lshlrev_b32 v184, 16, v48
    v_and_b32 v185, 0xffff0000, v48
    v_lshlrev_b32 v186, 16, v49
    v_and_b32 v187, 0xffff0000, v49
    v_lshlrev_b32 v188, 16, v50
    v_and_b32 v189, 0xffff0000, v50
    v_lshlrev_b32 v190, 16, v51
    v_and_b32 v191, 0xffff0000, v51
    v_lshlrev_b32 v192, 16, v52
    v_and_b32 v193, 0xffff0000, v52
    v_lshlrev_b32 v194, 16, v53
    v_and_b32 v195, 0xffff0000, v53
    v_lshlrev_b32 v196, 16, v54
    v_and_b32 v197, 0xffff0000, v54
    v_lshlrev_b32 v198, 16, v55
    v_and_b32 v199, 0xffff0000, v55
    v_lshlrev_b32 v200, 16, v56
    v_and_b32 v201, 0xffff0000, v56
    s_waitcnt lgkmcnt(14)
    v_lshlrev_b32 v202, 16, v57
    v_and_b32 v203, 0xffff0000, v57
    s_waitcnt lgkmcnt(13)
    v_lshlrev_b32 v204, 16, v58
    v_and_b32 v205, 0xffff0000, v58
    s_waitcnt lgkmcnt(12)
    v_lshlrev_b32 v206, 16, v59
    v_and_b32 v207, 0xffff0000, v59
    s_waitcnt lgkmcnt(11)
    v_lshlrev_b32 v208, 16, v60
    v_and_b32 v209, 0xffff0000, v60
    s_waitcnt lgkmcnt(10)
    v_lshlrev_b32 v210, 16, v61
    v_and_b32 v211, 0xffff0000, v61
    s_waitcnt lgkmcnt(9)
    v_lshlrev_b32 v212, 16, v62
    v_and_b32 v213, 0xffff0000, v62
    s_waitcnt lgkmcnt(8)
    v_lshlrev_b32 v214, 16, v63
    v_and_b32 v215, 0xffff0000, v63
    s_waitcnt lgkmcnt(7)
    v_lshlrev_b32 v216, 16, v64
    v_and_b32 v217, 0xffff0000, v64
    s_waitcnt lgkmcnt(6)
    v_lshlrev_b32 v218, 16, v65
    v_and_b32 v219, 0xffff0000, v65
    s_waitcnt lgkmcnt(5)
    v_lshlrev_b32 v220, 16, v66
    v_and_b32 v221, 0xffff0000, v66
    s_waitcnt lgkmcnt(4)
    v_lshlrev_b32 v222, 16, v67
    v_and_b32 v223, 0xffff0000, v67
    s_waitcnt lgkmcnt(3)
    v_lshlrev_b32 v224, 16, v68
    v_and_b32 v225, 0xffff0000, v68
    s_waitcnt lgkmcnt(2)
    v_lshlrev_b32 v226, 16, v69
    v_and_b32 v227, 0xffff0000, v69
    s_waitcnt lgkmcnt(1)
    v_lshlrev_b32 v228, 16, v70
    v_and_b32 v229, 0xffff0000, v70
    s_waitcnt lgkmcnt(0)
    v_lshlrev_b32 v230, 16, v71
    v_and_b32 v231, 0xffff0000, v71
    s_cmp_lg_u32 s3, 0
    s_cbranch_scc1 Lwic_x
    v_min_u32 v32, 49, v1
    v_add_u32 v32, 56, v32
    v_lshlrev_b32 v32, 1, v32
    s_branch Lwic_f
Lwic:
    s_sleep 4
Lwic_f:
    global_load_ushort v33, v32, s[36:37] sc1
    s_waitcnt vmcnt(0)
    v_cmp_eq_u32 vcc, 0, v33
    s_add_u32 s100, s100, 1
    s_cmp_ge_u32 s100, 262144
    s_cbranch_scc1 Lwic_x
    s_cbranch_vccnz Lwic
Lwic_x:
    s_waitcnt vmcnt(0)
    s_barrier
    s_sub_u32 s4, s42, 5
    s_cmp_ge_u32 s4, 21
    s_cbranch_scc1 Lwp_n3
    v_lshlrev_b32 v134, 16, v132
    v_and_b32 v135, 0xffff0000, v132
    v_lshlrev_b32 v79, 2, v79
    v_mul_f32 v136, 0xbfb8aa3b, v134
    v_mul_f32 v137, 0xbfb8aa3b, v135
    v_exp_f32 v136, v136
    v_exp_f32 v137, v137
    v_add_f32 v136, 1.0, v136
    v_add_f32 v137, 1.0, v137
    v_rcp_f32 v136, v136
    v_rcp_f32 v137, v137
    v_mul_f32 v134, v134, v136
    v_mul_f32 v135, v135, v137
    v_cvt_pk_bf16_f32 v132, v134, v135
    ds_bpermute_b32 v140, v79, v132 offset:0
    ds_bpermute_b32 v141, v79, v132 offset:32
    ds_bpermute_b32 v142, v79, v132 offset:64
    ds_bpermute_b32 v143, v79, v132 offset:96
    ds_bpermute_b32 v144, v79, v132 offset:128
    s_waitcnt lgkmcnt(4)
    v_lshlrev_b32 v80, 16, v140
    v_and_b32 v81, 0xffff0000, v140
    s_waitcnt lgkmcnt(3)
    v_lshlrev_b32 v82, 16, v141
    v_and_b32 v83, 0xffff0000, v141
    s_waitcnt lgkmcnt(2)
    v_lshlrev_b32 v84, 16, v142
    v_and_b32 v85, 0xffff0000, v142
    s_waitcnt lgkmcnt(1)
    v_lshlrev_b32 v86, 16, v143
    v_and_b32 v87, 0xffff0000, v143
    s_waitcnt lgkmcnt(0)
    v_lshlrev_b32 v88, 16, v144
    v_and_b32 v89, 0xffff0000, v144
    v_lshlrev_b32 v132, 16, v92
    v_and_b32 v133, 0xffff0000, v92
    v_lshlrev_b32 v134, 16, v93
    v_and_b32 v135, 0xffff0000, v93
    v_lshlrev_b32 v136, 16, v94
    v_and_b32 v137, 0xffff0000, v94
    v_lshlrev_b32 v138, 16, v95
    v_and_b32 v139, 0xffff0000, v95
    v_pk_mul_f32 v[140:141], v[80:81], v[132:133] op_sel:[0,0] op_sel_hi:[0,1]
    v_pk_mul_f32 v[142:143], v[80:81], v[134:135] op_sel:[0,0] op_sel_hi:[0,1]
    v_pk_mul_f32 v[144:145], v[80:81], v[136:137] op_sel:[0,0] op_sel_hi:[0,1]
    v_pk_mul_f32 v[146:147], v[80:81], v[138:139] op_sel:[0,0] op_sel_hi:[0,1]
    v_lshlrev_b32 v132, 16, v96
    v_and_b32 v133, 0xffff0000, v96
    v_lshlrev_b32 v134, 16, v97
    v_and_b32 v135, 0xffff0000, v97
    v_lshlrev_b32 v136, 16, v98
    v_and_b32 v137, 0xffff0000, v98
    v_lshlrev_b32 v138, 16, v99
    v_and_b32 v139, 0xffff0000, v99
    v_pk_fma_f32 v[140:141], v[80:81], v[132:133], v[140:141] op_sel:[1,0,0] op_sel_hi:[1,1,1]
    v_pk_fma_f32 v[142:143], v[80:81], v[134:135], v[142:143] op_sel:[1,0,0] op_sel_hi:[1,1,1]
    v_pk_fma_f32 v[144:145], v[80:81], v[136:137], v[144:145] op_sel:[1,0,0] op_sel_hi:[1,1,1]
    v_pk_fma_f32 v[146:147], v[80:81], v[138:139], v[146:147] op_sel:[1,0,0] op_sel_hi:[1,1,1]
    v_lshlrev_b32 v132, 16, v100
    v_and_b32 v133, 0xffff0000, v100
    v_lshlrev_b32 v134, 16, v101
    v_and_b32 v135, 0xffff0000, v101
    v_lshlrev_b32 v136, 16, v102
    v_and_b32 v137, 0xffff0000, v102
    v_lshlrev_b32 v138, 16, v103
    v_and_b32 v139, 0xffff0000, v103
    v_pk_fma_f32 v[140:141], v[82:83], v[132:133], v[140:141] op_sel:[0,0,0] op_sel_hi:[0,1,1]
    v_pk_fma_f32 v[142:143], v[82:83], v[134:135], v[142:143] op_sel:[0,0,0] op_sel_hi:[0,1,1]
    v_pk_fma_f32 v[144:145], v[82:83], v[136:137], v[144:145] op_sel:[0,0,0] op_sel_hi:[0,1,1]
    v_pk_fma_f32 v[146:147], v[82:83], v[138:139], v[146:147] op_sel:[0,0,0] op_sel_hi:[0,1,1]
    v_lshlrev_b32 v132, 16, v104
    v_and_b32 v133, 0xffff0000, v104
    v_lshlrev_b32 v134, 16, v105
    v_and_b32 v135, 0xffff0000, v105
    v_lshlrev_b32 v136, 16, v106
    v_and_b32 v137, 0xffff0000, v106
    v_lshlrev_b32 v138, 16, v107
    v_and_b32 v139, 0xffff0000, v107
    v_pk_fma_f32 v[140:141], v[82:83], v[132:133], v[140:141] op_sel:[1,0,0] op_sel_hi:[1,1,1]
    v_pk_fma_f32 v[142:143], v[82:83], v[134:135], v[142:143] op_sel:[1,0,0] op_sel_hi:[1,1,1]
    v_pk_fma_f32 v[144:145], v[82:83], v[136:137], v[144:145] op_sel:[1,0,0] op_sel_hi:[1,1,1]
    v_pk_fma_f32 v[146:147], v[82:83], v[138:139], v[146:147] op_sel:[1,0,0] op_sel_hi:[1,1,1]
    v_lshlrev_b32 v132, 16, v108
    v_and_b32 v133, 0xffff0000, v108
    v_lshlrev_b32 v134, 16, v109
    v_and_b32 v135, 0xffff0000, v109
    v_lshlrev_b32 v136, 16, v110
    v_and_b32 v137, 0xffff0000, v110
    v_lshlrev_b32 v138, 16, v111
    v_and_b32 v139, 0xffff0000, v111
    v_pk_fma_f32 v[140:141], v[84:85], v[132:133], v[140:141] op_sel:[0,0,0] op_sel_hi:[0,1,1]
    v_pk_fma_f32 v[142:143], v[84:85], v[134:135], v[142:143] op_sel:[0,0,0] op_sel_hi:[0,1,1]
    v_pk_fma_f32 v[144:145], v[84:85], v[136:137], v[144:145] op_sel:[0,0,0] op_sel_hi:[0,1,1]
    v_pk_fma_f32 v[146:147], v[84:85], v[138:139], v[146:147] op_sel:[0,0,0] op_sel_hi:[0,1,1]
    v_lshlrev_b32 v132, 16, v112
    v_and_b32 v133, 0xffff0000, v112
    v_lshlrev_b32 v134, 16, v113
    v_and_b32 v135, 0xffff0000, v113
    v_lshlrev_b32 v136, 16, v114
    v_and_b32 v137, 0xffff0000, v114
    v_lshlrev_b32 v138, 16, v115
    v_and_b32 v139, 0xffff0000, v115
    v_pk_fma_f32 v[140:141], v[84:85], v[132:133], v[140:141] op_sel:[1,0,0] op_sel_hi:[1,1,1]
    v_pk_fma_f32 v[142:143], v[84:85], v[134:135], v[142:143] op_sel:[1,0,0] op_sel_hi:[1,1,1]
    v_pk_fma_f32 v[144:145], v[84:85], v[136:137], v[144:145] op_sel:[1,0,0] op_sel_hi:[1,1,1]
    v_pk_fma_f32 v[146:147], v[84:85], v[138:139], v[146:147] op_sel:[1,0,0] op_sel_hi:[1,1,1]
    v_lshlrev_b32 v132, 16, v116
    v_and_b32 v133, 0xffff0000, v116
    v_lshlrev_b32 v134, 16, v117
    v_and_b32 v135, 0xffff0000, v117
    v_lshlrev_b32 v136, 16, v118
    v_and_b32 v137, 0xffff0000, v118
    v_lshlrev_b32 v138, 16, v119
    v_and_b32 v139, 0xffff0000, v119
    v_pk_fma_f32 v[140:141], v[86:87], v[132:133], v[140:141] op_sel:[0,0,0] op_sel_hi:[0,1,1]
    v_pk_fma_f32 v[142:143], v[86:87], v[134:135], v[142:143] op_sel:[0,0,0] op_sel_hi:[0,1,1]
    v_pk_fma_f32 v[144:145], v[86:87], v[136:137], v[144:145] op_sel:[0,0,0] op_sel_hi:[0,1,1]
    v_pk_fma_f32 v[146:147], v[86:87], v[138:139], v[146:147] op_sel:[0,0,0] op_sel_hi:[0,1,1]
    v_lshlrev_b32 v132, 16, v120
    v_and_b32 v133, 0xffff0000, v120
    v_lshlrev_b32 v134, 16, v121
    v_and_b32 v135, 0xffff0000, v121
    v_lshlrev_b32 v136, 16, v122
    v_and_b32 v137, 0xffff0000, v122
    v_lshlrev_b32 v138, 16, v123
    v_and_b32 v139, 0xffff0000, v123
    v_pk_fma_f32 v[140:141], v[86:87], v[132:133], v[140:141] op_sel:[1,0,0] op_sel_hi:[1,1,1]
    v_pk_fma_f32 v[142:143], v[86:87], v[134:135], v[142:143] op_sel:[1,0,0] op_sel_hi:[1,1,1]
    v_pk_fma_f32 v[144:145], v[86:87], v[136:137], v[144:145] op_sel:[1,0,0] op_sel_hi:[1,1,1]
    v_pk_fma_f32 v[146:147], v[86:87], v[138:139], v[146:147] op_sel:[1,0,0] op_sel_hi:[1,1,1]
    v_lshlrev_b32 v132, 16, v124
    v_and_b32 v133, 0xffff0000, v124
    v_lshlrev_b32 v134, 16, v125
    v_and_b32 v135, 0xffff0000, v125
    v_lshlrev_b32 v136, 16, v126
    v_and_b32 v137, 0xffff0000, v126
    v_lshlrev_b32 v138, 16, v127
    v_and_b32 v139, 0xffff0000, v127
    v_pk_fma_f32 v[140:141], v[88:89], v[132:133], v[140:141] op_sel:[0,0,0] op_sel_hi:[0,1,1]
    v_pk_fma_f32 v[142:143], v[88:89], v[134:135], v[142:143] op_sel:[0,0,0] op_sel_hi:[0,1,1]
    v_pk_fma_f32 v[144:145], v[88:89], v[136:137], v[144:145] op_sel:[0,0,0] op_sel_hi:[0,1,1]
    v_pk_fma_f32 v[146:147], v[88:89], v[138:139], v[146:147] op_sel:[0,0,0] op_sel_hi:[0,1,1]
    v_lshlrev_b32 v132, 16, v128
    v_and_b32 v133, 0xffff0000, v128
    v_lshlrev_b32 v134, 16, v129
    v_and_b32 v135, 0xffff0000, v129
    v_lshlrev_b32 v136, 16, v130
    v_and_b32 v137, 0xffff0000, v130
    v_lshlrev_b32 v138, 16, v131
    v_and_b32 v139, 0xffff0000, v131
    v_pk_fma_f32 v[140:141], v[88:89], v[132:133], v[140:141] op_sel:[1,0,0] op_sel_hi:[1,1,1]
    v_pk_fma_f32 v[142:143], v[88:89], v[134:135], v[142:143] op_sel:[1,0,0] op_sel_hi:[1,1,1]
    v_pk_fma_f32 v[144:145], v[88:89], v[136:137], v[144:145] op_sel:[1,0,0] op_sel_hi:[1,1,1]
    v_pk_fma_f32 v[146:147], v[88:89], v[138:139], v[146:147] op_sel:[1,0,0] op_sel_hi:[1,1,1]
    s_nop 0
    v_permlane32_swap_b32 v140, v144
    v_permlane32_swap_b32 v141, v145
    v_permlane32_swap_b32 v142, v146
    v_permlane32_swap_b32 v143, v147
    v_add_f32 v140, v140, v144
    v_add_f32 v141, v141, v145
    v_add_f32 v142, v142, v146
    v_add_f32 v143, v143, v147
    s_nop 0
    v_permlane16_swap_b32 v140, v142
    v_permlane16_swap_b32 v141, v143
    v_add_f32 v140, v140, v142
    v_add_f32 v141, v141, v143
    v_and_b32 v133, 7, v1
    v_lshrrev_b32 v134, 3, v1
    v_add_f32_dpp v132, v140, v140 row_ror:8 row_mask:0xf bank_mask:0x3
    s_nop 1
    v_add_f32_dpp v132, v141, v141 row_ror:8 row_mask:0xf bank_mask:0xc
    v_lshl_add_u32 v133, v133, 3, v134
    s_lshl_b32 s7, s3, 8
    s_add_u32 s7, s7, 122880
    v_lshl_add_u32 v133, v133, 2, s7
    ds_write_b32 v133, v132
    s_waitcnt lgkmcnt(0)
    s_barrier
    v_lshlrev_b32 v133, 2, v1
    v_add_u32 v134, 122880, v133
    ds_read_b32 v140, v134 offset:0
    ds_read_b32 v141, v134 offset:256
    ds_read_b32 v142, v134 offset:512
    ds_read_b32 v143, v134 offset:768
    v_add_u32 v133, s47, v133
    s_waitcnt lgkmcnt(2)
    v_add_f32 v140, v140, v141
    s_waitcnt lgkmcnt(0)
    v_add_f32 v142, v142, v143
    v_add_f32 v140, v140, v142
    v_min_u32 v140, -2, v140
    s_cmp_lg_u32 s3, 0
    s_cbranch_scc1 Lmod_skip_w
    global_store_dword v133, v140, s[38:39] offset:0 sc1
Lmod_skip_w:
Lwp_n3:
    s_branch Lwm_f
Lwm:
    s_sleep 2
Lwm_f:
    v_add_u32 v77, 0, v73
    global_load_dwordx4 v[80:83], v77, s[38:39] sc1
    global_load_dwordx4 v[84:87], v77, s[38:39] offset:2560 sc1
    v_add_u32 v77, 15360, v73
    global_load_dwordx4 v[88:91], v77, s[38:39] sc1
    global_load_dwordx4 v[92:95], v77, s[38:39] offset:2560 sc1
    s_waitcnt vmcnt(0)
    v_max_u32 v77, v80, v81
    v_max3_u32 v77, v82, v83, v77
    v_max3_u32 v77, v84, v85, v77
    v_max3_u32 v77, v86, v87, v77
    v_max3_u32 v77, v88, v89, v77
    v_max3_u32 v77, v90, v91, v77
    v_max3_u32 v77, v92, v93, v77
    v_max3_u32 v77, v94, v95, v77
    v_cmp_eq_u32 vcc, -1, v77
    s_add_u32 s100, s100, 1
    s_cmp_ge_u32 s100, 262144
    s_cbranch_scc1 Lwm_x
    s_cbranch_vccnz Lwm
Lwm_x:
    v_pk_add_f32 v[80:81], v[80:81], v[88:89] op_sel:[0,0] op_sel_hi:[1,1]
    v_pk_add_f32 v[82:83], v[82:83], v[90:91] op_sel:[0,0] op_sel_hi:[1,1]
    v_pk_add_f32 v[84:85], v[84:85], v[92:93] op_sel:[0,0] op_sel_hi:[1,1]
    v_pk_add_f32 v[86:87], v[86:87], v[94:95] op_sel:[0,0] op_sel_hi:[1,1]
    v_cvt_pk_bf16_f32 v80, v80, v80
    v_lshlrev_b32 v80, 16, v80
    v_cvt_pk_bf16_f32 v81, v81, v81
    v_lshlrev_b32 v81, 16, v81
    v_cvt_pk_bf16_f32 v82, v82, v82
    v_lshlrev_b32 v82, 16, v82
    v_cvt_pk_bf16_f32 v83, v83, v83
    v_lshlrev_b32 v83, 16, v83
    v_cvt_pk_bf16_f32 v84, v84, v84
    v_lshlrev_b32 v84, 16, v84
    v_cvt_pk_bf16_f32 v85, v85, v85
    v_lshlrev_b32 v85, 16, v85
    v_cvt_pk_bf16_f32 v86, v86, v86
    v_lshlrev_b32 v86, 16, v86
    v_cvt_pk_bf16_f32 v87, v87, v87
    v_lshlrev_b32 v87, 16, v87
    v_add_f32 v84, 1.0, v84
    v_add_f32 v85, 1.0, v85
    v_add_f32 v86, 1.0, v86
    v_add_f32 v87, 1.0, v87
    v_cvt_pk_bf16_f32 v84, v84, v84
    v_lshlrev_b32 v84, 16, v84
    v_cvt_pk_bf16_f32 v85, v85, v85
    v_lshlrev_b32 v85, 16, v85
    v_cvt_pk_bf16_f32 v86, v86, v86
    v_lshlrev_b32 v86, 16, v86
    v_cvt_pk_bf16_f32 v87, v87, v87
    v_lshlrev_b32 v87, 16, v87
    ds_write_b128 v72, v[84:87]
    ds_write_b128 v72, v[80:83] offset:640
    ds_read_b128 v[32:35], v74 offset:0
    ds_read_b128 v[36:39], v74 offset:16
    ds_read_b128 v[40:43], v74 offset:128
    ds_read_b128 v[44:47], v74 offset:144
    ds_read_b128 v[48:51], v74 offset:256
    ds_read_b128 v[52:55], v74 offset:272
    ds_read_b128 v[56:59], v74 offset:384
    ds_read_b128 v[60:63], v74 offset:400
    ds_read_b128 v[64:67], v74 offset:512
    ds_read_b128 v[68:71], v74 offset:528
    s_waitcnt lgkmcnt(9)
    v_pk_mul_f32 v[96:97], v[32:33], v[152:153] op_sel:[0,0] op_sel_hi:[0,1]
    v_pk_mul_f32 v[98:99], v[32:33], v[154:155] op_sel:[1,0] op_sel_hi:[1,1]
    v_pk_mul_f32 v[100:101], v[34:35], v[156:157] op_sel:[0,0] op_sel_hi:[0,1]
    v_pk_mul_f32 v[102:103], v[34:35], v[158:159] op_sel:[1,0] op_sel_hi:[1,1]
    s_waitcnt lgkmcnt(8)
    v_pk_mul_f32 v[104:105], v[36:37], v[160:161] op_sel:[0,0] op_sel_hi:[0,1]
    v_pk_mul_f32 v[106:107], v[36:37], v[162:163] op_sel:[1,0] op_sel_hi:[1,1]
    v_pk_mul_f32 v[108:109], v[38:39], v[164:165] op_sel:[0,0] op_sel_hi:[0,1]
    v_pk_mul_f32 v[110:111], v[38:39], v[166:167] op_sel:[1,0] op_sel_hi:[1,1]
    v_cvt_pk_bf16_f32 v112, v96, v98
    v_cvt_pk_bf16_f32 v113, v100, v102
    v_cvt_pk_bf16_f32 v114, v104, v106
    v_cvt_pk_bf16_f32 v115, v108, v110
    v_cvt_pk_bf16_f32 v116, v97, v99
    v_cvt_pk_bf16_f32 v117, v101, v103
    v_cvt_pk_bf16_f32 v118, v105, v107
    v_cvt_pk_bf16_f32 v119, v109, v111
    global_store_dwordx4 v75, v[112:115], s[38:39] offset:-2048 sc1
    global_store_dwordx4 v76, v[116:119], s[38:39] offset:-2048 sc1
    s_waitcnt lgkmcnt(7)
    v_pk_mul_f32 v[96:97], v[40:41], v[168:169] op_sel:[0,0] op_sel_hi:[0,1]
    v_pk_mul_f32 v[98:99], v[40:41], v[170:171] op_sel:[1,0] op_sel_hi:[1,1]
    v_pk_mul_f32 v[100:101], v[42:43], v[172:173] op_sel:[0,0] op_sel_hi:[0,1]
    v_pk_mul_f32 v[102:103], v[42:43], v[174:175] op_sel:[1,0] op_sel_hi:[1,1]
    s_waitcnt lgkmcnt(6)
    v_pk_mul_f32 v[104:105], v[44:45], v[176:177] op_sel:[0,0] op_sel_hi:[0,1]
    v_pk_mul_f32 v[106:107], v[44:45], v[178:179] op_sel:[1,0] op_sel_hi:[1,1]
    v_pk_mul_f32 v[108:109], v[46:47], v[180:181] op_sel:[0,0] op_sel_hi:[0,1]
    v_pk_mul_f32 v[110:111], v[46:47], v[182:183] op_sel:[1,0] op_sel_hi:[1,1]
    v_cvt_pk_bf16_f32 v120, v96, v98
    v_cvt_pk_bf16_f32 v121, v100, v102
    v_cvt_pk_bf16_f32 v122, v104, v106
    v_cvt_pk_bf16_f32 v123, v108, v110
    v_cvt_pk_bf16_f32 v124, v97, v99
    v_cvt_pk_bf16_f32 v125, v101, v103
    v_cvt_pk_bf16_f32 v126, v105, v107
    v_cvt_pk_bf16_f32 v127, v109, v111
    global_store_dwordx4 v75, v[120:123], s[38:39] offset:-1024 sc1
    global_store_dwordx4 v76, v[124:127], s[38:39] offset:-1024 sc1
    s_waitcnt lgkmcnt(5)
    v_pk_mul_f32 v[96:97], v[48:49], v[184:185] op_sel:[0,0] op_sel_hi:[0,1]
    v_pk_mul_f32 v[98:99], v[48:49], v[186:187] op_sel:[1,0] op_sel_hi:[1,1]
    v_pk_mul_f32 v[100:101], v[50:51], v[188:189] op_sel:[0,0] op_sel_hi:[0,1]
    v_pk_mul_f32 v[102:103], v[50:51], v[190:191] op_sel:[1,0] op_sel_hi:[1,1]
    s_waitcnt lgkmcnt(4)
    v_pk_mul_f32 v[104:105], v[52:53], v[192:193] op_sel:[0,0] op_sel_hi:[0,1]
    v_pk_mul_f32 v[106:107], v[52:53], v[194:195] op_sel:[1,0] op_sel_hi:[1,1]
    v_pk_mul_f32 v[108:109], v[54:55], v[196:197] op_sel:[0,0] op_sel_hi:[0,1]
    v_pk_mul_f32 v[110:111], v[54:55], v[198:199] op_sel:[1,0] op_sel_hi:[1,1]
    v_cvt_pk_bf16_f32 v128, v96, v98
    v_cvt_pk_bf16_f32 v129, v100, v102
    v_cvt_pk_bf16_f32 v130, v104, v106
    v_cvt_pk_bf16_f32 v131, v108, v110
    v_cvt_pk_bf16_f32 v132, v97, v99
    v_cvt_pk_bf16_f32 v133, v101, v103
    v_cvt_pk_bf16_f32 v134, v105, v107
    v_cvt_pk_bf16_f32 v135, v109, v111
    global_store_dwordx4 v75, v[128:131], s[38:39] offset:0 sc1
    global_store_dwordx4 v76, v[132:135], s[38:39] offset:0 sc1
    s_waitcnt lgkmcnt(3)
    v_pk_mul_f32 v[96:97], v[56:57], v[200:201] op_sel:[0,0] op_sel_hi:[0,1]
    v_pk_mul_f32 v[98:99], v[56:57], v[202:203] op_sel:[1,0] op_sel_hi:[1,1]
    v_pk_mul_f32 v[100:101], v[58:59], v[204:205] op_sel:[0,0] op_sel_hi:[0,1]
    v_pk_mul_f32 v[102:103], v[58:59], v[206:207] op_sel:[1,0] op_sel_hi:[1,1]
    s_waitcnt lgkmcnt(2)
    v_pk_mul_f32 v[104:105], v[60:61], v[208:209] op_sel:[0,0] op_sel_hi:[0,1]
    v_pk_mul_f32 v[106:107], v[60:61], v[210:211] op_sel:[1,0] op_sel_hi:[1,1]
    v_pk_mul_f32 v[108:109], v[62:63], v[212:213] op_sel:[0,0] op_sel_hi:[0,1]
    v_pk_mul_f32 v[110:111], v[62:63], v[214:215] op_sel:[1,0] op_sel_hi:[1,1]
    v_cvt_pk_bf16_f32 v136, v96, v98
    v_cvt_pk_bf16_f32 v137, v100, v102
    v_cvt_pk_bf16_f32 v138, v104, v106
    v_cvt_pk_bf16_f32 v139, v108, v110
    v_cvt_pk_bf16_f32 v140, v97, v99
    v_cvt_pk_bf16_f32 v141, v101, v103
    v_cvt_pk_bf16_f32 v142, v105, v107
    v_cvt_pk_bf16_f32 v143, v109, v111
    global_store_dwordx4 v75, v[136:139], s[38:39] offset:1024 sc1
    global_store_dwordx4 v76, v[140:143], s[38:39] offset:1024 sc1
    s_waitcnt lgkmcnt(1)
    v_pk_mul_f32 v[96:97], v[64:65], v[216:217] op_sel:[0,0] op_sel_hi:[0,1]
    v_pk_mul_f32 v[98:99], v[64:65], v[218:219] op_sel:[1,0] op_sel_hi:[1,1]
    v_pk_mul_f32 v[100:101], v[66:67], v[220:221] op_sel:[0,0] op_sel_hi:[0,1]
    v_pk_mul_f32 v[102:103], v[66:67], v[222:223] op_sel:[1,0] op_sel_hi:[1,1]
    s_waitcnt lgkmcnt(0)
    v_pk_mul_f32 v[104:105], v[68:69], v[224:225] op_sel:[0,0] op_sel_hi:[0,1]
    v_pk_mul_f32 v[106:107], v[68:69], v[226:227] op_sel:[1,0] op_sel_hi:[1,1]
    v_pk_mul_f32 v[108:109], v[70:71], v[228:229] op_sel:[0,0] op_sel_hi:[0,1]
    v_pk_mul_f32 v[110:111], v[70:71], v[230:231] op_sel:[1,0] op_sel_hi:[1,1]
    v_cvt_pk_bf16_f32 v144, v96, v98
    v_cvt_pk_bf16_f32 v145, v100, v102
    v_cvt_pk_bf16_f32 v146, v104, v106
    v_cvt_pk_bf16_f32 v147, v108, v110
    v_cvt_pk_bf16_f32 v148, v97, v99
    v_cvt_pk_bf16_f32 v149, v101, v103
    v_cvt_pk_bf16_f32 v150, v105, v107
    v_cvt_pk_bf16_f32 v151, v109, v111
    global_store_dwordx4 v75, v[144:147], s[38:39] offset:2048 sc1
    global_store_dwordx4 v76, v[148:151], s[38:39] offset:2048 sc1
    ds_read_b128 v[32:35], v74 offset:640
    ds_read_b128 v[36:39], v74 offset:656
    ds_read_b128 v[40:43], v74 offset:768
    ds_read_b128 v[44:47], v74 offset:784
    ds_read_b128 v[48:51], v74 offset:896
    ds_read_b128 v[52:55], v74 offset:912
    ds_read_b128 v[56:59], v74 offset:1024
    ds_read_b128 v[60:63], v74 offset:1040
    ds_read_b128 v[64:67], v74 offset:1152
    ds_read_b128 v[68:71], v74 offset:1168
    s_mov_b32 s7, 0x3f803f80
    v_mov_b32 v88, 0
    v_mov_b32 v89, 0
    v_mov_b32 v90, 0
    v_mov_b32 v91, 0
    v_mov_b32 v92, 0
    v_mov_b32 v93, 0
    v_mov_b32 v94, 0
    v_mov_b32 v95, 0
    v_dot2_f32_bf16 v88, v112, s7, v88
    v_dot2_f32_bf16 v89, v116, s7, v89
    v_dot2_f32_bf16 v88, v113, s7, v88
    v_dot2_f32_bf16 v89, v117, s7, v89
    v_dot2_f32_bf16 v88, v114, s7, v88
    v_dot2_f32_bf16 v89, v118, s7, v89
    v_dot2_f32_bf16 v88, v115, s7, v88
    v_dot2_f32_bf16 v89, v119, s7, v89
    v_dot2_f32_bf16 v88, v120, s7, v88
    v_dot2_f32_bf16 v89, v124, s7, v89
    v_dot2_f32_bf16 v88, v121, s7, v88
    v_dot2_f32_bf16 v89, v125, s7, v89
    v_dot2_f32_bf16 v88, v122, s7, v88
    v_dot2_f32_bf16 v89, v126, s7, v89
    v_dot2_f32_bf16 v88, v123, s7, v88
    v_dot2_f32_bf16 v89, v127, s7, v89
    v_dot2_f32_bf16 v88, v128, s7, v88
    v_dot2_f32_bf16 v89, v132, s7, v89
    v_dot2_f32_bf16 v88, v129, s7, v88
    v_dot2_f32_bf16 v89, v133, s7, v89
    v_dot2_f32_bf16 v88, v130, s7, v88
    v_dot2_f32_bf16 v89, v134, s7, v89
    v_dot2_f32_bf16 v88, v131, s7, v88
    v_dot2_f32_bf16 v89, v135, s7, v89
    v_dot2_f32_bf16 v88, v136, s7, v88
    v_dot2_f32_bf16 v89, v140, s7, v89
    v_dot2_f32_bf16 v88, v137, s7, v88
    v_dot2_f32_bf16 v89, v141, s7, v89
    v_dot2_f32_bf16 v88, v138, s7, v88
    v_dot2_f32_bf16 v89, v142, s7, v89
    v_dot2_f32_bf16 v88, v139, s7, v88
    v_dot2_f32_bf16 v89, v143, s7, v89
    v_dot2_f32_bf16 v88, v144, s7, v88
    v_dot2_f32_bf16 v89, v148, s7, v89
    v_dot2_f32_bf16 v88, v145, s7, v88
    v_dot2_f32_bf16 v89, v149, s7, v89
    v_dot2_f32_bf16 v88, v146, s7, v88
    v_dot2_f32_bf16 v89, v150, s7, v89
    v_dot2_f32_bf16 v88, v147, s7, v88
    v_dot2_f32_bf16 v89, v151, s7, v89
    s_waitcnt lgkmcnt(9)
    v_pk_fma_f32 v[90:91], v[32:33], v[152:153], v[90:91] op_sel:[0,0,0] op_sel_hi:[0,1,1]
    v_pk_fma_f32 v[92:93], v[32:33], v[154:155], v[92:93] op_sel:[1,0,0] op_sel_hi:[1,1,1]
    v_pk_fma_f32 v[94:95], v[34:35], v[156:157], v[94:95] op_sel:[0,0,0] op_sel_hi:[0,1,1]
    v_pk_fma_f32 v[90:91], v[34:35], v[158:159], v[90:91] op_sel:[1,0,0] op_sel_hi:[1,1,1]
    s_waitcnt lgkmcnt(8)
    v_pk_fma_f32 v[92:93], v[36:37], v[160:161], v[92:93] op_sel:[0,0,0] op_sel_hi:[0,1,1]
    v_pk_fma_f32 v[94:95], v[36:37], v[162:163], v[94:95] op_sel:[1,0,0] op_sel_hi:[1,1,1]
    v_pk_fma_f32 v[90:91], v[38:39], v[164:165], v[90:91] op_sel:[0,0,0] op_sel_hi:[0,1,1]
    v_pk_fma_f32 v[92:93], v[38:39], v[166:167], v[92:93] op_sel:[1,0,0] op_sel_hi:[1,1,1]
    s_waitcnt lgkmcnt(7)
    v_pk_fma_f32 v[94:95], v[40:41], v[168:169], v[94:95] op_sel:[0,0,0] op_sel_hi:[0,1,1]
    v_pk_fma_f32 v[90:91], v[40:41], v[170:171], v[90:91] op_sel:[1,0,0] op_sel_hi:[1,1,1]
    v_pk_fma_f32 v[92:93], v[42:43], v[172:173], v[92:93] op_sel:[0,0,0] op_sel_hi:[0,1,1]
    v_pk_fma_f32 v[94:95], v[42:43], v[174:175], v[94:95] op_sel:[1,0,0] op_sel_hi:[1,1,1]
    s_waitcnt lgkmcnt(6)
    v_pk_fma_f32 v[90:91], v[44:45], v[176:177], v[90:91] op_sel:[0,0,0] op_sel_hi:[0,1,1]
    v_pk_fma_f32 v[92:93], v[44:45], v[178:179], v[92:93] op_sel:[1,0,0] op_sel_hi:[1,1,1]
    v_pk_fma_f32 v[94:95], v[46:47], v[180:181], v[94:95] op_sel:[0,0,0] op_sel_hi:[0,1,1]
    v_pk_fma_f32 v[90:91], v[46:47], v[182:183], v[90:91] op_sel:[1,0,0] op_sel_hi:[1,1,1]
    s_waitcnt lgkmcnt(5)
    v_pk_fma_f32 v[92:93], v[48:49], v[184:185], v[92:93] op_sel:[0,0,0] op_sel_hi:[0,1,1]
    v_pk_fma_f32 v[94:95], v[48:49], v[186:187], v[94:95] op_sel:[1,0,0] op_sel_hi:[1,1,1]
    v_pk_fma_f32 v[90:91], v[50:51], v[188:189], v[90:91] op_sel:[0,0,0] op_sel_hi:[0,1,1]
    v_pk_fma_f32 v[92:93], v[50:51], v[190:191], v[92:93] op_sel:[1,0,0] op_sel_hi:[1,1,1]
    s_waitcnt lgkmcnt(4)
    v_pk_fma_f32 v[94:95], v[52:53], v[192:193], v[94:95] op_sel:[0,0,0] op_sel_hi:[0,1,1]
    v_pk_fma_f32 v[90:91], v[52:53], v[194:195], v[90:91] op_sel:[1,0,0] op_sel_hi:[1,1,1]
    v_pk_fma_f32 v[92:93], v[54:55], v[196:197], v[92:93] op_sel:[0,0,0] op_sel_hi:[0,1,1]
    v_pk_fma_f32 v[94:95], v[54:55], v[198:199], v[94:95] op_sel:[1,0,0] op_sel_hi:[1,1,1]
    s_waitcnt lgkmcnt(3)
    v_pk_fma_f32 v[90:91], v[56:57], v[200:201], v[90:91] op_sel:[0,0,0] op_sel_hi:[0,1,1]
    v_pk_fma_f32 v[92:93], v[56:57], v[202:203], v[92:93] op_sel:[1,0,0] op_sel_hi:[1,1,1]
    v_pk_fma_f32 v[94:95], v[58:59], v[204:205], v[94:95] op_sel:[0,0,0] op_sel_hi:[0,1,1]
    v_pk_fma_f32 v[90:91], v[58:59], v[206:207], v[90:91] op_sel:[1,0,0] op_sel_hi:[1,1,1]
    s_waitcnt lgkmcnt(2)
    v_pk_fma_f32 v[92:93], v[60:61], v[208:209], v[92:93] op_sel:[0,0,0] op_sel_hi:[0,1,1]
    v_pk_fma_f32 v[94:95], v[60:61], v[210:211], v[94:95] op_sel:[1,0,0] op_sel_hi:[1,1,1]
    v_pk_fma_f32 v[90:91], v[62:63], v[212:213], v[90:91] op_sel:[0,0,0] op_sel_hi:[0,1,1]
    v_pk_fma_f32 v[92:93], v[62:63], v[214:215], v[92:93] op_sel:[1,0,0] op_sel_hi:[1,1,1]
    s_waitcnt lgkmcnt(1)
    v_pk_fma_f32 v[94:95], v[64:65], v[216:217], v[94:95] op_sel:[0,0,0] op_sel_hi:[0,1,1]
    v_pk_fma_f32 v[90:91], v[64:65], v[218:219], v[90:91] op_sel:[1,0,0] op_sel_hi:[1,1,1]
    v_pk_fma_f32 v[92:93], v[66:67], v[220:221], v[92:93] op_sel:[0,0,0] op_sel_hi:[0,1,1]
    v_pk_fma_f32 v[94:95], v[66:67], v[222:223], v[94:95] op_sel:[1,0,0] op_sel_hi:[1,1,1]
    s_waitcnt lgkmcnt(0)
    v_pk_fma_f32 v[90:91], v[68:69], v[224:225], v[90:91] op_sel:[0,0,0] op_sel_hi:[0,1,1]
    v_pk_fma_f32 v[92:93], v[68:69], v[226:227], v[92:93] op_sel:[1,0,0] op_sel_hi:[1,1,1]
    v_pk_fma_f32 v[94:95], v[70:71], v[228:229], v[94:95] op_sel:[0,0,0] op_sel_hi:[0,1,1]
    v_pk_fma_f32 v[90:91], v[70:71], v[230:231], v[90:91] op_sel:[1,0,0] op_sel_hi:[1,1,1]
    v_pk_add_f32 v[90:91], v[90:91], v[92:93] op_sel:[0,0] op_sel_hi:[1,1]
    v_pk_add_f32 v[90:91], v[90:91], v[94:95] op_sel:[0,0] op_sel_hi:[1,1]
    v_permlane32_swap_b32 v88, v89
    s_nop 0
    v_permlane32_swap_b32 v90, v91
    v_add_f32 v88, v88, v89
    v_add_f32 v90, v90, v91
    s_nop 1
    v_permlane16_swap_b32 v88, v90
    v_add_f32 v88, v88, v90
    v_lshlrev_b32 v74, 2, v0
    v_add_u32 v74, 131072, v74
    ds_write_b32 v74, v88
    v_xor_b32 v74, 256, v74
    s_waitcnt vmcnt(0) lgkmcnt(0)
    s_barrier
    ds_read_b32 v89, v74
    s_lshl_b32 s6, s46, 7
    s_lshr_b32 s5, s44, 1
    s_mul_i32 s5, s5, 14336
    s_add_u32 s6, s6, s5
    s_add_u32 s6, s6, 49152
    v_lshl_add_u32 v74, v1, 2, s6
    s_waitcnt lgkmcnt(0)
    v_add_f32 v88, v88, v89
    v_min_u32 v88, -2, v88
    s_bitcmp1_b32 s3, 0
    s_cbranch_scc1 Lwp_skip
    global_store_dword v74, v88, s[38:39] sc1
Lwp_skip:
    s_branch Lsp_c
Lsp_b3:
    v_lshlrev_b32 v82, 16, v80
    v_and_b32 v83, 0xffff0000, v80
    v_lshlrev_b32 v29, 2, v29
    v_mul_f32 v84, 0xbfb8aa3b, v82
    v_mul_f32 v85, 0xbfb8aa3b, v83
    v_exp_f32 v84, v84
    v_exp_f32 v85, v85
    v_add_f32 v84, 1.0, v84
    v_add_f32 v85, 1.0, v85
    v_rcp_f32 v84, v84
    v_rcp_f32 v85, v85
    v_mul_f32 v82, v82, v84
    v_mul_f32 v83, v83, v85
    v_cvt_pk_bf16_f32 v80, v82, v83
    ds_bpermute_b32 v88, v29, v80 offset:0
    ds_bpermute_b32 v89, v29, v80 offset:32
    ds_bpermute_b32 v90, v29, v80 offset:64
    ds_bpermute_b32 v91, v29, v80 offset:96
    ds_bpermute_b32 v92, v29, v80 offset:128
    s_waitcnt lgkmcnt(4)
    v_lshlrev_b32 v30, 16, v88
    v_and_b32 v31, 0xffff0000, v88
    s_waitcnt lgkmcnt(3)
    v_lshlrev_b32 v32, 16, v89
    v_and_b32 v33, 0xffff0000, v89
    s_waitcnt lgkmcnt(2)
    v_lshlrev_b32 v34, 16, v90
    v_and_b32 v35, 0xffff0000, v90
    s_waitcnt lgkmcnt(1)
    v_lshlrev_b32 v36, 16, v91
    v_and_b32 v37, 0xffff0000, v91
    s_waitcnt lgkmcnt(0)
    v_lshlrev_b32 v38, 16, v92
    v_and_b32 v39, 0xffff0000, v92
    v_lshlrev_b32 v80, 16, v40
    v_and_b32 v81, 0xffff0000, v40
    v_lshlrev_b32 v82, 16, v41
    v_and_b32 v83, 0xffff0000, v41
    v_lshlrev_b32 v84, 16, v42
    v_and_b32 v85, 0xffff0000, v42
    v_lshlrev_b32 v86, 16, v43
    v_and_b32 v87, 0xffff0000, v43
    v_pk_mul_f32 v[88:89], v[30:31], v[80:81] op_sel:[0,0] op_sel_hi:[0,1]
    v_pk_mul_f32 v[90:91], v[30:31], v[82:83] op_sel:[0,0] op_sel_hi:[0,1]
    v_pk_mul_f32 v[92:93], v[30:31], v[84:85] op_sel:[0,0] op_sel_hi:[0,1]
    v_pk_mul_f32 v[94:95], v[30:31], v[86:87] op_sel:[0,0] op_sel_hi:[0,1]
    v_lshlrev_b32 v80, 16, v44
    v_and_b32 v81, 0xffff0000, v44
    v_lshlrev_b32 v82, 16, v45
    v_and_b32 v83, 0xffff0000, v45
    v_lshlrev_b32 v84, 16, v46
    v_and_b32 v85, 0xffff0000, v46
    v_lshlrev_b32 v86, 16, v47
    v_and_b32 v87, 0xffff0000, v47
    v_pk_fma_f32 v[88:89], v[30:31], v[80:81], v[88:89] op_sel:[1,0,0] op_sel_hi:[1,1,1]
    v_pk_fma_f32 v[90:91], v[30:31], v[82:83], v[90:91] op_sel:[1,0,0] op_sel_hi:[1,1,1]
    v_pk_fma_f32 v[92:93], v[30:31], v[84:85], v[92:93] op_sel:[1,0,0] op_sel_hi:[1,1,1]
    v_pk_fma_f32 v[94:95], v[30:31], v[86:87], v[94:95] op_sel:[1,0,0] op_sel_hi:[1,1,1]
    v_lshlrev_b32 v80, 16, v48
    v_and_b32 v81, 0xffff0000, v48
    v_lshlrev_b32 v82, 16, v49
    v_and_b32 v83, 0xffff0000, v49
    v_lshlrev_b32 v84, 16, v50
    v_and_b32 v85, 0xffff0000, v50
    v_lshlrev_b32 v86, 16, v51
    v_and_b32 v87, 0xffff0000, v51
    v_pk_fma_f32 v[88:89], v[32:33], v[80:81], v[88:89] op_sel:[0,0,0] op_sel_hi:[0,1,1]
    v_pk_fma_f32 v[90:91], v[32:33], v[82:83], v[90:91] op_sel:[0,0,0] op_sel_hi:[0,1,1]
    v_pk_fma_f32 v[92:93], v[32:33], v[84:85], v[92:93] op_sel:[0,0,0] op_sel_hi:[0,1,1]
    v_pk_fma_f32 v[94:95], v[32:33], v[86:87], v[94:95] op_sel:[0,0,0] op_sel_hi:[0,1,1]
    v_lshlrev_b32 v80, 16, v52
    v_and_b32 v81, 0xffff0000, v52
    v_lshlrev_b32 v82, 16, v53
    v_and_b32 v83, 0xffff0000, v53
    v_lshlrev_b32 v84, 16, v54
    v_and_b32 v85, 0xffff0000, v54
    v_lshlrev_b32 v86, 16, v55
    v_and_b32 v87, 0xffff0000, v55
    v_pk_fma_f32 v[88:89], v[32:33], v[80:81], v[88:89] op_sel:[1,0,0] op_sel_hi:[1,1,1]
    v_pk_fma_f32 v[90:91], v[32:33], v[82:83], v[90:91] op_sel:[1,0,0] op_sel_hi:[1,1,1]
    v_pk_fma_f32 v[92:93], v[32:33], v[84:85], v[92:93] op_sel:[1,0,0] op_sel_hi:[1,1,1]
    v_pk_fma_f32 v[94:95], v[32:33], v[86:87], v[94:95] op_sel:[1,0,0] op_sel_hi:[1,1,1]
    v_lshlrev_b32 v80, 16, v56
    v_and_b32 v81, 0xffff0000, v56
    v_lshlrev_b32 v82, 16, v57
    v_and_b32 v83, 0xffff0000, v57
    v_lshlrev_b32 v84, 16, v58
    v_and_b32 v85, 0xffff0000, v58
    v_lshlrev_b32 v86, 16, v59
    v_and_b32 v87, 0xffff0000, v59
    v_pk_fma_f32 v[88:89], v[34:35], v[80:81], v[88:89] op_sel:[0,0,0] op_sel_hi:[0,1,1]
    v_pk_fma_f32 v[90:91], v[34:35], v[82:83], v[90:91] op_sel:[0,0,0] op_sel_hi:[0,1,1]
    v_pk_fma_f32 v[92:93], v[34:35], v[84:85], v[92:93] op_sel:[0,0,0] op_sel_hi:[0,1,1]
    v_pk_fma_f32 v[94:95], v[34:35], v[86:87], v[94:95] op_sel:[0,0,0] op_sel_hi:[0,1,1]
    v_lshlrev_b32 v80, 16, v60
    v_and_b32 v81, 0xffff0000, v60
    v_lshlrev_b32 v82, 16, v61
    v_and_b32 v83, 0xffff0000, v61
    v_lshlrev_b32 v84, 16, v62
    v_and_b32 v85, 0xffff0000, v62
    v_lshlrev_b32 v86, 16, v63
    v_and_b32 v87, 0xffff0000, v63
    v_pk_fma_f32 v[88:89], v[34:35], v[80:81], v[88:89] op_sel:[1,0,0] op_sel_hi:[1,1,1]
    v_pk_fma_f32 v[90:91], v[34:35], v[82:83], v[90:91] op_sel:[1,0,0] op_sel_hi:[1,1,1]
    v_pk_fma_f32 v[92:93], v[34:35], v[84:85], v[92:93] op_sel:[1,0,0] op_sel_hi:[1,1,1]
    v_pk_fma_f32 v[94:95], v[34:35], v[86:87], v[94:95] op_sel:[1,0,0] op_sel_hi:[1,1,1]
    v_lshlrev_b32 v80, 16, v64
    v_and_b32 v81, 0xffff0000, v64
    v_lshlrev_b32 v82, 16, v65
    v_and_b32 v83, 0xffff0000, v65
    v_lshlrev_b32 v84, 16, v66
    v_and_b32 v85, 0xffff0000, v66
    v_lshlrev_b32 v86, 16, v67
    v_and_b32 v87, 0xffff0000, v67
    v_pk_fma_f32 v[88:89], v[36:37], v[80:81], v[88:89] op_sel:[0,0,0] op_sel_hi:[0,1,1]
    v_pk_fma_f32 v[90:91], v[36:37], v[82:83], v[90:91] op_sel:[0,0,0] op_sel_hi:[0,1,1]
    v_pk_fma_f32 v[92:93], v[36:37], v[84:85], v[92:93] op_sel:[0,0,0] op_sel_hi:[0,1,1]
    v_pk_fma_f32 v[94:95], v[36:37], v[86:87], v[94:95] op_sel:[0,0,0] op_sel_hi:[0,1,1]
    v_lshlrev_b32 v80, 16, v68
    v_and_b32 v81, 0xffff0000, v68
    v_lshlrev_b32 v82, 16, v69
    v_and_b32 v83, 0xffff0000, v69
    v_lshlrev_b32 v84, 16, v70
    v_and_b32 v85, 0xffff0000, v70
    v_lshlrev_b32 v86, 16, v71
    v_and_b32 v87, 0xffff0000, v71
    v_pk_fma_f32 v[88:89], v[36:37], v[80:81], v[88:89] op_sel:[1,0,0] op_sel_hi:[1,1,1]
    v_pk_fma_f32 v[90:91], v[36:37], v[82:83], v[90:91] op_sel:[1,0,0] op_sel_hi:[1,1,1]
    v_pk_fma_f32 v[92:93], v[36:37], v[84:85], v[92:93] op_sel:[1,0,0] op_sel_hi:[1,1,1]
    v_pk_fma_f32 v[94:95], v[36:37], v[86:87], v[94:95] op_sel:[1,0,0] op_sel_hi:[1,1,1]
    v_lshlrev_b32 v80, 16, v72
    v_and_b32 v81, 0xffff0000, v72
    v_lshlrev_b32 v82, 16, v73
    v_and_b32 v83, 0xffff0000, v73
    v_lshlrev_b32 v84, 16, v74
    v_and_b32 v85, 0xffff0000, v74
    v_lshlrev_b32 v86, 16, v75
    v_and_b32 v87, 0xffff0000, v75
    v_pk_fma_f32 v[88:89], v[38:39], v[80:81], v[88:89] op_sel:[0,0,0] op_sel_hi:[0,1,1]
    v_pk_fma_f32 v[90:91], v[38:39], v[82:83], v[90:91] op_sel:[0,0,0] op_sel_hi:[0,1,1]
    v_pk_fma_f32 v[92:93], v[38:39], v[84:85], v[92:93] op_sel:[0,0,0] op_sel_hi:[0,1,1]
    v_pk_fma_f32 v[94:95], v[38:39], v[86:87], v[94:95] op_sel:[0,0,0] op_sel_hi:[0,1,1]
    v_lshlrev_b32 v80, 16, v76
    v_and_b32 v81, 0xffff0000, v76
    v_lshlrev_b32 v82, 16, v77
    v_and_b32 v83, 0xffff0000, v77
    v_lshlrev_b32 v84, 16, v78
    v_and_b32 v85, 0xffff0000, v78
    v_lshlrev_b32 v86, 16, v79
    v_and_b32 v87, 0xffff0000, v79
    v_pk_fma_f32 v[88:89], v[38:39], v[80:81], v[88:89] op_sel:[1,0,0] op_sel_hi:[1,1,1]
    v_pk_fma_f32 v[90:91], v[38:39], v[82:83], v[90:91] op_sel:[1,0,0] op_sel_hi:[1,1,1]
    v_pk_fma_f32 v[92:93], v[38:39], v[84:85], v[92:93] op_sel:[1,0,0] op_sel_hi:[1,1,1]
    v_pk_fma_f32 v[94:95], v[38:39], v[86:87], v[94:95] op_sel:[1,0,0] op_sel_hi:[1,1,1]
    s_nop 0
    v_permlane32_swap_b32 v88, v92
    v_permlane32_swap_b32 v89, v93
    v_permlane32_swap_b32 v90, v94
    v_permlane32_swap_b32 v91, v95
    v_add_f32 v88, v88, v92
    v_add_f32 v89, v89, v93
    v_add_f32 v90, v90, v94
    v_add_f32 v91, v91, v95
    s_nop 0
    v_permlane16_swap_b32 v88, v90
    v_permlane16_swap_b32 v89, v91
    v_add_f32 v88, v88, v90
    v_add_f32 v89, v89, v91
    v_and_b32 v81, 7, v1
    v_lshrrev_b32 v82, 3, v1
    v_add_f32_dpp v80, v88, v88 row_ror:8 row_mask:0xf bank_mask:0x3
    s_nop 1
    v_add_f32_dpp v80, v89, v89 row_ror:8 row_mask:0xf bank_mask:0xc
    v_lshl_add_u32 v81, v81, 3, v82
    s_lshl_b32 s7, s3, 8
    s_add_u32 s7, s7, 124928
    v_lshl_add_u32 v81, v81, 2, s7
    ds_write_b32 v81, v80
    s_waitcnt lgkmcnt(0)
    s_barrier
    v_lshlrev_b32 v81, 2, v1
    v_add_u32 v82, 124928, v81
    ds_read_b32 v88, v82 offset:0
    ds_read_b32 v89, v82 offset:256
    ds_read_b32 v90, v82 offset:512
    ds_read_b32 v91, v82 offset:768
    v_add_u32 v81, s44, v81
    s_waitcnt lgkmcnt(2)
    v_add_f32 v88, v88, v89
    s_waitcnt lgkmcnt(0)
    v_add_f32 v90, v90, v91
    v_add_f32 v88, v88, v90
    v_min_u32 v88, -2, v88
    s_cmp_lg_u32 s3, 0
    s_cbranch_scc1 Lmod_skip_s3
    global_store_dword v81, v88, s[38:39] offset:0 sc1
Lmod_skip_s3:
Lsp_c:
    s_mov_b32 s51, 102400
Lsp_d:
    s_mov_b32 s93, s51
    s_waitcnt lgkmcnt(0)
    s_barrier
    s_lshr_b32 s5, s3, 1
    s_lshl_b32 s5, s5, 5
    s_and_b32 s6, s3, 1
    s_lshl_b32 s6, s6, 2
    s_add_u32 s6, s6, s5
    s_lshl_b32 s5, s40, 6
    s_add_u32 s90, s6, s5
    v_add_lshl_u32 v27, v5, s90, 1
    global_load_ushort v27, v27, s[26:27]
    s_and_b32 s4, s41, 3
    s_cmp_eq_u32 s4, 0
    s_cselect_b32 s5, 8, 0
    s_cmp_le_u32 s4, 1
    s_cselect_b32 s6, 16, 8
    s_cmp_eq_u32 s4, 3
    s_cselect_b32 s50, 16, 24
    s_lshl_b32 s44, s4, 3
    s_bitcmp1_b32 s43, 0
    s_cselect_b32 s46, s6, s5
    s_cselect_b32 s48, s5, s6
    s_lshl_b32 s5, s3, 1
    s_add_u32 s44, s44, s5
    s_add_u32 s45, s44, 1
    s_add_u32 s46, s46, s5
    s_add_u32 s47, s46, 1
    s_add_u32 s48, s48, s5
    s_add_u32 s49, s48, 1
    s_add_u32 s50, s50, s5
    s_add_u32 s51, s50, 1
    s_lshl_b32 s5, s40, 18
    s_lshl_b32 s6, s44, 7
    s_add_u32 s6, s6, s5
    s_add_u32 s68, s24, s6
    s_addc_u32 s69, s25, 0
    s_lshl_b32 s6, s45, 7
    s_add_u32 s6, s6, s5
    s_add_u32 s70, s24, s6
    s_addc_u32 s71, s25, 0
    s_lshl_b32 s6, s46, 7
    s_add_u32 s6, s6, s5
    s_add_u32 s72, s24, s6
    s_addc_u32 s73, s25, 0
    s_lshl_b32 s6, s47, 7
    s_add_u32 s6, s6, s5
    s_add_u32 s74, s24, s6
    s_addc_u32 s75, s25, 0
    s_lshl_b32 s6, s48, 7
    s_add_u32 s6, s6, s5
    s_add_u32 s76, s24, s6
    s_addc_u32 s77, s25, 0
    s_lshl_b32 s6, s49, 7
    s_add_u32 s6, s6, s5
    s_add_u32 s78, s24, s6
    s_addc_u32 s79, s25, 0
    s_lshl_b32 s6, s50, 7
    s_add_u32 s6, s6, s5
    s_add_u32 s80, s24, s6
    s_addc_u32 s81, s25, 0
    s_lshl_b32 s6, s51, 7
    s_add_u32 s6, s6, s5
    s_add_u32 s82, s24, s6
    s_addc_u32 s83, s25, 0
    s_lshl_b32 s89, s3, 14
    s_add_u32 s89, s89, 83200
    v_lshrrev_b32 v28, 3, v1
    v_lshlrev_b32 v28, 12, v28
    v_bfe_u32 v29, v1, 4, 1
    v_xor_b32 v29, v29, v1
    v_and_b32 v29, 7, v29
    v_xor_b32 v64, 0, v29
    v_lshl_add_u32 v64, v64, 4, v28
    v_add_u32 v68, 131072, v64
    v_xor_b32 v65, 2, v29
    v_lshl_add_u32 v65, v65, 4, v28
    v_add_u32 v65, 31744, v65
    v_add_u32 v69, 131072, v65
    v_xor_b32 v66, 4, v29
    v_lshl_add_u32 v66, v66, 4, v28
    v_add_u32 v66, 63488, v66
    v_add_u32 v70, 131072, v66
    v_xor_b32 v67, 6, v29
    v_lshl_add_u32 v67, v67, 4, v28
    v_add_u32 v67, 95232, v67
    v_add_u32 v71, 131072, v67
    s_and_b32 s4, s41, 1
    s_lshl_b32 s5, s3, 1
    s_add_u32 s5, s5, s4
    s_cmp_eq_u32 s5, 7
    s_cselect_b32 s5, 0, s5
    s_mul_i32 s96, s41, 7
    s_add_u32 s96, s96, s5
    s_cmp_lt_u32 s96, 54
    s_cselect_b32 s101, 2, 0
    s_min_u32 s96, s96, 53
    s_cmp_eq_u32 s3, 3
    s_cselect_b32 s101, 1, s101
    s_lshr_b32 s97, s101, 1
    s_cselect_b32 s5, -1, 0
    v_and_b32 v7, s5, v4
    s_add_u32 s97, s97, s96
    s_mul_i32 s4, s96, 20480
    s_add_u32 s5, s4, 7344128
    s_add_u32 s8, s38, s5
    s_addc_u32 s9, s39, 0
    s_add_u32 s5, s4, 7352320
    s_add_u32 s10, s38, s5
    s_addc_u32 s11, s39, 0
    s_add_u32 s5, s4, 7360512
    s_add_u32 s12, s38, s5
    s_addc_u32 s13, s39, 0
    s_mul_i32 s4, s97, 20480
    s_add_u32 s5, s4, 7344128
    s_add_u32 s14, s38, s5
    s_addc_u32 s15, s39, 0
    s_add_u32 s5, s4, 7352320
    s_add_u32 s16, s38, s5
    s_addc_u32 s17, s39, 0
    s_add_u32 s5, s4, 7360512
    s_add_u32 s18, s38, s5
    s_addc_u32 s19, s39, 0
    v_bfe_u32 v28, v1, 3, 1
    s_sub_u32 s4, s97, s96
    v_mul_u32_u24 v28, s4, v28
    v_add_lshl_u32 v28, v28, s96, 7
    v_mul_u32_u24 v29, 7168, v3
    v_add_u32 v28, v28, v29
    v_and_b32 v29, 112, v4
    v_add_u32 v28, v28, v29
    v_add_u32 v28, 49152, v28
    s_lshl_b32 s4, s40, 9
    s_add_u32 s4, s4, 32772
    v_lshl_add_u32 v30, v1, 3, s4
    s_branch Lsu_f
Lsu:
    s_sleep 4
Lsu_f:
    global_load_dwordx4 v[40:43], v28, s[38:39] sc1
    global_load_dword v44, v30, s[38:39] sc1
    s_waitcnt vmcnt(0)
    v_max3_u32 v29, v40, v41, v42
    v_max3_u32 v29, v43, v44, v29
    v_cmp_eq_u32 vcc, -1, v29
    s_add_u32 s100, s100, 1
    s_cmp_ge_u32 s100, 262144
    s_cbranch_scc1 Lsu_x
    s_cbranch_vccnz Lsu
Lsu_x:
    v_permlane32_swap_b32 v40, v42
    v_permlane32_swap_b32 v41, v43
    s_lshl_b32 s4, s3, 9
    s_add_u32 s4, s4, 156672
    v_and_b32 v28, 496, v4
    v_add_f32 v40, v40, v42
    v_add_f32 v41, v41, v43
    v_bfe_u32 v42, v1, 3, 1
    v_cmp_gt_u32 vcc, s101, v42
    v_lshrrev_b32 v42, 5, v1
    v_lshl_add_u32 v28, v42, 3, v28
    v_cndmask_b32 v40, 0, v40, vcc
    v_cndmask_b32 v41, 0, v41, vcc
    v_add_u32 v28, s4, v28
    ds_write_b64 v28, v[40:41]
    s_barrier
    s_cmp_eq_u32 s93, 102400
    s_cbranch_scc1 Lsd_none
    v_mov_b32 v31, s93
    s_cmp_lg_u32 s3, 0
    s_cbranch_scc1 Lsd_skip
    global_store_dword v31, v31, s[38:39] sc1
Lsd_skip:
Lsd_none:
    s_sub_u32 s5, s43, 5
    v_mad_u32_u24 v28, v1, 3, s5
    v_min_u32 v28, 159, v28
    v_lshlrev_b32 v28, 7, v28
    global_load_dwordx4 a[248:251], v4, s[12:13] offset:-1024 sc1
    global_load_dwordx4 a[252:255], v7, s[18:19] offset:-1024 sc1
    global_load_dwordx4 a[240:243], v4, s[12:13] offset:-2048 sc1
    global_load_dwordx4 a[244:247], v7, s[18:19] offset:-2048 sc1
    global_load_dwordx4 a[232:235], v4, s[12:13] offset:-3072 sc1
    global_load_dwordx4 a[236:239], v7, s[18:19] offset:-3072 sc1
    global_load_dwordx4 a[224:227], v4, s[12:13] offset:-4096 sc1
    global_load_dwordx4 a[228:231], v7, s[18:19] offset:-4096 sc1
    global_load_dwordx4 a[216:219], v4, s[10:11] offset:3072 sc1
    global_load_dwordx4 a[220:223], v7, s[16:17] offset:3072 sc1
    global_load_dwordx4 a[208:211], v4, s[10:11] offset:2048 sc1
    global_load_dwordx4 a[212:215], v7, s[16:17] offset:2048 sc1
    global_load_dwordx4 a[200:203], v4, s[10:11] offset:1024 sc1
    global_load_dwordx4 a[204:207], v7, s[16:17] offset:1024 sc1
    global_load_dwordx4 a[192:195], v4, s[10:11] offset:0 sc1
    global_load_dwordx4 a[196:199], v7, s[16:17] offset:0 sc1
    global_load_dwordx4 a[184:187], v4, s[10:11] offset:-1024 sc1
    global_load_dwordx4 a[188:191], v7, s[16:17] offset:-1024 sc1
    global_load_dwordx4 a[176:179], v4, s[10:11] offset:-2048 sc1
    global_load_dwordx4 a[180:183], v7, s[16:17] offset:-2048 sc1
    global_load_dwordx4 a[168:171], v4, s[10:11] offset:-3072 sc1
    global_load_dwordx4 a[172:175], v7, s[16:17] offset:-3072 sc1
    global_load_dwordx4 a[160:163], v4, s[10:11] offset:-4096 sc1
    global_load_dwordx4 a[164:167], v7, s[16:17] offset:-4096 sc1
    global_load_dwordx4 a[152:155], v4, s[8:9] offset:3072 sc1
    global_load_dwordx4 a[156:159], v7, s[14:15] offset:3072 sc1
    global_load_dwordx4 a[144:147], v4, s[8:9] offset:2048 sc1
    global_load_dwordx4 a[148:151], v7, s[14:15] offset:2048 sc1
    global_load_dwordx4 a[136:139], v4, s[8:9] offset:1024 sc1
    global_load_dwordx4 a[140:143], v7, s[14:15] offset:1024 sc1
    global_load_dwordx4 a[128:131], v4, s[8:9] offset:0 sc1
    global_load_dwordx4 a[132:135], v7, s[14:15] offset:0 sc1
    s_mul_i32 s4, s96, 20480
    s_add_u32 s4, s4, 8486912
    v_add_u32 v29, s4, v28
    global_load_dword v32, v29, s[38:39] sc1
    s_mul_i32 s4, s97, 20480
    s_add_u32 s4, s4, 8486912
    v_add_u32 v29, s4, v28
    global_load_dword v33, v29, s[38:39] sc1
    s_add_u32 m0, s89, 0
    s_nop 0
    global_load_lds_dwordx4 v64, s[68:69] offset:0
    global_load_lds_dwordx4 v65, s[68:69] offset:1024
    global_load_lds_dwordx4 v66, s[68:69] offset:2048
    global_load_lds_dwordx4 v67, s[68:69] offset:3072
    s_add_u32 m0, s89, 4096
    s_nop 0
    global_load_lds_dwordx4 v68, s[68:69] offset:0
    global_load_lds_dwordx4 v69, s[68:69] offset:1024
    global_load_lds_dwordx4 v70, s[68:69] offset:2048
    global_load_lds_dwordx4 v71, s[68:69] offset:3072
    s_barrier
    s_branch Ljoin
Lic_r:
    s_branch Lic_p_f
Lic_p:
    s_sleep 4
Lic_p_f:
    global_load_ushort v213, v212, s[36:37] sc1
    s_waitcnt vmcnt(0)
    v_cmp_eq_u32 vcc, 0, v213
    s_add_u32 s100, s100, 1
    s_cmp_ge_u32 s100, 262144
    s_cbranch_scc1 Lic_p_x
    s_cbranch_vccnz Lic_p
Lic_p_x:
    s_branch Lic_ok
Lic2_r:
    s_branch Lic2_p_f
Lic2_p:
    s_sleep 4
Lic2_p_f:
    global_load_ushort v42, v41, s[36:37] sc1
    s_waitcnt vmcnt(0)
    v_cmp_eq_u32 vcc, 0, v42
    s_add_u32 s100, s100, 1
    s_cmp_ge_u32 s100, 262144
    s_cbranch_scc1 Lic2_p_x
    s_cbranch_vccnz Lic2_p
Lic2_p_x:
    s_branch Lic2_ok
Lkf_r:
    s_nop 7
Lkf_p:
    global_load_dword v137, v136, s[38:39] sc1
    s_waitcnt vmcnt(0)
    v_cmp_eq_u32 vcc, -1, v137
    s_add_u32 s100, s100, 1
    s_cmp_ge_u32 s100, 262144
    s_cbranch_scc1 Lkf_p_x
    s_cbranch_vccnz Lkf_p
Lkf_p_x:
    s_nop 1
    s_branch Lkf_ok
Lcu_r:
    s_nop 7
Lcu_p:
    global_load_dword v222, v137, s[38:39] sc1
    s_waitcnt vmcnt(0)
    v_cmp_eq_u32 vcc, -1, v222
    s_add_u32 s100, s100, 1
    s_cmp_ge_u32 s100, 262144
    s_cbranch_scc1 Lcu_p_x
    s_cbranch_vccnz Lcu_p
Lcu_p_x:
    s_nop 1
    s_branch Lcu_ok
Lax_r:
    s_nop 7
Lax_p:
    v_lshlrev_b32 v28, 4, v0
    v_add_u32 v28, 36864, v28
    global_load_dwordx4 v[202:205], v28, s[38:39] offset:-4096 sc1
    global_load_dwordx4 v[206:209], v28, s[38:39] offset:0 sc1
    v_add_u32 v28, 8192, v28
    global_load_dwordx4 v[210:213], v28, s[38:39] offset:-4096 sc1
    global_load_dwordx4 v[214:217], v28, s[38:39] offset:0 sc1
    v_min_u32 v28, 11, v1
    v_lshrrev_b32 v29, 2, v28
    v_mul_u32_u24 v29, 2544, v29
    v_lshl_add_u32 v28, v28, 2, v29
    s_lshl_b32 s4, s42, 4
    s_add_u32 s4, s4, 0
    v_add_u32 v28, s4, v28
    global_load_dword v182, v28, s[38:39] sc1
    v_add_u32 v28, 15360, v28
    global_load_dword v183, v28, s[38:39] sc1
    s_waitcnt vmcnt(0)
    v_max_u32 v224, v203, v205
    v_max3_u32 v224, v207, v209, v224
    v_max3_u32 v224, v211, v213, v224
    v_max3_u32 v224, v215, v217, v224
    v_max3_u32 v224, v182, v183, v224
    v_cmp_eq_u32 vcc, -1, v224
    s_add_u32 s100, s100, 1
    s_cmp_ge_u32 s100, 262144
    s_cbranch_scc1 Lax_p_x
    s_cbranch_vccnz Lax_p
Lax_p_x:
    s_nop 1
    s_branch Lax_ok
Lcv_r:
    s_nop 7
Lcv_p:
    global_load_dwordx4 v[218:221], v223, s[38:39] sc1
    s_waitcnt vmcnt(0)
    v_max_u32 v224, v218, v219
    v_max3_u32 v224, v220, v221, v224
    v_cmp_eq_u32 vcc, -1, v224
    s_add_u32 s100, s100, 1
    s_cmp_ge_u32 s100, 262144
    s_cbranch_scc1 Lcv_p_x
    s_cbranch_vccnz Lcv_p
Lcv_p_x:
    s_nop 1
    s_branch Lcv_ok
Lgb_r:
    s_nop 7
Lgb_p:
    v_min_u32 v175, 26, v1
    v_lshlrev_b32 v175, 7, v175
    v_add_u32 v175, 98304, v175
    global_load_dword v250, v175, s[38:39] sc1
    s_mul_i32 s7, s41, 320
    s_add_u32 s7, s7, 12800
    v_min_u32 v175, 304, v4
    v_add_u32 v175, s7, v175
    global_load_dwordx4 v[242:245], v175, s[38:39] sc1
    v_add_u32 v175, 15360, v175
    global_load_dwordx4 v[246:249], v175, s[38:39] sc1
    s_waitcnt vmcnt(0)
    v_max3_u32 v28, v242, v243, v244
    v_max3_u32 v28, v245, v246, v28
    v_max3_u32 v28, v247, v248, v28
    v_max3_u32 v28, v249, v250, v28
    v_cmp_eq_u32 vcc, -1, v28
    s_add_u32 s100, s100, 1
    s_cmp_ge_u32 s100, 262144
    s_cbranch_scc1 Lgb_p_x
    s_cbranch_vccnz Lgb_p
Lgb_p_x:
    s_nop 1
    s_branch Lgb_ok
Ls3_r:
    s_nop 7
Ls3_p:
    global_load_dwordx2 v[130:131], v174, s[38:39] offset:0 sc1
    global_load_dwordx2 v[132:133], v174, s[38:39] offset:512 sc1
    global_load_dwordx2 v[134:135], v174, s[38:39] offset:1024 sc1
    global_load_dwordx2 v[136:137], v174, s[38:39] offset:1536 sc1
    global_load_dwordx2 v[138:139], v174, s[38:39] offset:2048 sc1
    global_load_dwordx2 v[140:141], v174, s[38:39] offset:2560 sc1
    global_load_dwordx2 v[142:143], v174, s[38:39] offset:3072 sc1
    global_load_dwordx2 v[144:145], v174, s[38:39] offset:3584 sc1
    s_waitcnt vmcnt(0)
    v_max_u32 v28, v131, v133
    v_max3_u32 v28, v135, v137, v28
    v_max3_u32 v28, v139, v141, v28
    v_max3_u32 v28, v143, v145, v28
    v_cmp_eq_u32 vcc, -1, v28
    s_add_u32 s100, s100, 1
    s_cmp_ge_u32 s100, 262144
    s_cbranch_scc1 Ls3_p_x
    s_cbranch_vccnz Ls3_p
Ls3_p_x:
    s_nop 1
    s_branch Ls3_ok
Lz0_r:
    s_nop 7
Lz0_p:
    global_load_dword v46, v29, s[56:57] offset:1020 sc1
    global_load_dwordx4 v[62:65], v30, s[56:57] offset:-3072 sc1
    global_load_dwordx4 v[66:69], v30, s[56:57] offset:-2048 sc1
    global_load_dwordx4 v[70:73], v30, s[56:57] offset:-1024 sc1
    global_load_dwordx4 v[74:77], v30, s[56:57] offset:0 sc1
    global_load_dwordx4 v[78:81], v30, s[56:57] offset:1024 sc1
    global_load_dwordx4 v[82:85], v30, s[56:57] offset:2048 sc1
    global_load_dwordx4 v[86:89], v30, s[56:57] offset:3072 sc1
    global_load_dwordx4 v[90:93], v31, s[56:57] offset:-3072 sc1
    global_load_dwordx4 v[94:97], v31, s[56:57] offset:-2048 sc1
    global_load_dwordx4 v[98:101], v31, s[56:57] offset:-1024 sc1
    global_load_dwordx4 v[102:105], v31, s[56:57] offset:0 sc1
    global_load_dwordx4 v[106:109], v31, s[56:57] offset:1024 sc1
    global_load_dwordx4 v[110:113], v31, s[56:57] offset:2048 sc1
    global_load_dwordx4 v[114:117], v31, s[56:57] offset:3072 sc1
    global_load_dwordx4 v[118:121], v30, s[58:59] offset:-3072 sc1
    global_load_dwordx4 v[122:125], v30, s[58:59] offset:-2048 sc1
    s_waitcnt vmcnt(0)
    v_bitop3_b32 v28, v46, v65, v69 bitop3:0x80
    v_bitop3_b32 v28, v73, v77, v28 bitop3:0x80
    v_and_b32 v28, 1, v28
    v_cmp_ne_u32 vcc, 1, v28
    s_add_u32 s100, s100, 1
    s_cmp_ge_u32 s100, 262144
    s_cbranch_scc1 Lz0_p_x
    s_cbranch_vccnz Lz0_p
Lz0_p_x:
    s_nop 1
    s_branch Lz0_ok
Lz1_r:
    s_nop 7
Lz1_p:
    global_load_dwordx4 v[78:81], v30, s[56:57] offset:1024 sc1
    global_load_dwordx4 v[82:85], v30, s[56:57] offset:2048 sc1
    global_load_dwordx4 v[86:89], v30, s[56:57] offset:3072 sc1
    global_load_dwordx4 v[90:93], v31, s[56:57] offset:-3072 sc1
    s_waitcnt vmcnt(0)
    v_and_b32 v28, v81, v85
    v_bitop3_b32 v28, v89, v93, v28 bitop3:0x80
    v_and_b32 v28, 1, v28
    v_cmp_ne_u32 vcc, 1, v28
    s_add_u32 s100, s100, 1
    s_cmp_ge_u32 s100, 262144
    s_cbranch_scc1 Lz1_p_x
    s_cbranch_vccnz Lz1_p
Lz1_p_x:
    s_nop 1
    s_branch Lz1_ok
Lz2_r:
    s_nop 7
Lz2_p:
    global_load_dwordx4 v[94:97], v31, s[56:57] offset:-2048 sc1
    global_load_dwordx4 v[98:101], v31, s[56:57] offset:-1024 sc1
    global_load_dwordx4 v[102:105], v31, s[56:57] offset:0 sc1
    global_load_dwordx4 v[106:109], v31, s[56:57] offset:1024 sc1
    s_waitcnt vmcnt(0)
    v_and_b32 v28, v97, v101
    v_bitop3_b32 v28, v105, v109, v28 bitop3:0x80
    v_and_b32 v28, 1, v28
    v_cmp_ne_u32 vcc, 1, v28
    s_add_u32 s100, s100, 1
    s_cmp_ge_u32 s100, 262144
    s_cbranch_scc1 Lz2_p_x
    s_cbranch_vccnz Lz2_p
Lz2_p_x:
    s_nop 1
    s_branch Lz2_ok
Lz3_r:
    s_nop 7
Lz3_p:
    global_load_dwordx4 v[110:113], v31, s[56:57] offset:2048 sc1
    global_load_dwordx4 v[114:117], v31, s[56:57] offset:3072 sc1
    global_load_dwordx4 v[118:121], v30, s[58:59] offset:-3072 sc1
    global_load_dwordx4 v[122:125], v30, s[58:59] offset:-2048 sc1
    s_waitcnt vmcnt(0)
    v_and_b32 v28, v113, v117
    v_bitop3_b32 v28, v121, v125, v28 bitop3:0x80
    v_and_b32 v28, 1, v28
    v_cmp_ne_u32 vcc, 1, v28
    s_add_u32 s100, s100, 1
    s_cmp_ge_u32 s100, 262144
    s_cbranch_scc1 Lz3_p_x
    s_cbranch_vccnz Lz3_p
Lz3_p_x:
    s_nop 1
    s_branch Lz3_ok
Lz4_r:
    s_nop 7
Lz4_p:
    global_load_dwordx4 v[126:129], v30, s[58:59] offset:-1024 sc1
    global_load_dwordx4 v[130:133], v30, s[58:59] offset:0 sc1
    global_load_dwordx4 v[134:137], v30, s[58:59] offset:1024 sc1
    global_load_dwordx4 v[138:141], v30, s[58:59] offset:2048 sc1
    s_waitcnt vmcnt(0)
    v_and_b32 v28, v129, v133
    v_bitop3_b32 v28, v137, v141, v28 bitop3:0x80
    v_and_b32 v28, 1, v28
    v_cmp_ne_u32 vcc, 1, v28
    s_add_u32 s100, s100, 1
    s_cmp_ge_u32 s100, 262144
    s_cbranch_scc1 Lz4_p_x
    s_cbranch_vccnz Lz4_p
Lz4_p_x:
    s_nop 1
    s_branch Lz4_ok
Lz5_r:
    s_nop 7
Lz5_p:
    global_load_dwordx4 v[62:65], v30, s[58:59] offset:3072 sc1
    global_load_dwordx4 v[66:69], v31, s[58:59] offset:-3072 sc1
    global_load_dwordx4 v[70:73], v31, s[58:59] offset:-2048 sc1
    global_load_dwordx4 v[74:77], v31, s[58:59] offset:-1024 sc1
    s_waitcnt vmcnt(0)
    v_and_b32 v28, v65, v69
    v_bitop3_b32 v28, v73, v77, v28 bitop3:0x80
    v_and_b32 v28, 1, v28
    v_cmp_ne_u32 vcc, 1, v28
    s_add_u32 s100, s100, 1
    s_cmp_ge_u32 s100, 262144
    s_cbranch_scc1 Lz5_p_x
    s_cbranch_vccnz Lz5_p
Lz5_p_x:
    s_nop 1
    s_branch Lz5_ok
Lz6_r:
    s_nop 7
Lz6_p:
    global_load_dwordx4 v[78:81], v31, s[58:59] offset:0 sc1
    global_load_dwordx4 v[82:85], v31, s[58:59] offset:1024 sc1
    global_load_dwordx4 v[86:89], v31, s[58:59] offset:2048 sc1
    global_load_dwordx4 v[90:93], v31, s[58:59] offset:3072 sc1
    s_waitcnt vmcnt(0)
    v_and_b32 v28, v81, v85
    v_bitop3_b32 v28, v89, v93, v28 bitop3:0x80
    v_and_b32 v28, 1, v28
    v_cmp_ne_u32 vcc, 1, v28
    s_add_u32 s100, s100, 1
    s_cmp_ge_u32 s100, 262144
    s_cbranch_scc1 Lz6_p_x
    s_cbranch_vccnz Lz6_p
Lz6_p_x:
    s_nop 1
    s_branch Lz6_ok
Lz7_r:
    s_nop 7
Lz7_p:
    global_load_dwordx4 v[94:97], v30, s[60:61] offset:-3072 sc1
    global_load_dwordx4 v[98:101], v31, s[60:61] offset:-3072 sc1
    global_load_dwordx4 v[102:105], v30, s[62:63] offset:-3072 sc1
    global_load_dwordx4 v[106:109], v31, s[62:63] offset:-3072 sc1
    s_waitcnt vmcnt(0)
    v_and_b32 v28, v97, v101
    v_bitop3_b32 v28, v105, v109, v28 bitop3:0x80
    v_and_b32 v28, 1, v28
    v_cmp_ne_u32 vcc, 1, v28
    s_add_u32 s100, s100, 1
    s_cmp_ge_u32 s100, 262144
    s_cbranch_scc1 Lz7_p_x
    s_cbranch_vccnz Lz7_p
Lz7_p_x:
    s_nop 1
    s_branch Lz7_ok
Lz8_r:
    s_nop 7
Lz8_p:
    global_load_dwordx4 v[110:113], v30, s[52:53] offset:-3072 sc1
    global_load_dwordx4 v[114:117], v31, s[52:53] offset:-3072 sc1
    global_load_dwordx4 v[118:121], v30, s[54:55] offset:-3072 sc1
    global_load_dwordx4 v[122:125], v31, s[54:55] offset:-3072 sc1
    s_waitcnt vmcnt(0)
    v_and_b32 v28, v113, v117
    v_bitop3_b32 v28, v121, v125, v28 bitop3:0x80
    v_and_b32 v28, 1, v28
    v_cmp_ne_u32 vcc, 1, v28
    s_add_u32 s100, s100, 1
    s_cmp_ge_u32 s100, 262144
    s_cbranch_scc1 Lz8_p_x
    s_cbranch_vccnz Lz8_p
Lz8_p_x:
    s_nop 1
    s_branch Lz8_ok
Lz9_r:
    s_nop 7
Lz9_p:
    global_load_dwordx4 v[126:129], v30, s[64:65] offset:-3072 sc1
    global_load_dwordx4 v[130:133], v31, s[64:65] offset:-3072 sc1
    global_load_dwordx4 v[134:137], v30, s[66:67] offset:-3072 sc1
    global_load_dwordx4 v[138:141], v31, s[66:67] offset:-3072 sc1
    s_waitcnt vmcnt(0)
    v_and_b32 v28, v129, v133
    v_bitop3_b32 v28, v137, v141, v28 bitop3:0x80
    v_and_b32 v28, 1, v28
    v_cmp_ne_u32 vcc, 1, v28
    s_add_u32 s100, s100, 1
    s_cmp_ge_u32 s100, 262144
    s_cbranch_scc1 Lz9_p_x
    s_cbranch_vccnz Lz9_p
Lz9_p_x:
    s_nop 1
    s_branch Lz9_ok
Lz10_r:
    s_nop 7
Lz10_p:
    global_load_dwordx4 v[62:65], v30, s[60:61] offset:-2048 sc1
    global_load_dwordx4 v[66:69], v31, s[60:61] offset:-2048 sc1
    global_load_dwordx4 v[70:73], v30, s[62:63] offset:-2048 sc1
    global_load_dwordx4 v[74:77], v31, s[62:63] offset:-2048 sc1
    s_waitcnt vmcnt(0)
    v_and_b32 v28, v65, v69
    v_bitop3_b32 v28, v73, v77, v28 bitop3:0x80
    v_and_b32 v28, 1, v28
    v_cmp_ne_u32 vcc, 1, v28
    s_add_u32 s100, s100, 1
    s_cmp_ge_u32 s100, 262144
    s_cbranch_scc1 Lz10_p_x
    s_cbranch_vccnz Lz10_p
Lz10_p_x:
    s_nop 1
    s_branch Lz10_ok
Lz11_r:
    s_nop 7
Lz11_p:
    global_load_dwordx4 v[78:81], v30, s[52:53] offset:-2048 sc1
    global_load_dwordx4 v[82:85], v31, s[52:53] offset:-2048 sc1
    global_load_dwordx4 v[86:89], v30, s[54:55] offset:-2048 sc1
    global_load_dwordx4 v[90:93], v31, s[54:55] offset:-2048 sc1
    s_waitcnt vmcnt(0)
    v_and_b32 v28, v81, v85
    v_bitop3_b32 v28, v89, v93, v28 bitop3:0x80
    v_and_b32 v28, 1, v28
    v_cmp_ne_u32 vcc, 1, v28
    s_add_u32 s100, s100, 1
    s_cmp_ge_u32 s100, 262144
    s_cbranch_scc1 Lz11_p_x
    s_cbranch_vccnz Lz11_p
Lz11_p_x:
    s_nop 1
    s_branch Lz11_ok
Lz12_r:
    s_nop 7
Lz12_p:
    global_load_dwordx4 v[94:97], v30, s[64:65] offset:-2048 sc1
    global_load_dwordx4 v[98:101], v31, s[64:65] offset:-2048 sc1
    global_load_dwordx4 v[102:105], v30, s[66:67] offset:-2048 sc1
    global_load_dwordx4 v[106:109], v31, s[66:67] offset:-2048 sc1
    s_waitcnt vmcnt(0)
    v_and_b32 v28, v97, v101
    v_bitop3_b32 v28, v105, v109, v28 bitop3:0x80
    v_and_b32 v28, 1, v28
    v_cmp_ne_u32 vcc, 1, v28
    s_add_u32 s100, s100, 1
    s_cmp_ge_u32 s100, 262144
    s_cbranch_scc1 Lz12_p_x
    s_cbranch_vccnz Lz12_p
Lz12_p_x:
    s_nop 1
    s_branch Lz12_ok
Lz13_r:
    s_nop 7
Lz13_p:
    global_load_dwordx4 v[110:113], v30, s[60:61] offset:-1024 sc1
    global_load_dwordx4 v[114:117], v31, s[60:61] offset:-1024 sc1
    global_load_dwordx4 v[118:121], v30, s[62:63] offset:-1024 sc1
    global_load_dwordx4 v[122:125], v31, s[62:63] offset:-1024 sc1
    s_waitcnt vmcnt(0)
    v_and_b32 v28, v113, v117
    v_bitop3_b32 v28, v121, v125, v28 bitop3:0x80
    v_and_b32 v28, 1, v28
    v_cmp_ne_u32 vcc, 1, v28
    s_add_u32 s100, s100, 1
    s_cmp_ge_u32 s100, 262144
    s_cbranch_scc1 Lz13_p_x
    s_cbranch_vccnz Lz13_p
Lz13_p_x:
    s_nop 1
    s_branch Lz13_ok
Lz14_r:
    s_nop 7
Lz14_p:
    global_load_dwordx4 v[126:129], v30, s[52:53] offset:-1024 sc1
    global_load_dwordx4 v[130:133], v31, s[52:53] offset:-1024 sc1
    global_load_dwordx4 v[134:137], v30, s[54:55] offset:-1024 sc1
    global_load_dwordx4 v[138:141], v31, s[54:55] offset:-1024 sc1
    s_waitcnt vmcnt(0)
    v_and_b32 v28, v129, v133
    v_bitop3_b32 v28, v137, v141, v28 bitop3:0x80
    v_and_b32 v28, 1, v28
    v_cmp_ne_u32 vcc, 1, v28
    s_add_u32 s100, s100, 1
    s_cmp_ge_u32 s100, 262144
    s_cbranch_scc1 Lz14_p_x
    s_cbranch_vccnz Lz14_p
Lz14_p_x:
    s_nop 1
    s_branch Lz14_ok
Lz15_r:
    s_nop 7
Lz15_p:
    global_load_dwordx4 v[62:65], v30, s[64:65] offset:-1024 sc1
    global_load_dwordx4 v[66:69], v31, s[64:65] offset:-1024 sc1
    global_load_dwordx4 v[70:73], v30, s[66:67] offset:-1024 sc1
    global_load_dwordx4 v[74:77], v31, s[66:67] offset:-1024 sc1
    s_waitcnt vmcnt(0)
    v_and_b32 v28, v65, v69
    v_bitop3_b32 v28, v73, v77, v28 bitop3:0x80
    v_and_b32 v28, 1, v28
    v_cmp_ne_u32 vcc, 1, v28
    s_add_u32 s100, s100, 1
    s_cmp_ge_u32 s100, 262144
    s_cbranch_scc1 Lz15_p_x
    s_cbranch_vccnz Lz15_p
Lz15_p_x:
    s_nop 1
    s_branch Lz15_ok
Lz16_r:
    s_nop 7
Lz16_p:
    global_load_dwordx4 v[78:81], v30, s[60:61] offset:0 sc1
    global_load_dwordx4 v[82:85], v31, s[60:61] offset:0 sc1
    global_load_dwordx4 v[86:89], v30, s[62:63] offset:0 sc1
    global_load_dwordx4 v[90:93], v31, s[62:63] offset:0 sc1
    s_waitcnt vmcnt(0)
    v_and_b32 v28, v81, v85
    v_bitop3_b32 v28, v89, v93, v28 bitop3:0x80
    v_and_b32 v28, 1, v28
    v_cmp_ne_u32 vcc, 1, v28
    s_add_u32 s100, s100, 1
    s_cmp_ge_u32 s100, 262144
    s_cbranch_scc1 Lz16_p_x
    s_cbranch_vccnz Lz16_p
Lz16_p_x:
    s_nop 1
    s_branch Lz16_ok
Lz17_r:
    s_nop 7
Lz17_p:
    global_load_dwordx4 v[94:97], v30, s[52:53] offset:0 sc1
    global_load_dwordx4 v[98:101], v31, s[52:53] offset:0 sc1
    global_load_dwordx4 v[102:105], v30, s[54:55] offset:0 sc1
    global_load_dwordx4 v[106:109], v31, s[54:55] offset:0 sc1
    s_waitcnt vmcnt(0)
    v_and_b32 v28, v97, v101
    v_bitop3_b32 v28, v105, v109, v28 bitop3:0x80
    v_and_b32 v28, 1, v28
    v_cmp_ne_u32 vcc, 1, v28
    s_add_u32 s100, s100, 1
    s_cmp_ge_u32 s100, 262144
    s_cbranch_scc1 Lz17_p_x
    s_cbranch_vccnz Lz17_p
Lz17_p_x:
    s_nop 1
    s_branch Lz17_ok
Lz18_r:
    s_nop 7
Lz18_p:
    global_load_dwordx4 v[110:113], v30, s[64:65] offset:0 sc1
    global_load_dwordx4 v[114:117], v31, s[64:65] offset:0 sc1
    global_load_dwordx4 v[118:121], v30, s[66:67] offset:0 sc1
    global_load_dwordx4 v[122:125], v31, s[66:67] offset:0 sc1
    s_waitcnt vmcnt(0)
    v_and_b32 v28, v113, v117
    v_bitop3_b32 v28, v121, v125, v28 bitop3:0x80
    v_and_b32 v28, 1, v28
    v_cmp_ne_u32 vcc, 1, v28
    s_add_u32 s100, s100, 1
    s_cmp_ge_u32 s100, 262144
    s_cbranch_scc1 Lz18_p_x
    s_cbranch_vccnz Lz18_p
Lz18_p_x:
    s_nop 1
    s_branch Lz18_ok
Lz19_r:
    s_nop 7
Lz19_p:
    global_load_dwordx4 v[126:129], v30, s[60:61] offset:1024 sc1
    global_load_dwordx4 v[130:133], v31, s[60:61] offset:1024 sc1
    global_load_dwordx4 v[134:137], v30, s[62:63] offset:1024 sc1
    global_load_dwordx4 v[138:141], v31, s[62:63] offset:1024 sc1
    s_waitcnt vmcnt(0)
    v_and_b32 v28, v129, v133
    v_bitop3_b32 v28, v137, v141, v28 bitop3:0x80
    v_and_b32 v28, 1, v28
    v_cmp_ne_u32 vcc, 1, v28
    s_add_u32 s100, s100, 1
    s_cmp_ge_u32 s100, 262144
    s_cbranch_scc1 Lz19_p_x
    s_cbranch_vccnz Lz19_p
Lz19_p_x:
    s_nop 1
    s_branch Lz19_ok
Lz20_r:
    s_nop 7
Lz20_p:
    global_load_dwordx4 v[62:65], v30, s[52:53] offset:1024 sc1
    global_load_dwordx4 v[66:69], v31, s[52:53] offset:1024 sc1
    global_load_dwordx4 v[70:73], v30, s[54:55] offset:1024 sc1
    global_load_dwordx4 v[74:77], v31, s[54:55] offset:1024 sc1
    s_waitcnt vmcnt(0)
    v_and_b32 v28, v65, v69
    v_bitop3_b32 v28, v73, v77, v28 bitop3:0x80
    v_and_b32 v28, 1, v28
    v_cmp_ne_u32 vcc, 1, v28
    s_add_u32 s100, s100, 1
    s_cmp_ge_u32 s100, 262144
    s_cbranch_scc1 Lz20_p_x
    s_cbranch_vccnz Lz20_p
Lz20_p_x:
    s_nop 1
    s_branch Lz20_ok
Lz21_r:
    s_nop 7
Lz21_p:
    global_load_dwordx4 v[78:81], v30, s[64:65] offset:1024 sc1
    global_load_dwordx4 v[82:85], v31, s[64:65] offset:1024 sc1
    global_load_dwordx4 v[86:89], v30, s[66:67] offset:1024 sc1
    global_load_dwordx4 v[90:93], v31, s[66:67] offset:1024 sc1
    s_waitcnt vmcnt(0)
    v_and_b32 v28, v81, v85
    v_bitop3_b32 v28, v89, v93, v28 bitop3:0x80
    v_and_b32 v28, 1, v28
    v_cmp_ne_u32 vcc, 1, v28
    s_add_u32 s100, s100, 1
    s_cmp_ge_u32 s100, 262144
    s_cbranch_scc1 Lz21_p_x
    s_cbranch_vccnz Lz21_p
Lz21_p_x:
    s_nop 1
    s_branch Lz21_ok
Lz22_r:
    s_nop 7
Lz22_p:
    global_load_dwordx4 v[94:97], v30, s[60:61] offset:2048 sc1
    global_load_dwordx4 v[98:101], v31, s[60:61] offset:2048 sc1
    global_load_dwordx4 v[102:105], v30, s[62:63] offset:2048 sc1
    global_load_dwordx4 v[106:109], v31, s[62:63] offset:2048 sc1
    s_waitcnt vmcnt(0)
    v_and_b32 v28, v97, v101
    v_bitop3_b32 v28, v105, v109, v28 bitop3:0x80
    v_and_b32 v28, 1, v28
    v_cmp_ne_u32 vcc, 1, v28
    s_add_u32 s100, s100, 1
    s_cmp_ge_u32 s100, 262144
    s_cbranch_scc1 Lz22_p_x
    s_cbranch_vccnz Lz22_p
Lz22_p_x:
    s_nop 1
    s_branch Lz22_ok
Lz23_r:
    s_nop 7
Lz23_p:
    global_load_dwordx4 v[110:113], v30, s[52:53] offset:2048 sc1
    global_load_dwordx4 v[114:117], v31, s[52:53] offset:2048 sc1
    global_load_dwordx4 v[118:121], v30, s[54:55] offset:2048 sc1
    global_load_dwordx4 v[122:125], v31, s[54:55] offset:2048 sc1
    s_waitcnt vmcnt(0)
    v_and_b32 v28, v113, v117
    v_bitop3_b32 v28, v121, v125, v28 bitop3:0x80
    v_and_b32 v28, 1, v28
    v_cmp_ne_u32 vcc, 1, v28
    s_add_u32 s100, s100, 1
    s_cmp_ge_u32 s100, 262144
    s_cbranch_scc1 Lz23_p_x
    s_cbranch_vccnz Lz23_p
Lz23_p_x:
    s_nop 1
    s_branch Lz23_ok
Lz24_r:
    s_nop 7
Lz24_p:
    global_load_dwordx4 v[126:129], v30, s[64:65] offset:2048 sc1
    global_load_dwordx4 v[130:133], v31, s[64:65] offset:2048 sc1
    global_load_dwordx4 v[134:137], v30, s[66:67] offset:2048 sc1
    global_load_dwordx4 v[138:141], v31, s[66:67] offset:2048 sc1
    s_waitcnt vmcnt(0)
    v_and_b32 v28, v129, v133
    v_bitop3_b32 v28, v137, v141, v28 bitop3:0x80
    v_and_b32 v28, 1, v28
    v_cmp_ne_u32 vcc, 1, v28
    s_add_u32 s100, s100, 1
    s_cmp_ge_u32 s100, 262144
    s_cbranch_scc1 Lz24_p_x
    s_cbranch_vccnz Lz24_p
Lz24_p_x:
    s_nop 1
    s_branch Lz24_ok
Lz25_r:
    s_nop 7
Lz25_p:
    global_load_dwordx4 v[62:65], v30, s[60:61] offset:3072 sc1
    global_load_dwordx4 v[66:69], v31, s[60:61] offset:3072 sc1
    global_load_dwordx4 v[70:73], v30, s[62:63] offset:3072 sc1
    global_load_dwordx4 v[74:77], v31, s[62:63] offset:3072 sc1
    s_waitcnt vmcnt(0)
    v_and_b32 v28, v65, v69
    v_bitop3_b32 v28, v73, v77, v28 bitop3:0x80
    v_and_b32 v28, 1, v28
    v_cmp_ne_u32 vcc, 1, v28
    s_add_u32 s100, s100, 1
    s_cmp_ge_u32 s100, 262144
    s_cbranch_scc1 Lz25_p_x
    s_cbranch_vccnz Lz25_p
Lz25_p_x:
    s_nop 1
    s_branch Lz25_ok
Lz26_r:
    s_nop 7
Lz26_p:
    global_load_dwordx4 v[78:81], v30, s[52:53] offset:3072 sc1
    global_load_dwordx4 v[82:85], v31, s[52:53] offset:3072 sc1
    global_load_dwordx4 v[86:89], v30, s[54:55] offset:3072 sc1
    global_load_dwordx4 v[90:93], v31, s[54:55] offset:3072 sc1
    s_waitcnt vmcnt(0)
    v_and_b32 v28, v81, v85
    v_bitop3_b32 v28, v89, v93, v28 bitop3:0x80
    v_and_b32 v28, 1, v28
    v_cmp_ne_u32 vcc, 1, v28
    s_add_u32 s100, s100, 1
    s_cmp_ge_u32 s100, 262144
    s_cbranch_scc1 Lz26_p_x
    s_cbranch_vccnz Lz26_p
Lz26_p_x:
    s_nop 1
    s_branch Lz26_ok
Lz27_r:
    s_nop 7
Lz27_p:
    global_load_dwordx4 v[94:97], v30, s[64:65] offset:3072 sc1
    global_load_dwordx4 v[98:101], v31, s[64:65] offset:3072 sc1
    global_load_dwordx4 v[102:105], v30, s[66:67] offset:3072 sc1
    global_load_dwordx4 v[106:109], v31, s[66:67] offset:3072 sc1
    s_waitcnt vmcnt(0)
    v_and_b32 v28, v97, v101
    v_bitop3_b32 v28, v105, v109, v28 bitop3:0x80
    v_and_b32 v28, 1, v28
    v_cmp_ne_u32 vcc, 1, v28
    s_add_u32 s100, s100, 1
    s_cmp_ge_u32 s100, 262144
    s_cbranch_scc1 Lz27_p_x
    s_cbranch_vccnz Lz27_p
Lz27_p_x:
    s_nop 1
    s_branch Lz27_ok
Lp0_r:
    s_nop 7
Lp0_p:
    global_load_dwordx4 v[142:145], v6, s[38:39] offset:-4096 sc1
    global_load_dwordx4 v[146:149], v6, s[38:39] offset:-3072 sc1
    global_load_dwordx4 v[150:153], v6, s[38:39] offset:-2048 sc1
    global_load_dwordx4 v[154:157], v6, s[38:39] offset:-1024 sc1
    global_load_dwordx4 v[158:161], v6, s[38:39] offset:0 sc1
    global_load_dwordx4 v[162:165], v6, s[38:39] offset:1024 sc1
    global_load_dwordx4 v[166:169], v6, s[38:39] offset:2048 sc1
    global_load_dwordx4 v[170:173], v6, s[38:39] offset:3072 sc1
    s_waitcnt vmcnt(0)
    v_or_b32 v28, v145, v149
    v_or3_b32 v28, v153, v157, v28
    v_or3_b32 v28, v161, v165, v28
    v_or3_b32 v28, v169, v173, v28
    v_and_b32 v28, 1, v28
    v_cmp_ne_u32 vcc, 0, v28
    s_add_u32 s100, s100, 1
    s_cmp_ge_u32 s100, 262144
    s_cbranch_scc1 Lp0_p_x
    s_cbranch_vccnz Lp0_p
Lp0_p_x:
    s_nop 1
    s_branch Lp0_ok
Lp1_r:
    s_nop 7
Lp1_p:
    global_load_dwordx4 v[174:177], v7, s[38:39] offset:-4096 sc1
    global_load_dwordx4 v[178:181], v7, s[38:39] offset:-3072 sc1
    global_load_dwordx4 v[182:185], v7, s[38:39] offset:-2048 sc1
    global_load_dwordx4 v[186:189], v7, s[38:39] offset:-1024 sc1
    global_load_dwordx4 v[190:193], v7, s[38:39] offset:0 sc1
    global_load_dwordx4 v[194:197], v7, s[38:39] offset:1024 sc1
    global_load_dwordx4 v[198:201], v7, s[38:39] offset:2048 sc1
    global_load_dwordx4 v[202:205], v7, s[38:39] offset:3072 sc1
    s_waitcnt vmcnt(0)
    v_or_b32 v28, v177, v181
    v_or3_b32 v28, v185, v189, v28
    v_or3_b32 v28, v193, v197, v28
    v_or3_b32 v28, v201, v205, v28
    v_and_b32 v28, 1, v28
    v_cmp_ne_u32 vcc, 0, v28
    s_add_u32 s100, s100, 1
    s_cmp_ge_u32 s100, 262144
    s_cbranch_scc1 Lp1_p_x
    s_cbranch_vccnz Lp1_p
Lp1_p_x:
    s_nop 1
    s_branch Lp1_ok
Lp2_r:
    s_nop 7
Lp2_p:
    global_load_dwordx4 v[206:209], v26, s[38:39] offset:-4096 sc1
    global_load_dwordx4 v[210:213], v26, s[38:39] offset:-3072 sc1
    global_load_dwordx4 v[214:217], v26, s[38:39] offset:-2048 sc1
    global_load_dwordx4 v[218:221], v26, s[38:39] offset:-1024 sc1
    global_load_dwordx4 v[222:225], v26, s[38:39] offset:0 sc1
    global_load_dwordx4 v[226:229], v26, s[38:39] offset:1024 sc1
    global_load_dwordx4 v[230:233], v26, s[38:39] offset:2048 sc1
    s_waitcnt vmcnt(0)
    v_or3_b32 v28, v209, v213, v217
    v_or3_b32 v28, v221, v225, v28
    v_or3_b32 v28, v229, v233, v28
    v_and_b32 v28, 1, v28
    v_cmp_ne_u32 vcc, 0, v28
    s_add_u32 s100, s100, 1
    s_cmp_ge_u32 s100, 262144
    s_cbranch_scc1 Lp2_p_x
    s_cbranch_vccnz Lp2_p
Lp2_p_x:
    s_nop 1
    s_branch Lp2_ok
Lp3_r:
    s_nop 7
Lp3_p:
    global_load_dwordx4 v[238:241], v27, s[38:39] offset:-4096 sc1
    global_load_dwordx4 v[242:245], v27, s[38:39] offset:-3072 sc1
    global_load_dwordx4 v[246:249], v27, s[38:39] offset:-2048 sc1
    global_load_dwordx4 v[250:253], v27, s[38:39] offset:-1024 sc1
    s_waitcnt vmcnt(0)
    v_or_b32 v28, v239, v241
    v_or3_b32 v28, v243, v245, v28
    v_or3_b32 v28, v247, v249, v28
    v_or3_b32 v28, v251, v253, v28
    v_and_b32 v28, 1, v28
    v_cmp_ne_u32 vcc, 0, v28
    s_add_u32 s100, s100, 1
    s_cmp_ge_u32 s100, 262144
    s_cbranch_scc1 Lp3_p_x
    s_cbranch_vccnz Lp3_p
Lp3_p_x:
    s_nop 1
    s_branch Lp3_ok
Lcode_end:
    s_endpgm
.section .rodata,"a"
.p2align 6
.amdhsa_kernel adaLN_cond__ssm_conv_h3__mixer_gmlp__prompt_kernel
  .amdhsa_next_free_vgpr 512
  .amdhsa_next_free_sgpr 102
  .amdhsa_accum_offset 256
  .amdhsa_group_segment_fixed_size 0
  .amdhsa_kernarg_size 128
  .amdhsa_user_sgpr_count 2
  .amdhsa_user_sgpr_kernarg_segment_ptr 1
  .amdhsa_system_sgpr_workgroup_id_x 1
  .amdhsa_float_denorm_mode_32 3
.end_amdhsa_kernel
```

```asm
; @launch grid=(256,1,1) block=(256,1,1) lds=163840
.amdgcn_target "amdgcn-amd-amdhsa--gfx950"
.text
.p2align 8
.globl adaLN_cond__ssm_conv_h3__mixer_gmlp__prompt_kernel
.type adaLN_cond__ssm_conv_h3__mixer_gmlp__prompt_kernel,@function
adaLN_cond__ssm_conv_h3__mixer_gmlp__prompt_kernel:
    s_cmp_ge_u32 s2, 256
    s_cbranch_scc1 Lend
    s_load_dwordx16 s[8:23], s[0:1], 0
    s_load_dwordx16 s[24:39], s[0:1], 64
    v_lshrrev_b32 v2, 6, v0
    v_and_b32 v1, 63, v0
    v_readfirstlane_b32 s3, v2
    s_getpc_b64 s[4:5]
Lpf_adaLN_cond__ssm_conv_h3__mixer_gmlp__prompt_kernel_9:
    s_add_u32 s4, s4, adaLN_cond__ssm_conv_h3__mixer_gmlp__prompt_kernel-Lpf_adaLN_cond__ssm_conv_h3__mixer_gmlp__prompt_kernel_9
    s_addc_u32 s5, s5, -1
    s_lshr_b32 s6, s2, 3
    s_and_b32 s6, s6, 31
    v_mul_u32_u24 v254, 32, v0
    v_add_lshl_u32 v254, v254, s6, 7
    v_min_u32 v254, (Lcode_end-adaLN_cond__ssm_conv_h3__mixer_gmlp__prompt_kernel-4), v254
    global_load_dword v254, v254, s[4:5]
    s_mov_b64 s[58:59], s[4:5]
    v_and_b32 v2, 15, v1
    v_lshrrev_b32 v3, 4, v1
    v_lshlrev_b32 v4, 4, v1
    v_lshrrev_b32 v6, 2, v2
    v_and_b32 v5, 3, v2
    v_lshl_add_u32 v5, v6, 3, v5
    s_mov_b32 s100, 0
    s_and_b32 s4, s2, 7
    s_lshr_b32 s5, s2, 3
    s_lshr_b32 s43, s5, 2
    s_lshr_b32 s6, s43, 1
    s_lshl_b32 s6, s6, 3
    s_and_b32 s7, s4, 6
    s_add_u32 s6, s6, s7
    s_and_b32 s7, s43, 1
    s_add_u32 s40, s6, s7
    s_and_b32 s6, s4, 1
    s_lshl_b32 s6, s6, 2
    s_and_b32 s7, s5, 3
    s_add_u32 s41, s6, s7
    s_mul_i32 s4, s4, 20
    s_add_u32 s42, s4, s5
    s_waitcnt lgkmcnt(0)
    s_mov_b64 s[0:1], s[58:59]
    s_cmp_ge_u32 s2, 160
    s_cbranch_scc1 Lspare
Lconv:
    s_and_b32 s4, s42, 15
    s_lshl_b32 s4, s4, 2
    s_add_u32 s4, s4, s3
    s_mul_i32 s4, s4, 40960
    s_lshr_b32 s5, s42, 4
    s_lshl_b32 s6, s5, 7
    s_add_u32 s4, s4, s6
    v_mul_u32_u24 v38, 10240, v3
    v_lshl_add_u32 v38, v2, 3, v38
    v_add_u32 v38, s4, v38
    v_add_u32 v39, 5120, v38
    global_load_dwordx2 v[48:49], v38, s[10:11] offset:0
    global_load_dwordx2 v[50:51], v38, s[10:11] offset:1280
    global_load_dwordx2 v[52:53], v38, s[10:11] offset:2560
    global_load_dwordx2 v[54:55], v38, s[10:11] offset:3840
    global_load_dwordx2 v[56:57], v39, s[10:11] offset:0
    global_load_dwordx2 v[58:59], v39, s[10:11] offset:1280
    global_load_dwordx2 v[60:61], v39, s[10:11] offset:2560
    global_load_dwordx2 v[62:63], v39, s[10:11] offset:3840
    v_max_u32 v40, 3840, v38
    global_load_dwordx2 v[42:43], v40, s[10:11] offset:-3840
    global_load_dwordx2 v[44:45], v40, s[10:11] offset:-2560
    global_load_dwordx2 v[46:47], v40, s[10:11] offset:-1280
    s_lshl_b32 s5, s5, 9
    v_lshl_add_u32 v40, v2, 5, s5
    global_load_dwordx4 v[80:83], v40, s[14:15] offset:0
    global_load_dwordx4 v[84:87], v40, s[14:15] offset:16
    global_load_dwordx2 v[64:65], v38, s[12:13] offset:0 nt
    global_load_dwordx2 v[66:67], v38, s[12:13] offset:1280 nt
    global_load_dwordx2 v[68:69], v38, s[12:13] offset:2560 nt
    global_load_dwordx2 v[70:71], v38, s[12:13] offset:3840 nt
    global_load_dwordx2 v[72:73], v39, s[12:13] offset:0 nt
    global_load_dwordx2 v[74:75], v39, s[12:13] offset:1280 nt
    global_load_dwordx2 v[76:77], v39, s[12:13] offset:2560 nt
    global_load_dwordx2 v[78:79], v39, s[12:13] offset:3840 nt
    s_lshl_b32 s7, s42, 3
    s_load_dwordx2 s[92:93], s[18:19], s7
    v_mov_b32 v148, 0
    v_mov_b32 v149, 0
    v_mov_b32 v150, 0
    v_mov_b32 v151, 0
    s_mul_i32 s5, s3, 8448
    v_and_b32 v28, 48, v4
    v_add_u32 v28, s5, v28
    ds_write_b128 v28, v[148:151] offset:0
    ds_write_b128 v28, v[148:151] offset:4224
    v_min_u32 v28, 448, v4
    s_mul_i32 s4, s3, 9280
    v_add_u32 v28, s4, v28
    ds_write_b128 v28, v[148:151] offset:37888
    ds_write_b128 v28, v[148:151] offset:42528
    v_add_u32 v31, s5, v4
    v_and_b32 v28, 1, v2
    v_lshrrev_b32 v29, 1, v2
    v_mul_u32_u24 v30, 4224, v28
    v_lshl_add_u32 v30, v29, 3, v30
    v_lshl_add_u32 v30, v3, 4, v30
    v_add_u32 v30, s5, v30
    v_mul_u32_u24 v32, 4640, v28
    v_lshlrev_b32 v29, 6, v29
    v_sub_u32 v32, v32, v29
    v_lshl_add_u32 v32, v3, 4, v32
    s_add_u32 s4, s4, 34256
    v_add_u32 v32, s4, v32
    v_lshl_add_u32 v34, v28, 2, v29
    v_lshl_add_u32 v34, v3, 4, v34
    s_mul_i32 s4, s3, 1056
    s_add_u32 s4, s4, 0
    v_add_u32 v34, s4, v34
    v_lshlrev_b32 v28, 2, v0
    v_sub_u32 v33, 34824, v28
    v_add_u32 v35, 0, v28
    v_lshrrev_b32 v28, 5, v0
    v_mul_u32_u24 v37, 114688, v28
    v_and_b32 v28, 31, v0
    v_lshl_add_u32 v37, v28, 4, v37
    s_lshl_b32 s4, s42, 9
    s_add_u32 s4, s4, 1048576
    v_add_u32 v37, s4, v37
    s_waitcnt lgkmcnt(0)
    s_lshl_b32 s52, s92, 16
    s_lshr_b32 s56, s52, 16
    s_and_b32 s53, s92, 0xffff0000
    s_lshr_b32 s57, s53, 16
    s_lshl_b32 s54, s93, 16
    s_lshr_b32 s58, s54, 16
    s_and_b32 s55, s93, 0xffff0000
    s_lshr_b32 s59, s55, 16
    v_and_b32 v203, 7, v1
    v_lshrrev_b32 v204, 3, v1
    s_lshl_b32 s4, s42, 2
    s_add_u32 s4, s4, s3
    s_lshl_b32 s94, s4, 12
    v_add_u32 v28, s94, v4
    s_mul_i32 s5, s3, 8448
    s_add_u32 m0, s5, 4288
    s_nop 0
    global_load_lds_dwordx4 v28, s[16:17] offset:0 nt
    global_load_lds_dwordx4 v28, s[16:17] offset:1024 nt
    global_load_lds_dwordx4 v28, s[16:17] offset:2048 nt
    global_load_lds_dwordx4 v28, s[16:17] offset:3072 nt
    s_lshr_b32 s5, s3, 1
    s_lshl_b32 s5, s5, 5
    s_and_b32 s6, s3, 1
    s_lshl_b32 s6, s6, 2
    s_add_u32 s6, s6, s5
    s_lshl_b32 s5, s40, 6
    s_add_u32 s90, s6, s5
    v_add_lshl_u32 v27, v5, s90, 1
    global_load_ushort v27, v27, s[26:27]
    s_waitcnt vmcnt(25)
    v_lshlrev_b32 v116, 16, v48
    v_and_b32 v117, 0xffff0000, v48
    v_lshlrev_b32 v118, 16, v49
    v_and_b32 v119, 0xffff0000, v49
    s_waitcnt vmcnt(24)
    v_lshlrev_b32 v120, 16, v50
    v_and_b32 v121, 0xffff0000, v50
    v_lshlrev_b32 v122, 16, v51
    v_and_b32 v123, 0xffff0000, v51
    s_waitcnt vmcnt(23)
    v_lshlrev_b32 v124, 16, v52
    v_and_b32 v125, 0xffff0000, v52
    v_lshlrev_b32 v126, 16, v53
    v_and_b32 v127, 0xffff0000, v53
    s_waitcnt vmcnt(22)
    v_lshlrev_b32 v128, 16, v54
    v_and_b32 v129, 0xffff0000, v54
    v_lshlrev_b32 v130, 16, v55
    v_and_b32 v131, 0xffff0000, v55
    s_waitcnt vmcnt(21)
    v_lshlrev_b32 v132, 16, v56
    v_and_b32 v133, 0xffff0000, v56
    v_lshlrev_b32 v134, 16, v57
    v_and_b32 v135, 0xffff0000, v57
    s_waitcnt vmcnt(20)
    v_lshlrev_b32 v136, 16, v58
    v_and_b32 v137, 0xffff0000, v58
    v_lshlrev_b32 v138, 16, v59
    v_and_b32 v139, 0xffff0000, v59
    s_waitcnt vmcnt(19)
    v_lshlrev_b32 v140, 16, v60
    v_and_b32 v141, 0xffff0000, v60
    v_lshlrev_b32 v142, 16, v61
    v_and_b32 v143, 0xffff0000, v61
    s_waitcnt vmcnt(18)
    v_lshlrev_b32 v144, 16, v62
    v_and_b32 v145, 0xffff0000, v62
    v_lshlrev_b32 v146, 16, v63
    v_and_b32 v147, 0xffff0000, v63
    s_lshl_b32 s4, s42, 2
    s_add_u32 s4, s4, s3
    s_mul_i32 s4, s4, 5120
    s_cmp_lt_u32 s42, 128
    s_cselect_b32 s5, -1, 0
    v_add_u32 v201, s4, v4
    v_and_b32 v201, s5, v201
    v_add_u32 v201, 2048, v201
    global_load_dwordx4 v[180:183], v201, s[8:9] offset:-2048 nt
    global_load_dwordx4 v[184:187], v201, s[8:9] offset:-1024 nt
    global_load_dwordx4 v[188:191], v201, s[8:9] offset:0 nt
    global_load_dwordx4 v[192:195], v201, s[8:9] offset:1024 nt
    global_load_dwordx4 v[196:199], v201, s[8:9] offset:2048 nt
    v_cmp_le_u32 vcc, 1280, v38
    s_waitcnt vmcnt(22)
    s_nop 0
    v_cndmask_b32 v42, 0, v42, vcc
    v_cndmask_b32 v43, 0, v43, vcc
    s_waitcnt vmcnt(21)
    v_cndmask_b32 v44, 0, v44, vcc
    v_cndmask_b32 v45, 0, v45, vcc
    s_waitcnt vmcnt(20)
    v_cndmask_b32 v46, 0, v46, vcc
    v_cndmask_b32 v47, 0, v47, vcc
    v_lshlrev_b32 v104, 16, v42
    v_and_b32 v105, 0xffff0000, v42
    v_lshlrev_b32 v106, 16, v43
    v_and_b32 v107, 0xffff0000, v43
    v_lshlrev_b32 v108, 16, v44
    v_and_b32 v109, 0xffff0000, v44
    v_lshlrev_b32 v110, 16, v45
    v_and_b32 v111, 0xffff0000, v45
    v_lshlrev_b32 v112, 16, v46
    v_and_b32 v113, 0xffff0000, v46
    v_lshlrev_b32 v114, 16, v47
    v_and_b32 v115, 0xffff0000, v47
    s_waitcnt vmcnt(19)
    v_lshlrev_b32 v88, 16, v80
    v_and_b32 v92, 0xffff0000, v80
    v_lshlrev_b32 v96, 16, v81
    v_and_b32 v100, 0xffff0000, v81
    v_lshlrev_b32 v89, 16, v82
    v_and_b32 v93, 0xffff0000, v82
    v_lshlrev_b32 v97, 16, v83
    v_and_b32 v101, 0xffff0000, v83
    s_waitcnt vmcnt(18)
    v_lshlrev_b32 v90, 16, v84
    v_and_b32 v94, 0xffff0000, v84
    v_lshlrev_b32 v98, 16, v85
    v_and_b32 v102, 0xffff0000, v85
    v_lshlrev_b32 v91, 16, v86
    v_and_b32 v95, 0xffff0000, v86
    v_lshlrev_b32 v99, 16, v87
    v_and_b32 v103, 0xffff0000, v87
    v_pk_mul_f32 v[148:149], v[116:117], v[88:89] op_sel:[0,0] op_sel_hi:[1,1]
    v_pk_mul_f32 v[150:151], v[118:119], v[90:91] op_sel:[0,0] op_sel_hi:[1,1]
    v_pk_mul_f32 v[152:153], v[120:121], v[88:89] op_sel:[0,0] op_sel_hi:[1,1]
    v_pk_mul_f32 v[154:155], v[122:123], v[90:91] op_sel:[0,0] op_sel_hi:[1,1]
    v_pk_mul_f32 v[156:157], v[124:125], v[88:89] op_sel:[0,0] op_sel_hi:[1,1]
    v_pk_mul_f32 v[158:159], v[126:127], v[90:91] op_sel:[0,0] op_sel_hi:[1,1]
    v_pk_mul_f32 v[160:161], v[128:129], v[88:89] op_sel:[0,0] op_sel_hi:[1,1]
    v_pk_mul_f32 v[162:163], v[130:131], v[90:91] op_sel:[0,0] op_sel_hi:[1,1]
    v_pk_mul_f32 v[164:165], v[132:133], v[88:89] op_sel:[0,0] op_sel_hi:[1,1]
    v_pk_mul_f32 v[166:167], v[134:135], v[90:91] op_sel:[0,0] op_sel_hi:[1,1]
    v_pk_mul_f32 v[168:169], v[136:137], v[88:89] op_sel:[0,0] op_sel_hi:[1,1]
    v_pk_mul_f32 v[170:171], v[138:139], v[90:91] op_sel:[0,0] op_sel_hi:[1,1]
    v_pk_mul_f32 v[172:173], v[140:141], v[88:89] op_sel:[0,0] op_sel_hi:[1,1]
    v_pk_mul_f32 v[174:175], v[142:143], v[90:91] op_sel:[0,0] op_sel_hi:[1,1]
    v_pk_mul_f32 v[176:177], v[144:145], v[88:89] op_sel:[0,0] op_sel_hi:[1,1]
    v_pk_mul_f32 v[178:179], v[146:147], v[90:91] op_sel:[0,0] op_sel_hi:[1,1]
    v_pk_fma_f32 v[148:149], v[112:113], v[92:93], v[148:149] op_sel:[0,0,0] op_sel_hi:[1,1,1]
    v_pk_fma_f32 v[150:151], v[114:115], v[94:95], v[150:151] op_sel:[0,0,0] op_sel_hi:[1,1,1]
    v_pk_fma_f32 v[152:153], v[116:117], v[92:93], v[152:153] op_sel:[0,0,0] op_sel_hi:[1,1,1]
    v_pk_fma_f32 v[154:155], v[118:119], v[94:95], v[154:155] op_sel:[0,0,0] op_sel_hi:[1,1,1]
    v_pk_fma_f32 v[156:157], v[120:121], v[92:93], v[156:157] op_sel:[0,0,0] op_sel_hi:[1,1,1]
    v_pk_fma_f32 v[158:159], v[122:123], v[94:95], v[158:159] op_sel:[0,0,0] op_sel_hi:[1,1,1]
    v_pk_fma_f32 v[160:161], v[124:125], v[92:93], v[160:161] op_sel:[0,0,0] op_sel_hi:[1,1,1]
    v_pk_fma_f32 v[162:163], v[126:127], v[94:95], v[162:163] op_sel:[0,0,0] op_sel_hi:[1,1,1]
    v_pk_fma_f32 v[164:165], v[128:129], v[92:93], v[164:165] op_sel:[0,0,0] op_sel_hi:[1,1,1]
    v_pk_fma_f32 v[166:167], v[130:131], v[94:95], v[166:167] op_sel:[0,0,0] op_sel_hi:[1,1,1]
    v_pk_fma_f32 v[168:169], v[132:133], v[92:93], v[168:169] op_sel:[0,0,0] op_sel_hi:[1,1,1]
    v_pk_fma_f32 v[170:171], v[134:135], v[94:95], v[170:171] op_sel:[0,0,0] op_sel_hi:[1,1,1]
    v_pk_fma_f32 v[172:173], v[136:137], v[92:93], v[172:173] op_sel:[0,0,0] op_sel_hi:[1,1,1]
    v_pk_fma_f32 v[174:175], v[138:139], v[94:95], v[174:175] op_sel:[0,0,0] op_sel_hi:[1,1,1]
    v_pk_fma_f32 v[176:177], v[140:141], v[92:93], v[176:177] op_sel:[0,0,0] op_sel_hi:[1,1,1]
    v_pk_fma_f32 v[178:179], v[142:143], v[94:95], v[178:179] op_sel:[0,0,0] op_sel_hi:[1,1,1]
    v_pk_fma_f32 v[148:149], v[108:109], v[96:97], v[148:149] op_sel:[0,0,0] op_sel_hi:[1,1,1]
    v_pk_fma_f32 v[150:151], v[110:111], v[98:99], v[150:151] op_sel:[0,0,0] op_sel_hi:[1,1,1]
    v_pk_fma_f32 v[152:153], v[112:113], v[96:97], v[152:153] op_sel:[0,0,0] op_sel_hi:[1,1,1]
    v_pk_fma_f32 v[154:155], v[114:115], v[98:99], v[154:155] op_sel:[0,0,0] op_sel_hi:[1,1,1]
    v_pk_fma_f32 v[156:157], v[116:117], v[96:97], v[156:157] op_sel:[0,0,0] op_sel_hi:[1,1,1]
    v_pk_fma_f32 v[158:159], v[118:119], v[98:99], v[158:159] op_sel:[0,0,0] op_sel_hi:[1,1,1]
    v_pk_fma_f32 v[160:161], v[120:121], v[96:97], v[160:161] op_sel:[0,0,0] op_sel_hi:[1,1,1]
    v_pk_fma_f32 v[162:163], v[122:123], v[98:99], v[162:163] op_sel:[0,0,0] op_sel_hi:[1,1,1]
    v_pk_fma_f32 v[164:165], v[124:125], v[96:97], v[164:165] op_sel:[0,0,0] op_sel_hi:[1,1,1]
    v_pk_fma_f32 v[166:167], v[126:127], v[98:99], v[166:167] op_sel:[0,0,0] op_sel_hi:[1,1,1]
    v_pk_fma_f32 v[168:169], v[128:129], v[96:97], v[168:169] op_sel:[0,0,0] op_sel_hi:[1,1,1]
    v_pk_fma_f32 v[170:171], v[130:131], v[98:99], v[170:171] op_sel:[0,0,0] op_sel_hi:[1,1,1]
    v_pk_fma_f32 v[172:173], v[132:133], v[96:97], v[172:173] op_sel:[0,0,0] op_sel_hi:[1,1,1]
    v_pk_fma_f32 v[174:175], v[134:135], v[98:99], v[174:175] op_sel:[0,0,0] op_sel_hi:[1,1,1]
    v_pk_fma_f32 v[176:177], v[136:137], v[96:97], v[176:177] op_sel:[0,0,0] op_sel_hi:[1,1,1]
    v_pk_fma_f32 v[178:179], v[138:139], v[98:99], v[178:179] op_sel:[0,0,0] op_sel_hi:[1,1,1]
    v_pk_fma_f32 v[148:149], v[104:105], v[100:101], v[148:149] op_sel:[0,0,0] op_sel_hi:[1,1,1]
    v_pk_fma_f32 v[150:151], v[106:107], v[102:103], v[150:151] op_sel:[0,0,0] op_sel_hi:[1,1,1]
    v_pk_fma_f32 v[152:153], v[108:109], v[100:101], v[152:153] op_sel:[0,0,0] op_sel_hi:[1,1,1]
    v_pk_fma_f32 v[154:155], v[110:111], v[102:103], v[154:155] op_sel:[0,0,0] op_sel_hi:[1,1,1]
    v_pk_fma_f32 v[156:157], v[112:113], v[100:101], v[156:157] op_sel:[0,0,0] op_sel_hi:[1,1,1]
    v_pk_fma_f32 v[158:159], v[114:115], v[102:103], v[158:159] op_sel:[0,0,0] op_sel_hi:[1,1,1]
    v_pk_fma_f32 v[160:161], v[116:117], v[100:101], v[160:161] op_sel:[0,0,0] op_sel_hi:[1,1,1]
    v_pk_fma_f32 v[162:163], v[118:119], v[102:103], v[162:163] op_sel:[0,0,0] op_sel_hi:[1,1,1]
    v_pk_fma_f32 v[164:165], v[120:121], v[100:101], v[164:165] op_sel:[0,0,0] op_sel_hi:[1,1,1]
    v_pk_fma_f32 v[166:167], v[122:123], v[102:103], v[166:167] op_sel:[0,0,0] op_sel_hi:[1,1,1]
    v_pk_fma_f32 v[168:169], v[124:125], v[100:101], v[168:169] op_sel:[0,0,0] op_sel_hi:[1,1,1]
    v_pk_fma_f32 v[170:171], v[126:127], v[102:103], v[170:171] op_sel:[0,0,0] op_sel_hi:[1,1,1]
    v_pk_fma_f32 v[172:173], v[128:129], v[100:101], v[172:173] op_sel:[0,0,0] op_sel_hi:[1,1,1]
    v_pk_fma_f32 v[174:175], v[130:131], v[102:103], v[174:175] op_sel:[0,0,0] op_sel_hi:[1,1,1]
    v_pk_fma_f32 v[176:177], v[132:133], v[100:101], v[176:177] op_sel:[0,0,0] op_sel_hi:[1,1,1]
    v_pk_fma_f32 v[178:179], v[134:135], v[102:103], v[178:179] op_sel:[0,0,0] op_sel_hi:[1,1,1]
    s_lshl_b32 s4, s3, 6
    s_sub_u32 s4, 104688, s4
    v_mul_u32_u24 v40, 272, v2
    v_add_u32 v40, s4, v40
    v_lshlrev_b32 v39, 4, v3
    v_sub_u32 v40, v40, v39
    s_waitcnt vmcnt(17)
    v_lshlrev_b32 v104, 16, v64
    v_and_b32 v105, 0xffff0000, v64
    v_lshlrev_b32 v106, 16, v65
    v_and_b32 v107, 0xffff0000, v65
    v_pk_mul_f32 v[148:149], v[148:149], v[104:105] op_sel:[0,0] op_sel_hi:[1,1]
    v_pk_mul_f32 v[150:151], v[150:151], v[106:107] op_sel:[0,0] op_sel_hi:[1,1]
    s_waitcnt vmcnt(16)
    v_lshlrev_b32 v108, 16, v66
    v_and_b32 v109, 0xffff0000, v66
    v_lshlrev_b32 v110, 16, v67
    v_and_b32 v111, 0xffff0000, v67
    v_pk_mul_f32 v[152:153], v[152:153], v[108:109] op_sel:[0,0] op_sel_hi:[1,1]
    v_pk_mul_f32 v[154:155], v[154:155], v[110:111] op_sel:[0,0] op_sel_hi:[1,1]
    s_waitcnt vmcnt(15)
    v_lshlrev_b32 v112, 16, v68
    v_and_b32 v113, 0xffff0000, v68
    v_lshlrev_b32 v114, 16, v69
    v_and_b32 v115, 0xffff0000, v69
    v_pk_mul_f32 v[156:157], v[156:157], v[112:113] op_sel:[0,0] op_sel_hi:[1,1]
    v_pk_mul_f32 v[158:159], v[158:159], v[114:115] op_sel:[0,0] op_sel_hi:[1,1]
    s_waitcnt vmcnt(14)
    v_lshlrev_b32 v116, 16, v70
    v_and_b32 v117, 0xffff0000, v70
    v_lshlrev_b32 v118, 16, v71
    v_and_b32 v119, 0xffff0000, v71
    v_pk_mul_f32 v[160:161], v[160:161], v[116:117] op_sel:[0,0] op_sel_hi:[1,1]
    v_pk_mul_f32 v[162:163], v[162:163], v[118:119] op_sel:[0,0] op_sel_hi:[1,1]
    s_waitcnt vmcnt(13)
    v_lshlrev_b32 v120, 16, v72
    v_and_b32 v121, 0xffff0000, v72
    v_lshlrev_b32 v122, 16, v73
    v_and_b32 v123, 0xffff0000, v73
    v_pk_mul_f32 v[164:165], v[164:165], v[120:121] op_sel:[0,0] op_sel_hi:[1,1]
    v_pk_mul_f32 v[166:167], v[166:167], v[122:123] op_sel:[0,0] op_sel_hi:[1,1]
    s_waitcnt vmcnt(12)
    v_lshlrev_b32 v124, 16, v74
    v_and_b32 v125, 0xffff0000, v74
    v_lshlrev_b32 v126, 16, v75
    v_and_b32 v127, 0xffff0000, v75
    v_pk_mul_f32 v[168:169], v[168:169], v[124:125] op_sel:[0,0] op_sel_hi:[1,1]
    v_pk_mul_f32 v[170:171], v[170:171], v[126:127] op_sel:[0,0] op_sel_hi:[1,1]
    s_waitcnt vmcnt(11)
    v_lshlrev_b32 v128, 16, v76
    v_and_b32 v129, 0xffff0000, v76
    v_lshlrev_b32 v130, 16, v77
    v_and_b32 v131, 0xffff0000, v77
    v_pk_mul_f32 v[172:173], v[172:173], v[128:129] op_sel:[0,0] op_sel_hi:[1,1]
    v_pk_mul_f32 v[174:175], v[174:175], v[130:131] op_sel:[0,0] op_sel_hi:[1,1]
    s_waitcnt vmcnt(10)
    v_lshlrev_b32 v132, 16, v78
    v_and_b32 v133, 0xffff0000, v78
    v_lshlrev_b32 v134, 16, v79
    v_and_b32 v135, 0xffff0000, v79
    v_pk_mul_f32 v[176:177], v[176:177], v[132:133] op_sel:[0,0] op_sel_hi:[1,1]
    v_pk_mul_f32 v[178:179], v[178:179], v[134:135] op_sel:[0,0] op_sel_hi:[1,1]
    v_cvt_pk_bf16_f32 v88, v176, v172
    v_cvt_pk_bf16_f32 v89, v168, v164
    v_cvt_pk_bf16_f32 v90, v160, v156
    v_cvt_pk_bf16_f32 v91, v152, v148
    v_and_b32 v91, -2, v91
    ds_write_b128 v40, v[88:91] offset:0
    v_cvt_pk_bf16_f32 v92, v177, v173
    v_cvt_pk_bf16_f32 v93, v169, v165
    v_cvt_pk_bf16_f32 v94, v161, v157
    v_cvt_pk_bf16_f32 v95, v153, v149
    v_and_b32 v95, -2, v95
    ds_write_b128 v40, v[92:95] offset:4352
    v_cvt_pk_bf16_f32 v96, v178, v174
    v_cvt_pk_bf16_f32 v97, v170, v166
    v_cvt_pk_bf16_f32 v98, v162, v158
    v_cvt_pk_bf16_f32 v99, v154, v150
    v_and_b32 v99, -2, v99
    ds_write_b128 v40, v[96:99] offset:8704
    v_cvt_pk_bf16_f32 v100, v179, v175
    v_cvt_pk_bf16_f32 v101, v171, v167
    v_cvt_pk_bf16_f32 v102, v163, v159
    v_cvt_pk_bf16_f32 v103, v155, v151
    v_and_b32 v103, -2, v103
    ds_write_b128 v40, v[100:103] offset:13056
    s_waitcnt lgkmcnt(0)
    s_barrier
    s_mul_i32 s4, s3, 4352
    s_add_u32 s4, s4, 104448
    v_mul_u32_u24 v40, 272, v3
    v_lshl_add_u32 v40, v2, 4, v40
    v_add_u32 v40, s4, v40
    ds_read_b128 v[148:151], v40 offset:0
    ds_read_b128 v[152:155], v40 offset:1088
    ds_read_b128 v[156:159], v40 offset:2176
    ds_read_b128 v[160:163], v40 offset:3264
    s_lshr_b32 s4, s42, 4
    s_lshl_b32 s4, s4, 6
    s_add_u32 s4, s4, s3
    s_lshl_b32 s4, s4, 12
    s_and_b32 s5, s42, 15
    s_lshl_b32 s5, s5, 8
    s_sub_u32 s4, s4, s5
    s_add_u32 s4, s4, 12586752
    v_lshl_add_u32 v38, v3, 14, s4
    v_lshl_add_u32 v38, v2, 4, v38
    s_waitcnt lgkmcnt(3)
    global_store_dwordx4 v38, v[148:151], s[38:39] sc1
    v_add_u32 v38, 65536, v38
    s_waitcnt lgkmcnt(2)
    global_store_dwordx4 v38, v[152:155], s[38:39] sc1
    v_add_u32 v38, 65536, v38
    s_waitcnt lgkmcnt(1)
    global_store_dwordx4 v38, v[156:159], s[38:39] sc1
    v_add_u32 v38, 65536, v38
    s_waitcnt lgkmcnt(0)
    global_store_dwordx4 v38, v[160:163], s[38:39] sc1
    v_and_b32 v212, 7, v1
    v_lshlrev_b32 v212, 2, v212
    v_mov_b32 v213, 1
    s_cmp_lg_u32 s3, 0
    s_cbranch_scc1 Ldb1
    global_load_dword v213, v212, s[36:37] sc1
Ldb1:
    s_waitcnt vmcnt(10)
    ds_read_b128 v[74:77], v31 offset:4288
    ds_read_b32 v73, v31 offset:4284
    ds_read_b128 v[82:85], v31 offset:5312
    ds_read_b32 v81, v31 offset:5308
    ds_read_b128 v[90:93], v31 offset:6336
    ds_read_b32 v89, v31 offset:6332
    ds_read_b128 v[98:101], v31 offset:7360
    ds_read_b32 v97, v31 offset:7356
    s_waitcnt lgkmcnt(6)
    v_alignbit_b32 v104, v74, v73, 16
    v_alignbit_b32 v105, v75, v74, 16
    v_alignbit_b32 v106, v76, v75, 16
    v_alignbit_b32 v107, v77, v76, 16
    ds_write_b128 v31, v[104:107] offset:64
    s_waitcnt lgkmcnt(5)
    v_alignbit_b32 v108, v82, v81, 16
    v_alignbit_b32 v109, v83, v82, 16
    v_alignbit_b32 v110, v84, v83, 16
    v_alignbit_b32 v111, v85, v84, 16
    ds_write_b128 v31, v[108:111] offset:1088
    s_waitcnt lgkmcnt(4)
    v_alignbit_b32 v112, v90, v89, 16
    v_alignbit_b32 v113, v91, v90, 16
    v_alignbit_b32 v114, v92, v91, 16
    v_alignbit_b32 v115, v93, v92, 16
    ds_write_b128 v31, v[112:115] offset:2112
    s_waitcnt lgkmcnt(3)
    v_alignbit_b32 v116, v98, v97, 16
    v_alignbit_b32 v117, v99, v98, 16
    v_alignbit_b32 v118, v100, v99, 16
    v_alignbit_b32 v119, v101, v100, 16
    ds_write_b128 v31, v[116:119] offset:3136
    ds_read_b64 a[0:1], v30 offset:8
    ds_read_b64 a[2:3], v30 offset:16
    ds_read_b64 a[4:5], v30 offset:72
    ds_read_b64 a[6:7], v30 offset:80
    ds_read_b64 a[8:9], v30 offset:136
    ds_read_b64 a[10:11], v30 offset:144
    ds_read_b64 a[12:13], v30 offset:200
    ds_read_b64 a[14:15], v30 offset:208
    ds_read_b64 a[16:17], v30 offset:264
    ds_read_b64 a[18:19], v30 offset:272
    ds_read_b64 a[20:21], v30 offset:328
    ds_read_b64 a[22:23], v30 offset:336
    ds_read_b64 a[24:25], v30 offset:392
    ds_read_b64 a[26:27], v30 offset:400
    ds_read_b64 a[28:29], v30 offset:456
    ds_read_b64 a[30:31], v30 offset:464
    ds_read_b64 a[32:33], v30 offset:520
    ds_read_b64 a[34:35], v30 offset:528
    ds_read_b64 a[36:37], v30 offset:584
    ds_read_b64 a[38:39], v30 offset:592
    ds_read_b64 a[40:41], v30 offset:648
    ds_read_b64 a[42:43], v30 offset:656
    ds_read_b64 a[44:45], v30 offset:712
    ds_read_b64 a[46:47], v30 offset:720
    ds_read_b64 a[48:49], v30 offset:776
    ds_read_b64 a[50:51], v30 offset:784
    ds_read_b64 a[52:53], v30 offset:840
    ds_read_b64 a[54:55], v30 offset:848
    ds_read_b64 a[56:57], v30 offset:904
    ds_read_b64 a[58:59], v30 offset:912
    ds_read_b64 a[60:61], v30 offset:968
    ds_read_b64 a[62:63], v30 offset:976
    ds_read_b64 a[64:65], v30 offset:1032
    ds_read_b64 a[66:67], v30 offset:1040
    ds_read_b64 a[68:69], v30 offset:1096
    ds_read_b64 a[70:71], v30 offset:1104
    ds_read_b64 a[72:73], v30 offset:1160
    ds_read_b64 a[74:75], v30 offset:1168
    ds_read_b64 a[76:77], v30 offset:1224
    ds_read_b64 a[78:79], v30 offset:1232
    ds_read_b64 a[80:81], v30 offset:1288
    ds_read_b64 a[82:83], v30 offset:1296
    ds_read_b64 a[84:85], v30 offset:1352
    ds_read_b64 a[86:87], v30 offset:1360
    ds_read_b64 a[88:89], v30 offset:1416
    ds_read_b64 a[90:91], v30 offset:1424
    ds_read_b64 a[92:93], v30 offset:1480
    ds_read_b64 a[94:95], v30 offset:1488
    s_mul_i32 s5, s3, 5152
    s_add_u32 s5, s5, 122880
    v_add_u32 v201, s5, v4
    v_lshrrev_b32 v202, 5, v1
    v_lshl_add_u32 v202, v202, 4, v201
    s_waitcnt vmcnt(8)
    ds_write_b128 v201, v[180:183] offset:0
    s_waitcnt vmcnt(7)
    ds_write_b128 v201, v[184:187] offset:1024
    s_waitcnt vmcnt(6)
    ds_write_b128 v202, v[188:191] offset:2048
    s_waitcnt vmcnt(5)
    ds_write_b128 v201, v[192:195] offset:3088
    s_waitcnt vmcnt(4)
    ds_write_b128 v201, v[196:199] offset:4112
    s_lshl_b32 s95, s42, 7
    s_add_u32 s95, s95, 77824
    v_max_u32 v136, 1, v2
    v_lshlrev_b32 v136, 7, v136
    v_xor_b32 v136, s95, v136
    s_add_u32 s4, s94, 12582912
    v_add_u32 v28, s4, v4
    s_mul_i32 s93, s3, 9280
    s_waitcnt vmcnt(0)
    v_cmp_eq_u32 vcc, 0, v213
    s_nop 0
    s_cbranch_vccnz Lic_r
Lic_ok:
    s_waitcnt lgkmcnt(0)
    s_barrier
    v_mov_b32 v29, s95
    s_cmp_lg_u32 s3, 0
    s_cbranch_scc1 Lkf_skip
    global_store_dword v29, v29, s[38:39] sc1
Lkf_skip:
    s_cmp_ge_u32 s42, 128
    s_cbranch_scc1 Lc_j2
    v_mul_u32_u24 v201, 2576, v203
    v_lshl_add_u32 v201, v204, 3, v201
    s_mul_i32 s5, s3, 320
    s_add_u32 s5, s5, 122880
    v_add_u32 v201, s5, v201
    ds_read2_b64 v[180:183], v201 offset0:0 offset1:160
    ds_read2_b64 v[184:187], v201 offset0:8 offset1:168
    ds_read2_b64 v[188:191], v201 offset0:16 offset1:176
    ds_read2_b64 v[192:195], v201 offset0:24 offset1:184
    ds_read2_b64 v[196:199], v201 offset0:32 offset1:192
    s_lshr_b32 s4, s42, 2
    s_mul_i32 s4, s4, 114688
    s_and_b32 s5, s42, 3
    s_lshl_b32 s5, s5, 7
    s_add_u32 s4, s4, s5
    s_mul_i32 s5, s3, 20480
    s_add_u32 s4, s4, s5
    s_add_u32 s4, s4, 1052672
    v_lshl_add_u32 v200, v204, 9, s4
    v_lshl_add_u32 v200, v203, 4, v200
    s_mov_b32 s7, 0x3f803f80
    v_mov_b32 v208, 0
    v_mov_b32 v209, 0
    v_mov_b32 v210, 0
    v_mov_b32 v211, 0
    s_waitcnt lgkmcnt(4)
    v_and_b32 v183, -2, v183
    global_store_dwordx4 v200, v[180:183], s[38:39] offset:-4096 sc1
    s_waitcnt lgkmcnt(3)
    v_and_b32 v187, -2, v187
    global_store_dwordx4 v200, v[184:187], s[38:39] offset:0 sc1
    v_add_u32 v200, 8192, v200
    s_waitcnt lgkmcnt(2)
    v_and_b32 v191, -2, v191
    global_store_dwordx4 v200, v[188:191], s[38:39] offset:-4096 sc1
    s_waitcnt lgkmcnt(1)
    v_and_b32 v195, -2, v195
    global_store_dwordx4 v200, v[192:195], s[38:39] offset:0 sc1
    v_add_u32 v200, 8192, v200
    s_waitcnt lgkmcnt(0)
    v_and_b32 v199, -2, v199
    global_store_dwordx4 v200, v[196:199], s[38:39] offset:-4096 sc1
    v_dot2_f32_bf16 v208, v180, s7, v208
    v_dot2_f32_bf16 v209, v180, v180, v209
    v_dot2_f32_bf16 v210, v182, s7, v210
    v_dot2_f32_bf16 v211, v182, v182, v211
    v_dot2_f32_bf16 v208, v181, s7, v208
    v_dot2_f32_bf16 v209, v181, v181, v209
    v_dot2_f32_bf16 v210, v183, s7, v210
    v_dot2_f32_bf16 v211, v183, v183, v211
    v_dot2_f32_bf16 v208, v184, s7, v208
    v_dot2_f32_bf16 v209, v184, v184, v209
    v_dot2_f32_bf16 v210, v186, s7, v210
    v_dot2_f32_bf16 v211, v186, v186, v211
    v_dot2_f32_bf16 v208, v185, s7, v208
    v_dot2_f32_bf16 v209, v185, v185, v209
    v_dot2_f32_bf16 v210, v187, s7, v210
    v_dot2_f32_bf16 v211, v187, v187, v211
    v_dot2_f32_bf16 v208, v188, s7, v208
    v_dot2_f32_bf16 v209, v188, v188, v209
    v_dot2_f32_bf16 v210, v190, s7, v210
    v_dot2_f32_bf16 v211, v190, v190, v211
    v_dot2_f32_bf16 v208, v189, s7, v208
    v_dot2_f32_bf16 v209, v189, v189, v209
    v_dot2_f32_bf16 v210, v191, s7, v210
    v_dot2_f32_bf16 v211, v191, v191, v211
    v_dot2_f32_bf16 v208, v192, s7, v208
    v_dot2_f32_bf16 v209, v192, v192, v209
    v_dot2_f32_bf16 v210, v194, s7, v210
    v_dot2_f32_bf16 v211, v194, v194, v211
    v_dot2_f32_bf16 v208, v193, s7, v208
    v_dot2_f32_bf16 v209, v193, v193, v209
    v_dot2_f32_bf16 v210, v195, s7, v210
    v_dot2_f32_bf16 v211, v195, v195, v211
    v_dot2_f32_bf16 v208, v196, s7, v208
    v_dot2_f32_bf16 v209, v196, v196, v209
    v_dot2_f32_bf16 v210, v198, s7, v210
    v_dot2_f32_bf16 v211, v198, v198, v211
    v_dot2_f32_bf16 v208, v197, s7, v208
    v_dot2_f32_bf16 v209, v197, v197, v209
    v_dot2_f32_bf16 v210, v199, s7, v210
    v_dot2_f32_bf16 v211, v199, v199, v211
    s_nop 1
    v_permlane32_swap_b32 v208, v210
    v_permlane32_swap_b32 v209, v211
    v_add_f32 v208, v208, v210
    v_add_f32 v209, v209, v211
    s_nop 1
    v_permlane16_swap_b32 v208, v209
    v_add_f32 v208, v208, v209
    v_lshlrev_b32 v201, 4, v203
    v_lshl_add_u32 v201, v3, 2, v201
    v_add_f32_dpp v208, v208, v208 row_ror:8 row_mask:0xf bank_mask:0xf
    s_lshl_b32 s5, s3, 7
    s_add_u32 s5, s5, 143616
    v_add_u32 v201, s5, v201
    ds_write_b32 v201, v208
    s_waitcnt vmcnt(5)
    s_branch Lc_j3
Lc_j2:
    s_waitcnt vmcnt(0)
Lc_j3:
    s_mov_b32 s95, 0
    ds_read_b64 a[96:97], v30 offset:1544
    ds_read_b64 a[98:99], v30 offset:1552
    ds_read_b64 a[100:101], v30 offset:1608
    ds_read_b64 a[102:103], v30 offset:1616
    ds_read_b64 a[104:105], v30 offset:1672
    ds_read_b64 a[106:107], v30 offset:1680
    ds_read_b64 a[108:109], v30 offset:1736
    ds_read_b64 a[110:111], v30 offset:1744
    ds_read_b64 a[112:113], v30 offset:1800
    ds_read_b64 a[114:115], v30 offset:1808
    ds_read_b64 a[116:117], v30 offset:1864
    ds_read_b64 a[118:119], v30 offset:1872
    ds_read_b64 a[120:121], v30 offset:1928
    ds_read_b64 a[122:123], v30 offset:1936
    ds_read_b64 a[124:125], v30 offset:1992
    ds_read_b64 a[126:127], v30 offset:2000
    ds_read_b64 a[128:129], v30 offset:2056
    ds_read_b64 a[130:131], v30 offset:2064
    ds_read_b64 a[132:133], v30 offset:2120
    ds_read_b64 a[134:135], v30 offset:2128
    ds_read_b64 a[136:137], v30 offset:2184
    ds_read_b64 a[138:139], v30 offset:2192
    ds_read_b64 a[140:141], v30 offset:2248
    ds_read_b64 a[142:143], v30 offset:2256
    ds_read_b64 a[144:145], v30 offset:2312
    ds_read_b64 a[146:147], v30 offset:2320
    ds_read_b64 a[148:149], v30 offset:2376
    ds_read_b64 a[150:151], v30 offset:2384
    ds_read_b64 a[152:153], v30 offset:2440
    ds_read_b64 a[154:155], v30 offset:2448
    ds_read_b64 a[156:157], v30 offset:2504
    ds_read_b64 a[158:159], v30 offset:2512
    ds_read_b64 a[160:161], v30 offset:2568
    ds_read_b64 a[162:163], v30 offset:2576
    ds_read_b64 a[164:165], v30 offset:2632
    ds_read_b64 a[166:167], v30 offset:2640
    ds_read_b64 a[168:169], v30 offset:2696
    ds_read_b64 a[170:171], v30 offset:2704
    ds_read_b64 a[172:173], v30 offset:2760
    ds_read_b64 a[174:175], v30 offset:2768
    global_load_dword v137, v136, s[38:39] sc1
    v_min_u32 v41, 49, v1
    v_cmp_lt_u32 vcc, 7, v41
    s_nop 1
    v_cndmask_b32_e64 v42, 0, 7, vcc
    v_add_lshl_u32 v41, v41, v42, 2
    v_mov_b32 v42, 1
    s_cmp_lg_u32 s3, 0
    s_cbranch_scc1 Ldb2
    global_load_dword v42, v41, s[36:37] sc1
Ldb2:
    ds_read_b64 a[176:177], v30 offset:2824
    ds_read_b64 a[178:179], v30 offset:2832
    ds_read_b64 a[180:181], v30 offset:2888
    ds_read_b64 a[182:183], v30 offset:2896
    ds_read_b64 a[184:185], v30 offset:2952
    ds_read_b64 a[186:187], v30 offset:2960
    ds_read_b64 a[188:189], v30 offset:3016
    ds_read_b64 a[190:191], v30 offset:3024
    ds_read_b64 a[192:193], v30 offset:3080
    ds_read_b64 a[194:195], v30 offset:3088
    ds_read_b64 a[196:197], v30 offset:3144
    ds_read_b64 a[198:199], v30 offset:3152
    ds_read_b64 a[200:201], v30 offset:3208
    ds_read_b64 a[202:203], v30 offset:3216
    ds_read_b64 a[204:205], v30 offset:3272
    ds_read_b64 a[206:207], v30 offset:3280
    ds_read_b64 a[208:209], v30 offset:3336
    ds_read_b64 a[210:211], v30 offset:3344
    ds_read_b64 a[212:213], v30 offset:3400
    ds_read_b64 a[214:215], v30 offset:3408
    ds_read_b64 a[216:217], v30 offset:3464
    ds_read_b64 a[218:219], v30 offset:3472
    ds_read_b64 a[220:221], v30 offset:3528
    ds_read_b64 a[222:223], v30 offset:3536
    ds_read_b64 a[224:225], v30 offset:3592
    ds_read_b64 a[226:227], v30 offset:3600
    ds_read_b64 a[228:229], v30 offset:3656
    ds_read_b64 a[230:231], v30 offset:3664
    ds_read_b64 a[232:233], v30 offset:3720
    ds_read_b64 a[234:235], v30 offset:3728
    ds_read_b64 a[236:237], v30 offset:3784
    ds_read_b64 a[238:239], v30 offset:3792
    ds_read_b64 a[240:241], v30 offset:3848
    ds_read_b64 a[242:243], v30 offset:3856
    ds_read_b64 a[244:245], v30 offset:3912
    ds_read_b64 a[246:247], v30 offset:3920
    ds_read_b64 a[248:249], v30 offset:3976
    ds_read_b64 a[250:251], v30 offset:3984
    ds_read_b64 a[252:253], v30 offset:4040
    ds_read_b64 a[254:255], v30 offset:4048
    s_and_b32 s4, s41, 1
    s_lshl_b32 s5, s3, 1
    s_add_u32 s5, s5, s4
    s_cmp_eq_u32 s5, 7
    s_cselect_b32 s5, 0, s5
    s_mul_i32 s96, s41, 7
    s_add_u32 s96, s96, s5
    s_cmp_lt_u32 s96, 54
    s_cselect_b32 s101, 2, 0
    s_min_u32 s96, s96, 53
    s_cmp_eq_u32 s3, 3
    s_cselect_b32 s101, 1, s101
    s_lshr_b32 s97, s101, 1
    s_cselect_b32 s5, -1, 0
    v_and_b32 v7, s5, v4
    s_add_u32 s97, s97, s96
    s_mul_i32 s4, s96, 20480
    s_add_u32 s5, s4, 7344128
    s_add_u32 s8, s38, s5
    s_addc_u32 s9, s39, 0
    s_add_u32 s5, s4, 7352320
    s_add_u32 s10, s38, s5
    s_addc_u32 s11, s39, 0
    s_add_u32 s5, s4, 7360512
    s_add_u32 s12, s38, s5
    s_addc_u32 s13, s39, 0
    s_mul_i32 s4, s97, 20480
    s_add_u32 s5, s4, 7344128
    s_add_u32 s14, s38, s5
    s_addc_u32 s15, s39, 0
    s_add_u32 s5, s4, 7352320
    s_add_u32 s16, s38, s5
    s_addc_u32 s17, s39, 0
    s_add_u32 s5, s4, 7360512
    s_add_u32 s18, s38, s5
    s_addc_u32 s19, s39, 0
    s_and_b32 s4, s41, 3
    s_cmp_eq_u32 s4, 0
    s_cselect_b32 s5, 8, 0
    s_cmp_le_u32 s4, 1
    s_cselect_b32 s6, 16, 8
    s_cmp_eq_u32 s4, 3
    s_cselect_b32 s50, 16, 24
    s_lshl_b32 s44, s4, 3
    s_bitcmp1_b32 s43, 0
    s_cselect_b32 s46, s6, s5
    s_cselect_b32 s48, s5, s6
    s_lshl_b32 s5, s3, 1
    s_add_u32 s44, s44, s5
    s_add_u32 s45, s44, 1
    s_add_u32 s46, s46, s5
    s_add_u32 s47, s46, 1
    s_add_u32 s48, s48, s5
    s_add_u32 s49, s48, 1
    s_add_u32 s50, s50, s5
    s_add_u32 s51, s50, 1
    s_lshl_b32 s5, s40, 18
    s_lshl_b32 s6, s44, 7
    s_add_u32 s6, s6, s5
    s_add_u32 s68, s24, s6
    s_addc_u32 s69, s25, 0
    s_lshl_b32 s6, s45, 7
    s_add_u32 s6, s6, s5
    s_add_u32 s70, s24, s6
    s_addc_u32 s71, s25, 0
    s_lshl_b32 s6, s46, 7
    s_add_u32 s6, s6, s5
    s_add_u32 s72, s24, s6
    s_addc_u32 s73, s25, 0
    s_lshl_b32 s6, s47, 7
    s_add_u32 s6, s6, s5
    s_add_u32 s74, s24, s6
    s_addc_u32 s75, s25, 0
    s_lshl_b32 s6, s48, 7
    s_add_u32 s6, s6, s5
    s_add_u32 s76, s24, s6
    s_addc_u32 s77, s25, 0
    s_lshl_b32 s6, s49, 7
    s_add_u32 s6, s6, s5
    s_add_u32 s78, s24, s6
    s_addc_u32 s79, s25, 0
    s_lshl_b32 s6, s50, 7
    s_add_u32 s6, s6, s5
    s_add_u32 s80, s24, s6
    s_addc_u32 s81, s25, 0
    s_lshl_b32 s6, s51, 7
    s_add_u32 s6, s6, s5
    s_add_u32 s82, s24, s6
    s_addc_u32 s83, s25, 0
    s_lshl_b32 s89, s3, 14
    s_add_u32 s89, s89, 83200
    s_waitcnt vmcnt(0) lgkmcnt(0)
    v_cmp_eq_u32 vcc, 0, v42
    s_nop 0
    s_cbranch_vccnz Lic2_r
Lic2_ok:
    s_barrier
    s_cmp_ge_u32 s42, 128
    s_cbranch_scc1 Lc_j5
    s_cmp_lg_u32 s3, 0
    s_cbranch_scc1 Lc_j5
    v_lshlrev_b32 v201, 3, v2
    v_add_u32 v202, 143616, v201
    ds_read_b64 v[212:213], v202 offset:0
    ds_read_b64 v[214:215], v202 offset:128
    ds_read_b64 v[216:217], v202 offset:256
    ds_read_b64 v[218:219], v202 offset:384
    s_waitcnt lgkmcnt(2)
    v_pk_add_f32 v[212:213], v[212:213], v[214:215] op_sel:[0,0] op_sel_hi:[1,1]
    s_waitcnt lgkmcnt(0)
    v_pk_add_f32 v[216:217], v[216:217], v[218:219] op_sel:[0,0] op_sel_hi:[1,1]
    v_pk_add_f32 v[212:213], v[212:213], v[216:217] op_sel:[0,0] op_sel_hi:[1,1]
    v_mul_f32 v212, 0x3acccccd, v212
    v_mul_f32 v213, 0x3acccccd, v213
    v_fma_f32 v213, -v212, v212, v213
    v_max_f32 v213, 0, v213
    v_add_f32 v213, 0x3727c5ac, v213
    v_rsq_f32 v214, v213
    s_nop 0
    v_mul_f32_e64 v213, -v212, v214
    v_mov_b32 v212, v214
    v_min_u32 v212, -2, v212
    v_min_u32 v213, -2, v213
    s_lshl_b32 s5, s42, 7
    s_add_u32 s5, s5, 32768
    v_add_u32 v201, s5, v201
    global_store_dwordx2 v201, v[212:213], s[38:39] sc1
Lc_j5:
    s_cmp_eq_u32 s95, 1
    s_cbranch_scc1 Lc_k2
    v_cmp_eq_u32 vcc, -1, v137
    s_nop 0
    s_cbranch_vccnz Lkf_r
Lkf_ok:
    s_add_u32 m0, s93, 33804
    s_nop 0
    global_load_lds_dwordx4 v28, s[38:39] offset:0 sc1
    global_load_lds_dwordx4 v28, s[38:39] offset:1024 sc1
    global_load_lds_dwordx4 v28, s[38:39] offset:2048 sc1
    global_load_lds_dwordx4 v28, s[38:39] offset:3072 sc1
    s_add_u32 m0, s93, 38448
    s_nop 0
    global_load_lds_dwordx4 v28, s[38:39] offset:0 sc1
    global_load_lds_dwordx4 v28, s[38:39] offset:1024 sc1
    global_load_lds_dwordx4 v28, s[38:39] offset:2048 sc1
    global_load_lds_dwordx4 v28, s[38:39] offset:3072 sc1
Lc_k2:
    v_bfe_u32 v223, v1, 3, 1
    s_sub_u32 s4, s97, s96
    v_mul_u32_u24 v223, s4, v223
    v_add_lshl_u32 v223, v223, s96, 7
    v_mul_u32_u24 v170, 7168, v3
    v_add_u32 v223, v223, v170
    v_and_b32 v170, 112, v4
    v_add_u32 v223, v223, v170
    v_add_u32 v223, 49152, v223
    v_and_b32 v137, 1, v3
    v_mul_u32_u24 v137, 7168, v137
    v_sub_u32 v137, v223, v137
    v_lshrrev_b32 v170, 3, v1
    v_lshlrev_b32 v170, 12, v170
    v_bfe_u32 v171, v1, 4, 1
    v_xor_b32 v171, v171, v1
    v_and_b32 v171, 7, v171
    v_xor_b32 v8, 0, v171
    v_lshl_add_u32 v8, v8, 4, v170
    v_add_u32 v12, 131072, v8
    v_xor_b32 v9, 2, v171
    v_lshl_add_u32 v9, v9, 4, v170
    v_add_u32 v9, 31744, v9
    v_add_u32 v13, 131072, v9
    v_xor_b32 v10, 4, v171
    v_lshl_add_u32 v10, v10, 4, v170
    v_add_u32 v10, 63488, v10
    v_add_u32 v14, 131072, v10
    v_xor_b32 v11, 6, v171
    v_lshl_add_u32 v11, v11, 4, v170
    v_add_u32 v11, 95232, v11
    v_add_u32 v15, 131072, v11
    s_barrier
    s_cmp_eq_u32 s95, 1
    s_cbranch_scc1 Lc_k3
    s_waitcnt vmcnt(0)
Lc_k3:
    ds_read_b128 v[72:75], v32 offset:3584
    ds_read_b128 v[76:79], v32 offset:3648
    ds_read_b128 v[80:83], v32 offset:3712
    ds_read_b128 v[84:87], v32 offset:3776
    ds_read_b128 v[88:91], v32 offset:3840
    ds_read_b128 v[92:95], v32 offset:3904
    ds_read_b128 v[96:99], v32 offset:3968
    ds_read_b128 v[100:103], v32 offset:4032
    s_waitcnt lgkmcnt(7)
    v_mfma_f32_16x16x32_bf16 v[40:43], a[0:3], v[72:75], 0
    ds_read_b128 v[104:107], v32 offset:3072
    v_mfma_f32_16x16x32_bf16 v[44:47], a[32:35], v[72:75], 0
    ds_read_b128 v[108:111], v32 offset:3136
    s_waitcnt lgkmcnt(8)
    v_mfma_f32_16x16x32_bf16 v[40:43], a[4:7], v[76:79], v[40:43]
    ds_read_b128 v[112:115], v32 offset:3200
    v_mfma_f32_16x16x32_bf16 v[44:47], a[36:39], v[76:79], v[44:47]
    ds_read_b128 v[116:119], v32 offset:3264
    s_waitcnt lgkmcnt(9)
    v_mfma_f32_16x16x32_bf16 v[40:43], a[8:11], v[80:83], v[40:43]
    ds_read_b128 v[120:123], v32 offset:3328
    v_mfma_f32_16x16x32_bf16 v[44:47], a[40:43], v[80:83], v[44:47]
    ds_read_b128 v[124:127], v32 offset:3392
    s_waitcnt lgkmcnt(10)
    v_mfma_f32_16x16x32_bf16 v[40:43], a[12:15], v[84:87], v[40:43]
    ds_read_b128 v[128:131], v32 offset:3456
    v_mfma_f32_16x16x32_bf16 v[44:47], a[44:47], v[84:87], v[44:47]
    ds_read_b128 v[132:135], v32 offset:3520
    s_waitcnt lgkmcnt(11)
    v_mfma_f32_16x16x32_bf16 v[40:43], a[16:19], v[88:91], v[40:43]
    v_mfma_f32_16x16x32_bf16 v[44:47], a[48:51], v[88:91], v[44:47]
    s_waitcnt lgkmcnt(10)
    v_mfma_f32_16x16x32_bf16 v[40:43], a[20:23], v[92:95], v[40:43]
    v_mfma_f32_16x16x32_bf16 v[44:47], a[52:55], v[92:95], v[44:47]
    s_waitcnt lgkmcnt(9)
    v_mfma_f32_16x16x32_bf16 v[40:43], a[24:27], v[96:99], v[40:43]
    v_mfma_f32_16x16x32_bf16 v[44:47], a[56:59], v[96:99], v[44:47]
    s_waitcnt lgkmcnt(8)
    v_mfma_f32_16x16x32_bf16 v[40:43], a[28:31], v[100:103], v[40:43]
    v_mfma_f32_16x16x32_bf16 v[44:47], a[60:63], v[100:103], v[44:47]
    s_waitcnt lgkmcnt(7)
    v_mfma_f32_16x16x32_bf16 v[44:47], a[0:3], v[104:107], v[44:47]
    s_waitcnt lgkmcnt(6)
    v_mfma_f32_16x16x32_bf16 v[44:47], a[4:7], v[108:111], v[44:47]
    s_waitcnt lgkmcnt(5)
    v_mfma_f32_16x16x32_bf16 v[44:47], a[8:11], v[112:115], v[44:47]
    s_waitcnt lgkmcnt(4)
    v_mfma_f32_16x16x32_bf16 v[44:47], a[12:15], v[116:119], v[44:47]
    s_waitcnt lgkmcnt(3)
    v_mfma_f32_16x16x32_bf16 v[44:47], a[16:19], v[120:123], v[44:47]
    v_mov_b32 v162, 0
    s_waitcnt lgkmcnt(2)
    v_mfma_f32_16x16x32_bf16 v[44:47], a[20:23], v[124:127], v[44:47]
    v_mov_b32 v163, 0
    s_waitcnt lgkmcnt(1)
    v_mfma_f32_16x16x32_bf16 v[44:47], a[24:27], v[128:131], v[44:47]
    v_mov_b32 v164, 0
    s_waitcnt lgkmcnt(0)
    v_mfma_f32_16x16x32_bf16 v[44:47], a[28:31], v[132:135], v[44:47]
    v_mfma_f32_16x16x32_bf16 v[48:51], a[64:67], v[72:75], 0
    v_mov_b32 v165, 0
    v_mfma_f32_16x16x32_bf16 v[52:55], a[96:99], v[72:75], 0
    s_min_u32 s5, s42, 127
    v_mfma_f32_16x16x32_bf16 v[56:59], a[128:131], v[72:75], 0
    v_mfma_f32_16x16x32_bf16 v[60:63], a[160:163], v[72:75], 0
    s_lshl_b32 s4, s5, 13
    v_mfma_f32_16x16x32_bf16 v[64:67], a[192:195], v[72:75], 0
    s_add_u32 s4, s4, 15208448
    v_mfma_f32_16x16x32_bf16 v[68:71], a[224:227], v[72:75], 0
    v_mfma_f32_16x16x32_bf16 v[48:51], a[68:71], v[76:79], v[48:51]
    v_lshl_add_u32 v224, v0, 4, s4
    v_mfma_f32_16x16x32_bf16 v[52:55], a[100:103], v[76:79], v[52:55]
    global_store_dwordx4 v224, v[162:165], s[38:39] offset:-4096 sc1
    v_mfma_f32_16x16x32_bf16 v[56:59], a[132:135], v[76:79], v[56:59]
    v_mfma_f32_16x16x32_bf16 v[60:63], a[164:167], v[76:79], v[60:63]
    global_store_dwordx4 v224, v[162:165], s[38:39] offset:0 sc1
    v_mfma_f32_16x16x32_bf16 v[64:67], a[196:199], v[76:79], v[64:67]
    v_mov_b32 v158, -1
    v_mfma_f32_16x16x32_bf16 v[68:71], a[228:231], v[76:79], v[68:71]
    v_mfma_f32_16x16x32_bf16 v[48:51], a[72:75], v[80:83], v[48:51]
    v_mov_b32 v159, -1
    v_mfma_f32_16x16x32_bf16 v[52:55], a[104:107], v[80:83], v[52:55]
    v_mov_b32 v160, -1
    v_mfma_f32_16x16x32_bf16 v[56:59], a[136:139], v[80:83], v[56:59]
    v_mfma_f32_16x16x32_bf16 v[60:63], a[168:171], v[80:83], v[60:63]
    v_mov_b32 v161, -1
    v_mfma_f32_16x16x32_bf16 v[64:67], a[200:203], v[80:83], v[64:67]
    s_lshr_b32 s4, s5, 2
    v_mfma_f32_16x16x32_bf16 v[68:71], a[232:235], v[80:83], v[68:71]
    s_mul_i32 s4, s4, 114688
    v_mfma_f32_16x16x32_bf16 v[48:51], a[76:79], v[84:87], v[48:51]
    v_mfma_f32_16x16x32_bf16 v[52:55], a[108:111], v[84:87], v[52:55]
    s_and_b32 s5, s5, 3
    v_mfma_f32_16x16x32_bf16 v[56:59], a[140:143], v[84:87], v[56:59]
    s_lshl_b32 s5, s5, 13
    v_mfma_f32_16x16x32_bf16 v[60:63], a[172:175], v[84:87], v[60:63]
    v_mfma_f32_16x16x32_bf16 v[64:67], a[204:207], v[84:87], v[64:67]
    s_add_u32 s4, s4, s5
    v_mfma_f32_16x16x32_bf16 v[68:71], a[236:239], v[84:87], v[68:71]
    s_add_u32 s4, s4, 1134592
    v_mfma_f32_16x16x32_bf16 v[48:51], a[80:83], v[88:91], v[48:51]
    v_mfma_f32_16x16x32_bf16 v[52:55], a[112:115], v[88:91], v[52:55]
    v_lshl_add_u32 v224, v0, 4, s4
    v_mfma_f32_16x16x32_bf16 v[56:59], a[144:147], v[88:91], v[56:59]
    global_store_dwordx4 v224, v[158:161], s[38:39] offset:-4096 sc1
    v_mfma_f32_16x16x32_bf16 v[60:63], a[176:179], v[88:91], v[60:63]
    v_mfma_f32_16x16x32_bf16 v[64:67], a[208:211], v[88:91], v[64:67]
    global_store_dwordx4 v224, v[158:161], s[38:39] offset:0 sc1
    v_mfma_f32_16x16x32_bf16 v[68:71], a[240:243], v[88:91], v[68:71]
    s_min_u32 s4, s42, 127
    v_mfma_f32_16x16x32_bf16 v[48:51], a[84:87], v[92:95], v[48:51]
    v_mfma_f32_16x16x32_bf16 v[52:55], a[116:119], v[92:95], v[52:55]
    s_lshl_b32 s4, s4, 10
    v_mfma_f32_16x16x32_bf16 v[56:59], a[148:151], v[92:95], v[56:59]
    s_add_u32 s4, s4, 12451840
    v_mfma_f32_16x16x32_bf16 v[60:63], a[180:183], v[92:95], v[60:63]
    v_mfma_f32_16x16x32_bf16 v[64:67], a[212:215], v[92:95], v[64:67]
    v_lshl_add_u32 v224, v0, 2, s4
    v_mfma_f32_16x16x32_bf16 v[68:71], a[244:247], v[92:95], v[68:71]
    global_store_dword v224, v158, s[38:39] sc1
    v_mfma_f32_16x16x32_bf16 v[48:51], a[88:91], v[96:99], v[48:51]
    v_mfma_f32_16x16x32_bf16 v[52:55], a[120:123], v[96:99], v[52:55]
    v_mfma_f32_16x16x32_bf16 v[56:59], a[152:155], v[96:99], v[56:59]
    v_mfma_f32_16x16x32_bf16 v[60:63], a[184:187], v[96:99], v[60:63]
    v_mfma_f32_16x16x32_bf16 v[64:67], a[216:219], v[96:99], v[64:67]
    v_mfma_f32_16x16x32_bf16 v[68:71], a[248:251], v[96:99], v[68:71]
    v_mfma_f32_16x16x32_bf16 v[48:51], a[92:95], v[100:103], v[48:51]
    v_mfma_f32_16x16x32_bf16 v[52:55], a[124:127], v[100:103], v[52:55]
    v_mfma_f32_16x16x32_bf16 v[56:59], a[156:159], v[100:103], v[56:59]
    v_mfma_f32_16x16x32_bf16 v[60:63], a[188:191], v[100:103], v[60:63]
    v_mfma_f32_16x16x32_bf16 v[64:67], a[220:223], v[100:103], v[64:67]
    v_mfma_f32_16x16x32_bf16 v[68:71], a[252:255], v[100:103], v[68:71]
    v_mfma_f32_16x16x32_bf16 v[48:51], a[32:35], v[104:107], v[48:51]
    v_mfma_f32_16x16x32_bf16 v[52:55], a[64:67], v[104:107], v[52:55]
    v_mfma_f32_16x16x32_bf16 v[56:59], a[96:99], v[104:107], v[56:59]
    v_mfma_f32_16x16x32_bf16 v[60:63], a[128:131], v[104:107], v[60:63]
    v_mfma_f32_16x16x32_bf16 v[64:67], a[160:163], v[104:107], v[64:67]
    v_mfma_f32_16x16x32_bf16 v[68:71], a[192:195], v[104:107], v[68:71]
    v_mfma_f32_16x16x32_bf16 v[48:51], a[36:39], v[108:111], v[48:51]
    v_mfma_f32_16x16x32_bf16 v[52:55], a[68:71], v[108:111], v[52:55]
    v_mfma_f32_16x16x32_bf16 v[56:59], a[100:103], v[108:111], v[56:59]
    v_mfma_f32_16x16x32_bf16 v[60:63], a[132:135], v[108:111], v[60:63]
    v_mfma_f32_16x16x32_bf16 v[64:67], a[164:167], v[108:111], v[64:67]
    v_mfma_f32_16x16x32_bf16 v[68:71], a[196:199], v[108:111], v[68:71]
    v_mfma_f32_16x16x32_bf16 v[48:51], a[40:43], v[112:115], v[48:51]
    v_mfma_f32_16x16x32_bf16 v[52:55], a[72:75], v[112:115], v[52:55]
    v_mfma_f32_16x16x32_bf16 v[56:59], a[104:107], v[112:115], v[56:59]
    v_mfma_f32_16x16x32_bf16 v[60:63], a[136:139], v[112:115], v[60:63]
    v_mfma_f32_16x16x32_bf16 v[64:67], a[168:171], v[112:115], v[64:67]
    v_mfma_f32_16x16x32_bf16 v[68:71], a[200:203], v[112:115], v[68:71]
    v_mfma_f32_16x16x32_bf16 v[48:51], a[44:47], v[116:119], v[48:51]
    v_mfma_f32_16x16x32_bf16 v[52:55], a[76:79], v[116:119], v[52:55]
    v_mfma_f32_16x16x32_bf16 v[56:59], a[108:111], v[116:119], v[56:59]
    v_mfma_f32_16x16x32_bf16 v[60:63], a[140:143], v[116:119], v[60:63]
    v_mfma_f32_16x16x32_bf16 v[64:67], a[172:175], v[116:119], v[64:67]
    v_mfma_f32_16x16x32_bf16 v[68:71], a[204:207], v[116:119], v[68:71]
    v_mfma_f32_16x16x32_bf16 v[48:51], a[48:51], v[120:123], v[48:51]
    v_mfma_f32_16x16x32_bf16 v[52:55], a[80:83], v[120:123], v[52:55]
    v_mfma_f32_16x16x32_bf16 v[56:59], a[112:115], v[120:123], v[56:59]
    v_mfma_f32_16x16x32_bf16 v[60:63], a[144:147], v[120:123], v[60:63]
    v_mfma_f32_16x16x32_bf16 v[64:67], a[176:179], v[120:123], v[64:67]
    v_mfma_f32_16x16x32_bf16 v[68:71], a[208:211], v[120:123], v[68:71]
    v_mfma_f32_16x16x32_bf16 v[48:51], a[52:55], v[124:127], v[48:51]
    v_mfma_f32_16x16x32_bf16 v[52:55], a[84:87], v[124:127], v[52:55]
    v_mfma_f32_16x16x32_bf16 v[56:59], a[116:119], v[124:127], v[56:59]
    v_lshlrev_b32 v28, 4, v0
    v_add_u32 v28, 36864, v28
    v_mfma_f32_16x16x32_bf16 v[60:63], a[148:151], v[124:127], v[60:63]
    global_load_dwordx4 v[202:205], v28, s[38:39] offset:-4096 sc1
    v_mfma_f32_16x16x32_bf16 v[64:67], a[180:183], v[124:127], v[64:67]
    global_load_dwordx4 v[206:209], v28, s[38:39] offset:0 sc1
    v_mfma_f32_16x16x32_bf16 v[68:71], a[212:215], v[124:127], v[68:71]
    v_add_u32 v28, 8192, v28
    global_load_dwordx4 v[210:213], v28, s[38:39] offset:-4096 sc1
    v_mfma_f32_16x16x32_bf16 v[48:51], a[56:59], v[128:131], v[48:51]
    ds_read_b128 v[72:75], v32 offset:2560
    global_load_dwordx4 v[214:217], v28, s[38:39] offset:0 sc1
    v_mfma_f32_16x16x32_bf16 v[52:55], a[88:91], v[128:131], v[52:55]
    ds_read_b128 v[76:79], v32 offset:2624
    v_min_u32 v28, 11, v1
    v_mfma_f32_16x16x32_bf16 v[56:59], a[120:123], v[128:131], v[56:59]
    ds_read_b128 v[80:83], v32 offset:2688
    v_lshrrev_b32 v29, 2, v28
    v_mfma_f32_16x16x32_bf16 v[60:63], a[152:155], v[128:131], v[60:63]
    ds_read_b128 v[84:87], v32 offset:2752
    v_mul_u32_u24 v29, 2544, v29
    v_mfma_f32_16x16x32_bf16 v[64:67], a[184:187], v[128:131], v[64:67]
    ds_read_b128 v[88:91], v32 offset:2816
    v_lshl_add_u32 v28, v28, 2, v29
    s_lshl_b32 s4, s42, 4
    v_mfma_f32_16x16x32_bf16 v[68:71], a[216:219], v[128:131], v[68:71]
    ds_read_b128 v[92:95], v32 offset:2880
    s_add_u32 s4, s4, 0
    v_add_u32 v28, s4, v28
    v_mfma_f32_16x16x32_bf16 v[48:51], a[60:63], v[132:135], v[48:51]
    ds_read_b128 v[96:99], v32 offset:2944
    global_load_dword v182, v28, s[38:39] sc1
    v_mfma_f32_16x16x32_bf16 v[52:55], a[92:95], v[132:135], v[52:55]
    ds_read_b128 v[100:103], v32 offset:3008
    v_add_u32 v28, 15360, v28
    v_mfma_f32_16x16x32_bf16 v[56:59], a[124:127], v[132:135], v[56:59]
    global_load_dword v183, v28, s[38:39] sc1
    v_mfma_f32_16x16x32_bf16 v[60:63], a[156:159], v[132:135], v[60:63]
    v_mfma_f32_16x16x32_bf16 v[64:67], a[188:191], v[132:135], v[64:67]
    global_load_dword v222, v137, s[38:39] sc1
    v_mfma_f32_16x16x32_bf16 v[68:71], a[220:223], v[132:135], v[68:71]
    s_waitcnt lgkmcnt(7)
    v_mfma_f32_16x16x32_bf16 v[48:51], a[0:3], v[72:75], v[48:51]
    ds_read_b128 v[104:107], v32 offset:2048
    v_mfma_f32_16x16x32_bf16 v[52:55], a[32:35], v[72:75], v[52:55]
    ds_read_b128 v[108:111], v32 offset:2112
    s_waitcnt lgkmcnt(8)
    v_mfma_f32_16x16x32_bf16 v[48:51], a[4:7], v[76:79], v[48:51]
    ds_read_b128 v[112:115], v32 offset:2176
    v_mfma_f32_16x16x32_bf16 v[52:55], a[36:39], v[76:79], v[52:55]
    ds_read_b128 v[116:119], v32 offset:2240
    s_waitcnt lgkmcnt(9)
    v_mfma_f32_16x16x32_bf16 v[48:51], a[8:11], v[80:83], v[48:51]
    ds_read_b128 v[120:123], v32 offset:2304
    v_mfma_f32_16x16x32_bf16 v[52:55], a[40:43], v[80:83], v[52:55]
    ds_read_b128 v[124:127], v32 offset:2368
    s_waitcnt lgkmcnt(10)
    v_mfma_f32_16x16x32_bf16 v[48:51], a[12:15], v[84:87], v[48:51]
    ds_read_b128 v[128:131], v32 offset:2432
    v_mfma_f32_16x16x32_bf16 v[52:55], a[44:47], v[84:87], v[52:55]
    ds_read_b128 v[132:135], v32 offset:2496
    s_waitcnt lgkmcnt(11)
    v_mfma_f32_16x16x32_bf16 v[48:51], a[16:19], v[88:91], v[48:51]
    v_mfma_f32_16x16x32_bf16 v[52:55], a[48:51], v[88:91], v[52:55]
    s_waitcnt lgkmcnt(10)
    v_mfma_f32_16x16x32_bf16 v[48:51], a[20:23], v[92:95], v[48:51]
    v_mfma_f32_16x16x32_bf16 v[52:55], a[52:55], v[92:95], v[52:55]
    s_waitcnt lgkmcnt(9)
    v_mfma_f32_16x16x32_bf16 v[48:51], a[24:27], v[96:99], v[48:51]
    v_mfma_f32_16x16x32_bf16 v[52:55], a[56:59], v[96:99], v[52:55]
    s_waitcnt lgkmcnt(8)
    v_mfma_f32_16x16x32_bf16 v[48:51], a[28:31], v[100:103], v[48:51]
    v_mfma_f32_16x16x32_bf16 v[52:55], a[60:63], v[100:103], v[52:55]
    s_waitcnt lgkmcnt(7)
    v_mfma_f32_16x16x32_bf16 v[52:55], a[0:3], v[104:107], v[52:55]
    s_waitcnt lgkmcnt(6)
    v_mfma_f32_16x16x32_bf16 v[52:55], a[4:7], v[108:111], v[52:55]
    s_waitcnt lgkmcnt(5)
    v_mfma_f32_16x16x32_bf16 v[52:55], a[8:11], v[112:115], v[52:55]
    s_waitcnt lgkmcnt(4)
    v_mfma_f32_16x16x32_bf16 v[52:55], a[12:15], v[116:119], v[52:55]
    s_waitcnt lgkmcnt(3)
    v_mfma_f32_16x16x32_bf16 v[52:55], a[16:19], v[120:123], v[52:55]
    s_waitcnt lgkmcnt(2)
    v_mfma_f32_16x16x32_bf16 v[52:55], a[20:23], v[124:127], v[52:55]
    s_waitcnt lgkmcnt(1)
    v_mfma_f32_16x16x32_bf16 v[52:55], a[24:27], v[128:131], v[52:55]
    s_waitcnt lgkmcnt(0)
    v_mfma_f32_16x16x32_bf16 v[52:55], a[28:31], v[132:135], v[52:55]
    v_mfma_f32_16x16x32_bf16 v[56:59], a[64:67], v[72:75], v[56:59]
    v_mfma_f32_16x16x32_bf16 v[60:63], a[96:99], v[72:75], v[60:63]
    v_mfma_f32_16x16x32_bf16 v[64:67], a[128:131], v[72:75], v[64:67]
    v_mfma_f32_16x16x32_bf16 v[68:71], a[160:163], v[72:75], v[68:71]
    v_mfma_f32_16x16x32_bf16 v[56:59], a[68:71], v[76:79], v[56:59]
    v_mfma_f32_16x16x32_bf16 v[60:63], a[100:103], v[76:79], v[60:63]
    v_mfma_f32_16x16x32_bf16 v[64:67], a[132:135], v[76:79], v[64:67]
    v_mfma_f32_16x16x32_bf16 v[68:71], a[164:167], v[76:79], v[68:71]
    v_mfma_f32_16x16x32_bf16 v[56:59], a[72:75], v[80:83], v[56:59]
    s_waitcnt vmcnt(0)
    v_cmp_eq_u32 vcc, -1, v222
    v_mfma_f32_16x16x32_bf16 v[60:63], a[104:107], v[80:83], v[60:63]
    v_mfma_f32_16x16x32_bf16 v[64:67], a[136:139], v[80:83], v[64:67]
    s_cbranch_vccnz Lcu_r
Lcu_ok:
    v_mfma_f32_16x16x32_bf16 v[68:71], a[168:171], v[80:83], v[68:71]
    v_mfma_f32_16x16x32_bf16 v[56:59], a[76:79], v[84:87], v[56:59]
    v_cvt_pk_bf16_f32 v138, v40, v41
    global_load_dwordx4 a[248:251], v4, s[12:13] offset:-1024 sc1
    v_mfma_f32_16x16x32_bf16 v[60:63], a[108:111], v[84:87], v[60:63]
    v_mfma_f32_16x16x32_bf16 v[64:67], a[140:143], v[84:87], v[64:67]
    v_cvt_pk_bf16_f32 v139, v42, v43
    v_mfma_f32_16x16x32_bf16 v[68:71], a[172:175], v[84:87], v[68:71]
    ds_write2_b32 v34, v138, v139 offset0:0 offset1:2
    v_mfma_f32_16x16x32_bf16 v[56:59], a[80:83], v[88:91], v[56:59]
    v_cvt_pk_bf16_f32 v140, v44, v45
    v_max_u32 v224, v203, v205
    v_mfma_f32_16x16x32_bf16 v[60:63], a[112:115], v[88:91], v[60:63]
    v_cvt_pk_bf16_f32 v141, v46, v47
    v_max3_u32 v224, v207, v209, v224
    v_mfma_f32_16x16x32_bf16 v[64:67], a[144:147], v[88:91], v[64:67]
    v_max3_u32 v224, v211, v213, v224
    ds_write2_b32 v34, v140, v141 offset0:128 offset1:130
    v_mfma_f32_16x16x32_bf16 v[68:71], a[176:179], v[88:91], v[68:71]
    v_max3_u32 v224, v215, v217, v224
    v_add_u32 v34, 4224, v34
    v_mfma_f32_16x16x32_bf16 v[56:59], a[84:87], v[92:95], v[56:59]
    v_max3_u32 v224, v182, v183, v224
    v_cmp_eq_u32 vcc, -1, v224
    s_nop 0
    s_cbranch_vccnz Lax_r
Lax_ok:
    v_mfma_f32_16x16x32_bf16 v[60:63], a[116:119], v[92:95], v[60:63]
    v_cvt_pk_bf16_f32 v138, v48, v49
    v_cvt_pk_bf16_f32 v139, v50, v51
    v_mfma_f32_16x16x32_bf16 v[64:67], a[148:151], v[92:95], v[64:67]
    v_add_u32 v36, 0, v37
    ds_write2_b32 v34, v138, v139 offset0:0 offset1:2
    s_add_u32 m0, s89, 0
    v_mfma_f32_16x16x32_bf16 v[68:71], a[180:183], v[92:95], v[68:71]
    global_load_dwordx4 v[186:189], v36, s[38:39] sc1
    v_add_u32 v36, 917504, v37
    v_mfma_f32_16x16x32_bf16 v[56:59], a[88:91], v[96:99], v[56:59]
    v_cvt_pk_bf16_f32 v140, v52, v53
    global_load_dwordx4 v[190:193], v36, s[38:39] sc1
    v_mfma_f32_16x16x32_bf16 v[60:63], a[120:123], v[96:99], v[60:63]
    v_cvt_pk_bf16_f32 v141, v54, v55
    v_add_u32 v36, 1835008, v37
    v_mfma_f32_16x16x32_bf16 v[64:67], a[152:155], v[96:99], v[64:67]
    ds_write2_b32 v34, v140, v141 offset0:128 offset1:130
    global_load_dwordx4 v[194:197], v36, s[38:39] sc1
    v_mfma_f32_16x16x32_bf16 v[68:71], a[184:187], v[96:99], v[68:71]
    v_add_u32 v36, 2752512, v37
    v_add_u32 v34, 4224, v34
    v_mfma_f32_16x16x32_bf16 v[56:59], a[92:95], v[100:103], v[56:59]
    s_waitcnt lgkmcnt(0)
    s_barrier
    global_load_dwordx4 v[198:201], v36, s[38:39] sc1
    v_mfma_f32_16x16x32_bf16 v[60:63], a[124:127], v[100:103], v[60:63]
    v_add_f32 v182, v182, v183
    v_cvt_pk_bf16_f32 v182, v182, v182
    v_mfma_f32_16x16x32_bf16 v[64:67], a[156:159], v[100:103], v[64:67]
    v_lshlrev_b32 v182, 16, v182
    global_load_dwordx4 a[252:255], v7, s[18:19] offset:-1024 sc1
    v_mfma_f32_16x16x32_bf16 v[68:71], a[188:191], v[100:103], v[68:71]
    v_mov_b32 v29, 1.0
    s_nop 1
    v_add_f32_dpp v182, v182, v29 quad_perm:[0,1,2,3] row_mask:0xf bank_mask:0x2
    v_mfma_f32_16x16x32_bf16 v[56:59], a[32:35], v[104:107], v[56:59]
    v_cvt_pk_bf16_f32 v182, v182, v182
    v_lshlrev_b32 v182, 16, v182
    v_mfma_f32_16x16x32_bf16 v[60:63], a[64:67], v[104:107], v[60:63]
    s_nop 0
    v_mul_f32_dpp v183, v182, v182 row_shl:8 row_mask:0xf bank_mask:0x1
    s_nop 1
    v_mul_f32_dpp v183, v182, v182 row_shl:4 row_mask:0xf bank_mask:0x2
    v_mfma_f32_16x16x32_bf16 v[64:67], a[96:99], v[104:107], v[64:67]
    v_readlane_b32 s64, v183, 0
    global_load_lds_dwordx4 v8, s[68:69] offset:0
    v_mfma_f32_16x16x32_bf16 v[68:71], a[128:131], v[104:107], v[68:71]
    v_readlane_b32 s65, v183, 1
    v_readlane_b32 s66, v183, 2
    v_mfma_f32_16x16x32_bf16 v[56:59], a[36:39], v[108:111], v[56:59]
    v_readlane_b32 s67, v183, 3
    v_readlane_b32 s60, v183, 4
    v_mfma_f32_16x16x32_bf16 v[60:63], a[68:71], v[108:111], v[60:63]
    v_readlane_b32 s61, v183, 5
    v_readlane_b32 s62, v183, 6
    v_mfma_f32_16x16x32_bf16 v[64:67], a[100:103], v[108:111], v[64:67]
    v_readlane_b32 s63, v183, 7
    v_mov_b32 v178, s64
    v_mfma_f32_16x16x32_bf16 v[68:71], a[132:135], v[108:111], v[68:71]
    v_mov_b32 v179, s65
    global_load_lds_dwordx4 v9, s[68:69] offset:1024
    v_mfma_f32_16x16x32_bf16 v[56:59], a[40:43], v[112:115], v[56:59]
    v_mov_b32 v180, s66
    v_mov_b32 v181, s67
    v_mfma_f32_16x16x32_bf16 v[60:63], a[72:75], v[112:115], v[60:63]
    global_load_dwordx4 a[240:243], v4, s[12:13] offset:-2048 sc1
    v_mfma_f32_16x16x32_bf16 v[64:67], a[104:107], v[112:115], v[64:67]
    v_mfma_f32_16x16x32_bf16 v[68:71], a[136:139], v[112:115], v[68:71]
    v_mfma_f32_16x16x32_bf16 v[56:59], a[44:47], v[116:119], v[56:59]
    global_load_lds_dwordx4 v10, s[68:69] offset:2048
    v_mfma_f32_16x16x32_bf16 v[60:63], a[76:79], v[116:119], v[60:63]
    v_mfma_f32_16x16x32_bf16 v[64:67], a[108:111], v[116:119], v[64:67]
    v_mfma_f32_16x16x32_bf16 v[68:71], a[140:143], v[116:119], v[68:71]
    v_mfma_f32_16x16x32_bf16 v[56:59], a[48:51], v[120:123], v[56:59]
    v_mfma_f32_16x16x32_bf16 v[60:63], a[80:83], v[120:123], v[60:63]
    v_mfma_f32_16x16x32_bf16 v[64:67], a[112:115], v[120:123], v[64:67]
    v_mfma_f32_16x16x32_bf16 v[68:71], a[144:147], v[120:123], v[68:71]
    global_load_dwordx4 a[244:247], v7, s[18:19] offset:-2048 sc1
    v_mfma_f32_16x16x32_bf16 v[56:59], a[52:55], v[124:127], v[56:59]
    ds_read_b128 v[72:75], v32 offset:1536
    global_load_lds_dwordx4 v11, s[68:69] offset:3072
    v_mfma_f32_16x16x32_bf16 v[60:63], a[84:87], v[124:127], v[60:63]
    ds_read_b128 v[76:79], v32 offset:1600
    v_mfma_f32_16x16x32_bf16 v[64:67], a[116:119], v[124:127], v[64:67]
    ds_read_b128 v[80:83], v32 offset:1664
    v_mfma_f32_16x16x32_bf16 v[68:71], a[148:151], v[124:127], v[68:71]
    ds_read_b128 v[84:87], v32 offset:1728
    v_mfma_f32_16x16x32_bf16 v[56:59], a[56:59], v[128:131], v[56:59]
    ds_read_b128 v[88:91], v32 offset:1792
    v_mfma_f32_16x16x32_bf16 v[60:63], a[88:91], v[128:131], v[60:63]
    ds_read_b128 v[92:95], v32 offset:1856
    v_mfma_f32_16x16x32_bf16 v[64:67], a[120:123], v[128:131], v[64:67]
    ds_read_b128 v[96:99], v32 offset:1920
    v_mfma_f32_16x16x32_bf16 v[68:71], a[152:155], v[128:131], v[68:71]
    ds_read_b128 v[100:103], v32 offset:1984
    s_add_u32 m0, s89, 4096
    v_mfma_f32_16x16x32_bf16 v[56:59], a[60:63], v[132:135], v[56:59]
    v_mfma_f32_16x16x32_bf16 v[60:63], a[92:95], v[132:135], v[60:63]
    v_mfma_f32_16x16x32_bf16 v[64:67], a[124:127], v[132:135], v[64:67]
    v_mfma_f32_16x16x32_bf16 v[68:71], a[156:159], v[132:135], v[68:71]
    s_waitcnt lgkmcnt(7)
    v_mfma_f32_16x16x32_bf16 v[56:59], a[0:3], v[72:75], v[56:59]
    ds_read_b128 v[104:107], v32 offset:1024
    global_load_dwordx4 a[232:235], v4, s[12:13] offset:-3072 sc1
    v_mfma_f32_16x16x32_bf16 v[60:63], a[32:35], v[72:75], v[60:63]
    ds_read_b128 v[108:111], v32 offset:1088
    s_waitcnt lgkmcnt(8)
    v_mfma_f32_16x16x32_bf16 v[56:59], a[4:7], v[76:79], v[56:59]
    ds_read_b128 v[112:115], v32 offset:1152
    v_mfma_f32_16x16x32_bf16 v[60:63], a[36:39], v[76:79], v[60:63]
    ds_read_b128 v[116:119], v32 offset:1216
    global_load_lds_dwordx4 v12, s[68:69] offset:0
    s_waitcnt lgkmcnt(9)
    v_mfma_f32_16x16x32_bf16 v[56:59], a[8:11], v[80:83], v[56:59]
    ds_read_b128 v[120:123], v32 offset:1280
    ds_read_b32 v150, v35 offset:0
    v_mfma_f32_16x16x32_bf16 v[60:63], a[40:43], v[80:83], v[60:63]
    ds_read_b128 v[124:127], v32 offset:1344
    ds_read_b32 v151, v35 offset:1056
    s_waitcnt lgkmcnt(12)
    v_mfma_f32_16x16x32_bf16 v[56:59], a[12:15], v[84:87], v[56:59]
    ds_read_b128 v[128:131], v32 offset:1408
    ds_read_b32 v152, v35 offset:2112
    v_mfma_f32_16x16x32_bf16 v[60:63], a[44:47], v[84:87], v[60:63]
    ds_read_b128 v[132:135], v32 offset:1472
    ds_read_b32 v153, v35 offset:3168
    s_waitcnt lgkmcnt(15)
    v_mfma_f32_16x16x32_bf16 v[56:59], a[16:19], v[88:91], v[56:59]
    ds_read_b32 v154, v33 offset:3072
    ds_read_b32 v155, v33 offset:12352
    v_mfma_f32_16x16x32_bf16 v[60:63], a[48:51], v[88:91], v[60:63]
    ds_read_b32 v156, v33 offset:21632
    ds_read_b32 v157, v33 offset:30912
    s_waitcnt lgkmcnt(15)
    v_mfma_f32_16x16x32_bf16 v[56:59], a[20:23], v[92:95], v[56:59]
    s_waitcnt vmcnt(12)
    v_lshlrev_b32 v158, 16, v186
    v_and_b32 v159, 0xffff0000, v186
    v_mfma_f32_16x16x32_bf16 v[60:63], a[52:55], v[92:95], v[60:63]
    v_lshlrev_b32 v160, 16, v187
    v_and_b32 v161, 0xffff0000, v187
    v_mfma_f32_16x16x32_bf16 v[56:59], a[24:27], v[96:99], v[56:59]
    v_lshlrev_b32 v162, 16, v188
    v_and_b32 v163, 0xffff0000, v188
    v_mfma_f32_16x16x32_bf16 v[60:63], a[56:59], v[96:99], v[60:63]
    v_lshlrev_b32 v164, 16, v189
    global_load_lds_dwordx4 v13, s[68:69] offset:1024
    v_mfma_f32_16x16x32_bf16 v[56:59], a[28:31], v[100:103], v[56:59]
    v_and_b32 v165, 0xffff0000, v189
    v_fma_f32 v166, v158, v202, v203
    v_mfma_f32_16x16x32_bf16 v[60:63], a[60:63], v[100:103], v[60:63]
    v_fma_f32 v167, v159, v202, v203
    v_fma_f32 v168, v160, v202, v203
    v_mfma_f32_16x16x32_bf16 v[60:63], a[0:3], v[104:107], v[60:63]
    global_load_dwordx4 a[236:239], v7, s[18:19] offset:-3072 sc1
    v_fma_f32 v169, v161, v202, v203
    s_waitcnt lgkmcnt(14)
    v_mfma_f32_16x16x32_bf16 v[60:63], a[4:7], v[108:111], v[60:63]
    v_fma_f32 v170, v162, v204, v205
    v_fma_f32 v171, v163, v204, v205
    s_waitcnt lgkmcnt(13)
    v_mfma_f32_16x16x32_bf16 v[60:63], a[8:11], v[112:115], v[60:63]
    v_fma_f32 v172, v164, v204, v205
    v_fma_f32 v173, v165, v204, v205
    s_waitcnt lgkmcnt(12)
    v_mfma_f32_16x16x32_bf16 v[60:63], a[12:15], v[116:119], v[60:63]
    v_fma_f32 v166, v166, s60, v178
    v_fma_f32 v167, v167, s61, v179
    s_waitcnt lgkmcnt(11)
    v_mfma_f32_16x16x32_bf16 v[60:63], a[16:19], v[120:123], v[60:63]
    v_fma_f32 v168, v168, s62, v180
    global_load_lds_dwordx4 v14, s[68:69] offset:2048
    s_waitcnt lgkmcnt(9)
    v_mfma_f32_16x16x32_bf16 v[60:63], a[20:23], v[124:127], v[60:63]
    v_fma_f32 v169, v169, s63, v181
    v_fma_f32 v170, v170, s60, v178
    s_waitcnt lgkmcnt(7)
    v_mfma_f32_16x16x32_bf16 v[60:63], a[24:27], v[128:131], v[60:63]
    v_fma_f32 v171, v171, s61, v179
    v_fma_f32 v172, v172, s62, v180
    s_waitcnt lgkmcnt(5)
    v_mfma_f32_16x16x32_bf16 v[60:63], a[28:31], v[132:135], v[60:63]
    v_fma_f32 v173, v173, s63, v181
    v_lshlrev_b32 v142, 16, v150
    v_mfma_f32_16x16x32_bf16 v[64:67], a[64:67], v[72:75], v[64:67]
    v_and_b32 v146, 0xffff0000, v150
    v_lshlrev_b32 v143, 16, v151
    v_mfma_f32_16x16x32_bf16 v[68:71], a[96:99], v[72:75], v[68:71]
    v_and_b32 v147, 0xffff0000, v151
    v_lshlrev_b32 v144, 16, v152
    v_mfma_f32_16x16x32_bf16 v[64:67], a[68:71], v[76:79], v[64:67]
    v_and_b32 v148, 0xffff0000, v152
    s_waitcnt lgkmcnt(4)
    v_lshlrev_b32 v145, 16, v153
    v_mfma_f32_16x16x32_bf16 v[68:71], a[100:103], v[76:79], v[68:71]
    v_and_b32 v149, 0xffff0000, v153
    global_load_lds_dwordx4 v15, s[68:69] offset:3072
    v_mfma_f32_16x16x32_bf16 v[64:67], a[72:75], v[80:83], v[64:67]
    s_waitcnt lgkmcnt(3)
    v_and_b32 v174, 0xffff0000, v154
    s_waitcnt lgkmcnt(2)
    v_and_b32 v175, 0xffff0000, v155
    v_mfma_f32_16x16x32_bf16 v[68:71], a[104:107], v[80:83], v[68:71]
    s_waitcnt lgkmcnt(1)
    v_and_b32 v176, 0xffff0000, v156
    global_load_dwordx4 a[224:227], v4, s[12:13] offset:-4096 sc1
    v_mfma_f32_16x16x32_bf16 v[64:67], a[76:79], v[84:87], v[64:67]
    s_waitcnt lgkmcnt(0)
    v_and_b32 v177, 0xffff0000, v157
    v_fmac_f32 v142, s52, v174
    v_mfma_f32_16x16x32_bf16 v[68:71], a[108:111], v[84:87], v[68:71]
    v_fmac_f32 v143, s53, v175
    v_fmac_f32 v144, s54, v176
    v_mfma_f32_16x16x32_bf16 v[64:67], a[80:83], v[88:91], v[64:67]
    v_fmac_f32 v145, s55, v177
    v_lshlrev_b32 v174, 16, v154
    v_mfma_f32_16x16x32_bf16 v[68:71], a[112:115], v[88:91], v[68:71]
    v_lshlrev_b32 v175, 16, v155
    v_lshlrev_b32 v176, 16, v156
    v_mfma_f32_16x16x32_bf16 v[64:67], a[84:87], v[92:95], v[64:67]
    v_lshlrev_b32 v177, 16, v157
    v_fmac_f32 v146, s52, v174
    v_mfma_f32_16x16x32_bf16 v[68:71], a[116:119], v[92:95], v[68:71]
    v_fmac_f32 v147, s53, v175
    v_fmac_f32 v148, s54, v176
    v_mfma_f32_16x16x32_bf16 v[64:67], a[88:91], v[96:99], v[64:67]
    v_fmac_f32 v149, s55, v177
    v_fma_f32 v158, v166, v142, v158
    v_mfma_f32_16x16x32_bf16 v[68:71], a[120:123], v[96:99], v[68:71]
    v_fma_f32 v159, v167, v143, v159
    v_fma_f32 v160, v168, v144, v160
    v_mfma_f32_16x16x32_bf16 v[64:67], a[92:95], v[100:103], v[64:67]
    v_fma_f32 v161, v169, v145, v161
    v_fma_f32 v162, v170, v146, v162
    v_mfma_f32_16x16x32_bf16 v[68:71], a[124:127], v[100:103], v[68:71]
    v_fma_f32 v163, v171, v147, v163
    v_fma_f32 v164, v172, v148, v164
    v_mfma_f32_16x16x32_bf16 v[64:67], a[32:35], v[104:107], v[64:67]
    v_fma_f32 v165, v173, v149, v165
    v_cvt_pk_bf16_f32 v186, v158, v159
    v_mfma_f32_16x16x32_bf16 v[68:71], a[64:67], v[104:107], v[68:71]
    v_cvt_pk_bf16_f32 v187, v160, v161
    v_mfma_f32_16x16x32_bf16 v[64:67], a[36:39], v[108:111], v[64:67]
    v_cvt_pk_bf16_f32 v188, v162, v163
    global_load_dwordx4 a[228:231], v7, s[18:19] offset:-4096 sc1
    v_mfma_f32_16x16x32_bf16 v[68:71], a[68:71], v[108:111], v[68:71]
    v_cvt_pk_bf16_f32 v189, v164, v165
    v_or_b32 v189, 1, v189
    v_mfma_f32_16x16x32_bf16 v[64:67], a[40:43], v[112:115], v[64:67]
    v_add_u32 v136, 0, v37
    global_store_dwordx4 v136, v[186:189], s[38:39] sc1
    v_mfma_f32_16x16x32_bf16 v[68:71], a[72:75], v[112:115], v[68:71]
    ds_read_b128 v[72:75], v32 offset:512
    ds_read_b128 v[76:79], v32 offset:576
    v_mfma_f32_16x16x32_bf16 v[64:67], a[44:47], v[116:119], v[64:67]
    v_cvt_pk_bf16_f32 v138, v56, v57
    ds_read_b128 v[80:83], v32 offset:640
    v_mfma_f32_16x16x32_bf16 v[68:71], a[76:79], v[116:119], v[68:71]
    v_cvt_pk_bf16_f32 v139, v58, v59
    ds_read_b128 v[84:87], v32 offset:704
    v_mfma_f32_16x16x32_bf16 v[64:67], a[48:51], v[120:123], v[64:67]
    ds_write2_b32 v34, v138, v139 offset0:0 offset1:2
    ds_read_b128 v[88:91], v32 offset:768
    v_mfma_f32_16x16x32_bf16 v[68:71], a[80:83], v[120:123], v[68:71]
    v_cvt_pk_bf16_f32 v140, v60, v61
    ds_read_b128 v[92:95], v32 offset:832
    v_mfma_f32_16x16x32_bf16 v[64:67], a[52:55], v[124:127], v[64:67]
    v_cvt_pk_bf16_f32 v141, v62, v63
    ds_read_b128 v[96:99], v32 offset:896
    v_mfma_f32_16x16x32_bf16 v[68:71], a[84:87], v[124:127], v[68:71]
    ds_read_b128 v[100:103], v32 offset:960
    ds_write2_b32 v34, v140, v141 offset0:128 offset1:130
    v_mfma_f32_16x16x32_bf16 v[64:67], a[56:59], v[128:131], v[64:67]
    v_add_u32 v34, 4224, v34
    s_waitcnt lgkmcnt(0)
    s_barrier
    v_mfma_f32_16x16x32_bf16 v[68:71], a[88:91], v[128:131], v[68:71]
    v_mfma_f32_16x16x32_bf16 v[64:67], a[60:63], v[132:135], v[64:67]
    v_mfma_f32_16x16x32_bf16 v[68:71], a[92:95], v[132:135], v[68:71]
    global_load_dwordx4 v[218:221], v223, s[38:39] sc1
    global_load_dwordx4 a[216:219], v4, s[10:11] offset:3072 sc1
    ds_read_b128 v[104:107], v32 offset:0
    ds_read_b128 v[108:111], v32 offset:64
    ds_read_b128 v[112:115], v32 offset:128
    ds_read_b128 v[116:119], v32 offset:192
    ds_read_b128 v[120:123], v32 offset:256
    ds_read_b128 v[124:127], v32 offset:320
    ds_read_b128 v[128:131], v32 offset:384
    ds_read_b128 v[132:135], v32 offset:448
    ds_read_b32 v150, v35 offset:4224
    ds_read_b32 v151, v35 offset:5280
    ds_read_b32 v152, v35 offset:6336
    ds_read_b32 v153, v35 offset:7392
    ds_read_b32 v154, v33 offset:2048
    ds_read_b32 v155, v33 offset:11328
    ds_read_b32 v156, v33 offset:20608
    ds_read_b32 v157, v33 offset:29888
    s_waitcnt vmcnt(20)
    v_lshlrev_b32 v158, 16, v190
    global_load_dwordx4 a[220:223], v7, s[16:17] offset:3072 sc1
    v_and_b32 v159, 0xffff0000, v190
    v_lshlrev_b32 v160, 16, v191
    v_and_b32 v161, 0xffff0000, v191
    v_lshlrev_b32 v162, 16, v192
    v_and_b32 v163, 0xffff0000, v192
    v_lshlrev_b32 v164, 16, v193
    v_and_b32 v165, 0xffff0000, v193
    v_pk_fma_f32 v[166:167], v[206:207], v[158:159], v[206:207] op_sel:[0,0,1] op_sel_hi:[0,1,1]
    v_pk_fma_f32 v[168:169], v[206:207], v[160:161], v[206:207] op_sel:[0,0,1] op_sel_hi:[0,1,1]
    v_pk_fma_f32 v[170:171], v[208:209], v[162:163], v[208:209] op_sel:[0,0,1] op_sel_hi:[0,1,1]
    v_pk_fma_f32 v[172:173], v[208:209], v[164:165], v[208:209] op_sel:[0,0,1] op_sel_hi:[0,1,1]
    v_pk_fma_f32 v[166:167], v[166:167], s[60:61], v[178:179] op_sel:[0,0,0] op_sel_hi:[1,1,1]
    v_pk_fma_f32 v[168:169], v[168:169], s[62:63], v[180:181] op_sel:[0,0,0] op_sel_hi:[1,1,1]
    v_pk_fma_f32 v[170:171], v[170:171], s[60:61], v[178:179] op_sel:[0,0,0] op_sel_hi:[1,1,1]
    v_pk_fma_f32 v[172:173], v[172:173], s[62:63], v[180:181] op_sel:[0,0,0] op_sel_hi:[1,1,1]
    s_waitcnt lgkmcnt(7)
    v_lshlrev_b32 v142, 16, v150
    v_and_b32 v146, 0xffff0000, v150
    global_load_dwordx4 a[208:211], v4, s[10:11] offset:2048 sc1
    s_waitcnt lgkmcnt(6)
    v_lshlrev_b32 v143, 16, v151
    v_and_b32 v147, 0xffff0000, v151
    s_waitcnt lgkmcnt(5)
    v_lshlrev_b32 v144, 16, v152
    v_and_b32 v148, 0xffff0000, v152
    s_waitcnt lgkmcnt(4)
    v_lshlrev_b32 v145, 16, v153
    v_and_b32 v149, 0xffff0000, v153
    s_waitcnt lgkmcnt(3)
    v_dot2_f32_bf16 v142, v154, s52, v142
    s_waitcnt lgkmcnt(2)
    v_dot2_f32_bf16 v143, v155, s53, v143
    s_waitcnt lgkmcnt(1)
    v_dot2_f32_bf16 v144, v156, s54, v144
    s_waitcnt lgkmcnt(0)
    v_dot2_f32_bf16 v145, v157, s55, v145
    v_dot2_f32_bf16 v146, v154, s56, v146
    v_dot2_f32_bf16 v147, v155, s57, v147
    v_dot2_f32_bf16 v148, v156, s58, v148
    v_dot2_f32_bf16 v149, v157, s59, v149
    v_pk_fma_f32 v[158:159], v[166:167], v[142:143], v[158:159] op_sel:[0,0,0] op_sel_hi:[1,1,1]
    v_pk_fma_f32 v[160:161], v[168:169], v[144:145], v[160:161] op_sel:[0,0,0] op_sel_hi:[1,1,1]
    v_pk_fma_f32 v[162:163], v[170:171], v[146:147], v[162:163] op_sel:[0,0,0] op_sel_hi:[1,1,1]
    global_load_dwordx4 a[212:215], v7, s[16:17] offset:2048 sc1
    v_pk_fma_f32 v[164:165], v[172:173], v[148:149], v[164:165] op_sel:[0,0,0] op_sel_hi:[1,1,1]
    v_cvt_pk_bf16_f32 v190, v158, v159
    v_cvt_pk_bf16_f32 v191, v160, v161
    v_cvt_pk_bf16_f32 v192, v162, v163
    v_cvt_pk_bf16_f32 v193, v164, v165
    v_or_b32 v193, 1, v193
    v_add_u32 v136, 917504, v37
    global_store_dwordx4 v136, v[190:193], s[38:39] sc1
    ds_read_b32 v150, v35 offset:8448
    ds_read_b32 v151, v35 offset:9504
    ds_read_b32 v152, v35 offset:10560
    ds_read_b32 v153, v35 offset:11616
    ds_read_b32 v154, v33 offset:1024
    ds_read_b32 v155, v33 offset:10304
    ds_read_b32 v156, v33 offset:19584
    ds_read_b32 v157, v33 offset:28864
    s_waitcnt vmcnt(23)
    v_lshlrev_b32 v158, 16, v194
    v_and_b32 v159, 0xffff0000, v194
    global_load_dwordx4 a[200:203], v4, s[10:11] offset:1024 sc1
    v_lshlrev_b32 v160, 16, v195
    v_and_b32 v161, 0xffff0000, v195
    v_lshlrev_b32 v162, 16, v196
    v_and_b32 v163, 0xffff0000, v196
    v_lshlrev_b32 v164, 16, v197
    v_and_b32 v165, 0xffff0000, v197
    v_pk_fma_f32 v[166:167], v[210:211], v[158:159], v[210:211] op_sel:[0,0,1] op_sel_hi:[0,1,1]
    v_pk_fma_f32 v[168:169], v[210:211], v[160:161], v[210:211] op_sel:[0,0,1] op_sel_hi:[0,1,1]
    v_pk_fma_f32 v[170:171], v[212:213], v[162:163], v[212:213] op_sel:[0,0,1] op_sel_hi:[0,1,1]
    v_pk_fma_f32 v[172:173], v[212:213], v[164:165], v[212:213] op_sel:[0,0,1] op_sel_hi:[0,1,1]
    v_pk_fma_f32 v[166:167], v[166:167], s[60:61], v[178:179] op_sel:[0,0,0] op_sel_hi:[1,1,1]
    v_pk_fma_f32 v[168:169], v[168:169], s[62:63], v[180:181] op_sel:[0,0,0] op_sel_hi:[1,1,1]
    v_pk_fma_f32 v[170:171], v[170:171], s[60:61], v[178:179] op_sel:[0,0,0] op_sel_hi:[1,1,1]
    v_pk_fma_f32 v[172:173], v[172:173], s[62:63], v[180:181] op_sel:[0,0,0] op_sel_hi:[1,1,1]
    s_waitcnt lgkmcnt(7)
    v_lshlrev_b32 v142, 16, v150
    v_and_b32 v146, 0xffff0000, v150
    s_waitcnt lgkmcnt(6)
    v_lshlrev_b32 v143, 16, v151
    global_load_dwordx4 a[204:207], v7, s[16:17] offset:1024 sc1
    v_and_b32 v147, 0xffff0000, v151
    s_waitcnt lgkmcnt(5)
    v_lshlrev_b32 v144, 16, v152
    v_and_b32 v148, 0xffff0000, v152
    s_waitcnt lgkmcnt(4)
    v_lshlrev_b32 v145, 16, v153
    v_and_b32 v149, 0xffff0000, v153
    s_waitcnt lgkmcnt(3)
    v_dot2_f32_bf16 v142, v154, s52, v142
    s_waitcnt lgkmcnt(2)
    v_dot2_f32_bf16 v143, v155, s53, v143
    s_waitcnt lgkmcnt(1)
    v_dot2_f32_bf16 v144, v156, s54, v144
    s_waitcnt lgkmcnt(0)
    v_dot2_f32_bf16 v145, v157, s55, v145
    v_dot2_f32_bf16 v146, v154, s56, v146
    v_dot2_f32_bf16 v147, v155, s57, v147
    v_dot2_f32_bf16 v148, v156, s58, v148
    v_dot2_f32_bf16 v149, v157, s59, v149
    v_pk_fma_f32 v[158:159], v[166:167], v[142:143], v[158:159] op_sel:[0,0,0] op_sel_hi:[1,1,1]
    v_pk_fma_f32 v[160:161], v[168:169], v[144:145], v[160:161] op_sel:[0,0,0] op_sel_hi:[1,1,1]
    v_pk_fma_f32 v[162:163], v[170:171], v[146:147], v[162:163] op_sel:[0,0,0] op_sel_hi:[1,1,1]
    v_pk_fma_f32 v[164:165], v[172:173], v[148:149], v[164:165] op_sel:[0,0,0] op_sel_hi:[1,1,1]
    global_load_dwordx4 a[192:195], v4, s[10:11] offset:0 sc1
    v_cvt_pk_bf16_f32 v194, v158, v159
    v_cvt_pk_bf16_f32 v195, v160, v161
    v_cvt_pk_bf16_f32 v196, v162, v163
    v_cvt_pk_bf16_f32 v197, v164, v165
    v_or_b32 v197, 1, v197
    v_add_u32 v136, 1835008, v37
    global_store_dwordx4 v136, v[194:197], s[38:39] sc1
    v_mfma_f32_16x16x32_bf16 v[64:67], a[0:3], v[72:75], v[64:67]
    v_mfma_f32_16x16x32_bf16 v[68:71], a[32:35], v[72:75], v[68:71]
    v_mfma_f32_16x16x32_bf16 v[64:67], a[4:7], v[76:79], v[64:67]
    v_mfma_f32_16x16x32_bf16 v[68:71], a[36:39], v[76:79], v[68:71]
    v_mfma_f32_16x16x32_bf16 v[64:67], a[8:11], v[80:83], v[64:67]
    v_mfma_f32_16x16x32_bf16 v[68:71], a[40:43], v[80:83], v[68:71]
    v_mfma_f32_16x16x32_bf16 v[64:67], a[12:15], v[84:87], v[64:67]
    v_mfma_f32_16x16x32_bf16 v[68:71], a[44:47], v[84:87], v[68:71]
    v_mfma_f32_16x16x32_bf16 v[64:67], a[16:19], v[88:91], v[64:67]
    v_mfma_f32_16x16x32_bf16 v[68:71], a[48:51], v[88:91], v[68:71]
    v_mfma_f32_16x16x32_bf16 v[64:67], a[20:23], v[92:95], v[64:67]
    global_load_dwordx4 a[196:199], v7, s[16:17] offset:0 sc1
    v_mfma_f32_16x16x32_bf16 v[68:71], a[52:55], v[92:95], v[68:71]
    v_mfma_f32_16x16x32_bf16 v[64:67], a[24:27], v[96:99], v[64:67]
    v_mfma_f32_16x16x32_bf16 v[68:71], a[56:59], v[96:99], v[68:71]
    v_mfma_f32_16x16x32_bf16 v[64:67], a[28:31], v[100:103], v[64:67]
    v_mfma_f32_16x16x32_bf16 v[68:71], a[60:63], v[100:103], v[68:71]
    v_mfma_f32_16x16x32_bf16 v[68:71], a[0:3], v[104:107], v[68:71]
    v_mfma_f32_16x16x32_bf16 v[68:71], a[4:7], v[108:111], v[68:71]
    v_mfma_f32_16x16x32_bf16 v[68:71], a[8:11], v[112:115], v[68:71]
    v_mfma_f32_16x16x32_bf16 v[68:71], a[12:15], v[116:119], v[68:71]
    v_mfma_f32_16x16x32_bf16 v[68:71], a[16:19], v[120:123], v[68:71]
    v_mfma_f32_16x16x32_bf16 v[68:71], a[20:23], v[124:127], v[68:71]
    v_mfma_f32_16x16x32_bf16 v[68:71], a[24:27], v[128:131], v[68:71]
    v_mfma_f32_16x16x32_bf16 v[68:71], a[28:31], v[132:135], v[68:71]
    v_cvt_pk_bf16_f32 v138, v64, v65
    v_cvt_pk_bf16_f32 v139, v66, v67
    ds_write2_b32 v34, v138, v139 offset0:0 offset1:2
    s_nop 4
    v_cvt_pk_bf16_f32 v140, v68, v69
    global_load_dwordx4 a[184:187], v4, s[10:11] offset:-1024 sc1
    v_cvt_pk_bf16_f32 v141, v70, v71
    ds_write2_b32 v34, v140, v141 offset0:128 offset1:130
    s_waitcnt lgkmcnt(0)
    s_barrier
    ds_read_b32 v150, v35 offset:12672
    ds_read_b32 v151, v35 offset:13728
    ds_read_b32 v152, v35 offset:14784
    ds_read_b32 v153, v35 offset:15840
    ds_read_b32 v154, v33 offset:0
    ds_read_b32 v155, v33 offset:9280
    ds_read_b32 v156, v33 offset:18560
    ds_read_b32 v157, v33 offset:27840
    s_waitcnt vmcnt(28)
    v_lshlrev_b32 v158, 16, v198
    v_and_b32 v159, 0xffff0000, v198
    v_lshlrev_b32 v160, 16, v199
    v_and_b32 v161, 0xffff0000, v199
    v_lshlrev_b32 v162, 16, v200
    global_load_dwordx4 a[188:191], v7, s[16:17] offset:-1024 sc1
    v_and_b32 v163, 0xffff0000, v200
    v_lshlrev_b32 v164, 16, v201
    v_and_b32 v165, 0xffff0000, v201
    v_pk_fma_f32 v[166:167], v[214:215], v[158:159], v[214:215] op_sel:[0,0,1] op_sel_hi:[0,1,1]
    v_pk_fma_f32 v[168:169], v[214:215], v[160:161], v[214:215] op_sel:[0,0,1] op_sel_hi:[0,1,1]
    v_pk_fma_f32 v[170:171], v[216:217], v[162:163], v[216:217] op_sel:[0,0,1] op_sel_hi:[0,1,1]
    v_pk_fma_f32 v[172:173], v[216:217], v[164:165], v[216:217] op_sel:[0,0,1] op_sel_hi:[0,1,1]
    v_pk_fma_f32 v[166:167], v[166:167], s[60:61], v[178:179] op_sel:[0,0,0] op_sel_hi:[1,1,1]
    v_pk_fma_f32 v[168:169], v[168:169], s[62:63], v[180:181] op_sel:[0,0,0] op_sel_hi:[1,1,1]
    v_pk_fma_f32 v[170:171], v[170:171], s[60:61], v[178:179] op_sel:[0,0,0] op_sel_hi:[1,1,1]
    v_pk_fma_f32 v[172:173], v[172:173], s[62:63], v[180:181] op_sel:[0,0,0] op_sel_hi:[1,1,1]
    s_waitcnt lgkmcnt(7)
    v_lshlrev_b32 v142, 16, v150
    v_and_b32 v146, 0xffff0000, v150
    s_waitcnt lgkmcnt(6)
    v_lshlrev_b32 v143, 16, v151
    v_and_b32 v147, 0xffff0000, v151
    s_waitcnt lgkmcnt(5)
    v_lshlrev_b32 v144, 16, v152
    v_and_b32 v148, 0xffff0000, v152
    s_waitcnt lgkmcnt(4)
    v_lshlrev_b32 v145, 16, v153
    v_and_b32 v149, 0xffff0000, v153
    s_waitcnt lgkmcnt(3)
    v_dot2_f32_bf16 v142, v154, s52, v142
    s_waitcnt lgkmcnt(2)
    v_dot2_f32_bf16 v143, v155, s53, v143
    s_waitcnt lgkmcnt(1)
    v_dot2_f32_bf16 v144, v156, s54, v144
    s_waitcnt lgkmcnt(0)
    v_dot2_f32_bf16 v145, v157, s55, v145
    v_dot2_f32_bf16 v146, v154, s56, v146
    v_dot2_f32_bf16 v147, v155, s57, v147
    v_dot2_f32_bf16 v148, v156, s58, v148
    v_dot2_f32_bf16 v149, v157, s59, v149
    v_pk_fma_f32 v[158:159], v[166:167], v[142:143], v[158:159] op_sel:[0,0,0] op_sel_hi:[1,1,1]
    v_pk_fma_f32 v[160:161], v[168:169], v[144:145], v[160:161] op_sel:[0,0,0] op_sel_hi:[1,1,1]
    v_pk_fma_f32 v[162:163], v[170:171], v[146:147], v[162:163] op_sel:[0,0,0] op_sel_hi:[1,1,1]
    v_pk_fma_f32 v[164:165], v[172:173], v[148:149], v[164:165] op_sel:[0,0,0] op_sel_hi:[1,1,1]
    v_cvt_pk_bf16_f32 v198, v158, v159
    v_cvt_pk_bf16_f32 v199, v160, v161
    v_cvt_pk_bf16_f32 v200, v162, v163
    v_cvt_pk_bf16_f32 v201, v164, v165
    v_or_b32 v201, 1, v201
    v_add_u32 v136, 2752512, v37
    global_store_dwordx4 v136, v[198:201], s[38:39] sc1
    s_waitcnt lgkmcnt(0)
    s_barrier
    s_waitcnt vmcnt(13)
    v_max_u32 v224, v218, v219
    v_max3_u32 v224, v220, v221, v224
    v_cmp_eq_u32 vcc, -1, v224
    s_nop 0
    s_cbranch_vccnz Lcv_r
Lcv_ok:
    v_permlane32_swap_b32 v218, v220
    v_permlane32_swap_b32 v219, v221
    s_lshl_b32 s4, s3, 9
    s_add_u32 s4, s4, 156672
    v_and_b32 v223, 496, v4
    v_add_f32 v218, v218, v220
    v_add_f32 v219, v219, v221
    v_bfe_u32 v220, v1, 3, 1
    v_cmp_gt_u32 vcc, s101, v220
    v_lshrrev_b32 v220, 5, v1
    v_lshl_add_u32 v223, v220, 3, v223
    v_cndmask_b32 v218, 0, v218, vcc
    v_cndmask_b32 v219, 0, v219, vcc
    v_add_u32 v223, s4, v223
    ds_write_b64 v223, v[218:219]
    global_load_dwordx4 a[176:179], v4, s[10:11] offset:-2048 sc1
    global_load_dwordx4 a[180:183], v7, s[16:17] offset:-2048 sc1
    global_load_dwordx4 a[168:171], v4, s[10:11] offset:-3072 sc1
    global_load_dwordx4 a[172:175], v7, s[16:17] offset:-3072 sc1
    global_load_dwordx4 a[160:163], v4, s[10:11] offset:-4096 sc1
    global_load_dwordx4 a[164:167], v7, s[16:17] offset:-4096 sc1
    global_load_dwordx4 a[152:155], v4, s[8:9] offset:3072 sc1
    global_load_dwordx4 a[156:159], v7, s[14:15] offset:3072 sc1
    global_load_dwordx4 a[144:147], v4, s[8:9] offset:2048 sc1
    global_load_dwordx4 a[148:151], v7, s[14:15] offset:2048 sc1
    global_load_dwordx4 a[136:139], v4, s[8:9] offset:1024 sc1
    global_load_dwordx4 a[140:143], v7, s[14:15] offset:1024 sc1
    global_load_dwordx4 a[128:131], v4, s[8:9] offset:0 sc1
    global_load_dwordx4 a[132:135], v7, s[14:15] offset:0 sc1
Ljoin:
    v_and_b32 v28, 7, v1
    v_lshl_add_u32 v28, v3, 3, v28
    v_bfe_u32 v29, v1, 3, 1
    v_lshlrev_b32 v66, 9, v29
    v_lshl_add_u32 v66, v28, 4, v66
    s_mul_i32 s4, s3, 20480
    s_mul_i32 s5, s40, 114688
    s_add_u32 s4, s4, s5
    s_add_u32 s4, s4, 1048576
    v_add_u32 v66, s4, v66
    v_lshl_add_u32 v70, v28, 1, v29
    v_min_u32 v72, 39, v1
    v_lshl_add_u32 v72, v72, 9, s4
    s_bfe_u32 s6, s2, 0x30003
    v_mul_u32_u24 v254, 8, v0
    v_add_lshl_u32 v254, v254, s6, 7
    v_min_u32 v254, (Lmid-Lx_go-4), v254
    v_add_u32 v254, (Lx_go-adaLN_cond__ssm_conv_h3__mixer_gmlp__prompt_kernel), v254
    global_load_dword v254, v254, s[0:1]
    s_cmp_lt_u32 s43, 4
    s_cbranch_scc1 Lx_first
Lx_redo:
    s_branch Lxp_f
Lxp:
    s_sleep 1
Lxp_f:
    global_load_dword v71, v72, s[38:39] offset:508 sc1
    s_waitcnt vmcnt(0)
    v_and_b32 v71, 1, v71
    v_cmp_ne_u32 vcc, 1, v71
    s_add_u32 s100, s100, 1
    s_cmp_ge_u32 s100, 262144
    s_cbranch_scc1 Lxp_x
    s_cbranch_vccnz Lxp
Lxp_x:
Lx_first:
    s_mov_b32 s7, 0x3f803f80
    v_add_u32 v67, 4096, v66
    global_load_dwordx4 v[98:101], v67, s[38:39] offset:-4096 sc1
    global_load_dwordx4 v[102:105], v67, s[38:39] offset:-3072 sc1
    global_load_dwordx4 v[106:109], v67, s[38:39] offset:-2048 sc1
    global_load_dwordx4 v[110:113], v67, s[38:39] offset:-1024 sc1
    global_load_dwordx4 v[114:117], v67, s[38:39] offset:0 sc1
    global_load_dwordx4 v[118:121], v67, s[38:39] offset:1024 sc1
    global_load_dwordx4 v[122:125], v67, s[38:39] offset:2048 sc1
    global_load_dwordx4 v[126:129], v67, s[38:39] offset:3072 sc1
    v_add_u32 v67, 8192, v67
    global_load_dwordx4 v[130:133], v67, s[38:39] offset:-4096 sc1
    global_load_dwordx4 v[134:137], v67, s[38:39] offset:-3072 sc1
    v_lshrrev_b32 v28, 5, v1
    v_bfe_u32 v68, v1, 1, 1
    v_lshl_add_u32 v28, v28, 1, v68
    v_mul_u32_u24 v68, 1040, v28
    v_bfe_u32 v28, v1, 3, 1
    v_lshl_add_u32 v68, v28, 3, v68
    v_bfe_u32 v28, v1, 2, 1
    v_lshl_add_u32 v68, v28, 6, v68
    v_bfe_u32 v28, v1, 4, 1
    v_lshl_add_u32 v68, v28, 7, v68
    v_bfe_u32 v28, v1, 0, 1
    v_lshl_add_u32 v68, v28, 5, v68
    s_mul_i32 s5, s3, 20800
    v_add_u32 v68, s5, v68
    v_lshlrev_b32 v30, 3, v1
    s_lshl_b32 s88, s3, 9
    v_lshrrev_b32 v28, 3, v1
    v_lshlrev_b32 v28, 12, v28
    v_bfe_u32 v29, v1, 4, 1
    v_xor_b32 v29, v29, v1
    v_and_b32 v29, 7, v29
    v_xor_b32 v74, 0, v29
    v_lshl_add_u32 v74, v74, 4, v28
    v_add_u32 v78, 131072, v74
    v_xor_b32 v75, 2, v29
    v_lshl_add_u32 v75, v75, 4, v28
    v_add_u32 v75, 31744, v75
    v_add_u32 v79, 131072, v75
    v_xor_b32 v76, 4, v29
    v_lshl_add_u32 v76, v76, 4, v28
    v_add_u32 v76, 63488, v76
    v_add_u32 v80, 131072, v76
    v_xor_b32 v77, 6, v29
    v_lshl_add_u32 v77, v77, 4, v28
    v_add_u32 v77, 95232, v77
    v_add_u32 v81, 131072, v77
    v_lshrrev_b32 v29, 1, v2
    v_xor_b32 v29, v29, v3
    v_lshlrev_b32 v29, 4, v29
    v_lshl_add_u32 v29, v5, 7, v29
    s_xor_b32 s4, s3, 0
    s_lshr_b32 s5, s4, 1
    s_lshl_b32 s5, s5, 12
    s_and_b32 s4, s4, 1
    s_lshl_b32 s4, s4, 9
    s_add_u32 s4, s4, s5
    s_add_u32 s4, s4, s89
    v_add_u32 v82, s4, v29
    v_xor_b32 v83, 64, v82
    s_xor_b32 s4, s3, 1
    s_lshr_b32 s5, s4, 1
    s_lshl_b32 s5, s5, 12
    s_and_b32 s4, s4, 1
    s_lshl_b32 s4, s4, 9
    s_add_u32 s4, s4, s5
    s_add_u32 s4, s4, s89
    v_add_u32 v84, s4, v29
    v_xor_b32 v85, 64, v84
    s_xor_b32 s4, s3, 2
    s_lshr_b32 s5, s4, 1
    s_lshl_b32 s5, s5, 12
    s_and_b32 s4, s4, 1
    s_lshl_b32 s4, s4, 9
    s_add_u32 s4, s4, s5
    s_add_u32 s4, s4, s89
    v_add_u32 v86, s4, v29
    v_xor_b32 v87, 64, v86
    s_xor_b32 s4, s3, 3
    s_lshr_b32 s5, s4, 1
    s_lshl_b32 s5, s5, 12
    s_and_b32 s4, s4, 1
    s_lshl_b32 s4, s4, 9
    s_add_u32 s4, s4, s5
    s_add_u32 s4, s4, s89
    v_add_u32 v88, s4, v29
    v_xor_b32 v89, 64, v88
    s_add_u32 s52, s8, 1146880
    s_addc_u32 s53, s9, 0
    s_add_u32 s54, s10, 1146880
    s_addc_u32 s55, s11, 0
    s_add_u32 s56, s12, 1146880
    s_addc_u32 s57, s13, 0
    s_add_u32 s58, s14, 1146880
    s_addc_u32 s59, s15, 0
    s_add_u32 s60, s16, 1146880
    s_addc_u32 s61, s17, 0
    s_add_u32 s62, s18, 1146880
    s_addc_u32 s63, s19, 0
    s_mov_b32 s84, 0xc0135761
    s_mov_b32 s85, 0xbdd2d3e8
    v_lshlrev_b32 v32, 16, v27
    v_lshlrev_b32 v33, 16, v27
    v_lshlrev_b32 v34, 16, v27
    v_lshlrev_b32 v35, 16, v27
    s_mul_i32 s5, s41, 10
    s_mul_i32 s6, s3, 1040
    v_add_u32 v28, s5, v3
    v_lshrrev_b32 v29, 2, v28
    v_mul_u32_u24 v29, 3136, v29
    v_lshl_add_u32 v29, v28, 8, v29
    v_lshl_add_u32 v29, v2, 4, v29
    v_add_u32 v46, s6, v29
    v_lshrrev_b32 v28, 1, v3
    v_add_u32 v28, s5, v28
    v_lshrrev_b32 v29, 2, v28
    v_mul_u32_u24 v29, 3136, v29
    v_lshl_add_u32 v29, v28, 8, v29
    v_lshl_add_u32 v29, v2, 4, v29
    v_add_u32 v47, s6, v29
    v_and_b32 v28, 1, v3
    v_lshl_add_u32 v47, v28, 3, v47
    v_mov_b32 v62, 0
    v_mov_b32 v63, 0
    v_mov_b32 v64, 0
    v_mov_b32 v65, 0
    v_mov_b32 v71, -1
    global_load_dwordx4 v[138:141], v67, s[38:39] offset:-2048 sc1
    v_add_u32 v69, 0, v68
    s_waitcnt vmcnt(10)
    ds_write2_b64 v69, v[98:99], v[100:101] offset0:0 offset1:2
    v_dot2_f32_bf16 v62, v98, s7, v62
    v_dot2_f32_bf16 v63, v98, v98, v63
    v_dot2_f32_bf16 v64, v100, s7, v64
    v_dot2_f32_bf16 v65, v100, v100, v65
    v_dot2_f32_bf16 v62, v99, s7, v62
    v_dot2_f32_bf16 v63, v99, v99, v63
    v_dot2_f32_bf16 v64, v101, s7, v64
    v_dot2_f32_bf16 v65, v101, v101, v65
    global_load_dwordx4 v[142:145], v67, s[38:39] offset:-1024 sc1
    s_waitcnt vmcnt(10)
    ds_write2_b64 v69, v[102:103], v[104:105] offset0:32 offset1:34
    v_bitop3_b32 v71, v101, v105, v71 bitop3:0x80
    v_dot2_f32_bf16 v62, v102, s7, v62
    v_dot2_f32_bf16 v63, v102, v102, v63
    v_dot2_f32_bf16 v64, v104, s7, v64
    v_dot2_f32_bf16 v65, v104, v104, v65
    v_dot2_f32_bf16 v62, v103, s7, v62
    v_dot2_f32_bf16 v63, v103, v103, v63
    v_dot2_f32_bf16 v64, v105, s7, v64
    v_dot2_f32_bf16 v65, v105, v105, v65
    global_load_dwordx4 v[146:149], v67, s[38:39] offset:0 sc1
    s_waitcnt vmcnt(10)
    ds_write2_b64 v69, v[106:107], v[108:109] offset0:64 offset1:66
    v_dot2_f32_bf16 v62, v106, s7, v62
    v_dot2_f32_bf16 v63, v106, v106, v63
    v_dot2_f32_bf16 v64, v108, s7, v64
    v_dot2_f32_bf16 v65, v108, v108, v65
    v_dot2_f32_bf16 v62, v107, s7, v62
    v_dot2_f32_bf16 v63, v107, v107, v63
    v_dot2_f32_bf16 v64, v109, s7, v64
    v_dot2_f32_bf16 v65, v109, v109, v65
    global_load_dwordx4 v[150:153], v67, s[38:39] offset:1024 sc1
    s_waitcnt vmcnt(10)
    ds_write2_b64 v69, v[110:111], v[112:113] offset0:96 offset1:98
    v_bitop3_b32 v71, v109, v113, v71 bitop3:0x80
    v_dot2_f32_bf16 v62, v110, s7, v62
    v_dot2_f32_bf16 v63, v110, v110, v63
    v_dot2_f32_bf16 v64, v112, s7, v64
    v_dot2_f32_bf16 v65, v112, v112, v65
    v_dot2_f32_bf16 v62, v111, s7, v62
    v_dot2_f32_bf16 v63, v111, v111, v63
    v_dot2_f32_bf16 v64, v113, s7, v64
    v_dot2_f32_bf16 v65, v113, v113, v65
    global_load_dwordx4 v[154:157], v67, s[38:39] offset:2048 sc1
    v_add_u32 v69, 4160, v68
    s_waitcnt vmcnt(10)
    ds_write2_b64 v69, v[114:115], v[116:117] offset0:0 offset1:2
    v_dot2_f32_bf16 v62, v114, s7, v62
    v_dot2_f32_bf16 v63, v114, v114, v63
    v_dot2_f32_bf16 v64, v116, s7, v64
    v_dot2_f32_bf16 v65, v116, v116, v65
    v_dot2_f32_bf16 v62, v115, s7, v62
    v_dot2_f32_bf16 v63, v115, v115, v63
    v_dot2_f32_bf16 v64, v117, s7, v64
    v_dot2_f32_bf16 v65, v117, v117, v65
    global_load_dwordx4 v[158:161], v67, s[38:39] offset:3072 sc1
    v_add_u32 v67, 8192, v67
    s_waitcnt vmcnt(10)
    ds_write2_b64 v69, v[118:119], v[120:121] offset0:32 offset1:34
    v_bitop3_b32 v71, v117, v121, v71 bitop3:0x80
    v_dot2_f32_bf16 v62, v118, s7, v62
    v_dot2_f32_bf16 v63, v118, v118, v63
    v_dot2_f32_bf16 v64, v120, s7, v64
    v_dot2_f32_bf16 v65, v120, v120, v65
    v_dot2_f32_bf16 v62, v119, s7, v62
    v_dot2_f32_bf16 v63, v119, v119, v63
    v_dot2_f32_bf16 v64, v121, s7, v64
    v_dot2_f32_bf16 v65, v121, v121, v65
    global_load_dwordx4 v[162:165], v67, s[38:39] offset:-4096 sc1
    s_waitcnt vmcnt(10)
    ds_write2_b64 v69, v[122:123], v[124:125] offset0:64 offset1:66
    v_dot2_f32_bf16 v62, v122, s7, v62
    v_dot2_f32_bf16 v63, v122, v122, v63
    v_dot2_f32_bf16 v64, v124, s7, v64
    v_dot2_f32_bf16 v65, v124, v124, v65
    v_dot2_f32_bf16 v62, v123, s7, v62
    v_dot2_f32_bf16 v63, v123, v123, v63
    v_dot2_f32_bf16 v64, v125, s7, v64
    v_dot2_f32_bf16 v65, v125, v125, v65
    global_load_dwordx4 v[166:169], v67, s[38:39] offset:-3072 sc1
    s_waitcnt vmcnt(10)
    ds_write2_b64 v69, v[126:127], v[128:129] offset0:96 offset1:98
    v_bitop3_b32 v71, v125, v129, v71 bitop3:0x80
    v_dot2_f32_bf16 v62, v126, s7, v62
    v_dot2_f32_bf16 v63, v126, v126, v63
    v_dot2_f32_bf16 v64, v128, s7, v64
    v_dot2_f32_bf16 v65, v128, v128, v65
    v_dot2_f32_bf16 v62, v127, s7, v62
    v_dot2_f32_bf16 v63, v127, v127, v63
    v_dot2_f32_bf16 v64, v129, s7, v64
    v_dot2_f32_bf16 v65, v129, v129, v65
    global_load_dwordx4 v[170:173], v67, s[38:39] offset:-2048 sc1
    v_add_u32 v69, 8320, v68
    s_waitcnt vmcnt(10)
    ds_write2_b64 v69, v[130:131], v[132:133] offset0:0 offset1:2
    v_dot2_f32_bf16 v62, v130, s7, v62
    v_dot2_f32_bf16 v63, v130, v130, v63
    v_dot2_f32_bf16 v64, v132, s7, v64
    v_dot2_f32_bf16 v65, v132, v132, v65
    v_dot2_f32_bf16 v62, v131, s7, v62
    v_dot2_f32_bf16 v63, v131, v131, v63
    v_dot2_f32_bf16 v64, v133, s7, v64
    v_dot2_f32_bf16 v65, v133, v133, v65
    global_load_dwordx4 v[174:177], v67, s[38:39] offset:-1024 sc1
    s_waitcnt vmcnt(10)
    ds_write2_b64 v69, v[134:135], v[136:137] offset0:32 offset1:34
    v_bitop3_b32 v71, v133, v137, v71 bitop3:0x80
    v_dot2_f32_bf16 v62, v134, s7, v62
    v_dot2_f32_bf16 v63, v134, v134, v63
    v_dot2_f32_bf16 v64, v136, s7, v64
    v_dot2_f32_bf16 v65, v136, v136, v65
    v_dot2_f32_bf16 v62, v135, s7, v62
    v_dot2_f32_bf16 v63, v135, v135, v63
    v_dot2_f32_bf16 v64, v137, s7, v64
    v_dot2_f32_bf16 v65, v137, v137, v65
    global_load_dwordx4 a[96:99], v4, s[8:9] offset:-4096 sc1
    s_waitcnt vmcnt(10)
    ds_write2_b64 v69, v[138:139], v[140:141] offset0:64 offset1:66
    v_dot2_f32_bf16 v62, v138, s7, v62
    v_dot2_f32_bf16 v63, v138, v138, v63
    v_dot2_f32_bf16 v64, v140, s7, v64
    v_dot2_f32_bf16 v65, v140, v140, v65
    v_dot2_f32_bf16 v62, v139, s7, v62
    v_dot2_f32_bf16 v63, v139, v139, v63
    v_dot2_f32_bf16 v64, v141, s7, v64
    v_dot2_f32_bf16 v65, v141, v141, v65
    global_load_dwordx4 a[100:103], v7, s[14:15] offset:-4096 sc1
    s_waitcnt vmcnt(10)
    ds_write2_b64 v69, v[142:143], v[144:145] offset0:96 offset1:98
    v_bitop3_b32 v71, v141, v145, v71 bitop3:0x80
    v_dot2_f32_bf16 v62, v142, s7, v62
    v_dot2_f32_bf16 v63, v142, v142, v63
    v_dot2_f32_bf16 v64, v144, s7, v64
    v_dot2_f32_bf16 v65, v144, v144, v65
    v_dot2_f32_bf16 v62, v143, s7, v62
    v_dot2_f32_bf16 v63, v143, v143, v63
    v_dot2_f32_bf16 v64, v145, s7, v64
    v_dot2_f32_bf16 v65, v145, v145, v65
    global_load_dwordx4 a[104:107], v4, s[8:9] offset:-3072 sc1
    v_add_u32 v69, 12480, v68
    s_waitcnt vmcnt(10)
    ds_write2_b64 v69, v[146:147], v[148:149] offset0:0 offset1:2
    v_dot2_f32_bf16 v62, v146, s7, v62
    v_dot2_f32_bf16 v63, v146, v146, v63
    v_dot2_f32_bf16 v64, v148, s7, v64
    v_dot2_f32_bf16 v65, v148, v148, v65
    v_dot2_f32_bf16 v62, v147, s7, v62
    v_dot2_f32_bf16 v63, v147, v147, v63
    v_dot2_f32_bf16 v64, v149, s7, v64
    v_dot2_f32_bf16 v65, v149, v149, v65
    global_load_dwordx4 a[108:111], v7, s[14:15] offset:-3072 sc1
    s_waitcnt vmcnt(10)
    ds_write2_b64 v69, v[150:151], v[152:153] offset0:32 offset1:34
    v_bitop3_b32 v71, v149, v153, v71 bitop3:0x80
    v_dot2_f32_bf16 v62, v150, s7, v62
    v_dot2_f32_bf16 v63, v150, v150, v63
    v_dot2_f32_bf16 v64, v152, s7, v64
    v_dot2_f32_bf16 v65, v152, v152, v65
    v_dot2_f32_bf16 v62, v151, s7, v62
    v_dot2_f32_bf16 v63, v151, v151, v63
    v_dot2_f32_bf16 v64, v153, s7, v64
    v_dot2_f32_bf16 v65, v153, v153, v65
    global_load_dwordx4 a[112:115], v4, s[8:9] offset:-2048 sc1
    s_waitcnt vmcnt(10)
    ds_write2_b64 v69, v[154:155], v[156:157] offset0:64 offset1:66
    v_dot2_f32_bf16 v62, v154, s7, v62
    v_dot2_f32_bf16 v63, v154, v154, v63
    v_dot2_f32_bf16 v64, v156, s7, v64
    v_dot2_f32_bf16 v65, v156, v156, v65
    v_dot2_f32_bf16 v62, v155, s7, v62
    v_dot2_f32_bf16 v63, v155, v155, v63
    v_dot2_f32_bf16 v64, v157, s7, v64
    v_dot2_f32_bf16 v65, v157, v157, v65
    global_load_dwordx4 a[116:119], v7, s[14:15] offset:-2048 sc1
    s_waitcnt vmcnt(10)
    ds_write2_b64 v69, v[158:159], v[160:161] offset0:96 offset1:98
    v_bitop3_b32 v71, v157, v161, v71 bitop3:0x80
    v_dot2_f32_bf16 v62, v158, s7, v62
    v_dot2_f32_bf16 v63, v158, v158, v63
    v_dot2_f32_bf16 v64, v160, s7, v64
    v_dot2_f32_bf16 v65, v160, v160, v65
    v_dot2_f32_bf16 v62, v159, s7, v62
    v_dot2_f32_bf16 v63, v159, v159, v63
    v_dot2_f32_bf16 v64, v161, s7, v64
    v_dot2_f32_bf16 v65, v161, v161, v65
    global_load_dwordx4 a[120:123], v4, s[8:9] offset:-1024 sc1
    v_add_u32 v69, 16640, v68
    s_waitcnt vmcnt(10)
    ds_write2_b64 v69, v[162:163], v[164:165] offset0:0 offset1:2
    v_dot2_f32_bf16 v62, v162, s7, v62
    v_dot2_f32_bf16 v63, v162, v162, v63
    v_dot2_f32_bf16 v64, v164, s7, v64
    v_dot2_f32_bf16 v65, v164, v164, v65
    v_dot2_f32_bf16 v62, v163, s7, v62
    v_dot2_f32_bf16 v63, v163, v163, v63
    v_dot2_f32_bf16 v64, v165, s7, v64
    v_dot2_f32_bf16 v65, v165, v165, v65
    global_load_dwordx4 a[124:127], v7, s[14:15] offset:-1024 sc1
    s_waitcnt vmcnt(10)
    ds_write2_b64 v69, v[166:167], v[168:169] offset0:32 offset1:34
    v_bitop3_b32 v71, v165, v169, v71 bitop3:0x80
    v_dot2_f32_bf16 v62, v166, s7, v62
    v_dot2_f32_bf16 v63, v166, v166, v63
    v_dot2_f32_bf16 v64, v168, s7, v64
    v_dot2_f32_bf16 v65, v168, v168, v65
    v_dot2_f32_bf16 v62, v167, s7, v62
    v_dot2_f32_bf16 v63, v167, v167, v63
    v_dot2_f32_bf16 v64, v169, s7, v64
    v_dot2_f32_bf16 v65, v169, v169, v65
    s_waitcnt vmcnt(9)
    ds_write2_b64 v69, v[170:171], v[172:173] offset0:64 offset1:66
    v_dot2_f32_bf16 v62, v170, s7, v62
    v_dot2_f32_bf16 v63, v170, v170, v63
    v_dot2_f32_bf16 v64, v172, s7, v64
    v_dot2_f32_bf16 v65, v172, v172, v65
    v_dot2_f32_bf16 v62, v171, s7, v62
    v_dot2_f32_bf16 v63, v171, v171, v63
    v_dot2_f32_bf16 v64, v173, s7, v64
    v_dot2_f32_bf16 v65, v173, v173, v65
    s_waitcnt vmcnt(8)
    ds_write2_b64 v69, v[174:175], v[176:177] offset0:96 offset1:98
    v_bitop3_b32 v71, v173, v177, v71 bitop3:0x80
    v_dot2_f32_bf16 v62, v174, s7, v62
    v_dot2_f32_bf16 v63, v174, v174, v63
    v_dot2_f32_bf16 v64, v176, s7, v64
    v_dot2_f32_bf16 v65, v176, v176, v65
    v_dot2_f32_bf16 v62, v175, s7, v62
    v_dot2_f32_bf16 v63, v175, v175, v63
    v_dot2_f32_bf16 v64, v177, s7, v64
    v_dot2_f32_bf16 v65, v177, v177, v65
    v_and_b32 v71, 1, v71
    v_cmp_ne_u32 vcc, 1, v71
    s_cmp_ge_u32 s100, 262144
    s_cbranch_scc1 Lx_go
    s_cbranch_vccnz Lx_redo
Lx_go:
    v_add_f32_dpp v90, v62, v62 row_ror:8 row_mask:0xf bank_mask:0x3
    s_nop 1
    v_add_f32_dpp v90, v64, v64 row_ror:8 row_mask:0xf bank_mask:0xc
    v_add_f32_dpp v91, v63, v63 row_ror:8 row_mask:0xf bank_mask:0x3
    s_nop 1
    v_add_f32_dpp v91, v65, v65 row_ror:8 row_mask:0xf bank_mask:0xc
    s_add_u32 s4, s88, 148736
    v_lshl_add_u32 v28, v70, 3, s4
    ds_write_b64 v28, v[90:91]
    s_waitcnt lgkmcnt(0)
    s_barrier
    v_add_u32 v173, 41600, v4
    ds_read_b128 v[48:51], v173 offset:37440
    ds_read_b128 v[52:55], v173 offset:38480
    ds_read_b128 v[56:59], v173 offset:39520
    ds_read_b128 v[60:63], v173 offset:40560
    ds_read_b128 v[64:67], v173 offset:33280
    s_waitcnt lgkmcnt(3)
    v_mfma_f32_16x16x32_bf16 v[178:181], v[48:51], a[248:251], 0
    ds_read_b128 v[68:71], v173 offset:34320
    s_add_u32 m0, s89, 8192
    v_mfma_f32_16x16x32_bf16 v[194:197], v[48:51], a[252:255], 0
    v_mfma_f32_16x16x32_bf16 v[182:185], v[52:55], a[248:251], 0
    ds_read_b128 v[48:51], v173 offset:35360
    v_mfma_f32_16x16x32_bf16 v[198:201], v[52:55], a[252:255], 0
    s_waitcnt lgkmcnt(3)
    v_mfma_f32_16x16x32_bf16 v[186:189], v[56:59], a[248:251], 0
    ds_read_b128 v[52:55], v173 offset:36400
    v_add_u32 v28, 148736, v30
    v_mfma_f32_16x16x32_bf16 v[202:205], v[56:59], a[252:255], 0
    global_load_lds_dwordx4 v74, s[70:71] offset:0
    ds_read_b64 v[90:91], v28 offset:0
    v_mfma_f32_16x16x32_bf16 v[190:193], v[60:63], a[248:251], 0
    ds_read_b128 v[56:59], v173 offset:29120
    v_mfma_f32_16x16x32_bf16 v[206:209], v[60:63], a[252:255], 0
    ds_read_b64 v[92:93], v28 offset:512
    s_waitcnt lgkmcnt(5)
    v_mfma_f32_16x16x32_bf16 v[178:181], v[64:67], a[240:243], v[178:181]
    ds_read_b128 v[60:63], v173 offset:30160
    v_mfma_f32_16x16x32_bf16 v[194:197], v[64:67], a[244:247], v[194:197]
    ds_read_b64 v[94:95], v28 offset:1024
    v_mfma_f32_16x16x32_bf16 v[182:185], v[68:71], a[240:243], v[182:185]
    ds_read_b128 v[64:67], v173 offset:31200
    global_load_lds_dwordx4 v75, s[70:71] offset:1024
    v_mfma_f32_16x16x32_bf16 v[198:201], v[68:71], a[244:247], v[198:201]
    ds_read_b64 v[96:97], v28 offset:1536
    s_waitcnt lgkmcnt(7)
    v_mfma_f32_16x16x32_bf16 v[186:189], v[48:51], a[240:243], v[186:189]
    ds_read_b128 v[68:71], v173 offset:32240
    v_mfma_f32_16x16x32_bf16 v[202:205], v[48:51], a[244:247], v[202:205]
    s_add_u32 s4, s88, 150784
    v_mfma_f32_16x16x32_bf16 v[190:193], v[52:55], a[240:243], v[190:193]
    ds_read_b128 v[48:51], v173 offset:24960
    v_mfma_f32_16x16x32_bf16 v[206:209], v[52:55], a[244:247], v[206:209]
    v_lshl_add_u32 v170, v1, 2, s4
    s_waitcnt lgkmcnt(5)
    v_mfma_f32_16x16x32_bf16 v[178:181], v[56:59], a[232:235], v[178:181]
    ds_read_b128 v[52:55], v173 offset:26000
    global_load_lds_dwordx4 v76, s[70:71] offset:2048
    v_mfma_f32_16x16x32_bf16 v[194:197], v[56:59], a[236:239], v[194:197]
    v_lshl_add_u32 v171, v3, 5, s4
    v_mfma_f32_16x16x32_bf16 v[182:185], v[60:63], a[232:235], v[182:185]
    ds_read_b128 v[56:59], v173 offset:27040
    v_lshl_add_u32 v172, v5, 2, s4
    v_mfma_f32_16x16x32_bf16 v[198:201], v[60:63], a[236:239], v[198:201]
    s_waitcnt lgkmcnt(3)
    v_mfma_f32_16x16x32_bf16 v[186:189], v[64:67], a[232:235], v[186:189]
    ds_read_b128 v[60:63], v173 offset:28080
    v_add_f32 v90, v90, v92
    v_mfma_f32_16x16x32_bf16 v[202:205], v[64:67], a[236:239], v[202:205]
    global_load_lds_dwordx4 v77, s[70:71] offset:3072
    v_mfma_f32_16x16x32_bf16 v[190:193], v[68:71], a[232:235], v[190:193]
    ds_read_b128 v[64:67], v173 offset:20800
    v_add_f32 v91, v91, v93
    v_mfma_f32_16x16x32_bf16 v[206:209], v[68:71], a[236:239], v[206:209]
    s_waitcnt lgkmcnt(3)
    v_mfma_f32_16x16x32_bf16 v[178:181], v[48:51], a[224:227], v[178:181]
    ds_read_b128 v[68:71], v173 offset:21840
    v_add_f32 v94, v94, v96
    v_mfma_f32_16x16x32_bf16 v[194:197], v[48:51], a[228:231], v[194:197]
    v_mfma_f32_16x16x32_bf16 v[182:185], v[52:55], a[224:227], v[182:185]
    ds_read_b128 v[48:51], v173 offset:22880
    v_add_f32 v95, v95, v97
    s_add_u32 m0, s89, 12288
    v_mfma_f32_16x16x32_bf16 v[198:201], v[52:55], a[228:231], v[198:201]
    s_waitcnt lgkmcnt(3)
    v_mfma_f32_16x16x32_bf16 v[186:189], v[56:59], a[224:227], v[186:189]
    ds_read_b128 v[52:55], v173 offset:23920
    v_add_f32 v90, v90, v94
    v_mfma_f32_16x16x32_bf16 v[202:205], v[56:59], a[228:231], v[202:205]
    v_add_f32 v91, v91, v95
    v_mfma_f32_16x16x32_bf16 v[190:193], v[60:63], a[224:227], v[190:193]
    ds_read_b128 v[56:59], v173 offset:16640
    v_mfma_f32_16x16x32_bf16 v[206:209], v[60:63], a[228:231], v[206:209]
    v_mul_f32 v90, 0x3acccccd, v90
    s_waitcnt lgkmcnt(3)
    v_mfma_f32_16x16x32_bf16 v[178:181], v[64:67], a[216:219], v[178:181]
    ds_read_b128 v[60:63], v173 offset:17680
    global_load_lds_dwordx4 v78, s[70:71] offset:0
    v_mfma_f32_16x16x32_bf16 v[194:197], v[64:67], a[220:223], v[194:197]
    v_mul_f32 v91, 0x3acccccd, v91
    v_mfma_f32_16x16x32_bf16 v[182:185], v[68:71], a[216:219], v[182:185]
    ds_read_b128 v[64:67], v173 offset:18720
    v_mfma_f32_16x16x32_bf16 v[198:201], v[68:71], a[220:223], v[198:201]
    v_fma_f32 v91, -v90, v90, v91
    s_waitcnt lgkmcnt(3)
    v_mfma_f32_16x16x32_bf16 v[186:189], v[48:51], a[216:219], v[186:189]
    ds_read_b128 v[68:71], v173 offset:19760
    v_mfma_f32_16x16x32_bf16 v[202:205], v[48:51], a[220:223], v[202:205]
    v_max_f32 v91, 0, v91
    global_load_lds_dwordx4 v79, s[70:71] offset:1024
    v_mfma_f32_16x16x32_bf16 v[190:193], v[52:55], a[216:219], v[190:193]
    ds_read_b128 v[48:51], v173 offset:12480
    v_mfma_f32_16x16x32_bf16 v[206:209], v[52:55], a[220:223], v[206:209]
    v_add_f32 v91, 0x3727c5ac, v91
    s_waitcnt lgkmcnt(3)
    v_mfma_f32_16x16x32_bf16 v[178:181], v[56:59], a[208:211], v[178:181]
    ds_read_b128 v[52:55], v173 offset:13520
    v_mfma_f32_16x16x32_bf16 v[194:197], v[56:59], a[212:215], v[194:197]
    v_rsq_f32 v92, v91
    v_mfma_f32_16x16x32_bf16 v[182:185], v[60:63], a[208:211], v[182:185]
    ds_read_b128 v[56:59], v173 offset:14560
    global_load_lds_dwordx4 v80, s[70:71] offset:2048
    v_mfma_f32_16x16x32_bf16 v[198:201], v[60:63], a[212:215], v[198:201]
    s_waitcnt lgkmcnt(3)
    v_mfma_f32_16x16x32_bf16 v[186:189], v[64:67], a[208:211], v[186:189]
    ds_read_b128 v[60:63], v173 offset:15600
    v_mul_f32_e64 v91, -v90, v92
    v_mfma_f32_16x16x32_bf16 v[202:205], v[64:67], a[212:215], v[202:205]
    v_mfma_f32_16x16x32_bf16 v[190:193], v[68:71], a[208:211], v[190:193]
    ds_read_b128 v[64:67], v173 offset:8320
    v_mov_b32 v90, v92
    v_mfma_f32_16x16x32_bf16 v[206:209], v[68:71], a[212:215], v[206:209]
    s_waitcnt lgkmcnt(3)
    v_mfma_f32_16x16x32_bf16 v[178:181], v[48:51], a[200:203], v[178:181]
    ds_read_b128 v[68:71], v173 offset:9360
    global_load_lds_dwordx4 v81, s[70:71] offset:3072
    v_mfma_f32_16x16x32_bf16 v[194:197], v[48:51], a[204:207], v[194:197]
    ds_write2st64_b32 v170, v90, v91 offset0:0 offset1:1
    v_mfma_f32_16x16x32_bf16 v[182:185], v[52:55], a[200:203], v[182:185]
    ds_read_b128 v[48:51], v173 offset:10400
    ds_read_b128 v[98:101], v171 offset:0
    v_mfma_f32_16x16x32_bf16 v[198:201], v[52:55], a[204:207], v[198:201]
    s_waitcnt lgkmcnt(5)
    v_mfma_f32_16x16x32_bf16 v[186:189], v[56:59], a[200:203], v[186:189]
    ds_read_b128 v[52:55], v173 offset:11440
    ds_read_b128 v[102:105], v171 offset:16
    v_mfma_f32_16x16x32_bf16 v[202:205], v[56:59], a[204:207], v[202:205]
    global_load_dwordx4 a[0:3], v4, s[52:53] offset:-4096 sc1
    v_mfma_f32_16x16x32_bf16 v[190:193], v[60:63], a[200:203], v[190:193]
    ds_read_b128 v[56:59], v173 offset:4160
    ds_read_b128 v[106:109], v171 offset:128
    v_mfma_f32_16x16x32_bf16 v[206:209], v[60:63], a[204:207], v[206:209]
    ds_read_b128 v[110:113], v171 offset:144
    s_waitcnt lgkmcnt(8)
    v_mfma_f32_16x16x32_bf16 v[178:181], v[64:67], a[192:195], v[178:181]
    ds_read_b128 v[60:63], v173 offset:5200
    v_mfma_f32_16x16x32_bf16 v[194:197], v[64:67], a[196:199], v[194:197]
    ds_read_b128 v[114:117], v171 offset:256
    v_mfma_f32_16x16x32_bf16 v[182:185], v[68:71], a[192:195], v[182:185]
    ds_read_b128 v[64:67], v173 offset:6240
    global_load_dwordx4 a[4:7], v7, s[58:59] offset:-4096 sc1
    v_mfma_f32_16x16x32_bf16 v[198:201], v[68:71], a[196:199], v[198:201]
    ds_read_b128 v[118:121], v171 offset:272
    s_waitcnt lgkmcnt(8)
    v_mfma_f32_16x16x32_bf16 v[186:189], v[48:51], a[192:195], v[186:189]
    ds_read_b128 v[68:71], v173 offset:7280
    v_mfma_f32_16x16x32_bf16 v[202:205], v[48:51], a[196:199], v[202:205]
    ds_read_b128 v[122:125], v171 offset:384
    v_mfma_f32_16x16x32_bf16 v[190:193], v[52:55], a[192:195], v[190:193]
    ds_read_b128 v[48:51], v173 offset:0
    v_mfma_f32_16x16x32_bf16 v[206:209], v[52:55], a[196:199], v[206:209]
    ds_read_b128 v[126:129], v171 offset:400
    s_waitcnt lgkmcnt(7)
    v_mfma_f32_16x16x32_bf16 v[178:181], v[56:59], a[184:187], v[178:181]
    ds_read_b128 v[52:55], v173 offset:1040
    global_load_dwordx4 a[8:11], v4, s[52:53] offset:-3072 sc1
    v_mfma_f32_16x16x32_bf16 v[194:197], v[56:59], a[188:191], v[194:197]
    ds_read_b32 v162, v172 offset:0
    v_mfma_f32_16x16x32_bf16 v[182:185], v[60:63], a[184:187], v[182:185]
    ds_read_b128 v[56:59], v173 offset:2080
    v_mfma_f32_16x16x32_bf16 v[198:201], v[60:63], a[188:191], v[198:201]
    ds_read_b32 v163, v172 offset:256
    s_waitcnt lgkmcnt(7)
    v_mfma_f32_16x16x32_bf16 v[186:189], v[64:67], a[184:187], v[186:189]
    ds_read_b128 v[60:63], v173 offset:3120
    ds_read_b32 v164, v172 offset:16
    v_mfma_f32_16x16x32_bf16 v[202:205], v[64:67], a[188:191], v[202:205]
    global_load_dwordx4 a[12:15], v7, s[58:59] offset:-3072 sc1
    v_mfma_f32_16x16x32_bf16 v[190:193], v[68:71], a[184:187], v[190:193]
    ds_read_b128 v[64:67], v4 offset:37440
    ds_read_b32 v165, v172 offset:272
    v_mfma_f32_16x16x32_bf16 v[206:209], v[68:71], a[188:191], v[206:209]
    s_waitcnt lgkmcnt(7)
    v_mfma_f32_16x16x32_bf16 v[178:181], v[48:51], a[176:179], v[178:181]
    ds_read_b128 v[68:71], v4 offset:38480
    ds_read_b32 v166, v172 offset:128
    v_mfma_f32_16x16x32_bf16 v[194:197], v[48:51], a[180:183], v[194:197]
    v_mfma_f32_16x16x32_bf16 v[182:185], v[52:55], a[176:179], v[182:185]
    ds_read_b128 v[48:51], v4 offset:39520
    ds_read_b32 v167, v172 offset:384
    v_mfma_f32_16x16x32_bf16 v[198:201], v[52:55], a[180:183], v[198:201]
    global_load_dwordx4 a[16:19], v4, s[52:53] offset:-2048 sc1
    s_waitcnt lgkmcnt(7)
    v_mfma_f32_16x16x32_bf16 v[186:189], v[56:59], a[176:179], v[186:189]
    ds_read_b128 v[52:55], v4 offset:40560
    ds_read_b32 v168, v172 offset:144
    v_mfma_f32_16x16x32_bf16 v[202:205], v[56:59], a[180:183], v[202:205]
    v_mfma_f32_16x16x32_bf16 v[190:193], v[60:63], a[176:179], v[190:193]
    ds_read_b128 v[56:59], v4 offset:33280
    ds_read_b32 v169, v172 offset:400
    v_mfma_f32_16x16x32_bf16 v[206:209], v[60:63], a[180:183], v[206:209]
    s_waitcnt lgkmcnt(7)
    v_mfma_f32_16x16x32_bf16 v[178:181], v[64:67], a[168:171], v[178:181]
    ds_read_b128 v[60:63], v4 offset:34320
    s_add_u32 s4, s88, 156672
    global_load_dwordx4 a[20:23], v7, s[58:59] offset:-2048 sc1
    v_mfma_f32_16x16x32_bf16 v[194:197], v[64:67], a[172:175], v[194:197]
    v_lshl_add_u32 v28, v2, 2, s4
    v_mfma_f32_16x16x32_bf16 v[182:185], v[68:71], a[168:171], v[182:185]
    ds_read_b128 v[64:67], v4 offset:35360
    v_mfma_f32_16x16x32_bf16 v[198:201], v[68:71], a[172:175], v[198:201]
    ds_read2_b32 v[8:9], v28 offset0:0 offset1:16
    s_waitcnt lgkmcnt(6)
    v_mfma_f32_16x16x32_bf16 v[186:189], v[48:51], a[168:171], v[186:189]
    ds_read_b128 v[68:71], v4 offset:36400
    v_mfma_f32_16x16x32_bf16 v[202:205], v[48:51], a[172:175], v[202:205]
    global_load_dwordx4 a[24:27], v4, s[52:53] offset:-1024 sc1
    ds_read2_b32 v[10:11], v28 offset0:32 offset1:48
    v_mfma_f32_16x16x32_bf16 v[190:193], v[52:55], a[168:171], v[190:193]
    ds_read_b128 v[48:51], v4 offset:29120
    v_mfma_f32_16x16x32_bf16 v[206:209], v[52:55], a[172:175], v[206:209]
    v_lshl_add_u32 v28, v3, 4, s4
    s_waitcnt lgkmcnt(5)
    v_mfma_f32_16x16x32_bf16 v[178:181], v[56:59], a[160:163], v[178:181]
    ds_read_b128 v[52:55], v4 offset:30160
    v_mfma_f32_16x16x32_bf16 v[194:197], v[56:59], a[164:167], v[194:197]
    ds_read_b128 v[12:15], v28 offset:256
    v_mfma_f32_16x16x32_bf16 v[182:185], v[60:63], a[160:163], v[182:185]
    ds_read_b128 v[56:59], v4 offset:31200
    global_load_dwordx4 a[28:31], v7, s[58:59] offset:-1024 sc1
    v_mfma_f32_16x16x32_bf16 v[198:201], v[60:63], a[164:167], v[198:201]
    ds_read_b128 v[16:19], v28 offset:320
    s_waitcnt lgkmcnt(6)
    v_mfma_f32_16x16x32_bf16 v[186:189], v[64:67], a[160:163], v[186:189]
    ds_read_b128 v[60:63], v4 offset:32240
    ds_read_b128 v[20:23], v28 offset:384
    v_mfma_f32_16x16x32_bf16 v[202:205], v[64:67], a[164:167], v[202:205]
    v_mfma_f32_16x16x32_bf16 v[190:193], v[68:71], a[160:163], v[190:193]
    ds_read_b128 v[64:67], v4 offset:24960
    ds_read_b128 v[24:27], v28 offset:448
    v_mfma_f32_16x16x32_bf16 v[206:209], v[68:71], a[164:167], v[206:209]
    s_waitcnt lgkmcnt(7)
    v_mfma_f32_16x16x32_bf16 v[178:181], v[48:51], a[152:155], v[178:181]
    ds_read_b128 v[68:71], v4 offset:26000
    global_load_dwordx4 a[32:35], v4, s[52:53] offset:0 sc1
    v_mfma_f32_16x16x32_bf16 v[194:197], v[48:51], a[156:159], v[194:197]
    v_fma_f32 v130, v114, v8, v9
    v_mfma_f32_16x16x32_bf16 v[182:185], v[52:55], a[152:155], v[182:185]
    ds_read_b128 v[48:51], v4 offset:27040
    v_fma_f32 v131, v115, v8, v9
    v_mfma_f32_16x16x32_bf16 v[198:201], v[52:55], a[156:159], v[198:201]
    s_waitcnt lgkmcnt(5)
    v_mfma_f32_16x16x32_bf16 v[186:189], v[56:59], a[152:155], v[186:189]
    ds_read_b128 v[52:55], v4 offset:28080
    v_fma_f32 v132, v116, v8, v9
    v_mfma_f32_16x16x32_bf16 v[202:205], v[56:59], a[156:159], v[202:205]
    global_load_dwordx4 a[36:39], v7, s[58:59] offset:0 sc1
    v_mfma_f32_16x16x32_bf16 v[190:193], v[60:63], a[152:155], v[190:193]
    ds_read_b128 v[56:59], v4 offset:20800
    v_fma_f32 v133, v117, v8, v9
    v_mfma_f32_16x16x32_bf16 v[206:209], v[60:63], a[156:159], v[206:209]
    s_waitcnt lgkmcnt(3)
    v_mfma_f32_16x16x32_bf16 v[178:181], v[64:67], a[144:147], v[178:181]
    ds_read_b128 v[60:63], v4 offset:21840
    v_fma_f32 v134, v118, v8, v9
    v_mfma_f32_16x16x32_bf16 v[194:197], v[64:67], a[148:151], v[194:197]
    v_fma_f32 v135, v119, v8, v9
    v_mfma_f32_16x16x32_bf16 v[182:185], v[68:71], a[144:147], v[182:185]
    ds_read_b128 v[64:67], v4 offset:22880
    global_load_dwordx4 a[40:43], v4, s[52:53] offset:1024 sc1
    v_mfma_f32_16x16x32_bf16 v[198:201], v[68:71], a[148:151], v[198:201]
    v_fma_f32 v136, v120, v8, v9
    s_waitcnt lgkmcnt(3)
    v_mfma_f32_16x16x32_bf16 v[186:189], v[48:51], a[144:147], v[186:189]
    ds_read_b128 v[68:71], v4 offset:23920
    v_mfma_f32_16x16x32_bf16 v[202:205], v[48:51], a[148:151], v[202:205]
    v_fma_f32 v137, v121, v8, v9
    v_mfma_f32_16x16x32_bf16 v[190:193], v[52:55], a[144:147], v[190:193]
    ds_read_b128 v[48:51], v4 offset:16640
    v_mfma_f32_16x16x32_bf16 v[206:209], v[52:55], a[148:151], v[206:209]
    v_fma_f32 v138, v122, v8, v9
    s_waitcnt lgkmcnt(3)
    v_mfma_f32_16x16x32_bf16 v[178:181], v[56:59], a[136:139], v[178:181]
    ds_read_b128 v[52:55], v4 offset:17680
    global_load_dwordx4 a[44:47], v7, s[58:59] offset:1024 sc1
    v_mfma_f32_16x16x32_bf16 v[194:197], v[56:59], a[140:143], v[194:197]
    v_fma_f32 v139, v123, v8, v9
    v_mfma_f32_16x16x32_bf16 v[182:185], v[60:63], a[136:139], v[182:185]
    ds_read_b128 v[56:59], v4 offset:18720
    v_mfma_f32_16x16x32_bf16 v[198:201], v[60:63], a[140:143], v[198:201]
    v_fma_f32 v140, v124, v8, v9
    s_waitcnt lgkmcnt(3)
    v_mfma_f32_16x16x32_bf16 v[186:189], v[64:67], a[136:139], v[186:189]
    ds_read_b128 v[60:63], v4 offset:19760
    v_mfma_f32_16x16x32_bf16 v[202:205], v[64:67], a[140:143], v[202:205]
    v_fma_f32 v141, v125, v8, v9
    global_load_dwordx4 a[48:51], v4, s[52:53] offset:2048 sc1
    v_mfma_f32_16x16x32_bf16 v[190:193], v[68:71], a[136:139], v[190:193]
    ds_read_b128 v[64:67], v4 offset:0
    v_fma_f32 v142, v126, v8, v9
    v_mfma_f32_16x16x32_bf16 v[206:209], v[68:71], a[140:143], v[206:209]
    s_waitcnt lgkmcnt(3)
    v_mfma_f32_16x16x32_bf16 v[178:181], v[48:51], a[128:131], v[178:181]
    ds_read_b128 v[68:71], v4 offset:1040
    v_fma_f32 v143, v127, v8, v9
    v_mfma_f32_16x16x32_bf16 v[194:197], v[48:51], a[132:135], v[194:197]
    v_mfma_f32_16x16x32_bf16 v[182:185], v[52:55], a[128:131], v[182:185]
    ds_read_b128 v[48:51], v4 offset:2080
    v_fma_f32 v144, v128, v8, v9
    v_mfma_f32_16x16x32_bf16 v[198:201], v[52:55], a[132:135], v[198:201]
    global_load_dwordx4 a[52:55], v7, s[58:59] offset:2048 sc1
    s_waitcnt lgkmcnt(3)
    v_mfma_f32_16x16x32_bf16 v[186:189], v[56:59], a[128:131], v[186:189]
    ds_read_b128 v[52:55], v4 offset:3120
    v_fma_f32 v145, v129, v8, v9
    v_mfma_f32_16x16x32_bf16 v[202:205], v[56:59], a[132:135], v[202:205]
    v_mfma_f32_16x16x32_bf16 v[190:193], v[60:63], a[128:131], v[190:193]
    ds_read_b128 v[56:59], v4 offset:4160
    v_fma_f32 v146, v114, v10, v11
    v_mfma_f32_16x16x32_bf16 v[206:209], v[60:63], a[132:135], v[206:209]
    s_waitcnt lgkmcnt(3)
    s_waitcnt vmcnt(29)
    v_mfma_f32_16x16x32_bf16 v[178:181], v[64:67], a[96:99], v[178:181]
    ds_read_b128 v[60:63], v4 offset:5200
    global_load_dwordx4 a[56:59], v4, s[52:53] offset:3072 sc1
    s_waitcnt vmcnt(29)
    v_mfma_f32_16x16x32_bf16 v[194:197], v[64:67], a[100:103], v[194:197]
    v_fma_f32 v147, v115, v10, v11
    v_mfma_f32_16x16x32_bf16 v[182:185], v[68:71], a[96:99], v[182:185]
    ds_read_b128 v[64:67], v4 offset:6240
    v_fma_f32 v148, v116, v10, v11
    v_mfma_f32_16x16x32_bf16 v[198:201], v[68:71], a[100:103], v[198:201]
    v_fma_f32 v149, v117, v10, v11
    s_waitcnt lgkmcnt(3)
    v_mfma_f32_16x16x32_bf16 v[186:189], v[48:51], a[96:99], v[186:189]
    ds_read_b128 v[68:71], v4 offset:7280
    v_mfma_f32_16x16x32_bf16 v[202:205], v[48:51], a[100:103], v[202:205]
    global_load_dwordx4 a[60:63], v7, s[58:59] offset:3072 sc1
    v_fma_f32 v150, v118, v10, v11
    v_mfma_f32_16x16x32_bf16 v[190:193], v[52:55], a[96:99], v[190:193]
    ds_read_b128 v[48:51], v4 offset:8320
    v_mfma_f32_16x16x32_bf16 v[206:209], v[52:55], a[100:103], v[206:209]
    v_fma_f32 v151, v119, v10, v11
    s_waitcnt lgkmcnt(3)
    s_waitcnt vmcnt(29)
    v_mfma_f32_16x16x32_bf16 v[178:181], v[56:59], a[104:107], v[178:181]
    ds_read_b128 v[52:55], v4 offset:9360
    s_waitcnt vmcnt(28)
    v_mfma_f32_16x16x32_bf16 v[194:197], v[56:59], a[108:111], v[194:197]
    v_fma_f32 v152, v120, v10, v11
    v_mfma_f32_16x16x32_bf16 v[182:185], v[60:63], a[104:107], v[182:185]
    ds_read_b128 v[56:59], v4 offset:10400
    global_load_dwordx4 a[64:67], v4, s[54:55] offset:-4096 sc1
    v_mfma_f32_16x16x32_bf16 v[198:201], v[60:63], a[108:111], v[198:201]
    v_fma_f32 v153, v121, v10, v11
    s_waitcnt lgkmcnt(3)
    v_mfma_f32_16x16x32_bf16 v[186:189], v[64:67], a[104:107], v[186:189]
    ds_read_b128 v[60:63], v4 offset:11440
    v_mfma_f32_16x16x32_bf16 v[202:205], v[64:67], a[108:111], v[202:205]
    v_fma_f32 v154, v122, v10, v11
    v_mfma_f32_16x16x32_bf16 v[190:193], v[68:71], a[104:107], v[190:193]
    ds_read_b128 v[64:67], v4 offset:12480
    v_mfma_f32_16x16x32_bf16 v[206:209], v[68:71], a[108:111], v[206:209]
    v_fma_f32 v155, v123, v10, v11
    s_waitcnt lgkmcnt(3)
    s_waitcnt vmcnt(28)
    v_mfma_f32_16x16x32_bf16 v[178:181], v[48:51], a[112:115], v[178:181]
    ds_read_b128 v[68:71], v4 offset:13520
    global_load_dwordx4 a[68:71], v7, s[60:61] offset:-4096 sc1
    s_waitcnt vmcnt(28)
    v_mfma_f32_16x16x32_bf16 v[194:197], v[48:51], a[116:119], v[194:197]
    v_fma_f32 v156, v124, v10, v11
    v_mfma_f32_16x16x32_bf16 v[182:185], v[52:55], a[112:115], v[182:185]
    ds_read_b128 v[48:51], v4 offset:14560
    v_fma_f32 v157, v125, v10, v11
    v_mfma_f32_16x16x32_bf16 v[198:201], v[52:55], a[116:119], v[198:201]
    s_waitcnt lgkmcnt(3)
    v_mfma_f32_16x16x32_bf16 v[186:189], v[56:59], a[112:115], v[186:189]
    ds_read_b128 v[52:55], v4 offset:15600
    v_fma_f32 v158, v126, v10, v11
    v_mfma_f32_16x16x32_bf16 v[202:205], v[56:59], a[116:119], v[202:205]
    global_load_dwordx4 a[72:75], v4, s[54:55] offset:-3072 sc1
    v_mfma_f32_16x16x32_bf16 v[190:193], v[60:63], a[112:115], v[190:193]
    v_fma_f32 v159, v127, v10, v11
    v_mfma_f32_16x16x32_bf16 v[206:209], v[60:63], a[116:119], v[206:209]
    s_waitcnt lgkmcnt(2)
    s_waitcnt vmcnt(28)
    v_mfma_f32_16x16x32_bf16 v[178:181], v[64:67], a[120:123], v[178:181]
    v_fma_f32 v160, v128, v10, v11
    s_waitcnt vmcnt(27)
    v_mfma_f32_16x16x32_bf16 v[194:197], v[64:67], a[124:127], v[194:197]
    v_mfma_f32_16x16x32_bf16 v[182:185], v[68:71], a[120:123], v[182:185]
    v_fma_f32 v161, v129, v10, v11
    global_load_dwordx4 a[76:79], v7, s[60:61] offset:-3072 sc1
    v_mfma_f32_16x16x32_bf16 v[198:201], v[68:71], a[124:127], v[198:201]
    s_waitcnt lgkmcnt(0)
    v_mfma_f32_16x16x32_bf16 v[186:189], v[48:51], a[120:123], v[186:189]
    v_mfma_f32_16x16x32_bf16 v[202:205], v[48:51], a[124:127], v[202:205]
    v_mfma_f32_16x16x32_bf16 v[190:193], v[52:55], a[120:123], v[190:193]
    v_mfma_f32_16x16x32_bf16 v[206:209], v[52:55], a[124:127], v[206:209]
    s_nop 7
    s_cmp_eq_u32 s101, 2
    s_cbranch_scc1 Lz_keep
    v_mov_b32 v194, 0
    v_mov_b32 v195, 0
    v_mov_b32 v196, 0
    v_mov_b32 v197, 0
    v_mov_b32 v198, 0
    v_mov_b32 v199, 0
    v_mov_b32 v200, 0
    v_mov_b32 v201, 0
    v_mov_b32 v202, 0
    v_mov_b32 v203, 0
    v_mov_b32 v204, 0
    v_mov_b32 v205, 0
    v_mov_b32 v206, 0
    v_mov_b32 v207, 0
    v_mov_b32 v208, 0
    v_mov_b32 v209, 0
    s_cmp_eq_u32 s101, 1
    s_cbranch_scc1 Lz_keep
    v_mov_b32 v178, 0
    v_mov_b32 v179, 0
    v_mov_b32 v180, 0
    v_mov_b32 v181, 0
    v_mov_b32 v182, 0
    v_mov_b32 v183, 0
    v_mov_b32 v184, 0
    v_mov_b32 v185, 0
    v_mov_b32 v186, 0
    v_mov_b32 v187, 0
    v_mov_b32 v188, 0
    v_mov_b32 v189, 0
    v_mov_b32 v190, 0
    v_mov_b32 v191, 0
    v_mov_b32 v192, 0
    v_mov_b32 v193, 0
Lz_keep:
    global_load_dwordx4 a[80:83], v4, s[54:55] offset:-2048 sc1
    v_pk_fma_f32 v[178:179], v[178:179], v[98:99], v[130:131] op_sel:[0,0,0] op_sel_hi:[1,1,1]
    v_pk_fma_f32 v[180:181], v[180:181], v[100:101], v[132:133] op_sel:[0,0,0] op_sel_hi:[1,1,1]
    v_pk_fma_f32 v[182:183], v[182:183], v[102:103], v[134:135] op_sel:[0,0,0] op_sel_hi:[1,1,1]
    v_pk_fma_f32 v[184:185], v[184:185], v[104:105], v[136:137] op_sel:[0,0,0] op_sel_hi:[1,1,1]
    global_load_dwordx4 a[84:87], v7, s[60:61] offset:-2048 sc1
    v_pk_fma_f32 v[186:187], v[186:187], v[106:107], v[138:139] op_sel:[0,0,0] op_sel_hi:[1,1,1]
    v_pk_fma_f32 v[188:189], v[188:189], v[108:109], v[140:141] op_sel:[0,0,0] op_sel_hi:[1,1,1]
    v_pk_fma_f32 v[190:191], v[190:191], v[110:111], v[142:143] op_sel:[0,0,0] op_sel_hi:[1,1,1]
    v_pk_fma_f32 v[192:193], v[192:193], v[112:113], v[144:145] op_sel:[0,0,0] op_sel_hi:[1,1,1]
    global_load_dwordx4 a[88:91], v4, s[54:55] offset:-1024 sc1
    v_pk_fma_f32 v[194:195], v[194:195], v[98:99], v[146:147] op_sel:[0,0,0] op_sel_hi:[1,1,1]
    v_pk_fma_f32 v[196:197], v[196:197], v[100:101], v[148:149] op_sel:[0,0,0] op_sel_hi:[1,1,1]
    v_pk_fma_f32 v[198:199], v[198:199], v[102:103], v[150:151] op_sel:[0,0,0] op_sel_hi:[1,1,1]
    v_pk_fma_f32 v[200:201], v[200:201], v[104:105], v[152:153] op_sel:[0,0,0] op_sel_hi:[1,1,1]
    v_pk_fma_f32 v[202:203], v[202:203], v[106:107], v[154:155] op_sel:[0,0,0] op_sel_hi:[1,1,1]
    global_load_dwordx4 a[92:95], v7, s[60:61] offset:-1024 sc1
    v_pk_fma_f32 v[204:205], v[204:205], v[108:109], v[156:157] op_sel:[0,0,0] op_sel_hi:[1,1,1]
    v_pk_fma_f32 v[206:207], v[206:207], v[110:111], v[158:159] op_sel:[0,0,0] op_sel_hi:[1,1,1]
    v_pk_fma_f32 v[208:209], v[208:209], v[112:113], v[160:161] op_sel:[0,0,0] op_sel_hi:[1,1,1]
    v_pk_mul_f32 v[130:131], v[178:179], v[178:179] op_sel:[0,0] op_sel_hi:[1,1]
    global_load_dwordx4 a[96:99], v4, s[54:55] offset:0 sc1
    v_pk_mul_f32 v[132:133], v[180:181], v[180:181] op_sel:[0,0] op_sel_hi:[1,1]
    v_pk_mul_f32 v[134:135], v[182:183], v[182:183] op_sel:[0,0] op_sel_hi:[1,1]
    v_pk_mul_f32 v[136:137], v[184:185], v[184:185] op_sel:[0,0] op_sel_hi:[1,1]
    v_pk_mul_f32 v[138:139], v[186:187], v[186:187] op_sel:[0,0] op_sel_hi:[1,1]
    global_load_dwordx4 a[100:103], v7, s[60:61] offset:0 sc1
    v_pk_mul_f32 v[140:141], v[188:189], v[188:189] op_sel:[0,0] op_sel_hi:[1,1]
    v_pk_mul_f32 v[142:143], v[190:191], v[190:191] op_sel:[0,0] op_sel_hi:[1,1]
    v_pk_mul_f32 v[144:145], v[192:193], v[192:193] op_sel:[0,0] op_sel_hi:[1,1]
    v_pk_mul_f32 v[146:147], v[194:195], v[194:195] op_sel:[0,0] op_sel_hi:[1,1]
    v_pk_mul_f32 v[148:149], v[196:197], v[196:197] op_sel:[0,0] op_sel_hi:[1,1]
    global_load_dwordx4 a[104:107], v4, s[54:55] offset:1024 sc1
    v_pk_mul_f32 v[150:151], v[198:199], v[198:199] op_sel:[0,0] op_sel_hi:[1,1]
    v_pk_mul_f32 v[152:153], v[200:201], v[200:201] op_sel:[0,0] op_sel_hi:[1,1]
    v_pk_mul_f32 v[154:155], v[202:203], v[202:203] op_sel:[0,0] op_sel_hi:[1,1]
    v_pk_mul_f32 v[156:157], v[204:205], v[204:205] op_sel:[0,0] op_sel_hi:[1,1]
    global_load_dwordx4 a[108:111], v7, s[60:61] offset:1024 sc1
    v_pk_mul_f32 v[158:159], v[206:207], v[206:207] op_sel:[0,0] op_sel_hi:[1,1]
    v_pk_mul_f32 v[160:161], v[208:209], v[208:209] op_sel:[0,0] op_sel_hi:[1,1]
    v_pk_fma_f32 v[130:131], v[130:131], s[84:85], s[84:85] op_sel:[0,1,0] op_sel_hi:[1,1,0]
    v_pk_fma_f32 v[132:133], v[132:133], s[84:85], s[84:85] op_sel:[0,1,0] op_sel_hi:[1,1,0]
    global_load_dwordx4 a[112:115], v4, s[54:55] offset:2048 sc1
    v_pk_fma_f32 v[134:135], v[134:135], s[84:85], s[84:85] op_sel:[0,1,0] op_sel_hi:[1,1,0]
    v_pk_fma_f32 v[136:137], v[136:137], s[84:85], s[84:85] op_sel:[0,1,0] op_sel_hi:[1,1,0]
    v_pk_fma_f32 v[138:139], v[138:139], s[84:85], s[84:85] op_sel:[0,1,0] op_sel_hi:[1,1,0]
    v_pk_fma_f32 v[140:141], v[140:141], s[84:85], s[84:85] op_sel:[0,1,0] op_sel_hi:[1,1,0]
    v_pk_fma_f32 v[142:143], v[142:143], s[84:85], s[84:85] op_sel:[0,1,0] op_sel_hi:[1,1,0]
    global_load_dwordx4 a[116:119], v7, s[60:61] offset:2048 sc1
    v_pk_fma_f32 v[144:145], v[144:145], s[84:85], s[84:85] op_sel:[0,1,0] op_sel_hi:[1,1,0]
    v_pk_fma_f32 v[146:147], v[146:147], s[84:85], s[84:85] op_sel:[0,1,0] op_sel_hi:[1,1,0]
    v_pk_fma_f32 v[148:149], v[148:149], s[84:85], s[84:85] op_sel:[0,1,0] op_sel_hi:[1,1,0]
    v_pk_fma_f32 v[150:151], v[150:151], s[84:85], s[84:85] op_sel:[0,1,0] op_sel_hi:[1,1,0]
    global_load_dwordx4 a[120:123], v4, s[54:55] offset:3072 sc1
    v_pk_fma_f32 v[152:153], v[152:153], s[84:85], s[84:85] op_sel:[0,1,0] op_sel_hi:[1,1,0]
    v_pk_fma_f32 v[154:155], v[154:155], s[84:85], s[84:85] op_sel:[0,1,0] op_sel_hi:[1,1,0]
    v_pk_fma_f32 v[156:157], v[156:157], s[84:85], s[84:85] op_sel:[0,1,0] op_sel_hi:[1,1,0]
    v_pk_fma_f32 v[158:159], v[158:159], s[84:85], s[84:85] op_sel:[0,1,0] op_sel_hi:[1,1,0]
    global_load_dwordx4 a[124:127], v7, s[60:61] offset:3072 sc1
    v_pk_fma_f32 v[160:161], v[160:161], s[84:85], s[84:85] op_sel:[0,1,0] op_sel_hi:[1,1,0]
    v_pk_mul_f32 v[130:131], v[130:131], v[178:179] op_sel:[0,0] op_sel_hi:[1,1]
    v_pk_mul_f32 v[132:133], v[132:133], v[180:181] op_sel:[0,0] op_sel_hi:[1,1]
    v_pk_mul_f32 v[134:135], v[134:135], v[182:183] op_sel:[0,0] op_sel_hi:[1,1]
    v_pk_mul_f32 v[136:137], v[136:137], v[184:185] op_sel:[0,0] op_sel_hi:[1,1]
    global_load_dwordx4 a[128:131], v4, s[56:57] offset:-4096 sc1
    v_pk_mul_f32 v[138:139], v[138:139], v[186:187] op_sel:[0,0] op_sel_hi:[1,1]
    v_pk_mul_f32 v[140:141], v[140:141], v[188:189] op_sel:[0,0] op_sel_hi:[1,1]
    v_pk_mul_f32 v[142:143], v[142:143], v[190:191] op_sel:[0,0] op_sel_hi:[1,1]
    v_pk_mul_f32 v[144:145], v[144:145], v[192:193] op_sel:[0,0] op_sel_hi:[1,1]
    global_load_dwordx4 a[132:135], v7, s[62:63] offset:-4096 sc1
    v_pk_mul_f32 v[146:147], v[146:147], v[194:195] op_sel:[0,0] op_sel_hi:[1,1]
    v_pk_mul_f32 v[148:149], v[148:149], v[196:197] op_sel:[0,0] op_sel_hi:[1,1]
    v_pk_mul_f32 v[150:151], v[150:151], v[198:199] op_sel:[0,0] op_sel_hi:[1,1]
    v_pk_mul_f32 v[152:153], v[152:153], v[200:201] op_sel:[0,0] op_sel_hi:[1,1]
    global_load_dwordx4 a[136:139], v4, s[56:57] offset:-3072 sc1
    v_pk_mul_f32 v[154:155], v[154:155], v[202:203] op_sel:[0,0] op_sel_hi:[1,1]
    v_pk_mul_f32 v[156:157], v[156:157], v[204:205] op_sel:[0,0] op_sel_hi:[1,1]
    v_pk_mul_f32 v[158:159], v[158:159], v[206:207] op_sel:[0,0] op_sel_hi:[1,1]
    v_pk_mul_f32 v[160:161], v[160:161], v[208:209] op_sel:[0,0] op_sel_hi:[1,1]
    v_exp_f32 v130, v130
    global_load_dwordx4 a[140:143], v7, s[62:63] offset:-3072 sc1
    v_exp_f32 v131, v131
    v_exp_f32 v132, v132
    v_exp_f32 v133, v133
    v_exp_f32 v134, v134
    global_load_dwordx4 a[144:147], v4, s[56:57] offset:-2048 sc1
    v_exp_f32 v135, v135
    v_exp_f32 v136, v136
    v_exp_f32 v137, v137
    v_exp_f32 v138, v138
    global_load_dwordx4 a[148:151], v7, s[62:63] offset:-2048 sc1
    v_exp_f32 v139, v139
    v_exp_f32 v140, v140
    v_exp_f32 v141, v141
    v_exp_f32 v142, v142
    v_exp_f32 v143, v143
    global_load_dwordx4 a[152:155], v4, s[56:57] offset:-1024 sc1
    v_exp_f32 v144, v144
    v_exp_f32 v145, v145
    v_exp_f32 v146, v146
    v_exp_f32 v147, v147
    global_load_dwordx4 a[156:159], v7, s[62:63] offset:-1024 sc1
    v_exp_f32 v148, v148
    v_exp_f32 v149, v149
    v_exp_f32 v150, v150
    v_exp_f32 v151, v151
    ds_read_b128 a[224:227], v82 offset:0
    v_exp_f32 v152, v152
    v_exp_f32 v153, v153
    v_exp_f32 v154, v154
    v_exp_f32 v155, v155
    v_exp_f32 v156, v156
    ds_read_b128 a[228:231], v84 offset:0
    v_exp_f32 v157, v157
    v_exp_f32 v158, v158
    v_exp_f32 v159, v159
    v_exp_f32 v160, v160
    ds_read_b128 a[232:235], v86 offset:0
    v_exp_f32 v161, v161
    v_pk_add_f32 v[130:131], v[130:131], 1.0 op_sel:[0,0] op_sel_hi:[1,0]
    v_pk_add_f32 v[132:133], v[132:133], 1.0 op_sel:[0,0] op_sel_hi:[1,0]
    v_pk_add_f32 v[134:135], v[134:135], 1.0 op_sel:[0,0] op_sel_hi:[1,0]
    ds_read_b128 a[236:239], v88 offset:0
    v_pk_add_f32 v[136:137], v[136:137], 1.0 op_sel:[0,0] op_sel_hi:[1,0]
    v_pk_add_f32 v[138:139], v[138:139], 1.0 op_sel:[0,0] op_sel_hi:[1,0]
    v_pk_add_f32 v[140:141], v[140:141], 1.0 op_sel:[0,0] op_sel_hi:[1,0]
    v_pk_add_f32 v[142:143], v[142:143], 1.0 op_sel:[0,0] op_sel_hi:[1,0]
    v_pk_add_f32 v[144:145], v[144:145], 1.0 op_sel:[0,0] op_sel_hi:[1,0]
    ds_read_b128 a[240:243], v83 offset:0
    v_pk_add_f32 v[146:147], v[146:147], 1.0 op_sel:[0,0] op_sel_hi:[1,0]
    v_pk_add_f32 v[148:149], v[148:149], 1.0 op_sel:[0,0] op_sel_hi:[1,0]
    v_pk_add_f32 v[150:151], v[150:151], 1.0 op_sel:[0,0] op_sel_hi:[1,0]
    v_pk_add_f32 v[152:153], v[152:153], 1.0 op_sel:[0,0] op_sel_hi:[1,0]
    ds_read_b128 a[244:247], v85 offset:0
    v_pk_add_f32 v[154:155], v[154:155], 1.0 op_sel:[0,0] op_sel_hi:[1,0]
    v_pk_add_f32 v[156:157], v[156:157], 1.0 op_sel:[0,0] op_sel_hi:[1,0]
    v_pk_add_f32 v[158:159], v[158:159], 1.0 op_sel:[0,0] op_sel_hi:[1,0]
    v_pk_add_f32 v[160:161], v[160:161], 1.0 op_sel:[0,0] op_sel_hi:[1,0]
    v_rcp_f32 v130, v130
    ds_read_b128 a[248:251], v87 offset:0
    v_rcp_f32 v131, v131
    v_rcp_f32 v132, v132
    v_rcp_f32 v133, v133
    v_rcp_f32 v134, v134
    ds_read_b128 a[252:255], v89 offset:0
    v_rcp_f32 v135, v135
    v_rcp_f32 v136, v136
    v_rcp_f32 v137, v137
    v_rcp_f32 v138, v138
    s_waitcnt lgkmcnt(0)
    s_add_u32 m0, s89, 0
    s_nop 0
    global_load_lds_dwordx4 v74, s[72:73] offset:0
    v_rcp_f32 v139, v139
    v_rcp_f32 v140, v140
    v_rcp_f32 v141, v141
    v_rcp_f32 v142, v142
    v_rcp_f32 v143, v143
    global_load_lds_dwordx4 v75, s[72:73] offset:1024
    v_rcp_f32 v144, v144
    v_rcp_f32 v145, v145
    v_rcp_f32 v146, v146
    v_rcp_f32 v147, v147
    global_load_lds_dwordx4 v76, s[72:73] offset:2048
    v_rcp_f32 v148, v148
    v_rcp_f32 v149, v149
    v_rcp_f32 v150, v150
    v_rcp_f32 v151, v151
    global_load_lds_dwordx4 v77, s[72:73] offset:3072
    v_rcp_f32 v152, v152
    v_rcp_f32 v153, v153
    v_rcp_f32 v154, v154
    v_rcp_f32 v155, v155
    v_rcp_f32 v156, v156
    s_add_u32 m0, s89, 4096
    s_nop 0
    global_load_lds_dwordx4 v78, s[72:73] offset:0
    v_rcp_f32 v157, v157
    v_rcp_f32 v158, v158
    v_rcp_f32 v159, v159
    v_rcp_f32 v160, v160
    global_load_lds_dwordx4 v79, s[72:73] offset:1024
    v_rcp_f32 v161, v161
    v_pk_mul_f32 v[178:179], v[178:179], v[130:131] op_sel:[0,0] op_sel_hi:[1,1]
    v_pk_mul_f32 v[180:181], v[180:181], v[132:133] op_sel:[0,0] op_sel_hi:[1,1]
    v_pk_mul_f32 v[182:183], v[182:183], v[134:135] op_sel:[0,0] op_sel_hi:[1,1]
    global_load_lds_dwordx4 v80, s[72:73] offset:2048
    v_pk_mul_f32 v[184:185], v[184:185], v[136:137] op_sel:[0,0] op_sel_hi:[1,1]
    v_pk_mul_f32 v[186:187], v[186:187], v[138:139] op_sel:[0,0] op_sel_hi:[1,1]
    v_pk_mul_f32 v[188:189], v[188:189], v[140:141] op_sel:[0,0] op_sel_hi:[1,1]
    v_pk_mul_f32 v[190:191], v[190:191], v[142:143] op_sel:[0,0] op_sel_hi:[1,1]
    v_pk_mul_f32 v[192:193], v[192:193], v[144:145] op_sel:[0,0] op_sel_hi:[1,1]
    global_load_lds_dwordx4 v81, s[72:73] offset:3072
    v_pk_mul_f32 v[194:195], v[194:195], v[146:147] op_sel:[0,0] op_sel_hi:[1,1]
    v_pk_mul_f32 v[196:197], v[196:197], v[148:149] op_sel:[0,0] op_sel_hi:[1,1]
    v_pk_mul_f32 v[198:199], v[198:199], v[150:151] op_sel:[0,0] op_sel_hi:[1,1]
    v_pk_mul_f32 v[200:201], v[200:201], v[152:153] op_sel:[0,0] op_sel_hi:[1,1]
    s_waitcnt vmcnt(48)
    ds_read_b128 a[192:195], v82 offset:8192
    v_pk_mul_f32 v[202:203], v[202:203], v[154:155] op_sel:[0,0] op_sel_hi:[1,1]
    v_pk_mul_f32 v[204:205], v[204:205], v[156:157] op_sel:[0,0] op_sel_hi:[1,1]
    v_pk_mul_f32 v[206:207], v[206:207], v[158:159] op_sel:[0,0] op_sel_hi:[1,1]
    v_pk_mul_f32 v[208:209], v[208:209], v[160:161] op_sel:[0,0] op_sel_hi:[1,1]
    ds_read_b128 a[196:199], v84 offset:8192
    v_pk_add_f32 v[130:131], v[178:179], v[194:195] op_sel:[0,0] op_sel_hi:[1,1]
    v_pk_mul_f32 v[146:147], v[178:179], v[178:179] op_sel:[0,0] op_sel_hi:[1,1]
    v_pk_add_f32 v[132:133], v[180:181], v[196:197] op_sel:[0,0] op_sel_hi:[1,1]
    v_pk_mul_f32 v[148:149], v[180:181], v[180:181] op_sel:[0,0] op_sel_hi:[1,1]
    v_pk_add_f32 v[134:135], v[182:183], v[198:199] op_sel:[0,0] op_sel_hi:[1,1]
    ds_read_b128 a[200:203], v86 offset:8192
    v_pk_mul_f32 v[150:151], v[182:183], v[182:183] op_sel:[0,0] op_sel_hi:[1,1]
    v_pk_add_f32 v[136:137], v[184:185], v[200:201] op_sel:[0,0] op_sel_hi:[1,1]
    v_pk_mul_f32 v[152:153], v[184:185], v[184:185] op_sel:[0,0] op_sel_hi:[1,1]
    v_pk_add_f32 v[138:139], v[186:187], v[202:203] op_sel:[0,0] op_sel_hi:[1,1]
    ds_read_b128 a[204:207], v88 offset:8192
    v_pk_mul_f32 v[154:155], v[186:187], v[186:187] op_sel:[0,0] op_sel_hi:[1,1]
    v_pk_add_f32 v[140:141], v[188:189], v[204:205] op_sel:[0,0] op_sel_hi:[1,1]
    v_pk_mul_f32 v[156:157], v[188:189], v[188:189] op_sel:[0,0] op_sel_hi:[1,1]
    v_pk_add_f32 v[142:143], v[190:191], v[206:207] op_sel:[0,0] op_sel_hi:[1,1]
    ds_read_b128 a[208:211], v83 offset:8192
    v_pk_mul_f32 v[158:159], v[190:191], v[190:191] op_sel:[0,0] op_sel_hi:[1,1]
    v_pk_add_f32 v[144:145], v[192:193], v[208:209] op_sel:[0,0] op_sel_hi:[1,1]
    v_pk_mul_f32 v[160:161], v[192:193], v[192:193] op_sel:[0,0] op_sel_hi:[1,1]
    v_pk_fma_f32 v[146:147], v[194:195], v[194:195], v[146:147] op_sel:[0,0,0] op_sel_hi:[1,1,1]
    v_pk_fma_f32 v[148:149], v[196:197], v[196:197], v[148:149] op_sel:[0,0,0] op_sel_hi:[1,1,1]
    ds_read_b128 a[212:215], v85 offset:8192
    v_pk_fma_f32 v[150:151], v[198:199], v[198:199], v[150:151] op_sel:[0,0,0] op_sel_hi:[1,1,1]
    v_pk_fma_f32 v[152:153], v[200:201], v[200:201], v[152:153] op_sel:[0,0,0] op_sel_hi:[1,1,1]
    v_pk_fma_f32 v[154:155], v[202:203], v[202:203], v[154:155] op_sel:[0,0,0] op_sel_hi:[1,1,1]
    v_pk_fma_f32 v[156:157], v[204:205], v[204:205], v[156:157] op_sel:[0,0,0] op_sel_hi:[1,1,1]
    ds_read_b128 a[216:219], v87 offset:8192
    v_pk_fma_f32 v[158:159], v[206:207], v[206:207], v[158:159] op_sel:[0,0,0] op_sel_hi:[1,1,1]
    v_pk_fma_f32 v[160:161], v[208:209], v[208:209], v[160:161] op_sel:[0,0,0] op_sel_hi:[1,1,1]
    v_add_f32_dpp v98, v130, v130 row_ror:8 row_mask:0xf bank_mask:0x3
    v_add_f32_dpp v99, v131, v131 row_ror:8 row_mask:0xf bank_mask:0x3
    ds_read_b128 a[220:223], v89 offset:8192
    v_add_f32_dpp v100, v132, v132 row_ror:8 row_mask:0xf bank_mask:0x3
    v_add_f32_dpp v101, v133, v133 row_ror:8 row_mask:0xf bank_mask:0x3
    v_add_f32_dpp v102, v134, v134 row_ror:8 row_mask:0xf bank_mask:0x3
    v_add_f32_dpp v103, v135, v135 row_ror:8 row_mask:0xf bank_mask:0x3
    v_add_f32_dpp v104, v136, v136 row_ror:8 row_mask:0xf bank_mask:0x3
    s_waitcnt lgkmcnt(0)
    s_add_u32 m0, s89, 8192
    s_nop 0
    global_load_lds_dwordx4 v74, s[74:75] offset:0
    v_add_f32_dpp v105, v137, v137 row_ror:8 row_mask:0xf bank_mask:0x3
    v_add_f32_dpp v106, v138, v138 row_ror:8 row_mask:0xf bank_mask:0x3
    v_add_f32_dpp v107, v139, v139 row_ror:8 row_mask:0xf bank_mask:0x3
    v_add_f32_dpp v108, v140, v140 row_ror:8 row_mask:0xf bank_mask:0x3
    global_load_lds_dwordx4 v75, s[74:75] offset:1024
    v_add_f32_dpp v109, v141, v141 row_ror:8 row_mask:0xf bank_mask:0x3
    v_add_f32_dpp v110, v142, v142 row_ror:8 row_mask:0xf bank_mask:0x3
    v_add_f32_dpp v111, v143, v143 row_ror:8 row_mask:0xf bank_mask:0x3
    v_add_f32_dpp v112, v144, v144 row_ror:8 row_mask:0xf bank_mask:0x3
    global_load_lds_dwordx4 v76, s[74:75] offset:2048
    v_add_f32_dpp v113, v145, v145 row_ror:8 row_mask:0xf bank_mask:0x3
    v_add_f32_dpp v98, v146, v146 row_ror:8 row_mask:0xf bank_mask:0xc
    v_add_f32_dpp v99, v147, v147 row_ror:8 row_mask:0xf bank_mask:0xc
    v_add_f32_dpp v100, v148, v148 row_ror:8 row_mask:0xf bank_mask:0xc
    v_add_f32_dpp v101, v149, v149 row_ror:8 row_mask:0xf bank_mask:0xc
    global_load_lds_dwordx4 v77, s[74:75] offset:3072
    v_add_f32_dpp v102, v150, v150 row_ror:8 row_mask:0xf bank_mask:0xc
    v_add_f32_dpp v103, v151, v151 row_ror:8 row_mask:0xf bank_mask:0xc
    v_add_f32_dpp v104, v152, v152 row_ror:8 row_mask:0xf bank_mask:0xc
    v_add_f32_dpp v105, v153, v153 row_ror:8 row_mask:0xf bank_mask:0xc
    s_add_u32 m0, s89, 12288
    s_nop 0
    global_load_lds_dwordx4 v78, s[74:75] offset:0
    v_add_f32_dpp v106, v154, v154 row_ror:8 row_mask:0xf bank_mask:0xc
    v_add_f32_dpp v107, v155, v155 row_ror:8 row_mask:0xf bank_mask:0xc
    v_add_f32_dpp v108, v156, v156 row_ror:8 row_mask:0xf bank_mask:0xc
    v_add_f32_dpp v109, v157, v157 row_ror:8 row_mask:0xf bank_mask:0xc
    global_load_lds_dwordx4 v79, s[74:75] offset:1024
    v_add_f32_dpp v110, v158, v158 row_ror:8 row_mask:0xf bank_mask:0xc
    v_add_f32_dpp v111, v159, v159 row_ror:8 row_mask:0xf bank_mask:0xc
    v_add_f32_dpp v112, v160, v160 row_ror:8 row_mask:0xf bank_mask:0xc
    v_add_f32_dpp v113, v161, v161 row_ror:8 row_mask:0xf bank_mask:0xc
    v_add_f32_dpp v130, v98, v98 row_half_mirror row_mask:0xf bank_mask:0x5
    global_load_lds_dwordx4 v80, s[74:75] offset:2048
    v_add_f32_dpp v131, v99, v99 row_half_mirror row_mask:0xf bank_mask:0x5
    v_add_f32_dpp v132, v100, v100 row_half_mirror row_mask:0xf bank_mask:0x5
    v_add_f32_dpp v133, v101, v101 row_half_mirror row_mask:0xf bank_mask:0x5
    v_add_f32_dpp v134, v102, v102 row_half_mirror row_mask:0xf bank_mask:0x5
    global_load_lds_dwordx4 v81, s[74:75] offset:3072
    v_add_f32_dpp v135, v103, v103 row_half_mirror row_mask:0xf bank_mask:0x5
    v_add_f32_dpp v136, v104, v104 row_half_mirror row_mask:0xf bank_mask:0x5
    v_add_f32_dpp v137, v105, v105 row_half_mirror row_mask:0xf bank_mask:0x5
    v_add_f32_dpp v130, v106, v106 row_half_mirror row_mask:0xf bank_mask:0xa
    v_add_f32_dpp v131, v107, v107 row_half_mirror row_mask:0xf bank_mask:0xa
    v_add_f32_dpp v132, v108, v108 row_half_mirror row_mask:0xf bank_mask:0xa
    v_add_f32_dpp v133, v109, v109 row_half_mirror row_mask:0xf bank_mask:0xa
    v_add_f32_dpp v134, v110, v110 row_half_mirror row_mask:0xf bank_mask:0xa
    v_add_f32_dpp v135, v111, v111 row_half_mirror row_mask:0xf bank_mask:0xa
    v_add_f32_dpp v136, v112, v112 row_half_mirror row_mask:0xf bank_mask:0xa
    v_add_f32_dpp v137, v113, v113 row_half_mirror row_mask:0xf bank_mask:0xa
    v_add_f32_dpp v130, v130, v130 quad_perm:[1,0,3,2] row_mask:0xf bank_mask:0xf
    v_add_f32_dpp v131, v131, v131 quad_perm:[1,0,3,2] row_mask:0xf bank_mask:0xf
    v_add_f32_dpp v132, v132, v132 quad_perm:[1,0,3,2] row_mask:0xf bank_mask:0xf
    v_add_f32_dpp v133, v133, v133 quad_perm:[1,0,3,2] row_mask:0xf bank_mask:0xf
    v_add_f32_dpp v134, v134, v134 quad_perm:[1,0,3,2] row_mask:0xf bank_mask:0xf
    v_add_f32_dpp v135, v135, v135 quad_perm:[1,0,3,2] row_mask:0xf bank_mask:0xf
    v_add_f32_dpp v136, v136, v136 quad_perm:[1,0,3,2] row_mask:0xf bank_mask:0xf
    v_add_f32_dpp v137, v137, v137 quad_perm:[1,0,3,2] row_mask:0xf bank_mask:0xf
    v_add_f32_dpp v130, v130, v130 quad_perm:[2,3,0,1] row_mask:0xf bank_mask:0xf
    v_add_f32_dpp v131, v131, v131 quad_perm:[2,3,0,1] row_mask:0xf bank_mask:0xf
    v_add_f32_dpp v132, v132, v132 quad_perm:[2,3,0,1] row_mask:0xf bank_mask:0xf
    v_add_f32_dpp v133, v133, v133 quad_perm:[2,3,0,1] row_mask:0xf bank_mask:0xf
    v_add_f32_dpp v134, v134, v134 quad_perm:[2,3,0,1] row_mask:0xf bank_mask:0xf
    v_add_f32_dpp v135, v135, v135 quad_perm:[2,3,0,1] row_mask:0xf bank_mask:0xf
    v_add_f32_dpp v136, v136, v136 quad_perm:[2,3,0,1] row_mask:0xf bank_mask:0xf
    v_add_f32_dpp v137, v137, v137 quad_perm:[2,3,0,1] row_mask:0xf bank_mask:0xf
    v_lshrrev_b32 v28, 2, v2
    v_lshl_add_u32 v28, v28, 7, v171
    ds_write_b128 v28, v[130:133]
    ds_write_b128 v28, v[134:137] offset:16
    s_waitcnt lgkmcnt(0)
    s_barrier
    v_lshlrev_b32 v28, 2, v1
    v_add_u32 v28, 150784, v28
    ds_read2st64_b32 v[90:91], v28 offset0:0 offset1:1
    ds_read2st64_b32 v[92:93], v28 offset0:2 offset1:3
    ds_read2st64_b32 v[94:95], v28 offset0:4 offset1:5
    ds_read2st64_b32 v[96:97], v28 offset0:6 offset1:7
    s_lshl_b32 s4, s40, 12
    s_add_u32 s4, s4, 12451840
    v_add_u32 v174, s4, v30
    s_lshl_b32 s4, s41, 9
    v_add_u32 v28, s4, v174
    v_subrev_u32 v170, 2048, v170
    v_subrev_u32 v171, 2048, v171
    s_waitcnt lgkmcnt(2)
    v_pk_add_f32 v[90:91], v[90:91], v[92:93] op_sel:[0,0] op_sel_hi:[1,1]
    s_waitcnt lgkmcnt(0)
    v_pk_add_f32 v[94:95], v[94:95], v[96:97] op_sel:[0,0] op_sel_hi:[1,1]
    v_pk_add_f32 v[90:91], v[90:91], v[94:95] op_sel:[0,0] op_sel_hi:[1,1]
    v_min_u32 v90, -2, v90
    v_min_u32 v91, -2, v91
    s_lshl_b32 s4, s3, 4
    s_lshl_b64 exec, 0xffff, s4
    global_store_dwordx2 v28, v[90:91], s[38:39] sc1
    s_mov_b64 exec, -1
    ds_read_b128 v[48:51], v4 offset:0
    ds_read_b128 v[52:55], v4 offset:1040
    ds_read_b128 v[56:59], v4 offset:2080
    ds_read_b128 v[60:63], v4 offset:3120
    ds_read_b128 v[64:67], v4 offset:4160
    s_waitcnt lgkmcnt(3)
    s_waitcnt vmcnt(56)
    v_mfma_f32_16x16x32_bf16 v[210:213], a[0:3], v[48:51], 0
    ds_read_b128 v[68:71], v4 offset:5200
    s_waitcnt vmcnt(55)
    v_mfma_f32_16x16x32_bf16 v[226:229], a[4:7], v[48:51], 0
    v_mfma_f32_16x16x32_bf16 v[214:217], a[0:3], v[52:55], 0
    ds_read_b128 v[48:51], v4 offset:6240
    s_waitcnt vmcnt(9)
    ds_read_b128 a[160:163], v82 offset:0
    v_mfma_f32_16x16x32_bf16 v[230:233], a[4:7], v[52:55], 0
    v_min_u32 v175, 26, v1
    s_waitcnt lgkmcnt(4)
    v_mfma_f32_16x16x32_bf16 v[218:221], a[0:3], v[56:59], 0
    ds_read_b128 v[52:55], v4 offset:7280
    v_lshlrev_b32 v175, 7, v175
    v_mfma_f32_16x16x32_bf16 v[234:237], a[4:7], v[56:59], 0
    ds_read_b128 a[164:167], v84 offset:0
    v_mfma_f32_16x16x32_bf16 v[222:225], a[0:3], v[60:63], 0
    ds_read_b128 v[56:59], v4 offset:8320
    v_add_u32 v175, 98304, v175
    v_mfma_f32_16x16x32_bf16 v[238:241], a[4:7], v[60:63], 0
    ds_read_b128 a[168:171], v86 offset:0
    s_waitcnt lgkmcnt(6)
    v_mfma_f32_16x16x32_bf16 v[210:213], a[8:11], v[64:67], v[210:213]
    ds_read_b128 v[60:63], v4 offset:9360
    ds_read_b128 a[172:175], v88 offset:0
    v_mfma_f32_16x16x32_bf16 v[226:229], a[12:15], v[64:67], v[226:229]
    global_load_dword v250, v175, s[38:39] sc1
    v_mfma_f32_16x16x32_bf16 v[214:217], a[8:11], v[68:71], v[214:217]
    ds_read_b128 v[64:67], v4 offset:10400
    ds_read_b128 a[176:179], v83 offset:0
    s_mul_i32 s7, s41, 320
    v_mfma_f32_16x16x32_bf16 v[230:233], a[12:15], v[68:71], v[230:233]
    ds_read_b128 a[180:183], v85 offset:0
    s_waitcnt lgkmcnt(8)
    v_mfma_f32_16x16x32_bf16 v[218:221], a[8:11], v[48:51], v[218:221]
    ds_read_b128 v[68:71], v4 offset:11440
    s_add_u32 s7, s7, 12800
    v_mfma_f32_16x16x32_bf16 v[234:237], a[12:15], v[48:51], v[234:237]
    ds_read_b128 a[184:187], v87 offset:0
    v_mfma_f32_16x16x32_bf16 v[222:225], a[8:11], v[52:55], v[222:225]
    ds_read_b128 v[48:51], v4 offset:12480
    v_min_u32 v175, 304, v4
    v_mfma_f32_16x16x32_bf16 v[238:241], a[12:15], v[52:55], v[238:241]
    ds_read_b128 a[188:191], v89 offset:0
    s_waitcnt lgkmcnt(8)
    v_mfma_f32_16x16x32_bf16 v[210:213], a[16:19], v[56:59], v[210:213]
    ds_read_b128 v[52:55], v4 offset:13520
    s_waitcnt lgkmcnt(1)
    s_add_u32 m0, s89, 0
    v_mfma_f32_16x16x32_bf16 v[226:229], a[20:23], v[56:59], v[226:229]
    v_add_u32 v175, s7, v175
    v_mfma_f32_16x16x32_bf16 v[214:217], a[16:19], v[60:63], v[214:217]
    ds_read_b128 v[56:59], v4 offset:14560
    global_load_dwordx4 v[242:245], v175, s[38:39] sc1
    v_mfma_f32_16x16x32_bf16 v[230:233], a[20:23], v[60:63], v[230:233]
    global_load_lds_dwordx4 v74, s[76:77] offset:0
    v_mfma_f32_16x16x32_bf16 v[218:221], a[16:19], v[64:67], v[218:221]
    ds_read_b128 v[60:63], v4 offset:15600
    v_add_u32 v175, 15360, v175
    v_mfma_f32_16x16x32_bf16 v[234:237], a[20:23], v[64:67], v[234:237]
    global_load_lds_dwordx4 v75, s[76:77] offset:1024
    v_mfma_f32_16x16x32_bf16 v[222:225], a[16:19], v[68:71], v[222:225]
    ds_read_b128 v[64:67], v4 offset:16640
    global_load_lds_dwordx4 v76, s[76:77] offset:2048
    v_mfma_f32_16x16x32_bf16 v[238:241], a[20:23], v[68:71], v[238:241]
    global_load_dwordx4 v[246:249], v175, s[38:39] sc1
    s_waitcnt lgkmcnt(3)
    v_mfma_f32_16x16x32_bf16 v[210:213], a[24:27], v[48:51], v[210:213]
    ds_read_b128 v[68:71], v4 offset:17680
    global_load_lds_dwordx4 v77, s[76:77] offset:3072
    v_mfma_f32_16x16x32_bf16 v[226:229], a[28:31], v[48:51], v[226:229]
    ds_read_b128 v[36:39], v46 offset:0
    v_mfma_f32_16x16x32_bf16 v[214:217], a[24:27], v[52:55], v[214:217]
    ds_read_b128 v[48:51], v4 offset:18720
    s_add_u32 m0, s89, 4096
    ds_read_b128 v[40:43], v46 offset:4160
    v_mfma_f32_16x16x32_bf16 v[230:233], a[28:31], v[52:55], v[230:233]
    global_load_lds_dwordx4 v78, s[76:77] offset:0
    s_waitcnt lgkmcnt(5)
    v_mfma_f32_16x16x32_bf16 v[218:221], a[24:27], v[56:59], v[218:221]
    ds_read_b128 v[52:55], v4 offset:19760
    ds_read_b64 v[44:45], v47 offset:8320
    v_mfma_f32_16x16x32_bf16 v[234:237], a[28:31], v[56:59], v[234:237]
    global_load_lds_dwordx4 v79, s[76:77] offset:1024
    v_mfma_f32_16x16x32_bf16 v[222:225], a[24:27], v[60:63], v[222:225]
    ds_read_b128 v[56:59], v4 offset:20800
    global_load_lds_dwordx4 v80, s[76:77] offset:2048
    v_mfma_f32_16x16x32_bf16 v[238:241], a[28:31], v[60:63], v[238:241]
    s_waitcnt vmcnt(8)
    v_max3_u32 v28, v242, v243, v244
    s_waitcnt lgkmcnt(6)
    v_mfma_f32_16x16x32_bf16 v[210:213], a[32:35], v[64:67], v[210:213]
    ds_read_b128 v[60:63], v4 offset:21840
    global_load_lds_dwordx4 v81, s[76:77] offset:3072
    v_mfma_f32_16x16x32_bf16 v[226:229], a[36:39], v[64:67], v[226:229]
    s_waitcnt vmcnt(5)
    v_max3_u32 v28, v245, v246, v28
    v_mfma_f32_16x16x32_bf16 v[214:217], a[32:35], v[68:71], v[214:217]
    ds_read_b128 v[64:67], v4 offset:22880
    ds_read_b128 a[0:3], v82 offset:8192
    v_mfma_f32_16x16x32_bf16 v[230:233], a[36:39], v[68:71], v[230:233]
    v_max3_u32 v28, v247, v248, v28
    s_waitcnt lgkmcnt(5)
    v_mfma_f32_16x16x32_bf16 v[218:221], a[32:35], v[48:51], v[218:221]
    ds_read_b128 v[68:71], v4 offset:23920
    v_max3_u32 v28, v249, v250, v28
    v_mfma_f32_16x16x32_bf16 v[234:237], a[36:39], v[48:51], v[234:237]
    ds_read_b128 a[4:7], v84 offset:8192
    v_mfma_f32_16x16x32_bf16 v[222:225], a[32:35], v[52:55], v[222:225]
    ds_read_b128 v[48:51], v4 offset:24960
    ds_read_b128 a[8:11], v86 offset:8192
    v_mfma_f32_16x16x32_bf16 v[238:241], a[36:39], v[52:55], v[238:241]
    v_cmp_eq_u32 vcc, -1, v28
    s_waitcnt lgkmcnt(6)
    v_mfma_f32_16x16x32_bf16 v[210:213], a[40:43], v[56:59], v[210:213]
    ds_read_b128 v[52:55], v4 offset:26000
    ds_read_b128 a[12:15], v88 offset:8192
    v_mfma_f32_16x16x32_bf16 v[226:229], a[44:47], v[56:59], v[226:229]
    s_cbranch_vccnz Lgb_r
Lgb_ok:
    v_mfma_f32_16x16x32_bf16 v[214:217], a[40:43], v[60:63], v[214:217]
    ds_read_b128 v[56:59], v4 offset:27040
    ds_read_b128 a[16:19], v83 offset:8192
    v_mfma_f32_16x16x32_bf16 v[230:233], a[44:47], v[60:63], v[230:233]
    ds_read_b128 a[20:23], v85 offset:8192
    v_add_f32 v242, v242, v246
    s_waitcnt lgkmcnt(8)
    v_mfma_f32_16x16x32_bf16 v[218:221], a[40:43], v[64:67], v[218:221]
    ds_read_b128 v[60:63], v4 offset:28080
    v_mfma_f32_16x16x32_bf16 v[234:237], a[44:47], v[64:67], v[234:237]
    ds_read_b128 a[24:27], v87 offset:8192
    v_add_f32 v243, v243, v247
    v_mfma_f32_16x16x32_bf16 v[222:225], a[40:43], v[68:71], v[222:225]
    ds_read_b128 v[64:67], v4 offset:29120
    ds_read_b128 a[28:31], v89 offset:8192
    v_mfma_f32_16x16x32_bf16 v[238:241], a[44:47], v[68:71], v[238:241]
    v_add_f32 v244, v244, v248
    s_waitcnt lgkmcnt(8)
    v_mfma_f32_16x16x32_bf16 v[210:213], a[48:51], v[48:51], v[210:213]
    ds_read_b128 v[68:71], v4 offset:30160
    s_waitcnt lgkmcnt(1)
    s_add_u32 m0, s89, 8192
    v_mfma_f32_16x16x32_bf16 v[226:229], a[52:55], v[48:51], v[226:229]
    v_add_f32 v245, v245, v249
    v_mfma_f32_16x16x32_bf16 v[214:217], a[48:51], v[52:55], v[214:217]
    ds_read_b128 v[48:51], v4 offset:31200
    v_mfma_f32_16x16x32_bf16 v[230:233], a[52:55], v[52:55], v[230:233]
    global_load_lds_dwordx4 v74, s[78:79] offset:0
    v_cvt_pk_bf16_f32 v242, v242, v242
    v_mfma_f32_16x16x32_bf16 v[218:221], a[48:51], v[56:59], v[218:221]
    ds_read_b128 v[52:55], v4 offset:32240
    v_mfma_f32_16x16x32_bf16 v[234:237], a[52:55], v[56:59], v[234:237]
    global_load_lds_dwordx4 v75, s[78:79] offset:1024
    v_lshlrev_b32 v242, 16, v242
    v_mfma_f32_16x16x32_bf16 v[222:225], a[48:51], v[60:63], v[222:225]
    ds_read_b128 v[56:59], v4 offset:33280
    global_load_lds_dwordx4 v76, s[78:79] offset:2048
    v_mfma_f32_16x16x32_bf16 v[238:241], a[52:55], v[60:63], v[238:241]
    v_cvt_pk_bf16_f32 v243, v243, v243
    s_waitcnt lgkmcnt(3)
    v_mfma_f32_16x16x32_bf16 v[210:213], a[56:59], v[64:67], v[210:213]
    ds_read_b128 v[60:63], v4 offset:34320
    global_load_lds_dwordx4 v77, s[78:79] offset:3072
    v_mfma_f32_16x16x32_bf16 v[226:229], a[60:63], v[64:67], v[226:229]
    v_lshlrev_b32 v243, 16, v243
    v_mfma_f32_16x16x32_bf16 v[214:217], a[56:59], v[68:71], v[214:217]
    ds_read_b128 v[64:67], v4 offset:35360
    s_add_u32 m0, s89, 12288
    v_mfma_f32_16x16x32_bf16 v[230:233], a[60:63], v[68:71], v[230:233]
    global_load_lds_dwordx4 v78, s[78:79] offset:0
    v_cvt_pk_bf16_f32 v244, v244, v244
    s_waitcnt lgkmcnt(3)
    v_mfma_f32_16x16x32_bf16 v[218:221], a[56:59], v[48:51], v[218:221]
    ds_read_b128 v[68:71], v4 offset:36400
    v_mfma_f32_16x16x32_bf16 v[234:237], a[60:63], v[48:51], v[234:237]
    global_load_lds_dwordx4 v79, s[78:79] offset:1024
    v_lshlrev_b32 v244, 16, v244
    v_mfma_f32_16x16x32_bf16 v[222:225], a[56:59], v[52:55], v[222:225]
    ds_read_b128 v[48:51], v4 offset:37440
    global_load_lds_dwordx4 v80, s[78:79] offset:2048
    v_mfma_f32_16x16x32_bf16 v[238:241], a[60:63], v[52:55], v[238:241]
    v_cvt_pk_bf16_f32 v245, v245, v245
    s_waitcnt lgkmcnt(3)
    v_mfma_f32_16x16x32_bf16 v[210:213], a[64:67], v[56:59], v[210:213]
    ds_read_b128 v[52:55], v4 offset:38480
    global_load_lds_dwordx4 v81, s[78:79] offset:3072
    v_mfma_f32_16x16x32_bf16 v[226:229], a[68:71], v[56:59], v[226:229]
    v_lshlrev_b32 v245, 16, v245
    v_mfma_f32_16x16x32_bf16 v[214:217], a[64:67], v[60:63], v[214:217]
    ds_read_b128 v[56:59], v4 offset:39520
    s_waitcnt vmcnt(8)
    ds_read_b128 a[32:35], v82 offset:0
    v_mfma_f32_16x16x32_bf16 v[230:233], a[68:71], v[60:63], v[230:233]
    v_min_u32 v175, 304, v4
    s_waitcnt lgkmcnt(4)
    v_mfma_f32_16x16x32_bf16 v[218:221], a[64:67], v[64:67], v[218:221]
    ds_read_b128 v[60:63], v4 offset:40560
    v_mfma_f32_16x16x32_bf16 v[234:237], a[68:71], v[64:67], v[234:237]
    ds_read_b128 a[36:39], v84 offset:0
    v_add_u32 v175, 162816, v175
    v_mfma_f32_16x16x32_bf16 v[222:225], a[64:67], v[68:71], v[222:225]
    ds_read_b128 v[64:67], v173 offset:0
    ds_read_b128 a[40:43], v86 offset:0
    v_mfma_f32_16x16x32_bf16 v[238:241], a[68:71], v[68:71], v[238:241]
    s_waitcnt lgkmcnt(6)
    v_mfma_f32_16x16x32_bf16 v[210:213], a[72:75], v[48:51], v[210:213]
    ds_read_b128 v[68:71], v173 offset:1040
    ds_read_b128 a[44:47], v88 offset:0
    v_mfma_f32_16x16x32_bf16 v[226:229], a[76:79], v[48:51], v[226:229]
    ds_write_b128 v175, v[242:245]
    v_mfma_f32_16x16x32_bf16 v[214:217], a[72:75], v[52:55], v[214:217]
    ds_read_b128 v[48:51], v173 offset:2080
    ds_read_b128 a[48:51], v83 offset:0
    v_mfma_f32_16x16x32_bf16 v[230:233], a[76:79], v[52:55], v[230:233]
    ds_read_b128 a[52:55], v85 offset:0
    s_waitcnt lgkmcnt(9)
    v_mfma_f32_16x16x32_bf16 v[218:221], a[72:75], v[56:59], v[218:221]
    ds_read_b128 v[52:55], v173 offset:3120
    v_mfma_f32_16x16x32_bf16 v[234:237], a[76:79], v[56:59], v[234:237]
    ds_read_b128 a[56:59], v87 offset:0
    v_mfma_f32_16x16x32_bf16 v[222:225], a[72:75], v[60:63], v[222:225]
    ds_read_b128 v[56:59], v173 offset:4160
    global_load_dwordx2 v[130:131], v174, s[38:39] offset:0 sc1
    v_mfma_f32_16x16x32_bf16 v[238:241], a[76:79], v[60:63], v[238:241]
    global_load_dwordx2 v[132:133], v174, s[38:39] offset:512 sc1
    ds_read_b128 a[60:63], v89 offset:0
    s_waitcnt lgkmcnt(9)
    v_mfma_f32_16x16x32_bf16 v[210:213], a[80:83], v[64:67], v[210:213]
    ds_read_b128 v[60:63], v173 offset:5200
    global_load_dwordx2 v[134:135], v174, s[38:39] offset:1024 sc1
    v_mfma_f32_16x16x32_bf16 v[226:229], a[84:87], v[64:67], v[226:229]
    global_load_dwordx2 v[136:137], v174, s[38:39] offset:1536 sc1
    s_waitcnt lgkmcnt(1)
    s_add_u32 m0, s89, 0
    v_mfma_f32_16x16x32_bf16 v[214:217], a[80:83], v[68:71], v[214:217]
    ds_read_b128 v[64:67], v173 offset:6240
    global_load_dwordx2 v[138:139], v174, s[38:39] offset:2048 sc1
    v_mfma_f32_16x16x32_bf16 v[230:233], a[84:87], v[68:71], v[230:233]
    global_load_dwordx2 v[140:141], v174, s[38:39] offset:2560 sc1
    global_load_dwordx2 v[142:143], v174, s[38:39] offset:3072 sc1
    v_mfma_f32_16x16x32_bf16 v[218:221], a[80:83], v[48:51], v[218:221]
    ds_read_b128 v[68:71], v173 offset:7280
    global_load_lds_dwordx4 v74, s[80:81] offset:0
    v_mfma_f32_16x16x32_bf16 v[234:237], a[84:87], v[48:51], v[234:237]
    global_load_dwordx2 v[144:145], v174, s[38:39] offset:3584 sc1
    s_bfe_u32 s6, s2, 0x30003
    global_load_lds_dwordx4 v75, s[80:81] offset:1024
    v_mfma_f32_16x16x32_bf16 v[222:225], a[80:83], v[52:55], v[222:225]
    ds_read_b128 v[48:51], v173 offset:8320
    v_mul_u32_u24 v254, 8, v0
    v_mfma_f32_16x16x32_bf16 v[238:241], a[84:87], v[52:55], v[238:241]
    v_add_lshl_u32 v254, v254, s6, 7
    global_load_lds_dwordx4 v76, s[80:81] offset:2048
    s_waitcnt lgkmcnt(3)
    v_mfma_f32_16x16x32_bf16 v[210:213], a[88:91], v[56:59], v[210:213]
    ds_read_b128 v[52:55], v173 offset:9360
    v_min_u32 v254, (Lend-Lmid-4), v254
    v_mfma_f32_16x16x32_bf16 v[226:229], a[92:95], v[56:59], v[226:229]
    v_add_u32 v254, (Lmid-adaLN_cond__ssm_conv_h3__mixer_gmlp__prompt_kernel), v254
    global_load_lds_dwordx4 v77, s[80:81] offset:3072
    v_mfma_f32_16x16x32_bf16 v[214:217], a[88:91], v[60:63], v[214:217]
    ds_read_b128 v[56:59], v173 offset:10400
    global_load_dword v254, v254, s[0:1]
    s_add_u32 m0, s89, 4096
    v_mfma_f32_16x16x32_bf16 v[230:233], a[92:95], v[60:63], v[230:233]
    global_load_lds_dwordx4 v78, s[80:81] offset:0
    s_waitcnt lgkmcnt(3)
    v_mfma_f32_16x16x32_bf16 v[218:221], a[88:91], v[64:67], v[218:221]
    ds_read_b128 v[60:63], v173 offset:11440
    v_mfma_f32_16x16x32_bf16 v[234:237], a[92:95], v[64:67], v[234:237]
    global_load_lds_dwordx4 v79, s[80:81] offset:1024
    v_mfma_f32_16x16x32_bf16 v[222:225], a[88:91], v[68:71], v[222:225]
    ds_read_b128 v[64:67], v173 offset:12480
    global_load_lds_dwordx4 v80, s[80:81] offset:2048
    v_mfma_f32_16x16x32_bf16 v[238:241], a[92:95], v[68:71], v[238:241]
    s_waitcnt lgkmcnt(3)
    v_mfma_f32_16x16x32_bf16 v[210:213], a[96:99], v[48:51], v[210:213]
    ds_read_b128 v[68:71], v173 offset:13520
    global_load_lds_dwordx4 v81, s[80:81] offset:3072
    v_mfma_f32_16x16x32_bf16 v[226:229], a[100:103], v[48:51], v[226:229]
    v_mfma_f32_16x16x32_bf16 v[214:217], a[96:99], v[52:55], v[214:217]
    ds_read_b128 v[48:51], v173 offset:14560
    s_waitcnt vmcnt(17)
    ds_read_b128 a[64:67], v82 offset:8192
    v_mfma_f32_16x16x32_bf16 v[230:233], a[100:103], v[52:55], v[230:233]
    s_waitcnt lgkmcnt(4)
    v_mfma_f32_16x16x32_bf16 v[218:221], a[96:99], v[56:59], v[218:221]
    ds_read_b128 v[52:55], v173 offset:15600
    v_mfma_f32_16x16x32_bf16 v[234:237], a[100:103], v[56:59], v[234:237]
    ds_read_b128 a[68:71], v84 offset:8192
    v_mfma_f32_16x16x32_bf16 v[222:225], a[96:99], v[60:63], v[222:225]
    ds_read_b128 v[56:59], v173 offset:16640
    ds_read_b128 a[72:75], v86 offset:8192
    v_mfma_f32_16x16x32_bf16 v[238:241], a[100:103], v[60:63], v[238:241]
    s_waitcnt lgkmcnt(6)
    v_mfma_f32_16x16x32_bf16 v[210:213], a[104:107], v[64:67], v[210:213]
    ds_read_b128 v[60:63], v173 offset:17680
    ds_read_b128 a[76:79], v88 offset:8192
    v_mfma_f32_16x16x32_bf16 v[226:229], a[108:111], v[64:67], v[226:229]
    v_mfma_f32_16x16x32_bf16 v[214:217], a[104:107], v[68:71], v[214:217]
    ds_read_b128 v[64:67], v173 offset:18720
    ds_read_b128 a[80:83], v83 offset:8192
    v_mfma_f32_16x16x32_bf16 v[230:233], a[108:111], v[68:71], v[230:233]
    ds_read_b128 a[84:87], v85 offset:8192
    s_waitcnt lgkmcnt(8)
    s_waitcnt vmcnt(15)
    v_max_u32 v28, v131, v133
    s_waitcnt vmcnt(13)
    v_max3_u32 v28, v135, v137, v28
    s_waitcnt vmcnt(11)
    v_max3_u32 v28, v139, v141, v28
    s_waitcnt vmcnt(8)
    v_max3_u32 v28, v143, v145, v28
    v_cmp_eq_u32 vcc, -1, v28
    s_nop 0
    s_cbranch_vccnz Ls3_r
Ls3_ok:
    v_pk_add_f32 v[130:131], v[130:131], v[132:133] op_sel:[0,0] op_sel_hi:[1,1]
    v_pk_add_f32 v[134:135], v[134:135], v[136:137] op_sel:[0,0] op_sel_hi:[1,1]
    v_pk_add_f32 v[138:139], v[138:139], v[140:141] op_sel:[0,0] op_sel_hi:[1,1]
    v_pk_add_f32 v[142:143], v[142:143], v[144:145] op_sel:[0,0] op_sel_hi:[1,1]
    v_pk_add_f32 v[130:131], v[130:131], v[134:135] op_sel:[0,0] op_sel_hi:[1,1]
    v_pk_add_f32 v[138:139], v[138:139], v[142:143] op_sel:[0,0] op_sel_hi:[1,1]
    v_pk_add_f32 v[130:131], v[130:131], v[138:139] op_sel:[0,0] op_sel_hi:[1,1]
    v_mul_f32 v130, 0x3a97b426, v130
    v_mul_f32 v131, 0x3a97b426, v131
    v_fma_f32 v131, -v130, v130, v131
    v_max_f32 v131, 0, v131
    v_add_f32 v131, 0x3727c5ac, v131
    v_rsq_f32 v132, v131
    s_nop 0
    v_mul_f32_e64 v131, -v130, v132
    v_mov_b32 v130, v132
    ds_write2st64_b32 v170, v130, v131 offset0:0 offset1:1
    ds_read_b128 v[98:101], v171 offset:0
    ds_read_b128 v[102:105], v171 offset:16
    ds_read_b128 v[106:109], v171 offset:128
    ds_read_b128 v[110:113], v171 offset:144
    ds_read_b128 v[114:117], v171 offset:256
    ds_read_b128 v[118:121], v171 offset:272
    ds_read_b128 v[122:125], v171 offset:384
    ds_read_b128 v[126:129], v171 offset:400
    s_lshl_b32 s4, s41, 6
    s_lshl_b32 s5, s40, 1
    s_add_u32 s4, s4, s5
    s_mul_i32 s4, s4, 7168
    s_lshl_b32 s5, s3, 11
    s_add_u32 s4, s4, s5
    s_add_u32 s4, s4, 12582912
    v_add_u32 v28, s4, v4
    v_add_u32 v29, 7168, v28
    s_waitcnt lgkmcnt(3)
    v_pk_fma_f32 v[178:179], v[178:179], v[98:99], v[114:115] op_sel:[0,0,0] op_sel_hi:[1,1,1]
    v_pk_fma_f32 v[180:181], v[180:181], v[100:101], v[116:117] op_sel:[0,0,0] op_sel_hi:[1,1,1]
    s_waitcnt lgkmcnt(2)
    v_pk_fma_f32 v[182:183], v[182:183], v[102:103], v[118:119] op_sel:[0,0,0] op_sel_hi:[1,1,1]
    v_pk_fma_f32 v[184:185], v[184:185], v[104:105], v[120:121] op_sel:[0,0,0] op_sel_hi:[1,1,1]
    v_cvt_pk_bf16_f32 v130, v178, v179
    v_cvt_pk_bf16_f32 v131, v180, v181
    v_cvt_pk_bf16_f32 v132, v182, v183
    v_cvt_pk_bf16_f32 v133, v184, v185
    v_or_b32 v133, 1, v133
    global_store_dwordx4 v28, v[130:133], s[38:39] offset:0 sc1
    s_waitcnt lgkmcnt(1)
    v_pk_fma_f32 v[186:187], v[186:187], v[106:107], v[122:123] op_sel:[0,0,0] op_sel_hi:[1,1,1]
    v_pk_fma_f32 v[188:189], v[188:189], v[108:109], v[124:125] op_sel:[0,0,0] op_sel_hi:[1,1,1]
    s_waitcnt lgkmcnt(0)
    v_pk_fma_f32 v[190:191], v[190:191], v[110:111], v[126:127] op_sel:[0,0,0] op_sel_hi:[1,1,1]
    v_pk_fma_f32 v[192:193], v[192:193], v[112:113], v[128:129] op_sel:[0,0,0] op_sel_hi:[1,1,1]
    v_cvt_pk_bf16_f32 v134, v186, v187
    v_cvt_pk_bf16_f32 v135, v188, v189
    v_cvt_pk_bf16_f32 v136, v190, v191
    v_cvt_pk_bf16_f32 v137, v192, v193
    v_or_b32 v137, 1, v137
    global_store_dwordx4 v29, v[134:137], s[38:39] offset:0 sc1
    v_pk_fma_f32 v[194:195], v[194:195], v[98:99], v[114:115] op_sel:[0,0,0] op_sel_hi:[1,1,1]
    v_pk_fma_f32 v[196:197], v[196:197], v[100:101], v[116:117] op_sel:[0,0,0] op_sel_hi:[1,1,1]
    v_pk_fma_f32 v[198:199], v[198:199], v[102:103], v[118:119] op_sel:[0,0,0] op_sel_hi:[1,1,1]
    v_pk_fma_f32 v[200:201], v[200:201], v[104:105], v[120:121] op_sel:[0,0,0] op_sel_hi:[1,1,1]
    v_cvt_pk_bf16_f32 v138, v194, v195
    v_cvt_pk_bf16_f32 v139, v196, v197
    v_cvt_pk_bf16_f32 v140, v198, v199
    v_cvt_pk_bf16_f32 v141, v200, v201
    v_or_b32 v141, 1, v141
    s_cmp_eq_u32 s3, 3
    s_cbranch_scc1 Lzs_0
    global_store_dwordx4 v28, v[138:141], s[38:39] offset:1024 sc1
Lzs_0:
    v_pk_fma_f32 v[202:203], v[202:203], v[106:107], v[122:123] op_sel:[0,0,0] op_sel_hi:[1,1,1]
    v_pk_fma_f32 v[204:205], v[204:205], v[108:109], v[124:125] op_sel:[0,0,0] op_sel_hi:[1,1,1]
    v_pk_fma_f32 v[206:207], v[206:207], v[110:111], v[126:127] op_sel:[0,0,0] op_sel_hi:[1,1,1]
    v_pk_fma_f32 v[208:209], v[208:209], v[112:113], v[128:129] op_sel:[0,0,0] op_sel_hi:[1,1,1]
    v_cvt_pk_bf16_f32 v142, v202, v203
    v_cvt_pk_bf16_f32 v143, v204, v205
    v_cvt_pk_bf16_f32 v144, v206, v207
    v_cvt_pk_bf16_f32 v145, v208, v209
    v_or_b32 v145, 1, v145
    s_cmp_eq_u32 s3, 3
    s_cbranch_scc1 Lzs_1
    global_store_dwordx4 v29, v[142:145], s[38:39] offset:1024 sc1
Lzs_1:
    v_mfma_f32_16x16x32_bf16 v[218:221], a[104:107], v[48:51], v[218:221]
    ds_read_b128 v[68:71], v173 offset:19760
    v_mfma_f32_16x16x32_bf16 v[234:237], a[108:111], v[48:51], v[234:237]
    ds_read_b128 a[88:91], v87 offset:8192
    s_mul_i32 s91, s41, 458752
    v_mfma_f32_16x16x32_bf16 v[222:225], a[104:107], v[52:55], v[222:225]
    ds_read_b128 v[48:51], v173 offset:20800
    ds_read_b128 a[92:95], v89 offset:8192
    s_add_u32 s91, s91, 12582912
    v_mfma_f32_16x16x32_bf16 v[238:241], a[108:111], v[52:55], v[238:241]
    v_mfma_f32_16x16x32_bf16 v[210:213], a[112:115], v[56:59], v[210:213]
    ds_read_b128 v[52:55], v173 offset:21840
    s_waitcnt lgkmcnt(1)
    s_add_u32 m0, s89, 8192
    v_mfma_f32_16x16x32_bf16 v[226:229], a[116:119], v[56:59], v[226:229]
    s_mul_i32 s6, s44, 14336
    v_mfma_f32_16x16x32_bf16 v[214:217], a[112:115], v[60:63], v[214:217]
    ds_read_b128 v[56:59], v173 offset:22880
    s_add_u32 s6, s6, s91
    v_mfma_f32_16x16x32_bf16 v[230:233], a[116:119], v[60:63], v[230:233]
    global_load_lds_dwordx4 v74, s[82:83] offset:0
    v_mfma_f32_16x16x32_bf16 v[218:221], a[112:115], v[64:67], v[218:221]
    ds_read_b128 v[60:63], v173 offset:23920
    s_add_u32 s52, s38, s6
    s_addc_u32 s53, s39, 0
    v_mfma_f32_16x16x32_bf16 v[234:237], a[116:119], v[64:67], v[234:237]
    global_load_lds_dwordx4 v75, s[82:83] offset:1024
    v_mfma_f32_16x16x32_bf16 v[222:225], a[112:115], v[68:71], v[222:225]
    ds_read_b128 v[64:67], v173 offset:24960
    global_load_lds_dwordx4 v76, s[82:83] offset:2048
    v_mfma_f32_16x16x32_bf16 v[238:241], a[116:119], v[68:71], v[238:241]
    s_waitcnt lgkmcnt(3)
    v_mfma_f32_16x16x32_bf16 v[210:213], a[120:123], v[48:51], v[210:213]
    ds_read_b128 v[68:71], v173 offset:26000
    global_load_lds_dwordx4 v77, s[82:83] offset:3072
    v_mfma_f32_16x16x32_bf16 v[226:229], a[124:127], v[48:51], v[226:229]
    s_add_u32 s54, s52, 14336
    s_addc_u32 s55, s53, 0
    v_mfma_f32_16x16x32_bf16 v[214:217], a[120:123], v[52:55], v[214:217]
    ds_read_b128 v[48:51], v173 offset:27040
    s_add_u32 m0, s89, 12288
    v_mfma_f32_16x16x32_bf16 v[230:233], a[124:127], v[52:55], v[230:233]
    global_load_lds_dwordx4 v78, s[82:83] offset:0
    s_waitcnt lgkmcnt(3)
    v_mfma_f32_16x16x32_bf16 v[218:221], a[120:123], v[56:59], v[218:221]
    ds_read_b128 v[52:55], v173 offset:28080
    s_mul_i32 s6, s46, 14336
    v_mfma_f32_16x16x32_bf16 v[234:237], a[124:127], v[56:59], v[234:237]
    global_load_lds_dwordx4 v79, s[82:83] offset:1024
    v_mfma_f32_16x16x32_bf16 v[222:225], a[120:123], v[60:63], v[222:225]
    ds_read_b128 v[56:59], v173 offset:29120
    s_add_u32 s6, s6, s91
    global_load_lds_dwordx4 v80, s[82:83] offset:2048
    v_mfma_f32_16x16x32_bf16 v[238:241], a[124:127], v[60:63], v[238:241]
    s_waitcnt lgkmcnt(3)
    v_mfma_f32_16x16x32_bf16 v[210:213], a[128:131], v[64:67], v[210:213]
    ds_read_b128 v[60:63], v173 offset:30160
    global_load_lds_dwordx4 v81, s[82:83] offset:3072
    v_mfma_f32_16x16x32_bf16 v[226:229], a[132:135], v[64:67], v[226:229]
    s_add_u32 s56, s38, s6
    s_addc_u32 s57, s39, 0
    v_mfma_f32_16x16x32_bf16 v[214:217], a[128:131], v[68:71], v[214:217]
    ds_read_b128 v[64:67], v173 offset:31200
    s_waitcnt vmcnt(10)
    ds_read_b128 a[96:99], v82 offset:0
    v_mfma_f32_16x16x32_bf16 v[230:233], a[132:135], v[68:71], v[230:233]
    s_waitcnt lgkmcnt(4)
    v_mfma_f32_16x16x32_bf16 v[218:221], a[128:131], v[48:51], v[218:221]
    ds_read_b128 v[68:71], v173 offset:32240
    s_add_u32 s58, s56, 14336
    s_addc_u32 s59, s57, 0
    v_mfma_f32_16x16x32_bf16 v[234:237], a[132:135], v[48:51], v[234:237]
    v_mfma_f32_16x16x32_bf16 v[222:225], a[128:131], v[52:55], v[222:225]
    ds_read_b128 v[48:51], v173 offset:33280
    ds_read_b128 a[100:103], v84 offset:0
    v_mfma_f32_16x16x32_bf16 v[238:241], a[132:135], v[52:55], v[238:241]
    s_mul_i32 s6, s48, 14336
    s_waitcnt lgkmcnt(5)
    v_mfma_f32_16x16x32_bf16 v[210:213], a[136:139], v[56:59], v[210:213]
    ds_read_b128 v[52:55], v173 offset:34320
    v_mfma_f32_16x16x32_bf16 v[226:229], a[140:143], v[56:59], v[226:229]
    ds_read_b128 a[104:107], v86 offset:0
    s_add_u32 s6, s6, s91
    v_mfma_f32_16x16x32_bf16 v[214:217], a[136:139], v[60:63], v[214:217]
    ds_read_b128 v[56:59], v173 offset:35360
    v_mfma_f32_16x16x32_bf16 v[230:233], a[140:143], v[60:63], v[230:233]
    ds_read_b128 a[108:111], v88 offset:0
    s_waitcnt lgkmcnt(6)
    v_mfma_f32_16x16x32_bf16 v[218:221], a[136:139], v[64:67], v[218:221]
    ds_read_b128 v[60:63], v173 offset:36400
    s_add_u32 s60, s38, s6
    s_addc_u32 s61, s39, 0
    v_mfma_f32_16x16x32_bf16 v[234:237], a[140:143], v[64:67], v[234:237]
    ds_read_b128 a[112:115], v83 offset:0
    v_mfma_f32_16x16x32_bf16 v[222:225], a[136:139], v[68:71], v[222:225]
    ds_read_b128 v[64:67], v173 offset:37440
    v_mfma_f32_16x16x32_bf16 v[238:241], a[140:143], v[68:71], v[238:241]
    s_add_u32 s62, s60, 14336
    s_addc_u32 s63, s61, 0
    s_waitcnt lgkmcnt(6)
    v_mfma_f32_16x16x32_bf16 v[210:213], a[144:147], v[48:51], v[210:213]
    ds_read_b128 v[68:71], v173 offset:38480
    ds_read_b128 a[116:119], v85 offset:0
    v_mfma_f32_16x16x32_bf16 v[226:229], a[148:151], v[48:51], v[226:229]
    v_mfma_f32_16x16x32_bf16 v[214:217], a[144:147], v[52:55], v[214:217]
    ds_read_b128 v[48:51], v173 offset:39520
    ds_read_b128 a[120:123], v87 offset:0
    v_mfma_f32_16x16x32_bf16 v[230:233], a[148:151], v[52:55], v[230:233]
    s_mul_i32 s6, s50, 14336
    s_waitcnt lgkmcnt(6)
    v_mfma_f32_16x16x32_bf16 v[218:221], a[144:147], v[56:59], v[218:221]
    ds_read_b128 v[52:55], v173 offset:40560
    ds_read_b128 a[124:127], v89 offset:0
    v_mfma_f32_16x16x32_bf16 v[234:237], a[148:151], v[56:59], v[234:237]
    s_add_u32 s6, s6, s91
    v_mfma_f32_16x16x32_bf16 v[222:225], a[144:147], v[60:63], v[222:225]
    v_mfma_f32_16x16x32_bf16 v[238:241], a[148:151], v[60:63], v[238:241]
    s_add_u32 s64, s38, s6
    s_addc_u32 s65, s39, 0
    s_waitcnt lgkmcnt(5)
    v_mfma_f32_16x16x32_bf16 v[210:213], a[152:155], v[64:67], v[210:213]
    v_mfma_f32_16x16x32_bf16 v[226:229], a[156:159], v[64:67], v[226:229]
    v_mfma_f32_16x16x32_bf16 v[214:217], a[152:155], v[68:71], v[214:217]
    v_mfma_f32_16x16x32_bf16 v[230:233], a[156:159], v[68:71], v[230:233]
    s_add_u32 s66, s64, 14336
    s_addc_u32 s67, s65, 0
    s_waitcnt lgkmcnt(1)
    v_mfma_f32_16x16x32_bf16 v[218:221], a[152:155], v[48:51], v[218:221]
    v_mfma_f32_16x16x32_bf16 v[234:237], a[156:159], v[48:51], v[234:237]
    v_mfma_f32_16x16x32_bf16 v[222:225], a[152:155], v[52:55], v[222:225]
    v_mfma_f32_16x16x32_bf16 v[238:241], a[156:159], v[52:55], v[238:241]
    s_waitcnt vmcnt(0)
    ds_read_b128 a[128:131], v82 offset:8192
    ds_read_b128 a[132:135], v84 offset:8192
    ds_read_b128 a[136:139], v86 offset:8192
    ds_read_b128 a[140:143], v88 offset:8192
    ds_read_b128 a[144:147], v83 offset:8192
    ds_read_b128 a[148:151], v85 offset:8192
    ds_read_b128 a[152:155], v87 offset:8192
    ds_read_b128 a[156:159], v89 offset:8192
    s_waitcnt lgkmcnt(0)
    s_barrier
    s_mul_i32 s5, s41, 138240
    s_add_u32 s5, s5, 10485760
    s_add_u32 s92, s38, s5
    s_addc_u32 s93, s39, 0
    s_mul_i32 s95, s3, 34816
    s_min_u32 s95, s95, 103424
    s_add_u32 s92, s92, s95
    s_addc_u32 s93, s93, 0
    s_add_u32 m0, s95, 0
    s_nop 0
    global_load_lds_dwordx4 v4, s[92:93] offset:0 sc1
    s_lshl_b32 s4, s3, 10
    s_add_u32 s4, s4, 138240
    v_add_u32 v170, s4, v30
    s_lshl_b32 s4, s3, 12
    s_add_u32 s4, s4, 138240
    v_add_u32 v171, s4, v30
    v_add_u32 v30, 3072, v4
    v_add_u32 v31, 10240, v4
    v_min_u32 v29, 27, v1
    v_lshlrev_b32 v29, 10, v29
    v_pk_fma_f32 v[178:179], v[162:163], v[12:13], v[16:17] op_sel:[1,0,0] op_sel_hi:[1,1,1]
    v_pk_fma_f32 v[180:181], v[162:163], v[14:15], v[18:19] op_sel:[1,0,0] op_sel_hi:[1,1,1]
    v_pk_fma_f32 v[182:183], v[164:165], v[12:13], v[16:17] op_sel:[1,0,0] op_sel_hi:[1,1,1]
    v_pk_fma_f32 v[184:185], v[164:165], v[14:15], v[18:19] op_sel:[1,0,0] op_sel_hi:[1,1,1]
    v_pk_fma_f32 v[186:187], v[166:167], v[12:13], v[16:17] op_sel:[1,0,0] op_sel_hi:[1,1,1]
    v_pk_fma_f32 v[188:189], v[166:167], v[14:15], v[18:19] op_sel:[1,0,0] op_sel_hi:[1,1,1]
    v_pk_fma_f32 v[190:191], v[168:169], v[12:13], v[16:17] op_sel:[1,0,0] op_sel_hi:[1,1,1]
    v_pk_fma_f32 v[192:193], v[168:169], v[14:15], v[18:19] op_sel:[1,0,0] op_sel_hi:[1,1,1]
    v_pk_fma_f32 v[210:211], v[162:163], v[210:211], v[178:179] op_sel:[0,0,0] op_sel_hi:[0,1,1]
    global_load_lds_dwordx4 v4, s[92:93] offset:1024 sc1
    v_pk_fma_f32 v[212:213], v[162:163], v[212:213], v[180:181] op_sel:[0,0,0] op_sel_hi:[0,1,1]
    v_pk_fma_f32 v[214:215], v[164:165], v[214:215], v[182:183] op_sel:[0,0,0] op_sel_hi:[0,1,1]
    v_pk_fma_f32 v[216:217], v[164:165], v[216:217], v[184:185] op_sel:[0,0,0] op_sel_hi:[0,1,1]
    v_pk_fma_f32 v[218:219], v[166:167], v[218:219], v[186:187] op_sel:[0,0,0] op_sel_hi:[0,1,1]
    v_pk_fma_f32 v[220:221], v[166:167], v[220:221], v[188:189] op_sel:[0,0,0] op_sel_hi:[0,1,1]
    v_pk_fma_f32 v[222:223], v[168:169], v[222:223], v[190:191] op_sel:[0,0,0] op_sel_hi:[0,1,1]
    v_pk_fma_f32 v[224:225], v[168:169], v[224:225], v[192:193] op_sel:[0,0,0] op_sel_hi:[0,1,1]
    v_pk_fma_f32 v[178:179], v[162:163], v[20:21], v[24:25] op_sel:[1,0,0] op_sel_hi:[1,1,1]
    v_pk_fma_f32 v[180:181], v[162:163], v[22:23], v[26:27] op_sel:[1,0,0] op_sel_hi:[1,1,1]
    v_pk_fma_f32 v[182:183], v[164:165], v[20:21], v[24:25] op_sel:[1,0,0] op_sel_hi:[1,1,1]
    v_pk_fma_f32 v[184:185], v[164:165], v[22:23], v[26:27] op_sel:[1,0,0] op_sel_hi:[1,1,1]
    v_pk_fma_f32 v[186:187], v[166:167], v[20:21], v[24:25] op_sel:[1,0,0] op_sel_hi:[1,1,1]
    v_pk_fma_f32 v[188:189], v[166:167], v[22:23], v[26:27] op_sel:[1,0,0] op_sel_hi:[1,1,1]
    v_pk_fma_f32 v[190:191], v[168:169], v[20:21], v[24:25] op_sel:[1,0,0] op_sel_hi:[1,1,1]
    v_pk_fma_f32 v[192:193], v[168:169], v[22:23], v[26:27] op_sel:[1,0,0] op_sel_hi:[1,1,1]
    v_pk_fma_f32 v[226:227], v[162:163], v[226:227], v[178:179] op_sel:[0,0,0] op_sel_hi:[0,1,1]
    v_pk_fma_f32 v[228:229], v[162:163], v[228:229], v[180:181] op_sel:[0,0,0] op_sel_hi:[0,1,1]
    v_pk_fma_f32 v[230:231], v[164:165], v[230:231], v[182:183] op_sel:[0,0,0] op_sel_hi:[0,1,1]
    v_pk_fma_f32 v[232:233], v[164:165], v[232:233], v[184:185] op_sel:[0,0,0] op_sel_hi:[0,1,1]
    global_load_lds_dwordx4 v4, s[92:93] offset:2048 sc1
    v_pk_fma_f32 v[234:235], v[166:167], v[234:235], v[186:187] op_sel:[0,0,0] op_sel_hi:[0,1,1]
    v_pk_fma_f32 v[236:237], v[166:167], v[236:237], v[188:189] op_sel:[0,0,0] op_sel_hi:[0,1,1]
    v_pk_fma_f32 v[238:239], v[168:169], v[238:239], v[190:191] op_sel:[0,0,0] op_sel_hi:[0,1,1]
    v_pk_fma_f32 v[240:241], v[168:169], v[240:241], v[192:193] op_sel:[0,0,0] op_sel_hi:[0,1,1]
    v_pk_mul_f32 v[178:179], v[210:211], v[210:211] op_sel:[0,0] op_sel_hi:[1,1]
    v_pk_mul_f32 v[180:181], v[212:213], v[212:213] op_sel:[0,0] op_sel_hi:[1,1]
    v_pk_mul_f32 v[182:183], v[214:215], v[214:215] op_sel:[0,0] op_sel_hi:[1,1]
    v_pk_mul_f32 v[184:185], v[216:217], v[216:217] op_sel:[0,0] op_sel_hi:[1,1]
    v_pk_mul_f32 v[186:187], v[218:219], v[218:219] op_sel:[0,0] op_sel_hi:[1,1]
    v_pk_mul_f32 v[188:189], v[220:221], v[220:221] op_sel:[0,0] op_sel_hi:[1,1]
    v_pk_mul_f32 v[190:191], v[222:223], v[222:223] op_sel:[0,0] op_sel_hi:[1,1]
    v_pk_mul_f32 v[192:193], v[224:225], v[224:225] op_sel:[0,0] op_sel_hi:[1,1]
    v_pk_mul_f32 v[194:195], v[226:227], v[226:227] op_sel:[0,0] op_sel_hi:[1,1]
    v_pk_mul_f32 v[196:197], v[228:229], v[228:229] op_sel:[0,0] op_sel_hi:[1,1]
    v_pk_mul_f32 v[198:199], v[230:231], v[230:231] op_sel:[0,0] op_sel_hi:[1,1]
    v_pk_mul_f32 v[200:201], v[232:233], v[232:233] op_sel:[0,0] op_sel_hi:[1,1]
    v_pk_mul_f32 v[202:203], v[234:235], v[234:235] op_sel:[0,0] op_sel_hi:[1,1]
    v_pk_mul_f32 v[204:205], v[236:237], v[236:237] op_sel:[0,0] op_sel_hi:[1,1]
    v_pk_mul_f32 v[206:207], v[238:239], v[238:239] op_sel:[0,0] op_sel_hi:[1,1]
    global_load_lds_dwordx4 v4, s[92:93] offset:3072 sc1
    v_pk_mul_f32 v[208:209], v[240:241], v[240:241] op_sel:[0,0] op_sel_hi:[1,1]
    v_pk_fma_f32 v[178:179], v[178:179], s[84:85], s[84:85] op_sel:[0,1,0] op_sel_hi:[1,1,0]
    v_pk_fma_f32 v[180:181], v[180:181], s[84:85], s[84:85] op_sel:[0,1,0] op_sel_hi:[1,1,0]
    v_pk_fma_f32 v[182:183], v[182:183], s[84:85], s[84:85] op_sel:[0,1,0] op_sel_hi:[1,1,0]
    v_pk_fma_f32 v[184:185], v[184:185], s[84:85], s[84:85] op_sel:[0,1,0] op_sel_hi:[1,1,0]
    v_pk_fma_f32 v[186:187], v[186:187], s[84:85], s[84:85] op_sel:[0,1,0] op_sel_hi:[1,1,0]
    v_pk_fma_f32 v[188:189], v[188:189], s[84:85], s[84:85] op_sel:[0,1,0] op_sel_hi:[1,1,0]
    v_pk_fma_f32 v[190:191], v[190:191], s[84:85], s[84:85] op_sel:[0,1,0] op_sel_hi:[1,1,0]
    v_pk_fma_f32 v[192:193], v[192:193], s[84:85], s[84:85] op_sel:[0,1,0] op_sel_hi:[1,1,0]
    v_pk_fma_f32 v[194:195], v[194:195], s[84:85], s[84:85] op_sel:[0,1,0] op_sel_hi:[1,1,0]
    v_pk_fma_f32 v[196:197], v[196:197], s[84:85], s[84:85] op_sel:[0,1,0] op_sel_hi:[1,1,0]
    v_pk_fma_f32 v[198:199], v[198:199], s[84:85], s[84:85] op_sel:[0,1,0] op_sel_hi:[1,1,0]
    v_pk_fma_f32 v[200:201], v[200:201], s[84:85], s[84:85] op_sel:[0,1,0] op_sel_hi:[1,1,0]
    v_pk_fma_f32 v[202:203], v[202:203], s[84:85], s[84:85] op_sel:[0,1,0] op_sel_hi:[1,1,0]
    v_pk_fma_f32 v[204:205], v[204:205], s[84:85], s[84:85] op_sel:[0,1,0] op_sel_hi:[1,1,0]
    v_pk_fma_f32 v[206:207], v[206:207], s[84:85], s[84:85] op_sel:[0,1,0] op_sel_hi:[1,1,0]
    v_pk_fma_f32 v[208:209], v[208:209], s[84:85], s[84:85] op_sel:[0,1,0] op_sel_hi:[1,1,0]
    v_pk_mul_f32 v[178:179], v[178:179], v[210:211] op_sel:[0,0] op_sel_hi:[1,1]
    v_pk_mul_f32 v[180:181], v[180:181], v[212:213] op_sel:[0,0] op_sel_hi:[1,1]
    s_add_u32 m0, s95, 4096
    s_add_u32 s92, s92, 4096
    s_addc_u32 s93, s93, 0
    global_load_lds_dwordx4 v4, s[92:93] offset:0 sc1
    v_pk_mul_f32 v[182:183], v[182:183], v[214:215] op_sel:[0,0] op_sel_hi:[1,1]
    v_pk_mul_f32 v[184:185], v[184:185], v[216:217] op_sel:[0,0] op_sel_hi:[1,1]
    v_pk_mul_f32 v[186:187], v[186:187], v[218:219] op_sel:[0,0] op_sel_hi:[1,1]
    v_pk_mul_f32 v[188:189], v[188:189], v[220:221] op_sel:[0,0] op_sel_hi:[1,1]
    v_pk_mul_f32 v[190:191], v[190:191], v[222:223] op_sel:[0,0] op_sel_hi:[1,1]
    v_pk_mul_f32 v[192:193], v[192:193], v[224:225] op_sel:[0,0] op_sel_hi:[1,1]
    v_pk_mul_f32 v[194:195], v[194:195], v[226:227] op_sel:[0,0] op_sel_hi:[1,1]
    v_pk_mul_f32 v[196:197], v[196:197], v[228:229] op_sel:[0,0] op_sel_hi:[1,1]
    v_pk_mul_f32 v[198:199], v[198:199], v[230:231] op_sel:[0,0] op_sel_hi:[1,1]
    v_pk_mul_f32 v[200:201], v[200:201], v[232:233] op_sel:[0,0] op_sel_hi:[1,1]
    v_pk_mul_f32 v[202:203], v[202:203], v[234:235] op_sel:[0,0] op_sel_hi:[1,1]
    v_pk_mul_f32 v[204:205], v[204:205], v[236:237] op_sel:[0,0] op_sel_hi:[1,1]
    v_pk_mul_f32 v[206:207], v[206:207], v[238:239] op_sel:[0,0] op_sel_hi:[1,1]
    v_pk_mul_f32 v[208:209], v[208:209], v[240:241] op_sel:[0,0] op_sel_hi:[1,1]
    v_exp_f32 v178, v178
    v_exp_f32 v179, v179
    v_exp_f32 v180, v180
    v_exp_f32 v181, v181
    v_exp_f32 v182, v182
    global_load_lds_dwordx4 v4, s[92:93] offset:1024 sc1
    v_exp_f32 v183, v183
    v_exp_f32 v184, v184
    v_exp_f32 v185, v185
    v_exp_f32 v186, v186
    v_exp_f32 v187, v187
    v_exp_f32 v188, v188
    v_exp_f32 v189, v189
    v_exp_f32 v190, v190
    v_exp_f32 v191, v191
    v_exp_f32 v192, v192
    v_exp_f32 v193, v193
    v_exp_f32 v194, v194
    global_load_dword v46, v29, s[56:57] offset:1020 sc1
    v_exp_f32 v195, v195
    v_exp_f32 v196, v196
    v_exp_f32 v197, v197
    v_exp_f32 v198, v198
    v_exp_f32 v199, v199
    v_exp_f32 v200, v200
    global_load_dwordx4 v[62:65], v30, s[56:57] offset:-3072 sc1
    v_exp_f32 v201, v201
    v_exp_f32 v202, v202
    v_exp_f32 v203, v203
    v_exp_f32 v204, v204
    v_exp_f32 v205, v205
    v_exp_f32 v206, v206
    global_load_dwordx4 v[66:69], v30, s[56:57] offset:-2048 sc1
    v_exp_f32 v207, v207
    v_exp_f32 v208, v208
    v_exp_f32 v209, v209
    v_pk_add_f32 v[178:179], v[178:179], 1.0 op_sel:[0,0] op_sel_hi:[1,0]
    v_pk_add_f32 v[180:181], v[180:181], 1.0 op_sel:[0,0] op_sel_hi:[1,0]
    v_pk_add_f32 v[182:183], v[182:183], 1.0 op_sel:[0,0] op_sel_hi:[1,0]
    global_load_dwordx4 v[70:73], v30, s[56:57] offset:-1024 sc1
    v_pk_add_f32 v[184:185], v[184:185], 1.0 op_sel:[0,0] op_sel_hi:[1,0]
    v_pk_add_f32 v[186:187], v[186:187], 1.0 op_sel:[0,0] op_sel_hi:[1,0]
    v_pk_add_f32 v[188:189], v[188:189], 1.0 op_sel:[0,0] op_sel_hi:[1,0]
    v_pk_add_f32 v[190:191], v[190:191], 1.0 op_sel:[0,0] op_sel_hi:[1,0]
    v_pk_add_f32 v[192:193], v[192:193], 1.0 op_sel:[0,0] op_sel_hi:[1,0]
    v_pk_add_f32 v[194:195], v[194:195], 1.0 op_sel:[0,0] op_sel_hi:[1,0]
    global_load_dwordx4 v[74:77], v30, s[56:57] offset:0 sc1
    v_pk_add_f32 v[196:197], v[196:197], 1.0 op_sel:[0,0] op_sel_hi:[1,0]
    v_pk_add_f32 v[198:199], v[198:199], 1.0 op_sel:[0,0] op_sel_hi:[1,0]
    v_pk_add_f32 v[200:201], v[200:201], 1.0 op_sel:[0,0] op_sel_hi:[1,0]
    v_pk_add_f32 v[202:203], v[202:203], 1.0 op_sel:[0,0] op_sel_hi:[1,0]
    v_pk_add_f32 v[204:205], v[204:205], 1.0 op_sel:[0,0] op_sel_hi:[1,0]
    v_pk_add_f32 v[206:207], v[206:207], 1.0 op_sel:[0,0] op_sel_hi:[1,0]
    global_load_dwordx4 v[78:81], v30, s[56:57] offset:1024 sc1
    v_pk_add_f32 v[208:209], v[208:209], 1.0 op_sel:[0,0] op_sel_hi:[1,0]
    v_rcp_f32 v178, v178
    v_rcp_f32 v179, v179
    v_rcp_f32 v180, v180
    v_rcp_f32 v181, v181
    v_rcp_f32 v182, v182
    global_load_dwordx4 v[82:85], v30, s[56:57] offset:2048 sc1
    v_rcp_f32 v183, v183
    v_rcp_f32 v184, v184
    v_rcp_f32 v185, v185
    v_rcp_f32 v186, v186
    v_rcp_f32 v187, v187
    v_rcp_f32 v188, v188
    global_load_dwordx4 v[86:89], v30, s[56:57] offset:3072 sc1
    v_rcp_f32 v189, v189
    v_rcp_f32 v190, v190
    v_rcp_f32 v191, v191
    v_rcp_f32 v192, v192
    v_rcp_f32 v193, v193
    v_rcp_f32 v194, v194
    global_load_dwordx4 v[90:93], v31, s[56:57] offset:-3072 sc1
    v_rcp_f32 v195, v195
    v_rcp_f32 v196, v196
    v_rcp_f32 v197, v197
    v_rcp_f32 v198, v198
    v_rcp_f32 v199, v199
    v_rcp_f32 v200, v200
    global_load_dwordx4 v[94:97], v31, s[56:57] offset:-2048 sc1
    v_rcp_f32 v201, v201
    v_rcp_f32 v202, v202
    v_rcp_f32 v203, v203
    v_rcp_f32 v204, v204
    v_rcp_f32 v205, v205
    v_rcp_f32 v206, v206
    global_load_dwordx4 v[98:101], v31, s[56:57] offset:-1024 sc1
    v_rcp_f32 v207, v207
    v_rcp_f32 v208, v208
    v_rcp_f32 v209, v209
    v_pk_mul_f32 v[210:211], v[210:211], v[178:179] op_sel:[0,0] op_sel_hi:[1,1]
    v_pk_mul_f32 v[212:213], v[212:213], v[180:181] op_sel:[0,0] op_sel_hi:[1,1]
    v_pk_mul_f32 v[214:215], v[214:215], v[182:183] op_sel:[0,0] op_sel_hi:[1,1]
    global_load_dwordx4 v[102:105], v31, s[56:57] offset:0 sc1
    v_pk_mul_f32 v[216:217], v[216:217], v[184:185] op_sel:[0,0] op_sel_hi:[1,1]
    v_pk_mul_f32 v[218:219], v[218:219], v[186:187] op_sel:[0,0] op_sel_hi:[1,1]
    v_pk_mul_f32 v[220:221], v[220:221], v[188:189] op_sel:[0,0] op_sel_hi:[1,1]
    v_pk_mul_f32 v[222:223], v[222:223], v[190:191] op_sel:[0,0] op_sel_hi:[1,1]
    v_pk_mul_f32 v[224:225], v[224:225], v[192:193] op_sel:[0,0] op_sel_hi:[1,1]
    v_pk_mul_f32 v[226:227], v[226:227], v[194:195] op_sel:[0,0] op_sel_hi:[1,1]
    global_load_dwordx4 v[106:109], v31, s[56:57] offset:1024 sc1
    v_pk_mul_f32 v[228:229], v[228:229], v[196:197] op_sel:[0,0] op_sel_hi:[1,1]
    v_pk_mul_f32 v[230:231], v[230:231], v[198:199] op_sel:[0,0] op_sel_hi:[1,1]
    v_pk_mul_f32 v[232:233], v[232:233], v[200:201] op_sel:[0,0] op_sel_hi:[1,1]
    v_pk_mul_f32 v[234:235], v[234:235], v[202:203] op_sel:[0,0] op_sel_hi:[1,1]
    v_pk_mul_f32 v[236:237], v[236:237], v[204:205] op_sel:[0,0] op_sel_hi:[1,1]
    v_pk_mul_f32 v[238:239], v[238:239], v[206:207] op_sel:[0,0] op_sel_hi:[1,1]
    global_load_dwordx4 v[110:113], v31, s[56:57] offset:2048 sc1
    v_pk_mul_f32 v[240:241], v[240:241], v[208:209] op_sel:[0,0] op_sel_hi:[1,1]
    v_cvt_pk_bf16_f32 v178, v210, v211
    v_cvt_pk_bf16_f32 v179, v212, v213
    v_cvt_pk_bf16_f32 v180, v214, v215
    v_cvt_pk_bf16_f32 v181, v216, v217
    v_cvt_pk_bf16_f32 v182, v218, v219
    global_load_dwordx4 v[114:117], v31, s[56:57] offset:3072 sc1
    v_cvt_pk_bf16_f32 v183, v220, v221
    v_cvt_pk_bf16_f32 v184, v222, v223
    v_cvt_pk_bf16_f32 v185, v224, v225
    v_cvt_pk_bf16_f32 v186, v226, v227
    v_cvt_pk_bf16_f32 v187, v228, v229
    v_cvt_pk_bf16_f32 v188, v230, v231
    global_load_dwordx4 v[118:121], v30, s[58:59] offset:-3072 sc1
    v_cvt_pk_bf16_f32 v189, v232, v233
    v_cvt_pk_bf16_f32 v190, v234, v235
    v_cvt_pk_bf16_f32 v191, v236, v237
    v_cvt_pk_bf16_f32 v192, v238, v239
    v_cvt_pk_bf16_f32 v193, v240, v241
    ds_write_b64 v170, v[178:179] offset:0
    global_load_dwordx4 v[122:125], v30, s[58:59] offset:-2048 sc1
    ds_write_b64 v170, v[180:181] offset:4096
    ds_write_b64 v170, v[182:183] offset:8192
    ds_write_b64 v170, v[184:185] offset:12288
    ds_write_b64 v170, v[186:187] offset:512
    ds_write_b64 v170, v[188:189] offset:4608
    ds_write_b64 v170, v[190:191] offset:8704
    ds_write_b64 v170, v[192:193] offset:12800
    s_waitcnt lgkmcnt(0)
    s_barrier
    ds_read_b64 v[48:49], v171 offset:0
    ds_read_b64 v[50:51], v171 offset:512
    ds_read_b64 v[52:53], v171 offset:1024
    ds_read_b64 v[54:55], v171 offset:1536
    ds_read_b64 v[56:57], v171 offset:2048
    ds_read_b64 v[58:59], v171 offset:2560
    ds_read_b64 v[60:61], v171 offset:3072
Lmid:
    s_waitcnt vmcnt(14)
    v_bitop3_b32 v28, v46, v65, v69 bitop3:0x80
    s_waitcnt vmcnt(12)
    v_bitop3_b32 v28, v73, v77, v28 bitop3:0x80
    v_and_b32 v28, 1, v28
    v_cmp_ne_u32 vcc, 1, v28
    s_nop 0
    s_cbranch_vccnz Lz0_r
Lz0_ok:
    v_mfma_f32_16x16x32_bf16 v[142:145], v[62:65], a[160:163], v[32:35]
    global_load_dwordx4 v[126:129], v30, s[58:59] offset:-1024 sc1
    v_mfma_f32_16x16x32_bf16 v[146:149], v[62:65], a[164:167], 0
    v_mfma_f32_16x16x32_bf16 v[150:153], v[62:65], a[168:171], 0
    v_mfma_f32_16x16x32_bf16 v[154:157], v[62:65], a[172:175], 0
    v_mfma_f32_16x16x32_bf16 v[158:161], v[66:69], a[160:163], v[32:35]
    global_load_dwordx4 v[130:133], v30, s[58:59] offset:0 sc1
    v_mfma_f32_16x16x32_bf16 v[162:165], v[66:69], a[164:167], 0
    v_mfma_f32_16x16x32_bf16 v[166:169], v[66:69], a[168:171], 0
    v_mfma_f32_16x16x32_bf16 v[170:173], v[66:69], a[172:175], 0
    v_mfma_f32_16x16x32_bf16 v[174:177], v[70:73], a[160:163], v[32:35]
    global_load_dwordx4 v[134:137], v30, s[58:59] offset:1024 sc1
    v_mfma_f32_16x16x32_bf16 v[178:181], v[70:73], a[164:167], 0
    v_mfma_f32_16x16x32_bf16 v[182:185], v[70:73], a[168:171], 0
    s_waitcnt vmcnt(13)
    v_and_b32 v28, v81, v85
    v_mfma_f32_16x16x32_bf16 v[186:189], v[70:73], a[172:175], 0
    s_waitcnt vmcnt(11)
    v_bitop3_b32 v28, v89, v93, v28 bitop3:0x80
    v_mfma_f32_16x16x32_bf16 v[190:193], v[74:77], a[160:163], v[32:35]
    v_and_b32 v28, 1, v28
    global_load_dwordx4 v[138:141], v30, s[58:59] offset:2048 sc1
    v_mfma_f32_16x16x32_bf16 v[194:197], v[74:77], a[164:167], 0
    v_cmp_ne_u32 vcc, 1, v28
    v_mfma_f32_16x16x32_bf16 v[198:201], v[74:77], a[168:171], 0
    v_mfma_f32_16x16x32_bf16 v[202:205], v[74:77], a[172:175], 0
    s_cbranch_vccnz Lz1_r
Lz1_ok:
    v_mfma_f32_16x16x32_bf16 v[206:209], v[78:81], a[160:163], v[32:35]
    global_load_dwordx4 v[62:65], v30, s[58:59] offset:3072 sc1
    s_xor_b32 s4, s3, 1
    s_mul_i32 s4, s4, 3072
    v_mfma_f32_16x16x32_bf16 v[210:213], v[78:81], a[164:167], 0
    s_add_u32 s4, s4, 138240
    v_add_u32 v20, s4, v4
    s_xor_b32 s4, s3, 2
    v_mfma_f32_16x16x32_bf16 v[214:217], v[78:81], a[168:171], 0
    s_mul_i32 s4, s4, 3072
    s_add_u32 s4, s4, 139264
    v_add_u32 v21, s4, v4
    v_mfma_f32_16x16x32_bf16 v[218:221], v[78:81], a[172:175], 0
    s_xor_b32 s4, s3, 3
    s_mul_i32 s4, s4, 3072
    v_mfma_f32_16x16x32_bf16 v[222:225], v[82:85], a[160:163], v[32:35]
    global_load_dwordx4 v[66:69], v31, s[58:59] offset:-3072 sc1
    s_add_u32 s4, s4, 140288
    v_add_u32 v22, s4, v4
    v_mfma_f32_16x16x32_bf16 v[226:229], v[82:85], a[164:167], 0
    s_mul_i32 s4, s3, 3072
    s_add_u32 s4, s4, 138240
    v_add_u32 v23, s4, v4
    v_mfma_f32_16x16x32_bf16 v[230:233], v[82:85], a[168:171], 0
    s_mul_i32 s4, s40, 114688
    s_add_u32 s4, s4, 1052672
    v_mfma_f32_16x16x32_bf16 v[234:237], v[82:85], a[172:175], 0
    s_lshl_b32 s5, s3, 13
    s_add_u32 s5, s5, s4
    v_mfma_f32_16x16x32_bf16 v[238:241], v[86:89], a[160:163], v[32:35]
    global_load_dwordx4 v[70:73], v31, s[58:59] offset:-2048 sc1
    v_add_u32 v6, s5, v4
    v_mfma_f32_16x16x32_bf16 v[242:245], v[86:89], a[164:167], 0
    v_add_u32 v7, 32768, v6
    v_add_u32 v26, 65536, v6
    s_lshl_b32 s5, s3, 12
    v_mfma_f32_16x16x32_bf16 v[246:249], v[86:89], a[168:171], 0
    s_waitcnt vmcnt(13)
    v_and_b32 v28, v97, v101
    s_add_u32 s5, s5, s4
    s_add_u32 s5, s5, 98304
    v_mfma_f32_16x16x32_bf16 v[250:253], v[86:89], a[172:175], 0
    s_waitcnt vmcnt(11)
    v_bitop3_b32 v28, v105, v109, v28 bitop3:0x80
    v_add_u32 v27, s5, v4
    s_lshl_b32 s4, s41, 10
    v_mfma_f32_16x16x32_bf16 v[142:145], v[90:93], a[176:179], v[142:145]
    s_add_u32 s8, s38, s4
    s_addc_u32 s9, s39, 0
    v_and_b32 v28, 1, v28
    v_mfma_f32_16x16x32_bf16 v[146:149], v[90:93], a[180:183], v[146:149]
    global_load_dwordx4 v[74:77], v31, s[58:59] offset:-1024 sc1
    s_lshr_b32 s4, s41, 1
    s_lshl_b32 s4, s4, 10
    s_and_b32 s5, s41, 1
    v_mfma_f32_16x16x32_bf16 v[150:153], v[90:93], a[184:187], v[150:153]
    v_cmp_ne_u32 vcc, 1, v28
    s_lshl_b32 s5, s5, 3
    s_add_u32 s4, s4, s5
    s_add_u32 s10, s38, s4
    s_addc_u32 s11, s39, 0
    v_mfma_f32_16x16x32_bf16 v[154:157], v[90:93], a[188:191], v[154:157]
    s_waitcnt lgkmcnt(0)
    s_barrier
    s_cbranch_vccnz Lz2_r
Lz2_ok:
    v_mfma_f32_16x16x32_bf16 v[158:161], v[94:97], a[176:179], v[158:161]
    global_load_dwordx4 v[78:81], v31, s[58:59] offset:0 sc1
    v_mfma_f32_16x16x32_bf16 v[162:165], v[94:97], a[180:183], v[162:165]
    v_mfma_f32_16x16x32_bf16 v[166:169], v[94:97], a[184:187], v[166:169]
    v_mfma_f32_16x16x32_bf16 v[170:173], v[94:97], a[188:191], v[170:173]
    v_mfma_f32_16x16x32_bf16 v[174:177], v[98:101], a[176:179], v[174:177]
    global_load_dwordx4 v[82:85], v31, s[58:59] offset:1024 sc1
    v_mfma_f32_16x16x32_bf16 v[178:181], v[98:101], a[180:183], v[178:181]
    v_mfma_f32_16x16x32_bf16 v[182:185], v[98:101], a[184:187], v[182:185]
    v_mfma_f32_16x16x32_bf16 v[186:189], v[98:101], a[188:191], v[186:189]
    v_mfma_f32_16x16x32_bf16 v[190:193], v[102:105], a[176:179], v[190:193]
    global_load_dwordx4 v[86:89], v31, s[58:59] offset:2048 sc1
    v_mfma_f32_16x16x32_bf16 v[194:197], v[102:105], a[180:183], v[194:197]
    v_mfma_f32_16x16x32_bf16 v[198:201], v[102:105], a[184:187], v[198:201]
    s_waitcnt vmcnt(13)
    v_and_b32 v28, v113, v117
    v_mfma_f32_16x16x32_bf16 v[202:205], v[102:105], a[188:191], v[202:205]
    s_waitcnt vmcnt(11)
    v_bitop3_b32 v28, v121, v125, v28 bitop3:0x80
    v_mfma_f32_16x16x32_bf16 v[206:209], v[106:109], a[176:179], v[206:209]
    v_and_b32 v28, 1, v28
    global_load_dwordx4 v[90:93], v31, s[58:59] offset:3072 sc1
    v_mfma_f32_16x16x32_bf16 v[210:213], v[106:109], a[180:183], v[210:213]
    v_cmp_ne_u32 vcc, 1, v28
    v_mfma_f32_16x16x32_bf16 v[214:217], v[106:109], a[184:187], v[214:217]
    v_mfma_f32_16x16x32_bf16 v[218:221], v[106:109], a[188:191], v[218:221]
    s_cbranch_vccnz Lz3_r
Lz3_ok:
    v_mfma_f32_16x16x32_bf16 v[222:225], v[110:113], a[176:179], v[222:225]
    global_load_dwordx4 v[94:97], v30, s[60:61] offset:-3072 sc1
    v_mfma_f32_16x16x32_bf16 v[226:229], v[110:113], a[180:183], v[226:229]
    v_mfma_f32_16x16x32_bf16 v[230:233], v[110:113], a[184:187], v[230:233]
    v_mfma_f32_16x16x32_bf16 v[234:237], v[110:113], a[188:191], v[234:237]
    v_mfma_f32_16x16x32_bf16 v[238:241], v[114:117], a[176:179], v[238:241]
    global_load_dwordx4 v[98:101], v31, s[60:61] offset:-3072 sc1
    v_mfma_f32_16x16x32_bf16 v[242:245], v[114:117], a[180:183], v[242:245]
    v_mfma_f32_16x16x32_bf16 v[246:249], v[114:117], a[184:187], v[246:249]
    v_mfma_f32_16x16x32_bf16 v[250:253], v[114:117], a[188:191], v[250:253]
    v_mfma_f32_16x16x32_bf16 v[142:145], v[118:121], a[0:3], v[142:145]
    global_load_dwordx4 v[102:105], v30, s[62:63] offset:-3072 sc1
    v_mfma_f32_16x16x32_bf16 v[146:149], v[118:121], a[4:7], v[146:149]
    v_mfma_f32_16x16x32_bf16 v[150:153], v[118:121], a[8:11], v[150:153]
    s_waitcnt vmcnt(13)
    v_and_b32 v28, v129, v133
    v_mfma_f32_16x16x32_bf16 v[154:157], v[118:121], a[12:15], v[154:157]
    s_waitcnt vmcnt(11)
    v_bitop3_b32 v28, v137, v141, v28 bitop3:0x80
    v_mfma_f32_16x16x32_bf16 v[158:161], v[122:125], a[0:3], v[158:161]
    v_and_b32 v28, 1, v28
    global_load_dwordx4 v[106:109], v31, s[62:63] offset:-3072 sc1
    v_mfma_f32_16x16x32_bf16 v[162:165], v[122:125], a[4:7], v[162:165]
    v_cmp_ne_u32 vcc, 1, v28
    v_mfma_f32_16x16x32_bf16 v[166:169], v[122:125], a[8:11], v[166:169]
    v_mfma_f32_16x16x32_bf16 v[170:173], v[122:125], a[12:15], v[170:173]
    s_cbranch_vccnz Lz4_r
Lz4_ok:
    v_mfma_f32_16x16x32_bf16 v[174:177], v[126:129], a[0:3], v[174:177]
    global_load_dwordx4 v[110:113], v30, s[52:53] offset:-3072 sc1
    v_mfma_f32_16x16x32_bf16 v[178:181], v[126:129], a[4:7], v[178:181]
    v_mfma_f32_16x16x32_bf16 v[182:185], v[126:129], a[8:11], v[182:185]
    v_mfma_f32_16x16x32_bf16 v[186:189], v[126:129], a[12:15], v[186:189]
    v_mfma_f32_16x16x32_bf16 v[190:193], v[130:133], a[0:3], v[190:193]
    global_load_dwordx4 v[114:117], v31, s[52:53] offset:-3072 sc1
    v_mfma_f32_16x16x32_bf16 v[194:197], v[130:133], a[4:7], v[194:197]
    v_mfma_f32_16x16x32_bf16 v[198:201], v[130:133], a[8:11], v[198:201]
    v_mfma_f32_16x16x32_bf16 v[202:205], v[130:133], a[12:15], v[202:205]
    v_mfma_f32_16x16x32_bf16 v[206:209], v[134:137], a[0:3], v[206:209]
    global_load_dwordx4 v[118:121], v30, s[54:55] offset:-3072 sc1
    v_mfma_f32_16x16x32_bf16 v[210:213], v[134:137], a[4:7], v[210:213]
    v_mfma_f32_16x16x32_bf16 v[214:217], v[134:137], a[8:11], v[214:217]
    s_waitcnt vmcnt(13)
    v_and_b32 v28, v65, v69
    v_mfma_f32_16x16x32_bf16 v[218:221], v[134:137], a[12:15], v[218:221]
    s_waitcnt vmcnt(11)
    v_bitop3_b32 v28, v73, v77, v28 bitop3:0x80
    v_mfma_f32_16x16x32_bf16 v[222:225], v[138:141], a[0:3], v[222:225]
    v_and_b32 v28, 1, v28
    global_load_dwordx4 v[122:125], v31, s[54:55] offset:-3072 sc1
    v_mfma_f32_16x16x32_bf16 v[226:229], v[138:141], a[4:7], v[226:229]
    v_cmp_ne_u32 vcc, 1, v28
    v_mfma_f32_16x16x32_bf16 v[230:233], v[138:141], a[8:11], v[230:233]
    v_mfma_f32_16x16x32_bf16 v[234:237], v[138:141], a[12:15], v[234:237]
    s_cbranch_vccnz Lz5_r
Lz5_ok:
    v_mfma_f32_16x16x32_bf16 v[238:241], v[62:65], a[0:3], v[238:241]
    global_load_dwordx4 v[126:129], v30, s[64:65] offset:-3072 sc1
    v_mfma_f32_16x16x32_bf16 v[242:245], v[62:65], a[4:7], v[242:245]
    v_mfma_f32_16x16x32_bf16 v[246:249], v[62:65], a[8:11], v[246:249]
    v_mfma_f32_16x16x32_bf16 v[250:253], v[62:65], a[12:15], v[250:253]
    v_mfma_f32_16x16x32_bf16 v[142:145], v[66:69], a[16:19], v[142:145]
    global_load_dwordx4 v[130:133], v31, s[64:65] offset:-3072 sc1
    v_mfma_f32_16x16x32_bf16 v[146:149], v[66:69], a[20:23], v[146:149]
    v_mfma_f32_16x16x32_bf16 v[150:153], v[66:69], a[24:27], v[150:153]
    v_mfma_f32_16x16x32_bf16 v[154:157], v[66:69], a[28:31], v[154:157]
    v_mfma_f32_16x16x32_bf16 v[158:161], v[70:73], a[16:19], v[158:161]
    global_load_dwordx4 v[134:137], v30, s[66:67] offset:-3072 sc1
    v_mfma_f32_16x16x32_bf16 v[162:165], v[70:73], a[20:23], v[162:165]
    v_mfma_f32_16x16x32_bf16 v[166:169], v[70:73], a[24:27], v[166:169]
    s_waitcnt vmcnt(13)
    v_and_b32 v28, v81, v85
    v_mfma_f32_16x16x32_bf16 v[170:173], v[70:73], a[28:31], v[170:173]
    s_waitcnt vmcnt(11)
    v_bitop3_b32 v28, v89, v93, v28 bitop3:0x80
    v_mfma_f32_16x16x32_bf16 v[174:177], v[74:77], a[16:19], v[174:177]
    v_and_b32 v28, 1, v28
    global_load_dwordx4 v[138:141], v31, s[66:67] offset:-3072 sc1
    v_mfma_f32_16x16x32_bf16 v[178:181], v[74:77], a[20:23], v[178:181]
    v_cmp_ne_u32 vcc, 1, v28
    v_mfma_f32_16x16x32_bf16 v[182:185], v[74:77], a[24:27], v[182:185]
    v_mfma_f32_16x16x32_bf16 v[186:189], v[74:77], a[28:31], v[186:189]
    s_cbranch_vccnz Lz6_r
Lz6_ok:
    v_mfma_f32_16x16x32_bf16 v[190:193], v[78:81], a[16:19], v[190:193]
    global_load_dwordx4 v[62:65], v30, s[60:61] offset:-2048 sc1
    v_mfma_f32_16x16x32_bf16 v[194:197], v[78:81], a[20:23], v[194:197]
    v_mfma_f32_16x16x32_bf16 v[198:201], v[78:81], a[24:27], v[198:201]
    v_mfma_f32_16x16x32_bf16 v[202:205], v[78:81], a[28:31], v[202:205]
    v_mfma_f32_16x16x32_bf16 v[206:209], v[82:85], a[16:19], v[206:209]
    global_load_dwordx4 v[66:69], v31, s[60:61] offset:-2048 sc1
    v_mfma_f32_16x16x32_bf16 v[210:213], v[82:85], a[20:23], v[210:213]
    v_mfma_f32_16x16x32_bf16 v[214:217], v[82:85], a[24:27], v[214:217]
    v_mfma_f32_16x16x32_bf16 v[218:221], v[82:85], a[28:31], v[218:221]
    v_mfma_f32_16x16x32_bf16 v[222:225], v[86:89], a[16:19], v[222:225]
    global_load_dwordx4 v[70:73], v30, s[62:63] offset:-2048 sc1
    v_mfma_f32_16x16x32_bf16 v[226:229], v[86:89], a[20:23], v[226:229]
    v_mfma_f32_16x16x32_bf16 v[230:233], v[86:89], a[24:27], v[230:233]
    s_waitcnt vmcnt(13)
    v_and_b32 v28, v97, v101
    v_mfma_f32_16x16x32_bf16 v[234:237], v[86:89], a[28:31], v[234:237]
    s_waitcnt vmcnt(11)
    v_bitop3_b32 v28, v105, v109, v28 bitop3:0x80
    v_mfma_f32_16x16x32_bf16 v[238:241], v[90:93], a[16:19], v[238:241]
    v_and_b32 v28, 1, v28
    global_load_dwordx4 v[74:77], v31, s[62:63] offset:-2048 sc1
    v_mfma_f32_16x16x32_bf16 v[242:245], v[90:93], a[20:23], v[242:245]
    v_cmp_ne_u32 vcc, 1, v28
    v_mfma_f32_16x16x32_bf16 v[246:249], v[90:93], a[24:27], v[246:249]
    v_mfma_f32_16x16x32_bf16 v[250:253], v[90:93], a[28:31], v[250:253]
    s_cbranch_vccnz Lz7_r
Lz7_ok:
    v_mfma_f32_16x16x32_bf16 v[142:145], v[94:97], a[32:35], v[142:145]
    global_load_dwordx4 v[78:81], v30, s[52:53] offset:-2048 sc1
    v_mfma_f32_16x16x32_bf16 v[146:149], v[94:97], a[36:39], v[146:149]
    v_mfma_f32_16x16x32_bf16 v[150:153], v[94:97], a[40:43], v[150:153]
    v_mfma_f32_16x16x32_bf16 v[154:157], v[94:97], a[44:47], v[154:157]
    v_mfma_f32_16x16x32_bf16 v[142:145], v[98:101], a[48:51], v[142:145]
    global_load_dwordx4 v[82:85], v31, s[52:53] offset:-2048 sc1
    v_mfma_f32_16x16x32_bf16 v[146:149], v[98:101], a[52:55], v[146:149]
    v_mfma_f32_16x16x32_bf16 v[150:153], v[98:101], a[56:59], v[150:153]
    v_mfma_f32_16x16x32_bf16 v[154:157], v[98:101], a[60:63], v[154:157]
    v_mfma_f32_16x16x32_bf16 v[142:145], v[102:105], a[64:67], v[142:145]
    global_load_dwordx4 v[86:89], v30, s[54:55] offset:-2048 sc1
    v_mfma_f32_16x16x32_bf16 v[146:149], v[102:105], a[68:71], v[146:149]
    v_mfma_f32_16x16x32_bf16 v[150:153], v[102:105], a[72:75], v[150:153]
    s_waitcnt vmcnt(13)
    v_and_b32 v28, v113, v117
    v_mfma_f32_16x16x32_bf16 v[154:157], v[102:105], a[76:79], v[154:157]
    s_waitcnt vmcnt(11)
    v_bitop3_b32 v28, v121, v125, v28 bitop3:0x80
    v_mfma_f32_16x16x32_bf16 v[142:145], v[106:109], a[80:83], v[142:145]
    v_and_b32 v28, 1, v28
    global_load_dwordx4 v[90:93], v31, s[54:55] offset:-2048 sc1
    v_mfma_f32_16x16x32_bf16 v[146:149], v[106:109], a[84:87], v[146:149]
    v_cmp_ne_u32 vcc, 1, v28
    v_mfma_f32_16x16x32_bf16 v[150:153], v[106:109], a[88:91], v[150:153]
    v_mfma_f32_16x16x32_bf16 v[154:157], v[106:109], a[92:95], v[154:157]
    s_cbranch_vccnz Lz8_r
Lz8_ok:
    v_mfma_f32_16x16x32_bf16 v[142:145], v[110:113], a[224:227], v[142:145]
    global_load_dwordx4 v[94:97], v30, s[64:65] offset:-2048 sc1
    v_mfma_f32_16x16x32_bf16 v[146:149], v[110:113], a[228:231], v[146:149]
    v_mfma_f32_16x16x32_bf16 v[150:153], v[110:113], a[232:235], v[150:153]
    v_mfma_f32_16x16x32_bf16 v[154:157], v[110:113], a[236:239], v[154:157]
    v_mfma_f32_16x16x32_bf16 v[142:145], v[114:117], a[240:243], v[142:145]
    global_load_dwordx4 v[98:101], v31, s[64:65] offset:-2048 sc1
    v_mfma_f32_16x16x32_bf16 v[146:149], v[114:117], a[244:247], v[146:149]
    v_mfma_f32_16x16x32_bf16 v[150:153], v[114:117], a[248:251], v[150:153]
    v_mfma_f32_16x16x32_bf16 v[154:157], v[114:117], a[252:255], v[154:157]
    v_mfma_f32_16x16x32_bf16 v[142:145], v[118:121], a[192:195], v[142:145]
    global_load_dwordx4 v[102:105], v30, s[66:67] offset:-2048 sc1
    v_mfma_f32_16x16x32_bf16 v[146:149], v[118:121], a[196:199], v[146:149]
    v_mfma_f32_16x16x32_bf16 v[150:153], v[118:121], a[200:203], v[150:153]
    s_waitcnt vmcnt(13)
    v_and_b32 v28, v129, v133
    v_mfma_f32_16x16x32_bf16 v[154:157], v[118:121], a[204:207], v[154:157]
    s_waitcnt vmcnt(11)
    v_bitop3_b32 v28, v137, v141, v28 bitop3:0x80
    v_mfma_f32_16x16x32_bf16 v[142:145], v[122:125], a[208:211], v[142:145]
    v_and_b32 v28, 1, v28
    global_load_dwordx4 v[106:109], v31, s[66:67] offset:-2048 sc1
    v_mfma_f32_16x16x32_bf16 v[146:149], v[122:125], a[212:215], v[146:149]
    v_cmp_ne_u32 vcc, 1, v28
    v_mfma_f32_16x16x32_bf16 v[150:153], v[122:125], a[216:219], v[150:153]
    v_mfma_f32_16x16x32_bf16 v[154:157], v[122:125], a[220:223], v[154:157]
    s_cbranch_vccnz Lz9_r
Lz9_ok:
    v_mfma_f32_16x16x32_bf16 v[142:145], v[126:129], a[96:99], v[142:145]
    global_load_dwordx4 v[110:113], v30, s[60:61] offset:-1024 sc1
    v_mfma_f32_16x16x32_bf16 v[146:149], v[126:129], a[100:103], v[146:149]
    v_mfma_f32_16x16x32_bf16 v[150:153], v[126:129], a[104:107], v[150:153]
    v_mfma_f32_16x16x32_bf16 v[154:157], v[126:129], a[108:111], v[154:157]
    v_mfma_f32_16x16x32_bf16 v[142:145], v[130:133], a[112:115], v[142:145]
    global_load_dwordx4 v[114:117], v31, s[60:61] offset:-1024 sc1
    v_mfma_f32_16x16x32_bf16 v[146:149], v[130:133], a[116:119], v[146:149]
    v_mfma_f32_16x16x32_bf16 v[150:153], v[130:133], a[120:123], v[150:153]
    v_mfma_f32_16x16x32_bf16 v[154:157], v[130:133], a[124:127], v[154:157]
    v_mfma_f32_16x16x32_bf16 v[142:145], v[134:137], a[128:131], v[142:145]
    global_load_dwordx4 v[118:121], v30, s[62:63] offset:-1024 sc1
    v_mfma_f32_16x16x32_bf16 v[146:149], v[134:137], a[132:135], v[146:149]
    v_mfma_f32_16x16x32_bf16 v[150:153], v[134:137], a[136:139], v[150:153]
    s_waitcnt vmcnt(13)
    v_and_b32 v28, v65, v69
    v_mfma_f32_16x16x32_bf16 v[154:157], v[134:137], a[140:143], v[154:157]
    s_waitcnt vmcnt(11)
    v_bitop3_b32 v28, v73, v77, v28 bitop3:0x80
    v_mfma_f32_16x16x32_bf16 v[142:145], v[138:141], a[144:147], v[142:145]
    v_and_b32 v28, 1, v28
    global_load_dwordx4 v[122:125], v31, s[62:63] offset:-1024 sc1
    v_mfma_f32_16x16x32_bf16 v[146:149], v[138:141], a[148:151], v[146:149]
    v_cmp_ne_u32 vcc, 1, v28
    v_mfma_f32_16x16x32_bf16 v[150:153], v[138:141], a[152:155], v[150:153]
    v_mfma_f32_16x16x32_bf16 v[154:157], v[138:141], a[156:159], v[154:157]
    s_cbranch_vccnz Lz10_r
Lz10_ok:
    v_mfma_f32_16x16x32_bf16 v[158:161], v[62:65], a[32:35], v[158:161]
    global_load_dwordx4 v[126:129], v30, s[52:53] offset:-1024 sc1
    v_mfma_f32_16x16x32_bf16 v[162:165], v[62:65], a[36:39], v[162:165]
    v_mfma_f32_16x16x32_bf16 v[166:169], v[62:65], a[40:43], v[166:169]
    v_mfma_f32_16x16x32_bf16 v[170:173], v[62:65], a[44:47], v[170:173]
    ds_write_b128 v20, v[146:149] offset:0
    v_mfma_f32_16x16x32_bf16 v[158:161], v[66:69], a[48:51], v[158:161]
    global_load_dwordx4 v[130:133], v31, s[52:53] offset:-1024 sc1
    v_mfma_f32_16x16x32_bf16 v[162:165], v[66:69], a[52:55], v[162:165]
    v_mfma_f32_16x16x32_bf16 v[166:169], v[66:69], a[56:59], v[166:169]
    ds_write_b128 v21, v[150:153] offset:0
    v_mfma_f32_16x16x32_bf16 v[170:173], v[66:69], a[60:63], v[170:173]
    v_mfma_f32_16x16x32_bf16 v[158:161], v[70:73], a[64:67], v[158:161]
    global_load_dwordx4 v[134:137], v30, s[54:55] offset:-1024 sc1
    v_mfma_f32_16x16x32_bf16 v[162:165], v[70:73], a[68:71], v[162:165]
    ds_write_b128 v22, v[154:157] offset:0
    v_mfma_f32_16x16x32_bf16 v[166:169], v[70:73], a[72:75], v[166:169]
    s_waitcnt vmcnt(13)
    v_and_b32 v28, v81, v85
    v_mfma_f32_16x16x32_bf16 v[170:173], v[70:73], a[76:79], v[170:173]
    s_waitcnt vmcnt(11)
    v_bitop3_b32 v28, v89, v93, v28 bitop3:0x80
    v_mfma_f32_16x16x32_bf16 v[158:161], v[74:77], a[80:83], v[158:161]
    v_and_b32 v28, 1, v28
    global_load_dwordx4 v[138:141], v31, s[54:55] offset:-1024 sc1
    v_mfma_f32_16x16x32_bf16 v[162:165], v[74:77], a[84:87], v[162:165]
    s_waitcnt lgkmcnt(0)
    s_barrier
    v_cmp_ne_u32 vcc, 1, v28
    v_mfma_f32_16x16x32_bf16 v[166:169], v[74:77], a[88:91], v[166:169]
    v_mfma_f32_16x16x32_bf16 v[170:173], v[74:77], a[92:95], v[170:173]
    s_cbranch_vccnz Lz11_r
Lz11_ok:
    v_mfma_f32_16x16x32_bf16 v[158:161], v[78:81], a[224:227], v[158:161]
    global_load_dwordx4 v[62:65], v30, s[64:65] offset:-1024 sc1
    ds_read_b128 v[146:149], v23 offset:0
    v_mfma_f32_16x16x32_bf16 v[162:165], v[78:81], a[228:231], v[162:165]
    ds_read_b128 v[150:153], v23 offset:1024
    v_mfma_f32_16x16x32_bf16 v[166:169], v[78:81], a[232:235], v[166:169]
    ds_read_b128 v[154:157], v23 offset:2048
    v_mfma_f32_16x16x32_bf16 v[170:173], v[78:81], a[236:239], v[170:173]
    v_lshlrev_b32 v12, 16, v48
    v_mfma_f32_16x16x32_bf16 v[158:161], v[82:85], a[240:243], v[158:161]
    global_load_dwordx4 v[66:69], v31, s[64:65] offset:-1024 sc1
    v_and_b32 v13, 0xffff0000, v48
    v_mfma_f32_16x16x32_bf16 v[162:165], v[82:85], a[244:247], v[162:165]
    v_mfma_f32_16x16x32_bf16 v[166:169], v[82:85], a[248:251], v[166:169]
    v_lshlrev_b32 v14, 16, v49
    v_mfma_f32_16x16x32_bf16 v[170:173], v[82:85], a[252:255], v[170:173]
    v_and_b32 v15, 0xffff0000, v49
    v_mfma_f32_16x16x32_bf16 v[158:161], v[86:89], a[192:195], v[158:161]
    global_load_dwordx4 v[70:73], v30, s[66:67] offset:-1024 sc1
    s_waitcnt lgkmcnt(2)
    v_add_f32 v142, v142, v146
    v_mfma_f32_16x16x32_bf16 v[162:165], v[86:89], a[196:199], v[162:165]
    v_add_f32 v143, v143, v147
    v_mfma_f32_16x16x32_bf16 v[166:169], v[86:89], a[200:203], v[166:169]
    s_waitcnt vmcnt(13)
    v_and_b32 v28, v97, v101
    v_mfma_f32_16x16x32_bf16 v[170:173], v[86:89], a[204:207], v[170:173]
    s_waitcnt vmcnt(11)
    v_bitop3_b32 v28, v105, v109, v28 bitop3:0x80
    v_add_f32 v144, v144, v148
    v_mfma_f32_16x16x32_bf16 v[158:161], v[90:93], a[208:211], v[158:161]
    v_and_b32 v28, 1, v28
    global_load_dwordx4 v[74:77], v31, s[66:67] offset:-1024 sc1
    v_mfma_f32_16x16x32_bf16 v[162:165], v[90:93], a[212:215], v[162:165]
    v_add_f32 v145, v145, v149
    v_cmp_ne_u32 vcc, 1, v28
    v_mfma_f32_16x16x32_bf16 v[166:169], v[90:93], a[216:219], v[166:169]
    s_waitcnt lgkmcnt(1)
    v_add_f32 v142, v142, v150
    v_add_f32 v143, v143, v151
    v_mfma_f32_16x16x32_bf16 v[170:173], v[90:93], a[220:223], v[170:173]
    s_cbranch_vccnz Lz12_r
Lz12_ok:
    v_mfma_f32_16x16x32_bf16 v[158:161], v[94:97], a[96:99], v[158:161]
    global_load_dwordx4 v[78:81], v30, s[60:61] offset:0 sc1
    v_add_f32 v144, v144, v152
    v_mfma_f32_16x16x32_bf16 v[162:165], v[94:97], a[100:103], v[162:165]
    v_add_f32 v145, v145, v153
    v_mfma_f32_16x16x32_bf16 v[166:169], v[94:97], a[104:107], v[166:169]
    s_waitcnt lgkmcnt(0)
    v_add_f32 v142, v142, v154
    v_mfma_f32_16x16x32_bf16 v[170:173], v[94:97], a[108:111], v[170:173]
    v_mfma_f32_16x16x32_bf16 v[158:161], v[98:101], a[112:115], v[158:161]
    global_load_dwordx4 v[82:85], v31, s[60:61] offset:0 sc1
    v_add_f32 v143, v143, v155
    v_mfma_f32_16x16x32_bf16 v[162:165], v[98:101], a[116:119], v[162:165]
    v_add_f32 v144, v144, v156
    v_mfma_f32_16x16x32_bf16 v[166:169], v[98:101], a[120:123], v[166:169]
    v_add_f32 v145, v145, v157
    v_mfma_f32_16x16x32_bf16 v[170:173], v[98:101], a[124:127], v[170:173]
    v_mfma_f32_16x16x32_bf16 v[158:161], v[102:105], a[128:131], v[158:161]
    global_load_dwordx4 v[86:89], v30, s[62:63] offset:0 sc1
    v_mul_f32 v142, v142, v12
    v_mfma_f32_16x16x32_bf16 v[162:165], v[102:105], a[132:135], v[162:165]
    v_mul_f32 v143, v143, v13
    v_mfma_f32_16x16x32_bf16 v[166:169], v[102:105], a[136:139], v[166:169]
    s_waitcnt vmcnt(13)
    v_and_b32 v28, v113, v117
    v_mul_f32 v144, v144, v14
    v_mfma_f32_16x16x32_bf16 v[170:173], v[102:105], a[140:143], v[170:173]
    s_waitcnt vmcnt(11)
    v_bitop3_b32 v28, v121, v125, v28 bitop3:0x80
    v_mfma_f32_16x16x32_bf16 v[158:161], v[106:109], a[144:147], v[158:161]
    v_and_b32 v28, 1, v28
    global_load_dwordx4 v[90:93], v31, s[62:63] offset:0 sc1
    v_mfma_f32_16x16x32_bf16 v[162:165], v[106:109], a[148:151], v[162:165]
    v_mul_f32 v145, v145, v15
    v_cmp_ne_u32 vcc, 1, v28
    v_mfma_f32_16x16x32_bf16 v[166:169], v[106:109], a[152:155], v[166:169]
    v_cvt_pk_bf16_f32 v48, v142, v143
    v_cvt_pk_bf16_f32 v49, v144, v145
    v_mfma_f32_16x16x32_bf16 v[170:173], v[106:109], a[156:159], v[170:173]
    s_cbranch_vccnz Lz13_r
Lz13_ok:
    v_mfma_f32_16x16x32_bf16 v[174:177], v[110:113], a[32:35], v[174:177]
    global_load_dwordx4 v[94:97], v30, s[52:53] offset:0 sc1
    v_mfma_f32_16x16x32_bf16 v[178:181], v[110:113], a[36:39], v[178:181]
    v_mfma_f32_16x16x32_bf16 v[182:185], v[110:113], a[40:43], v[182:185]
    v_mfma_f32_16x16x32_bf16 v[186:189], v[110:113], a[44:47], v[186:189]
    ds_write_b128 v20, v[162:165] offset:12288
    v_mfma_f32_16x16x32_bf16 v[174:177], v[114:117], a[48:51], v[174:177]
    global_load_dwordx4 v[98:101], v31, s[52:53] offset:0 sc1
    v_mfma_f32_16x16x32_bf16 v[178:181], v[114:117], a[52:55], v[178:181]
    v_mfma_f32_16x16x32_bf16 v[182:185], v[114:117], a[56:59], v[182:185]
    ds_write_b128 v21, v[166:169] offset:12288
    v_mfma_f32_16x16x32_bf16 v[186:189], v[114:117], a[60:63], v[186:189]
    v_mfma_f32_16x16x32_bf16 v[174:177], v[118:121], a[64:67], v[174:177]
    global_load_dwordx4 v[102:105], v30, s[54:55] offset:0 sc1
    v_mfma_f32_16x16x32_bf16 v[178:181], v[118:121], a[68:71], v[178:181]
    ds_write_b128 v22, v[170:173] offset:12288
    v_mfma_f32_16x16x32_bf16 v[182:185], v[118:121], a[72:75], v[182:185]
    s_waitcnt vmcnt(13)
    v_and_b32 v28, v129, v133
    v_mfma_f32_16x16x32_bf16 v[186:189], v[118:121], a[76:79], v[186:189]
    s_waitcnt vmcnt(11)
    v_bitop3_b32 v28, v137, v141, v28 bitop3:0x80
    v_mfma_f32_16x16x32_bf16 v[174:177], v[122:125], a[80:83], v[174:177]
    v_and_b32 v28, 1, v28
    global_load_dwordx4 v[106:109], v31, s[54:55] offset:0 sc1
    v_mfma_f32_16x16x32_bf16 v[178:181], v[122:125], a[84:87], v[178:181]
    s_waitcnt lgkmcnt(0)
    s_barrier
    v_cmp_ne_u32 vcc, 1, v28
    v_mfma_f32_16x16x32_bf16 v[182:185], v[122:125], a[88:91], v[182:185]
    v_mfma_f32_16x16x32_bf16 v[186:189], v[122:125], a[92:95], v[186:189]
    s_cbranch_vccnz Lz14_r
Lz14_ok:
    v_mfma_f32_16x16x32_bf16 v[174:177], v[126:129], a[224:227], v[174:177]
    global_load_dwordx4 v[110:113], v30, s[64:65] offset:0 sc1
    ds_read_b128 v[162:165], v23 offset:12288
    v_mfma_f32_16x16x32_bf16 v[178:181], v[126:129], a[228:231], v[178:181]
    ds_read_b128 v[166:169], v23 offset:13312
    v_mfma_f32_16x16x32_bf16 v[182:185], v[126:129], a[232:235], v[182:185]
    ds_read_b128 v[170:173], v23 offset:14336
    global_load_dwordx4 v[114:117], v31, s[64:65] offset:0 sc1
    v_mfma_f32_16x16x32_bf16 v[186:189], v[126:129], a[236:239], v[186:189]
    v_lshlrev_b32 v12, 16, v50
    v_mfma_f32_16x16x32_bf16 v[174:177], v[130:133], a[240:243], v[174:177]
    v_and_b32 v13, 0xffff0000, v50
    v_mfma_f32_16x16x32_bf16 v[178:181], v[130:133], a[244:247], v[178:181]
    global_load_dwordx4 v[118:121], v30, s[66:67] offset:0 sc1
    v_mfma_f32_16x16x32_bf16 v[182:185], v[130:133], a[248:251], v[182:185]
    v_lshlrev_b32 v14, 16, v51
    v_mfma_f32_16x16x32_bf16 v[186:189], v[130:133], a[252:255], v[186:189]
    v_and_b32 v15, 0xffff0000, v51
    v_mfma_f32_16x16x32_bf16 v[174:177], v[134:137], a[192:195], v[174:177]
    global_load_dwordx4 v[122:125], v31, s[66:67] offset:0 sc1
    s_waitcnt lgkmcnt(2)
    v_add_f32 v158, v158, v162
    v_mfma_f32_16x16x32_bf16 v[178:181], v[134:137], a[196:199], v[178:181]
    v_add_f32 v159, v159, v163
    v_mfma_f32_16x16x32_bf16 v[182:185], v[134:137], a[200:203], v[182:185]
    s_waitcnt vmcnt(14)
    v_and_b32 v28, v65, v69
    global_load_lds_dwordx4 v4, s[92:93] offset:2048 sc1
    v_mfma_f32_16x16x32_bf16 v[186:189], v[134:137], a[204:207], v[186:189]
    s_waitcnt vmcnt(13)
    v_bitop3_b32 v28, v73, v77, v28 bitop3:0x80
    v_add_f32 v160, v160, v164
    v_mfma_f32_16x16x32_bf16 v[174:177], v[138:141], a[208:211], v[174:177]
    v_and_b32 v28, 1, v28
    v_add_f32 v161, v161, v165
    v_mfma_f32_16x16x32_bf16 v[178:181], v[138:141], a[212:215], v[178:181]
    v_cmp_ne_u32 vcc, 1, v28
    global_load_lds_dwordx4 v4, s[92:93] offset:3072 sc1
    v_mfma_f32_16x16x32_bf16 v[182:185], v[138:141], a[216:219], v[182:185]
    s_waitcnt lgkmcnt(1)
    v_add_f32 v158, v158, v166
    v_add_f32 v159, v159, v167
    v_mfma_f32_16x16x32_bf16 v[186:189], v[138:141], a[220:223], v[186:189]
    s_cbranch_vccnz Lz15_r
Lz15_ok:
    v_mfma_f32_16x16x32_bf16 v[174:177], v[62:65], a[96:99], v[174:177]
    global_load_dwordx4 v[126:129], v30, s[60:61] offset:1024 sc1
    v_add_f32 v160, v160, v168
    v_mfma_f32_16x16x32_bf16 v[178:181], v[62:65], a[100:103], v[178:181]
    v_add_f32 v161, v161, v169
    global_load_dwordx4 v[130:133], v31, s[60:61] offset:1024 sc1
    v_mfma_f32_16x16x32_bf16 v[182:185], v[62:65], a[104:107], v[182:185]
    s_waitcnt lgkmcnt(0)
    v_add_f32 v158, v158, v170
    v_mfma_f32_16x16x32_bf16 v[186:189], v[62:65], a[108:111], v[186:189]
    global_load_dwordx4 v[134:137], v30, s[62:63] offset:1024 sc1
    v_add_f32 v159, v159, v171
    v_mfma_f32_16x16x32_bf16 v[174:177], v[66:69], a[112:115], v[174:177]
    v_add_f32 v160, v160, v172
    v_mfma_f32_16x16x32_bf16 v[178:181], v[66:69], a[116:119], v[178:181]
    global_load_dwordx4 v[138:141], v31, s[62:63] offset:1024 sc1
    v_mfma_f32_16x16x32_bf16 v[182:185], v[66:69], a[120:123], v[182:185]
    v_add_f32 v161, v161, v173
    v_mfma_f32_16x16x32_bf16 v[186:189], v[66:69], a[124:127], v[186:189]
    s_add_u32 m0, s95, 8192
    v_mul_f32 v158, v158, v12
    v_mfma_f32_16x16x32_bf16 v[174:177], v[70:73], a[128:131], v[174:177]
    v_mul_f32 v159, v159, v13
    s_add_u32 s92, s92, 4096
    s_addc_u32 s93, s93, 0
    v_mfma_f32_16x16x32_bf16 v[178:181], v[70:73], a[132:135], v[178:181]
    v_mul_f32 v160, v160, v14
    v_mfma_f32_16x16x32_bf16 v[182:185], v[70:73], a[136:139], v[182:185]
    s_waitcnt vmcnt(16)
    v_and_b32 v28, v81, v85
    v_mfma_f32_16x16x32_bf16 v[186:189], v[70:73], a[140:143], v[186:189]
    s_waitcnt vmcnt(14)
    v_bitop3_b32 v28, v89, v93, v28 bitop3:0x80
    v_mul_f32 v161, v161, v15
    v_mfma_f32_16x16x32_bf16 v[174:177], v[74:77], a[144:147], v[174:177]
    v_and_b32 v28, 1, v28
    v_cvt_pk_bf16_f32 v50, v158, v159
    v_mfma_f32_16x16x32_bf16 v[178:181], v[74:77], a[148:151], v[178:181]
    global_load_lds_dwordx4 v4, s[92:93] offset:0 sc1
    v_cmp_ne_u32 vcc, 1, v28
    v_mfma_f32_16x16x32_bf16 v[182:185], v[74:77], a[152:155], v[182:185]
    v_cvt_pk_bf16_f32 v51, v160, v161
    global_load_lds_dwordx4 v4, s[92:93] offset:1024 sc1
    v_mfma_f32_16x16x32_bf16 v[186:189], v[74:77], a[156:159], v[186:189]
    v_and_b32 v51, -2, v51
    s_cbranch_vccnz Lz16_r
Lz16_ok:
    v_mfma_f32_16x16x32_bf16 v[190:193], v[78:81], a[32:35], v[190:193]
    global_load_dwordx4 v[62:65], v30, s[52:53] offset:1024 sc1
    v_mfma_f32_16x16x32_bf16 v[194:197], v[78:81], a[36:39], v[194:197]
    v_mfma_f32_16x16x32_bf16 v[198:201], v[78:81], a[40:43], v[198:201]
    global_load_dwordx4 v[66:69], v31, s[52:53] offset:1024 sc1
    v_mfma_f32_16x16x32_bf16 v[202:205], v[78:81], a[44:47], v[202:205]
    ds_write_b128 v20, v[178:181] offset:0
    v_mfma_f32_16x16x32_bf16 v[190:193], v[82:85], a[48:51], v[190:193]
    v_mfma_f32_16x16x32_bf16 v[194:197], v[82:85], a[52:55], v[194:197]
    global_load_dwordx4 v[70:73], v30, s[54:55] offset:1024 sc1
    v_mfma_f32_16x16x32_bf16 v[198:201], v[82:85], a[56:59], v[198:201]
    ds_write_b128 v21, v[182:185] offset:0
    v_mfma_f32_16x16x32_bf16 v[202:205], v[82:85], a[60:63], v[202:205]
    v_mfma_f32_16x16x32_bf16 v[190:193], v[86:89], a[64:67], v[190:193]
    global_load_dwordx4 v[74:77], v31, s[54:55] offset:1024 sc1
    v_mfma_f32_16x16x32_bf16 v[194:197], v[86:89], a[68:71], v[194:197]
    ds_write_b128 v22, v[186:189] offset:0
    v_mfma_f32_16x16x32_bf16 v[198:201], v[86:89], a[72:75], v[198:201]
    s_waitcnt vmcnt(18)
    v_and_b32 v28, v97, v101
    global_load_lds_dwordx4 v4, s[92:93] offset:2048 sc1
    v_mfma_f32_16x16x32_bf16 v[202:205], v[86:89], a[76:79], v[202:205]
    s_waitcnt vmcnt(17)
    v_bitop3_b32 v28, v105, v109, v28 bitop3:0x80
    v_mfma_f32_16x16x32_bf16 v[190:193], v[90:93], a[80:83], v[190:193]
    v_and_b32 v28, 1, v28
    s_waitcnt lgkmcnt(0)
    s_barrier
    v_mfma_f32_16x16x32_bf16 v[194:197], v[90:93], a[84:87], v[194:197]
    v_cmp_ne_u32 vcc, 1, v28
    global_load_lds_dwordx4 v4, s[92:93] offset:3072 sc1
    v_mfma_f32_16x16x32_bf16 v[198:201], v[90:93], a[88:91], v[198:201]
    v_mfma_f32_16x16x32_bf16 v[202:205], v[90:93], a[92:95], v[202:205]
    s_cbranch_vccnz Lz17_r
Lz17_ok:
    v_mfma_f32_16x16x32_bf16 v[190:193], v[94:97], a[224:227], v[190:193]
    global_load_dwordx4 v[78:81], v30, s[64:65] offset:1024 sc1
    ds_read_b128 v[178:181], v23 offset:0
    v_mfma_f32_16x16x32_bf16 v[194:197], v[94:97], a[228:231], v[194:197]
    ds_read_b128 v[182:185], v23 offset:1024
    global_load_dwordx4 v[82:85], v31, s[64:65] offset:1024 sc1
    v_mfma_f32_16x16x32_bf16 v[198:201], v[94:97], a[232:235], v[198:201]
    ds_read_b128 v[186:189], v23 offset:2048
    v_mfma_f32_16x16x32_bf16 v[202:205], v[94:97], a[236:239], v[202:205]
    global_load_dwordx4 v[86:89], v30, s[66:67] offset:1024 sc1
    v_lshlrev_b32 v12, 16, v52
    v_mfma_f32_16x16x32_bf16 v[190:193], v[98:101], a[240:243], v[190:193]
    v_and_b32 v13, 0xffff0000, v52
    v_mfma_f32_16x16x32_bf16 v[194:197], v[98:101], a[244:247], v[194:197]
    global_load_dwordx4 v[90:93], v31, s[66:67] offset:1024 sc1
    v_mfma_f32_16x16x32_bf16 v[198:201], v[98:101], a[248:251], v[198:201]
    v_lshlrev_b32 v14, 16, v53
    v_mfma_f32_16x16x32_bf16 v[202:205], v[98:101], a[252:255], v[202:205]
    s_add_u32 m0, s95, 12288
    v_and_b32 v15, 0xffff0000, v53
    v_mfma_f32_16x16x32_bf16 v[190:193], v[102:105], a[192:195], v[190:193]
    s_waitcnt lgkmcnt(2)
    v_add_f32 v174, v174, v178
    s_add_u32 s92, s92, 4096
    s_addc_u32 s93, s93, 0
    v_mfma_f32_16x16x32_bf16 v[194:197], v[102:105], a[196:199], v[194:197]
    v_add_f32 v175, v175, v179
    v_mfma_f32_16x16x32_bf16 v[198:201], v[102:105], a[200:203], v[198:201]
    s_waitcnt vmcnt(20)
    v_and_b32 v28, v113, v117
    v_mfma_f32_16x16x32_bf16 v[202:205], v[102:105], a[204:207], v[202:205]
    s_waitcnt vmcnt(18)
    v_bitop3_b32 v28, v121, v125, v28 bitop3:0x80
    v_add_f32 v176, v176, v180
    v_mfma_f32_16x16x32_bf16 v[190:193], v[106:109], a[208:211], v[190:193]
    v_and_b32 v28, 1, v28
    v_add_f32 v177, v177, v181
    v_mfma_f32_16x16x32_bf16 v[194:197], v[106:109], a[212:215], v[194:197]
    global_load_lds_dwordx4 v4, s[92:93] offset:0 sc1
    v_cmp_ne_u32 vcc, 1, v28
    v_mfma_f32_16x16x32_bf16 v[198:201], v[106:109], a[216:219], v[198:201]
    s_waitcnt lgkmcnt(1)
    v_add_f32 v174, v174, v182
    global_load_lds_dwordx4 v4, s[92:93] offset:1024 sc1
    v_mfma_f32_16x16x32_bf16 v[202:205], v[106:109], a[220:223], v[202:205]
    v_add_f32 v175, v175, v183
    s_cbranch_vccnz Lz18_r
Lz18_ok:
    v_mfma_f32_16x16x32_bf16 v[190:193], v[110:113], a[96:99], v[190:193]
    global_load_dwordx4 v[94:97], v30, s[60:61] offset:2048 sc1
    v_add_f32 v176, v176, v184
    v_mfma_f32_16x16x32_bf16 v[194:197], v[110:113], a[100:103], v[194:197]
    v_add_f32 v177, v177, v185
    v_mfma_f32_16x16x32_bf16 v[198:201], v[110:113], a[104:107], v[198:201]
    global_load_dwordx4 v[98:101], v31, s[60:61] offset:2048 sc1
    s_waitcnt lgkmcnt(0)
    v_add_f32 v174, v174, v186
    v_mfma_f32_16x16x32_bf16 v[202:205], v[110:113], a[108:111], v[202:205]
    v_mfma_f32_16x16x32_bf16 v[190:193], v[114:117], a[112:115], v[190:193]
    v_add_f32 v175, v175, v187
    v_mfma_f32_16x16x32_bf16 v[194:197], v[114:117], a[116:119], v[194:197]
    global_load_dwordx4 v[102:105], v30, s[62:63] offset:2048 sc1
    v_add_f32 v176, v176, v188
    v_mfma_f32_16x16x32_bf16 v[198:201], v[114:117], a[120:123], v[198:201]
    v_add_f32 v177, v177, v189
    v_mfma_f32_16x16x32_bf16 v[202:205], v[114:117], a[124:127], v[202:205]
    v_mfma_f32_16x16x32_bf16 v[190:193], v[118:121], a[128:131], v[190:193]
    global_load_dwordx4 v[106:109], v31, s[62:63] offset:2048 sc1
    v_mul_f32 v174, v174, v12
    v_mfma_f32_16x16x32_bf16 v[194:197], v[118:121], a[132:135], v[194:197]
    v_mul_f32 v175, v175, v13
    v_mfma_f32_16x16x32_bf16 v[198:201], v[118:121], a[136:139], v[198:201]
    s_waitcnt vmcnt(20)
    v_and_b32 v28, v129, v133
    global_load_lds_dwordx4 v4, s[92:93] offset:2048 sc1
    v_mfma_f32_16x16x32_bf16 v[202:205], v[118:121], a[140:143], v[202:205]
    s_waitcnt vmcnt(19)
    v_bitop3_b32 v28, v137, v141, v28 bitop3:0x80
    v_mul_f32 v176, v176, v14
    v_mfma_f32_16x16x32_bf16 v[190:193], v[122:125], a[144:147], v[190:193]
    v_and_b32 v28, 1, v28
    v_mul_f32 v177, v177, v15
    v_mfma_f32_16x16x32_bf16 v[194:197], v[122:125], a[148:151], v[194:197]
    v_cmp_ne_u32 vcc, 1, v28
    global_load_lds_dwordx4 v4, s[92:93] offset:3072 sc1
    v_mfma_f32_16x16x32_bf16 v[198:201], v[122:125], a[152:155], v[198:201]
    v_cvt_pk_bf16_f32 v52, v174, v175
    v_cvt_pk_bf16_f32 v53, v176, v177
    v_mfma_f32_16x16x32_bf16 v[202:205], v[122:125], a[156:159], v[202:205]
    s_cbranch_vccnz Lz19_r
Lz19_ok:
    v_mfma_f32_16x16x32_bf16 v[206:209], v[126:129], a[32:35], v[206:209]
    global_load_dwordx4 v[110:113], v30, s[52:53] offset:2048 sc1
    v_mfma_f32_16x16x32_bf16 v[210:213], v[126:129], a[36:39], v[210:213]
    global_load_dwordx4 v[114:117], v31, s[52:53] offset:2048 sc1
    v_mfma_f32_16x16x32_bf16 v[214:217], v[126:129], a[40:43], v[214:217]
    v_mfma_f32_16x16x32_bf16 v[218:221], v[126:129], a[44:47], v[218:221]
    ds_write_b128 v20, v[194:197] offset:12288
    v_mfma_f32_16x16x32_bf16 v[206:209], v[130:133], a[48:51], v[206:209]
    global_load_dwordx4 v[118:121], v30, s[54:55] offset:2048 sc1
    v_mfma_f32_16x16x32_bf16 v[210:213], v[130:133], a[52:55], v[210:213]
    global_load_dwordx4 v[122:125], v31, s[54:55] offset:2048 sc1
    v_mfma_f32_16x16x32_bf16 v[214:217], v[130:133], a[56:59], v[214:217]
    ds_write_b128 v21, v[198:201] offset:12288
    v_mfma_f32_16x16x32_bf16 v[218:221], v[130:133], a[60:63], v[218:221]
    s_add_u32 m0, s95, 16384
    v_mfma_f32_16x16x32_bf16 v[206:209], v[134:137], a[64:67], v[206:209]
    s_add_u32 s92, s92, 4096
    s_addc_u32 s93, s93, 0
    v_mfma_f32_16x16x32_bf16 v[210:213], v[134:137], a[68:71], v[210:213]
    ds_write_b128 v22, v[202:205] offset:12288
    v_mfma_f32_16x16x32_bf16 v[214:217], v[134:137], a[72:75], v[214:217]
    s_waitcnt vmcnt(20)
    v_and_b32 v28, v65, v69
    v_mfma_f32_16x16x32_bf16 v[218:221], v[134:137], a[76:79], v[218:221]
    s_waitcnt vmcnt(18)
    v_bitop3_b32 v28, v73, v77, v28 bitop3:0x80
    v_mfma_f32_16x16x32_bf16 v[206:209], v[138:141], a[80:83], v[206:209]
    v_and_b32 v28, 1, v28
    global_load_lds_dwordx4 v4, s[92:93] offset:0 sc1
    v_mfma_f32_16x16x32_bf16 v[210:213], v[138:141], a[84:87], v[210:213]
    s_waitcnt lgkmcnt(0)
    s_barrier
    v_cmp_ne_u32 vcc, 1, v28
    v_mfma_f32_16x16x32_bf16 v[214:217], v[138:141], a[88:91], v[214:217]
    global_load_lds_dwordx4 v4, s[92:93] offset:1024 sc1
    v_mfma_f32_16x16x32_bf16 v[218:221], v[138:141], a[92:95], v[218:221]
    s_cbranch_vccnz Lz20_r
Lz20_ok:
    v_mfma_f32_16x16x32_bf16 v[206:209], v[62:65], a[224:227], v[206:209]
    global_load_dwordx4 v[126:129], v30, s[64:65] offset:2048 sc1
    ds_read_b128 v[194:197], v23 offset:12288
    v_mfma_f32_16x16x32_bf16 v[210:213], v[62:65], a[228:231], v[210:213]
    ds_read_b128 v[198:201], v23 offset:13312
    v_mfma_f32_16x16x32_bf16 v[214:217], v[62:65], a[232:235], v[214:217]
    ds_read_b128 v[202:205], v23 offset:14336
    global_load_dwordx4 v[130:133], v31, s[64:65] offset:2048 sc1
    v_mfma_f32_16x16x32_bf16 v[218:221], v[62:65], a[236:239], v[218:221]
    v_lshlrev_b32 v12, 16, v54
    v_mfma_f32_16x16x32_bf16 v[206:209], v[66:69], a[240:243], v[206:209]
    v_and_b32 v13, 0xffff0000, v54
    v_mfma_f32_16x16x32_bf16 v[210:213], v[66:69], a[244:247], v[210:213]
    global_load_dwordx4 v[134:137], v30, s[66:67] offset:2048 sc1
    v_mfma_f32_16x16x32_bf16 v[214:217], v[66:69], a[248:251], v[214:217]
    v_lshlrev_b32 v14, 16, v55
    v_mfma_f32_16x16x32_bf16 v[218:221], v[66:69], a[252:255], v[218:221]
    v_and_b32 v15, 0xffff0000, v55
    v_mfma_f32_16x16x32_bf16 v[206:209], v[70:73], a[192:195], v[206:209]
    global_load_dwordx4 v[138:141], v31, s[66:67] offset:2048 sc1
    s_waitcnt lgkmcnt(2)
    v_add_f32 v190, v190, v194
    v_mfma_f32_16x16x32_bf16 v[210:213], v[70:73], a[196:199], v[210:213]
    v_add_f32 v191, v191, v195
    v_mfma_f32_16x16x32_bf16 v[214:217], v[70:73], a[200:203], v[214:217]
    s_waitcnt vmcnt(20)
    v_and_b32 v28, v81, v85
    global_load_lds_dwordx4 v4, s[92:93] offset:2048 sc1
    v_mfma_f32_16x16x32_bf16 v[218:221], v[70:73], a[204:207], v[218:221]
    s_waitcnt vmcnt(19)
    v_bitop3_b32 v28, v89, v93, v28 bitop3:0x80
    v_add_f32 v192, v192, v196
    v_mfma_f32_16x16x32_bf16 v[206:209], v[74:77], a[208:211], v[206:209]
    v_and_b32 v28, 1, v28
    v_add_f32 v193, v193, v197
    v_mfma_f32_16x16x32_bf16 v[210:213], v[74:77], a[212:215], v[210:213]
    v_cmp_ne_u32 vcc, 1, v28
    global_load_lds_dwordx4 v4, s[92:93] offset:3072 sc1
    v_mfma_f32_16x16x32_bf16 v[214:217], v[74:77], a[216:219], v[214:217]
    s_waitcnt lgkmcnt(1)
    v_add_f32 v190, v190, v198
    v_add_f32 v191, v191, v199
    v_mfma_f32_16x16x32_bf16 v[218:221], v[74:77], a[220:223], v[218:221]
    s_cbranch_vccnz Lz21_r
Lz21_ok:
    v_mfma_f32_16x16x32_bf16 v[206:209], v[78:81], a[96:99], v[206:209]
    global_load_dwordx4 v[62:65], v30, s[60:61] offset:3072 sc1
    v_add_f32 v192, v192, v200
    v_mfma_f32_16x16x32_bf16 v[210:213], v[78:81], a[100:103], v[210:213]
    v_add_f32 v193, v193, v201
    global_load_dwordx4 v[66:69], v31, s[60:61] offset:3072 sc1
    v_mfma_f32_16x16x32_bf16 v[214:217], v[78:81], a[104:107], v[214:217]
    s_waitcnt lgkmcnt(0)
    v_add_f32 v190, v190, v202
    v_mfma_f32_16x16x32_bf16 v[218:221], v[78:81], a[108:111], v[218:221]
    global_load_dwordx4 v[70:73], v30, s[62:63] offset:3072 sc1
    v_add_f32 v191, v191, v203
    v_mfma_f32_16x16x32_bf16 v[206:209], v[82:85], a[112:115], v[206:209]
    v_add_f32 v192, v192, v204
    v_mfma_f32_16x16x32_bf16 v[210:213], v[82:85], a[116:119], v[210:213]
    global_load_dwordx4 v[74:77], v31, s[62:63] offset:3072 sc1
    v_mfma_f32_16x16x32_bf16 v[214:217], v[82:85], a[120:123], v[214:217]
    v_add_f32 v193, v193, v205
    v_mfma_f32_16x16x32_bf16 v[218:221], v[82:85], a[124:127], v[218:221]
    s_add_u32 m0, s95, 20480
    v_mul_f32 v190, v190, v12
    v_mfma_f32_16x16x32_bf16 v[206:209], v[86:89], a[128:131], v[206:209]
    v_mul_f32 v191, v191, v13
    s_add_u32 s92, s92, 4096
    s_addc_u32 s93, s93, 0
    v_mfma_f32_16x16x32_bf16 v[210:213], v[86:89], a[132:135], v[210:213]
    v_mul_f32 v192, v192, v14
    v_mfma_f32_16x16x32_bf16 v[214:217], v[86:89], a[136:139], v[214:217]
    s_waitcnt vmcnt(20)
    v_and_b32 v28, v97, v101
    v_mfma_f32_16x16x32_bf16 v[218:221], v[86:89], a[140:143], v[218:221]
    s_waitcnt vmcnt(18)
    v_bitop3_b32 v28, v105, v109, v28 bitop3:0x80
    v_mul_f32 v193, v193, v15
    v_mfma_f32_16x16x32_bf16 v[206:209], v[90:93], a[144:147], v[206:209]
    v_and_b32 v28, 1, v28
    v_cvt_pk_bf16_f32 v54, v190, v191
    v_mfma_f32_16x16x32_bf16 v[210:213], v[90:93], a[148:151], v[210:213]
    global_load_lds_dwordx4 v4, s[92:93] offset:0 sc1
    v_cmp_ne_u32 vcc, 1, v28
    v_mfma_f32_16x16x32_bf16 v[214:217], v[90:93], a[152:155], v[214:217]
    v_cvt_pk_bf16_f32 v55, v192, v193
    global_load_lds_dwordx4 v4, s[92:93] offset:1024 sc1
    v_mfma_f32_16x16x32_bf16 v[218:221], v[90:93], a[156:159], v[218:221]
    v_and_b32 v55, -2, v55
    s_cbranch_vccnz Lz22_r
Lz22_ok:
    v_mfma_f32_16x16x32_bf16 v[222:225], v[94:97], a[32:35], v[222:225]
    global_load_dwordx4 v[78:81], v30, s[52:53] offset:3072 sc1
    v_mfma_f32_16x16x32_bf16 v[226:229], v[94:97], a[36:39], v[226:229]
    v_mfma_f32_16x16x32_bf16 v[230:233], v[94:97], a[40:43], v[230:233]
    global_load_dwordx4 v[82:85], v31, s[52:53] offset:3072 sc1
    v_mfma_f32_16x16x32_bf16 v[234:237], v[94:97], a[44:47], v[234:237]
    ds_write_b128 v20, v[210:213] offset:0
    v_mfma_f32_16x16x32_bf16 v[222:225], v[98:101], a[48:51], v[222:225]
    v_mfma_f32_16x16x32_bf16 v[226:229], v[98:101], a[52:55], v[226:229]
    global_load_dwordx4 v[86:89], v30, s[54:55] offset:3072 sc1
    v_mfma_f32_16x16x32_bf16 v[230:233], v[98:101], a[56:59], v[230:233]
    ds_write_b128 v21, v[214:217] offset:0
    v_mfma_f32_16x16x32_bf16 v[234:237], v[98:101], a[60:63], v[234:237]
    v_mfma_f32_16x16x32_bf16 v[222:225], v[102:105], a[64:67], v[222:225]
    global_load_dwordx4 v[90:93], v31, s[54:55] offset:3072 sc1
    v_mfma_f32_16x16x32_bf16 v[226:229], v[102:105], a[68:71], v[226:229]
    ds_write_b128 v22, v[218:221] offset:0
    v_mfma_f32_16x16x32_bf16 v[230:233], v[102:105], a[72:75], v[230:233]
    s_waitcnt vmcnt(20)
    v_and_b32 v28, v113, v117
    global_load_lds_dwordx4 v4, s[92:93] offset:2048 sc1
    v_mfma_f32_16x16x32_bf16 v[234:237], v[102:105], a[76:79], v[234:237]
    s_waitcnt vmcnt(19)
    v_bitop3_b32 v28, v121, v125, v28 bitop3:0x80
    v_mfma_f32_16x16x32_bf16 v[222:225], v[106:109], a[80:83], v[222:225]
    v_and_b32 v28, 1, v28
    s_waitcnt lgkmcnt(0)
    s_barrier
    v_mfma_f32_16x16x32_bf16 v[226:229], v[106:109], a[84:87], v[226:229]
    v_cmp_ne_u32 vcc, 1, v28
    global_load_lds_dwordx4 v4, s[92:93] offset:3072 sc1
    v_mfma_f32_16x16x32_bf16 v[230:233], v[106:109], a[88:91], v[230:233]
    v_mfma_f32_16x16x32_bf16 v[234:237], v[106:109], a[92:95], v[234:237]
    s_cbranch_vccnz Lz23_r
Lz23_ok:
    v_mfma_f32_16x16x32_bf16 v[222:225], v[110:113], a[224:227], v[222:225]
    global_load_dwordx4 v[94:97], v30, s[64:65] offset:3072 sc1
    ds_read_b128 v[210:213], v23 offset:0
    v_mfma_f32_16x16x32_bf16 v[226:229], v[110:113], a[228:231], v[226:229]
    ds_read_b128 v[214:217], v23 offset:1024
    global_load_dwordx4 v[98:101], v31, s[64:65] offset:3072 sc1
    v_mfma_f32_16x16x32_bf16 v[230:233], v[110:113], a[232:235], v[230:233]
    ds_read_b128 v[218:221], v23 offset:2048
    v_mfma_f32_16x16x32_bf16 v[234:237], v[110:113], a[236:239], v[234:237]
    global_load_dwordx4 v[102:105], v30, s[66:67] offset:3072 sc1
    v_lshlrev_b32 v12, 16, v56
    v_mfma_f32_16x16x32_bf16 v[222:225], v[114:117], a[240:243], v[222:225]
    v_and_b32 v13, 0xffff0000, v56
    v_mfma_f32_16x16x32_bf16 v[226:229], v[114:117], a[244:247], v[226:229]
    global_load_dwordx4 v[106:109], v31, s[66:67] offset:3072 sc1
    v_mfma_f32_16x16x32_bf16 v[230:233], v[114:117], a[248:251], v[230:233]
    v_lshlrev_b32 v14, 16, v57
    v_mfma_f32_16x16x32_bf16 v[234:237], v[114:117], a[252:255], v[234:237]
    s_add_u32 m0, s95, 24576
    v_and_b32 v15, 0xffff0000, v57
    v_mfma_f32_16x16x32_bf16 v[222:225], v[118:121], a[192:195], v[222:225]
    s_waitcnt lgkmcnt(2)
    v_add_f32 v206, v206, v210
    s_add_u32 s92, s92, 4096
    s_addc_u32 s93, s93, 0
    v_mfma_f32_16x16x32_bf16 v[226:229], v[118:121], a[196:199], v[226:229]
    v_add_f32 v207, v207, v211
    v_mfma_f32_16x16x32_bf16 v[230:233], v[118:121], a[200:203], v[230:233]
    s_waitcnt vmcnt(20)
    v_and_b32 v28, v129, v133
    v_mfma_f32_16x16x32_bf16 v[234:237], v[118:121], a[204:207], v[234:237]
    s_waitcnt vmcnt(18)
    v_bitop3_b32 v28, v137, v141, v28 bitop3:0x80
    v_add_f32 v208, v208, v212
    v_mfma_f32_16x16x32_bf16 v[222:225], v[122:125], a[208:211], v[222:225]
    v_and_b32 v28, 1, v28
    v_add_f32 v209, v209, v213
    v_mfma_f32_16x16x32_bf16 v[226:229], v[122:125], a[212:215], v[226:229]
    global_load_lds_dwordx4 v4, s[92:93] offset:0 sc1
    v_cmp_ne_u32 vcc, 1, v28
    v_mfma_f32_16x16x32_bf16 v[230:233], v[122:125], a[216:219], v[230:233]
    s_waitcnt lgkmcnt(1)
    v_add_f32 v206, v206, v214
    global_load_lds_dwordx4 v4, s[92:93] offset:1024 sc1
    v_mfma_f32_16x16x32_bf16 v[234:237], v[122:125], a[220:223], v[234:237]
    v_add_f32 v207, v207, v215
    s_cbranch_vccnz Lz24_r
Lz24_ok:
    v_mfma_f32_16x16x32_bf16 v[222:225], v[126:129], a[96:99], v[222:225]
    global_store_dwordx4 v6, v[48:51], s[8:9] offset:-4096 sc1
    v_add_f32 v208, v208, v216
    v_mfma_f32_16x16x32_bf16 v[226:229], v[126:129], a[100:103], v[226:229]
    v_add_f32 v209, v209, v217
    v_mfma_f32_16x16x32_bf16 v[230:233], v[126:129], a[104:107], v[230:233]
    s_waitcnt lgkmcnt(0)
    v_add_f32 v206, v206, v218
    v_mfma_f32_16x16x32_bf16 v[234:237], v[126:129], a[108:111], v[234:237]
    v_mfma_f32_16x16x32_bf16 v[222:225], v[130:133], a[112:115], v[222:225]
    global_store_dwordx4 v7, v[52:55], s[8:9] offset:-4096 sc1
    v_add_f32 v207, v207, v219
    v_mfma_f32_16x16x32_bf16 v[226:229], v[130:133], a[116:119], v[226:229]
    v_add_f32 v208, v208, v220
    v_mfma_f32_16x16x32_bf16 v[230:233], v[130:133], a[120:123], v[230:233]
    v_add_f32 v209, v209, v221
    v_mfma_f32_16x16x32_bf16 v[234:237], v[130:133], a[124:127], v[234:237]
    v_mfma_f32_16x16x32_bf16 v[222:225], v[134:137], a[128:131], v[222:225]
    global_load_lds_dwordx4 v4, s[92:93] offset:2048 sc1
    v_mul_f32 v206, v206, v12
    v_mfma_f32_16x16x32_bf16 v[226:229], v[134:137], a[132:135], v[226:229]
    v_mul_f32 v207, v207, v13
    v_mfma_f32_16x16x32_bf16 v[230:233], v[134:137], a[136:139], v[230:233]
    s_waitcnt vmcnt(19)
    v_and_b32 v28, v65, v69
    v_mul_f32 v208, v208, v14
    v_mfma_f32_16x16x32_bf16 v[234:237], v[134:137], a[140:143], v[234:237]
    s_waitcnt vmcnt(17)
    v_bitop3_b32 v28, v73, v77, v28 bitop3:0x80
    v_mfma_f32_16x16x32_bf16 v[222:225], v[138:141], a[144:147], v[222:225]
    v_and_b32 v28, 1, v28
    global_load_lds_dwordx4 v4, s[92:93] offset:3072 sc1
    v_mfma_f32_16x16x32_bf16 v[226:229], v[138:141], a[148:151], v[226:229]
    v_mul_f32 v209, v209, v15
    v_cmp_ne_u32 vcc, 1, v28
    v_mfma_f32_16x16x32_bf16 v[230:233], v[138:141], a[152:155], v[230:233]
    v_cvt_pk_bf16_f32 v56, v206, v207
    v_cvt_pk_bf16_f32 v57, v208, v209
    v_mfma_f32_16x16x32_bf16 v[234:237], v[138:141], a[156:159], v[234:237]
    s_cbranch_vccnz Lz25_r
Lz25_ok:
    v_mfma_f32_16x16x32_bf16 v[238:241], v[62:65], a[32:35], v[238:241]
    s_add_u32 m0, s95, 28672
    v_mfma_f32_16x16x32_bf16 v[242:245], v[62:65], a[36:39], v[242:245]
    v_mfma_f32_16x16x32_bf16 v[246:249], v[62:65], a[40:43], v[246:249]
    v_mfma_f32_16x16x32_bf16 v[250:253], v[62:65], a[44:47], v[250:253]
    ds_write_b128 v20, v[226:229] offset:12288
    v_mfma_f32_16x16x32_bf16 v[238:241], v[66:69], a[48:51], v[238:241]
    s_add_u32 s92, s92, 4096
    s_addc_u32 s93, s93, 0
    v_mfma_f32_16x16x32_bf16 v[242:245], v[66:69], a[52:55], v[242:245]
    v_mfma_f32_16x16x32_bf16 v[246:249], v[66:69], a[56:59], v[246:249]
    ds_write_b128 v21, v[230:233] offset:12288
    v_mfma_f32_16x16x32_bf16 v[250:253], v[66:69], a[60:63], v[250:253]
    v_mfma_f32_16x16x32_bf16 v[238:241], v[70:73], a[64:67], v[238:241]
    v_mfma_f32_16x16x32_bf16 v[242:245], v[70:73], a[68:71], v[242:245]
    ds_write_b128 v22, v[234:237] offset:12288
    v_mfma_f32_16x16x32_bf16 v[246:249], v[70:73], a[72:75], v[246:249]
    s_waitcnt vmcnt(14)
    v_and_b32 v28, v81, v85
    global_load_lds_dwordx4 v4, s[92:93] offset:0 sc1
    v_mfma_f32_16x16x32_bf16 v[250:253], v[70:73], a[76:79], v[250:253]
    s_waitcnt vmcnt(13)
    v_bitop3_b32 v28, v89, v93, v28 bitop3:0x80
    v_mfma_f32_16x16x32_bf16 v[238:241], v[74:77], a[80:83], v[238:241]
    v_and_b32 v28, 1, v28
    s_waitcnt lgkmcnt(0)
    s_barrier
    v_mfma_f32_16x16x32_bf16 v[242:245], v[74:77], a[84:87], v[242:245]
    global_load_lds_dwordx4 v4, s[92:93] offset:1024 sc1
    v_cmp_ne_u32 vcc, 1, v28
    v_mfma_f32_16x16x32_bf16 v[246:249], v[74:77], a[88:91], v[246:249]
    v_mfma_f32_16x16x32_bf16 v[250:253], v[74:77], a[92:95], v[250:253]
    s_cbranch_vccnz Lz26_r
Lz26_ok:
    v_mfma_f32_16x16x32_bf16 v[238:241], v[78:81], a[224:227], v[238:241]
    global_load_lds_dwordx4 v4, s[92:93] offset:2048 sc1
    ds_read_b128 v[226:229], v23 offset:12288
    v_mfma_f32_16x16x32_bf16 v[242:245], v[78:81], a[228:231], v[242:245]
    ds_read_b128 v[230:233], v23 offset:13312
    v_mfma_f32_16x16x32_bf16 v[246:249], v[78:81], a[232:235], v[246:249]
    ds_read_b128 v[234:237], v23 offset:14336
    v_mfma_f32_16x16x32_bf16 v[250:253], v[78:81], a[236:239], v[250:253]
    v_lshlrev_b32 v12, 16, v58
    v_mfma_f32_16x16x32_bf16 v[238:241], v[82:85], a[240:243], v[238:241]
    v_and_b32 v13, 0xffff0000, v58
    v_mfma_f32_16x16x32_bf16 v[242:245], v[82:85], a[244:247], v[242:245]
    v_mfma_f32_16x16x32_bf16 v[246:249], v[82:85], a[248:251], v[246:249]
    v_lshlrev_b32 v14, 16, v59
    v_mfma_f32_16x16x32_bf16 v[250:253], v[82:85], a[252:255], v[250:253]
    v_and_b32 v15, 0xffff0000, v59
    v_mfma_f32_16x16x32_bf16 v[238:241], v[86:89], a[192:195], v[238:241]
    global_load_lds_dwordx4 v4, s[92:93] offset:3072 sc1
    s_waitcnt lgkmcnt(2)
    v_add_f32 v222, v222, v226
    v_mfma_f32_16x16x32_bf16 v[242:245], v[86:89], a[196:199], v[242:245]
    v_add_f32 v223, v223, v227
    v_mfma_f32_16x16x32_bf16 v[246:249], v[86:89], a[200:203], v[246:249]
    s_waitcnt vmcnt(12)
    v_and_b32 v28, v97, v101
    v_mfma_f32_16x16x32_bf16 v[250:253], v[86:89], a[204:207], v[250:253]
    s_waitcnt vmcnt(10)
    v_bitop3_b32 v28, v105, v109, v28 bitop3:0x80
    v_add_f32 v224, v224, v228
    v_mfma_f32_16x16x32_bf16 v[238:241], v[90:93], a[208:211], v[238:241]
    v_and_b32 v28, 1, v28
    v_add_f32 v225, v225, v229
    v_mfma_f32_16x16x32_bf16 v[242:245], v[90:93], a[212:215], v[242:245]
    v_cmp_ne_u32 vcc, 1, v28
    s_waitcnt lgkmcnt(1)
    v_add_f32 v222, v222, v230
    v_mfma_f32_16x16x32_bf16 v[246:249], v[90:93], a[216:219], v[246:249]
    v_add_f32 v223, v223, v231
    v_mfma_f32_16x16x32_bf16 v[250:253], v[90:93], a[220:223], v[250:253]
    s_cbranch_vccnz Lz27_r
Lz27_ok:
    v_mfma_f32_16x16x32_bf16 v[238:241], v[94:97], a[96:99], v[238:241]
    s_add_u32 m0, s95, 32768
    v_add_f32 v224, v224, v232
    v_mfma_f32_16x16x32_bf16 v[242:245], v[94:97], a[100:103], v[242:245]
    v_add_f32 v225, v225, v233
    v_mfma_f32_16x16x32_bf16 v[246:249], v[94:97], a[104:107], v[246:249]
    s_waitcnt lgkmcnt(0)
    v_add_f32 v222, v222, v234
    v_mfma_f32_16x16x32_bf16 v[250:253], v[94:97], a[108:111], v[250:253]
    s_add_u32 s92, s92, 4096
    s_addc_u32 s93, s93, 0
    v_add_f32 v223, v223, v235
    v_mfma_f32_16x16x32_bf16 v[238:241], v[98:101], a[112:115], v[238:241]
    v_add_f32 v224, v224, v236
    v_mfma_f32_16x16x32_bf16 v[242:245], v[98:101], a[116:119], v[242:245]
    v_mfma_f32_16x16x32_bf16 v[246:249], v[98:101], a[120:123], v[246:249]
    v_add_f32 v225, v225, v237
    v_mfma_f32_16x16x32_bf16 v[250:253], v[98:101], a[124:127], v[250:253]
    v_mul_f32 v222, v222, v12
    v_mfma_f32_16x16x32_bf16 v[238:241], v[102:105], a[128:131], v[238:241]
    v_mul_f32 v223, v223, v13
    v_mfma_f32_16x16x32_bf16 v[242:245], v[102:105], a[132:135], v[242:245]
    global_load_lds_dwordx4 v4, s[92:93] offset:0 sc1
    v_mul_f32 v224, v224, v14
    v_mfma_f32_16x16x32_bf16 v[246:249], v[102:105], a[136:139], v[246:249]
    v_mfma_f32_16x16x32_bf16 v[250:253], v[102:105], a[140:143], v[250:253]
    v_mul_f32 v225, v225, v15
    v_mfma_f32_16x16x32_bf16 v[238:241], v[106:109], a[144:147], v[238:241]
    v_cvt_pk_bf16_f32 v58, v222, v223
    global_load_lds_dwordx4 v4, s[92:93] offset:1024 sc1
    v_mfma_f32_16x16x32_bf16 v[242:245], v[106:109], a[148:151], v[242:245]
    v_cvt_pk_bf16_f32 v59, v224, v225
    v_mfma_f32_16x16x32_bf16 v[246:249], v[106:109], a[152:155], v[246:249]
    v_and_b32 v59, -2, v59
    v_mfma_f32_16x16x32_bf16 v[250:253], v[106:109], a[156:159], v[250:253]
    global_load_dwordx4 v[142:145], v6, s[38:39] offset:-4096 sc1
    s_nop 2
    ds_write_b128 v20, v[242:245] offset:0
    s_nop 0
    ds_write_b128 v21, v[246:249] offset:0
    global_load_dwordx4 v[146:149], v6, s[38:39] offset:-3072 sc1
    ds_write_b128 v22, v[250:253] offset:0
    s_waitcnt lgkmcnt(0)
    s_barrier
    global_load_dwordx4 v[150:153], v6, s[38:39] offset:-2048 sc1
    ds_read_b128 v[242:245], v23 offset:0
    ds_read_b128 v[246:249], v23 offset:1024
    global_load_dwordx4 v[154:157], v6, s[38:39] offset:-1024 sc1
    ds_read_b128 v[250:253], v23 offset:2048
    v_lshlrev_b32 v12, 16, v60
    v_and_b32 v13, 0xffff0000, v60
    global_load_dwordx4 v[158:161], v6, s[38:39] offset:0 sc1
    v_lshlrev_b32 v14, 16, v61
    v_and_b32 v15, 0xffff0000, v61
    global_load_dwordx4 v[162:165], v6, s[38:39] offset:1024 sc1
    s_waitcnt lgkmcnt(2)
    v_pk_add_f32 v[238:239], v[238:239], v[242:243] op_sel:[0,0] op_sel_hi:[1,1]
    v_pk_add_f32 v[240:241], v[240:241], v[244:245] op_sel:[0,0] op_sel_hi:[1,1]
    s_waitcnt lgkmcnt(1)
    v_pk_add_f32 v[238:239], v[238:239], v[246:247] op_sel:[0,0] op_sel_hi:[1,1]
    global_load_dwordx4 v[166:169], v6, s[38:39] offset:2048 sc1
    v_pk_add_f32 v[240:241], v[240:241], v[248:249] op_sel:[0,0] op_sel_hi:[1,1]
    s_waitcnt lgkmcnt(0)
    v_pk_add_f32 v[238:239], v[238:239], v[250:251] op_sel:[0,0] op_sel_hi:[1,1]
    global_load_dwordx4 v[170:173], v6, s[38:39] offset:3072 sc1
    v_pk_add_f32 v[240:241], v[240:241], v[252:253] op_sel:[0,0] op_sel_hi:[1,1]
    v_pk_mul_f32 v[238:239], v[238:239], v[12:13] op_sel:[0,0] op_sel_hi:[1,1]
    v_pk_mul_f32 v[240:241], v[240:241], v[14:15] op_sel:[0,0] op_sel_hi:[1,1]
    v_cvt_pk_bf16_f32 v60, v238, v239
    v_cvt_pk_bf16_f32 v61, v240, v241
    v_and_b32 v61, -2, v61
    global_store_dwordx4 v26, v[56:59], s[8:9] offset:-4096 sc1
    global_store_dwordx2 v27, v[60:61], s[10:11] offset:-4096 sc1
    v_add_u32 v30, 61440, v4
    v_add_u32 v31, 122880, v4
    global_load_dwordx4 v[174:177], v7, s[38:39] offset:-4096 sc1
    global_load_dwordx4 v[178:181], v7, s[38:39] offset:-3072 sc1
    global_load_dwordx4 v[182:185], v7, s[38:39] offset:-2048 sc1
    global_load_dwordx4 v[186:189], v7, s[38:39] offset:-1024 sc1
    global_load_dwordx4 v[190:193], v7, s[38:39] offset:0 sc1
    global_load_dwordx4 v[194:197], v7, s[38:39] offset:1024 sc1
    global_load_dwordx4 v[198:201], v7, s[38:39] offset:2048 sc1
    global_load_dwordx4 v[202:205], v7, s[38:39] offset:3072 sc1
    s_waitcnt vmcnt(18)
    s_barrier
    ds_read_b128 v[82:85], v4 offset:0
    ds_read_b128 v[86:89], v4 offset:1024
    ds_read_b128 v[90:93], v4 offset:2048
    ds_read_b128 v[94:97], v4 offset:3072
    ds_read_b128 v[98:101], v4 offset:4096
    s_waitcnt vmcnt(16)
    v_or_b32 v28, v145, v149
    s_waitcnt vmcnt(14)
    v_or3_b32 v28, v153, v157, v28
    s_waitcnt vmcnt(12)
    v_or3_b32 v28, v161, v165, v28
    s_waitcnt vmcnt(10)
    v_or3_b32 v28, v169, v173, v28
    v_and_b32 v28, 1, v28
    v_cmp_ne_u32 vcc, 0, v28
    s_nop 0
    s_cbranch_vccnz Lp0_r
Lp0_ok:
    s_waitcnt lgkmcnt(4)
    v_mfma_f32_16x16x32_bf16 v[62:65], v[82:85], v[142:145], 0
    ds_read_b128 v[102:105], v4 offset:20480
    s_waitcnt lgkmcnt(4)
    v_mfma_f32_16x16x32_bf16 v[66:69], v[86:89], v[142:145], 0
    ds_read_b128 v[82:85], v4 offset:21504
    s_waitcnt lgkmcnt(4)
    v_mfma_f32_16x16x32_bf16 v[70:73], v[90:93], v[142:145], 0
    ds_read_b128 v[86:89], v4 offset:22528
    s_waitcnt lgkmcnt(4)
    v_mfma_f32_16x16x32_bf16 v[74:77], v[94:97], v[142:145], 0
    ds_read_b128 v[90:93], v4 offset:23552
    s_waitcnt lgkmcnt(4)
    v_mfma_f32_16x16x32_bf16 v[78:81], v[98:101], v[142:145], 0
    ds_read_b128 v[94:97], v4 offset:24576
    s_waitcnt lgkmcnt(4)
    v_mfma_f32_16x16x32_bf16 v[62:65], v[102:105], v[146:149], v[62:65]
    ds_read_b128 v[98:101], v4 offset:35840
    s_waitcnt lgkmcnt(4)
    v_mfma_f32_16x16x32_bf16 v[66:69], v[82:85], v[146:149], v[66:69]
    ds_read_b128 v[102:105], v4 offset:36864
    s_waitcnt lgkmcnt(4)
    v_mfma_f32_16x16x32_bf16 v[70:73], v[86:89], v[146:149], v[70:73]
    ds_read_b128 v[82:85], v4 offset:37888
    s_waitcnt lgkmcnt(4)
    v_mfma_f32_16x16x32_bf16 v[74:77], v[90:93], v[146:149], v[74:77]
    ds_read_b128 v[86:89], v4 offset:38912
    s_waitcnt lgkmcnt(4)
    v_mfma_f32_16x16x32_bf16 v[78:81], v[94:97], v[146:149], v[78:81]
    ds_read_b128 v[90:93], v4 offset:39936
    s_waitcnt lgkmcnt(4)
    v_mfma_f32_16x16x32_bf16 v[62:65], v[98:101], v[150:153], v[62:65]
    ds_read_b128 v[94:97], v4 offset:56320
    s_waitcnt lgkmcnt(4)
    v_mfma_f32_16x16x32_bf16 v[66:69], v[102:105], v[150:153], v[66:69]
    ds_read_b128 v[98:101], v4 offset:57344
    s_waitcnt lgkmcnt(4)
    v_mfma_f32_16x16x32_bf16 v[70:73], v[82:85], v[150:153], v[70:73]
    ds_read_b128 v[102:105], v4 offset:58368
    s_waitcnt lgkmcnt(4)
    v_mfma_f32_16x16x32_bf16 v[74:77], v[86:89], v[150:153], v[74:77]
    ds_read_b128 v[82:85], v4 offset:59392
    s_waitcnt lgkmcnt(4)
    v_mfma_f32_16x16x32_bf16 v[78:81], v[90:93], v[150:153], v[78:81]
    ds_read_b128 v[86:89], v4 offset:60416
    s_waitcnt lgkmcnt(4)
    v_mfma_f32_16x16x32_bf16 v[62:65], v[94:97], v[154:157], v[62:65]
    ds_read_b128 v[90:93], v30 offset:10240
    s_waitcnt lgkmcnt(4)
    v_mfma_f32_16x16x32_bf16 v[66:69], v[98:101], v[154:157], v[66:69]
    ds_read_b128 v[94:97], v30 offset:11264
    s_waitcnt lgkmcnt(4)
    v_mfma_f32_16x16x32_bf16 v[70:73], v[102:105], v[154:157], v[70:73]
    ds_read_b128 v[98:101], v30 offset:12288
    s_waitcnt lgkmcnt(4)
    v_mfma_f32_16x16x32_bf16 v[74:77], v[82:85], v[154:157], v[74:77]
    ds_read_b128 v[102:105], v30 offset:13312
    s_waitcnt lgkmcnt(4)
    v_mfma_f32_16x16x32_bf16 v[78:81], v[86:89], v[154:157], v[78:81]
    ds_read_b128 v[82:85], v30 offset:14336
    s_waitcnt lgkmcnt(4)
    v_mfma_f32_16x16x32_bf16 v[62:65], v[90:93], v[158:161], v[62:65]
    ds_read_b128 v[86:89], v30 offset:30720
    s_waitcnt lgkmcnt(4)
    v_mfma_f32_16x16x32_bf16 v[66:69], v[94:97], v[158:161], v[66:69]
    ds_read_b128 v[90:93], v30 offset:31744
    s_waitcnt lgkmcnt(4)
    v_mfma_f32_16x16x32_bf16 v[70:73], v[98:101], v[158:161], v[70:73]
    ds_read_b128 v[94:97], v30 offset:32768
    s_waitcnt lgkmcnt(4)
    v_mfma_f32_16x16x32_bf16 v[74:77], v[102:105], v[158:161], v[74:77]
    ds_read_b128 v[98:101], v30 offset:33792
    s_waitcnt lgkmcnt(4)
    v_mfma_f32_16x16x32_bf16 v[78:81], v[82:85], v[158:161], v[78:81]
    ds_read_b128 v[102:105], v30 offset:34816
    s_waitcnt lgkmcnt(4)
    v_mfma_f32_16x16x32_bf16 v[62:65], v[86:89], v[162:165], v[62:65]
    ds_read_b128 v[82:85], v30 offset:46080
    s_waitcnt lgkmcnt(4)
    v_mfma_f32_16x16x32_bf16 v[66:69], v[90:93], v[162:165], v[66:69]
    ds_read_b128 v[86:89], v30 offset:47104
    s_waitcnt lgkmcnt(4)
    v_mfma_f32_16x16x32_bf16 v[70:73], v[94:97], v[162:165], v[70:73]
    ds_read_b128 v[90:93], v30 offset:48128
    s_waitcnt lgkmcnt(4)
    v_mfma_f32_16x16x32_bf16 v[74:77], v[98:101], v[162:165], v[74:77]
    ds_read_b128 v[94:97], v30 offset:49152
    s_waitcnt lgkmcnt(4)
    v_mfma_f32_16x16x32_bf16 v[78:81], v[102:105], v[162:165], v[78:81]
    ds_read_b128 v[98:101], v30 offset:50176
    s_waitcnt lgkmcnt(4)
    v_mfma_f32_16x16x32_bf16 v[62:65], v[82:85], v[166:169], v[62:65]
    ds_read_b128 v[102:105], v31 offset:5120
    s_waitcnt lgkmcnt(4)
    v_mfma_f32_16x16x32_bf16 v[66:69], v[86:89], v[166:169], v[66:69]
    ds_read_b128 v[82:85], v31 offset:6144
    s_waitcnt lgkmcnt(4)
    v_mfma_f32_16x16x32_bf16 v[70:73], v[90:93], v[166:169], v[70:73]
    ds_read_b128 v[86:89], v31 offset:7168
    s_waitcnt lgkmcnt(4)
    v_mfma_f32_16x16x32_bf16 v[74:77], v[94:97], v[166:169], v[74:77]
    ds_read_b128 v[90:93], v31 offset:8192
    s_waitcnt lgkmcnt(4)
    v_mfma_f32_16x16x32_bf16 v[78:81], v[98:101], v[166:169], v[78:81]
    ds_read_b128 v[94:97], v31 offset:9216
    s_waitcnt lgkmcnt(4)
    v_mfma_f32_16x16x32_bf16 v[62:65], v[102:105], v[170:173], v[62:65]
    ds_read_b128 v[98:101], v4 offset:5120
    s_waitcnt lgkmcnt(4)
    v_mfma_f32_16x16x32_bf16 v[66:69], v[82:85], v[170:173], v[66:69]
    ds_read_b128 v[102:105], v4 offset:6144
    s_waitcnt lgkmcnt(4)
    v_mfma_f32_16x16x32_bf16 v[70:73], v[86:89], v[170:173], v[70:73]
    ds_read_b128 v[82:85], v4 offset:7168
    s_waitcnt lgkmcnt(4)
    v_mfma_f32_16x16x32_bf16 v[74:77], v[90:93], v[170:173], v[74:77]
    ds_read_b128 v[86:89], v4 offset:8192
    s_waitcnt lgkmcnt(4)
    v_mfma_f32_16x16x32_bf16 v[78:81], v[94:97], v[170:173], v[78:81]
    ds_read_b128 v[90:93], v4 offset:9216
    s_waitcnt vmcnt(6)
    v_or_b32 v28, v177, v181
    s_waitcnt vmcnt(4)
    v_or3_b32 v28, v185, v189, v28
    s_waitcnt vmcnt(2)
    v_or3_b32 v28, v193, v197, v28
    s_waitcnt vmcnt(0)
    v_or3_b32 v28, v201, v205, v28
    v_and_b32 v28, 1, v28
    v_cmp_ne_u32 vcc, 0, v28
    s_nop 0
    s_cbranch_vccnz Lp1_r
Lp1_ok:
    s_waitcnt lgkmcnt(4)
    v_mfma_f32_16x16x32_bf16 v[62:65], v[98:101], v[174:177], v[62:65]
    ds_read_b128 v[94:97], v4 offset:25600
    s_waitcnt lgkmcnt(4)
    v_mfma_f32_16x16x32_bf16 v[66:69], v[102:105], v[174:177], v[66:69]
    ds_read_b128 v[98:101], v4 offset:26624
    s_waitcnt lgkmcnt(4)
    v_mfma_f32_16x16x32_bf16 v[70:73], v[82:85], v[174:177], v[70:73]
    ds_read_b128 v[102:105], v4 offset:27648
    s_waitcnt lgkmcnt(4)
    v_mfma_f32_16x16x32_bf16 v[74:77], v[86:89], v[174:177], v[74:77]
    ds_read_b128 v[82:85], v4 offset:28672
    s_waitcnt lgkmcnt(4)
    v_mfma_f32_16x16x32_bf16 v[78:81], v[90:93], v[174:177], v[78:81]
    ds_read_b128 v[86:89], v4 offset:29696
    s_waitcnt lgkmcnt(4)
    v_mfma_f32_16x16x32_bf16 v[62:65], v[94:97], v[178:181], v[62:65]
    ds_read_b128 v[90:93], v4 offset:40960
    s_waitcnt lgkmcnt(4)
    v_mfma_f32_16x16x32_bf16 v[66:69], v[98:101], v[178:181], v[66:69]
    ds_read_b128 v[94:97], v4 offset:41984
    s_waitcnt lgkmcnt(4)
    v_mfma_f32_16x16x32_bf16 v[70:73], v[102:105], v[178:181], v[70:73]
    ds_read_b128 v[98:101], v4 offset:43008
    s_waitcnt lgkmcnt(4)
    v_mfma_f32_16x16x32_bf16 v[74:77], v[82:85], v[178:181], v[74:77]
    ds_read_b128 v[102:105], v4 offset:44032
    s_waitcnt lgkmcnt(4)
    v_mfma_f32_16x16x32_bf16 v[78:81], v[86:89], v[178:181], v[78:81]
    ds_read_b128 v[82:85], v4 offset:45056
    s_waitcnt lgkmcnt(4)
    v_mfma_f32_16x16x32_bf16 v[62:65], v[90:93], v[182:185], v[62:65]
    ds_read_b128 v[86:89], v30 offset:0
    global_load_dwordx4 v[206:209], v26, s[38:39] offset:-4096 sc1
    s_waitcnt lgkmcnt(4)
    v_mfma_f32_16x16x32_bf16 v[66:69], v[94:97], v[182:185], v[66:69]
    ds_read_b128 v[90:93], v30 offset:1024
    s_waitcnt lgkmcnt(4)
    v_mfma_f32_16x16x32_bf16 v[70:73], v[98:101], v[182:185], v[70:73]
    ds_read_b128 v[94:97], v30 offset:2048
    global_load_dwordx4 v[210:213], v26, s[38:39] offset:-3072 sc1
    s_waitcnt lgkmcnt(4)
    v_mfma_f32_16x16x32_bf16 v[74:77], v[102:105], v[182:185], v[74:77]
    ds_read_b128 v[98:101], v30 offset:3072
    s_waitcnt lgkmcnt(4)
    v_mfma_f32_16x16x32_bf16 v[78:81], v[82:85], v[182:185], v[78:81]
    ds_read_b128 v[102:105], v30 offset:4096
    s_waitcnt lgkmcnt(4)
    v_mfma_f32_16x16x32_bf16 v[62:65], v[86:89], v[186:189], v[62:65]
    ds_read_b128 v[82:85], v30 offset:15360
    global_load_dwordx4 v[214:217], v26, s[38:39] offset:-2048 sc1
    s_waitcnt lgkmcnt(4)
    v_mfma_f32_16x16x32_bf16 v[66:69], v[90:93], v[186:189], v[66:69]
    ds_read_b128 v[86:89], v30 offset:16384
    s_waitcnt lgkmcnt(4)
    v_mfma_f32_16x16x32_bf16 v[70:73], v[94:97], v[186:189], v[70:73]
    ds_read_b128 v[90:93], v30 offset:17408
    s_waitcnt lgkmcnt(4)
    v_mfma_f32_16x16x32_bf16 v[74:77], v[98:101], v[186:189], v[74:77]
    ds_read_b128 v[94:97], v30 offset:18432
    global_load_dwordx4 v[218:221], v26, s[38:39] offset:-1024 sc1
    s_waitcnt lgkmcnt(4)
    v_mfma_f32_16x16x32_bf16 v[78:81], v[102:105], v[186:189], v[78:81]
    ds_read_b128 v[98:101], v30 offset:19456
    s_waitcnt lgkmcnt(4)
    v_mfma_f32_16x16x32_bf16 v[62:65], v[82:85], v[190:193], v[62:65]
    ds_read_b128 v[102:105], v30 offset:35840
    global_load_dwordx4 v[222:225], v26, s[38:39] offset:0 sc1
    s_waitcnt lgkmcnt(4)
    v_mfma_f32_16x16x32_bf16 v[66:69], v[86:89], v[190:193], v[66:69]
    ds_read_b128 v[82:85], v30 offset:36864
    s_waitcnt lgkmcnt(4)
    v_mfma_f32_16x16x32_bf16 v[70:73], v[90:93], v[190:193], v[70:73]
    ds_read_b128 v[86:89], v30 offset:37888
    s_waitcnt lgkmcnt(4)
    v_mfma_f32_16x16x32_bf16 v[74:77], v[94:97], v[190:193], v[74:77]
    ds_read_b128 v[90:93], v30 offset:38912
    global_load_dwordx4 v[226:229], v26, s[38:39] offset:1024 sc1
    s_waitcnt lgkmcnt(4)
    v_mfma_f32_16x16x32_bf16 v[78:81], v[98:101], v[190:193], v[78:81]
    ds_read_b128 v[94:97], v30 offset:39936
    s_waitcnt lgkmcnt(4)
    v_mfma_f32_16x16x32_bf16 v[62:65], v[102:105], v[194:197], v[62:65]
    ds_read_b128 v[98:101], v30 offset:51200
    s_waitcnt lgkmcnt(4)
    v_mfma_f32_16x16x32_bf16 v[66:69], v[82:85], v[194:197], v[66:69]
    ds_read_b128 v[102:105], v30 offset:52224
    global_load_dwordx4 v[230:233], v26, s[38:39] offset:2048 sc1
    s_waitcnt lgkmcnt(4)
    v_mfma_f32_16x16x32_bf16 v[70:73], v[86:89], v[194:197], v[70:73]
    ds_read_b128 v[82:85], v30 offset:53248
    s_waitcnt lgkmcnt(4)
    v_mfma_f32_16x16x32_bf16 v[74:77], v[90:93], v[194:197], v[74:77]
    ds_read_b128 v[86:89], v30 offset:54272
    s_waitcnt lgkmcnt(4)
    v_mfma_f32_16x16x32_bf16 v[78:81], v[94:97], v[194:197], v[78:81]
    ds_read_b128 v[90:93], v30 offset:55296
    global_load_dwordx4 v[238:241], v27, s[38:39] offset:-4096 sc1
    s_waitcnt lgkmcnt(4)
    v_mfma_f32_16x16x32_bf16 v[62:65], v[98:101], v[198:201], v[62:65]
    ds_read_b128 v[94:97], v31 offset:10240
    s_waitcnt lgkmcnt(4)
    v_mfma_f32_16x16x32_bf16 v[66:69], v[102:105], v[198:201], v[66:69]
    ds_read_b128 v[98:101], v31 offset:11264
    global_load_dwordx4 v[242:245], v27, s[38:39] offset:-3072 sc1
    s_waitcnt lgkmcnt(4)
    v_mfma_f32_16x16x32_bf16 v[70:73], v[82:85], v[198:201], v[70:73]
    ds_read_b128 v[102:105], v31 offset:12288
    s_waitcnt lgkmcnt(4)
    v_mfma_f32_16x16x32_bf16 v[74:77], v[86:89], v[198:201], v[74:77]
    ds_read_b128 v[82:85], v31 offset:13312
    s_waitcnt lgkmcnt(4)
    v_mfma_f32_16x16x32_bf16 v[78:81], v[90:93], v[198:201], v[78:81]
    ds_read_b128 v[86:89], v31 offset:14336
    global_load_dwordx4 v[246:249], v27, s[38:39] offset:-2048 sc1
    s_waitcnt lgkmcnt(4)
    v_mfma_f32_16x16x32_bf16 v[62:65], v[94:97], v[202:205], v[62:65]
    ds_read_b128 v[90:93], v4 offset:10240
    s_waitcnt lgkmcnt(4)
    v_mfma_f32_16x16x32_bf16 v[66:69], v[98:101], v[202:205], v[66:69]
    ds_read_b128 v[94:97], v4 offset:11264
    s_waitcnt lgkmcnt(4)
    v_mfma_f32_16x16x32_bf16 v[70:73], v[102:105], v[202:205], v[70:73]
    ds_read_b128 v[98:101], v4 offset:12288
    global_load_dwordx4 v[250:253], v27, s[38:39] offset:-1024 sc1
    s_waitcnt lgkmcnt(4)
    v_mfma_f32_16x16x32_bf16 v[74:77], v[82:85], v[202:205], v[74:77]
    ds_read_b128 v[102:105], v4 offset:13312
    s_waitcnt lgkmcnt(4)
    v_mfma_f32_16x16x32_bf16 v[78:81], v[86:89], v[202:205], v[78:81]
    ds_read_b128 v[82:85], v4 offset:14336
    v_lshlrev_b32 v29, 5, v3
    v_add_u32 v29, 162816, v29
    ds_read_b128 v[106:109], v29 offset:0
    ds_read_b128 v[110:113], v29 offset:16
    ds_read_b128 v[114:117], v29 offset:128
    ds_read_b128 v[118:121], v29 offset:144
    v_lshlrev_b32 v29, 4, v3
    v_add_u32 v29, 162816, v29
    ds_read_b128 v[122:125], v29 offset:256
    v_lshlrev_b32 v126, 16, v36
    v_and_b32 v127, 0xffff0000, v36
    v_lshlrev_b32 v128, 16, v37
    v_and_b32 v129, 0xffff0000, v37
    v_lshlrev_b32 v130, 16, v38
    v_and_b32 v131, 0xffff0000, v38
    v_lshlrev_b32 v132, 16, v39
    v_and_b32 v133, 0xffff0000, v39
    v_lshlrev_b32 v134, 16, v40
    v_and_b32 v135, 0xffff0000, v40
    v_lshlrev_b32 v136, 16, v41
    v_and_b32 v137, 0xffff0000, v41
    v_lshlrev_b32 v138, 16, v42
    v_and_b32 v139, 0xffff0000, v42
    v_lshlrev_b32 v140, 16, v43
    v_and_b32 v141, 0xffff0000, v43
    v_lshlrev_b32 v12, 16, v44
    v_and_b32 v13, 0xffff0000, v44
    v_lshlrev_b32 v14, 16, v45
    v_and_b32 v15, 0xffff0000, v45
    v_add_u32 v46, s90, v5
    v_mul_u32_u24 v46, 1280, v46
    s_mul_i32 s4, s41, 160
    v_add_u32 v46, s4, v46
    v_lshl_add_u32 v47, v3, 4, v46
    v_lshl_add_u32 v46, v3, 3, v46
    s_waitcnt vmcnt(8)
    v_or3_b32 v28, v209, v213, v217
    s_waitcnt vmcnt(6)
    v_or3_b32 v28, v221, v225, v28
    s_waitcnt vmcnt(4)
    v_or3_b32 v28, v229, v233, v28
    v_and_b32 v28, 1, v28
    v_cmp_ne_u32 vcc, 0, v28
    s_nop 0
    s_cbranch_vccnz Lp2_r
Lp2_ok:
    s_waitcnt lgkmcnt(9)
    v_mfma_f32_16x16x32_bf16 v[62:65], v[90:93], v[206:209], v[62:65]
    ds_read_b128 v[86:89], v4 offset:30720
    s_waitcnt lgkmcnt(9)
    v_mfma_f32_16x16x32_bf16 v[66:69], v[94:97], v[206:209], v[66:69]
    ds_read_b128 v[90:93], v4 offset:31744
    s_waitcnt lgkmcnt(9)
    v_mfma_f32_16x16x32_bf16 v[70:73], v[98:101], v[206:209], v[70:73]
    ds_read_b128 v[94:97], v4 offset:32768
    s_waitcnt lgkmcnt(9)
    v_mfma_f32_16x16x32_bf16 v[74:77], v[102:105], v[206:209], v[74:77]
    ds_read_b128 v[98:101], v4 offset:33792
    s_waitcnt lgkmcnt(9)
    v_mfma_f32_16x16x32_bf16 v[78:81], v[82:85], v[206:209], v[78:81]
    ds_read_b128 v[102:105], v4 offset:34816
    s_waitcnt lgkmcnt(4)
    v_mfma_f32_16x16x32_bf16 v[62:65], v[86:89], v[210:213], v[62:65]
    ds_read_b128 v[82:85], v4 offset:46080
    s_waitcnt lgkmcnt(4)
    v_mfma_f32_16x16x32_bf16 v[66:69], v[90:93], v[210:213], v[66:69]
    ds_read_b128 v[86:89], v4 offset:47104
    s_waitcnt lgkmcnt(4)
    v_mfma_f32_16x16x32_bf16 v[70:73], v[94:97], v[210:213], v[70:73]
    ds_read_b128 v[90:93], v4 offset:48128
    s_waitcnt lgkmcnt(4)
    v_mfma_f32_16x16x32_bf16 v[74:77], v[98:101], v[210:213], v[74:77]
    ds_read_b128 v[94:97], v4 offset:49152
    s_waitcnt lgkmcnt(4)
    v_mfma_f32_16x16x32_bf16 v[78:81], v[102:105], v[210:213], v[78:81]
    ds_read_b128 v[98:101], v4 offset:50176
    s_waitcnt lgkmcnt(4)
    v_mfma_f32_16x16x32_bf16 v[62:65], v[82:85], v[214:217], v[62:65]
    ds_read_b128 v[102:105], v30 offset:5120
    s_waitcnt lgkmcnt(4)
    v_mfma_f32_16x16x32_bf16 v[66:69], v[86:89], v[214:217], v[66:69]
    ds_read_b128 v[82:85], v30 offset:6144
    s_waitcnt lgkmcnt(4)
    v_mfma_f32_16x16x32_bf16 v[70:73], v[90:93], v[214:217], v[70:73]
    ds_read_b128 v[86:89], v30 offset:7168
    s_waitcnt lgkmcnt(4)
    v_mfma_f32_16x16x32_bf16 v[74:77], v[94:97], v[214:217], v[74:77]
    ds_read_b128 v[90:93], v30 offset:8192
    s_waitcnt lgkmcnt(4)
    v_mfma_f32_16x16x32_bf16 v[78:81], v[98:101], v[214:217], v[78:81]
    ds_read_b128 v[94:97], v30 offset:9216
    s_waitcnt lgkmcnt(4)
    v_mfma_f32_16x16x32_bf16 v[62:65], v[102:105], v[218:221], v[62:65]
    ds_read_b128 v[98:101], v30 offset:20480
    s_waitcnt lgkmcnt(4)
    v_mfma_f32_16x16x32_bf16 v[66:69], v[82:85], v[218:221], v[66:69]
    ds_read_b128 v[102:105], v30 offset:21504
    s_waitcnt lgkmcnt(4)
    v_mfma_f32_16x16x32_bf16 v[70:73], v[86:89], v[218:221], v[70:73]
    ds_read_b128 v[82:85], v30 offset:22528
    s_waitcnt lgkmcnt(4)
    v_mfma_f32_16x16x32_bf16 v[74:77], v[90:93], v[218:221], v[74:77]
    ds_read_b128 v[86:89], v30 offset:23552
    s_waitcnt lgkmcnt(4)
    v_mfma_f32_16x16x32_bf16 v[78:81], v[94:97], v[218:221], v[78:81]
    ds_read_b128 v[90:93], v30 offset:24576
    s_waitcnt lgkmcnt(4)
    v_mfma_f32_16x16x32_bf16 v[62:65], v[98:101], v[222:225], v[62:65]
    ds_read_b128 v[94:97], v30 offset:40960
    s_waitcnt lgkmcnt(4)
    v_mfma_f32_16x16x32_bf16 v[66:69], v[102:105], v[222:225], v[66:69]
    ds_read_b128 v[98:101], v30 offset:41984
    s_waitcnt lgkmcnt(4)
    v_mfma_f32_16x16x32_bf16 v[70:73], v[82:85], v[222:225], v[70:73]
    ds_read_b128 v[102:105], v30 offset:43008
    s_waitcnt lgkmcnt(4)
    v_mfma_f32_16x16x32_bf16 v[74:77], v[86:89], v[222:225], v[74:77]
    ds_read_b128 v[82:85], v30 offset:44032
    s_waitcnt lgkmcnt(4)
    v_mfma_f32_16x16x32_bf16 v[78:81], v[90:93], v[222:225], v[78:81]
    ds_read_b128 v[86:89], v30 offset:45056
    s_waitcnt lgkmcnt(4)
    v_mfma_f32_16x16x32_bf16 v[62:65], v[94:97], v[226:229], v[62:65]
    ds_read_b128 v[90:93], v30 offset:56320
    s_waitcnt lgkmcnt(4)
    v_mfma_f32_16x16x32_bf16 v[66:69], v[98:101], v[226:229], v[66:69]
    ds_read_b128 v[94:97], v30 offset:57344
    s_waitcnt lgkmcnt(4)
    v_mfma_f32_16x16x32_bf16 v[70:73], v[102:105], v[226:229], v[70:73]
    ds_read_b128 v[98:101], v30 offset:58368
    s_waitcnt lgkmcnt(4)
    v_mfma_f32_16x16x32_bf16 v[74:77], v[82:85], v[226:229], v[74:77]
    ds_read_b128 v[102:105], v30 offset:59392
    s_waitcnt lgkmcnt(4)
    v_mfma_f32_16x16x32_bf16 v[78:81], v[86:89], v[226:229], v[78:81]
    ds_read_b128 v[82:85], v30 offset:60416
    s_waitcnt lgkmcnt(4)
    v_mfma_f32_16x16x32_bf16 v[62:65], v[90:93], v[230:233], v[62:65]
    ds_read_b128 v[86:89], v4 offset:15360
    s_waitcnt lgkmcnt(4)
    v_mfma_f32_16x16x32_bf16 v[66:69], v[94:97], v[230:233], v[66:69]
    ds_read_b128 v[90:93], v4 offset:16384
    s_waitcnt lgkmcnt(4)
    v_mfma_f32_16x16x32_bf16 v[70:73], v[98:101], v[230:233], v[70:73]
    ds_read_b128 v[94:97], v4 offset:17408
    s_waitcnt lgkmcnt(4)
    v_mfma_f32_16x16x32_bf16 v[74:77], v[102:105], v[230:233], v[74:77]
    ds_read_b128 v[98:101], v4 offset:18432
    s_waitcnt lgkmcnt(4)
    v_mfma_f32_16x16x32_bf16 v[78:81], v[82:85], v[230:233], v[78:81]
    ds_read_b128 v[102:105], v4 offset:19456
    s_waitcnt vmcnt(3)
    v_or_b32 v28, v239, v241
    s_waitcnt vmcnt(2)
    v_or3_b32 v28, v243, v245, v28
    s_waitcnt vmcnt(1)
    v_or3_b32 v28, v247, v249, v28
    s_waitcnt vmcnt(0)
    v_or3_b32 v28, v251, v253, v28
    v_and_b32 v28, 1, v28
    v_cmp_ne_u32 vcc, 0, v28
    s_nop 0
    s_cbranch_vccnz Lp3_r
Lp3_ok:
    s_waitcnt lgkmcnt(4)
    v_mfma_f32_16x16x32_bf16 v[62:65], v[86:89], v[238:241], v[62:65]
    ds_read_b128 v[82:85], v4 offset:51200
    s_waitcnt lgkmcnt(4)
    v_mfma_f32_16x16x32_bf16 v[66:69], v[90:93], v[238:241], v[66:69]
    ds_read_b128 v[86:89], v4 offset:52224
    s_waitcnt lgkmcnt(4)
    v_mfma_f32_16x16x32_bf16 v[70:73], v[94:97], v[238:241], v[70:73]
    ds_read_b128 v[90:93], v4 offset:53248
    s_waitcnt lgkmcnt(4)
    v_mfma_f32_16x16x32_bf16 v[74:77], v[98:101], v[238:241], v[74:77]
    ds_read_b128 v[94:97], v4 offset:54272
    s_waitcnt lgkmcnt(4)
    v_mfma_f32_16x16x32_bf16 v[78:81], v[102:105], v[238:241], v[78:81]
    ds_read_b128 v[98:101], v4 offset:55296
    s_waitcnt lgkmcnt(4)
    v_mfma_f32_16x16x32_bf16 v[62:65], v[82:85], v[242:245], v[62:65]
    ds_read_b128 v[102:105], v30 offset:25600
    s_waitcnt lgkmcnt(4)
    v_mfma_f32_16x16x32_bf16 v[66:69], v[86:89], v[242:245], v[66:69]
    ds_read_b128 v[82:85], v30 offset:26624
    s_waitcnt lgkmcnt(4)
    v_mfma_f32_16x16x32_bf16 v[70:73], v[90:93], v[242:245], v[70:73]
    ds_read_b128 v[86:89], v30 offset:27648
    s_waitcnt lgkmcnt(4)
    v_mfma_f32_16x16x32_bf16 v[74:77], v[94:97], v[242:245], v[74:77]
    ds_read_b128 v[90:93], v30 offset:28672
    s_waitcnt lgkmcnt(4)
    v_mfma_f32_16x16x32_bf16 v[78:81], v[98:101], v[242:245], v[78:81]
    ds_read_b128 v[94:97], v30 offset:29696
    s_waitcnt lgkmcnt(4)
    v_mfma_f32_16x16x32_bf16 v[62:65], v[102:105], v[246:249], v[62:65]
    ds_read_b128 v[98:101], v31 offset:0
    s_waitcnt lgkmcnt(4)
    v_mfma_f32_16x16x32_bf16 v[66:69], v[82:85], v[246:249], v[66:69]
    ds_read_b128 v[102:105], v31 offset:1024
    s_waitcnt lgkmcnt(4)
    v_mfma_f32_16x16x32_bf16 v[70:73], v[86:89], v[246:249], v[70:73]
    ds_read_b128 v[82:85], v31 offset:2048
    s_waitcnt lgkmcnt(4)
    v_mfma_f32_16x16x32_bf16 v[74:77], v[90:93], v[246:249], v[74:77]
    ds_read_b128 v[86:89], v31 offset:3072
    s_waitcnt lgkmcnt(4)
    v_mfma_f32_16x16x32_bf16 v[78:81], v[94:97], v[246:249], v[78:81]
    ds_read_b128 v[90:93], v31 offset:4096
    s_waitcnt lgkmcnt(4)
    v_mfma_f32_16x16x32_bf16 v[62:65], v[98:101], v[250:253], v[62:65]
    s_waitcnt lgkmcnt(3)
    v_mfma_f32_16x16x32_bf16 v[66:69], v[102:105], v[250:253], v[66:69]
    s_waitcnt lgkmcnt(2)
    v_mfma_f32_16x16x32_bf16 v[70:73], v[82:85], v[250:253], v[70:73]
    s_waitcnt lgkmcnt(1)
    v_mfma_f32_16x16x32_bf16 v[74:77], v[86:89], v[250:253], v[74:77]
    s_waitcnt lgkmcnt(0)
    v_mfma_f32_16x16x32_bf16 v[78:81], v[90:93], v[250:253], v[78:81]
    v_fmac_f32 v126, v62, v106
    s_nop 0
    v_fmac_f32 v127, v66, v107
    v_fmac_f32 v128, v63, v108
    v_fmac_f32 v129, v67, v109
    v_fmac_f32 v130, v64, v110
    v_fmac_f32 v131, v68, v111
    v_fmac_f32 v132, v65, v112
    v_fmac_f32 v133, v69, v113
    v_cvt_pk_bf16_f32 v142, v126, v127
    v_cvt_pk_bf16_f32 v143, v128, v129
    v_cvt_pk_bf16_f32 v144, v130, v131
    v_cvt_pk_bf16_f32 v145, v132, v133
    global_store_dwordx4 v47, v[142:145], s[34:35] offset:0
    v_fmac_f32 v134, v70, v114
    v_fmac_f32 v135, v74, v115
    v_fmac_f32 v136, v71, v116
    v_fmac_f32 v137, v75, v117
    v_fmac_f32 v138, v72, v118
    v_fmac_f32 v139, v76, v119
    v_fmac_f32 v140, v73, v120
    v_fmac_f32 v141, v77, v121
    v_cvt_pk_bf16_f32 v146, v134, v135
    v_cvt_pk_bf16_f32 v147, v136, v137
    v_cvt_pk_bf16_f32 v148, v138, v139
    v_cvt_pk_bf16_f32 v149, v140, v141
    global_store_dwordx4 v47, v[146:149], s[34:35] offset:64
    v_fmac_f32 v12, v78, v122
    v_fmac_f32 v13, v79, v123
    v_fmac_f32 v14, v80, v124
    v_fmac_f32 v15, v81, v125
    v_cvt_pk_bf16_f32 v150, v12, v13
    v_cvt_pk_bf16_f32 v151, v14, v15
    global_store_dwordx2 v46, v[150:151], s[34:35] offset:128
Lflush:
Lend:
    s_endpgm
Lspare:
    s_sub_u32 s42, s2, 160
    s_cmp_lt_u32 s42, 54
    s_cbranch_scc0 Lsp_b
    s_cmp_ge_u32 s42, 8
    s_cbranch_scc1 Lsp_a2
    s_mov_b32 s48, s42
    v_mov_b32 v8, -1
    v_mov_b32 v9, -1
    v_mov_b32 v10, -1
    v_mov_b32 v11, -1
    s_mul_i32 s4, s48, 9216
    s_mul_i32 s5, s3, 2304
    s_add_u32 s4, s4, s5
    s_add_u32 s4, s4, 32768
    v_add_u32 v6, s4, v4
    global_store_dwordx4 v6, v[8:11], s[38:39] offset:0 sc1
    global_store_dwordx4 v6, v[8:11], s[38:39] offset:1024 sc1
    global_store_dwordx4 v6, v[8:11], s[38:39] offset:1280 sc1
    s_lshl_b32 s4, s48, 2
    v_mov_b32 v6, s4
    s_waitcnt vmcnt(0)
    s_barrier
    s_cmp_lg_u32 s3, 0
    s_cbranch_scc1 Linit_skip
    global_store_dword v6, v8, s[36:37] sc1
Linit_skip:
    s_branch Lsp_a2
Lsp_b:
    s_sub_u32 s48, s42, 54
    s_add_u32 s49, s48, 42
    s_add_u32 s50, s48, 84
    s_cmp_ge_u32 s50, 120
    s_cselect_b32 s50, s49, s50
    s_cmp_eq_u32 s3, 1
    s_cselect_b32 s51, s49, s48
    s_cmp_eq_u32 s3, 2
    s_cselect_b32 s51, s50, s51
    s_lshr_b32 s4, s51, 1
    s_and_b32 s5, s51, 1
    s_cmp_lt_u32 s4, 50
    s_cselect_b32 s6, -20, 0
    s_cmp_lt_u32 s4, 20
    s_cselect_b32 s6, 30, s6
    s_add_u32 s4, s4, s6
    s_mul_i32 s6, s5, 15360
    s_lshl_b32 s7, s4, 8
    s_add_u32 s51, s6, s7
    v_lshl_add_u32 v164, v1, 2, s51
    v_mov_b32 v165, -1
    global_store_dword v164, v165, s[38:39] offset:0 sc1
    s_lshr_b32 s4, s48, 1
    s_and_b32 s5, s48, 1
    s_cmp_lt_u32 s4, 50
    s_cselect_b32 s6, -20, 0
    s_cmp_lt_u32 s4, 20
    s_cselect_b32 s6, 30, s6
    s_add_u32 s4, s4, s6
    s_mul_i32 s6, s5, 15360
    s_lshl_b32 s7, s4, 8
    s_add_u32 s44, s6, s7
    s_lshl_b32 s5, s5, 2
    s_add_u32 s5, s5, s3
    s_mul_i32 s5, s5, 80
    s_lshl_b32 s4, s4, 7
    s_mul_i32 s6, s5, 7680
    s_add_u32 s4, s4, s6
    v_min_u32 v28, 39, v1
    s_lshl_b32 s5, s5, 1
    v_lshl_add_u32 v28, v28, 2, s5
    global_load_dword v80, v28, s[30:31]
    v_lshrrev_b32 v29, 3, v1
    v_mul_u32_u24 v28, 15232, v29
    v_add3_u32 v28, v28, v4, s4
    global_load_dwordx4 v[40:43], v28, s[32:33] nt
    v_add_u32 v28, 7680, v28
    global_load_dwordx4 v[44:47], v28, s[32:33] nt
    v_add_u32 v28, 115200, v28
    global_load_dwordx4 v[48:51], v28, s[32:33] nt
    v_add_u32 v28, 7680, v28
    global_load_dwordx4 v[52:55], v28, s[32:33] nt
    v_add_u32 v28, 115200, v28
    global_load_dwordx4 v[56:59], v28, s[32:33] nt
    v_add_u32 v28, 7680, v28
    global_load_dwordx4 v[60:63], v28, s[32:33] nt
    v_add_u32 v28, 115200, v28
    global_load_dwordx4 v[64:67], v28, s[32:33] nt
    v_add_u32 v28, 7680, v28
    global_load_dwordx4 v[68:71], v28, s[32:33] nt
    v_add_u32 v28, 115200, v28
    global_load_dwordx4 v[72:75], v28, s[32:33] nt
    v_add_u32 v28, 7680, v28
    global_load_dwordx4 v[76:79], v28, s[32:33] nt
    s_lshl_b32 s4, s48, 2
    s_add_u32 s4, s4, 60
    v_mov_b32 v164, s4
    s_waitcnt vmcnt(10)
    s_barrier
    s_cmp_lg_u32 s3, 0
    s_cbranch_scc1 Lsb_skip
    global_store_dword v164, v165, s[36:37] sc1
    s_branch Lsb_skip2
Lsb_skip:
    global_load_dword v165, v164, s[30:31]
Lsb_skip2:
    s_lshr_b32 s4, s49, 1
    s_and_b32 s5, s49, 1
    s_cmp_lt_u32 s4, 50
    s_cselect_b32 s6, -20, 0
    s_cmp_lt_u32 s4, 20
    s_cselect_b32 s6, 30, s6
    s_add_u32 s4, s4, s6
    s_mul_i32 s6, s5, 15360
    s_lshl_b32 s7, s4, 8
    s_add_u32 s45, s6, s7
    s_lshl_b32 s5, s5, 2
    s_add_u32 s5, s5, s3
    s_mul_i32 s5, s5, 80
    s_lshl_b32 s4, s4, 7
    s_mul_i32 s6, s5, 7680
    s_add_u32 s4, s4, s6
    v_min_u32 v96, 39, v1
    s_lshl_b32 s5, s5, 1
    v_lshl_add_u32 v96, v96, 2, s5
    global_load_dword v148, v96, s[30:31]
    v_lshrrev_b32 v97, 3, v1
    v_mul_u32_u24 v96, 15232, v97
    v_add3_u32 v96, v96, v4, s4
    global_load_dwordx4 v[108:111], v96, s[32:33] nt
    v_add_u32 v96, 7680, v96
    global_load_dwordx4 v[112:115], v96, s[32:33] nt
    v_add_u32 v96, 115200, v96
    global_load_dwordx4 v[116:119], v96, s[32:33] nt
    v_add_u32 v96, 7680, v96
    global_load_dwordx4 v[120:123], v96, s[32:33] nt
    v_add_u32 v96, 115200, v96
    global_load_dwordx4 v[124:127], v96, s[32:33] nt
    v_add_u32 v96, 7680, v96
    global_load_dwordx4 v[128:131], v96, s[32:33] nt
    v_add_u32 v96, 115200, v96
    global_load_dwordx4 v[132:135], v96, s[32:33] nt
    v_add_u32 v96, 7680, v96
    global_load_dwordx4 v[136:139], v96, s[32:33] nt
    v_add_u32 v96, 115200, v96
    global_load_dwordx4 v[140:143], v96, s[32:33] nt
    v_add_u32 v96, 7680, v96
    v_lshlrev_b32 v82, 16, v80
    v_and_b32 v83, 0xffff0000, v80
    v_lshlrev_b32 v29, 2, v29
    v_mul_f32 v84, 0xbfb8aa3b, v82
    v_mul_f32 v85, 0xbfb8aa3b, v83
    v_exp_f32 v84, v84
    v_exp_f32 v85, v85
    v_add_f32 v84, 1.0, v84
    v_add_f32 v85, 1.0, v85
    v_rcp_f32 v84, v84
    v_rcp_f32 v85, v85
    v_mul_f32 v82, v82, v84
    v_mul_f32 v83, v83, v85
    v_cvt_pk_bf16_f32 v80, v82, v83
    ds_bpermute_b32 v88, v29, v80 offset:0
    ds_bpermute_b32 v89, v29, v80 offset:32
    ds_bpermute_b32 v90, v29, v80 offset:64
    ds_bpermute_b32 v91, v29, v80 offset:96
    ds_bpermute_b32 v92, v29, v80 offset:128
    s_waitcnt lgkmcnt(4)
    v_lshlrev_b32 v30, 16, v88
    v_and_b32 v31, 0xffff0000, v88
    s_waitcnt lgkmcnt(3)
    v_lshlrev_b32 v32, 16, v89
    v_and_b32 v33, 0xffff0000, v89
    s_waitcnt lgkmcnt(2)
    v_lshlrev_b32 v34, 16, v90
    v_and_b32 v35, 0xffff0000, v90
    s_waitcnt lgkmcnt(1)
    v_lshlrev_b32 v36, 16, v91
    v_and_b32 v37, 0xffff0000, v91
    s_waitcnt lgkmcnt(0)
    v_lshlrev_b32 v38, 16, v92
    v_and_b32 v39, 0xffff0000, v92
    s_waitcnt vmcnt(20)
    v_lshlrev_b32 v80, 16, v40
    v_and_b32 v81, 0xffff0000, v40
    v_lshlrev_b32 v82, 16, v41
    v_and_b32 v83, 0xffff0000, v41
    v_lshlrev_b32 v84, 16, v42
    v_and_b32 v85, 0xffff0000, v42
    v_lshlrev_b32 v86, 16, v43
    v_and_b32 v87, 0xffff0000, v43
    v_pk_mul_f32 v[88:89], v[30:31], v[80:81] op_sel:[0,0] op_sel_hi:[0,1]
    v_pk_mul_f32 v[90:91], v[30:31], v[82:83] op_sel:[0,0] op_sel_hi:[0,1]
    v_pk_mul_f32 v[92:93], v[30:31], v[84:85] op_sel:[0,0] op_sel_hi:[0,1]
    v_pk_mul_f32 v[94:95], v[30:31], v[86:87] op_sel:[0,0] op_sel_hi:[0,1]
    s_waitcnt vmcnt(19)
    v_lshlrev_b32 v80, 16, v44
    v_and_b32 v81, 0xffff0000, v44
    v_lshlrev_b32 v82, 16, v45
    v_and_b32 v83, 0xffff0000, v45
    v_lshlrev_b32 v84, 16, v46
    v_and_b32 v85, 0xffff0000, v46
    v_lshlrev_b32 v86, 16, v47
    v_and_b32 v87, 0xffff0000, v47
    v_pk_fma_f32 v[88:89], v[30:31], v[80:81], v[88:89] op_sel:[1,0,0] op_sel_hi:[1,1,1]
    v_pk_fma_f32 v[90:91], v[30:31], v[82:83], v[90:91] op_sel:[1,0,0] op_sel_hi:[1,1,1]
    v_pk_fma_f32 v[92:93], v[30:31], v[84:85], v[92:93] op_sel:[1,0,0] op_sel_hi:[1,1,1]
    v_pk_fma_f32 v[94:95], v[30:31], v[86:87], v[94:95] op_sel:[1,0,0] op_sel_hi:[1,1,1]
    s_waitcnt vmcnt(18)
    v_lshlrev_b32 v80, 16, v48
    v_and_b32 v81, 0xffff0000, v48
    v_lshlrev_b32 v82, 16, v49
    v_and_b32 v83, 0xffff0000, v49
    v_lshlrev_b32 v84, 16, v50
    v_and_b32 v85, 0xffff0000, v50
    v_lshlrev_b32 v86, 16, v51
    v_and_b32 v87, 0xffff0000, v51
    v_pk_fma_f32 v[88:89], v[32:33], v[80:81], v[88:89] op_sel:[0,0,0] op_sel_hi:[0,1,1]
    v_pk_fma_f32 v[90:91], v[32:33], v[82:83], v[90:91] op_sel:[0,0,0] op_sel_hi:[0,1,1]
    v_pk_fma_f32 v[92:93], v[32:33], v[84:85], v[92:93] op_sel:[0,0,0] op_sel_hi:[0,1,1]
    v_pk_fma_f32 v[94:95], v[32:33], v[86:87], v[94:95] op_sel:[0,0,0] op_sel_hi:[0,1,1]
    s_waitcnt vmcnt(17)
    v_lshlrev_b32 v80, 16, v52
    v_and_b32 v81, 0xffff0000, v52
    v_lshlrev_b32 v82, 16, v53
    v_and_b32 v83, 0xffff0000, v53
    v_lshlrev_b32 v84, 16, v54
    v_and_b32 v85, 0xffff0000, v54
    v_lshlrev_b32 v86, 16, v55
    v_and_b32 v87, 0xffff0000, v55
    v_pk_fma_f32 v[88:89], v[32:33], v[80:81], v[88:89] op_sel:[1,0,0] op_sel_hi:[1,1,1]
    v_pk_fma_f32 v[90:91], v[32:33], v[82:83], v[90:91] op_sel:[1,0,0] op_sel_hi:[1,1,1]
    v_pk_fma_f32 v[92:93], v[32:33], v[84:85], v[92:93] op_sel:[1,0,0] op_sel_hi:[1,1,1]
    v_pk_fma_f32 v[94:95], v[32:33], v[86:87], v[94:95] op_sel:[1,0,0] op_sel_hi:[1,1,1]
    s_waitcnt vmcnt(16)
    v_lshlrev_b32 v80, 16, v56
    v_and_b32 v81, 0xffff0000, v56
    v_lshlrev_b32 v82, 16, v57
    v_and_b32 v83, 0xffff0000, v57
    v_lshlrev_b32 v84, 16, v58
    v_and_b32 v85, 0xffff0000, v58
    v_lshlrev_b32 v86, 16, v59
    v_and_b32 v87, 0xffff0000, v59
    v_pk_fma_f32 v[88:89], v[34:35], v[80:81], v[88:89] op_sel:[0,0,0] op_sel_hi:[0,1,1]
    v_pk_fma_f32 v[90:91], v[34:35], v[82:83], v[90:91] op_sel:[0,0,0] op_sel_hi:[0,1,1]
    v_pk_fma_f32 v[92:93], v[34:35], v[84:85], v[92:93] op_sel:[0,0,0] op_sel_hi:[0,1,1]
    v_pk_fma_f32 v[94:95], v[34:35], v[86:87], v[94:95] op_sel:[0,0,0] op_sel_hi:[0,1,1]
    s_waitcnt vmcnt(15)
    v_lshlrev_b32 v80, 16, v60
    v_and_b32 v81, 0xffff0000, v60
    v_lshlrev_b32 v82, 16, v61
    v_and_b32 v83, 0xffff0000, v61
    v_lshlrev_b32 v84, 16, v62
    v_and_b32 v85, 0xffff0000, v62
    v_lshlrev_b32 v86, 16, v63
    v_and_b32 v87, 0xffff0000, v63
    v_pk_fma_f32 v[88:89], v[34:35], v[80:81], v[88:89] op_sel:[1,0,0] op_sel_hi:[1,1,1]
    v_pk_fma_f32 v[90:91], v[34:35], v[82:83], v[90:91] op_sel:[1,0,0] op_sel_hi:[1,1,1]
    v_pk_fma_f32 v[92:93], v[34:35], v[84:85], v[92:93] op_sel:[1,0,0] op_sel_hi:[1,1,1]
    v_pk_fma_f32 v[94:95], v[34:35], v[86:87], v[94:95] op_sel:[1,0,0] op_sel_hi:[1,1,1]
    s_waitcnt vmcnt(14)
    v_lshlrev_b32 v80, 16, v64
    v_and_b32 v81, 0xffff0000, v64
    v_lshlrev_b32 v82, 16, v65
    v_and_b32 v83, 0xffff0000, v65
    v_lshlrev_b32 v84, 16, v66
    v_and_b32 v85, 0xffff0000, v66
    v_lshlrev_b32 v86, 16, v67
    v_and_b32 v87, 0xffff0000, v67
    v_pk_fma_f32 v[88:89], v[36:37], v[80:81], v[88:89] op_sel:[0,0,0] op_sel_hi:[0,1,1]
    v_pk_fma_f32 v[90:91], v[36:37], v[82:83], v[90:91] op_sel:[0,0,0] op_sel_hi:[0,1,1]
    v_pk_fma_f32 v[92:93], v[36:37], v[84:85], v[92:93] op_sel:[0,0,0] op_sel_hi:[0,1,1]
    v_pk_fma_f32 v[94:95], v[36:37], v[86:87], v[94:95] op_sel:[0,0,0] op_sel_hi:[0,1,1]
    s_waitcnt vmcnt(13)
    v_lshlrev_b32 v80, 16, v68
    v_and_b32 v81, 0xffff0000, v68
    v_lshlrev_b32 v82, 16, v69
    v_and_b32 v83, 0xffff0000, v69
    v_lshlrev_b32 v84, 16, v70
    v_and_b32 v85, 0xffff0000, v70
    v_lshlrev_b32 v86, 16, v71
    v_and_b32 v87, 0xffff0000, v71
    v_pk_fma_f32 v[88:89], v[36:37], v[80:81], v[88:89] op_sel:[1,0,0] op_sel_hi:[1,1,1]
    v_pk_fma_f32 v[90:91], v[36:37], v[82:83], v[90:91] op_sel:[1,0,0] op_sel_hi:[1,1,1]
    v_pk_fma_f32 v[92:93], v[36:37], v[84:85], v[92:93] op_sel:[1,0,0] op_sel_hi:[1,1,1]
    v_pk_fma_f32 v[94:95], v[36:37], v[86:87], v[94:95] op_sel:[1,0,0] op_sel_hi:[1,1,1]
    s_waitcnt vmcnt(12)
    v_lshlrev_b32 v80, 16, v72
    v_and_b32 v81, 0xffff0000, v72
    v_lshlrev_b32 v82, 16, v73
    v_and_b32 v83, 0xffff0000, v73
    v_lshlrev_b32 v84, 16, v74
    v_and_b32 v85, 0xffff0000, v74
    v_lshlrev_b32 v86, 16, v75
    v_and_b32 v87, 0xffff0000, v75
    v_pk_fma_f32 v[88:89], v[38:39], v[80:81], v[88:89] op_sel:[0,0,0] op_sel_hi:[0,1,1]
    v_pk_fma_f32 v[90:91], v[38:39], v[82:83], v[90:91] op_sel:[0,0,0] op_sel_hi:[0,1,1]
    v_pk_fma_f32 v[92:93], v[38:39], v[84:85], v[92:93] op_sel:[0,0,0] op_sel_hi:[0,1,1]
    v_pk_fma_f32 v[94:95], v[38:39], v[86:87], v[94:95] op_sel:[0,0,0] op_sel_hi:[0,1,1]
    s_waitcnt vmcnt(11)
    v_lshlrev_b32 v80, 16, v76
    v_and_b32 v81, 0xffff0000, v76
    v_lshlrev_b32 v82, 16, v77
    v_and_b32 v83, 0xffff0000, v77
    v_lshlrev_b32 v84, 16, v78
    v_and_b32 v85, 0xffff0000, v78
    v_lshlrev_b32 v86, 16, v79
    v_and_b32 v87, 0xffff0000, v79
    v_pk_fma_f32 v[88:89], v[38:39], v[80:81], v[88:89] op_sel:[1,0,0] op_sel_hi:[1,1,1]
    v_pk_fma_f32 v[90:91], v[38:39], v[82:83], v[90:91] op_sel:[1,0,0] op_sel_hi:[1,1,1]
    v_pk_fma_f32 v[92:93], v[38:39], v[84:85], v[92:93] op_sel:[1,0,0] op_sel_hi:[1,1,1]
    v_pk_fma_f32 v[94:95], v[38:39], v[86:87], v[94:95] op_sel:[1,0,0] op_sel_hi:[1,1,1]
    s_nop 0
    v_permlane32_swap_b32 v88, v92
    v_permlane32_swap_b32 v89, v93
    v_permlane32_swap_b32 v90, v94
    v_permlane32_swap_b32 v91, v95
    v_add_f32 v88, v88, v92
    v_add_f32 v89, v89, v93
    v_add_f32 v90, v90, v94
    v_add_f32 v91, v91, v95
    s_nop 0
    v_permlane16_swap_b32 v88, v90
    v_permlane16_swap_b32 v89, v91
    v_add_f32 v88, v88, v90
    v_add_f32 v89, v89, v91
    v_and_b32 v81, 7, v1
    v_lshrrev_b32 v82, 3, v1
    v_add_f32_dpp v80, v88, v88 row_ror:8 row_mask:0xf bank_mask:0x3
    s_nop 1
    v_add_f32_dpp v80, v89, v89 row_ror:8 row_mask:0xf bank_mask:0xc
    v_lshl_add_u32 v81, v81, 3, v82
    s_lshl_b32 s7, s3, 8
    s_add_u32 s7, s7, 122880
    v_lshl_add_u32 v81, v81, 2, s7
    ds_write_b32 v81, v80
    s_waitcnt lgkmcnt(0)
    s_barrier
    v_lshlrev_b32 v81, 2, v1
    v_add_u32 v82, 122880, v81
    ds_read_b32 v88, v82 offset:0
    ds_read_b32 v89, v82 offset:256
    ds_read_b32 v90, v82 offset:512
    ds_read_b32 v91, v82 offset:768
    v_add_u32 v81, s44, v81
    s_waitcnt lgkmcnt(2)
    v_add_f32 v88, v88, v89
    s_waitcnt lgkmcnt(0)
    v_add_f32 v90, v90, v91
    v_add_f32 v88, v88, v90
    v_min_u32 v88, -2, v88
    s_cmp_lg_u32 s3, 0
    s_cbranch_scc1 Lmod_skip_s1
    global_store_dword v81, v88, s[38:39] offset:0 sc1
Lmod_skip_s1:
    global_load_dwordx4 v[144:147], v96, s[32:33] nt
    s_cmp_ge_u32 s48, 27
    s_cbranch_scc1 Lsb_n3
    s_mul_i32 s4, s48, 40960
    s_mul_i32 s5, s3, 10240
    s_add_u32 s4, s4, s5
    v_lshl_add_u32 v164, v1, 4, s4
    s_add_u32 m0, s5, 0
    s_nop 0
    global_load_lds_dwordx4 v164, s[28:29] offset:0 nt
    global_load_lds_dwordx4 v164, s[28:29] offset:1024 nt
    global_load_lds_dwordx4 v164, s[28:29] offset:2048 nt
    global_load_lds_dwordx4 v164, s[28:29] offset:3072 nt
    s_add_u32 m0, s5, 4096
    v_add_u32 v164, 4096, v164
    global_load_lds_dwordx4 v164, s[28:29] offset:0 nt
    global_load_lds_dwordx4 v164, s[28:29] offset:1024 nt
    global_load_lds_dwordx4 v164, s[28:29] offset:2048 nt
    global_load_lds_dwordx4 v164, s[28:29] offset:3072 nt
    s_add_u32 m0, s5, 8192
    v_add_u32 v164, 4096, v164
    global_load_lds_dwordx4 v164, s[28:29] offset:0 nt
    global_load_lds_dwordx4 v164, s[28:29] offset:1024 nt
    s_waitcnt vmcnt(10)
    s_branch Lsb_n4
Lsb_n3:
    s_add_u32 s50, s48, 78
    s_lshr_b32 s4, s50, 1
    s_and_b32 s5, s50, 1
    s_cmp_lt_u32 s4, 50
    s_cselect_b32 s6, -20, 0
    s_cmp_lt_u32 s4, 20
    s_cselect_b32 s6, 30, s6
    s_add_u32 s4, s4, s6
    s_mul_i32 s6, s5, 15360
    s_lshl_b32 s7, s4, 8
    s_add_u32 s44, s6, s7
    s_lshl_b32 s5, s5, 2
    s_add_u32 s5, s5, s3
    s_mul_i32 s5, s5, 80
    s_lshl_b32 s4, s4, 7
    s_mul_i32 s6, s5, 7680
    s_add_u32 s4, s4, s6
    v_min_u32 v28, 39, v1
    s_lshl_b32 s5, s5, 1
    v_lshl_add_u32 v28, v28, 2, s5
    global_load_dword v80, v28, s[30:31]
    v_lshrrev_b32 v29, 3, v1
    v_mul_u32_u24 v28, 15232, v29
    v_add3_u32 v28, v28, v4, s4
    global_load_dwordx4 v[40:43], v28, s[32:33] nt
    v_add_u32 v28, 7680, v28
    global_load_dwordx4 v[44:47], v28, s[32:33] nt
    v_add_u32 v28, 115200, v28
    global_load_dwordx4 v[48:51], v28, s[32:33] nt
    v_add_u32 v28, 7680, v28
    global_load_dwordx4 v[52:55], v28, s[32:33] nt
    v_add_u32 v28, 115200, v28
    global_load_dwordx4 v[56:59], v28, s[32:33] nt
    v_add_u32 v28, 7680, v28
    global_load_dwordx4 v[60:63], v28, s[32:33] nt
    v_add_u32 v28, 115200, v28
    global_load_dwordx4 v[64:67], v28, s[32:33] nt
    v_add_u32 v28, 7680, v28
    global_load_dwordx4 v[68:71], v28, s[32:33] nt
    v_add_u32 v28, 115200, v28
    global_load_dwordx4 v[72:75], v28, s[32:33] nt
    v_add_u32 v28, 7680, v28
    global_load_dwordx4 v[76:79], v28, s[32:33] nt
    s_waitcnt vmcnt(11)
Lsb_n4:
    v_lshlrev_b32 v150, 16, v148
    v_and_b32 v151, 0xffff0000, v148
    v_lshlrev_b32 v97, 2, v97
    v_mul_f32 v152, 0xbfb8aa3b, v150
    v_mul_f32 v153, 0xbfb8aa3b, v151
    v_exp_f32 v152, v152
    v_exp_f32 v153, v153
    v_add_f32 v152, 1.0, v152
    v_add_f32 v153, 1.0, v153
    v_rcp_f32 v152, v152
    v_rcp_f32 v153, v153
    v_mul_f32 v150, v150, v152
    v_mul_f32 v151, v151, v153
    v_cvt_pk_bf16_f32 v148, v150, v151
    ds_bpermute_b32 v156, v97, v148 offset:0
    ds_bpermute_b32 v157, v97, v148 offset:32
    ds_bpermute_b32 v158, v97, v148 offset:64
    ds_bpermute_b32 v159, v97, v148 offset:96
    ds_bpermute_b32 v160, v97, v148 offset:128
    s_waitcnt lgkmcnt(4)
    v_lshlrev_b32 v98, 16, v156
    v_and_b32 v99, 0xffff0000, v156
    s_waitcnt lgkmcnt(3)
    v_lshlrev_b32 v100, 16, v157
    v_and_b32 v101, 0xffff0000, v157
    s_waitcnt lgkmcnt(2)
    v_lshlrev_b32 v102, 16, v158
    v_and_b32 v103, 0xffff0000, v158
    s_waitcnt lgkmcnt(1)
    v_lshlrev_b32 v104, 16, v159
    v_and_b32 v105, 0xffff0000, v159
    s_waitcnt lgkmcnt(0)
    v_lshlrev_b32 v106, 16, v160
    v_and_b32 v107, 0xffff0000, v160
    v_lshlrev_b32 v148, 16, v108
    v_and_b32 v149, 0xffff0000, v108
    v_lshlrev_b32 v150, 16, v109
    v_and_b32 v151, 0xffff0000, v109
    v_lshlrev_b32 v152, 16, v110
    v_and_b32 v153, 0xffff0000, v110
    v_lshlrev_b32 v154, 16, v111
    v_and_b32 v155, 0xffff0000, v111
    v_pk_mul_f32 v[156:157], v[98:99], v[148:149] op_sel:[0,0] op_sel_hi:[0,1]
    v_pk_mul_f32 v[158:159], v[98:99], v[150:151] op_sel:[0,0] op_sel_hi:[0,1]
    v_pk_mul_f32 v[160:161], v[98:99], v[152:153] op_sel:[0,0] op_sel_hi:[0,1]
    v_pk_mul_f32 v[162:163], v[98:99], v[154:155] op_sel:[0,0] op_sel_hi:[0,1]
    v_lshlrev_b32 v148, 16, v112
    v_and_b32 v149, 0xffff0000, v112
    v_lshlrev_b32 v150, 16, v113
    v_and_b32 v151, 0xffff0000, v113
    v_lshlrev_b32 v152, 16, v114
    v_and_b32 v153, 0xffff0000, v114
    v_lshlrev_b32 v154, 16, v115
    v_and_b32 v155, 0xffff0000, v115
    v_pk_fma_f32 v[156:157], v[98:99], v[148:149], v[156:157] op_sel:[1,0,0] op_sel_hi:[1,1,1]
    v_pk_fma_f32 v[158:159], v[98:99], v[150:151], v[158:159] op_sel:[1,0,0] op_sel_hi:[1,1,1]
    v_pk_fma_f32 v[160:161], v[98:99], v[152:153], v[160:161] op_sel:[1,0,0] op_sel_hi:[1,1,1]
    v_pk_fma_f32 v[162:163], v[98:99], v[154:155], v[162:163] op_sel:[1,0,0] op_sel_hi:[1,1,1]
    v_lshlrev_b32 v148, 16, v116
    v_and_b32 v149, 0xffff0000, v116
    v_lshlrev_b32 v150, 16, v117
    v_and_b32 v151, 0xffff0000, v117
    v_lshlrev_b32 v152, 16, v118
    v_and_b32 v153, 0xffff0000, v118
    v_lshlrev_b32 v154, 16, v119
    v_and_b32 v155, 0xffff0000, v119
    v_pk_fma_f32 v[156:157], v[100:101], v[148:149], v[156:157] op_sel:[0,0,0] op_sel_hi:[0,1,1]
    v_pk_fma_f32 v[158:159], v[100:101], v[150:151], v[158:159] op_sel:[0,0,0] op_sel_hi:[0,1,1]
    v_pk_fma_f32 v[160:161], v[100:101], v[152:153], v[160:161] op_sel:[0,0,0] op_sel_hi:[0,1,1]
    v_pk_fma_f32 v[162:163], v[100:101], v[154:155], v[162:163] op_sel:[0,0,0] op_sel_hi:[0,1,1]
    v_lshlrev_b32 v148, 16, v120
    v_and_b32 v149, 0xffff0000, v120
    v_lshlrev_b32 v150, 16, v121
    v_and_b32 v151, 0xffff0000, v121
    v_lshlrev_b32 v152, 16, v122
    v_and_b32 v153, 0xffff0000, v122
    v_lshlrev_b32 v154, 16, v123
    v_and_b32 v155, 0xffff0000, v123
    v_pk_fma_f32 v[156:157], v[100:101], v[148:149], v[156:157] op_sel:[1,0,0] op_sel_hi:[1,1,1]
    v_pk_fma_f32 v[158:159], v[100:101], v[150:151], v[158:159] op_sel:[1,0,0] op_sel_hi:[1,1,1]
    v_pk_fma_f32 v[160:161], v[100:101], v[152:153], v[160:161] op_sel:[1,0,0] op_sel_hi:[1,1,1]
    v_pk_fma_f32 v[162:163], v[100:101], v[154:155], v[162:163] op_sel:[1,0,0] op_sel_hi:[1,1,1]
    v_lshlrev_b32 v148, 16, v124
    v_and_b32 v149, 0xffff0000, v124
    v_lshlrev_b32 v150, 16, v125
    v_and_b32 v151, 0xffff0000, v125
    v_lshlrev_b32 v152, 16, v126
    v_and_b32 v153, 0xffff0000, v126
    v_lshlrev_b32 v154, 16, v127
    v_and_b32 v155, 0xffff0000, v127
    v_pk_fma_f32 v[156:157], v[102:103], v[148:149], v[156:157] op_sel:[0,0,0] op_sel_hi:[0,1,1]
    v_pk_fma_f32 v[158:159], v[102:103], v[150:151], v[158:159] op_sel:[0,0,0] op_sel_hi:[0,1,1]
    v_pk_fma_f32 v[160:161], v[102:103], v[152:153], v[160:161] op_sel:[0,0,0] op_sel_hi:[0,1,1]
    v_pk_fma_f32 v[162:163], v[102:103], v[154:155], v[162:163] op_sel:[0,0,0] op_sel_hi:[0,1,1]
    v_lshlrev_b32 v148, 16, v128
    v_and_b32 v149, 0xffff0000, v128
    v_lshlrev_b32 v150, 16, v129
    v_and_b32 v151, 0xffff0000, v129
    v_lshlrev_b32 v152, 16, v130
    v_and_b32 v153, 0xffff0000, v130
    v_lshlrev_b32 v154, 16, v131
    v_and_b32 v155, 0xffff0000, v131
    v_pk_fma_f32 v[156:157], v[102:103], v[148:149], v[156:157] op_sel:[1,0,0] op_sel_hi:[1,1,1]
    v_pk_fma_f32 v[158:159], v[102:103], v[150:151], v[158:159] op_sel:[1,0,0] op_sel_hi:[1,1,1]
    v_pk_fma_f32 v[160:161], v[102:103], v[152:153], v[160:161] op_sel:[1,0,0] op_sel_hi:[1,1,1]
    v_pk_fma_f32 v[162:163], v[102:103], v[154:155], v[162:163] op_sel:[1,0,0] op_sel_hi:[1,1,1]
    v_lshlrev_b32 v148, 16, v132
    v_and_b32 v149, 0xffff0000, v132
    v_lshlrev_b32 v150, 16, v133
    v_and_b32 v151, 0xffff0000, v133
    v_lshlrev_b32 v152, 16, v134
    v_and_b32 v153, 0xffff0000, v134
    v_lshlrev_b32 v154, 16, v135
    v_and_b32 v155, 0xffff0000, v135
    v_pk_fma_f32 v[156:157], v[104:105], v[148:149], v[156:157] op_sel:[0,0,0] op_sel_hi:[0,1,1]
    v_pk_fma_f32 v[158:159], v[104:105], v[150:151], v[158:159] op_sel:[0,0,0] op_sel_hi:[0,1,1]
    v_pk_fma_f32 v[160:161], v[104:105], v[152:153], v[160:161] op_sel:[0,0,0] op_sel_hi:[0,1,1]
    v_pk_fma_f32 v[162:163], v[104:105], v[154:155], v[162:163] op_sel:[0,0,0] op_sel_hi:[0,1,1]
    v_lshlrev_b32 v148, 16, v136
    v_and_b32 v149, 0xffff0000, v136
    v_lshlrev_b32 v150, 16, v137
    v_and_b32 v151, 0xffff0000, v137
    v_lshlrev_b32 v152, 16, v138
    v_and_b32 v153, 0xffff0000, v138
    v_lshlrev_b32 v154, 16, v139
    v_and_b32 v155, 0xffff0000, v139
    v_pk_fma_f32 v[156:157], v[104:105], v[148:149], v[156:157] op_sel:[1,0,0] op_sel_hi:[1,1,1]
    v_pk_fma_f32 v[158:159], v[104:105], v[150:151], v[158:159] op_sel:[1,0,0] op_sel_hi:[1,1,1]
    v_pk_fma_f32 v[160:161], v[104:105], v[152:153], v[160:161] op_sel:[1,0,0] op_sel_hi:[1,1,1]
    v_pk_fma_f32 v[162:163], v[104:105], v[154:155], v[162:163] op_sel:[1,0,0] op_sel_hi:[1,1,1]
    v_lshlrev_b32 v148, 16, v140
    v_and_b32 v149, 0xffff0000, v140
    v_lshlrev_b32 v150, 16, v141
    v_and_b32 v151, 0xffff0000, v141
    v_lshlrev_b32 v152, 16, v142
    v_and_b32 v153, 0xffff0000, v142
    v_lshlrev_b32 v154, 16, v143
    v_and_b32 v155, 0xffff0000, v143
    v_pk_fma_f32 v[156:157], v[106:107], v[148:149], v[156:157] op_sel:[0,0,0] op_sel_hi:[0,1,1]
    v_pk_fma_f32 v[158:159], v[106:107], v[150:151], v[158:159] op_sel:[0,0,0] op_sel_hi:[0,1,1]
    v_pk_fma_f32 v[160:161], v[106:107], v[152:153], v[160:161] op_sel:[0,0,0] op_sel_hi:[0,1,1]
    v_pk_fma_f32 v[162:163], v[106:107], v[154:155], v[162:163] op_sel:[0,0,0] op_sel_hi:[0,1,1]
    v_lshlrev_b32 v148, 16, v144
    v_and_b32 v149, 0xffff0000, v144
    v_lshlrev_b32 v150, 16, v145
    v_and_b32 v151, 0xffff0000, v145
    v_lshlrev_b32 v152, 16, v146
    v_and_b32 v153, 0xffff0000, v146
    v_lshlrev_b32 v154, 16, v147
    v_and_b32 v155, 0xffff0000, v147
    v_pk_fma_f32 v[156:157], v[106:107], v[148:149], v[156:157] op_sel:[1,0,0] op_sel_hi:[1,1,1]
    v_pk_fma_f32 v[158:159], v[106:107], v[150:151], v[158:159] op_sel:[1,0,0] op_sel_hi:[1,1,1]
    v_pk_fma_f32 v[160:161], v[106:107], v[152:153], v[160:161] op_sel:[1,0,0] op_sel_hi:[1,1,1]
    v_pk_fma_f32 v[162:163], v[106:107], v[154:155], v[162:163] op_sel:[1,0,0] op_sel_hi:[1,1,1]
    s_nop 0
    v_permlane32_swap_b32 v156, v160
    v_permlane32_swap_b32 v157, v161
    v_permlane32_swap_b32 v158, v162
    v_permlane32_swap_b32 v159, v163
    v_add_f32 v156, v156, v160
    v_add_f32 v157, v157, v161
    v_add_f32 v158, v158, v162
    v_add_f32 v159, v159, v163
    s_nop 0
    v_permlane16_swap_b32 v156, v158
    v_permlane16_swap_b32 v157, v159
    v_add_f32 v156, v156, v158
    v_add_f32 v157, v157, v159
    v_and_b32 v149, 7, v1
    v_lshrrev_b32 v150, 3, v1
    v_add_f32_dpp v148, v156, v156 row_ror:8 row_mask:0xf bank_mask:0x3
    s_nop 1
    v_add_f32_dpp v148, v157, v157 row_ror:8 row_mask:0xf bank_mask:0xc
    v_lshl_add_u32 v149, v149, 3, v150
    s_lshl_b32 s7, s3, 8
    s_add_u32 s7, s7, 123904
    v_lshl_add_u32 v149, v149, 2, s7
    ds_write_b32 v149, v148
    s_waitcnt lgkmcnt(0)
    s_barrier
    v_lshlrev_b32 v149, 2, v1
    v_add_u32 v150, 123904, v149
    ds_read_b32 v156, v150 offset:0
    ds_read_b32 v157, v150 offset:256
    ds_read_b32 v158, v150 offset:512
    ds_read_b32 v159, v150 offset:768
    v_add_u32 v149, s45, v149
    s_waitcnt lgkmcnt(2)
    v_add_f32 v156, v156, v157
    s_waitcnt lgkmcnt(0)
    v_add_f32 v158, v158, v159
    v_add_f32 v156, v156, v158
    v_min_u32 v156, -2, v156
    s_cmp_lg_u32 s3, 0
    s_cbranch_scc1 Lmod_skip_s2
    global_store_dword v149, v156, s[38:39] offset:0 sc1
Lmod_skip_s2:
    s_cmp_lg_u32 s3, 0
    s_cbranch_scc1 Lbic_x
    v_min_u32 v164, 49, v1
    v_cmp_lt_u32 vcc, 7, v164
    s_nop 1
    v_cndmask_b32_e64 v165, 0, 7, vcc
    v_add_lshl_u32 v164, v164, v165, 2
    s_branch Lbic_f
Lbic:
    s_sleep 4
Lbic_f:
    global_load_dword v165, v164, s[36:37] sc1
    s_waitcnt vmcnt(0)
    v_cmp_eq_u32 vcc, 0, v165
    s_add_u32 s100, s100, 1
    s_cmp_ge_u32 s100, 262144
    s_cbranch_scc1 Lbic_x
    s_cbranch_vccnz Lbic
Lbic_x:
    s_waitcnt vmcnt(0)
    s_cmp_ge_u32 s48, 27
    s_cbranch_scc1 Lsp_b3
    s_barrier
    v_and_b32 v33, 15, v1
    v_lshrrev_b32 v34, 4, v1
    v_mul_u32_u24 v34, 10240, v34
    s_mul_i32 s5, s3, 320
    s_add_u32 s5, s5, 0
    v_add_u32 v34, s5, v34
    v_lshl_add_u32 v31, v33, 2, v34
    v_lshl_add_u32 v32, v33, 1, v34
    s_mul_i32 s5, s3, 276480
    s_mul_i32 s6, s48, 5120
    s_add_u32 s5, s5, s6
    s_add_u32 s5, s5, 10487808
    v_lshl_add_u32 v30, v1, 4, s5
    s_mov_b32 s6, 0x5040100
    s_mov_b32 s7, 0x7060302
    ds_read_b32 v36, v31 offset:0
    ds_read_b32 v37, v31 offset:2560
    ds_read_b32 v38, v31 offset:5120
    ds_read_b32 v39, v31 offset:7680
    ds_read_b32 v40, v31 offset:1280
    ds_read_b32 v41, v31 offset:3840
    ds_read_b32 v42, v31 offset:6400
    ds_read_b32 v43, v31 offset:8960
    ds_read_b32 v44, v31 offset:64
    ds_read_b32 v45, v31 offset:2624
    ds_read_b32 v46, v31 offset:5184
    ds_read_b32 v47, v31 offset:7744
    ds_read_b32 v48, v31 offset:1344
    ds_read_b32 v49, v31 offset:3904
    ds_read_b32 v50, v31 offset:6464
    ds_read_b32 v51, v31 offset:9024
    ds_read_u16 v52, v32 offset:128
    ds_read_u16 v53, v32 offset:2688
    ds_read_u16 v54, v32 offset:5248
    ds_read_u16 v55, v32 offset:7808
    ds_read_u16 v56, v32 offset:1408
    ds_read_u16 v57, v32 offset:3968
    ds_read_u16 v58, v32 offset:6528
    ds_read_u16 v59, v32 offset:9088
    s_waitcnt lgkmcnt(15)
    v_perm_b32 v60, v37, v36, s6
    v_perm_b32 v61, v39, v38, s6
    v_perm_b32 v62, v41, v40, s6
    v_perm_b32 v63, v43, v42, s6
    v_perm_b32 v64, v37, v36, s7
    v_perm_b32 v65, v39, v38, s7
    v_perm_b32 v66, v41, v40, s7
    v_perm_b32 v67, v43, v42, s7
    s_waitcnt lgkmcnt(14)
    v_perm_b32 v68, v45, v44, s6
    s_waitcnt lgkmcnt(12)
    v_perm_b32 v69, v47, v46, s6
    s_waitcnt lgkmcnt(10)
    v_perm_b32 v70, v49, v48, s6
    s_waitcnt lgkmcnt(8)
    v_perm_b32 v71, v51, v50, s6
    v_perm_b32 v72, v45, v44, s7
    v_perm_b32 v73, v47, v46, s7
    v_perm_b32 v74, v49, v48, s7
    v_perm_b32 v75, v51, v50, s7
    s_waitcnt lgkmcnt(6)
    v_perm_b32 v76, v53, v52, s6
    s_waitcnt lgkmcnt(4)
    v_perm_b32 v77, v55, v54, s6
    s_waitcnt lgkmcnt(2)
    v_perm_b32 v78, v57, v56, s6
    s_waitcnt lgkmcnt(0)
    v_perm_b32 v79, v59, v58, s6
    global_store_dwordx4 v30, v[60:63], s[38:39] offset:-2048 sc1
    global_store_dwordx4 v30, v[64:67], s[38:39] offset:-1024 sc1
    global_store_dwordx4 v30, v[68:71], s[38:39] offset:0 sc1
    global_store_dwordx4 v30, v[72:75], s[38:39] offset:1024 sc1
    global_store_dwordx4 v30, v[76:79], s[38:39] offset:2048 sc1
    v_add_u32 v30, 138240, v30
    ds_read_b32 v80, v31 offset:160
    ds_read_b32 v81, v31 offset:2720
    ds_read_b32 v82, v31 offset:5280
    ds_read_b32 v83, v31 offset:7840
    ds_read_b32 v84, v31 offset:1440
    ds_read_b32 v85, v31 offset:4000
    ds_read_b32 v86, v31 offset:6560
    ds_read_b32 v87, v31 offset:9120
    ds_read_b32 v88, v31 offset:224
    ds_read_b32 v89, v31 offset:2784
    ds_read_b32 v90, v31 offset:5344
    ds_read_b32 v91, v31 offset:7904
    ds_read_b32 v92, v31 offset:1504
    ds_read_b32 v93, v31 offset:4064
    ds_read_b32 v94, v31 offset:6624
    ds_read_b32 v95, v31 offset:9184
    ds_read_u16 v96, v32 offset:288
    ds_read_u16 v97, v32 offset:2848
    ds_read_u16 v98, v32 offset:5408
    ds_read_u16 v99, v32 offset:7968
    ds_read_u16 v100, v32 offset:1568
    ds_read_u16 v101, v32 offset:4128
    ds_read_u16 v102, v32 offset:6688
    ds_read_u16 v103, v32 offset:9248
    s_waitcnt lgkmcnt(15)
    v_perm_b32 v104, v81, v80, s6
    v_perm_b32 v105, v83, v82, s6
    v_perm_b32 v106, v85, v84, s6
    v_perm_b32 v107, v87, v86, s6
    v_perm_b32 v108, v81, v80, s7
    v_perm_b32 v109, v83, v82, s7
    v_perm_b32 v110, v85, v84, s7
    v_perm_b32 v111, v87, v86, s7
    s_waitcnt lgkmcnt(14)
    v_perm_b32 v112, v89, v88, s6
    s_waitcnt lgkmcnt(12)
    v_perm_b32 v113, v91, v90, s6
    s_waitcnt lgkmcnt(10)
    v_perm_b32 v114, v93, v92, s6
    s_waitcnt lgkmcnt(8)
    v_perm_b32 v115, v95, v94, s6
    v_perm_b32 v116, v89, v88, s7
    v_perm_b32 v117, v91, v90, s7
    v_perm_b32 v118, v93, v92, s7
    v_perm_b32 v119, v95, v94, s7
    s_waitcnt lgkmcnt(6)
    v_perm_b32 v120, v97, v96, s6
    s_waitcnt lgkmcnt(4)
    v_perm_b32 v121, v99, v98, s6
    s_waitcnt lgkmcnt(2)
    v_perm_b32 v122, v101, v100, s6
    s_waitcnt lgkmcnt(0)
    v_perm_b32 v123, v103, v102, s6
    global_store_dwordx4 v30, v[104:107], s[38:39] offset:-2048 sc1
    global_store_dwordx4 v30, v[108:111], s[38:39] offset:-1024 sc1
    global_store_dwordx4 v30, v[112:115], s[38:39] offset:0 sc1
    global_store_dwordx4 v30, v[116:119], s[38:39] offset:1024 sc1
    global_store_dwordx4 v30, v[120:123], s[38:39] offset:2048 sc1
    s_lshl_b32 s4, s48, 7
    s_add_u32 s51, s4, 98304
    s_branch Lsp_d
Lsp_a2:
    s_and_b32 s4, s42, 1
    s_lshl_b32 s4, s4, 1
    s_and_b32 s5, s3, 1
    s_add_u32 s44, s4, s5
    s_and_b32 s4, s42, -2
    s_lshr_b32 s5, s3, 1
    s_add_u32 s45, s4, s5
    s_and_b32 s4, s42, 1
    s_lshl_b32 s4, s4, 2
    s_add_u32 s4, s4, s3
    s_mul_i32 s4, s4, 276480
    s_lshr_b32 s5, s42, 1
    s_lshl_b32 s5, s5, 7
    s_add_u32 s4, s4, s5
    v_lshrrev_b32 v28, 3, v1
    v_mul_u32_u24 v28, 3328, v28
    v_add3_u32 v28, v28, v4, s4
    s_mul_i32 s5, s3, 10240
    s_add_u32 m0, s5, 0
    s_nop 0
    global_load_lds_dwordx4 v28, s[22:23] nt
    v_add_u32 v28, 27648, v28
    s_add_u32 m0, s5, 1024
    s_nop 0
    global_load_lds_dwordx4 v28, s[22:23] nt
    v_add_u32 v28, 27648, v28
    s_add_u32 m0, s5, 2048
    s_nop 0
    global_load_lds_dwordx4 v28, s[22:23] nt
    v_add_u32 v28, 27648, v28
    s_add_u32 m0, s5, 3072
    s_nop 0
    global_load_lds_dwordx4 v28, s[22:23] nt
    v_add_u32 v28, 27648, v28
    s_add_u32 m0, s5, 4096
    s_nop 0
    global_load_lds_dwordx4 v28, s[22:23] nt
    v_add_u32 v28, 27648, v28
    s_add_u32 m0, s5, 5120
    s_nop 0
    global_load_lds_dwordx4 v28, s[22:23] nt
    v_add_u32 v28, 27648, v28
    s_add_u32 m0, s5, 6144
    s_nop 0
    global_load_lds_dwordx4 v28, s[22:23] nt
    v_add_u32 v28, 27648, v28
    s_add_u32 m0, s5, 7168
    s_nop 0
    global_load_lds_dwordx4 v28, s[22:23] nt
    v_add_u32 v28, 27648, v28
    s_add_u32 m0, s5, 8192
    s_nop 0
    global_load_lds_dwordx4 v28, s[22:23] nt
    v_add_u32 v28, 27648, v28
    s_add_u32 m0, s5, 9216
    s_nop 0
    global_load_lds_dwordx4 v28, s[22:23] nt
    v_add_u32 v28, 27648, v28
    v_min_u32 v72, 624, v4
    s_mul_i32 s5, s44, 640
    s_add_u32 s5, s5, 7680
    v_add_u32 v73, s5, v72
    s_mul_i32 s5, s3, 1280
    s_add_u32 s5, s5, 124928
    v_add_u32 v72, s5, v72
    v_lshl_add_u32 v74, v3, 5, s5
    s_cmp_ge_u32 s45, 27
    s_cselect_b32 s6, -54, 56
    s_lshl_b32 s7, s45, 1
    s_add_u32 s46, s6, s7
    s_mul_i32 s4, s46, 20480
    s_mul_i32 s5, s44, 5120
    s_add_u32 s4, s4, s5
    s_add_u32 s4, s4, 7342080
    v_add_u32 v75, s4, v4
    v_add_u32 v76, 20480, v75
    s_and_b32 s4, s3, 1
    s_mul_i32 s4, s4, 20480
    s_lshr_b32 s5, s3, 1
    s_lshl_b32 s5, s5, 6
    s_add_u32 s4, s4, s5
    v_lshl_add_u32 v28, v3, 10, s4
    v_lshl_add_u32 v28, v2, 2, v28
    s_cmp_lt_u32 s42, 8
    s_cselect_b32 s48, 21, 0
    s_add_u32 s48, s48, s42
    s_add_u32 s48, s48, 76
    s_sub_u32 s4, s42, 5
    s_cmp_ge_u32 s4, 21
    s_cbranch_scc1 Lwp_n1
    s_lshr_b32 s4, s48, 1
    s_and_b32 s5, s48, 1
    s_cmp_lt_u32 s4, 50
    s_cselect_b32 s6, -20, 0
    s_cmp_lt_u32 s4, 20
    s_cselect_b32 s6, 30, s6
    s_add_u32 s4, s4, s6
    s_mul_i32 s6, s5, 15360
    s_lshl_b32 s7, s4, 8
    s_add_u32 s47, s6, s7
    s_lshl_b32 s5, s5, 2
    s_add_u32 s5, s5, s3
    s_mul_i32 s5, s5, 80
    s_lshl_b32 s4, s4, 7
    s_mul_i32 s6, s5, 7680
    s_add_u32 s4, s4, s6
    v_min_u32 v78, 39, v1
    s_lshl_b32 s5, s5, 1
    v_lshl_add_u32 v78, v78, 2, s5
    global_load_dword v132, v78, s[30:31]
    v_lshrrev_b32 v79, 3, v1
    v_mul_u32_u24 v78, 15232, v79
    v_add3_u32 v78, v78, v4, s4
    global_load_dwordx4 v[92:95], v78, s[32:33] nt
    v_add_u32 v78, 7680, v78
    global_load_dwordx4 v[96:99], v78, s[32:33] nt
    v_add_u32 v78, 115200, v78
    global_load_dwordx4 v[100:103], v78, s[32:33] nt
    v_add_u32 v78, 7680, v78
    global_load_dwordx4 v[104:107], v78, s[32:33] nt
    v_add_u32 v78, 115200, v78
    global_load_dwordx4 v[108:111], v78, s[32:33] nt
    v_add_u32 v78, 7680, v78
    global_load_dwordx4 v[112:115], v78, s[32:33] nt
    v_add_u32 v78, 115200, v78
    global_load_dwordx4 v[116:119], v78, s[32:33] nt
    v_add_u32 v78, 7680, v78
    global_load_dwordx4 v[120:123], v78, s[32:33] nt
    v_add_u32 v78, 115200, v78
    global_load_dwordx4 v[124:127], v78, s[32:33] nt
    v_add_u32 v78, 7680, v78
    global_load_dwordx4 v[128:131], v78, s[32:33] nt
    s_waitcnt vmcnt(11)
    s_branch Lwp_n2
Lwp_n1:
    s_waitcnt vmcnt(0)
Lwp_n2:
    s_barrier
    ds_read_b32 v32, v28 offset:0
    ds_read_b32 v33, v28 offset:128
    ds_read_b32 v34, v28 offset:256
    ds_read_b32 v35, v28 offset:384
    ds_read_b32 v36, v28 offset:512
    ds_read_b32 v37, v28 offset:640
    ds_read_b32 v38, v28 offset:768
    ds_read_b32 v39, v28 offset:896
    ds_read_b32 v40, v28 offset:4096
    ds_read_b32 v41, v28 offset:4224
    ds_read_b32 v42, v28 offset:4352
    ds_read_b32 v43, v28 offset:4480
    ds_read_b32 v44, v28 offset:4608
    ds_read_b32 v45, v28 offset:4736
    ds_read_b32 v46, v28 offset:4864
    ds_read_b32 v47, v28 offset:4992
    ds_read_b32 v48, v28 offset:8192
    ds_read_b32 v49, v28 offset:8320
    ds_read_b32 v50, v28 offset:8448
    ds_read_b32 v51, v28 offset:8576
    ds_read_b32 v52, v28 offset:8704
    ds_read_b32 v53, v28 offset:8832
    ds_read_b32 v54, v28 offset:8960
    ds_read_b32 v55, v28 offset:9088
    ds_read_b32 v56, v28 offset:12288
    ds_read_b32 v57, v28 offset:12416
    ds_read_b32 v58, v28 offset:12544
    ds_read_b32 v59, v28 offset:12672
    ds_read_b32 v60, v28 offset:12800
    ds_read_b32 v61, v28 offset:12928
    ds_read_b32 v62, v28 offset:13056
    ds_read_b32 v63, v28 offset:13184
    ds_read_b32 v64, v28 offset:16384
    ds_read_b32 v65, v28 offset:16512
    ds_read_b32 v66, v28 offset:16640
    ds_read_b32 v67, v28 offset:16768
    ds_read_b32 v68, v28 offset:16896
    ds_read_b32 v69, v28 offset:17024
    ds_read_b32 v70, v28 offset:17152
    ds_read_b32 v71, v28 offset:17280
    s_waitcnt lgkmcnt(15)
    v_lshlrev_b32 v152, 16, v32
    v_and_b32 v153, 0xffff0000, v32
    v_lshlrev_b32 v154, 16, v33
    v_and_b32 v155, 0xffff0000, v33
    v_lshlrev_b32 v156, 16, v34
    v_and_b32 v157, 0xffff0000, v34
    v_lshlrev_b32 v158, 16, v35
    v_and_b32 v159, 0xffff0000, v35
    v_lshlrev_b32 v160, 16, v36
    v_and_b32 v161, 0xffff0000, v36
    v_lshlrev_b32 v162, 16, v37
    v_and_b32 v163, 0xffff0000, v37
    v_lshlrev_b32 v164, 16, v38
    v_and_b32 v165, 0xffff0000, v38
    v_lshlrev_b32 v166, 16, v39
    v_and_b32 v167, 0xffff0000, v39
    v_lshlrev_b32 v168, 16, v40
    v_and_b32 v169, 0xffff0000, v40
    v_lshlrev_b32 v170, 16, v41
    v_and_b32 v171, 0xffff0000, v41
    v_lshlrev_b32 v172, 16, v42
    v_and_b32 v173, 0xffff0000, v42
    v_lshlrev_b32 v174, 16, v43
    v_and_b32 v175, 0xffff0000, v43
    v_lshlrev_b32 v176, 16, v44
    v_and_b32 v177, 0xffff0000, v44
    v_lshlrev_b32 v178, 16, v45
    v_and_b32 v179, 0xffff0000, v45
    v_lshlrev_b32 v180, 16, v46
    v_and_b32 v181, 0xffff0000, v46
    v_lshlrev_b32 v182, 16, v47
    v_and_b32 v183, 0xffff0000, v47
    v_lshlrev_b32 v184, 16, v48
    v_and_b32 v185, 0xffff0000, v48
    v_lshlrev_b32 v186, 16, v49
    v_and_b32 v187, 0xffff0000, v49
    v_lshlrev_b32 v188, 16, v50
    v_and_b32 v189, 0xffff0000, v50
    v_lshlrev_b32 v190, 16, v51
    v_and_b32 v191, 0xffff0000, v51
    v_lshlrev_b32 v192, 16, v52
    v_and_b32 v193, 0xffff0000, v52
    v_lshlrev_b32 v194, 16, v53
    v_and_b32 v195, 0xffff0000, v53
    v_lshlrev_b32 v196, 16, v54
    v_and_b32 v197, 0xffff0000, v54
    v_lshlrev_b32 v198, 16, v55
    v_and_b32 v199, 0xffff0000, v55
    v_lshlrev_b32 v200, 16, v56
    v_and_b32 v201, 0xffff0000, v56
    s_waitcnt lgkmcnt(14)
    v_lshlrev_b32 v202, 16, v57
    v_and_b32 v203, 0xffff0000, v57
    s_waitcnt lgkmcnt(13)
    v_lshlrev_b32 v204, 16, v58
    v_and_b32 v205, 0xffff0000, v58
    s_waitcnt lgkmcnt(12)
    v_lshlrev_b32 v206, 16, v59
    v_and_b32 v207, 0xffff0000, v59
    s_waitcnt lgkmcnt(11)
    v_lshlrev_b32 v208, 16, v60
    v_and_b32 v209, 0xffff0000, v60
    s_waitcnt lgkmcnt(10)
    v_lshlrev_b32 v210, 16, v61
    v_and_b32 v211, 0xffff0000, v61
    s_waitcnt lgkmcnt(9)
    v_lshlrev_b32 v212, 16, v62
    v_and_b32 v213, 0xffff0000, v62
    s_waitcnt lgkmcnt(8)
    v_lshlrev_b32 v214, 16, v63
    v_and_b32 v215, 0xffff0000, v63
    s_waitcnt lgkmcnt(7)
    v_lshlrev_b32 v216, 16, v64
    v_and_b32 v217, 0xffff0000, v64
    s_waitcnt lgkmcnt(6)
    v_lshlrev_b32 v218, 16, v65
    v_and_b32 v219, 0xffff0000, v65
    s_waitcnt lgkmcnt(5)
    v_lshlrev_b32 v220, 16, v66
    v_and_b32 v221, 0xffff0000, v66
    s_waitcnt lgkmcnt(4)
    v_lshlrev_b32 v222, 16, v67
    v_and_b32 v223, 0xffff0000, v67
    s_waitcnt lgkmcnt(3)
    v_lshlrev_b32 v224, 16, v68
    v_and_b32 v225, 0xffff0000, v68
    s_waitcnt lgkmcnt(2)
    v_lshlrev_b32 v226, 16, v69
    v_and_b32 v227, 0xffff0000, v69
    s_waitcnt lgkmcnt(1)
    v_lshlrev_b32 v228, 16, v70
    v_and_b32 v229, 0xffff0000, v70
    s_waitcnt lgkmcnt(0)
    v_lshlrev_b32 v230, 16, v71
    v_and_b32 v231, 0xffff0000, v71
    s_cmp_lg_u32 s3, 0
    s_cbranch_scc1 Lwic_x
    v_min_u32 v32, 49, v1
    v_cmp_lt_u32 vcc, 7, v32
    s_nop 1
    v_cndmask_b32_e64 v33, 0, 7, vcc
    v_add_lshl_u32 v32, v32, v33, 2
    s_branch Lwic_f
Lwic:
    s_sleep 4
Lwic_f:
    global_load_dword v33, v32, s[36:37] sc1
    s_waitcnt vmcnt(0)
    v_cmp_eq_u32 vcc, 0, v33
    s_add_u32 s100, s100, 1
    s_cmp_ge_u32 s100, 262144
    s_cbranch_scc1 Lwic_x
    s_cbranch_vccnz Lwic
Lwic_x:
    s_waitcnt vmcnt(0)
    s_barrier
    s_sub_u32 s4, s42, 5
    s_cmp_ge_u32 s4, 21
    s_cbranch_scc1 Lwp_n3
    v_lshlrev_b32 v134, 16, v132
    v_and_b32 v135, 0xffff0000, v132
    v_lshlrev_b32 v79, 2, v79
    v_mul_f32 v136, 0xbfb8aa3b, v134
    v_mul_f32 v137, 0xbfb8aa3b, v135
    v_exp_f32 v136, v136
    v_exp_f32 v137, v137
    v_add_f32 v136, 1.0, v136
    v_add_f32 v137, 1.0, v137
    v_rcp_f32 v136, v136
    v_rcp_f32 v137, v137
    v_mul_f32 v134, v134, v136
    v_mul_f32 v135, v135, v137
    v_cvt_pk_bf16_f32 v132, v134, v135
    ds_bpermute_b32 v140, v79, v132 offset:0
    ds_bpermute_b32 v141, v79, v132 offset:32
    ds_bpermute_b32 v142, v79, v132 offset:64
    ds_bpermute_b32 v143, v79, v132 offset:96
    ds_bpermute_b32 v144, v79, v132 offset:128
    s_waitcnt lgkmcnt(4)
    v_lshlrev_b32 v80, 16, v140
    v_and_b32 v81, 0xffff0000, v140
    s_waitcnt lgkmcnt(3)
    v_lshlrev_b32 v82, 16, v141
    v_and_b32 v83, 0xffff0000, v141
    s_waitcnt lgkmcnt(2)
    v_lshlrev_b32 v84, 16, v142
    v_and_b32 v85, 0xffff0000, v142
    s_waitcnt lgkmcnt(1)
    v_lshlrev_b32 v86, 16, v143
    v_and_b32 v87, 0xffff0000, v143
    s_waitcnt lgkmcnt(0)
    v_lshlrev_b32 v88, 16, v144
    v_and_b32 v89, 0xffff0000, v144
    v_lshlrev_b32 v132, 16, v92
    v_and_b32 v133, 0xffff0000, v92
    v_lshlrev_b32 v134, 16, v93
    v_and_b32 v135, 0xffff0000, v93
    v_lshlrev_b32 v136, 16, v94
    v_and_b32 v137, 0xffff0000, v94
    v_lshlrev_b32 v138, 16, v95
    v_and_b32 v139, 0xffff0000, v95
    v_pk_mul_f32 v[140:141], v[80:81], v[132:133] op_sel:[0,0] op_sel_hi:[0,1]
    v_pk_mul_f32 v[142:143], v[80:81], v[134:135] op_sel:[0,0] op_sel_hi:[0,1]
    v_pk_mul_f32 v[144:145], v[80:81], v[136:137] op_sel:[0,0] op_sel_hi:[0,1]
    v_pk_mul_f32 v[146:147], v[80:81], v[138:139] op_sel:[0,0] op_sel_hi:[0,1]
    v_lshlrev_b32 v132, 16, v96
    v_and_b32 v133, 0xffff0000, v96
    v_lshlrev_b32 v134, 16, v97
    v_and_b32 v135, 0xffff0000, v97
    v_lshlrev_b32 v136, 16, v98
    v_and_b32 v137, 0xffff0000, v98
    v_lshlrev_b32 v138, 16, v99
    v_and_b32 v139, 0xffff0000, v99
    v_pk_fma_f32 v[140:141], v[80:81], v[132:133], v[140:141] op_sel:[1,0,0] op_sel_hi:[1,1,1]
    v_pk_fma_f32 v[142:143], v[80:81], v[134:135], v[142:143] op_sel:[1,0,0] op_sel_hi:[1,1,1]
    v_pk_fma_f32 v[144:145], v[80:81], v[136:137], v[144:145] op_sel:[1,0,0] op_sel_hi:[1,1,1]
    v_pk_fma_f32 v[146:147], v[80:81], v[138:139], v[146:147] op_sel:[1,0,0] op_sel_hi:[1,1,1]
    v_lshlrev_b32 v132, 16, v100
    v_and_b32 v133, 0xffff0000, v100
    v_lshlrev_b32 v134, 16, v101
    v_and_b32 v135, 0xffff0000, v101
    v_lshlrev_b32 v136, 16, v102
    v_and_b32 v137, 0xffff0000, v102
    v_lshlrev_b32 v138, 16, v103
    v_and_b32 v139, 0xffff0000, v103
    v_pk_fma_f32 v[140:141], v[82:83], v[132:133], v[140:141] op_sel:[0,0,0] op_sel_hi:[0,1,1]
    v_pk_fma_f32 v[142:143], v[82:83], v[134:135], v[142:143] op_sel:[0,0,0] op_sel_hi:[0,1,1]
    v_pk_fma_f32 v[144:145], v[82:83], v[136:137], v[144:145] op_sel:[0,0,0] op_sel_hi:[0,1,1]
    v_pk_fma_f32 v[146:147], v[82:83], v[138:139], v[146:147] op_sel:[0,0,0] op_sel_hi:[0,1,1]
    v_lshlrev_b32 v132, 16, v104
    v_and_b32 v133, 0xffff0000, v104
    v_lshlrev_b32 v134, 16, v105
    v_and_b32 v135, 0xffff0000, v105
    v_lshlrev_b32 v136, 16, v106
    v_and_b32 v137, 0xffff0000, v106
    v_lshlrev_b32 v138, 16, v107
    v_and_b32 v139, 0xffff0000, v107
    v_pk_fma_f32 v[140:141], v[82:83], v[132:133], v[140:141] op_sel:[1,0,0] op_sel_hi:[1,1,1]
    v_pk_fma_f32 v[142:143], v[82:83], v[134:135], v[142:143] op_sel:[1,0,0] op_sel_hi:[1,1,1]
    v_pk_fma_f32 v[144:145], v[82:83], v[136:137], v[144:145] op_sel:[1,0,0] op_sel_hi:[1,1,1]
    v_pk_fma_f32 v[146:147], v[82:83], v[138:139], v[146:147] op_sel:[1,0,0] op_sel_hi:[1,1,1]
    v_lshlrev_b32 v132, 16, v108
    v_and_b32 v133, 0xffff0000, v108
    v_lshlrev_b32 v134, 16, v109
    v_and_b32 v135, 0xffff0000, v109
    v_lshlrev_b32 v136, 16, v110
    v_and_b32 v137, 0xffff0000, v110
    v_lshlrev_b32 v138, 16, v111
    v_and_b32 v139, 0xffff0000, v111
    v_pk_fma_f32 v[140:141], v[84:85], v[132:133], v[140:141] op_sel:[0,0,0] op_sel_hi:[0,1,1]
    v_pk_fma_f32 v[142:143], v[84:85], v[134:135], v[142:143] op_sel:[0,0,0] op_sel_hi:[0,1,1]
    v_pk_fma_f32 v[144:145], v[84:85], v[136:137], v[144:145] op_sel:[0,0,0] op_sel_hi:[0,1,1]
    v_pk_fma_f32 v[146:147], v[84:85], v[138:139], v[146:147] op_sel:[0,0,0] op_sel_hi:[0,1,1]
    v_lshlrev_b32 v132, 16, v112
    v_and_b32 v133, 0xffff0000, v112
    v_lshlrev_b32 v134, 16, v113
    v_and_b32 v135, 0xffff0000, v113
    v_lshlrev_b32 v136, 16, v114
    v_and_b32 v137, 0xffff0000, v114
    v_lshlrev_b32 v138, 16, v115
    v_and_b32 v139, 0xffff0000, v115
    v_pk_fma_f32 v[140:141], v[84:85], v[132:133], v[140:141] op_sel:[1,0,0] op_sel_hi:[1,1,1]
    v_pk_fma_f32 v[142:143], v[84:85], v[134:135], v[142:143] op_sel:[1,0,0] op_sel_hi:[1,1,1]
    v_pk_fma_f32 v[144:145], v[84:85], v[136:137], v[144:145] op_sel:[1,0,0] op_sel_hi:[1,1,1]
    v_pk_fma_f32 v[146:147], v[84:85], v[138:139], v[146:147] op_sel:[1,0,0] op_sel_hi:[1,1,1]
    v_lshlrev_b32 v132, 16, v116
    v_and_b32 v133, 0xffff0000, v116
    v_lshlrev_b32 v134, 16, v117
    v_and_b32 v135, 0xffff0000, v117
    v_lshlrev_b32 v136, 16, v118
    v_and_b32 v137, 0xffff0000, v118
    v_lshlrev_b32 v138, 16, v119
    v_and_b32 v139, 0xffff0000, v119
    v_pk_fma_f32 v[140:141], v[86:87], v[132:133], v[140:141] op_sel:[0,0,0] op_sel_hi:[0,1,1]
    v_pk_fma_f32 v[142:143], v[86:87], v[134:135], v[142:143] op_sel:[0,0,0] op_sel_hi:[0,1,1]
    v_pk_fma_f32 v[144:145], v[86:87], v[136:137], v[144:145] op_sel:[0,0,0] op_sel_hi:[0,1,1]
    v_pk_fma_f32 v[146:147], v[86:87], v[138:139], v[146:147] op_sel:[0,0,0] op_sel_hi:[0,1,1]
    v_lshlrev_b32 v132, 16, v120
    v_and_b32 v133, 0xffff0000, v120
    v_lshlrev_b32 v134, 16, v121
    v_and_b32 v135, 0xffff0000, v121
    v_lshlrev_b32 v136, 16, v122
    v_and_b32 v137, 0xffff0000, v122
    v_lshlrev_b32 v138, 16, v123
    v_and_b32 v139, 0xffff0000, v123
    v_pk_fma_f32 v[140:141], v[86:87], v[132:133], v[140:141] op_sel:[1,0,0] op_sel_hi:[1,1,1]
    v_pk_fma_f32 v[142:143], v[86:87], v[134:135], v[142:143] op_sel:[1,0,0] op_sel_hi:[1,1,1]
    v_pk_fma_f32 v[144:145], v[86:87], v[136:137], v[144:145] op_sel:[1,0,0] op_sel_hi:[1,1,1]
    v_pk_fma_f32 v[146:147], v[86:87], v[138:139], v[146:147] op_sel:[1,0,0] op_sel_hi:[1,1,1]
    v_lshlrev_b32 v132, 16, v124
    v_and_b32 v133, 0xffff0000, v124
    v_lshlrev_b32 v134, 16, v125
    v_and_b32 v135, 0xffff0000, v125
    v_lshlrev_b32 v136, 16, v126
    v_and_b32 v137, 0xffff0000, v126
    v_lshlrev_b32 v138, 16, v127
    v_and_b32 v139, 0xffff0000, v127
    v_pk_fma_f32 v[140:141], v[88:89], v[132:133], v[140:141] op_sel:[0,0,0] op_sel_hi:[0,1,1]
    v_pk_fma_f32 v[142:143], v[88:89], v[134:135], v[142:143] op_sel:[0,0,0] op_sel_hi:[0,1,1]
    v_pk_fma_f32 v[144:145], v[88:89], v[136:137], v[144:145] op_sel:[0,0,0] op_sel_hi:[0,1,1]
    v_pk_fma_f32 v[146:147], v[88:89], v[138:139], v[146:147] op_sel:[0,0,0] op_sel_hi:[0,1,1]
    v_lshlrev_b32 v132, 16, v128
    v_and_b32 v133, 0xffff0000, v128
    v_lshlrev_b32 v134, 16, v129
    v_and_b32 v135, 0xffff0000, v129
    v_lshlrev_b32 v136, 16, v130
    v_and_b32 v137, 0xffff0000, v130
    v_lshlrev_b32 v138, 16, v131
    v_and_b32 v139, 0xffff0000, v131
    v_pk_fma_f32 v[140:141], v[88:89], v[132:133], v[140:141] op_sel:[1,0,0] op_sel_hi:[1,1,1]
    v_pk_fma_f32 v[142:143], v[88:89], v[134:135], v[142:143] op_sel:[1,0,0] op_sel_hi:[1,1,1]
    v_pk_fma_f32 v[144:145], v[88:89], v[136:137], v[144:145] op_sel:[1,0,0] op_sel_hi:[1,1,1]
    v_pk_fma_f32 v[146:147], v[88:89], v[138:139], v[146:147] op_sel:[1,0,0] op_sel_hi:[1,1,1]
    s_nop 0
    v_permlane32_swap_b32 v140, v144
    v_permlane32_swap_b32 v141, v145
    v_permlane32_swap_b32 v142, v146
    v_permlane32_swap_b32 v143, v147
    v_add_f32 v140, v140, v144
    v_add_f32 v141, v141, v145
    v_add_f32 v142, v142, v146
    v_add_f32 v143, v143, v147
    s_nop 0
    v_permlane16_swap_b32 v140, v142
    v_permlane16_swap_b32 v141, v143
    v_add_f32 v140, v140, v142
    v_add_f32 v141, v141, v143
    v_and_b32 v133, 7, v1
    v_lshrrev_b32 v134, 3, v1
    v_add_f32_dpp v132, v140, v140 row_ror:8 row_mask:0xf bank_mask:0x3
    s_nop 1
    v_add_f32_dpp v132, v141, v141 row_ror:8 row_mask:0xf bank_mask:0xc
    v_lshl_add_u32 v133, v133, 3, v134
    s_lshl_b32 s7, s3, 8
    s_add_u32 s7, s7, 122880
    v_lshl_add_u32 v133, v133, 2, s7
    ds_write_b32 v133, v132
    s_waitcnt lgkmcnt(0)
    s_barrier
    v_lshlrev_b32 v133, 2, v1
    v_add_u32 v134, 122880, v133
    ds_read_b32 v140, v134 offset:0
    ds_read_b32 v141, v134 offset:256
    ds_read_b32 v142, v134 offset:512
    ds_read_b32 v143, v134 offset:768
    v_add_u32 v133, s47, v133
    s_waitcnt lgkmcnt(2)
    v_add_f32 v140, v140, v141
    s_waitcnt lgkmcnt(0)
    v_add_f32 v142, v142, v143
    v_add_f32 v140, v140, v142
    v_min_u32 v140, -2, v140
    s_cmp_lg_u32 s3, 0
    s_cbranch_scc1 Lmod_skip_w
    global_store_dword v133, v140, s[38:39] offset:0 sc1
Lmod_skip_w:
Lwp_n3:
    s_branch Lwm_f
Lwm:
    s_sleep 2
Lwm_f:
    v_add_u32 v77, 0, v73
    global_load_dwordx4 v[80:83], v77, s[38:39] sc1
    global_load_dwordx4 v[84:87], v77, s[38:39] offset:2560 sc1
    v_add_u32 v77, 15360, v73
    global_load_dwordx4 v[88:91], v77, s[38:39] sc1
    global_load_dwordx4 v[92:95], v77, s[38:39] offset:2560 sc1
    s_waitcnt vmcnt(0)
    v_max_u32 v77, v80, v81
    v_max3_u32 v77, v82, v83, v77
    v_max3_u32 v77, v84, v85, v77
    v_max3_u32 v77, v86, v87, v77
    v_max3_u32 v77, v88, v89, v77
    v_max3_u32 v77, v90, v91, v77
    v_max3_u32 v77, v92, v93, v77
    v_max3_u32 v77, v94, v95, v77
    v_cmp_eq_u32 vcc, -1, v77
    s_add_u32 s100, s100, 1
    s_cmp_ge_u32 s100, 262144
    s_cbranch_scc1 Lwm_x
    s_cbranch_vccnz Lwm
Lwm_x:
    v_pk_add_f32 v[80:81], v[80:81], v[88:89] op_sel:[0,0] op_sel_hi:[1,1]
    v_pk_add_f32 v[82:83], v[82:83], v[90:91] op_sel:[0,0] op_sel_hi:[1,1]
    v_pk_add_f32 v[84:85], v[84:85], v[92:93] op_sel:[0,0] op_sel_hi:[1,1]
    v_pk_add_f32 v[86:87], v[86:87], v[94:95] op_sel:[0,0] op_sel_hi:[1,1]
    v_cvt_pk_bf16_f32 v80, v80, v80
    v_lshlrev_b32 v80, 16, v80
    v_cvt_pk_bf16_f32 v81, v81, v81
    v_lshlrev_b32 v81, 16, v81
    v_cvt_pk_bf16_f32 v82, v82, v82
    v_lshlrev_b32 v82, 16, v82
    v_cvt_pk_bf16_f32 v83, v83, v83
    v_lshlrev_b32 v83, 16, v83
    v_cvt_pk_bf16_f32 v84, v84, v84
    v_lshlrev_b32 v84, 16, v84
    v_cvt_pk_bf16_f32 v85, v85, v85
    v_lshlrev_b32 v85, 16, v85
    v_cvt_pk_bf16_f32 v86, v86, v86
    v_lshlrev_b32 v86, 16, v86
    v_cvt_pk_bf16_f32 v87, v87, v87
    v_lshlrev_b32 v87, 16, v87
    v_add_f32 v84, 1.0, v84
    v_add_f32 v85, 1.0, v85
    v_add_f32 v86, 1.0, v86
    v_add_f32 v87, 1.0, v87
    v_cvt_pk_bf16_f32 v84, v84, v84
    v_lshlrev_b32 v84, 16, v84
    v_cvt_pk_bf16_f32 v85, v85, v85
    v_lshlrev_b32 v85, 16, v85
    v_cvt_pk_bf16_f32 v86, v86, v86
    v_lshlrev_b32 v86, 16, v86
    v_cvt_pk_bf16_f32 v87, v87, v87
    v_lshlrev_b32 v87, 16, v87
    ds_write_b128 v72, v[84:87]
    ds_write_b128 v72, v[80:83] offset:640
    ds_read_b128 v[32:35], v74 offset:0
    ds_read_b128 v[36:39], v74 offset:16
    ds_read_b128 v[40:43], v74 offset:128
    ds_read_b128 v[44:47], v74 offset:144
    ds_read_b128 v[48:51], v74 offset:256
    ds_read_b128 v[52:55], v74 offset:272
    ds_read_b128 v[56:59], v74 offset:384
    ds_read_b128 v[60:63], v74 offset:400
    ds_read_b128 v[64:67], v74 offset:512
    ds_read_b128 v[68:71], v74 offset:528
    s_waitcnt lgkmcnt(9)
    v_pk_mul_f32 v[96:97], v[32:33], v[152:153] op_sel:[0,0] op_sel_hi:[0,1]
    v_pk_mul_f32 v[98:99], v[32:33], v[154:155] op_sel:[1,0] op_sel_hi:[1,1]
    v_pk_mul_f32 v[100:101], v[34:35], v[156:157] op_sel:[0,0] op_sel_hi:[0,1]
    v_pk_mul_f32 v[102:103], v[34:35], v[158:159] op_sel:[1,0] op_sel_hi:[1,1]
    s_waitcnt lgkmcnt(8)
    v_pk_mul_f32 v[104:105], v[36:37], v[160:161] op_sel:[0,0] op_sel_hi:[0,1]
    v_pk_mul_f32 v[106:107], v[36:37], v[162:163] op_sel:[1,0] op_sel_hi:[1,1]
    v_pk_mul_f32 v[108:109], v[38:39], v[164:165] op_sel:[0,0] op_sel_hi:[0,1]
    v_pk_mul_f32 v[110:111], v[38:39], v[166:167] op_sel:[1,0] op_sel_hi:[1,1]
    v_cvt_pk_bf16_f32 v112, v96, v98
    v_cvt_pk_bf16_f32 v113, v100, v102
    v_cvt_pk_bf16_f32 v114, v104, v106
    v_cvt_pk_bf16_f32 v115, v108, v110
    v_cvt_pk_bf16_f32 v116, v97, v99
    v_cvt_pk_bf16_f32 v117, v101, v103
    v_cvt_pk_bf16_f32 v118, v105, v107
    v_cvt_pk_bf16_f32 v119, v109, v111
    global_store_dwordx4 v75, v[112:115], s[38:39] offset:-2048 sc1
    global_store_dwordx4 v76, v[116:119], s[38:39] offset:-2048 sc1
    s_waitcnt lgkmcnt(7)
    v_pk_mul_f32 v[96:97], v[40:41], v[168:169] op_sel:[0,0] op_sel_hi:[0,1]
    v_pk_mul_f32 v[98:99], v[40:41], v[170:171] op_sel:[1,0] op_sel_hi:[1,1]
    v_pk_mul_f32 v[100:101], v[42:43], v[172:173] op_sel:[0,0] op_sel_hi:[0,1]
    v_pk_mul_f32 v[102:103], v[42:43], v[174:175] op_sel:[1,0] op_sel_hi:[1,1]
    s_waitcnt lgkmcnt(6)
    v_pk_mul_f32 v[104:105], v[44:45], v[176:177] op_sel:[0,0] op_sel_hi:[0,1]
    v_pk_mul_f32 v[106:107], v[44:45], v[178:179] op_sel:[1,0] op_sel_hi:[1,1]
    v_pk_mul_f32 v[108:109], v[46:47], v[180:181] op_sel:[0,0] op_sel_hi:[0,1]
    v_pk_mul_f32 v[110:111], v[46:47], v[182:183] op_sel:[1,0] op_sel_hi:[1,1]
    v_cvt_pk_bf16_f32 v120, v96, v98
    v_cvt_pk_bf16_f32 v121, v100, v102
    v_cvt_pk_bf16_f32 v122, v104, v106
    v_cvt_pk_bf16_f32 v123, v108, v110
    v_cvt_pk_bf16_f32 v124, v97, v99
    v_cvt_pk_bf16_f32 v125, v101, v103
    v_cvt_pk_bf16_f32 v126, v105, v107
    v_cvt_pk_bf16_f32 v127, v109, v111
    global_store_dwordx4 v75, v[120:123], s[38:39] offset:-1024 sc1
    global_store_dwordx4 v76, v[124:127], s[38:39] offset:-1024 sc1
    s_waitcnt lgkmcnt(5)
    v_pk_mul_f32 v[96:97], v[48:49], v[184:185] op_sel:[0,0] op_sel_hi:[0,1]
    v_pk_mul_f32 v[98:99], v[48:49], v[186:187] op_sel:[1,0] op_sel_hi:[1,1]
    v_pk_mul_f32 v[100:101], v[50:51], v[188:189] op_sel:[0,0] op_sel_hi:[0,1]
    v_pk_mul_f32 v[102:103], v[50:51], v[190:191] op_sel:[1,0] op_sel_hi:[1,1]
    s_waitcnt lgkmcnt(4)
    v_pk_mul_f32 v[104:105], v[52:53], v[192:193] op_sel:[0,0] op_sel_hi:[0,1]
    v_pk_mul_f32 v[106:107], v[52:53], v[194:195] op_sel:[1,0] op_sel_hi:[1,1]
    v_pk_mul_f32 v[108:109], v[54:55], v[196:197] op_sel:[0,0] op_sel_hi:[0,1]
    v_pk_mul_f32 v[110:111], v[54:55], v[198:199] op_sel:[1,0] op_sel_hi:[1,1]
    v_cvt_pk_bf16_f32 v128, v96, v98
    v_cvt_pk_bf16_f32 v129, v100, v102
    v_cvt_pk_bf16_f32 v130, v104, v106
    v_cvt_pk_bf16_f32 v131, v108, v110
    v_cvt_pk_bf16_f32 v132, v97, v99
    v_cvt_pk_bf16_f32 v133, v101, v103
    v_cvt_pk_bf16_f32 v134, v105, v107
    v_cvt_pk_bf16_f32 v135, v109, v111
    global_store_dwordx4 v75, v[128:131], s[38:39] offset:0 sc1
    global_store_dwordx4 v76, v[132:135], s[38:39] offset:0 sc1
    s_waitcnt lgkmcnt(3)
    v_pk_mul_f32 v[96:97], v[56:57], v[200:201] op_sel:[0,0] op_sel_hi:[0,1]
    v_pk_mul_f32 v[98:99], v[56:57], v[202:203] op_sel:[1,0] op_sel_hi:[1,1]
    v_pk_mul_f32 v[100:101], v[58:59], v[204:205] op_sel:[0,0] op_sel_hi:[0,1]
    v_pk_mul_f32 v[102:103], v[58:59], v[206:207] op_sel:[1,0] op_sel_hi:[1,1]
    s_waitcnt lgkmcnt(2)
    v_pk_mul_f32 v[104:105], v[60:61], v[208:209] op_sel:[0,0] op_sel_hi:[0,1]
    v_pk_mul_f32 v[106:107], v[60:61], v[210:211] op_sel:[1,0] op_sel_hi:[1,1]
    v_pk_mul_f32 v[108:109], v[62:63], v[212:213] op_sel:[0,0] op_sel_hi:[0,1]
    v_pk_mul_f32 v[110:111], v[62:63], v[214:215] op_sel:[1,0] op_sel_hi:[1,1]
    v_cvt_pk_bf16_f32 v136, v96, v98
    v_cvt_pk_bf16_f32 v137, v100, v102
    v_cvt_pk_bf16_f32 v138, v104, v106
    v_cvt_pk_bf16_f32 v139, v108, v110
    v_cvt_pk_bf16_f32 v140, v97, v99
    v_cvt_pk_bf16_f32 v141, v101, v103
    v_cvt_pk_bf16_f32 v142, v105, v107
    v_cvt_pk_bf16_f32 v143, v109, v111
    global_store_dwordx4 v75, v[136:139], s[38:39] offset:1024 sc1
    global_store_dwordx4 v76, v[140:143], s[38:39] offset:1024 sc1
    s_waitcnt lgkmcnt(1)
    v_pk_mul_f32 v[96:97], v[64:65], v[216:217] op_sel:[0,0] op_sel_hi:[0,1]
    v_pk_mul_f32 v[98:99], v[64:65], v[218:219] op_sel:[1,0] op_sel_hi:[1,1]
    v_pk_mul_f32 v[100:101], v[66:67], v[220:221] op_sel:[0,0] op_sel_hi:[0,1]
    v_pk_mul_f32 v[102:103], v[66:67], v[222:223] op_sel:[1,0] op_sel_hi:[1,1]
    s_waitcnt lgkmcnt(0)
    v_pk_mul_f32 v[104:105], v[68:69], v[224:225] op_sel:[0,0] op_sel_hi:[0,1]
    v_pk_mul_f32 v[106:107], v[68:69], v[226:227] op_sel:[1,0] op_sel_hi:[1,1]
    v_pk_mul_f32 v[108:109], v[70:71], v[228:229] op_sel:[0,0] op_sel_hi:[0,1]
    v_pk_mul_f32 v[110:111], v[70:71], v[230:231] op_sel:[1,0] op_sel_hi:[1,1]
    v_cvt_pk_bf16_f32 v144, v96, v98
    v_cvt_pk_bf16_f32 v145, v100, v102
    v_cvt_pk_bf16_f32 v146, v104, v106
    v_cvt_pk_bf16_f32 v147, v108, v110
    v_cvt_pk_bf16_f32 v148, v97, v99
    v_cvt_pk_bf16_f32 v149, v101, v103
    v_cvt_pk_bf16_f32 v150, v105, v107
    v_cvt_pk_bf16_f32 v151, v109, v111
    global_store_dwordx4 v75, v[144:147], s[38:39] offset:2048 sc1
    global_store_dwordx4 v76, v[148:151], s[38:39] offset:2048 sc1
    ds_read_b128 v[32:35], v74 offset:640
    ds_read_b128 v[36:39], v74 offset:656
    ds_read_b128 v[40:43], v74 offset:768
    ds_read_b128 v[44:47], v74 offset:784
    ds_read_b128 v[48:51], v74 offset:896
    ds_read_b128 v[52:55], v74 offset:912
    ds_read_b128 v[56:59], v74 offset:1024
    ds_read_b128 v[60:63], v74 offset:1040
    ds_read_b128 v[64:67], v74 offset:1152
    ds_read_b128 v[68:71], v74 offset:1168
    s_mov_b32 s7, 0x3f803f80
    v_mov_b32 v88, 0
    v_mov_b32 v89, 0
    v_mov_b32 v90, 0
    v_mov_b32 v91, 0
    v_mov_b32 v92, 0
    v_mov_b32 v93, 0
    v_mov_b32 v94, 0
    v_mov_b32 v95, 0
    v_dot2_f32_bf16 v88, v112, s7, v88
    v_dot2_f32_bf16 v89, v116, s7, v89
    v_dot2_f32_bf16 v88, v113, s7, v88
    v_dot2_f32_bf16 v89, v117, s7, v89
    v_dot2_f32_bf16 v88, v114, s7, v88
    v_dot2_f32_bf16 v89, v118, s7, v89
    v_dot2_f32_bf16 v88, v115, s7, v88
    v_dot2_f32_bf16 v89, v119, s7, v89
    v_dot2_f32_bf16 v88, v120, s7, v88
    v_dot2_f32_bf16 v89, v124, s7, v89
    v_dot2_f32_bf16 v88, v121, s7, v88
    v_dot2_f32_bf16 v89, v125, s7, v89
    v_dot2_f32_bf16 v88, v122, s7, v88
    v_dot2_f32_bf16 v89, v126, s7, v89
    v_dot2_f32_bf16 v88, v123, s7, v88
    v_dot2_f32_bf16 v89, v127, s7, v89
    v_dot2_f32_bf16 v88, v128, s7, v88
    v_dot2_f32_bf16 v89, v132, s7, v89
    v_dot2_f32_bf16 v88, v129, s7, v88
    v_dot2_f32_bf16 v89, v133, s7, v89
    v_dot2_f32_bf16 v88, v130, s7, v88
    v_dot2_f32_bf16 v89, v134, s7, v89
    v_dot2_f32_bf16 v88, v131, s7, v88
    v_dot2_f32_bf16 v89, v135, s7, v89
    v_dot2_f32_bf16 v88, v136, s7, v88
    v_dot2_f32_bf16 v89, v140, s7, v89
    v_dot2_f32_bf16 v88, v137, s7, v88
    v_dot2_f32_bf16 v89, v141, s7, v89
    v_dot2_f32_bf16 v88, v138, s7, v88
    v_dot2_f32_bf16 v89, v142, s7, v89
    v_dot2_f32_bf16 v88, v139, s7, v88
    v_dot2_f32_bf16 v89, v143, s7, v89
    v_dot2_f32_bf16 v88, v144, s7, v88
    v_dot2_f32_bf16 v89, v148, s7, v89
    v_dot2_f32_bf16 v88, v145, s7, v88
    v_dot2_f32_bf16 v89, v149, s7, v89
    v_dot2_f32_bf16 v88, v146, s7, v88
    v_dot2_f32_bf16 v89, v150, s7, v89
    v_dot2_f32_bf16 v88, v147, s7, v88
    v_dot2_f32_bf16 v89, v151, s7, v89
    s_waitcnt lgkmcnt(9)
    v_pk_fma_f32 v[90:91], v[32:33], v[152:153], v[90:91] op_sel:[0,0,0] op_sel_hi:[0,1,1]
    v_pk_fma_f32 v[92:93], v[32:33], v[154:155], v[92:93] op_sel:[1,0,0] op_sel_hi:[1,1,1]
    v_pk_fma_f32 v[94:95], v[34:35], v[156:157], v[94:95] op_sel:[0,0,0] op_sel_hi:[0,1,1]
    v_pk_fma_f32 v[90:91], v[34:35], v[158:159], v[90:91] op_sel:[1,0,0] op_sel_hi:[1,1,1]
    s_waitcnt lgkmcnt(8)
    v_pk_fma_f32 v[92:93], v[36:37], v[160:161], v[92:93] op_sel:[0,0,0] op_sel_hi:[0,1,1]
    v_pk_fma_f32 v[94:95], v[36:37], v[162:163], v[94:95] op_sel:[1,0,0] op_sel_hi:[1,1,1]
    v_pk_fma_f32 v[90:91], v[38:39], v[164:165], v[90:91] op_sel:[0,0,0] op_sel_hi:[0,1,1]
    v_pk_fma_f32 v[92:93], v[38:39], v[166:167], v[92:93] op_sel:[1,0,0] op_sel_hi:[1,1,1]
    s_waitcnt lgkmcnt(7)
    v_pk_fma_f32 v[94:95], v[40:41], v[168:169], v[94:95] op_sel:[0,0,0] op_sel_hi:[0,1,1]
    v_pk_fma_f32 v[90:91], v[40:41], v[170:171], v[90:91] op_sel:[1,0,0] op_sel_hi:[1,1,1]
    v_pk_fma_f32 v[92:93], v[42:43], v[172:173], v[92:93] op_sel:[0,0,0] op_sel_hi:[0,1,1]
    v_pk_fma_f32 v[94:95], v[42:43], v[174:175], v[94:95] op_sel:[1,0,0] op_sel_hi:[1,1,1]
    s_waitcnt lgkmcnt(6)
    v_pk_fma_f32 v[90:91], v[44:45], v[176:177], v[90:91] op_sel:[0,0,0] op_sel_hi:[0,1,1]
    v_pk_fma_f32 v[92:93], v[44:45], v[178:179], v[92:93] op_sel:[1,0,0] op_sel_hi:[1,1,1]
    v_pk_fma_f32 v[94:95], v[46:47], v[180:181], v[94:95] op_sel:[0,0,0] op_sel_hi:[0,1,1]
    v_pk_fma_f32 v[90:91], v[46:47], v[182:183], v[90:91] op_sel:[1,0,0] op_sel_hi:[1,1,1]
    s_waitcnt lgkmcnt(5)
    v_pk_fma_f32 v[92:93], v[48:49], v[184:185], v[92:93] op_sel:[0,0,0] op_sel_hi:[0,1,1]
    v_pk_fma_f32 v[94:95], v[48:49], v[186:187], v[94:95] op_sel:[1,0,0] op_sel_hi:[1,1,1]
    v_pk_fma_f32 v[90:91], v[50:51], v[188:189], v[90:91] op_sel:[0,0,0] op_sel_hi:[0,1,1]
    v_pk_fma_f32 v[92:93], v[50:51], v[190:191], v[92:93] op_sel:[1,0,0] op_sel_hi:[1,1,1]
    s_waitcnt lgkmcnt(4)
    v_pk_fma_f32 v[94:95], v[52:53], v[192:193], v[94:95] op_sel:[0,0,0] op_sel_hi:[0,1,1]
    v_pk_fma_f32 v[90:91], v[52:53], v[194:195], v[90:91] op_sel:[1,0,0] op_sel_hi:[1,1,1]
    v_pk_fma_f32 v[92:93], v[54:55], v[196:197], v[92:93] op_sel:[0,0,0] op_sel_hi:[0,1,1]
    v_pk_fma_f32 v[94:95], v[54:55], v[198:199], v[94:95] op_sel:[1,0,0] op_sel_hi:[1,1,1]
    s_waitcnt lgkmcnt(3)
    v_pk_fma_f32 v[90:91], v[56:57], v[200:201], v[90:91] op_sel:[0,0,0] op_sel_hi:[0,1,1]
    v_pk_fma_f32 v[92:93], v[56:57], v[202:203], v[92:93] op_sel:[1,0,0] op_sel_hi:[1,1,1]
    v_pk_fma_f32 v[94:95], v[58:59], v[204:205], v[94:95] op_sel:[0,0,0] op_sel_hi:[0,1,1]
    v_pk_fma_f32 v[90:91], v[58:59], v[206:207], v[90:91] op_sel:[1,0,0] op_sel_hi:[1,1,1]
    s_waitcnt lgkmcnt(2)
    v_pk_fma_f32 v[92:93], v[60:61], v[208:209], v[92:93] op_sel:[0,0,0] op_sel_hi:[0,1,1]
    v_pk_fma_f32 v[94:95], v[60:61], v[210:211], v[94:95] op_sel:[1,0,0] op_sel_hi:[1,1,1]
    v_pk_fma_f32 v[90:91], v[62:63], v[212:213], v[90:91] op_sel:[0,0,0] op_sel_hi:[0,1,1]
    v_pk_fma_f32 v[92:93], v[62:63], v[214:215], v[92:93] op_sel:[1,0,0] op_sel_hi:[1,1,1]
    s_waitcnt lgkmcnt(1)
    v_pk_fma_f32 v[94:95], v[64:65], v[216:217], v[94:95] op_sel:[0,0,0] op_sel_hi:[0,1,1]
    v_pk_fma_f32 v[90:91], v[64:65], v[218:219], v[90:91] op_sel:[1,0,0] op_sel_hi:[1,1,1]
    v_pk_fma_f32 v[92:93], v[66:67], v[220:221], v[92:93] op_sel:[0,0,0] op_sel_hi:[0,1,1]
    v_pk_fma_f32 v[94:95], v[66:67], v[222:223], v[94:95] op_sel:[1,0,0] op_sel_hi:[1,1,1]
    s_waitcnt lgkmcnt(0)
    v_pk_fma_f32 v[90:91], v[68:69], v[224:225], v[90:91] op_sel:[0,0,0] op_sel_hi:[0,1,1]
    v_pk_fma_f32 v[92:93], v[68:69], v[226:227], v[92:93] op_sel:[1,0,0] op_sel_hi:[1,1,1]
    v_pk_fma_f32 v[94:95], v[70:71], v[228:229], v[94:95] op_sel:[0,0,0] op_sel_hi:[0,1,1]
    v_pk_fma_f32 v[90:91], v[70:71], v[230:231], v[90:91] op_sel:[1,0,0] op_sel_hi:[1,1,1]
    v_pk_add_f32 v[90:91], v[90:91], v[92:93] op_sel:[0,0] op_sel_hi:[1,1]
    v_pk_add_f32 v[90:91], v[90:91], v[94:95] op_sel:[0,0] op_sel_hi:[1,1]
    v_permlane32_swap_b32 v88, v89
    s_nop 0
    v_permlane32_swap_b32 v90, v91
    v_add_f32 v88, v88, v89
    v_add_f32 v90, v90, v91
    s_nop 1
    v_permlane16_swap_b32 v88, v90
    v_add_f32 v88, v88, v90
    v_lshlrev_b32 v74, 2, v0
    v_add_u32 v74, 131072, v74
    ds_write_b32 v74, v88
    v_xor_b32 v74, 256, v74
    s_waitcnt vmcnt(0) lgkmcnt(0)
    s_barrier
    ds_read_b32 v89, v74
    s_lshl_b32 s6, s46, 7
    s_lshr_b32 s5, s44, 1
    s_mul_i32 s5, s5, 14336
    s_add_u32 s6, s6, s5
    s_add_u32 s6, s6, 49152
    v_lshl_add_u32 v74, v1, 2, s6
    s_waitcnt lgkmcnt(0)
    v_add_f32 v88, v88, v89
    v_min_u32 v88, -2, v88
    s_bitcmp1_b32 s3, 0
    s_cbranch_scc1 Lwp_skip
    global_store_dword v74, v88, s[38:39] sc1
Lwp_skip:
    s_branch Lsp_c
Lsp_b3:
    v_lshlrev_b32 v82, 16, v80
    v_and_b32 v83, 0xffff0000, v80
    v_lshlrev_b32 v29, 2, v29
    v_mul_f32 v84, 0xbfb8aa3b, v82
    v_mul_f32 v85, 0xbfb8aa3b, v83
    v_exp_f32 v84, v84
    v_exp_f32 v85, v85
    v_add_f32 v84, 1.0, v84
    v_add_f32 v85, 1.0, v85
    v_rcp_f32 v84, v84
    v_rcp_f32 v85, v85
    v_mul_f32 v82, v82, v84
    v_mul_f32 v83, v83, v85
    v_cvt_pk_bf16_f32 v80, v82, v83
    ds_bpermute_b32 v88, v29, v80 offset:0
    ds_bpermute_b32 v89, v29, v80 offset:32
    ds_bpermute_b32 v90, v29, v80 offset:64
    ds_bpermute_b32 v91, v29, v80 offset:96
    ds_bpermute_b32 v92, v29, v80 offset:128
    s_waitcnt lgkmcnt(4)
    v_lshlrev_b32 v30, 16, v88
    v_and_b32 v31, 0xffff0000, v88
    s_waitcnt lgkmcnt(3)
    v_lshlrev_b32 v32, 16, v89
    v_and_b32 v33, 0xffff0000, v89
    s_waitcnt lgkmcnt(2)
    v_lshlrev_b32 v34, 16, v90
    v_and_b32 v35, 0xffff0000, v90
    s_waitcnt lgkmcnt(1)
    v_lshlrev_b32 v36, 16, v91
    v_and_b32 v37, 0xffff0000, v91
    s_waitcnt lgkmcnt(0)
    v_lshlrev_b32 v38, 16, v92
    v_and_b32 v39, 0xffff0000, v92
    v_lshlrev_b32 v80, 16, v40
    v_and_b32 v81, 0xffff0000, v40
    v_lshlrev_b32 v82, 16, v41
    v_and_b32 v83, 0xffff0000, v41
    v_lshlrev_b32 v84, 16, v42
    v_and_b32 v85, 0xffff0000, v42
    v_lshlrev_b32 v86, 16, v43
    v_and_b32 v87, 0xffff0000, v43
    v_pk_mul_f32 v[88:89], v[30:31], v[80:81] op_sel:[0,0] op_sel_hi:[0,1]
    v_pk_mul_f32 v[90:91], v[30:31], v[82:83] op_sel:[0,0] op_sel_hi:[0,1]
    v_pk_mul_f32 v[92:93], v[30:31], v[84:85] op_sel:[0,0] op_sel_hi:[0,1]
    v_pk_mul_f32 v[94:95], v[30:31], v[86:87] op_sel:[0,0] op_sel_hi:[0,1]
    v_lshlrev_b32 v80, 16, v44
    v_and_b32 v81, 0xffff0000, v44
    v_lshlrev_b32 v82, 16, v45
    v_and_b32 v83, 0xffff0000, v45
    v_lshlrev_b32 v84, 16, v46
    v_and_b32 v85, 0xffff0000, v46
    v_lshlrev_b32 v86, 16, v47
    v_and_b32 v87, 0xffff0000, v47
    v_pk_fma_f32 v[88:89], v[30:31], v[80:81], v[88:89] op_sel:[1,0,0] op_sel_hi:[1,1,1]
    v_pk_fma_f32 v[90:91], v[30:31], v[82:83], v[90:91] op_sel:[1,0,0] op_sel_hi:[1,1,1]
    v_pk_fma_f32 v[92:93], v[30:31], v[84:85], v[92:93] op_sel:[1,0,0] op_sel_hi:[1,1,1]
    v_pk_fma_f32 v[94:95], v[30:31], v[86:87], v[94:95] op_sel:[1,0,0] op_sel_hi:[1,1,1]
    v_lshlrev_b32 v80, 16, v48
    v_and_b32 v81, 0xffff0000, v48
    v_lshlrev_b32 v82, 16, v49
    v_and_b32 v83, 0xffff0000, v49
    v_lshlrev_b32 v84, 16, v50
    v_and_b32 v85, 0xffff0000, v50
    v_lshlrev_b32 v86, 16, v51
    v_and_b32 v87, 0xffff0000, v51
    v_pk_fma_f32 v[88:89], v[32:33], v[80:81], v[88:89] op_sel:[0,0,0] op_sel_hi:[0,1,1]
    v_pk_fma_f32 v[90:91], v[32:33], v[82:83], v[90:91] op_sel:[0,0,0] op_sel_hi:[0,1,1]
    v_pk_fma_f32 v[92:93], v[32:33], v[84:85], v[92:93] op_sel:[0,0,0] op_sel_hi:[0,1,1]
    v_pk_fma_f32 v[94:95], v[32:33], v[86:87], v[94:95] op_sel:[0,0,0] op_sel_hi:[0,1,1]
    v_lshlrev_b32 v80, 16, v52
    v_and_b32 v81, 0xffff0000, v52
    v_lshlrev_b32 v82, 16, v53
    v_and_b32 v83, 0xffff0000, v53
    v_lshlrev_b32 v84, 16, v54
    v_and_b32 v85, 0xffff0000, v54
    v_lshlrev_b32 v86, 16, v55
    v_and_b32 v87, 0xffff0000, v55
    v_pk_fma_f32 v[88:89], v[32:33], v[80:81], v[88:89] op_sel:[1,0,0] op_sel_hi:[1,1,1]
    v_pk_fma_f32 v[90:91], v[32:33], v[82:83], v[90:91] op_sel:[1,0,0] op_sel_hi:[1,1,1]
    v_pk_fma_f32 v[92:93], v[32:33], v[84:85], v[92:93] op_sel:[1,0,0] op_sel_hi:[1,1,1]
    v_pk_fma_f32 v[94:95], v[32:33], v[86:87], v[94:95] op_sel:[1,0,0] op_sel_hi:[1,1,1]
    v_lshlrev_b32 v80, 16, v56
    v_and_b32 v81, 0xffff0000, v56
    v_lshlrev_b32 v82, 16, v57
    v_and_b32 v83, 0xffff0000, v57
    v_lshlrev_b32 v84, 16, v58
    v_and_b32 v85, 0xffff0000, v58
    v_lshlrev_b32 v86, 16, v59
    v_and_b32 v87, 0xffff0000, v59
    v_pk_fma_f32 v[88:89], v[34:35], v[80:81], v[88:89] op_sel:[0,0,0] op_sel_hi:[0,1,1]
    v_pk_fma_f32 v[90:91], v[34:35], v[82:83], v[90:91] op_sel:[0,0,0] op_sel_hi:[0,1,1]
    v_pk_fma_f32 v[92:93], v[34:35], v[84:85], v[92:93] op_sel:[0,0,0] op_sel_hi:[0,1,1]
    v_pk_fma_f32 v[94:95], v[34:35], v[86:87], v[94:95] op_sel:[0,0,0] op_sel_hi:[0,1,1]
    v_lshlrev_b32 v80, 16, v60
    v_and_b32 v81, 0xffff0000, v60
    v_lshlrev_b32 v82, 16, v61
    v_and_b32 v83, 0xffff0000, v61
    v_lshlrev_b32 v84, 16, v62
    v_and_b32 v85, 0xffff0000, v62
    v_lshlrev_b32 v86, 16, v63
    v_and_b32 v87, 0xffff0000, v63
    v_pk_fma_f32 v[88:89], v[34:35], v[80:81], v[88:89] op_sel:[1,0,0] op_sel_hi:[1,1,1]
    v_pk_fma_f32 v[90:91], v[34:35], v[82:83], v[90:91] op_sel:[1,0,0] op_sel_hi:[1,1,1]
    v_pk_fma_f32 v[92:93], v[34:35], v[84:85], v[92:93] op_sel:[1,0,0] op_sel_hi:[1,1,1]
    v_pk_fma_f32 v[94:95], v[34:35], v[86:87], v[94:95] op_sel:[1,0,0] op_sel_hi:[1,1,1]
    v_lshlrev_b32 v80, 16, v64
    v_and_b32 v81, 0xffff0000, v64
    v_lshlrev_b32 v82, 16, v65
    v_and_b32 v83, 0xffff0000, v65
    v_lshlrev_b32 v84, 16, v66
    v_and_b32 v85, 0xffff0000, v66
    v_lshlrev_b32 v86, 16, v67
    v_and_b32 v87, 0xffff0000, v67
    v_pk_fma_f32 v[88:89], v[36:37], v[80:81], v[88:89] op_sel:[0,0,0] op_sel_hi:[0,1,1]
    v_pk_fma_f32 v[90:91], v[36:37], v[82:83], v[90:91] op_sel:[0,0,0] op_sel_hi:[0,1,1]
    v_pk_fma_f32 v[92:93], v[36:37], v[84:85], v[92:93] op_sel:[0,0,0] op_sel_hi:[0,1,1]
    v_pk_fma_f32 v[94:95], v[36:37], v[86:87], v[94:95] op_sel:[0,0,0] op_sel_hi:[0,1,1]
    v_lshlrev_b32 v80, 16, v68
    v_and_b32 v81, 0xffff0000, v68
    v_lshlrev_b32 v82, 16, v69
    v_and_b32 v83, 0xffff0000, v69
    v_lshlrev_b32 v84, 16, v70
    v_and_b32 v85, 0xffff0000, v70
    v_lshlrev_b32 v86, 16, v71
    v_and_b32 v87, 0xffff0000, v71
    v_pk_fma_f32 v[88:89], v[36:37], v[80:81], v[88:89] op_sel:[1,0,0] op_sel_hi:[1,1,1]
    v_pk_fma_f32 v[90:91], v[36:37], v[82:83], v[90:91] op_sel:[1,0,0] op_sel_hi:[1,1,1]
    v_pk_fma_f32 v[92:93], v[36:37], v[84:85], v[92:93] op_sel:[1,0,0] op_sel_hi:[1,1,1]
    v_pk_fma_f32 v[94:95], v[36:37], v[86:87], v[94:95] op_sel:[1,0,0] op_sel_hi:[1,1,1]
    v_lshlrev_b32 v80, 16, v72
    v_and_b32 v81, 0xffff0000, v72
    v_lshlrev_b32 v82, 16, v73
    v_and_b32 v83, 0xffff0000, v73
    v_lshlrev_b32 v84, 16, v74
    v_and_b32 v85, 0xffff0000, v74
    v_lshlrev_b32 v86, 16, v75
    v_and_b32 v87, 0xffff0000, v75
    v_pk_fma_f32 v[88:89], v[38:39], v[80:81], v[88:89] op_sel:[0,0,0] op_sel_hi:[0,1,1]
    v_pk_fma_f32 v[90:91], v[38:39], v[82:83], v[90:91] op_sel:[0,0,0] op_sel_hi:[0,1,1]
    v_pk_fma_f32 v[92:93], v[38:39], v[84:85], v[92:93] op_sel:[0,0,0] op_sel_hi:[0,1,1]
    v_pk_fma_f32 v[94:95], v[38:39], v[86:87], v[94:95] op_sel:[0,0,0] op_sel_hi:[0,1,1]
    v_lshlrev_b32 v80, 16, v76
    v_and_b32 v81, 0xffff0000, v76
    v_lshlrev_b32 v82, 16, v77
    v_and_b32 v83, 0xffff0000, v77
    v_lshlrev_b32 v84, 16, v78
    v_and_b32 v85, 0xffff0000, v78
    v_lshlrev_b32 v86, 16, v79
    v_and_b32 v87, 0xffff0000, v79
    v_pk_fma_f32 v[88:89], v[38:39], v[80:81], v[88:89] op_sel:[1,0,0] op_sel_hi:[1,1,1]
    v_pk_fma_f32 v[90:91], v[38:39], v[82:83], v[90:91] op_sel:[1,0,0] op_sel_hi:[1,1,1]
    v_pk_fma_f32 v[92:93], v[38:39], v[84:85], v[92:93] op_sel:[1,0,0] op_sel_hi:[1,1,1]
    v_pk_fma_f32 v[94:95], v[38:39], v[86:87], v[94:95] op_sel:[1,0,0] op_sel_hi:[1,1,1]
    s_nop 0
    v_permlane32_swap_b32 v88, v92
    v_permlane32_swap_b32 v89, v93
    v_permlane32_swap_b32 v90, v94
    v_permlane32_swap_b32 v91, v95
    v_add_f32 v88, v88, v92
    v_add_f32 v89, v89, v93
    v_add_f32 v90, v90, v94
    v_add_f32 v91, v91, v95
    s_nop 0
    v_permlane16_swap_b32 v88, v90
    v_permlane16_swap_b32 v89, v91
    v_add_f32 v88, v88, v90
    v_add_f32 v89, v89, v91
    v_and_b32 v81, 7, v1
    v_lshrrev_b32 v82, 3, v1
    v_add_f32_dpp v80, v88, v88 row_ror:8 row_mask:0xf bank_mask:0x3
    s_nop 1
    v_add_f32_dpp v80, v89, v89 row_ror:8 row_mask:0xf bank_mask:0xc
    v_lshl_add_u32 v81, v81, 3, v82
    s_lshl_b32 s7, s3, 8
    s_add_u32 s7, s7, 124928
    v_lshl_add_u32 v81, v81, 2, s7
    ds_write_b32 v81, v80
    s_waitcnt lgkmcnt(0)
    s_barrier
    v_lshlrev_b32 v81, 2, v1
    v_add_u32 v82, 124928, v81
    ds_read_b32 v88, v82 offset:0
    ds_read_b32 v89, v82 offset:256
    ds_read_b32 v90, v82 offset:512
    ds_read_b32 v91, v82 offset:768
    v_add_u32 v81, s44, v81
    s_waitcnt lgkmcnt(2)
    v_add_f32 v88, v88, v89
    s_waitcnt lgkmcnt(0)
    v_add_f32 v90, v90, v91
    v_add_f32 v88, v88, v90
    v_min_u32 v88, -2, v88
    s_cmp_lg_u32 s3, 0
    s_cbranch_scc1 Lmod_skip_s3
    global_store_dword v81, v88, s[38:39] offset:0 sc1
Lmod_skip_s3:
Lsp_c:
    s_mov_b32 s51, 102400
Lsp_d:
    s_mov_b32 s93, s51
    s_waitcnt lgkmcnt(0)
    s_barrier
    s_lshr_b32 s5, s3, 1
    s_lshl_b32 s5, s5, 5
    s_and_b32 s6, s3, 1
    s_lshl_b32 s6, s6, 2
    s_add_u32 s6, s6, s5
    s_lshl_b32 s5, s40, 6
    s_add_u32 s90, s6, s5
    v_add_lshl_u32 v27, v5, s90, 1
    global_load_ushort v27, v27, s[26:27]
    s_and_b32 s4, s41, 3
    s_cmp_eq_u32 s4, 0
    s_cselect_b32 s5, 8, 0
    s_cmp_le_u32 s4, 1
    s_cselect_b32 s6, 16, 8
    s_cmp_eq_u32 s4, 3
    s_cselect_b32 s50, 16, 24
    s_lshl_b32 s44, s4, 3
    s_bitcmp1_b32 s43, 0
    s_cselect_b32 s46, s6, s5
    s_cselect_b32 s48, s5, s6
    s_lshl_b32 s5, s3, 1
    s_add_u32 s44, s44, s5
    s_add_u32 s45, s44, 1
    s_add_u32 s46, s46, s5
    s_add_u32 s47, s46, 1
    s_add_u32 s48, s48, s5
    s_add_u32 s49, s48, 1
    s_add_u32 s50, s50, s5
    s_add_u32 s51, s50, 1
    s_lshl_b32 s5, s40, 18
    s_lshl_b32 s6, s44, 7
    s_add_u32 s6, s6, s5
    s_add_u32 s68, s24, s6
    s_addc_u32 s69, s25, 0
    s_lshl_b32 s6, s45, 7
    s_add_u32 s6, s6, s5
    s_add_u32 s70, s24, s6
    s_addc_u32 s71, s25, 0
    s_lshl_b32 s6, s46, 7
    s_add_u32 s6, s6, s5
    s_add_u32 s72, s24, s6
    s_addc_u32 s73, s25, 0
    s_lshl_b32 s6, s47, 7
    s_add_u32 s6, s6, s5
    s_add_u32 s74, s24, s6
    s_addc_u32 s75, s25, 0
    s_lshl_b32 s6, s48, 7
    s_add_u32 s6, s6, s5
    s_add_u32 s76, s24, s6
    s_addc_u32 s77, s25, 0
    s_lshl_b32 s6, s49, 7
    s_add_u32 s6, s6, s5
    s_add_u32 s78, s24, s6
    s_addc_u32 s79, s25, 0
    s_lshl_b32 s6, s50, 7
    s_add_u32 s6, s6, s5
    s_add_u32 s80, s24, s6
    s_addc_u32 s81, s25, 0
    s_lshl_b32 s6, s51, 7
    s_add_u32 s6, s6, s5
    s_add_u32 s82, s24, s6
    s_addc_u32 s83, s25, 0
    s_lshl_b32 s89, s3, 14
    s_add_u32 s89, s89, 83200
    v_lshrrev_b32 v28, 3, v1
    v_lshlrev_b32 v28, 12, v28
    v_bfe_u32 v29, v1, 4, 1
    v_xor_b32 v29, v29, v1
    v_and_b32 v29, 7, v29
    v_xor_b32 v64, 0, v29
    v_lshl_add_u32 v64, v64, 4, v28
    v_add_u32 v68, 131072, v64
    v_xor_b32 v65, 2, v29
    v_lshl_add_u32 v65, v65, 4, v28
    v_add_u32 v65, 31744, v65
    v_add_u32 v69, 131072, v65
    v_xor_b32 v66, 4, v29
    v_lshl_add_u32 v66, v66, 4, v28
    v_add_u32 v66, 63488, v66
    v_add_u32 v70, 131072, v66
    v_xor_b32 v67, 6, v29
    v_lshl_add_u32 v67, v67, 4, v28
    v_add_u32 v67, 95232, v67
    v_add_u32 v71, 131072, v67
    s_and_b32 s4, s41, 1
    s_lshl_b32 s5, s3, 1
    s_add_u32 s5, s5, s4
    s_cmp_eq_u32 s5, 7
    s_cselect_b32 s5, 0, s5
    s_mul_i32 s96, s41, 7
    s_add_u32 s96, s96, s5
    s_cmp_lt_u32 s96, 54
    s_cselect_b32 s101, 2, 0
    s_min_u32 s96, s96, 53
    s_cmp_eq_u32 s3, 3
    s_cselect_b32 s101, 1, s101
    s_lshr_b32 s97, s101, 1
    s_cselect_b32 s5, -1, 0
    v_and_b32 v7, s5, v4
    s_add_u32 s97, s97, s96
    s_mul_i32 s4, s96, 20480
    s_add_u32 s5, s4, 7344128
    s_add_u32 s8, s38, s5
    s_addc_u32 s9, s39, 0
    s_add_u32 s5, s4, 7352320
    s_add_u32 s10, s38, s5
    s_addc_u32 s11, s39, 0
    s_add_u32 s5, s4, 7360512
    s_add_u32 s12, s38, s5
    s_addc_u32 s13, s39, 0
    s_mul_i32 s4, s97, 20480
    s_add_u32 s5, s4, 7344128
    s_add_u32 s14, s38, s5
    s_addc_u32 s15, s39, 0
    s_add_u32 s5, s4, 7352320
    s_add_u32 s16, s38, s5
    s_addc_u32 s17, s39, 0
    s_add_u32 s5, s4, 7360512
    s_add_u32 s18, s38, s5
    s_addc_u32 s19, s39, 0
    v_bfe_u32 v34, v1, 3, 1
    s_sub_u32 s4, s97, s96
    v_mul_u32_u24 v34, s4, v34
    v_add_lshl_u32 v34, v34, s96, 7
    v_mul_u32_u24 v29, 7168, v3
    v_add_u32 v34, v34, v29
    v_and_b32 v29, 112, v4
    v_add_u32 v34, v34, v29
    v_add_u32 v34, 49152, v34
    v_and_b32 v28, 1, v3
    v_mul_u32_u24 v28, 7168, v28
    v_sub_u32 v28, v34, v28
    s_branch Lsp_f
Lsp:
    s_sleep 4
Lsp_f:
    global_load_dword v40, v28, s[38:39] sc1
    s_waitcnt vmcnt(0)
    v_cmp_eq_u32 vcc, -1, v40
    s_add_u32 s100, s100, 1
    s_cmp_ge_u32 s100, 262144
    s_cbranch_scc1 Lsp_x
    s_cbranch_vccnz Lsp
Lsp_x:
    s_barrier
    s_cmp_eq_u32 s93, 102400
    s_cbranch_scc1 Lsd_none
    v_mov_b32 v31, s93
    s_cmp_lg_u32 s3, 0
    s_cbranch_scc1 Lsd_skip
    global_store_dword v31, v31, s[38:39] sc1
Lsd_skip:
Lsd_none:
    global_load_dwordx4 a[248:251], v4, s[12:13] offset:-1024 sc1
    global_load_dwordx4 a[252:255], v7, s[18:19] offset:-1024 sc1
    global_load_dwordx4 a[240:243], v4, s[12:13] offset:-2048 sc1
    global_load_dwordx4 a[244:247], v7, s[18:19] offset:-2048 sc1
    global_load_dwordx4 a[232:235], v4, s[12:13] offset:-3072 sc1
    global_load_dwordx4 a[236:239], v7, s[18:19] offset:-3072 sc1
    global_load_dwordx4 a[224:227], v4, s[12:13] offset:-4096 sc1
    global_load_dwordx4 a[228:231], v7, s[18:19] offset:-4096 sc1
    global_load_dwordx4 a[216:219], v4, s[10:11] offset:3072 sc1
    global_load_dwordx4 a[220:223], v7, s[16:17] offset:3072 sc1
    global_load_dwordx4 a[208:211], v4, s[10:11] offset:2048 sc1
    global_load_dwordx4 a[212:215], v7, s[16:17] offset:2048 sc1
    global_load_dwordx4 a[200:203], v4, s[10:11] offset:1024 sc1
    global_load_dwordx4 a[204:207], v7, s[16:17] offset:1024 sc1
    global_load_dwordx4 a[192:195], v4, s[10:11] offset:0 sc1
    global_load_dwordx4 a[196:199], v7, s[16:17] offset:0 sc1
    global_load_dwordx4 a[184:187], v4, s[10:11] offset:-1024 sc1
    global_load_dwordx4 a[188:191], v7, s[16:17] offset:-1024 sc1
    global_load_dwordx4 a[176:179], v4, s[10:11] offset:-2048 sc1
    global_load_dwordx4 a[180:183], v7, s[16:17] offset:-2048 sc1
    global_load_dwordx4 a[168:171], v4, s[10:11] offset:-3072 sc1
    global_load_dwordx4 a[172:175], v7, s[16:17] offset:-3072 sc1
    global_load_dwordx4 a[160:163], v4, s[10:11] offset:-4096 sc1
    global_load_dwordx4 a[164:167], v7, s[16:17] offset:-4096 sc1
    global_load_dwordx4 a[152:155], v4, s[8:9] offset:3072 sc1
    global_load_dwordx4 a[156:159], v7, s[14:15] offset:3072 sc1
    global_load_dwordx4 a[144:147], v4, s[8:9] offset:2048 sc1
    global_load_dwordx4 a[148:151], v7, s[14:15] offset:2048 sc1
    global_load_dwordx4 a[136:139], v4, s[8:9] offset:1024 sc1
    global_load_dwordx4 a[140:143], v7, s[14:15] offset:1024 sc1
    global_load_dwordx4 a[128:131], v4, s[8:9] offset:0 sc1
    global_load_dwordx4 a[132:135], v7, s[14:15] offset:0 sc1
    s_add_u32 m0, s89, 0
    s_nop 0
    global_load_lds_dwordx4 v64, s[68:69] offset:0
    global_load_lds_dwordx4 v65, s[68:69] offset:1024
    global_load_lds_dwordx4 v66, s[68:69] offset:2048
    global_load_lds_dwordx4 v67, s[68:69] offset:3072
    s_add_u32 m0, s89, 4096
    s_nop 0
    global_load_lds_dwordx4 v68, s[68:69] offset:0
    global_load_lds_dwordx4 v69, s[68:69] offset:1024
    global_load_lds_dwordx4 v70, s[68:69] offset:2048
    global_load_lds_dwordx4 v71, s[68:69] offset:3072
    s_lshl_b32 s4, s40, 9
    s_add_u32 s4, s4, 32772
    v_lshl_add_u32 v30, v1, 3, s4
    s_branch Lsu_f
Lsu:
    s_sleep 4
Lsu_f:
    global_load_dwordx4 v[40:43], v34, s[38:39] sc1
    global_load_dword v44, v30, s[38:39] sc1
    s_waitcnt vmcnt(0)
    v_max3_u32 v29, v40, v41, v42
    v_max3_u32 v29, v43, v44, v29
    v_cmp_eq_u32 vcc, -1, v29
    s_add_u32 s100, s100, 1
    s_cmp_ge_u32 s100, 262144
    s_cbranch_scc1 Lsu_x
    s_cbranch_vccnz Lsu
Lsu_x:
    v_permlane32_swap_b32 v40, v42
    v_permlane32_swap_b32 v41, v43
    s_lshl_b32 s4, s3, 9
    s_add_u32 s4, s4, 156672
    v_and_b32 v34, 496, v4
    v_add_f32 v40, v40, v42
    v_add_f32 v41, v41, v43
    v_bfe_u32 v42, v1, 3, 1
    v_cmp_gt_u32 vcc, s101, v42
    v_lshrrev_b32 v42, 5, v1
    v_lshl_add_u32 v34, v42, 3, v34
    v_cndmask_b32 v40, 0, v40, vcc
    v_cndmask_b32 v41, 0, v41, vcc
    v_add_u32 v34, s4, v34
    ds_write_b64 v34, v[40:41]
    s_barrier
    s_branch Ljoin
Lic_r:
    s_branch Lic_p_f
Lic_p:
    s_sleep 4
Lic_p_f:
    global_load_dword v213, v212, s[36:37] sc1
    s_waitcnt vmcnt(0)
    v_cmp_eq_u32 vcc, 0, v213
    s_add_u32 s100, s100, 1
    s_cmp_ge_u32 s100, 262144
    s_cbranch_scc1 Lic_p_x
    s_cbranch_vccnz Lic_p
Lic_p_x:
    s_branch Lic_ok
Lic2_r:
    s_branch Lic2_p_f
Lic2_p:
    s_sleep 4
Lic2_p_f:
    global_load_dword v42, v41, s[36:37] sc1
    s_waitcnt vmcnt(0)
    v_cmp_eq_u32 vcc, 0, v42
    s_add_u32 s100, s100, 1
    s_cmp_ge_u32 s100, 262144
    s_cbranch_scc1 Lic2_p_x
    s_cbranch_vccnz Lic2_p
Lic2_p_x:
    s_branch Lic2_ok
Lkf_r:
    s_nop 7
Lkf_p:
    global_load_dword v137, v136, s[38:39] sc1
    s_waitcnt vmcnt(0)
    v_cmp_eq_u32 vcc, -1, v137
    s_add_u32 s100, s100, 1
    s_cmp_ge_u32 s100, 262144
    s_cbranch_scc1 Lkf_p_x
    s_cbranch_vccnz Lkf_p
Lkf_p_x:
    s_nop 1
    s_branch Lkf_ok
Lcu_r:
    s_nop 7
Lcu_p:
    global_load_dword v222, v137, s[38:39] sc1
    s_waitcnt vmcnt(0)
    v_cmp_eq_u32 vcc, -1, v222
    s_add_u32 s100, s100, 1
    s_cmp_ge_u32 s100, 262144
    s_cbranch_scc1 Lcu_p_x
    s_cbranch_vccnz Lcu_p
Lcu_p_x:
    s_nop 1
    s_branch Lcu_ok
Lax_r:
    s_nop 7
Lax_p:
    v_lshlrev_b32 v28, 4, v0
    v_add_u32 v28, 36864, v28
    global_load_dwordx4 v[202:205], v28, s[38:39] offset:-4096 sc1
    global_load_dwordx4 v[206:209], v28, s[38:39] offset:0 sc1
    v_add_u32 v28, 8192, v28
    global_load_dwordx4 v[210:213], v28, s[38:39] offset:-4096 sc1
    global_load_dwordx4 v[214:217], v28, s[38:39] offset:0 sc1
    v_min_u32 v28, 11, v1
    v_lshrrev_b32 v29, 2, v28
    v_mul_u32_u24 v29, 2544, v29
    v_lshl_add_u32 v28, v28, 2, v29
    s_lshl_b32 s4, s42, 4
    s_add_u32 s4, s4, 0
    v_add_u32 v28, s4, v28
    global_load_dword v182, v28, s[38:39] sc1
    v_add_u32 v28, 15360, v28
    global_load_dword v183, v28, s[38:39] sc1
    s_waitcnt vmcnt(0)
    v_max_u32 v224, v203, v205
    v_max3_u32 v224, v207, v209, v224
    v_max3_u32 v224, v211, v213, v224
    v_max3_u32 v224, v215, v217, v224
    v_max3_u32 v224, v182, v183, v224
    v_cmp_eq_u32 vcc, -1, v224
    s_add_u32 s100, s100, 1
    s_cmp_ge_u32 s100, 262144
    s_cbranch_scc1 Lax_p_x
    s_cbranch_vccnz Lax_p
Lax_p_x:
    s_nop 1
    s_branch Lax_ok
Lcv_r:
    s_nop 7
Lcv_p:
    global_load_dwordx4 v[218:221], v223, s[38:39] sc1
    s_waitcnt vmcnt(0)
    v_max_u32 v224, v218, v219
    v_max3_u32 v224, v220, v221, v224
    v_cmp_eq_u32 vcc, -1, v224
    s_add_u32 s100, s100, 1
    s_cmp_ge_u32 s100, 262144
    s_cbranch_scc1 Lcv_p_x
    s_cbranch_vccnz Lcv_p
Lcv_p_x:
    s_nop 1
    s_branch Lcv_ok
Lgb_r:
    s_nop 7
Lgb_p:
    v_min_u32 v175, 26, v1
    v_lshlrev_b32 v175, 7, v175
    v_add_u32 v175, 98304, v175
    global_load_dword v250, v175, s[38:39] sc1
    s_mul_i32 s7, s41, 320
    s_add_u32 s7, s7, 12800
    v_min_u32 v175, 304, v4
    v_add_u32 v175, s7, v175
    global_load_dwordx4 v[242:245], v175, s[38:39] sc1
    v_add_u32 v175, 15360, v175
    global_load_dwordx4 v[246:249], v175, s[38:39] sc1
    s_waitcnt vmcnt(0)
    v_max3_u32 v28, v242, v243, v244
    v_max3_u32 v28, v245, v246, v28
    v_max3_u32 v28, v247, v248, v28
    v_max3_u32 v28, v249, v250, v28
    v_cmp_eq_u32 vcc, -1, v28
    s_add_u32 s100, s100, 1
    s_cmp_ge_u32 s100, 262144
    s_cbranch_scc1 Lgb_p_x
    s_cbranch_vccnz Lgb_p
Lgb_p_x:
    s_nop 1
    s_branch Lgb_ok
Ls3_r:
    s_nop 7
Ls3_p:
    global_load_dwordx2 v[130:131], v174, s[38:39] offset:0 sc1
    global_load_dwordx2 v[132:133], v174, s[38:39] offset:512 sc1
    global_load_dwordx2 v[134:135], v174, s[38:39] offset:1024 sc1
    global_load_dwordx2 v[136:137], v174, s[38:39] offset:1536 sc1
    global_load_dwordx2 v[138:139], v174, s[38:39] offset:2048 sc1
    global_load_dwordx2 v[140:141], v174, s[38:39] offset:2560 sc1
    global_load_dwordx2 v[142:143], v174, s[38:39] offset:3072 sc1
    global_load_dwordx2 v[144:145], v174, s[38:39] offset:3584 sc1
    s_waitcnt vmcnt(0)
    v_max_u32 v28, v131, v133
    v_max3_u32 v28, v135, v137, v28
    v_max3_u32 v28, v139, v141, v28
    v_max3_u32 v28, v143, v145, v28
    v_cmp_eq_u32 vcc, -1, v28
    s_add_u32 s100, s100, 1
    s_cmp_ge_u32 s100, 262144
    s_cbranch_scc1 Ls3_p_x
    s_cbranch_vccnz Ls3_p
Ls3_p_x:
    s_nop 1
    s_branch Ls3_ok
Lz0_r:
    s_nop 7
Lz0_p:
    global_load_dword v46, v29, s[56:57] offset:1020 sc1
    global_load_dwordx4 v[62:65], v30, s[56:57] offset:-3072 sc1
    global_load_dwordx4 v[66:69], v30, s[56:57] offset:-2048 sc1
    global_load_dwordx4 v[70:73], v30, s[56:57] offset:-1024 sc1
    global_load_dwordx4 v[74:77], v30, s[56:57] offset:0 sc1
    global_load_dwordx4 v[78:81], v30, s[56:57] offset:1024 sc1
    global_load_dwordx4 v[82:85], v30, s[56:57] offset:2048 sc1
    global_load_dwordx4 v[86:89], v30, s[56:57] offset:3072 sc1
    global_load_dwordx4 v[90:93], v31, s[56:57] offset:-3072 sc1
    global_load_dwordx4 v[94:97], v31, s[56:57] offset:-2048 sc1
    global_load_dwordx4 v[98:101], v31, s[56:57] offset:-1024 sc1
    global_load_dwordx4 v[102:105], v31, s[56:57] offset:0 sc1
    global_load_dwordx4 v[106:109], v31, s[56:57] offset:1024 sc1
    global_load_dwordx4 v[110:113], v31, s[56:57] offset:2048 sc1
    global_load_dwordx4 v[114:117], v31, s[56:57] offset:3072 sc1
    global_load_dwordx4 v[118:121], v30, s[58:59] offset:-3072 sc1
    global_load_dwordx4 v[122:125], v30, s[58:59] offset:-2048 sc1
    s_waitcnt vmcnt(0)
    v_bitop3_b32 v28, v46, v65, v69 bitop3:0x80
    v_bitop3_b32 v28, v73, v77, v28 bitop3:0x80
    v_and_b32 v28, 1, v28
    v_cmp_ne_u32 vcc, 1, v28
    s_add_u32 s100, s100, 1
    s_cmp_ge_u32 s100, 262144
    s_cbranch_scc1 Lz0_p_x
    s_cbranch_vccnz Lz0_p
Lz0_p_x:
    s_nop 1
    s_branch Lz0_ok
Lz1_r:
    s_nop 7
Lz1_p:
    global_load_dwordx4 v[78:81], v30, s[56:57] offset:1024 sc1
    global_load_dwordx4 v[82:85], v30, s[56:57] offset:2048 sc1
    global_load_dwordx4 v[86:89], v30, s[56:57] offset:3072 sc1
    global_load_dwordx4 v[90:93], v31, s[56:57] offset:-3072 sc1
    s_waitcnt vmcnt(0)
    v_and_b32 v28, v81, v85
    v_bitop3_b32 v28, v89, v93, v28 bitop3:0x80
    v_and_b32 v28, 1, v28
    v_cmp_ne_u32 vcc, 1, v28
    s_add_u32 s100, s100, 1
    s_cmp_ge_u32 s100, 262144
    s_cbranch_scc1 Lz1_p_x
    s_cbranch_vccnz Lz1_p
Lz1_p_x:
    s_nop 1
    s_branch Lz1_ok
Lz2_r:
    s_nop 7
Lz2_p:
    global_load_dwordx4 v[94:97], v31, s[56:57] offset:-2048 sc1
    global_load_dwordx4 v[98:101], v31, s[56:57] offset:-1024 sc1
    global_load_dwordx4 v[102:105], v31, s[56:57] offset:0 sc1
    global_load_dwordx4 v[106:109], v31, s[56:57] offset:1024 sc1
    s_waitcnt vmcnt(0)
    v_and_b32 v28, v97, v101
    v_bitop3_b32 v28, v105, v109, v28 bitop3:0x80
    v_and_b32 v28, 1, v28
    v_cmp_ne_u32 vcc, 1, v28
    s_add_u32 s100, s100, 1
    s_cmp_ge_u32 s100, 262144
    s_cbranch_scc1 Lz2_p_x
    s_cbranch_vccnz Lz2_p
Lz2_p_x:
    s_nop 1
    s_branch Lz2_ok
Lz3_r:
    s_nop 7
Lz3_p:
    global_load_dwordx4 v[110:113], v31, s[56:57] offset:2048 sc1
    global_load_dwordx4 v[114:117], v31, s[56:57] offset:3072 sc1
    global_load_dwordx4 v[118:121], v30, s[58:59] offset:-3072 sc1
    global_load_dwordx4 v[122:125], v30, s[58:59] offset:-2048 sc1
    s_waitcnt vmcnt(0)
    v_and_b32 v28, v113, v117
    v_bitop3_b32 v28, v121, v125, v28 bitop3:0x80
    v_and_b32 v28, 1, v28
    v_cmp_ne_u32 vcc, 1, v28
    s_add_u32 s100, s100, 1
    s_cmp_ge_u32 s100, 262144
    s_cbranch_scc1 Lz3_p_x
    s_cbranch_vccnz Lz3_p
Lz3_p_x:
    s_nop 1
    s_branch Lz3_ok
Lz4_r:
    s_nop 7
Lz4_p:
    global_load_dwordx4 v[126:129], v30, s[58:59] offset:-1024 sc1
    global_load_dwordx4 v[130:133], v30, s[58:59] offset:0 sc1
    global_load_dwordx4 v[134:137], v30, s[58:59] offset:1024 sc1
    global_load_dwordx4 v[138:141], v30, s[58:59] offset:2048 sc1
    s_waitcnt vmcnt(0)
    v_and_b32 v28, v129, v133
    v_bitop3_b32 v28, v137, v141, v28 bitop3:0x80
    v_and_b32 v28, 1, v28
    v_cmp_ne_u32 vcc, 1, v28
    s_add_u32 s100, s100, 1
    s_cmp_ge_u32 s100, 262144
    s_cbranch_scc1 Lz4_p_x
    s_cbranch_vccnz Lz4_p
Lz4_p_x:
    s_nop 1
    s_branch Lz4_ok
Lz5_r:
    s_nop 7
Lz5_p:
    global_load_dwordx4 v[62:65], v30, s[58:59] offset:3072 sc1
    global_load_dwordx4 v[66:69], v31, s[58:59] offset:-3072 sc1
    global_load_dwordx4 v[70:73], v31, s[58:59] offset:-2048 sc1
    global_load_dwordx4 v[74:77], v31, s[58:59] offset:-1024 sc1
    s_waitcnt vmcnt(0)
    v_and_b32 v28, v65, v69
    v_bitop3_b32 v28, v73, v77, v28 bitop3:0x80
    v_and_b32 v28, 1, v28
    v_cmp_ne_u32 vcc, 1, v28
    s_add_u32 s100, s100, 1
    s_cmp_ge_u32 s100, 262144
    s_cbranch_scc1 Lz5_p_x
    s_cbranch_vccnz Lz5_p
Lz5_p_x:
    s_nop 1
    s_branch Lz5_ok
Lz6_r:
    s_nop 7
Lz6_p:
    global_load_dwordx4 v[78:81], v31, s[58:59] offset:0 sc1
    global_load_dwordx4 v[82:85], v31, s[58:59] offset:1024 sc1
    global_load_dwordx4 v[86:89], v31, s[58:59] offset:2048 sc1
    global_load_dwordx4 v[90:93], v31, s[58:59] offset:3072 sc1
    s_waitcnt vmcnt(0)
    v_and_b32 v28, v81, v85
    v_bitop3_b32 v28, v89, v93, v28 bitop3:0x80
    v_and_b32 v28, 1, v28
    v_cmp_ne_u32 vcc, 1, v28
    s_add_u32 s100, s100, 1
    s_cmp_ge_u32 s100, 262144
    s_cbranch_scc1 Lz6_p_x
    s_cbranch_vccnz Lz6_p
Lz6_p_x:
    s_nop 1
    s_branch Lz6_ok
Lz7_r:
    s_nop 7
Lz7_p:
    global_load_dwordx4 v[94:97], v30, s[60:61] offset:-3072 sc1
    global_load_dwordx4 v[98:101], v31, s[60:61] offset:-3072 sc1
    global_load_dwordx4 v[102:105], v30, s[62:63] offset:-3072 sc1
    global_load_dwordx4 v[106:109], v31, s[62:63] offset:-3072 sc1
    s_waitcnt vmcnt(0)
    v_and_b32 v28, v97, v101
    v_bitop3_b32 v28, v105, v109, v28 bitop3:0x80
    v_and_b32 v28, 1, v28
    v_cmp_ne_u32 vcc, 1, v28
    s_add_u32 s100, s100, 1
    s_cmp_ge_u32 s100, 262144
    s_cbranch_scc1 Lz7_p_x
    s_cbranch_vccnz Lz7_p
Lz7_p_x:
    s_nop 1
    s_branch Lz7_ok
Lz8_r:
    s_nop 7
Lz8_p:
    global_load_dwordx4 v[110:113], v30, s[52:53] offset:-3072 sc1
    global_load_dwordx4 v[114:117], v31, s[52:53] offset:-3072 sc1
    global_load_dwordx4 v[118:121], v30, s[54:55] offset:-3072 sc1
    global_load_dwordx4 v[122:125], v31, s[54:55] offset:-3072 sc1
    s_waitcnt vmcnt(0)
    v_and_b32 v28, v113, v117
    v_bitop3_b32 v28, v121, v125, v28 bitop3:0x80
    v_and_b32 v28, 1, v28
    v_cmp_ne_u32 vcc, 1, v28
    s_add_u32 s100, s100, 1
    s_cmp_ge_u32 s100, 262144
    s_cbranch_scc1 Lz8_p_x
    s_cbranch_vccnz Lz8_p
Lz8_p_x:
    s_nop 1
    s_branch Lz8_ok
Lz9_r:
    s_nop 7
Lz9_p:
    global_load_dwordx4 v[126:129], v30, s[64:65] offset:-3072 sc1
    global_load_dwordx4 v[130:133], v31, s[64:65] offset:-3072 sc1
    global_load_dwordx4 v[134:137], v30, s[66:67] offset:-3072 sc1
    global_load_dwordx4 v[138:141], v31, s[66:67] offset:-3072 sc1
    s_waitcnt vmcnt(0)
    v_and_b32 v28, v129, v133
    v_bitop3_b32 v28, v137, v141, v28 bitop3:0x80
    v_and_b32 v28, 1, v28
    v_cmp_ne_u32 vcc, 1, v28
    s_add_u32 s100, s100, 1
    s_cmp_ge_u32 s100, 262144
    s_cbranch_scc1 Lz9_p_x
    s_cbranch_vccnz Lz9_p
Lz9_p_x:
    s_nop 1
    s_branch Lz9_ok
Lz10_r:
    s_nop 7
Lz10_p:
    global_load_dwordx4 v[62:65], v30, s[60:61] offset:-2048 sc1
    global_load_dwordx4 v[66:69], v31, s[60:61] offset:-2048 sc1
    global_load_dwordx4 v[70:73], v30, s[62:63] offset:-2048 sc1
    global_load_dwordx4 v[74:77], v31, s[62:63] offset:-2048 sc1
    s_waitcnt vmcnt(0)
    v_and_b32 v28, v65, v69
    v_bitop3_b32 v28, v73, v77, v28 bitop3:0x80
    v_and_b32 v28, 1, v28
    v_cmp_ne_u32 vcc, 1, v28
    s_add_u32 s100, s100, 1
    s_cmp_ge_u32 s100, 262144
    s_cbranch_scc1 Lz10_p_x
    s_cbranch_vccnz Lz10_p
Lz10_p_x:
    s_nop 1
    s_branch Lz10_ok
Lz11_r:
    s_nop 7
Lz11_p:
    global_load_dwordx4 v[78:81], v30, s[52:53] offset:-2048 sc1
    global_load_dwordx4 v[82:85], v31, s[52:53] offset:-2048 sc1
    global_load_dwordx4 v[86:89], v30, s[54:55] offset:-2048 sc1
    global_load_dwordx4 v[90:93], v31, s[54:55] offset:-2048 sc1
    s_waitcnt vmcnt(0)
    v_and_b32 v28, v81, v85
    v_bitop3_b32 v28, v89, v93, v28 bitop3:0x80
    v_and_b32 v28, 1, v28
    v_cmp_ne_u32 vcc, 1, v28
    s_add_u32 s100, s100, 1
    s_cmp_ge_u32 s100, 262144
    s_cbranch_scc1 Lz11_p_x
    s_cbranch_vccnz Lz11_p
Lz11_p_x:
    s_nop 1
    s_branch Lz11_ok
Lz12_r:
    s_nop 7
Lz12_p:
    global_load_dwordx4 v[94:97], v30, s[64:65] offset:-2048 sc1
    global_load_dwordx4 v[98:101], v31, s[64:65] offset:-2048 sc1
    global_load_dwordx4 v[102:105], v30, s[66:67] offset:-2048 sc1
    global_load_dwordx4 v[106:109], v31, s[66:67] offset:-2048 sc1
    s_waitcnt vmcnt(0)
    v_and_b32 v28, v97, v101
    v_bitop3_b32 v28, v105, v109, v28 bitop3:0x80
    v_and_b32 v28, 1, v28
    v_cmp_ne_u32 vcc, 1, v28
    s_add_u32 s100, s100, 1
    s_cmp_ge_u32 s100, 262144
    s_cbranch_scc1 Lz12_p_x
    s_cbranch_vccnz Lz12_p
Lz12_p_x:
    s_nop 1
    s_branch Lz12_ok
Lz13_r:
    s_nop 7
Lz13_p:
    global_load_dwordx4 v[110:113], v30, s[60:61] offset:-1024 sc1
    global_load_dwordx4 v[114:117], v31, s[60:61] offset:-1024 sc1
    global_load_dwordx4 v[118:121], v30, s[62:63] offset:-1024 sc1
    global_load_dwordx4 v[122:125], v31, s[62:63] offset:-1024 sc1
    s_waitcnt vmcnt(0)
    v_and_b32 v28, v113, v117
    v_bitop3_b32 v28, v121, v125, v28 bitop3:0x80
    v_and_b32 v28, 1, v28
    v_cmp_ne_u32 vcc, 1, v28
    s_add_u32 s100, s100, 1
    s_cmp_ge_u32 s100, 262144
    s_cbranch_scc1 Lz13_p_x
    s_cbranch_vccnz Lz13_p
Lz13_p_x:
    s_nop 1
    s_branch Lz13_ok
Lz14_r:
    s_nop 7
Lz14_p:
    global_load_dwordx4 v[126:129], v30, s[52:53] offset:-1024 sc1
    global_load_dwordx4 v[130:133], v31, s[52:53] offset:-1024 sc1
    global_load_dwordx4 v[134:137], v30, s[54:55] offset:-1024 sc1
    global_load_dwordx4 v[138:141], v31, s[54:55] offset:-1024 sc1
    s_waitcnt vmcnt(0)
    v_and_b32 v28, v129, v133
    v_bitop3_b32 v28, v137, v141, v28 bitop3:0x80
    v_and_b32 v28, 1, v28
    v_cmp_ne_u32 vcc, 1, v28
    s_add_u32 s100, s100, 1
    s_cmp_ge_u32 s100, 262144
    s_cbranch_scc1 Lz14_p_x
    s_cbranch_vccnz Lz14_p
Lz14_p_x:
    s_nop 1
    s_branch Lz14_ok
Lz15_r:
    s_nop 7
Lz15_p:
    global_load_dwordx4 v[62:65], v30, s[64:65] offset:-1024 sc1
    global_load_dwordx4 v[66:69], v31, s[64:65] offset:-1024 sc1
    global_load_dwordx4 v[70:73], v30, s[66:67] offset:-1024 sc1
    global_load_dwordx4 v[74:77], v31, s[66:67] offset:-1024 sc1
    s_waitcnt vmcnt(0)
    v_and_b32 v28, v65, v69
    v_bitop3_b32 v28, v73, v77, v28 bitop3:0x80
    v_and_b32 v28, 1, v28
    v_cmp_ne_u32 vcc, 1, v28
    s_add_u32 s100, s100, 1
    s_cmp_ge_u32 s100, 262144
    s_cbranch_scc1 Lz15_p_x
    s_cbranch_vccnz Lz15_p
Lz15_p_x:
    s_nop 1
    s_branch Lz15_ok
Lz16_r:
    s_nop 7
Lz16_p:
    global_load_dwordx4 v[78:81], v30, s[60:61] offset:0 sc1
    global_load_dwordx4 v[82:85], v31, s[60:61] offset:0 sc1
    global_load_dwordx4 v[86:89], v30, s[62:63] offset:0 sc1
    global_load_dwordx4 v[90:93], v31, s[62:63] offset:0 sc1
    s_waitcnt vmcnt(0)
    v_and_b32 v28, v81, v85
    v_bitop3_b32 v28, v89, v93, v28 bitop3:0x80
    v_and_b32 v28, 1, v28
    v_cmp_ne_u32 vcc, 1, v28
    s_add_u32 s100, s100, 1
    s_cmp_ge_u32 s100, 262144
    s_cbranch_scc1 Lz16_p_x
    s_cbranch_vccnz Lz16_p
Lz16_p_x:
    s_nop 1
    s_branch Lz16_ok
Lz17_r:
    s_nop 7
Lz17_p:
    global_load_dwordx4 v[94:97], v30, s[52:53] offset:0 sc1
    global_load_dwordx4 v[98:101], v31, s[52:53] offset:0 sc1
    global_load_dwordx4 v[102:105], v30, s[54:55] offset:0 sc1
    global_load_dwordx4 v[106:109], v31, s[54:55] offset:0 sc1
    s_waitcnt vmcnt(0)
    v_and_b32 v28, v97, v101
    v_bitop3_b32 v28, v105, v109, v28 bitop3:0x80
    v_and_b32 v28, 1, v28
    v_cmp_ne_u32 vcc, 1, v28
    s_add_u32 s100, s100, 1
    s_cmp_ge_u32 s100, 262144
    s_cbranch_scc1 Lz17_p_x
    s_cbranch_vccnz Lz17_p
Lz17_p_x:
    s_nop 1
    s_branch Lz17_ok
Lz18_r:
    s_nop 7
Lz18_p:
    global_load_dwordx4 v[110:113], v30, s[64:65] offset:0 sc1
    global_load_dwordx4 v[114:117], v31, s[64:65] offset:0 sc1
    global_load_dwordx4 v[118:121], v30, s[66:67] offset:0 sc1
    global_load_dwordx4 v[122:125], v31, s[66:67] offset:0 sc1
    s_waitcnt vmcnt(0)
    v_and_b32 v28, v113, v117
    v_bitop3_b32 v28, v121, v125, v28 bitop3:0x80
    v_and_b32 v28, 1, v28
    v_cmp_ne_u32 vcc, 1, v28
    s_add_u32 s100, s100, 1
    s_cmp_ge_u32 s100, 262144
    s_cbranch_scc1 Lz18_p_x
    s_cbranch_vccnz Lz18_p
Lz18_p_x:
    s_nop 1
    s_branch Lz18_ok
Lz19_r:
    s_nop 7
Lz19_p:
    global_load_dwordx4 v[126:129], v30, s[60:61] offset:1024 sc1
    global_load_dwordx4 v[130:133], v31, s[60:61] offset:1024 sc1
    global_load_dwordx4 v[134:137], v30, s[62:63] offset:1024 sc1
    global_load_dwordx4 v[138:141], v31, s[62:63] offset:1024 sc1
    s_waitcnt vmcnt(0)
    v_and_b32 v28, v129, v133
    v_bitop3_b32 v28, v137, v141, v28 bitop3:0x80
    v_and_b32 v28, 1, v28
    v_cmp_ne_u32 vcc, 1, v28
    s_add_u32 s100, s100, 1
    s_cmp_ge_u32 s100, 262144
    s_cbranch_scc1 Lz19_p_x
    s_cbranch_vccnz Lz19_p
Lz19_p_x:
    s_nop 1
    s_branch Lz19_ok
Lz20_r:
    s_nop 7
Lz20_p:
    global_load_dwordx4 v[62:65], v30, s[52:53] offset:1024 sc1
    global_load_dwordx4 v[66:69], v31, s[52:53] offset:1024 sc1
    global_load_dwordx4 v[70:73], v30, s[54:55] offset:1024 sc1
    global_load_dwordx4 v[74:77], v31, s[54:55] offset:1024 sc1
    s_waitcnt vmcnt(0)
    v_and_b32 v28, v65, v69
    v_bitop3_b32 v28, v73, v77, v28 bitop3:0x80
    v_and_b32 v28, 1, v28
    v_cmp_ne_u32 vcc, 1, v28
    s_add_u32 s100, s100, 1
    s_cmp_ge_u32 s100, 262144
    s_cbranch_scc1 Lz20_p_x
    s_cbranch_vccnz Lz20_p
Lz20_p_x:
    s_nop 1
    s_branch Lz20_ok
Lz21_r:
    s_nop 7
Lz21_p:
    global_load_dwordx4 v[78:81], v30, s[64:65] offset:1024 sc1
    global_load_dwordx4 v[82:85], v31, s[64:65] offset:1024 sc1
    global_load_dwordx4 v[86:89], v30, s[66:67] offset:1024 sc1
    global_load_dwordx4 v[90:93], v31, s[66:67] offset:1024 sc1
    s_waitcnt vmcnt(0)
    v_and_b32 v28, v81, v85
    v_bitop3_b32 v28, v89, v93, v28 bitop3:0x80
    v_and_b32 v28, 1, v28
    v_cmp_ne_u32 vcc, 1, v28
    s_add_u32 s100, s100, 1
    s_cmp_ge_u32 s100, 262144
    s_cbranch_scc1 Lz21_p_x
    s_cbranch_vccnz Lz21_p
Lz21_p_x:
    s_nop 1
    s_branch Lz21_ok
Lz22_r:
    s_nop 7
Lz22_p:
    global_load_dwordx4 v[94:97], v30, s[60:61] offset:2048 sc1
    global_load_dwordx4 v[98:101], v31, s[60:61] offset:2048 sc1
    global_load_dwordx4 v[102:105], v30, s[62:63] offset:2048 sc1
    global_load_dwordx4 v[106:109], v31, s[62:63] offset:2048 sc1
    s_waitcnt vmcnt(0)
    v_and_b32 v28, v97, v101
    v_bitop3_b32 v28, v105, v109, v28 bitop3:0x80
    v_and_b32 v28, 1, v28
    v_cmp_ne_u32 vcc, 1, v28
    s_add_u32 s100, s100, 1
    s_cmp_ge_u32 s100, 262144
    s_cbranch_scc1 Lz22_p_x
    s_cbranch_vccnz Lz22_p
Lz22_p_x:
    s_nop 1
    s_branch Lz22_ok
Lz23_r:
    s_nop 7
Lz23_p:
    global_load_dwordx4 v[110:113], v30, s[52:53] offset:2048 sc1
    global_load_dwordx4 v[114:117], v31, s[52:53] offset:2048 sc1
    global_load_dwordx4 v[118:121], v30, s[54:55] offset:2048 sc1
    global_load_dwordx4 v[122:125], v31, s[54:55] offset:2048 sc1
    s_waitcnt vmcnt(0)
    v_and_b32 v28, v113, v117
    v_bitop3_b32 v28, v121, v125, v28 bitop3:0x80
    v_and_b32 v28, 1, v28
    v_cmp_ne_u32 vcc, 1, v28
    s_add_u32 s100, s100, 1
    s_cmp_ge_u32 s100, 262144
    s_cbranch_scc1 Lz23_p_x
    s_cbranch_vccnz Lz23_p
Lz23_p_x:
    s_nop 1
    s_branch Lz23_ok
Lz24_r:
    s_nop 7
Lz24_p:
    global_load_dwordx4 v[126:129], v30, s[64:65] offset:2048 sc1
    global_load_dwordx4 v[130:133], v31, s[64:65] offset:2048 sc1
    global_load_dwordx4 v[134:137], v30, s[66:67] offset:2048 sc1
    global_load_dwordx4 v[138:141], v31, s[66:67] offset:2048 sc1
    s_waitcnt vmcnt(0)
    v_and_b32 v28, v129, v133
    v_bitop3_b32 v28, v137, v141, v28 bitop3:0x80
    v_and_b32 v28, 1, v28
    v_cmp_ne_u32 vcc, 1, v28
    s_add_u32 s100, s100, 1
    s_cmp_ge_u32 s100, 262144
    s_cbranch_scc1 Lz24_p_x
    s_cbranch_vccnz Lz24_p
Lz24_p_x:
    s_nop 1
    s_branch Lz24_ok
Lz25_r:
    s_nop 7
Lz25_p:
    global_load_dwordx4 v[62:65], v30, s[60:61] offset:3072 sc1
    global_load_dwordx4 v[66:69], v31, s[60:61] offset:3072 sc1
    global_load_dwordx4 v[70:73], v30, s[62:63] offset:3072 sc1
    global_load_dwordx4 v[74:77], v31, s[62:63] offset:3072 sc1
    s_waitcnt vmcnt(0)
    v_and_b32 v28, v65, v69
    v_bitop3_b32 v28, v73, v77, v28 bitop3:0x80
    v_and_b32 v28, 1, v28
    v_cmp_ne_u32 vcc, 1, v28
    s_add_u32 s100, s100, 1
    s_cmp_ge_u32 s100, 262144
    s_cbranch_scc1 Lz25_p_x
    s_cbranch_vccnz Lz25_p
Lz25_p_x:
    s_nop 1
    s_branch Lz25_ok
Lz26_r:
    s_nop 7
Lz26_p:
    global_load_dwordx4 v[78:81], v30, s[52:53] offset:3072 sc1
    global_load_dwordx4 v[82:85], v31, s[52:53] offset:3072 sc1
    global_load_dwordx4 v[86:89], v30, s[54:55] offset:3072 sc1
    global_load_dwordx4 v[90:93], v31, s[54:55] offset:3072 sc1
    s_waitcnt vmcnt(0)
    v_and_b32 v28, v81, v85
    v_bitop3_b32 v28, v89, v93, v28 bitop3:0x80
    v_and_b32 v28, 1, v28
    v_cmp_ne_u32 vcc, 1, v28
    s_add_u32 s100, s100, 1
    s_cmp_ge_u32 s100, 262144
    s_cbranch_scc1 Lz26_p_x
    s_cbranch_vccnz Lz26_p
Lz26_p_x:
    s_nop 1
    s_branch Lz26_ok
Lz27_r:
    s_nop 7
Lz27_p:
    global_load_dwordx4 v[94:97], v30, s[64:65] offset:3072 sc1
    global_load_dwordx4 v[98:101], v31, s[64:65] offset:3072 sc1
    global_load_dwordx4 v[102:105], v30, s[66:67] offset:3072 sc1
    global_load_dwordx4 v[106:109], v31, s[66:67] offset:3072 sc1
    s_waitcnt vmcnt(0)
    v_and_b32 v28, v97, v101
    v_bitop3_b32 v28, v105, v109, v28 bitop3:0x80
    v_and_b32 v28, 1, v28
    v_cmp_ne_u32 vcc, 1, v28
    s_add_u32 s100, s100, 1
    s_cmp_ge_u32 s100, 262144
    s_cbranch_scc1 Lz27_p_x
    s_cbranch_vccnz Lz27_p
Lz27_p_x:
    s_nop 1
    s_branch Lz27_ok
Lp0_r:
    s_nop 7
Lp0_p:
    global_load_dwordx4 v[142:145], v6, s[38:39] offset:-4096 sc1
    global_load_dwordx4 v[146:149], v6, s[38:39] offset:-3072 sc1
    global_load_dwordx4 v[150:153], v6, s[38:39] offset:-2048 sc1
    global_load_dwordx4 v[154:157], v6, s[38:39] offset:-1024 sc1
    global_load_dwordx4 v[158:161], v6, s[38:39] offset:0 sc1
    global_load_dwordx4 v[162:165], v6, s[38:39] offset:1024 sc1
    global_load_dwordx4 v[166:169], v6, s[38:39] offset:2048 sc1
    global_load_dwordx4 v[170:173], v6, s[38:39] offset:3072 sc1
    s_waitcnt vmcnt(0)
    v_or_b32 v28, v145, v149
    v_or3_b32 v28, v153, v157, v28
    v_or3_b32 v28, v161, v165, v28
    v_or3_b32 v28, v169, v173, v28
    v_and_b32 v28, 1, v28
    v_cmp_ne_u32 vcc, 0, v28
    s_add_u32 s100, s100, 1
    s_cmp_ge_u32 s100, 262144
    s_cbranch_scc1 Lp0_p_x
    s_cbranch_vccnz Lp0_p
Lp0_p_x:
    s_nop 1
    s_branch Lp0_ok
Lp1_r:
    s_nop 7
Lp1_p:
    global_load_dwordx4 v[174:177], v7, s[38:39] offset:-4096 sc1
    global_load_dwordx4 v[178:181], v7, s[38:39] offset:-3072 sc1
    global_load_dwordx4 v[182:185], v7, s[38:39] offset:-2048 sc1
    global_load_dwordx4 v[186:189], v7, s[38:39] offset:-1024 sc1
    global_load_dwordx4 v[190:193], v7, s[38:39] offset:0 sc1
    global_load_dwordx4 v[194:197], v7, s[38:39] offset:1024 sc1
    global_load_dwordx4 v[198:201], v7, s[38:39] offset:2048 sc1
    global_load_dwordx4 v[202:205], v7, s[38:39] offset:3072 sc1
    s_waitcnt vmcnt(0)
    v_or_b32 v28, v177, v181
    v_or3_b32 v28, v185, v189, v28
    v_or3_b32 v28, v193, v197, v28
    v_or3_b32 v28, v201, v205, v28
    v_and_b32 v28, 1, v28
    v_cmp_ne_u32 vcc, 0, v28
    s_add_u32 s100, s100, 1
    s_cmp_ge_u32 s100, 262144
    s_cbranch_scc1 Lp1_p_x
    s_cbranch_vccnz Lp1_p
Lp1_p_x:
    s_nop 1
    s_branch Lp1_ok
Lp2_r:
    s_nop 7
Lp2_p:
    global_load_dwordx4 v[206:209], v26, s[38:39] offset:-4096 sc1
    global_load_dwordx4 v[210:213], v26, s[38:39] offset:-3072 sc1
    global_load_dwordx4 v[214:217], v26, s[38:39] offset:-2048 sc1
    global_load_dwordx4 v[218:221], v26, s[38:39] offset:-1024 sc1
    global_load_dwordx4 v[222:225], v26, s[38:39] offset:0 sc1
    global_load_dwordx4 v[226:229], v26, s[38:39] offset:1024 sc1
    global_load_dwordx4 v[230:233], v26, s[38:39] offset:2048 sc1
    s_waitcnt vmcnt(0)
    v_or3_b32 v28, v209, v213, v217
    v_or3_b32 v28, v221, v225, v28
    v_or3_b32 v28, v229, v233, v28
    v_and_b32 v28, 1, v28
    v_cmp_ne_u32 vcc, 0, v28
    s_add_u32 s100, s100, 1
    s_cmp_ge_u32 s100, 262144
    s_cbranch_scc1 Lp2_p_x
    s_cbranch_vccnz Lp2_p
Lp2_p_x:
    s_nop 1
    s_branch Lp2_ok
Lp3_r:
    s_nop 7
Lp3_p:
    global_load_dwordx4 v[238:241], v27, s[38:39] offset:-4096 sc1
    global_load_dwordx4 v[242:245], v27, s[38:39] offset:-3072 sc1
    global_load_dwordx4 v[246:249], v27, s[38:39] offset:-2048 sc1
    global_load_dwordx4 v[250:253], v27, s[38:39] offset:-1024 sc1
    s_waitcnt vmcnt(0)
    v_or_b32 v28, v239, v241
    v_or3_b32 v28, v243, v245, v28
    v_or3_b32 v28, v247, v249, v28
    v_or3_b32 v28, v251, v253, v28
    v_and_b32 v28, 1, v28
    v_cmp_ne_u32 vcc, 0, v28
    s_add_u32 s100, s100, 1
    s_cmp_ge_u32 s100, 262144
    s_cbranch_scc1 Lp3_p_x
    s_cbranch_vccnz Lp3_p
Lp3_p_x:
    s_nop 1
    s_branch Lp3_ok
Lcode_end:
    s_endpgm
.section .rodata,"a"
.p2align 6
.amdhsa_kernel adaLN_cond__ssm_conv_h3__mixer_gmlp__prompt_kernel
  .amdhsa_next_free_vgpr 512
  .amdhsa_next_free_sgpr 102
  .amdhsa_accum_offset 256
  .amdhsa_group_segment_fixed_size 0
  .amdhsa_kernarg_size 128
  .amdhsa_user_sgpr_count 2
  .amdhsa_user_sgpr_kernarg_segment_ptr 1
  .amdhsa_system_sgpr_workgroup_id_x 1
  .amdhsa_float_denorm_mode_32 3
.end_amdhsa_kernel
```

```asm
; @launch grid=(256,1,1) block=(256,1,1) lds=163840
.amdgcn_target "amdgcn-amd-amdhsa--gfx950"
.text
.p2align 8
.globl adaLN_cond__ssm_conv_h3__mixer_gmlp__prompt_kernel
.type adaLN_cond__ssm_conv_h3__mixer_gmlp__prompt_kernel,@function
adaLN_cond__ssm_conv_h3__mixer_gmlp__prompt_kernel:
    s_cmp_ge_u32 s2, 256
    s_cbranch_scc1 Lend
    s_load_dwordx16 s[8:23], s[0:1], 0
    s_load_dwordx16 s[24:39], s[0:1], 64
    v_lshrrev_b32 v2, 6, v0
    v_and_b32 v1, 63, v0
    v_readfirstlane_b32 s3, v2
    s_getpc_b64 s[4:5]
Lpf_adaLN_cond__ssm_conv_h3__mixer_gmlp__prompt_kernel_9:
    s_add_u32 s4, s4, adaLN_cond__ssm_conv_h3__mixer_gmlp__prompt_kernel-Lpf_adaLN_cond__ssm_conv_h3__mixer_gmlp__prompt_kernel_9
    s_addc_u32 s5, s5, -1
    s_lshr_b32 s6, s2, 3
    s_and_b32 s6, s6, 31
    v_mul_u32_u24 v254, 32, v0
    v_add_lshl_u32 v254, v254, s6, 7
    v_min_u32 v254, (Lcode_end-adaLN_cond__ssm_conv_h3__mixer_gmlp__prompt_kernel-4), v254
    global_load_dword v254, v254, s[4:5]
    s_mov_b64 s[58:59], s[4:5]
    v_and_b32 v2, 15, v1
    v_lshrrev_b32 v3, 4, v1
    v_lshlrev_b32 v4, 4, v1
    v_lshrrev_b32 v6, 2, v2
    v_and_b32 v5, 3, v2
    v_lshl_add_u32 v5, v6, 3, v5
    s_mov_b32 s100, 0
    s_and_b32 s4, s2, 7
    s_lshr_b32 s5, s2, 3
    s_lshr_b32 s43, s5, 2
    s_lshr_b32 s6, s43, 1
    s_lshl_b32 s6, s6, 3
    s_and_b32 s7, s4, 6
    s_add_u32 s6, s6, s7
    s_and_b32 s7, s43, 1
    s_add_u32 s40, s6, s7
    s_and_b32 s6, s4, 1
    s_lshl_b32 s6, s6, 2
    s_and_b32 s7, s5, 3
    s_add_u32 s41, s6, s7
    s_mul_i32 s4, s4, 20
    s_add_u32 s42, s4, s5
    s_waitcnt lgkmcnt(0)
    s_mov_b64 s[0:1], s[58:59]
    s_cmp_ge_u32 s2, 160
    s_cbranch_scc1 Lspare
Lconv:
    s_and_b32 s4, s42, 15
    s_lshl_b32 s4, s4, 2
    s_add_u32 s4, s4, s3
    s_mul_i32 s4, s4, 40960
    s_lshr_b32 s5, s42, 4
    s_lshl_b32 s6, s5, 7
    s_add_u32 s4, s4, s6
    v_mul_u32_u24 v38, 10240, v3
    v_lshl_add_u32 v38, v2, 3, v38
    v_add_u32 v38, s4, v38
    v_add_u32 v39, 5120, v38
    global_load_dwordx2 v[48:49], v38, s[10:11] offset:0
    global_load_dwordx2 v[50:51], v38, s[10:11] offset:1280
    global_load_dwordx2 v[52:53], v38, s[10:11] offset:2560
    global_load_dwordx2 v[54:55], v38, s[10:11] offset:3840
    global_load_dwordx2 v[56:57], v39, s[10:11] offset:0
    global_load_dwordx2 v[58:59], v39, s[10:11] offset:1280
    global_load_dwordx2 v[60:61], v39, s[10:11] offset:2560
    global_load_dwordx2 v[62:63], v39, s[10:11] offset:3840
    v_max_u32 v40, 3840, v38
    global_load_dwordx2 v[42:43], v40, s[10:11] offset:-3840
    global_load_dwordx2 v[44:45], v40, s[10:11] offset:-2560
    global_load_dwordx2 v[46:47], v40, s[10:11] offset:-1280
    s_lshl_b32 s5, s5, 9
    v_lshl_add_u32 v40, v2, 5, s5
    global_load_dwordx4 v[80:83], v40, s[14:15] offset:0
    global_load_dwordx4 v[84:87], v40, s[14:15] offset:16
    global_load_dwordx2 v[64:65], v38, s[12:13] offset:0 nt
    global_load_dwordx2 v[66:67], v38, s[12:13] offset:1280 nt
    global_load_dwordx2 v[68:69], v38, s[12:13] offset:2560 nt
    global_load_dwordx2 v[70:71], v38, s[12:13] offset:3840 nt
    global_load_dwordx2 v[72:73], v39, s[12:13] offset:0 nt
    global_load_dwordx2 v[74:75], v39, s[12:13] offset:1280 nt
    global_load_dwordx2 v[76:77], v39, s[12:13] offset:2560 nt
    global_load_dwordx2 v[78:79], v39, s[12:13] offset:3840 nt
    s_lshl_b32 s7, s42, 3
    s_load_dwordx2 s[92:93], s[18:19], s7
    v_mov_b32 v148, 0
    v_mov_b32 v149, 0
    v_mov_b32 v150, 0
    v_mov_b32 v151, 0
    s_mul_i32 s5, s3, 8448
    v_and_b32 v28, 48, v4
    v_add_u32 v28, s5, v28
    ds_write_b128 v28, v[148:151] offset:0
    ds_write_b128 v28, v[148:151] offset:4224
    v_min_u32 v28, 448, v4
    s_mul_i32 s4, s3, 9280
    v_add_u32 v28, s4, v28
    ds_write_b128 v28, v[148:151] offset:37888
    ds_write_b128 v28, v[148:151] offset:42528
    v_add_u32 v31, s5, v4
    v_and_b32 v28, 1, v2
    v_lshrrev_b32 v29, 1, v2
    v_mul_u32_u24 v30, 4224, v28
    v_lshl_add_u32 v30, v29, 3, v30
    v_lshl_add_u32 v30, v3, 4, v30
    v_add_u32 v30, s5, v30
    v_mul_u32_u24 v32, 4640, v28
    v_lshlrev_b32 v29, 6, v29
    v_sub_u32 v32, v32, v29
    v_lshl_add_u32 v32, v3, 4, v32
    s_add_u32 s4, s4, 34256
    v_add_u32 v32, s4, v32
    v_lshl_add_u32 v34, v28, 2, v29
    v_lshl_add_u32 v34, v3, 4, v34
    s_mul_i32 s4, s3, 1056
    s_add_u32 s4, s4, 0
    v_add_u32 v34, s4, v34
    v_lshlrev_b32 v28, 2, v0
    v_sub_u32 v33, 34824, v28
    v_add_u32 v35, 0, v28
    v_lshrrev_b32 v28, 5, v0
    v_mul_u32_u24 v37, 114688, v28
    v_and_b32 v28, 31, v0
    v_lshl_add_u32 v37, v28, 4, v37
    s_lshl_b32 s4, s42, 9
    s_add_u32 s4, s4, 1048576
    v_add_u32 v37, s4, v37
    s_waitcnt lgkmcnt(0)
    s_lshl_b32 s52, s92, 16
    s_lshr_b32 s56, s52, 16
    s_and_b32 s53, s92, 0xffff0000
    s_lshr_b32 s57, s53, 16
    s_lshl_b32 s54, s93, 16
    s_lshr_b32 s58, s54, 16
    s_and_b32 s55, s93, 0xffff0000
    s_lshr_b32 s59, s55, 16
    v_and_b32 v203, 7, v1
    v_lshrrev_b32 v204, 3, v1
    s_lshl_b32 s4, s42, 2
    s_add_u32 s4, s4, s3
    s_lshl_b32 s94, s4, 12
    v_add_u32 v28, s94, v4
    s_mul_i32 s5, s3, 8448
    s_add_u32 m0, s5, 4288
    s_nop 0
    global_load_lds_dwordx4 v28, s[16:17] offset:0 nt
    global_load_lds_dwordx4 v28, s[16:17] offset:1024 nt
    global_load_lds_dwordx4 v28, s[16:17] offset:2048 nt
    global_load_lds_dwordx4 v28, s[16:17] offset:3072 nt
    s_lshr_b32 s5, s3, 1
    s_lshl_b32 s5, s5, 5
    s_and_b32 s6, s3, 1
    s_lshl_b32 s6, s6, 2
    s_add_u32 s6, s6, s5
    s_lshl_b32 s5, s40, 6
    s_add_u32 s90, s6, s5
    v_add_lshl_u32 v27, v5, s90, 1
    global_load_ushort v27, v27, s[26:27]
    s_waitcnt vmcnt(25)
    v_lshlrev_b32 v116, 16, v48
    v_and_b32 v117, 0xffff0000, v48
    v_lshlrev_b32 v118, 16, v49
    v_and_b32 v119, 0xffff0000, v49
    s_waitcnt vmcnt(24)
    v_lshlrev_b32 v120, 16, v50
    v_and_b32 v121, 0xffff0000, v50
    v_lshlrev_b32 v122, 16, v51
    v_and_b32 v123, 0xffff0000, v51
    s_waitcnt vmcnt(23)
    v_lshlrev_b32 v124, 16, v52
    v_and_b32 v125, 0xffff0000, v52
    v_lshlrev_b32 v126, 16, v53
    v_and_b32 v127, 0xffff0000, v53
    s_waitcnt vmcnt(22)
    v_lshlrev_b32 v128, 16, v54
    v_and_b32 v129, 0xffff0000, v54
    v_lshlrev_b32 v130, 16, v55
    v_and_b32 v131, 0xffff0000, v55
    s_waitcnt vmcnt(21)
    v_lshlrev_b32 v132, 16, v56
    v_and_b32 v133, 0xffff0000, v56
    v_lshlrev_b32 v134, 16, v57
    v_and_b32 v135, 0xffff0000, v57
    s_waitcnt vmcnt(20)
    v_lshlrev_b32 v136, 16, v58
    v_and_b32 v137, 0xffff0000, v58
    v_lshlrev_b32 v138, 16, v59
    v_and_b32 v139, 0xffff0000, v59
    s_waitcnt vmcnt(19)
    v_lshlrev_b32 v140, 16, v60
    v_and_b32 v141, 0xffff0000, v60
    v_lshlrev_b32 v142, 16, v61
    v_and_b32 v143, 0xffff0000, v61
    s_waitcnt vmcnt(18)
    v_lshlrev_b32 v144, 16, v62
    v_and_b32 v145, 0xffff0000, v62
    v_lshlrev_b32 v146, 16, v63
    v_and_b32 v147, 0xffff0000, v63
    s_lshl_b32 s4, s42, 2
    s_add_u32 s4, s4, s3
    s_mul_i32 s4, s4, 5120
    s_cmp_lt_u32 s42, 128
    s_cselect_b32 s5, -1, 0
    v_add_u32 v201, s4, v4
    v_and_b32 v201, s5, v201
    v_add_u32 v201, 2048, v201
    global_load_dwordx4 v[180:183], v201, s[8:9] offset:-2048 nt
    global_load_dwordx4 v[184:187], v201, s[8:9] offset:-1024 nt
    global_load_dwordx4 v[188:191], v201, s[8:9] offset:0 nt
    global_load_dwordx4 v[192:195], v201, s[8:9] offset:1024 nt
    global_load_dwordx4 v[196:199], v201, s[8:9] offset:2048 nt
    v_cmp_le_u32 vcc, 1280, v38
    s_waitcnt vmcnt(22)
    s_nop 0
    v_cndmask_b32 v42, 0, v42, vcc
    v_cndmask_b32 v43, 0, v43, vcc
    s_waitcnt vmcnt(21)
    v_cndmask_b32 v44, 0, v44, vcc
    v_cndmask_b32 v45, 0, v45, vcc
    s_waitcnt vmcnt(20)
    v_cndmask_b32 v46, 0, v46, vcc
    v_cndmask_b32 v47, 0, v47, vcc
    v_lshlrev_b32 v104, 16, v42
    v_and_b32 v105, 0xffff0000, v42
    v_lshlrev_b32 v106, 16, v43
    v_and_b32 v107, 0xffff0000, v43
    v_lshlrev_b32 v108, 16, v44
    v_and_b32 v109, 0xffff0000, v44
    v_lshlrev_b32 v110, 16, v45
    v_and_b32 v111, 0xffff0000, v45
    v_lshlrev_b32 v112, 16, v46
    v_and_b32 v113, 0xffff0000, v46
    v_lshlrev_b32 v114, 16, v47
    v_and_b32 v115, 0xffff0000, v47
    s_waitcnt vmcnt(19)
    v_lshlrev_b32 v88, 16, v80
    v_and_b32 v92, 0xffff0000, v80
    v_lshlrev_b32 v96, 16, v81
    v_and_b32 v100, 0xffff0000, v81
    v_lshlrev_b32 v89, 16, v82
    v_and_b32 v93, 0xffff0000, v82
    v_lshlrev_b32 v97, 16, v83
    v_and_b32 v101, 0xffff0000, v83
    s_waitcnt vmcnt(18)
    v_lshlrev_b32 v90, 16, v84
    v_and_b32 v94, 0xffff0000, v84
    v_lshlrev_b32 v98, 16, v85
    v_and_b32 v102, 0xffff0000, v85
    v_lshlrev_b32 v91, 16, v86
    v_and_b32 v95, 0xffff0000, v86
    v_lshlrev_b32 v99, 16, v87
    v_and_b32 v103, 0xffff0000, v87
    v_pk_mul_f32 v[148:149], v[116:117], v[88:89] op_sel:[0,0] op_sel_hi:[1,1]
    v_pk_mul_f32 v[150:151], v[118:119], v[90:91] op_sel:[0,0] op_sel_hi:[1,1]
    v_pk_mul_f32 v[152:153], v[120:121], v[88:89] op_sel:[0,0] op_sel_hi:[1,1]
    v_pk_mul_f32 v[154:155], v[122:123], v[90:91] op_sel:[0,0] op_sel_hi:[1,1]
    v_pk_mul_f32 v[156:157], v[124:125], v[88:89] op_sel:[0,0] op_sel_hi:[1,1]
    v_pk_mul_f32 v[158:159], v[126:127], v[90:91] op_sel:[0,0] op_sel_hi:[1,1]
    v_pk_mul_f32 v[160:161], v[128:129], v[88:89] op_sel:[0,0] op_sel_hi:[1,1]
    v_pk_mul_f32 v[162:163], v[130:131], v[90:91] op_sel:[0,0] op_sel_hi:[1,1]
    v_pk_mul_f32 v[164:165], v[132:133], v[88:89] op_sel:[0,0] op_sel_hi:[1,1]
    v_pk_mul_f32 v[166:167], v[134:135], v[90:91] op_sel:[0,0] op_sel_hi:[1,1]
    v_pk_mul_f32 v[168:169], v[136:137], v[88:89] op_sel:[0,0] op_sel_hi:[1,1]
    v_pk_mul_f32 v[170:171], v[138:139], v[90:91] op_sel:[0,0] op_sel_hi:[1,1]
    v_pk_mul_f32 v[172:173], v[140:141], v[88:89] op_sel:[0,0] op_sel_hi:[1,1]
    v_pk_mul_f32 v[174:175], v[142:143], v[90:91] op_sel:[0,0] op_sel_hi:[1,1]
    v_pk_mul_f32 v[176:177], v[144:145], v[88:89] op_sel:[0,0] op_sel_hi:[1,1]
    v_pk_mul_f32 v[178:179], v[146:147], v[90:91] op_sel:[0,0] op_sel_hi:[1,1]
    v_pk_fma_f32 v[148:149], v[112:113], v[92:93], v[148:149] op_sel:[0,0,0] op_sel_hi:[1,1,1]
    v_pk_fma_f32 v[150:151], v[114:115], v[94:95], v[150:151] op_sel:[0,0,0] op_sel_hi:[1,1,1]
    v_pk_fma_f32 v[152:153], v[116:117], v[92:93], v[152:153] op_sel:[0,0,0] op_sel_hi:[1,1,1]
    v_pk_fma_f32 v[154:155], v[118:119], v[94:95], v[154:155] op_sel:[0,0,0] op_sel_hi:[1,1,1]
    v_pk_fma_f32 v[156:157], v[120:121], v[92:93], v[156:157] op_sel:[0,0,0] op_sel_hi:[1,1,1]
    v_pk_fma_f32 v[158:159], v[122:123], v[94:95], v[158:159] op_sel:[0,0,0] op_sel_hi:[1,1,1]
    v_pk_fma_f32 v[160:161], v[124:125], v[92:93], v[160:161] op_sel:[0,0,0] op_sel_hi:[1,1,1]
    v_pk_fma_f32 v[162:163], v[126:127], v[94:95], v[162:163] op_sel:[0,0,0] op_sel_hi:[1,1,1]
    v_pk_fma_f32 v[164:165], v[128:129], v[92:93], v[164:165] op_sel:[0,0,0] op_sel_hi:[1,1,1]
    v_pk_fma_f32 v[166:167], v[130:131], v[94:95], v[166:167] op_sel:[0,0,0] op_sel_hi:[1,1,1]
    v_pk_fma_f32 v[168:169], v[132:133], v[92:93], v[168:169] op_sel:[0,0,0] op_sel_hi:[1,1,1]
    v_pk_fma_f32 v[170:171], v[134:135], v[94:95], v[170:171] op_sel:[0,0,0] op_sel_hi:[1,1,1]
    v_pk_fma_f32 v[172:173], v[136:137], v[92:93], v[172:173] op_sel:[0,0,0] op_sel_hi:[1,1,1]
    v_pk_fma_f32 v[174:175], v[138:139], v[94:95], v[174:175] op_sel:[0,0,0] op_sel_hi:[1,1,1]
    v_pk_fma_f32 v[176:177], v[140:141], v[92:93], v[176:177] op_sel:[0,0,0] op_sel_hi:[1,1,1]
    v_pk_fma_f32 v[178:179], v[142:143], v[94:95], v[178:179] op_sel:[0,0,0] op_sel_hi:[1,1,1]
    v_pk_fma_f32 v[148:149], v[108:109], v[96:97], v[148:149] op_sel:[0,0,0] op_sel_hi:[1,1,1]
    v_pk_fma_f32 v[150:151], v[110:111], v[98:99], v[150:151] op_sel:[0,0,0] op_sel_hi:[1,1,1]
    v_pk_fma_f32 v[152:153], v[112:113], v[96:97], v[152:153] op_sel:[0,0,0] op_sel_hi:[1,1,1]
    v_pk_fma_f32 v[154:155], v[114:115], v[98:99], v[154:155] op_sel:[0,0,0] op_sel_hi:[1,1,1]
    v_pk_fma_f32 v[156:157], v[116:117], v[96:97], v[156:157] op_sel:[0,0,0] op_sel_hi:[1,1,1]
    v_pk_fma_f32 v[158:159], v[118:119], v[98:99], v[158:159] op_sel:[0,0,0] op_sel_hi:[1,1,1]
    v_pk_fma_f32 v[160:161], v[120:121], v[96:97], v[160:161] op_sel:[0,0,0] op_sel_hi:[1,1,1]
    v_pk_fma_f32 v[162:163], v[122:123], v[98:99], v[162:163] op_sel:[0,0,0] op_sel_hi:[1,1,1]
    v_pk_fma_f32 v[164:165], v[124:125], v[96:97], v[164:165] op_sel:[0,0,0] op_sel_hi:[1,1,1]
    v_pk_fma_f32 v[166:167], v[126:127], v[98:99], v[166:167] op_sel:[0,0,0] op_sel_hi:[1,1,1]
    v_pk_fma_f32 v[168:169], v[128:129], v[96:97], v[168:169] op_sel:[0,0,0] op_sel_hi:[1,1,1]
    v_pk_fma_f32 v[170:171], v[130:131], v[98:99], v[170:171] op_sel:[0,0,0] op_sel_hi:[1,1,1]
    v_pk_fma_f32 v[172:173], v[132:133], v[96:97], v[172:173] op_sel:[0,0,0] op_sel_hi:[1,1,1]
    v_pk_fma_f32 v[174:175], v[134:135], v[98:99], v[174:175] op_sel:[0,0,0] op_sel_hi:[1,1,1]
    v_pk_fma_f32 v[176:177], v[136:137], v[96:97], v[176:177] op_sel:[0,0,0] op_sel_hi:[1,1,1]
    v_pk_fma_f32 v[178:179], v[138:139], v[98:99], v[178:179] op_sel:[0,0,0] op_sel_hi:[1,1,1]
    v_pk_fma_f32 v[148:149], v[104:105], v[100:101], v[148:149] op_sel:[0,0,0] op_sel_hi:[1,1,1]
    v_pk_fma_f32 v[150:151], v[106:107], v[102:103], v[150:151] op_sel:[0,0,0] op_sel_hi:[1,1,1]
    v_pk_fma_f32 v[152:153], v[108:109], v[100:101], v[152:153] op_sel:[0,0,0] op_sel_hi:[1,1,1]
    v_pk_fma_f32 v[154:155], v[110:111], v[102:103], v[154:155] op_sel:[0,0,0] op_sel_hi:[1,1,1]
    v_pk_fma_f32 v[156:157], v[112:113], v[100:101], v[156:157] op_sel:[0,0,0] op_sel_hi:[1,1,1]
    v_pk_fma_f32 v[158:159], v[114:115], v[102:103], v[158:159] op_sel:[0,0,0] op_sel_hi:[1,1,1]
    v_pk_fma_f32 v[160:161], v[116:117], v[100:101], v[160:161] op_sel:[0,0,0] op_sel_hi:[1,1,1]
    v_pk_fma_f32 v[162:163], v[118:119], v[102:103], v[162:163] op_sel:[0,0,0] op_sel_hi:[1,1,1]
    v_pk_fma_f32 v[164:165], v[120:121], v[100:101], v[164:165] op_sel:[0,0,0] op_sel_hi:[1,1,1]
    v_pk_fma_f32 v[166:167], v[122:123], v[102:103], v[166:167] op_sel:[0,0,0] op_sel_hi:[1,1,1]
    v_pk_fma_f32 v[168:169], v[124:125], v[100:101], v[168:169] op_sel:[0,0,0] op_sel_hi:[1,1,1]
    v_pk_fma_f32 v[170:171], v[126:127], v[102:103], v[170:171] op_sel:[0,0,0] op_sel_hi:[1,1,1]
    v_pk_fma_f32 v[172:173], v[128:129], v[100:101], v[172:173] op_sel:[0,0,0] op_sel_hi:[1,1,1]
    v_pk_fma_f32 v[174:175], v[130:131], v[102:103], v[174:175] op_sel:[0,0,0] op_sel_hi:[1,1,1]
    v_pk_fma_f32 v[176:177], v[132:133], v[100:101], v[176:177] op_sel:[0,0,0] op_sel_hi:[1,1,1]
    v_pk_fma_f32 v[178:179], v[134:135], v[102:103], v[178:179] op_sel:[0,0,0] op_sel_hi:[1,1,1]
    s_lshl_b32 s4, s3, 6
    s_sub_u32 s4, 104688, s4
    v_mul_u32_u24 v40, 272, v2
    v_add_u32 v40, s4, v40
    v_lshlrev_b32 v39, 4, v3
    v_sub_u32 v40, v40, v39
    s_waitcnt vmcnt(17)
    v_lshlrev_b32 v104, 16, v64
    v_and_b32 v105, 0xffff0000, v64
    v_lshlrev_b32 v106, 16, v65
    v_and_b32 v107, 0xffff0000, v65
    v_pk_mul_f32 v[148:149], v[148:149], v[104:105] op_sel:[0,0] op_sel_hi:[1,1]
    v_pk_mul_f32 v[150:151], v[150:151], v[106:107] op_sel:[0,0] op_sel_hi:[1,1]
    s_waitcnt vmcnt(16)
    v_lshlrev_b32 v108, 16, v66
    v_and_b32 v109, 0xffff0000, v66
    v_lshlrev_b32 v110, 16, v67
    v_and_b32 v111, 0xffff0000, v67
    v_pk_mul_f32 v[152:153], v[152:153], v[108:109] op_sel:[0,0] op_sel_hi:[1,1]
    v_pk_mul_f32 v[154:155], v[154:155], v[110:111] op_sel:[0,0] op_sel_hi:[1,1]
    s_waitcnt vmcnt(15)
    v_lshlrev_b32 v112, 16, v68
    v_and_b32 v113, 0xffff0000, v68
    v_lshlrev_b32 v114, 16, v69
    v_and_b32 v115, 0xffff0000, v69
    v_pk_mul_f32 v[156:157], v[156:157], v[112:113] op_sel:[0,0] op_sel_hi:[1,1]
    v_pk_mul_f32 v[158:159], v[158:159], v[114:115] op_sel:[0,0] op_sel_hi:[1,1]
    s_waitcnt vmcnt(14)
    v_lshlrev_b32 v116, 16, v70
    v_and_b32 v117, 0xffff0000, v70
    v_lshlrev_b32 v118, 16, v71
    v_and_b32 v119, 0xffff0000, v71
    v_pk_mul_f32 v[160:161], v[160:161], v[116:117] op_sel:[0,0] op_sel_hi:[1,1]
    v_pk_mul_f32 v[162:163], v[162:163], v[118:119] op_sel:[0,0] op_sel_hi:[1,1]
    s_waitcnt vmcnt(13)
    v_lshlrev_b32 v120, 16, v72
    v_and_b32 v121, 0xffff0000, v72
    v_lshlrev_b32 v122, 16, v73
    v_and_b32 v123, 0xffff0000, v73
    v_pk_mul_f32 v[164:165], v[164:165], v[120:121] op_sel:[0,0] op_sel_hi:[1,1]
    v_pk_mul_f32 v[166:167], v[166:167], v[122:123] op_sel:[0,0] op_sel_hi:[1,1]
    s_waitcnt vmcnt(12)
    v_lshlrev_b32 v124, 16, v74
    v_and_b32 v125, 0xffff0000, v74
    v_lshlrev_b32 v126, 16, v75
    v_and_b32 v127, 0xffff0000, v75
    v_pk_mul_f32 v[168:169], v[168:169], v[124:125] op_sel:[0,0] op_sel_hi:[1,1]
    v_pk_mul_f32 v[170:171], v[170:171], v[126:127] op_sel:[0,0] op_sel_hi:[1,1]
    s_waitcnt vmcnt(11)
    v_lshlrev_b32 v128, 16, v76
    v_and_b32 v129, 0xffff0000, v76
    v_lshlrev_b32 v130, 16, v77
    v_and_b32 v131, 0xffff0000, v77
    v_pk_mul_f32 v[172:173], v[172:173], v[128:129] op_sel:[0,0] op_sel_hi:[1,1]
    v_pk_mul_f32 v[174:175], v[174:175], v[130:131] op_sel:[0,0] op_sel_hi:[1,1]
    s_waitcnt vmcnt(10)
    v_lshlrev_b32 v132, 16, v78
    v_and_b32 v133, 0xffff0000, v78
    v_lshlrev_b32 v134, 16, v79
    v_and_b32 v135, 0xffff0000, v79
    v_pk_mul_f32 v[176:177], v[176:177], v[132:133] op_sel:[0,0] op_sel_hi:[1,1]
    v_pk_mul_f32 v[178:179], v[178:179], v[134:135] op_sel:[0,0] op_sel_hi:[1,1]
    v_cvt_pk_bf16_f32 v88, v176, v172
    v_cvt_pk_bf16_f32 v89, v168, v164
    v_cvt_pk_bf16_f32 v90, v160, v156
    v_cvt_pk_bf16_f32 v91, v152, v148
    v_and_b32 v91, -2, v91
    ds_write_b128 v40, v[88:91] offset:0
    v_cvt_pk_bf16_f32 v92, v177, v173
    v_cvt_pk_bf16_f32 v93, v169, v165
    v_cvt_pk_bf16_f32 v94, v161, v157
    v_cvt_pk_bf16_f32 v95, v153, v149
    v_and_b32 v95, -2, v95
    ds_write_b128 v40, v[92:95] offset:4352
    v_cvt_pk_bf16_f32 v96, v178, v174
    v_cvt_pk_bf16_f32 v97, v170, v166
    v_cvt_pk_bf16_f32 v98, v162, v158
    v_cvt_pk_bf16_f32 v99, v154, v150
    v_and_b32 v99, -2, v99
    ds_write_b128 v40, v[96:99] offset:8704
    v_cvt_pk_bf16_f32 v100, v179, v175
    v_cvt_pk_bf16_f32 v101, v171, v167
    v_cvt_pk_bf16_f32 v102, v163, v159
    v_cvt_pk_bf16_f32 v103, v155, v151
    v_and_b32 v103, -2, v103
    ds_write_b128 v40, v[100:103] offset:13056
    s_waitcnt lgkmcnt(0)
    s_barrier
    s_mul_i32 s4, s3, 4352
    s_add_u32 s4, s4, 104448
    v_mul_u32_u24 v40, 272, v3
    v_lshl_add_u32 v40, v2, 4, v40
    v_add_u32 v40, s4, v40
    ds_read_b128 v[148:151], v40 offset:0
    ds_read_b128 v[152:155], v40 offset:1088
    ds_read_b128 v[156:159], v40 offset:2176
    ds_read_b128 v[160:163], v40 offset:3264
    s_lshr_b32 s4, s42, 4
    s_lshl_b32 s4, s4, 6
    s_add_u32 s4, s4, s3
    s_lshl_b32 s4, s4, 12
    s_and_b32 s5, s42, 15
    s_lshl_b32 s5, s5, 8
    s_sub_u32 s4, s4, s5
    s_add_u32 s4, s4, 12586752
    v_lshl_add_u32 v38, v3, 14, s4
    v_lshl_add_u32 v38, v2, 4, v38
    s_waitcnt lgkmcnt(3)
    global_store_dwordx4 v38, v[148:151], s[38:39] sc1
    v_add_u32 v38, 65536, v38
    s_waitcnt lgkmcnt(2)
    global_store_dwordx4 v38, v[152:155], s[38:39] sc1
    v_add_u32 v38, 65536, v38
    s_waitcnt lgkmcnt(1)
    global_store_dwordx4 v38, v[156:159], s[38:39] sc1
    v_add_u32 v38, 65536, v38
    s_waitcnt lgkmcnt(0)
    global_store_dwordx4 v38, v[160:163], s[38:39] sc1
    v_and_b32 v212, 7, v1
    v_lshlrev_b32 v212, 2, v212
    v_mov_b32 v213, 1
    s_cmp_lg_u32 s3, 0
    s_cbranch_scc1 Ldb1
    global_load_dword v213, v212, s[36:37] sc1
Ldb1:
    s_waitcnt vmcnt(10)
    ds_read_b128 v[74:77], v31 offset:4288
    ds_read_b32 v73, v31 offset:4284
    ds_read_b128 v[82:85], v31 offset:5312
    ds_read_b32 v81, v31 offset:5308
    ds_read_b128 v[90:93], v31 offset:6336
    ds_read_b32 v89, v31 offset:6332
    ds_read_b128 v[98:101], v31 offset:7360
    ds_read_b32 v97, v31 offset:7356
    s_waitcnt lgkmcnt(6)
    v_alignbit_b32 v104, v74, v73, 16
    v_alignbit_b32 v105, v75, v74, 16
    v_alignbit_b32 v106, v76, v75, 16
    v_alignbit_b32 v107, v77, v76, 16
    ds_write_b128 v31, v[104:107] offset:64
    s_waitcnt lgkmcnt(5)
    v_alignbit_b32 v108, v82, v81, 16
    v_alignbit_b32 v109, v83, v82, 16
    v_alignbit_b32 v110, v84, v83, 16
    v_alignbit_b32 v111, v85, v84, 16
    ds_write_b128 v31, v[108:111] offset:1088
    s_waitcnt lgkmcnt(4)
    v_alignbit_b32 v112, v90, v89, 16
    v_alignbit_b32 v113, v91, v90, 16
    v_alignbit_b32 v114, v92, v91, 16
    v_alignbit_b32 v115, v93, v92, 16
    ds_write_b128 v31, v[112:115] offset:2112
    s_waitcnt lgkmcnt(3)
    v_alignbit_b32 v116, v98, v97, 16
    v_alignbit_b32 v117, v99, v98, 16
    v_alignbit_b32 v118, v100, v99, 16
    v_alignbit_b32 v119, v101, v100, 16
    ds_write_b128 v31, v[116:119] offset:3136
    ds_read_b64 a[0:1], v30 offset:8
    ds_read_b64 a[2:3], v30 offset:16
    ds_read_b64 a[4:5], v30 offset:72
    ds_read_b64 a[6:7], v30 offset:80
    ds_read_b64 a[8:9], v30 offset:136
    ds_read_b64 a[10:11], v30 offset:144
    ds_read_b64 a[12:13], v30 offset:200
    ds_read_b64 a[14:15], v30 offset:208
    ds_read_b64 a[16:17], v30 offset:264
    ds_read_b64 a[18:19], v30 offset:272
    ds_read_b64 a[20:21], v30 offset:328
    ds_read_b64 a[22:23], v30 offset:336
    ds_read_b64 a[24:25], v30 offset:392
    ds_read_b64 a[26:27], v30 offset:400
    ds_read_b64 a[28:29], v30 offset:456
    ds_read_b64 a[30:31], v30 offset:464
    ds_read_b64 a[32:33], v30 offset:520
    ds_read_b64 a[34:35], v30 offset:528
    ds_read_b64 a[36:37], v30 offset:584
    ds_read_b64 a[38:39], v30 offset:592
    ds_read_b64 a[40:41], v30 offset:648
    ds_read_b64 a[42:43], v30 offset:656
    ds_read_b64 a[44:45], v30 offset:712
    ds_read_b64 a[46:47], v30 offset:720
    ds_read_b64 a[48:49], v30 offset:776
    ds_read_b64 a[50:51], v30 offset:784
    ds_read_b64 a[52:53], v30 offset:840
    ds_read_b64 a[54:55], v30 offset:848
    ds_read_b64 a[56:57], v30 offset:904
    ds_read_b64 a[58:59], v30 offset:912
    ds_read_b64 a[60:61], v30 offset:968
    ds_read_b64 a[62:63], v30 offset:976
    ds_read_b64 a[64:65], v30 offset:1032
    ds_read_b64 a[66:67], v30 offset:1040
    ds_read_b64 a[68:69], v30 offset:1096
    ds_read_b64 a[70:71], v30 offset:1104
    ds_read_b64 a[72:73], v30 offset:1160
    ds_read_b64 a[74:75], v30 offset:1168
    ds_read_b64 a[76:77], v30 offset:1224
    ds_read_b64 a[78:79], v30 offset:1232
    ds_read_b64 a[80:81], v30 offset:1288
    ds_read_b64 a[82:83], v30 offset:1296
    ds_read_b64 a[84:85], v30 offset:1352
    ds_read_b64 a[86:87], v30 offset:1360
    ds_read_b64 a[88:89], v30 offset:1416
    ds_read_b64 a[90:91], v30 offset:1424
    ds_read_b64 a[92:93], v30 offset:1480
    ds_read_b64 a[94:95], v30 offset:1488
    s_mul_i32 s5, s3, 5152
    s_add_u32 s5, s5, 122880
    v_add_u32 v201, s5, v4
    v_lshrrev_b32 v202, 5, v1
    v_lshl_add_u32 v202, v202, 4, v201
    s_waitcnt vmcnt(8)
    ds_write_b128 v201, v[180:183] offset:0
    s_waitcnt vmcnt(7)
    ds_write_b128 v201, v[184:187] offset:1024
    s_waitcnt vmcnt(6)
    ds_write_b128 v202, v[188:191] offset:2048
    s_waitcnt vmcnt(5)
    ds_write_b128 v201, v[192:195] offset:3088
    s_waitcnt vmcnt(4)
    ds_write_b128 v201, v[196:199] offset:4112
    s_lshl_b32 s95, s42, 7
    s_add_u32 s95, s95, 77824
    v_max_u32 v136, 1, v2
    v_lshlrev_b32 v136, 7, v136
    v_xor_b32 v136, s95, v136
    s_add_u32 s4, s94, 12582912
    v_add_u32 v28, s4, v4
    s_mul_i32 s93, s3, 9280
    s_waitcnt vmcnt(0)
    v_cmp_eq_u32 vcc, 0, v213
    s_nop 0
    s_cbranch_vccnz Lic_r
Lic_ok:
    s_waitcnt lgkmcnt(0)
    s_barrier
    v_mov_b32 v29, s95
    s_cmp_lg_u32 s3, 0
    s_cbranch_scc1 Lkf_skip
    global_store_dword v29, v29, s[38:39] sc1
Lkf_skip:
    s_cmp_ge_u32 s42, 128
    s_cbranch_scc1 Lc_j2
    v_mul_u32_u24 v201, 2576, v203
    v_lshl_add_u32 v201, v204, 3, v201
    s_mul_i32 s5, s3, 320
    s_add_u32 s5, s5, 122880
    v_add_u32 v201, s5, v201
    ds_read2_b64 v[180:183], v201 offset0:0 offset1:160
    ds_read2_b64 v[184:187], v201 offset0:8 offset1:168
    ds_read2_b64 v[188:191], v201 offset0:16 offset1:176
    ds_read2_b64 v[192:195], v201 offset0:24 offset1:184
    ds_read2_b64 v[196:199], v201 offset0:32 offset1:192
    s_lshr_b32 s4, s42, 2
    s_mul_i32 s4, s4, 114688
    s_and_b32 s5, s42, 3
    s_lshl_b32 s5, s5, 7
    s_add_u32 s4, s4, s5
    s_mul_i32 s5, s3, 20480
    s_add_u32 s4, s4, s5
    s_add_u32 s4, s4, 1052672
    v_lshl_add_u32 v200, v204, 9, s4
    v_lshl_add_u32 v200, v203, 4, v200
    s_mov_b32 s7, 0x3f803f80
    v_mov_b32 v208, 0
    v_mov_b32 v209, 0
    v_mov_b32 v210, 0
    v_mov_b32 v211, 0
    s_waitcnt lgkmcnt(4)
    v_and_b32 v183, -2, v183
    global_store_dwordx4 v200, v[180:183], s[38:39] offset:-4096 sc1
    s_waitcnt lgkmcnt(3)
    v_and_b32 v187, -2, v187
    global_store_dwordx4 v200, v[184:187], s[38:39] offset:0 sc1
    v_add_u32 v200, 8192, v200
    s_waitcnt lgkmcnt(2)
    v_and_b32 v191, -2, v191
    global_store_dwordx4 v200, v[188:191], s[38:39] offset:-4096 sc1
    s_waitcnt lgkmcnt(1)
    v_and_b32 v195, -2, v195
    global_store_dwordx4 v200, v[192:195], s[38:39] offset:0 sc1
    v_add_u32 v200, 8192, v200
    s_waitcnt lgkmcnt(0)
    v_and_b32 v199, -2, v199
    global_store_dwordx4 v200, v[196:199], s[38:39] offset:-4096 sc1
    v_dot2_f32_bf16 v208, v180, s7, v208
    v_dot2_f32_bf16 v209, v180, v180, v209
    v_dot2_f32_bf16 v210, v182, s7, v210
    v_dot2_f32_bf16 v211, v182, v182, v211
    v_dot2_f32_bf16 v208, v181, s7, v208
    v_dot2_f32_bf16 v209, v181, v181, v209
    v_dot2_f32_bf16 v210, v183, s7, v210
    v_dot2_f32_bf16 v211, v183, v183, v211
    v_dot2_f32_bf16 v208, v184, s7, v208
    v_dot2_f32_bf16 v209, v184, v184, v209
    v_dot2_f32_bf16 v210, v186, s7, v210
    v_dot2_f32_bf16 v211, v186, v186, v211
    v_dot2_f32_bf16 v208, v185, s7, v208
    v_dot2_f32_bf16 v209, v185, v185, v209
    v_dot2_f32_bf16 v210, v187, s7, v210
    v_dot2_f32_bf16 v211, v187, v187, v211
    v_dot2_f32_bf16 v208, v188, s7, v208
    v_dot2_f32_bf16 v209, v188, v188, v209
    v_dot2_f32_bf16 v210, v190, s7, v210
    v_dot2_f32_bf16 v211, v190, v190, v211
    v_dot2_f32_bf16 v208, v189, s7, v208
    v_dot2_f32_bf16 v209, v189, v189, v209
    v_dot2_f32_bf16 v210, v191, s7, v210
    v_dot2_f32_bf16 v211, v191, v191, v211
    v_dot2_f32_bf16 v208, v192, s7, v208
    v_dot2_f32_bf16 v209, v192, v192, v209
    v_dot2_f32_bf16 v210, v194, s7, v210
    v_dot2_f32_bf16 v211, v194, v194, v211
    v_dot2_f32_bf16 v208, v193, s7, v208
    v_dot2_f32_bf16 v209, v193, v193, v209
    v_dot2_f32_bf16 v210, v195, s7, v210
    v_dot2_f32_bf16 v211, v195, v195, v211
    v_dot2_f32_bf16 v208, v196, s7, v208
    v_dot2_f32_bf16 v209, v196, v196, v209
    v_dot2_f32_bf16 v210, v198, s7, v210
    v_dot2_f32_bf16 v211, v198, v198, v211
    v_dot2_f32_bf16 v208, v197, s7, v208
    v_dot2_f32_bf16 v209, v197, v197, v209
    v_dot2_f32_bf16 v210, v199, s7, v210
    v_dot2_f32_bf16 v211, v199, v199, v211
    s_nop 1
    v_permlane32_swap_b32 v208, v210
    v_permlane32_swap_b32 v209, v211
    v_add_f32 v208, v208, v210
    v_add_f32 v209, v209, v211
    s_nop 1
    v_permlane16_swap_b32 v208, v209
    v_add_f32 v208, v208, v209
    v_lshlrev_b32 v201, 4, v203
    v_lshl_add_u32 v201, v3, 2, v201
    v_add_f32_dpp v208, v208, v208 row_ror:8 row_mask:0xf bank_mask:0xf
    s_lshl_b32 s5, s3, 7
    s_add_u32 s5, s5, 143616
    v_add_u32 v201, s5, v201
    ds_write_b32 v201, v208
    s_waitcnt vmcnt(5)
    s_branch Lc_j3
Lc_j2:
    s_waitcnt vmcnt(0)
Lc_j3:
    s_mov_b32 s95, 0
    ds_read_b64 a[96:97], v30 offset:1544
    ds_read_b64 a[98:99], v30 offset:1552
    ds_read_b64 a[100:101], v30 offset:1608
    ds_read_b64 a[102:103], v30 offset:1616
    ds_read_b64 a[104:105], v30 offset:1672
    ds_read_b64 a[106:107], v30 offset:1680
    ds_read_b64 a[108:109], v30 offset:1736
    ds_read_b64 a[110:111], v30 offset:1744
    ds_read_b64 a[112:113], v30 offset:1800
    ds_read_b64 a[114:115], v30 offset:1808
    ds_read_b64 a[116:117], v30 offset:1864
    ds_read_b64 a[118:119], v30 offset:1872
    ds_read_b64 a[120:121], v30 offset:1928
    ds_read_b64 a[122:123], v30 offset:1936
    ds_read_b64 a[124:125], v30 offset:1992
    ds_read_b64 a[126:127], v30 offset:2000
    ds_read_b64 a[128:129], v30 offset:2056
    ds_read_b64 a[130:131], v30 offset:2064
    ds_read_b64 a[132:133], v30 offset:2120
    ds_read_b64 a[134:135], v30 offset:2128
    ds_read_b64 a[136:137], v30 offset:2184
    ds_read_b64 a[138:139], v30 offset:2192
    ds_read_b64 a[140:141], v30 offset:2248
    ds_read_b64 a[142:143], v30 offset:2256
    ds_read_b64 a[144:145], v30 offset:2312
    ds_read_b64 a[146:147], v30 offset:2320
    ds_read_b64 a[148:149], v30 offset:2376
    ds_read_b64 a[150:151], v30 offset:2384
    ds_read_b64 a[152:153], v30 offset:2440
    ds_read_b64 a[154:155], v30 offset:2448
    ds_read_b64 a[156:157], v30 offset:2504
    ds_read_b64 a[158:159], v30 offset:2512
    ds_read_b64 a[160:161], v30 offset:2568
    ds_read_b64 a[162:163], v30 offset:2576
    ds_read_b64 a[164:165], v30 offset:2632
    ds_read_b64 a[166:167], v30 offset:2640
    ds_read_b64 a[168:169], v30 offset:2696
    ds_read_b64 a[170:171], v30 offset:2704
    ds_read_b64 a[172:173], v30 offset:2760
    ds_read_b64 a[174:175], v30 offset:2768
    ds_read_b64 a[176:177], v30 offset:2824
    ds_read_b64 a[178:179], v30 offset:2832
    ds_read_b64 a[180:181], v30 offset:2888
    ds_read_b64 a[182:183], v30 offset:2896
    ds_read_b64 a[184:185], v30 offset:2952
    ds_read_b64 a[186:187], v30 offset:2960
    ds_read_b64 a[188:189], v30 offset:3016
    ds_read_b64 a[190:191], v30 offset:3024
    ds_read_b64 a[192:193], v30 offset:3080
    ds_read_b64 a[194:195], v30 offset:3088
    ds_read_b64 a[196:197], v30 offset:3144
    ds_read_b64 a[198:199], v30 offset:3152
    ds_read_b64 a[200:201], v30 offset:3208
    ds_read_b64 a[202:203], v30 offset:3216
    ds_read_b64 a[204:205], v30 offset:3272
    ds_read_b64 a[206:207], v30 offset:3280
    ds_read_b64 a[208:209], v30 offset:3336
    ds_read_b64 a[210:211], v30 offset:3344
    ds_read_b64 a[212:213], v30 offset:3400
    ds_read_b64 a[214:215], v30 offset:3408
    ds_read_b64 a[216:217], v30 offset:3464
    ds_read_b64 a[218:219], v30 offset:3472
    ds_read_b64 a[220:221], v30 offset:3528
    ds_read_b64 a[222:223], v30 offset:3536
    ds_read_b64 a[224:225], v30 offset:3592
    ds_read_b64 a[226:227], v30 offset:3600
    ds_read_b64 a[228:229], v30 offset:3656
    ds_read_b64 a[230:231], v30 offset:3664
    ds_read_b64 a[232:233], v30 offset:3720
    ds_read_b64 a[234:235], v30 offset:3728
    ds_read_b64 a[236:237], v30 offset:3784
    ds_read_b64 a[238:239], v30 offset:3792
    global_load_dword v137, v136, s[38:39] sc1
    v_min_u32 v41, 49, v1
    v_cmp_lt_u32 vcc, 7, v41
    s_nop 1
    v_cndmask_b32_e64 v42, 0, 7, vcc
    v_add_lshl_u32 v41, v41, v42, 2
    v_mov_b32 v42, 1
    s_cmp_lg_u32 s3, 0
    s_cbranch_scc1 Ldb2
    global_load_dword v42, v41, s[36:37] sc1
Ldb2:
    ds_read_b64 a[240:241], v30 offset:3848
    ds_read_b64 a[242:243], v30 offset:3856
    ds_read_b64 a[244:245], v30 offset:3912
    ds_read_b64 a[246:247], v30 offset:3920
    ds_read_b64 a[248:249], v30 offset:3976
    ds_read_b64 a[250:251], v30 offset:3984
    ds_read_b64 a[252:253], v30 offset:4040
    ds_read_b64 a[254:255], v30 offset:4048
    s_and_b32 s4, s41, 1
    s_lshl_b32 s5, s3, 1
    s_add_u32 s5, s5, s4
    s_cmp_eq_u32 s5, 7
    s_cselect_b32 s5, 0, s5
    s_mul_i32 s96, s41, 7
    s_add_u32 s96, s96, s5
    s_cmp_lt_u32 s96, 54
    s_cselect_b32 s101, 2, 0
    s_min_u32 s96, s96, 53
    s_cmp_eq_u32 s3, 3
    s_cselect_b32 s101, 1, s101
    s_lshr_b32 s97, s101, 1
    s_cselect_b32 s5, -1, 0
    v_and_b32 v7, s5, v4
    s_add_u32 s97, s97, s96
    s_mul_i32 s4, s96, 20480
    s_add_u32 s5, s4, 7344128
    s_add_u32 s8, s38, s5
    s_addc_u32 s9, s39, 0
    s_add_u32 s5, s4, 7352320
    s_add_u32 s10, s38, s5
    s_addc_u32 s11, s39, 0
    s_add_u32 s5, s4, 7360512
    s_add_u32 s12, s38, s5
    s_addc_u32 s13, s39, 0
    s_mul_i32 s4, s97, 20480
    s_add_u32 s5, s4, 7344128
    s_add_u32 s14, s38, s5
    s_addc_u32 s15, s39, 0
    s_add_u32 s5, s4, 7352320
    s_add_u32 s16, s38, s5
    s_addc_u32 s17, s39, 0
    s_add_u32 s5, s4, 7360512
    s_add_u32 s18, s38, s5
    s_addc_u32 s19, s39, 0
    s_and_b32 s4, s41, 3
    s_cmp_eq_u32 s4, 0
    s_cselect_b32 s5, 8, 0
    s_cmp_le_u32 s4, 1
    s_cselect_b32 s6, 16, 8
    s_cmp_eq_u32 s4, 3
    s_cselect_b32 s50, 16, 24
    s_lshl_b32 s44, s4, 3
    s_bitcmp1_b32 s43, 0
    s_cselect_b32 s46, s6, s5
    s_cselect_b32 s48, s5, s6
    s_lshl_b32 s5, s3, 1
    s_add_u32 s44, s44, s5
    s_add_u32 s45, s44, 1
    s_add_u32 s46, s46, s5
    s_add_u32 s47, s46, 1
    s_add_u32 s48, s48, s5
    s_add_u32 s49, s48, 1
    s_add_u32 s50, s50, s5
    s_add_u32 s51, s50, 1
    s_lshl_b32 s5, s40, 18
    s_lshl_b32 s6, s44, 7
    s_add_u32 s6, s6, s5
    s_add_u32 s68, s24, s6
    s_addc_u32 s69, s25, 0
    s_lshl_b32 s6, s45, 7
    s_add_u32 s6, s6, s5
    s_add_u32 s70, s24, s6
    s_addc_u32 s71, s25, 0
    s_lshl_b32 s6, s46, 7
    s_add_u32 s6, s6, s5
    s_add_u32 s72, s24, s6
    s_addc_u32 s73, s25, 0
    s_lshl_b32 s6, s47, 7
    s_add_u32 s6, s6, s5
    s_add_u32 s74, s24, s6
    s_addc_u32 s75, s25, 0
    s_lshl_b32 s6, s48, 7
    s_add_u32 s6, s6, s5
    s_add_u32 s76, s24, s6
    s_addc_u32 s77, s25, 0
    s_lshl_b32 s6, s49, 7
    s_add_u32 s6, s6, s5
    s_add_u32 s78, s24, s6
    s_addc_u32 s79, s25, 0
    s_lshl_b32 s6, s50, 7
    s_add_u32 s6, s6, s5
    s_add_u32 s80, s24, s6
    s_addc_u32 s81, s25, 0
    s_lshl_b32 s6, s51, 7
    s_add_u32 s6, s6, s5
    s_add_u32 s82, s24, s6
    s_addc_u32 s83, s25, 0
    s_lshl_b32 s89, s3, 14
    s_add_u32 s89, s89, 83200
    s_waitcnt vmcnt(0) lgkmcnt(0)
    v_cmp_eq_u32 vcc, 0, v42
    s_nop 0
    s_cbranch_vccnz Lic2_r
Lic2_ok:
    s_barrier
    s_cmp_ge_u32 s42, 128
    s_cbranch_scc1 Lc_j5
    s_cmp_lg_u32 s3, 0
    s_cbranch_scc1 Lc_j5
    v_lshlrev_b32 v201, 3, v2
    v_add_u32 v202, 143616, v201
    ds_read_b64 v[212:213], v202 offset:0
    ds_read_b64 v[214:215], v202 offset:128
    ds_read_b64 v[216:217], v202 offset:256
    ds_read_b64 v[218:219], v202 offset:384
    s_waitcnt lgkmcnt(2)
    v_pk_add_f32 v[212:213], v[212:213], v[214:215] op_sel:[0,0] op_sel_hi:[1,1]
    s_waitcnt lgkmcnt(0)
    v_pk_add_f32 v[216:217], v[216:217], v[218:219] op_sel:[0,0] op_sel_hi:[1,1]
    v_pk_add_f32 v[212:213], v[212:213], v[216:217] op_sel:[0,0] op_sel_hi:[1,1]
    v_mul_f32 v212, 0x3acccccd, v212
    v_mul_f32 v213, 0x3acccccd, v213
    v_fma_f32 v213, -v212, v212, v213
    v_max_f32 v213, 0, v213
    v_add_f32 v213, 0x3727c5ac, v213
    v_rsq_f32 v214, v213
    s_nop 0
    v_mul_f32_e64 v213, -v212, v214
    v_mov_b32 v212, v214
    v_min_u32 v212, -2, v212
    v_min_u32 v213, -2, v213
    s_lshl_b32 s5, s42, 7
    s_add_u32 s5, s5, 32768
    v_add_u32 v201, s5, v201
    global_store_dwordx2 v201, v[212:213], s[38:39] sc1
Lc_j5:
    s_cmp_eq_u32 s95, 1
    s_cbranch_scc1 Lc_k2
    v_cmp_eq_u32 vcc, -1, v137
    s_nop 0
    s_cbranch_vccnz Lkf_r
Lkf_ok:
    s_add_u32 m0, s93, 33804
    s_nop 0
    global_load_lds_dwordx4 v28, s[38:39] offset:0 sc1
    global_load_lds_dwordx4 v28, s[38:39] offset:1024 sc1
    global_load_lds_dwordx4 v28, s[38:39] offset:2048 sc1
    global_load_lds_dwordx4 v28, s[38:39] offset:3072 sc1
    s_add_u32 m0, s93, 38448
    s_nop 0
    global_load_lds_dwordx4 v28, s[38:39] offset:0 sc1
    global_load_lds_dwordx4 v28, s[38:39] offset:1024 sc1
    global_load_lds_dwordx4 v28, s[38:39] offset:2048 sc1
    global_load_lds_dwordx4 v28, s[38:39] offset:3072 sc1
Lc_k2:
    v_bfe_u32 v223, v1, 3, 1
    s_sub_u32 s4, s97, s96
    v_mul_u32_u24 v223, s4, v223
    v_add_lshl_u32 v223, v223, s96, 7
    v_mul_u32_u24 v170, 7168, v3
    v_add_u32 v223, v223, v170
    v_and_b32 v170, 112, v4
    v_add_u32 v223, v223, v170
    v_add_u32 v223, 49152, v223
    v_and_b32 v137, 1, v3
    v_mul_u32_u24 v137, 7168, v137
    v_sub_u32 v137, v223, v137
    v_lshrrev_b32 v170, 3, v1
    v_lshlrev_b32 v170, 12, v170
    v_bfe_u32 v171, v1, 4, 1
    v_xor_b32 v171, v171, v1
    v_and_b32 v171, 7, v171
    v_xor_b32 v8, 0, v171
    v_lshl_add_u32 v8, v8, 4, v170
    v_add_u32 v12, 131072, v8
    v_xor_b32 v9, 2, v171
    v_lshl_add_u32 v9, v9, 4, v170
    v_add_u32 v9, 31744, v9
    v_add_u32 v13, 131072, v9
    v_xor_b32 v10, 4, v171
    v_lshl_add_u32 v10, v10, 4, v170
    v_add_u32 v10, 63488, v10
    v_add_u32 v14, 131072, v10
    v_xor_b32 v11, 6, v171
    v_lshl_add_u32 v11, v11, 4, v170
    v_add_u32 v11, 95232, v11
    v_add_u32 v15, 131072, v11
    s_barrier
    s_cmp_eq_u32 s95, 1
    s_cbranch_scc1 Lc_k3
    s_waitcnt vmcnt(0)
Lc_k3:
    ds_read_b128 v[72:75], v32 offset:3584
    ds_read_b128 v[76:79], v32 offset:3648
    ds_read_b128 v[80:83], v32 offset:3712
    ds_read_b128 v[84:87], v32 offset:3776
    ds_read_b128 v[88:91], v32 offset:3840
    ds_read_b128 v[92:95], v32 offset:3904
    ds_read_b128 v[96:99], v32 offset:3968
    ds_read_b128 v[100:103], v32 offset:4032
    s_waitcnt lgkmcnt(7)
    v_mfma_f32_16x16x32_bf16 v[40:43], a[0:3], v[72:75], 0
    ds_read_b128 v[104:107], v32 offset:3072
    v_mfma_f32_16x16x32_bf16 v[44:47], a[32:35], v[72:75], 0
    ds_read_b128 v[108:111], v32 offset:3136
    s_waitcnt lgkmcnt(8)
    v_mfma_f32_16x16x32_bf16 v[40:43], a[4:7], v[76:79], v[40:43]
    ds_read_b128 v[112:115], v32 offset:3200
    v_mfma_f32_16x16x32_bf16 v[44:47], a[36:39], v[76:79], v[44:47]
    ds_read_b128 v[116:119], v32 offset:3264
    s_waitcnt lgkmcnt(9)
    v_mfma_f32_16x16x32_bf16 v[40:43], a[8:11], v[80:83], v[40:43]
    ds_read_b128 v[120:123], v32 offset:3328
    v_mfma_f32_16x16x32_bf16 v[44:47], a[40:43], v[80:83], v[44:47]
    ds_read_b128 v[124:127], v32 offset:3392
    s_waitcnt lgkmcnt(10)
    v_mfma_f32_16x16x32_bf16 v[40:43], a[12:15], v[84:87], v[40:43]
    ds_read_b128 v[128:131], v32 offset:3456
    v_mfma_f32_16x16x32_bf16 v[44:47], a[44:47], v[84:87], v[44:47]
    ds_read_b128 v[132:135], v32 offset:3520
    s_waitcnt lgkmcnt(11)
    v_mfma_f32_16x16x32_bf16 v[40:43], a[16:19], v[88:91], v[40:43]
    v_mfma_f32_16x16x32_bf16 v[44:47], a[48:51], v[88:91], v[44:47]
    s_waitcnt lgkmcnt(10)
    v_mfma_f32_16x16x32_bf16 v[40:43], a[20:23], v[92:95], v[40:43]
    v_mfma_f32_16x16x32_bf16 v[44:47], a[52:55], v[92:95], v[44:47]
    s_waitcnt lgkmcnt(9)
    v_mfma_f32_16x16x32_bf16 v[40:43], a[24:27], v[96:99], v[40:43]
    v_mfma_f32_16x16x32_bf16 v[44:47], a[56:59], v[96:99], v[44:47]
    s_waitcnt lgkmcnt(8)
    v_mfma_f32_16x16x32_bf16 v[40:43], a[28:31], v[100:103], v[40:43]
    v_mfma_f32_16x16x32_bf16 v[44:47], a[60:63], v[100:103], v[44:47]
    s_waitcnt lgkmcnt(7)
    v_mfma_f32_16x16x32_bf16 v[44:47], a[0:3], v[104:107], v[44:47]
    s_waitcnt lgkmcnt(6)
    v_mfma_f32_16x16x32_bf16 v[44:47], a[4:7], v[108:111], v[44:47]
    s_waitcnt lgkmcnt(5)
    v_mfma_f32_16x16x32_bf16 v[44:47], a[8:11], v[112:115], v[44:47]
    s_waitcnt lgkmcnt(4)
    v_mfma_f32_16x16x32_bf16 v[44:47], a[12:15], v[116:119], v[44:47]
    s_waitcnt lgkmcnt(3)
    v_mfma_f32_16x16x32_bf16 v[44:47], a[16:19], v[120:123], v[44:47]
    v_mov_b32 v162, 0
    s_waitcnt lgkmcnt(2)
    v_mfma_f32_16x16x32_bf16 v[44:47], a[20:23], v[124:127], v[44:47]
    v_mov_b32 v163, 0
    s_waitcnt lgkmcnt(1)
    v_mfma_f32_16x16x32_bf16 v[44:47], a[24:27], v[128:131], v[44:47]
    v_mov_b32 v164, 0
    s_waitcnt lgkmcnt(0)
    v_mfma_f32_16x16x32_bf16 v[44:47], a[28:31], v[132:135], v[44:47]
    v_mfma_f32_16x16x32_bf16 v[48:51], a[64:67], v[72:75], 0
    v_mov_b32 v165, 0
    v_mfma_f32_16x16x32_bf16 v[52:55], a[96:99], v[72:75], 0
    s_min_u32 s5, s42, 127
    v_mfma_f32_16x16x32_bf16 v[56:59], a[128:131], v[72:75], 0
    v_mfma_f32_16x16x32_bf16 v[60:63], a[160:163], v[72:75], 0
    s_lshl_b32 s4, s5, 13
    v_mfma_f32_16x16x32_bf16 v[64:67], a[192:195], v[72:75], 0
    s_add_u32 s4, s4, 15208448
    v_mfma_f32_16x16x32_bf16 v[68:71], a[224:227], v[72:75], 0
    v_mfma_f32_16x16x32_bf16 v[48:51], a[68:71], v[76:79], v[48:51]
    v_lshl_add_u32 v224, v0, 4, s4
    v_mfma_f32_16x16x32_bf16 v[52:55], a[100:103], v[76:79], v[52:55]
    global_store_dwordx4 v224, v[162:165], s[38:39] offset:-4096 sc1
    v_mfma_f32_16x16x32_bf16 v[56:59], a[132:135], v[76:79], v[56:59]
    v_mfma_f32_16x16x32_bf16 v[60:63], a[164:167], v[76:79], v[60:63]
    global_store_dwordx4 v224, v[162:165], s[38:39] offset:0 sc1
    v_mfma_f32_16x16x32_bf16 v[64:67], a[196:199], v[76:79], v[64:67]
    v_mov_b32 v158, -1
    v_mfma_f32_16x16x32_bf16 v[68:71], a[228:231], v[76:79], v[68:71]
    v_mfma_f32_16x16x32_bf16 v[48:51], a[72:75], v[80:83], v[48:51]
    v_mov_b32 v159, -1
    v_mfma_f32_16x16x32_bf16 v[52:55], a[104:107], v[80:83], v[52:55]
    v_mov_b32 v160, -1
    v_mfma_f32_16x16x32_bf16 v[56:59], a[136:139], v[80:83], v[56:59]
    v_mfma_f32_16x16x32_bf16 v[60:63], a[168:171], v[80:83], v[60:63]
    v_mov_b32 v161, -1
    v_mfma_f32_16x16x32_bf16 v[64:67], a[200:203], v[80:83], v[64:67]
    s_lshr_b32 s4, s5, 2
    v_mfma_f32_16x16x32_bf16 v[68:71], a[232:235], v[80:83], v[68:71]
    s_mul_i32 s4, s4, 114688
    v_mfma_f32_16x16x32_bf16 v[48:51], a[76:79], v[84:87], v[48:51]
    v_mfma_f32_16x16x32_bf16 v[52:55], a[108:111], v[84:87], v[52:55]
    s_and_b32 s5, s5, 3
    v_mfma_f32_16x16x32_bf16 v[56:59], a[140:143], v[84:87], v[56:59]
    s_lshl_b32 s5, s5, 13
    v_mfma_f32_16x16x32_bf16 v[60:63], a[172:175], v[84:87], v[60:63]
    v_mfma_f32_16x16x32_bf16 v[64:67], a[204:207], v[84:87], v[64:67]
    s_add_u32 s4, s4, s5
    v_mfma_f32_16x16x32_bf16 v[68:71], a[236:239], v[84:87], v[68:71]
    s_add_u32 s4, s4, 1134592
    v_mfma_f32_16x16x32_bf16 v[48:51], a[80:83], v[88:91], v[48:51]
    v_mfma_f32_16x16x32_bf16 v[52:55], a[112:115], v[88:91], v[52:55]
    v_lshl_add_u32 v224, v0, 4, s4
    v_mfma_f32_16x16x32_bf16 v[56:59], a[144:147], v[88:91], v[56:59]
    global_store_dwordx4 v224, v[158:161], s[38:39] offset:-4096 sc1
    v_mfma_f32_16x16x32_bf16 v[60:63], a[176:179], v[88:91], v[60:63]
    v_mfma_f32_16x16x32_bf16 v[64:67], a[208:211], v[88:91], v[64:67]
    global_store_dwordx4 v224, v[158:161], s[38:39] offset:0 sc1
    v_mfma_f32_16x16x32_bf16 v[68:71], a[240:243], v[88:91], v[68:71]
    s_min_u32 s4, s42, 127
    v_mfma_f32_16x16x32_bf16 v[48:51], a[84:87], v[92:95], v[48:51]
    v_mfma_f32_16x16x32_bf16 v[52:55], a[116:119], v[92:95], v[52:55]
    s_lshl_b32 s4, s4, 10
    v_mfma_f32_16x16x32_bf16 v[56:59], a[148:151], v[92:95], v[56:59]
    s_add_u32 s4, s4, 12451840
    v_mfma_f32_16x16x32_bf16 v[60:63], a[180:183], v[92:95], v[60:63]
    v_mfma_f32_16x16x32_bf16 v[64:67], a[212:215], v[92:95], v[64:67]
    v_lshl_add_u32 v224, v0, 2, s4
    v_mfma_f32_16x16x32_bf16 v[68:71], a[244:247], v[92:95], v[68:71]
    global_store_dword v224, v158, s[38:39] sc1
    v_mfma_f32_16x16x32_bf16 v[48:51], a[88:91], v[96:99], v[48:51]
    v_mfma_f32_16x16x32_bf16 v[52:55], a[120:123], v[96:99], v[52:55]
    v_mfma_f32_16x16x32_bf16 v[56:59], a[152:155], v[96:99], v[56:59]
    v_mfma_f32_16x16x32_bf16 v[60:63], a[184:187], v[96:99], v[60:63]
    v_mfma_f32_16x16x32_bf16 v[64:67], a[216:219], v[96:99], v[64:67]
    v_mfma_f32_16x16x32_bf16 v[68:71], a[248:251], v[96:99], v[68:71]
    v_mfma_f32_16x16x32_bf16 v[48:51], a[92:95], v[100:103], v[48:51]
    v_mfma_f32_16x16x32_bf16 v[52:55], a[124:127], v[100:103], v[52:55]
    v_mfma_f32_16x16x32_bf16 v[56:59], a[156:159], v[100:103], v[56:59]
    v_mfma_f32_16x16x32_bf16 v[60:63], a[188:191], v[100:103], v[60:63]
    v_mfma_f32_16x16x32_bf16 v[64:67], a[220:223], v[100:103], v[64:67]
    v_mfma_f32_16x16x32_bf16 v[68:71], a[252:255], v[100:103], v[68:71]
    v_mfma_f32_16x16x32_bf16 v[48:51], a[32:35], v[104:107], v[48:51]
    v_mfma_f32_16x16x32_bf16 v[52:55], a[64:67], v[104:107], v[52:55]
    v_mfma_f32_16x16x32_bf16 v[56:59], a[96:99], v[104:107], v[56:59]
    v_mfma_f32_16x16x32_bf16 v[60:63], a[128:131], v[104:107], v[60:63]
    v_mfma_f32_16x16x32_bf16 v[64:67], a[160:163], v[104:107], v[64:67]
    v_mfma_f32_16x16x32_bf16 v[68:71], a[192:195], v[104:107], v[68:71]
    v_mfma_f32_16x16x32_bf16 v[48:51], a[36:39], v[108:111], v[48:51]
    v_mfma_f32_16x16x32_bf16 v[52:55], a[68:71], v[108:111], v[52:55]
    v_mfma_f32_16x16x32_bf16 v[56:59], a[100:103], v[108:111], v[56:59]
    v_mfma_f32_16x16x32_bf16 v[60:63], a[132:135], v[108:111], v[60:63]
    v_mfma_f32_16x16x32_bf16 v[64:67], a[164:167], v[108:111], v[64:67]
    v_mfma_f32_16x16x32_bf16 v[68:71], a[196:199], v[108:111], v[68:71]
    v_mfma_f32_16x16x32_bf16 v[48:51], a[40:43], v[112:115], v[48:51]
    v_mfma_f32_16x16x32_bf16 v[52:55], a[72:75], v[112:115], v[52:55]
    v_mfma_f32_16x16x32_bf16 v[56:59], a[104:107], v[112:115], v[56:59]
    v_mfma_f32_16x16x32_bf16 v[60:63], a[136:139], v[112:115], v[60:63]
    v_mfma_f32_16x16x32_bf16 v[64:67], a[168:171], v[112:115], v[64:67]
    v_mfma_f32_16x16x32_bf16 v[68:71], a[200:203], v[112:115], v[68:71]
    v_mfma_f32_16x16x32_bf16 v[48:51], a[44:47], v[116:119], v[48:51]
    v_mfma_f32_16x16x32_bf16 v[52:55], a[76:79], v[116:119], v[52:55]
    v_mfma_f32_16x16x32_bf16 v[56:59], a[108:111], v[116:119], v[56:59]
    v_mfma_f32_16x16x32_bf16 v[60:63], a[140:143], v[116:119], v[60:63]
    v_mfma_f32_16x16x32_bf16 v[64:67], a[172:175], v[116:119], v[64:67]
    v_mfma_f32_16x16x32_bf16 v[68:71], a[204:207], v[116:119], v[68:71]
    v_mfma_f32_16x16x32_bf16 v[48:51], a[48:51], v[120:123], v[48:51]
    v_mfma_f32_16x16x32_bf16 v[52:55], a[80:83], v[120:123], v[52:55]
    v_mfma_f32_16x16x32_bf16 v[56:59], a[112:115], v[120:123], v[56:59]
    v_mfma_f32_16x16x32_bf16 v[60:63], a[144:147], v[120:123], v[60:63]
    v_mfma_f32_16x16x32_bf16 v[64:67], a[176:179], v[120:123], v[64:67]
    v_mfma_f32_16x16x32_bf16 v[68:71], a[208:211], v[120:123], v[68:71]
    v_mfma_f32_16x16x32_bf16 v[48:51], a[52:55], v[124:127], v[48:51]
    v_mfma_f32_16x16x32_bf16 v[52:55], a[84:87], v[124:127], v[52:55]
    v_mfma_f32_16x16x32_bf16 v[56:59], a[116:119], v[124:127], v[56:59]
    v_lshlrev_b32 v28, 4, v0
    v_add_u32 v28, 36864, v28
    v_mfma_f32_16x16x32_bf16 v[60:63], a[148:151], v[124:127], v[60:63]
    global_load_dwordx4 v[202:205], v28, s[38:39] offset:-4096 sc1
    v_mfma_f32_16x16x32_bf16 v[64:67], a[180:183], v[124:127], v[64:67]
    global_load_dwordx4 v[206:209], v28, s[38:39] offset:0 sc1
    v_mfma_f32_16x16x32_bf16 v[68:71], a[212:215], v[124:127], v[68:71]
    v_add_u32 v28, 8192, v28
    global_load_dwordx4 v[210:213], v28, s[38:39] offset:-4096 sc1
    v_mfma_f32_16x16x32_bf16 v[48:51], a[56:59], v[128:131], v[48:51]
    ds_read_b128 v[72:75], v32 offset:2560
    global_load_dwordx4 v[214:217], v28, s[38:39] offset:0 sc1
    v_mfma_f32_16x16x32_bf16 v[52:55], a[88:91], v[128:131], v[52:55]
    ds_read_b128 v[76:79], v32 offset:2624
    v_min_u32 v28, 11, v1
    v_mfma_f32_16x16x32_bf16 v[56:59], a[120:123], v[128:131], v[56:59]
    ds_read_b128 v[80:83], v32 offset:2688
    v_lshrrev_b32 v29, 2, v28
    v_mfma_f32_16x16x32_bf16 v[60:63], a[152:155], v[128:131], v[60:63]
    ds_read_b128 v[84:87], v32 offset:2752
    v_mul_u32_u24 v29, 2544, v29
    v_mfma_f32_16x16x32_bf16 v[64:67], a[184:187], v[128:131], v[64:67]
    ds_read_b128 v[88:91], v32 offset:2816
    v_lshl_add_u32 v28, v28, 2, v29
    s_lshl_b32 s4, s42, 4
    v_mfma_f32_16x16x32_bf16 v[68:71], a[216:219], v[128:131], v[68:71]
    ds_read_b128 v[92:95], v32 offset:2880
    s_add_u32 s4, s4, 0
    v_add_u32 v28, s4, v28
    v_mfma_f32_16x16x32_bf16 v[48:51], a[60:63], v[132:135], v[48:51]
    ds_read_b128 v[96:99], v32 offset:2944
    global_load_dword v182, v28, s[38:39] sc1
    v_mfma_f32_16x16x32_bf16 v[52:55], a[92:95], v[132:135], v[52:55]
    ds_read_b128 v[100:103], v32 offset:3008
    v_add_u32 v28, 15360, v28
    v_mfma_f32_16x16x32_bf16 v[56:59], a[124:127], v[132:135], v[56:59]
    global_load_dword v183, v28, s[38:39] sc1
    v_mfma_f32_16x16x32_bf16 v[60:63], a[156:159], v[132:135], v[60:63]
    v_mfma_f32_16x16x32_bf16 v[64:67], a[188:191], v[132:135], v[64:67]
    global_load_dword v222, v137, s[38:39] sc1
    v_mfma_f32_16x16x32_bf16 v[68:71], a[220:223], v[132:135], v[68:71]
    s_waitcnt lgkmcnt(7)
    v_mfma_f32_16x16x32_bf16 v[48:51], a[0:3], v[72:75], v[48:51]
    ds_read_b128 v[104:107], v32 offset:2048
    v_mfma_f32_16x16x32_bf16 v[52:55], a[32:35], v[72:75], v[52:55]
    ds_read_b128 v[108:111], v32 offset:2112
    s_waitcnt lgkmcnt(8)
    v_mfma_f32_16x16x32_bf16 v[48:51], a[4:7], v[76:79], v[48:51]
    ds_read_b128 v[112:115], v32 offset:2176
    v_mfma_f32_16x16x32_bf16 v[52:55], a[36:39], v[76:79], v[52:55]
    ds_read_b128 v[116:119], v32 offset:2240
    s_waitcnt lgkmcnt(9)
    v_mfma_f32_16x16x32_bf16 v[48:51], a[8:11], v[80:83], v[48:51]
    ds_read_b128 v[120:123], v32 offset:2304
    v_mfma_f32_16x16x32_bf16 v[52:55], a[40:43], v[80:83], v[52:55]
    ds_read_b128 v[124:127], v32 offset:2368
    s_waitcnt lgkmcnt(10)
    v_mfma_f32_16x16x32_bf16 v[48:51], a[12:15], v[84:87], v[48:51]
    ds_read_b128 v[128:131], v32 offset:2432
    v_mfma_f32_16x16x32_bf16 v[52:55], a[44:47], v[84:87], v[52:55]
    ds_read_b128 v[132:135], v32 offset:2496
    s_waitcnt lgkmcnt(11)
    v_mfma_f32_16x16x32_bf16 v[48:51], a[16:19], v[88:91], v[48:51]
    v_mfma_f32_16x16x32_bf16 v[52:55], a[48:51], v[88:91], v[52:55]
    s_waitcnt lgkmcnt(10)
    v_mfma_f32_16x16x32_bf16 v[48:51], a[20:23], v[92:95], v[48:51]
    v_mfma_f32_16x16x32_bf16 v[52:55], a[52:55], v[92:95], v[52:55]
    s_waitcnt lgkmcnt(9)
    v_mfma_f32_16x16x32_bf16 v[48:51], a[24:27], v[96:99], v[48:51]
    v_mfma_f32_16x16x32_bf16 v[52:55], a[56:59], v[96:99], v[52:55]
    s_waitcnt lgkmcnt(8)
    v_mfma_f32_16x16x32_bf16 v[48:51], a[28:31], v[100:103], v[48:51]
    v_mfma_f32_16x16x32_bf16 v[52:55], a[60:63], v[100:103], v[52:55]
    s_waitcnt lgkmcnt(7)
    v_mfma_f32_16x16x32_bf16 v[52:55], a[0:3], v[104:107], v[52:55]
    s_waitcnt lgkmcnt(6)
    v_mfma_f32_16x16x32_bf16 v[52:55], a[4:7], v[108:111], v[52:55]
    s_waitcnt lgkmcnt(5)
    v_mfma_f32_16x16x32_bf16 v[52:55], a[8:11], v[112:115], v[52:55]
    s_waitcnt lgkmcnt(4)
    v_mfma_f32_16x16x32_bf16 v[52:55], a[12:15], v[116:119], v[52:55]
    s_waitcnt lgkmcnt(3)
    v_mfma_f32_16x16x32_bf16 v[52:55], a[16:19], v[120:123], v[52:55]
    s_waitcnt lgkmcnt(2)
    v_mfma_f32_16x16x32_bf16 v[52:55], a[20:23], v[124:127], v[52:55]
    s_waitcnt lgkmcnt(1)
    v_mfma_f32_16x16x32_bf16 v[52:55], a[24:27], v[128:131], v[52:55]
    s_waitcnt lgkmcnt(0)
    v_mfma_f32_16x16x32_bf16 v[52:55], a[28:31], v[132:135], v[52:55]
    v_mfma_f32_16x16x32_bf16 v[56:59], a[64:67], v[72:75], v[56:59]
    v_mfma_f32_16x16x32_bf16 v[60:63], a[96:99], v[72:75], v[60:63]
    v_mfma_f32_16x16x32_bf16 v[64:67], a[128:131], v[72:75], v[64:67]
    v_mfma_f32_16x16x32_bf16 v[68:71], a[160:163], v[72:75], v[68:71]
    v_mfma_f32_16x16x32_bf16 v[56:59], a[68:71], v[76:79], v[56:59]
    v_mfma_f32_16x16x32_bf16 v[60:63], a[100:103], v[76:79], v[60:63]
    v_mfma_f32_16x16x32_bf16 v[64:67], a[132:135], v[76:79], v[64:67]
    v_mfma_f32_16x16x32_bf16 v[68:71], a[164:167], v[76:79], v[68:71]
    v_mfma_f32_16x16x32_bf16 v[56:59], a[72:75], v[80:83], v[56:59]
    s_waitcnt vmcnt(0)
    v_cmp_eq_u32 vcc, -1, v222
    v_mfma_f32_16x16x32_bf16 v[60:63], a[104:107], v[80:83], v[60:63]
    v_mfma_f32_16x16x32_bf16 v[64:67], a[136:139], v[80:83], v[64:67]
    s_cbranch_vccnz Lcu_r
Lcu_ok:
    v_mfma_f32_16x16x32_bf16 v[68:71], a[168:171], v[80:83], v[68:71]
    v_mfma_f32_16x16x32_bf16 v[56:59], a[76:79], v[84:87], v[56:59]
    v_cvt_pk_bf16_f32 v138, v40, v41
    global_load_dwordx4 a[248:251], v4, s[12:13] offset:-1024 sc1
    v_mfma_f32_16x16x32_bf16 v[60:63], a[108:111], v[84:87], v[60:63]
    v_mfma_f32_16x16x32_bf16 v[64:67], a[140:143], v[84:87], v[64:67]
    v_cvt_pk_bf16_f32 v139, v42, v43
    v_mfma_f32_16x16x32_bf16 v[68:71], a[172:175], v[84:87], v[68:71]
    ds_write2_b32 v34, v138, v139 offset0:0 offset1:2
    v_mfma_f32_16x16x32_bf16 v[56:59], a[80:83], v[88:91], v[56:59]
    v_cvt_pk_bf16_f32 v140, v44, v45
    v_max_u32 v224, v203, v205
    v_mfma_f32_16x16x32_bf16 v[60:63], a[112:115], v[88:91], v[60:63]
    v_cvt_pk_bf16_f32 v141, v46, v47
    v_max3_u32 v224, v207, v209, v224
    v_mfma_f32_16x16x32_bf16 v[64:67], a[144:147], v[88:91], v[64:67]
    v_max3_u32 v224, v211, v213, v224
    ds_write2_b32 v34, v140, v141 offset0:128 offset1:130
    v_mfma_f32_16x16x32_bf16 v[68:71], a[176:179], v[88:91], v[68:71]
    v_max3_u32 v224, v215, v217, v224
    v_add_u32 v34, 4224, v34
    v_mfma_f32_16x16x32_bf16 v[56:59], a[84:87], v[92:95], v[56:59]
    v_max3_u32 v224, v182, v183, v224
    v_cmp_eq_u32 vcc, -1, v224
    s_nop 0
    s_cbranch_vccnz Lax_r
Lax_ok:
    v_mfma_f32_16x16x32_bf16 v[60:63], a[116:119], v[92:95], v[60:63]
    v_cvt_pk_bf16_f32 v138, v48, v49
    v_cvt_pk_bf16_f32 v139, v50, v51
    v_mfma_f32_16x16x32_bf16 v[64:67], a[148:151], v[92:95], v[64:67]
    v_add_u32 v36, 0, v37
    ds_write2_b32 v34, v138, v139 offset0:0 offset1:2
    s_add_u32 m0, s89, 0
    v_mfma_f32_16x16x32_bf16 v[68:71], a[180:183], v[92:95], v[68:71]
    global_load_dwordx4 v[186:189], v36, s[38:39] sc1
    v_add_u32 v36, 917504, v37
    v_mfma_f32_16x16x32_bf16 v[56:59], a[88:91], v[96:99], v[56:59]
    v_cvt_pk_bf16_f32 v140, v52, v53
    global_load_dwordx4 v[190:193], v36, s[38:39] sc1
    v_mfma_f32_16x16x32_bf16 v[60:63], a[120:123], v[96:99], v[60:63]
    v_cvt_pk_bf16_f32 v141, v54, v55
    v_add_u32 v36, 1835008, v37
    v_mfma_f32_16x16x32_bf16 v[64:67], a[152:155], v[96:99], v[64:67]
    ds_write2_b32 v34, v140, v141 offset0:128 offset1:130
    global_load_dwordx4 v[194:197], v36, s[38:39] sc1
    v_mfma_f32_16x16x32_bf16 v[68:71], a[184:187], v[96:99], v[68:71]
    v_add_u32 v36, 2752512, v37
    v_add_u32 v34, 4224, v34
    v_mfma_f32_16x16x32_bf16 v[56:59], a[92:95], v[100:103], v[56:59]
    s_waitcnt lgkmcnt(0)
    s_barrier
    global_load_dwordx4 v[198:201], v36, s[38:39] sc1
    v_mfma_f32_16x16x32_bf16 v[60:63], a[124:127], v[100:103], v[60:63]
    v_add_f32 v182, v182, v183
    v_cvt_pk_bf16_f32 v182, v182, v182
    v_mfma_f32_16x16x32_bf16 v[64:67], a[156:159], v[100:103], v[64:67]
    v_lshlrev_b32 v182, 16, v182
    global_load_dwordx4 a[252:255], v7, s[18:19] offset:-1024 sc1
    v_mfma_f32_16x16x32_bf16 v[68:71], a[188:191], v[100:103], v[68:71]
    v_mov_b32 v29, 1.0
    s_nop 1
    v_add_f32_dpp v182, v182, v29 quad_perm:[0,1,2,3] row_mask:0xf bank_mask:0x2
    v_mfma_f32_16x16x32_bf16 v[56:59], a[32:35], v[104:107], v[56:59]
    v_cvt_pk_bf16_f32 v182, v182, v182
    v_lshlrev_b32 v182, 16, v182
    v_mfma_f32_16x16x32_bf16 v[60:63], a[64:67], v[104:107], v[60:63]
    s_nop 0
    v_mul_f32_dpp v183, v182, v182 row_shl:8 row_mask:0xf bank_mask:0x1
    s_nop 1
    v_mul_f32_dpp v183, v182, v182 row_shl:4 row_mask:0xf bank_mask:0x2
    v_mfma_f32_16x16x32_bf16 v[64:67], a[96:99], v[104:107], v[64:67]
    v_readlane_b32 s64, v183, 0
    global_load_lds_dwordx4 v8, s[68:69] offset:0
    v_mfma_f32_16x16x32_bf16 v[68:71], a[128:131], v[104:107], v[68:71]
    v_readlane_b32 s65, v183, 1
    v_readlane_b32 s66, v183, 2
    v_mfma_f32_16x16x32_bf16 v[56:59], a[36:39], v[108:111], v[56:59]
    v_readlane_b32 s67, v183, 3
    v_readlane_b32 s60, v183, 4
    v_mfma_f32_16x16x32_bf16 v[60:63], a[68:71], v[108:111], v[60:63]
    v_readlane_b32 s61, v183, 5
    v_readlane_b32 s62, v183, 6
    v_mfma_f32_16x16x32_bf16 v[64:67], a[100:103], v[108:111], v[64:67]
    v_readlane_b32 s63, v183, 7
    v_mov_b32 v178, s64
    v_mfma_f32_16x16x32_bf16 v[68:71], a[132:135], v[108:111], v[68:71]
    v_mov_b32 v179, s65
    global_load_lds_dwordx4 v9, s[68:69] offset:1024
    v_mfma_f32_16x16x32_bf16 v[56:59], a[40:43], v[112:115], v[56:59]
    v_mov_b32 v180, s66
    v_mov_b32 v181, s67
    v_mfma_f32_16x16x32_bf16 v[60:63], a[72:75], v[112:115], v[60:63]
    global_load_dwordx4 a[240:243], v4, s[12:13] offset:-2048 sc1
    v_mfma_f32_16x16x32_bf16 v[64:67], a[104:107], v[112:115], v[64:67]
    v_mfma_f32_16x16x32_bf16 v[68:71], a[136:139], v[112:115], v[68:71]
    v_mfma_f32_16x16x32_bf16 v[56:59], a[44:47], v[116:119], v[56:59]
    global_load_lds_dwordx4 v10, s[68:69] offset:2048
    v_mfma_f32_16x16x32_bf16 v[60:63], a[76:79], v[116:119], v[60:63]
    v_mfma_f32_16x16x32_bf16 v[64:67], a[108:111], v[116:119], v[64:67]
    v_mfma_f32_16x16x32_bf16 v[68:71], a[140:143], v[116:119], v[68:71]
    v_mfma_f32_16x16x32_bf16 v[56:59], a[48:51], v[120:123], v[56:59]
    v_mfma_f32_16x16x32_bf16 v[60:63], a[80:83], v[120:123], v[60:63]
    v_mfma_f32_16x16x32_bf16 v[64:67], a[112:115], v[120:123], v[64:67]
    v_mfma_f32_16x16x32_bf16 v[68:71], a[144:147], v[120:123], v[68:71]
    global_load_dwordx4 a[244:247], v7, s[18:19] offset:-2048 sc1
    v_mfma_f32_16x16x32_bf16 v[56:59], a[52:55], v[124:127], v[56:59]
    ds_read_b128 v[72:75], v32 offset:1536
    global_load_lds_dwordx4 v11, s[68:69] offset:3072
    v_mfma_f32_16x16x32_bf16 v[60:63], a[84:87], v[124:127], v[60:63]
    ds_read_b128 v[76:79], v32 offset:1600
    v_mfma_f32_16x16x32_bf16 v[64:67], a[116:119], v[124:127], v[64:67]
    ds_read_b128 v[80:83], v32 offset:1664
    v_mfma_f32_16x16x32_bf16 v[68:71], a[148:151], v[124:127], v[68:71]
    ds_read_b128 v[84:87], v32 offset:1728
    v_mfma_f32_16x16x32_bf16 v[56:59], a[56:59], v[128:131], v[56:59]
    ds_read_b128 v[88:91], v32 offset:1792
    v_mfma_f32_16x16x32_bf16 v[60:63], a[88:91], v[128:131], v[60:63]
    ds_read_b128 v[92:95], v32 offset:1856
    v_mfma_f32_16x16x32_bf16 v[64:67], a[120:123], v[128:131], v[64:67]
    ds_read_b128 v[96:99], v32 offset:1920
    v_mfma_f32_16x16x32_bf16 v[68:71], a[152:155], v[128:131], v[68:71]
    ds_read_b128 v[100:103], v32 offset:1984
    s_add_u32 m0, s89, 4096
    v_mfma_f32_16x16x32_bf16 v[56:59], a[60:63], v[132:135], v[56:59]
    v_mfma_f32_16x16x32_bf16 v[60:63], a[92:95], v[132:135], v[60:63]
    v_mfma_f32_16x16x32_bf16 v[64:67], a[124:127], v[132:135], v[64:67]
    v_mfma_f32_16x16x32_bf16 v[68:71], a[156:159], v[132:135], v[68:71]
    s_waitcnt lgkmcnt(7)
    v_mfma_f32_16x16x32_bf16 v[56:59], a[0:3], v[72:75], v[56:59]
    ds_read_b128 v[104:107], v32 offset:1024
    global_load_dwordx4 a[232:235], v4, s[12:13] offset:-3072 sc1
    v_mfma_f32_16x16x32_bf16 v[60:63], a[32:35], v[72:75], v[60:63]
    ds_read_b128 v[108:111], v32 offset:1088
    s_waitcnt lgkmcnt(8)
    v_mfma_f32_16x16x32_bf16 v[56:59], a[4:7], v[76:79], v[56:59]
    ds_read_b128 v[112:115], v32 offset:1152
    v_mfma_f32_16x16x32_bf16 v[60:63], a[36:39], v[76:79], v[60:63]
    ds_read_b128 v[116:119], v32 offset:1216
    global_load_lds_dwordx4 v12, s[68:69] offset:0
    s_waitcnt lgkmcnt(9)
    v_mfma_f32_16x16x32_bf16 v[56:59], a[8:11], v[80:83], v[56:59]
    ds_read_b128 v[120:123], v32 offset:1280
    ds_read_b32 v150, v35 offset:0
    v_mfma_f32_16x16x32_bf16 v[60:63], a[40:43], v[80:83], v[60:63]
    ds_read_b128 v[124:127], v32 offset:1344
    ds_read_b32 v151, v35 offset:1056
    s_waitcnt lgkmcnt(12)
    v_mfma_f32_16x16x32_bf16 v[56:59], a[12:15], v[84:87], v[56:59]
    ds_read_b128 v[128:131], v32 offset:1408
    ds_read_b32 v152, v35 offset:2112
    v_mfma_f32_16x16x32_bf16 v[60:63], a[44:47], v[84:87], v[60:63]
    ds_read_b128 v[132:135], v32 offset:1472
    ds_read_b32 v153, v35 offset:3168
    s_waitcnt lgkmcnt(15)
    v_mfma_f32_16x16x32_bf16 v[56:59], a[16:19], v[88:91], v[56:59]
    ds_read_b32 v154, v33 offset:3072
    ds_read_b32 v155, v33 offset:12352
    v_mfma_f32_16x16x32_bf16 v[60:63], a[48:51], v[88:91], v[60:63]
    ds_read_b32 v156, v33 offset:21632
    ds_read_b32 v157, v33 offset:30912
    s_waitcnt lgkmcnt(15)
    v_mfma_f32_16x16x32_bf16 v[56:59], a[20:23], v[92:95], v[56:59]
    s_waitcnt vmcnt(12)
    v_lshlrev_b32 v158, 16, v186
    v_and_b32 v159, 0xffff0000, v186
    v_mfma_f32_16x16x32_bf16 v[60:63], a[52:55], v[92:95], v[60:63]
    v_lshlrev_b32 v160, 16, v187
    v_and_b32 v161, 0xffff0000, v187
    v_mfma_f32_16x16x32_bf16 v[56:59], a[24:27], v[96:99], v[56:59]
    v_lshlrev_b32 v162, 16, v188
    v_and_b32 v163, 0xffff0000, v188
    v_mfma_f32_16x16x32_bf16 v[60:63], a[56:59], v[96:99], v[60:63]
    v_lshlrev_b32 v164, 16, v189
    global_load_lds_dwordx4 v13, s[68:69] offset:1024
    v_mfma_f32_16x16x32_bf16 v[56:59], a[28:31], v[100:103], v[56:59]
    v_and_b32 v165, 0xffff0000, v189
    v_fma_f32 v166, v158, v202, v203
    v_mfma_f32_16x16x32_bf16 v[60:63], a[60:63], v[100:103], v[60:63]
    v_fma_f32 v167, v159, v202, v203
    v_fma_f32 v168, v160, v202, v203
    v_mfma_f32_16x16x32_bf16 v[60:63], a[0:3], v[104:107], v[60:63]
    global_load_dwordx4 a[236:239], v7, s[18:19] offset:-3072 sc1
    v_fma_f32 v169, v161, v202, v203
    s_waitcnt lgkmcnt(14)
    v_mfma_f32_16x16x32_bf16 v[60:63], a[4:7], v[108:111], v[60:63]
    v_fma_f32 v170, v162, v204, v205
    v_fma_f32 v171, v163, v204, v205
    s_waitcnt lgkmcnt(13)
    v_mfma_f32_16x16x32_bf16 v[60:63], a[8:11], v[112:115], v[60:63]
    v_fma_f32 v172, v164, v204, v205
    v_fma_f32 v173, v165, v204, v205
    s_waitcnt lgkmcnt(12)
    v_mfma_f32_16x16x32_bf16 v[60:63], a[12:15], v[116:119], v[60:63]
    v_fma_f32 v166, v166, s60, v178
    v_fma_f32 v167, v167, s61, v179
    s_waitcnt lgkmcnt(11)
    v_mfma_f32_16x16x32_bf16 v[60:63], a[16:19], v[120:123], v[60:63]
    v_fma_f32 v168, v168, s62, v180
    global_load_lds_dwordx4 v14, s[68:69] offset:2048
    s_waitcnt lgkmcnt(9)
    v_mfma_f32_16x16x32_bf16 v[60:63], a[20:23], v[124:127], v[60:63]
    v_fma_f32 v169, v169, s63, v181
    v_fma_f32 v170, v170, s60, v178
    s_waitcnt lgkmcnt(7)
    v_mfma_f32_16x16x32_bf16 v[60:63], a[24:27], v[128:131], v[60:63]
    v_fma_f32 v171, v171, s61, v179
    v_fma_f32 v172, v172, s62, v180
    s_waitcnt lgkmcnt(5)
    v_mfma_f32_16x16x32_bf16 v[60:63], a[28:31], v[132:135], v[60:63]
    v_fma_f32 v173, v173, s63, v181
    v_lshlrev_b32 v142, 16, v150
    v_mfma_f32_16x16x32_bf16 v[64:67], a[64:67], v[72:75], v[64:67]
    v_and_b32 v146, 0xffff0000, v150
    v_lshlrev_b32 v143, 16, v151
    v_mfma_f32_16x16x32_bf16 v[68:71], a[96:99], v[72:75], v[68:71]
    v_and_b32 v147, 0xffff0000, v151
    v_lshlrev_b32 v144, 16, v152
    v_mfma_f32_16x16x32_bf16 v[64:67], a[68:71], v[76:79], v[64:67]
    v_and_b32 v148, 0xffff0000, v152
    s_waitcnt lgkmcnt(4)
    v_lshlrev_b32 v145, 16, v153
    v_mfma_f32_16x16x32_bf16 v[68:71], a[100:103], v[76:79], v[68:71]
    v_and_b32 v149, 0xffff0000, v153
    global_load_lds_dwordx4 v15, s[68:69] offset:3072
    v_mfma_f32_16x16x32_bf16 v[64:67], a[72:75], v[80:83], v[64:67]
    s_waitcnt lgkmcnt(3)
    v_and_b32 v174, 0xffff0000, v154
    s_waitcnt lgkmcnt(2)
    v_and_b32 v175, 0xffff0000, v155
    v_mfma_f32_16x16x32_bf16 v[68:71], a[104:107], v[80:83], v[68:71]
    s_waitcnt lgkmcnt(1)
    v_and_b32 v176, 0xffff0000, v156
    global_load_dwordx4 a[224:227], v4, s[12:13] offset:-4096 sc1
    v_mfma_f32_16x16x32_bf16 v[64:67], a[76:79], v[84:87], v[64:67]
    s_waitcnt lgkmcnt(0)
    v_and_b32 v177, 0xffff0000, v157
    v_fmac_f32 v142, s52, v174
    v_mfma_f32_16x16x32_bf16 v[68:71], a[108:111], v[84:87], v[68:71]
    v_fmac_f32 v143, s53, v175
    v_fmac_f32 v144, s54, v176
    v_mfma_f32_16x16x32_bf16 v[64:67], a[80:83], v[88:91], v[64:67]
    v_fmac_f32 v145, s55, v177
    v_lshlrev_b32 v174, 16, v154
    v_mfma_f32_16x16x32_bf16 v[68:71], a[112:115], v[88:91], v[68:71]
    v_lshlrev_b32 v175, 16, v155
    v_lshlrev_b32 v176, 16, v156
    v_mfma_f32_16x16x32_bf16 v[64:67], a[84:87], v[92:95], v[64:67]
    v_lshlrev_b32 v177, 16, v157
    v_fmac_f32 v146, s52, v174
    v_mfma_f32_16x16x32_bf16 v[68:71], a[116:119], v[92:95], v[68:71]
    v_fmac_f32 v147, s53, v175
    v_fmac_f32 v148, s54, v176
    v_mfma_f32_16x16x32_bf16 v[64:67], a[88:91], v[96:99], v[64:67]
    v_fmac_f32 v149, s55, v177
    v_fma_f32 v158, v166, v142, v158
    v_mfma_f32_16x16x32_bf16 v[68:71], a[120:123], v[96:99], v[68:71]
    v_fma_f32 v159, v167, v143, v159
    v_fma_f32 v160, v168, v144, v160
    v_mfma_f32_16x16x32_bf16 v[64:67], a[92:95], v[100:103], v[64:67]
    v_fma_f32 v161, v169, v145, v161
    v_fma_f32 v162, v170, v146, v162
    v_mfma_f32_16x16x32_bf16 v[68:71], a[124:127], v[100:103], v[68:71]
    v_fma_f32 v163, v171, v147, v163
    v_fma_f32 v164, v172, v148, v164
    v_mfma_f32_16x16x32_bf16 v[64:67], a[32:35], v[104:107], v[64:67]
    v_fma_f32 v165, v173, v149, v165
    v_cvt_pk_bf16_f32 v186, v158, v159
    v_mfma_f32_16x16x32_bf16 v[68:71], a[64:67], v[104:107], v[68:71]
    v_cvt_pk_bf16_f32 v187, v160, v161
    v_mfma_f32_16x16x32_bf16 v[64:67], a[36:39], v[108:111], v[64:67]
    v_cvt_pk_bf16_f32 v188, v162, v163
    global_load_dwordx4 a[228:231], v7, s[18:19] offset:-4096 sc1
    v_mfma_f32_16x16x32_bf16 v[68:71], a[68:71], v[108:111], v[68:71]
    v_cvt_pk_bf16_f32 v189, v164, v165
    v_or_b32 v189, 1, v189
    v_mfma_f32_16x16x32_bf16 v[64:67], a[40:43], v[112:115], v[64:67]
    v_add_u32 v136, 0, v37
    global_store_dwordx4 v136, v[186:189], s[38:39] sc1
    v_mfma_f32_16x16x32_bf16 v[68:71], a[72:75], v[112:115], v[68:71]
    ds_read_b128 v[72:75], v32 offset:512
    ds_read_b128 v[76:79], v32 offset:576
    v_mfma_f32_16x16x32_bf16 v[64:67], a[44:47], v[116:119], v[64:67]
    v_cvt_pk_bf16_f32 v138, v56, v57
    ds_read_b128 v[80:83], v32 offset:640
    v_mfma_f32_16x16x32_bf16 v[68:71], a[76:79], v[116:119], v[68:71]
    v_cvt_pk_bf16_f32 v139, v58, v59
    ds_read_b128 v[84:87], v32 offset:704
    v_mfma_f32_16x16x32_bf16 v[64:67], a[48:51], v[120:123], v[64:67]
    ds_write2_b32 v34, v138, v139 offset0:0 offset1:2
    ds_read_b128 v[88:91], v32 offset:768
    v_mfma_f32_16x16x32_bf16 v[68:71], a[80:83], v[120:123], v[68:71]
    v_cvt_pk_bf16_f32 v140, v60, v61
    ds_read_b128 v[92:95], v32 offset:832
    v_mfma_f32_16x16x32_bf16 v[64:67], a[52:55], v[124:127], v[64:67]
    v_cvt_pk_bf16_f32 v141, v62, v63
    ds_read_b128 v[96:99], v32 offset:896
    v_mfma_f32_16x16x32_bf16 v[68:71], a[84:87], v[124:127], v[68:71]
    ds_read_b128 v[100:103], v32 offset:960
    ds_write2_b32 v34, v140, v141 offset0:128 offset1:130
    v_mfma_f32_16x16x32_bf16 v[64:67], a[56:59], v[128:131], v[64:67]
    v_add_u32 v34, 4224, v34
    s_waitcnt lgkmcnt(0)
    s_barrier
    v_mfma_f32_16x16x32_bf16 v[68:71], a[88:91], v[128:131], v[68:71]
    v_mfma_f32_16x16x32_bf16 v[64:67], a[60:63], v[132:135], v[64:67]
    v_mfma_f32_16x16x32_bf16 v[68:71], a[92:95], v[132:135], v[68:71]
    global_load_dwordx4 v[218:221], v223, s[38:39] sc1
    global_load_dwordx4 a[216:219], v4, s[10:11] offset:3072 sc1
    ds_read_b128 v[104:107], v32 offset:0
    ds_read_b128 v[108:111], v32 offset:64
    ds_read_b128 v[112:115], v32 offset:128
    ds_read_b128 v[116:119], v32 offset:192
    ds_read_b128 v[120:123], v32 offset:256
    ds_read_b128 v[124:127], v32 offset:320
    ds_read_b128 v[128:131], v32 offset:384
    ds_read_b128 v[132:135], v32 offset:448
    ds_read_b32 v150, v35 offset:4224
    ds_read_b32 v151, v35 offset:5280
    ds_read_b32 v152, v35 offset:6336
    ds_read_b32 v153, v35 offset:7392
    ds_read_b32 v154, v33 offset:2048
    ds_read_b32 v155, v33 offset:11328
    ds_read_b32 v156, v33 offset:20608
    ds_read_b32 v157, v33 offset:29888
    s_waitcnt vmcnt(20)
    v_lshlrev_b32 v158, 16, v190
    global_load_dwordx4 a[220:223], v7, s[16:17] offset:3072 sc1
    v_and_b32 v159, 0xffff0000, v190
    v_lshlrev_b32 v160, 16, v191
    v_and_b32 v161, 0xffff0000, v191
    v_lshlrev_b32 v162, 16, v192
    v_and_b32 v163, 0xffff0000, v192
    v_lshlrev_b32 v164, 16, v193
    v_and_b32 v165, 0xffff0000, v193
    v_pk_fma_f32 v[166:167], v[206:207], v[158:159], v[206:207] op_sel:[0,0,1] op_sel_hi:[0,1,1]
    v_pk_fma_f32 v[168:169], v[206:207], v[160:161], v[206:207] op_sel:[0,0,1] op_sel_hi:[0,1,1]
    v_pk_fma_f32 v[170:171], v[208:209], v[162:163], v[208:209] op_sel:[0,0,1] op_sel_hi:[0,1,1]
    v_pk_fma_f32 v[172:173], v[208:209], v[164:165], v[208:209] op_sel:[0,0,1] op_sel_hi:[0,1,1]
    v_pk_fma_f32 v[166:167], v[166:167], s[60:61], v[178:179] op_sel:[0,0,0] op_sel_hi:[1,1,1]
    v_pk_fma_f32 v[168:169], v[168:169], s[62:63], v[180:181] op_sel:[0,0,0] op_sel_hi:[1,1,1]
    v_pk_fma_f32 v[170:171], v[170:171], s[60:61], v[178:179] op_sel:[0,0,0] op_sel_hi:[1,1,1]
    v_pk_fma_f32 v[172:173], v[172:173], s[62:63], v[180:181] op_sel:[0,0,0] op_sel_hi:[1,1,1]
    s_waitcnt lgkmcnt(7)
    v_lshlrev_b32 v142, 16, v150
    v_and_b32 v146, 0xffff0000, v150
    global_load_dwordx4 a[208:211], v4, s[10:11] offset:2048 sc1
    s_waitcnt lgkmcnt(6)
    v_lshlrev_b32 v143, 16, v151
    v_and_b32 v147, 0xffff0000, v151
    s_waitcnt lgkmcnt(5)
    v_lshlrev_b32 v144, 16, v152
    v_and_b32 v148, 0xffff0000, v152
    s_waitcnt lgkmcnt(4)
    v_lshlrev_b32 v145, 16, v153
    v_and_b32 v149, 0xffff0000, v153
    s_waitcnt lgkmcnt(3)
    v_dot2_f32_bf16 v142, v154, s52, v142
    s_waitcnt lgkmcnt(2)
    v_dot2_f32_bf16 v143, v155, s53, v143
    s_waitcnt lgkmcnt(1)
    v_dot2_f32_bf16 v144, v156, s54, v144
    s_waitcnt lgkmcnt(0)
    v_dot2_f32_bf16 v145, v157, s55, v145
    v_dot2_f32_bf16 v146, v154, s56, v146
    v_dot2_f32_bf16 v147, v155, s57, v147
    v_dot2_f32_bf16 v148, v156, s58, v148
    v_dot2_f32_bf16 v149, v157, s59, v149
    v_pk_fma_f32 v[158:159], v[166:167], v[142:143], v[158:159] op_sel:[0,0,0] op_sel_hi:[1,1,1]
    v_pk_fma_f32 v[160:161], v[168:169], v[144:145], v[160:161] op_sel:[0,0,0] op_sel_hi:[1,1,1]
    v_pk_fma_f32 v[162:163], v[170:171], v[146:147], v[162:163] op_sel:[0,0,0] op_sel_hi:[1,1,1]
    global_load_dwordx4 a[212:215], v7, s[16:17] offset:2048 sc1
    v_pk_fma_f32 v[164:165], v[172:173], v[148:149], v[164:165] op_sel:[0,0,0] op_sel_hi:[1,1,1]
    v_cvt_pk_bf16_f32 v190, v158, v159
    v_cvt_pk_bf16_f32 v191, v160, v161
    v_cvt_pk_bf16_f32 v192, v162, v163
    v_cvt_pk_bf16_f32 v193, v164, v165
    v_or_b32 v193, 1, v193
    v_add_u32 v136, 917504, v37
    global_store_dwordx4 v136, v[190:193], s[38:39] sc1
    ds_read_b32 v150, v35 offset:8448
    ds_read_b32 v151, v35 offset:9504
    ds_read_b32 v152, v35 offset:10560
    ds_read_b32 v153, v35 offset:11616
    ds_read_b32 v154, v33 offset:1024
    ds_read_b32 v155, v33 offset:10304
    ds_read_b32 v156, v33 offset:19584
    ds_read_b32 v157, v33 offset:28864
    s_waitcnt vmcnt(23)
    v_lshlrev_b32 v158, 16, v194
    v_and_b32 v159, 0xffff0000, v194
    global_load_dwordx4 a[200:203], v4, s[10:11] offset:1024 sc1
    v_lshlrev_b32 v160, 16, v195
    v_and_b32 v161, 0xffff0000, v195
    v_lshlrev_b32 v162, 16, v196
    v_and_b32 v163, 0xffff0000, v196
    v_lshlrev_b32 v164, 16, v197
    v_and_b32 v165, 0xffff0000, v197
    v_pk_fma_f32 v[166:167], v[210:211], v[158:159], v[210:211] op_sel:[0,0,1] op_sel_hi:[0,1,1]
    v_pk_fma_f32 v[168:169], v[210:211], v[160:161], v[210:211] op_sel:[0,0,1] op_sel_hi:[0,1,1]
    v_pk_fma_f32 v[170:171], v[212:213], v[162:163], v[212:213] op_sel:[0,0,1] op_sel_hi:[0,1,1]
    v_pk_fma_f32 v[172:173], v[212:213], v[164:165], v[212:213] op_sel:[0,0,1] op_sel_hi:[0,1,1]
    v_pk_fma_f32 v[166:167], v[166:167], s[60:61], v[178:179] op_sel:[0,0,0] op_sel_hi:[1,1,1]
    v_pk_fma_f32 v[168:169], v[168:169], s[62:63], v[180:181] op_sel:[0,0,0] op_sel_hi:[1,1,1]
    v_pk_fma_f32 v[170:171], v[170:171], s[60:61], v[178:179] op_sel:[0,0,0] op_sel_hi:[1,1,1]
    v_pk_fma_f32 v[172:173], v[172:173], s[62:63], v[180:181] op_sel:[0,0,0] op_sel_hi:[1,1,1]
    s_waitcnt lgkmcnt(7)
    v_lshlrev_b32 v142, 16, v150
    v_and_b32 v146, 0xffff0000, v150
    s_waitcnt lgkmcnt(6)
    v_lshlrev_b32 v143, 16, v151
    global_load_dwordx4 a[204:207], v7, s[16:17] offset:1024 sc1
    v_and_b32 v147, 0xffff0000, v151
    s_waitcnt lgkmcnt(5)
    v_lshlrev_b32 v144, 16, v152
    v_and_b32 v148, 0xffff0000, v152
    s_waitcnt lgkmcnt(4)
    v_lshlrev_b32 v145, 16, v153
    v_and_b32 v149, 0xffff0000, v153
    s_waitcnt lgkmcnt(3)
    v_dot2_f32_bf16 v142, v154, s52, v142
    s_waitcnt lgkmcnt(2)
    v_dot2_f32_bf16 v143, v155, s53, v143
    s_waitcnt lgkmcnt(1)
    v_dot2_f32_bf16 v144, v156, s54, v144
    s_waitcnt lgkmcnt(0)
    v_dot2_f32_bf16 v145, v157, s55, v145
    v_dot2_f32_bf16 v146, v154, s56, v146
    v_dot2_f32_bf16 v147, v155, s57, v147
    v_dot2_f32_bf16 v148, v156, s58, v148
    v_dot2_f32_bf16 v149, v157, s59, v149
    v_pk_fma_f32 v[158:159], v[166:167], v[142:143], v[158:159] op_sel:[0,0,0] op_sel_hi:[1,1,1]
    v_pk_fma_f32 v[160:161], v[168:169], v[144:145], v[160:161] op_sel:[0,0,0] op_sel_hi:[1,1,1]
    v_pk_fma_f32 v[162:163], v[170:171], v[146:147], v[162:163] op_sel:[0,0,0] op_sel_hi:[1,1,1]
    v_pk_fma_f32 v[164:165], v[172:173], v[148:149], v[164:165] op_sel:[0,0,0] op_sel_hi:[1,1,1]
    global_load_dwordx4 a[192:195], v4, s[10:11] offset:0 sc1
    v_cvt_pk_bf16_f32 v194, v158, v159
    v_cvt_pk_bf16_f32 v195, v160, v161
    v_cvt_pk_bf16_f32 v196, v162, v163
    v_cvt_pk_bf16_f32 v197, v164, v165
    v_or_b32 v197, 1, v197
    v_add_u32 v136, 1835008, v37
    global_store_dwordx4 v136, v[194:197], s[38:39] sc1
    v_mfma_f32_16x16x32_bf16 v[64:67], a[0:3], v[72:75], v[64:67]
    v_mfma_f32_16x16x32_bf16 v[68:71], a[32:35], v[72:75], v[68:71]
    v_mfma_f32_16x16x32_bf16 v[64:67], a[4:7], v[76:79], v[64:67]
    v_mfma_f32_16x16x32_bf16 v[68:71], a[36:39], v[76:79], v[68:71]
    v_mfma_f32_16x16x32_bf16 v[64:67], a[8:11], v[80:83], v[64:67]
    v_mfma_f32_16x16x32_bf16 v[68:71], a[40:43], v[80:83], v[68:71]
    v_mfma_f32_16x16x32_bf16 v[64:67], a[12:15], v[84:87], v[64:67]
    v_mfma_f32_16x16x32_bf16 v[68:71], a[44:47], v[84:87], v[68:71]
    v_mfma_f32_16x16x32_bf16 v[64:67], a[16:19], v[88:91], v[64:67]
    v_mfma_f32_16x16x32_bf16 v[68:71], a[48:51], v[88:91], v[68:71]
    v_mfma_f32_16x16x32_bf16 v[64:67], a[20:23], v[92:95], v[64:67]
    global_load_dwordx4 a[196:199], v7, s[16:17] offset:0 sc1
    v_mfma_f32_16x16x32_bf16 v[68:71], a[52:55], v[92:95], v[68:71]
    v_mfma_f32_16x16x32_bf16 v[64:67], a[24:27], v[96:99], v[64:67]
    v_mfma_f32_16x16x32_bf16 v[68:71], a[56:59], v[96:99], v[68:71]
    v_mfma_f32_16x16x32_bf16 v[64:67], a[28:31], v[100:103], v[64:67]
    v_mfma_f32_16x16x32_bf16 v[68:71], a[60:63], v[100:103], v[68:71]
    v_mfma_f32_16x16x32_bf16 v[68:71], a[0:3], v[104:107], v[68:71]
    v_mfma_f32_16x16x32_bf16 v[68:71], a[4:7], v[108:111], v[68:71]
    v_mfma_f32_16x16x32_bf16 v[68:71], a[8:11], v[112:115], v[68:71]
    v_mfma_f32_16x16x32_bf16 v[68:71], a[12:15], v[116:119], v[68:71]
    v_mfma_f32_16x16x32_bf16 v[68:71], a[16:19], v[120:123], v[68:71]
    v_mfma_f32_16x16x32_bf16 v[68:71], a[20:23], v[124:127], v[68:71]
    v_mfma_f32_16x16x32_bf16 v[68:71], a[24:27], v[128:131], v[68:71]
    v_mfma_f32_16x16x32_bf16 v[68:71], a[28:31], v[132:135], v[68:71]
    v_cvt_pk_bf16_f32 v138, v64, v65
    v_cvt_pk_bf16_f32 v139, v66, v67
    ds_write2_b32 v34, v138, v139 offset0:0 offset1:2
    s_nop 4
    v_cvt_pk_bf16_f32 v140, v68, v69
    global_load_dwordx4 a[184:187], v4, s[10:11] offset:-1024 sc1
    v_cvt_pk_bf16_f32 v141, v70, v71
    ds_write2_b32 v34, v140, v141 offset0:128 offset1:130
    s_waitcnt lgkmcnt(0)
    s_barrier
    ds_read_b32 v150, v35 offset:12672
    ds_read_b32 v151, v35 offset:13728
    ds_read_b32 v152, v35 offset:14784
    ds_read_b32 v153, v35 offset:15840
    ds_read_b32 v154, v33 offset:0
    ds_read_b32 v155, v33 offset:9280
    ds_read_b32 v156, v33 offset:18560
    ds_read_b32 v157, v33 offset:27840
    s_waitcnt vmcnt(28)
    v_lshlrev_b32 v158, 16, v198
    v_and_b32 v159, 0xffff0000, v198
    v_lshlrev_b32 v160, 16, v199
    v_and_b32 v161, 0xffff0000, v199
    v_lshlrev_b32 v162, 16, v200
    global_load_dwordx4 a[188:191], v7, s[16:17] offset:-1024 sc1
    v_and_b32 v163, 0xffff0000, v200
    v_lshlrev_b32 v164, 16, v201
    v_and_b32 v165, 0xffff0000, v201
    v_pk_fma_f32 v[166:167], v[214:215], v[158:159], v[214:215] op_sel:[0,0,1] op_sel_hi:[0,1,1]
    v_pk_fma_f32 v[168:169], v[214:215], v[160:161], v[214:215] op_sel:[0,0,1] op_sel_hi:[0,1,1]
    v_pk_fma_f32 v[170:171], v[216:217], v[162:163], v[216:217] op_sel:[0,0,1] op_sel_hi:[0,1,1]
    v_pk_fma_f32 v[172:173], v[216:217], v[164:165], v[216:217] op_sel:[0,0,1] op_sel_hi:[0,1,1]
    v_pk_fma_f32 v[166:167], v[166:167], s[60:61], v[178:179] op_sel:[0,0,0] op_sel_hi:[1,1,1]
    v_pk_fma_f32 v[168:169], v[168:169], s[62:63], v[180:181] op_sel:[0,0,0] op_sel_hi:[1,1,1]
    v_pk_fma_f32 v[170:171], v[170:171], s[60:61], v[178:179] op_sel:[0,0,0] op_sel_hi:[1,1,1]
    v_pk_fma_f32 v[172:173], v[172:173], s[62:63], v[180:181] op_sel:[0,0,0] op_sel_hi:[1,1,1]
    s_waitcnt lgkmcnt(7)
    v_lshlrev_b32 v142, 16, v150
    v_and_b32 v146, 0xffff0000, v150
    s_waitcnt lgkmcnt(6)
    v_lshlrev_b32 v143, 16, v151
    v_and_b32 v147, 0xffff0000, v151
    s_waitcnt lgkmcnt(5)
    v_lshlrev_b32 v144, 16, v152
    v_and_b32 v148, 0xffff0000, v152
    s_waitcnt lgkmcnt(4)
    v_lshlrev_b32 v145, 16, v153
    v_and_b32 v149, 0xffff0000, v153
    s_waitcnt lgkmcnt(3)
    v_dot2_f32_bf16 v142, v154, s52, v142
    s_waitcnt lgkmcnt(2)
    v_dot2_f32_bf16 v143, v155, s53, v143
    s_waitcnt lgkmcnt(1)
    v_dot2_f32_bf16 v144, v156, s54, v144
    s_waitcnt lgkmcnt(0)
    v_dot2_f32_bf16 v145, v157, s55, v145
    v_dot2_f32_bf16 v146, v154, s56, v146
    v_dot2_f32_bf16 v147, v155, s57, v147
    v_dot2_f32_bf16 v148, v156, s58, v148
    v_dot2_f32_bf16 v149, v157, s59, v149
    v_pk_fma_f32 v[158:159], v[166:167], v[142:143], v[158:159] op_sel:[0,0,0] op_sel_hi:[1,1,1]
    v_pk_fma_f32 v[160:161], v[168:169], v[144:145], v[160:161] op_sel:[0,0,0] op_sel_hi:[1,1,1]
    v_pk_fma_f32 v[162:163], v[170:171], v[146:147], v[162:163] op_sel:[0,0,0] op_sel_hi:[1,1,1]
    v_pk_fma_f32 v[164:165], v[172:173], v[148:149], v[164:165] op_sel:[0,0,0] op_sel_hi:[1,1,1]
    v_cvt_pk_bf16_f32 v198, v158, v159
    v_cvt_pk_bf16_f32 v199, v160, v161
    v_cvt_pk_bf16_f32 v200, v162, v163
    v_cvt_pk_bf16_f32 v201, v164, v165
    v_or_b32 v201, 1, v201
    v_add_u32 v136, 2752512, v37
    global_store_dwordx4 v136, v[198:201], s[38:39] sc1
    s_waitcnt lgkmcnt(0)
    s_barrier
    s_waitcnt vmcnt(13)
    v_max_u32 v224, v218, v219
    v_max3_u32 v224, v220, v221, v224
    v_cmp_eq_u32 vcc, -1, v224
    s_nop 0
    s_cbranch_vccnz Lcv_r
Lcv_ok:
    v_permlane32_swap_b32 v218, v220
    v_permlane32_swap_b32 v219, v221
    s_lshl_b32 s4, s3, 9
    s_add_u32 s4, s4, 156672
    v_and_b32 v223, 496, v4
    v_add_f32 v218, v218, v220
    v_add_f32 v219, v219, v221
    v_bfe_u32 v220, v1, 3, 1
    v_cmp_gt_u32 vcc, s101, v220
    v_lshrrev_b32 v220, 5, v1
    v_lshl_add_u32 v223, v220, 3, v223
    v_cndmask_b32 v218, 0, v218, vcc
    v_cndmask_b32 v219, 0, v219, vcc
    v_add_u32 v223, s4, v223
    ds_write_b64 v223, v[218:219]
    global_load_dwordx4 a[176:179], v4, s[10:11] offset:-2048 sc1
    global_load_dwordx4 a[180:183], v7, s[16:17] offset:-2048 sc1
    global_load_dwordx4 a[168:171], v4, s[10:11] offset:-3072 sc1
    global_load_dwordx4 a[172:175], v7, s[16:17] offset:-3072 sc1
    global_load_dwordx4 a[160:163], v4, s[10:11] offset:-4096 sc1
    global_load_dwordx4 a[164:167], v7, s[16:17] offset:-4096 sc1
    global_load_dwordx4 a[152:155], v4, s[8:9] offset:3072 sc1
    global_load_dwordx4 a[156:159], v7, s[14:15] offset:3072 sc1
    global_load_dwordx4 a[144:147], v4, s[8:9] offset:2048 sc1
    global_load_dwordx4 a[148:151], v7, s[14:15] offset:2048 sc1
    global_load_dwordx4 a[136:139], v4, s[8:9] offset:1024 sc1
    global_load_dwordx4 a[140:143], v7, s[14:15] offset:1024 sc1
    global_load_dwordx4 a[128:131], v4, s[8:9] offset:0 sc1
    global_load_dwordx4 a[132:135], v7, s[14:15] offset:0 sc1
Ljoin:
    v_and_b32 v28, 7, v1
    v_lshl_add_u32 v28, v3, 3, v28
    v_bfe_u32 v29, v1, 3, 1
    v_lshlrev_b32 v66, 9, v29
    v_lshl_add_u32 v66, v28, 4, v66
    s_mul_i32 s4, s3, 20480
    s_mul_i32 s5, s40, 114688
    s_add_u32 s4, s4, s5
    s_add_u32 s4, s4, 1048576
    v_add_u32 v66, s4, v66
    v_lshl_add_u32 v70, v28, 1, v29
    v_min_u32 v72, 9, v1
    v_lshl_add_u32 v72, v72, 11, s4
    s_bfe_u32 s6, s2, 0x30003
    v_mul_u32_u24 v254, 8, v0
    v_add_lshl_u32 v254, v254, s6, 7
    v_min_u32 v254, (Lmid-Lx_go-4), v254
    v_add_u32 v254, (Lx_go-adaLN_cond__ssm_conv_h3__mixer_gmlp__prompt_kernel), v254
    global_load_dword v254, v254, s[0:1]
    s_cmp_lt_u32 s43, 4
    s_cbranch_scc1 Lx_first
Lx_redo:
    s_branch Lxp_f
Lxp:
    s_sleep 1
Lxp_f:
    global_load_dword v71, v72, s[38:39] offset:508 sc1
    s_waitcnt vmcnt(0)
    v_and_b32 v71, 1, v71
    v_cmp_ne_u32 vcc, 1, v71
    s_add_u32 s100, s100, 1
    s_cmp_ge_u32 s100, 262144
    s_cbranch_scc1 Lxp_x
    s_cbranch_vccnz Lxp
Lxp_x:
Lx_first:
    s_mov_b32 s7, 0x3f803f80
    v_add_u32 v67, 4096, v66
    global_load_dwordx4 v[98:101], v67, s[38:39] offset:-4096 sc1
    global_load_dwordx4 v[102:105], v67, s[38:39] offset:-3072 sc1
    global_load_dwordx4 v[106:109], v67, s[38:39] offset:-2048 sc1
    global_load_dwordx4 v[110:113], v67, s[38:39] offset:-1024 sc1
    global_load_dwordx4 v[114:117], v67, s[38:39] offset:0 sc1
    global_load_dwordx4 v[118:121], v67, s[38:39] offset:1024 sc1
    global_load_dwordx4 v[122:125], v67, s[38:39] offset:2048 sc1
    global_load_dwordx4 v[126:129], v67, s[38:39] offset:3072 sc1
    v_add_u32 v67, 8192, v67
    global_load_dwordx4 v[130:133], v67, s[38:39] offset:-4096 sc1
    global_load_dwordx4 v[134:137], v67, s[38:39] offset:-3072 sc1
    v_lshrrev_b32 v28, 5, v1
    v_bfe_u32 v68, v1, 1, 1
    v_lshl_add_u32 v28, v28, 1, v68
    v_mul_u32_u24 v68, 1040, v28
    v_bfe_u32 v28, v1, 3, 1
    v_lshl_add_u32 v68, v28, 3, v68
    v_bfe_u32 v28, v1, 2, 1
    v_lshl_add_u32 v68, v28, 6, v68
    v_bfe_u32 v28, v1, 4, 1
    v_lshl_add_u32 v68, v28, 7, v68
    v_bfe_u32 v28, v1, 0, 1
    v_lshl_add_u32 v68, v28, 5, v68
    s_mul_i32 s5, s3, 20800
    v_add_u32 v68, s5, v68
    v_lshlrev_b32 v30, 3, v1
    s_lshl_b32 s88, s3, 9
    v_lshrrev_b32 v28, 3, v1
    v_lshlrev_b32 v28, 12, v28
    v_bfe_u32 v29, v1, 4, 1
    v_xor_b32 v29, v29, v1
    v_and_b32 v29, 7, v29
    v_xor_b32 v74, 0, v29
    v_lshl_add_u32 v74, v74, 4, v28
    v_add_u32 v78, 131072, v74
    v_xor_b32 v75, 2, v29
    v_lshl_add_u32 v75, v75, 4, v28
    v_add_u32 v75, 31744, v75
    v_add_u32 v79, 131072, v75
    v_xor_b32 v76, 4, v29
    v_lshl_add_u32 v76, v76, 4, v28
    v_add_u32 v76, 63488, v76
    v_add_u32 v80, 131072, v76
    v_xor_b32 v77, 6, v29
    v_lshl_add_u32 v77, v77, 4, v28
    v_add_u32 v77, 95232, v77
    v_add_u32 v81, 131072, v77
    v_lshrrev_b32 v29, 1, v2
    v_xor_b32 v29, v29, v3
    v_lshlrev_b32 v29, 4, v29
    v_lshl_add_u32 v29, v5, 7, v29
    s_xor_b32 s4, s3, 0
    s_lshr_b32 s5, s4, 1
    s_lshl_b32 s5, s5, 12
    s_and_b32 s4, s4, 1
    s_lshl_b32 s4, s4, 9
    s_add_u32 s4, s4, s5
    s_add_u32 s4, s4, s89
    v_add_u32 v82, s4, v29
    v_xor_b32 v83, 64, v82
    s_xor_b32 s4, s3, 1
    s_lshr_b32 s5, s4, 1
    s_lshl_b32 s5, s5, 12
    s_and_b32 s4, s4, 1
    s_lshl_b32 s4, s4, 9
    s_add_u32 s4, s4, s5
    s_add_u32 s4, s4, s89
    v_add_u32 v84, s4, v29
    v_xor_b32 v85, 64, v84
    s_xor_b32 s4, s3, 2
    s_lshr_b32 s5, s4, 1
    s_lshl_b32 s5, s5, 12
    s_and_b32 s4, s4, 1
    s_lshl_b32 s4, s4, 9
    s_add_u32 s4, s4, s5
    s_add_u32 s4, s4, s89
    v_add_u32 v86, s4, v29
    v_xor_b32 v87, 64, v86
    s_xor_b32 s4, s3, 3
    s_lshr_b32 s5, s4, 1
    s_lshl_b32 s5, s5, 12
    s_and_b32 s4, s4, 1
    s_lshl_b32 s4, s4, 9
    s_add_u32 s4, s4, s5
    s_add_u32 s4, s4, s89
    v_add_u32 v88, s4, v29
    v_xor_b32 v89, 64, v88
    s_add_u32 s52, s8, 1146880
    s_addc_u32 s53, s9, 0
    s_add_u32 s54, s10, 1146880
    s_addc_u32 s55, s11, 0
    s_add_u32 s56, s12, 1146880
    s_addc_u32 s57, s13, 0
    s_add_u32 s58, s14, 1146880
    s_addc_u32 s59, s15, 0
    s_add_u32 s60, s16, 1146880
    s_addc_u32 s61, s17, 0
    s_add_u32 s62, s18, 1146880
    s_addc_u32 s63, s19, 0
    s_mov_b32 s84, 0xc0135761
    s_mov_b32 s85, 0xbdd2d3e8
    v_lshlrev_b32 v32, 16, v27
    v_lshlrev_b32 v33, 16, v27
    v_lshlrev_b32 v34, 16, v27
    v_lshlrev_b32 v35, 16, v27
    s_mul_i32 s5, s41, 10
    s_mul_i32 s6, s3, 1040
    v_add_u32 v28, s5, v3
    v_lshrrev_b32 v29, 2, v28
    v_mul_u32_u24 v29, 3136, v29
    v_lshl_add_u32 v29, v28, 8, v29
    v_lshl_add_u32 v29, v2, 4, v29
    v_add_u32 v46, s6, v29
    v_lshrrev_b32 v28, 1, v3
    v_add_u32 v28, s5, v28
    v_lshrrev_b32 v29, 2, v28
    v_mul_u32_u24 v29, 3136, v29
    v_lshl_add_u32 v29, v28, 8, v29
    v_lshl_add_u32 v29, v2, 4, v29
    v_add_u32 v47, s6, v29
    v_and_b32 v28, 1, v3
    v_lshl_add_u32 v47, v28, 3, v47
    v_mov_b32 v62, 0
    v_mov_b32 v63, 0
    v_mov_b32 v64, 0
    v_mov_b32 v65, 0
    v_mov_b32 v71, -1
    global_load_dwordx4 v[138:141], v67, s[38:39] offset:-2048 sc1
    v_add_u32 v69, 0, v68
    s_waitcnt vmcnt(10)
    ds_write2_b64 v69, v[98:99], v[100:101] offset0:0 offset1:2
    v_dot2_f32_bf16 v62, v98, s7, v62
    v_dot2_f32_bf16 v63, v98, v98, v63
    v_dot2_f32_bf16 v64, v100, s7, v64
    v_dot2_f32_bf16 v65, v100, v100, v65
    v_dot2_f32_bf16 v62, v99, s7, v62
    v_dot2_f32_bf16 v63, v99, v99, v63
    v_dot2_f32_bf16 v64, v101, s7, v64
    v_dot2_f32_bf16 v65, v101, v101, v65
    global_load_dwordx4 v[142:145], v67, s[38:39] offset:-1024 sc1
    s_waitcnt vmcnt(10)
    ds_write2_b64 v69, v[102:103], v[104:105] offset0:32 offset1:34
    v_bitop3_b32 v71, v101, v105, v71 bitop3:0x80
    v_dot2_f32_bf16 v62, v102, s7, v62
    v_dot2_f32_bf16 v63, v102, v102, v63
    v_dot2_f32_bf16 v64, v104, s7, v64
    v_dot2_f32_bf16 v65, v104, v104, v65
    v_dot2_f32_bf16 v62, v103, s7, v62
    v_dot2_f32_bf16 v63, v103, v103, v63
    v_dot2_f32_bf16 v64, v105, s7, v64
    v_dot2_f32_bf16 v65, v105, v105, v65
    global_load_dwordx4 v[146:149], v67, s[38:39] offset:0 sc1
    s_waitcnt vmcnt(10)
    ds_write2_b64 v69, v[106:107], v[108:109] offset0:64 offset1:66
    v_dot2_f32_bf16 v62, v106, s7, v62
    v_dot2_f32_bf16 v63, v106, v106, v63
    v_dot2_f32_bf16 v64, v108, s7, v64
    v_dot2_f32_bf16 v65, v108, v108, v65
    v_dot2_f32_bf16 v62, v107, s7, v62
    v_dot2_f32_bf16 v63, v107, v107, v63
    v_dot2_f32_bf16 v64, v109, s7, v64
    v_dot2_f32_bf16 v65, v109, v109, v65
    global_load_dwordx4 v[150:153], v67, s[38:39] offset:1024 sc1
    s_waitcnt vmcnt(10)
    ds_write2_b64 v69, v[110:111], v[112:113] offset0:96 offset1:98
    v_bitop3_b32 v71, v109, v113, v71 bitop3:0x80
    v_dot2_f32_bf16 v62, v110, s7, v62
    v_dot2_f32_bf16 v63, v110, v110, v63
    v_dot2_f32_bf16 v64, v112, s7, v64
    v_dot2_f32_bf16 v65, v112, v112, v65
    v_dot2_f32_bf16 v62, v111, s7, v62
    v_dot2_f32_bf16 v63, v111, v111, v63
    v_dot2_f32_bf16 v64, v113, s7, v64
    v_dot2_f32_bf16 v65, v113, v113, v65
    global_load_dwordx4 v[154:157], v67, s[38:39] offset:2048 sc1
    v_add_u32 v69, 4160, v68
    s_waitcnt vmcnt(10)
    ds_write2_b64 v69, v[114:115], v[116:117] offset0:0 offset1:2
    v_dot2_f32_bf16 v62, v114, s7, v62
    v_dot2_f32_bf16 v63, v114, v114, v63
    v_dot2_f32_bf16 v64, v116, s7, v64
    v_dot2_f32_bf16 v65, v116, v116, v65
    v_dot2_f32_bf16 v62, v115, s7, v62
    v_dot2_f32_bf16 v63, v115, v115, v63
    v_dot2_f32_bf16 v64, v117, s7, v64
    v_dot2_f32_bf16 v65, v117, v117, v65
    global_load_dwordx4 v[158:161], v67, s[38:39] offset:3072 sc1
    v_add_u32 v67, 8192, v67
    s_waitcnt vmcnt(10)
    ds_write2_b64 v69, v[118:119], v[120:121] offset0:32 offset1:34
    v_bitop3_b32 v71, v117, v121, v71 bitop3:0x80
    v_dot2_f32_bf16 v62, v118, s7, v62
    v_dot2_f32_bf16 v63, v118, v118, v63
    v_dot2_f32_bf16 v64, v120, s7, v64
    v_dot2_f32_bf16 v65, v120, v120, v65
    v_dot2_f32_bf16 v62, v119, s7, v62
    v_dot2_f32_bf16 v63, v119, v119, v63
    v_dot2_f32_bf16 v64, v121, s7, v64
    v_dot2_f32_bf16 v65, v121, v121, v65
    global_load_dwordx4 v[162:165], v67, s[38:39] offset:-4096 sc1
    s_waitcnt vmcnt(10)
    ds_write2_b64 v69, v[122:123], v[124:125] offset0:64 offset1:66
    v_dot2_f32_bf16 v62, v122, s7, v62
    v_dot2_f32_bf16 v63, v122, v122, v63
    v_dot2_f32_bf16 v64, v124, s7, v64
    v_dot2_f32_bf16 v65, v124, v124, v65
    v_dot2_f32_bf16 v62, v123, s7, v62
    v_dot2_f32_bf16 v63, v123, v123, v63
    v_dot2_f32_bf16 v64, v125, s7, v64
    v_dot2_f32_bf16 v65, v125, v125, v65
    global_load_dwordx4 v[166:169], v67, s[38:39] offset:-3072 sc1
    s_waitcnt vmcnt(10)
    ds_write2_b64 v69, v[126:127], v[128:129] offset0:96 offset1:98
    v_bitop3_b32 v71, v125, v129, v71 bitop3:0x80
    v_dot2_f32_bf16 v62, v126, s7, v62
    v_dot2_f32_bf16 v63, v126, v126, v63
    v_dot2_f32_bf16 v64, v128, s7, v64
    v_dot2_f32_bf16 v65, v128, v128, v65
    v_dot2_f32_bf16 v62, v127, s7, v62
    v_dot2_f32_bf16 v63, v127, v127, v63
    v_dot2_f32_bf16 v64, v129, s7, v64
    v_dot2_f32_bf16 v65, v129, v129, v65
    global_load_dwordx4 v[170:173], v67, s[38:39] offset:-2048 sc1
    v_add_u32 v69, 8320, v68
    s_waitcnt vmcnt(10)
    ds_write2_b64 v69, v[130:131], v[132:133] offset0:0 offset1:2
    v_dot2_f32_bf16 v62, v130, s7, v62
    v_dot2_f32_bf16 v63, v130, v130, v63
    v_dot2_f32_bf16 v64, v132, s7, v64
    v_dot2_f32_bf16 v65, v132, v132, v65
    v_dot2_f32_bf16 v62, v131, s7, v62
    v_dot2_f32_bf16 v63, v131, v131, v63
    v_dot2_f32_bf16 v64, v133, s7, v64
    v_dot2_f32_bf16 v65, v133, v133, v65
    global_load_dwordx4 v[174:177], v67, s[38:39] offset:-1024 sc1
    s_waitcnt vmcnt(10)
    ds_write2_b64 v69, v[134:135], v[136:137] offset0:32 offset1:34
    v_bitop3_b32 v71, v133, v137, v71 bitop3:0x80
    v_dot2_f32_bf16 v62, v134, s7, v62
    v_dot2_f32_bf16 v63, v134, v134, v63
    v_dot2_f32_bf16 v64, v136, s7, v64
    v_dot2_f32_bf16 v65, v136, v136, v65
    v_dot2_f32_bf16 v62, v135, s7, v62
    v_dot2_f32_bf16 v63, v135, v135, v63
    v_dot2_f32_bf16 v64, v137, s7, v64
    v_dot2_f32_bf16 v65, v137, v137, v65
    global_load_dwordx4 a[96:99], v4, s[8:9] offset:-4096 sc1
    s_waitcnt vmcnt(10)
    ds_write2_b64 v69, v[138:139], v[140:141] offset0:64 offset1:66
    v_dot2_f32_bf16 v62, v138, s7, v62
    v_dot2_f32_bf16 v63, v138, v138, v63
    v_dot2_f32_bf16 v64, v140, s7, v64
    v_dot2_f32_bf16 v65, v140, v140, v65
    v_dot2_f32_bf16 v62, v139, s7, v62
    v_dot2_f32_bf16 v63, v139, v139, v63
    v_dot2_f32_bf16 v64, v141, s7, v64
    v_dot2_f32_bf16 v65, v141, v141, v65
    global_load_dwordx4 a[100:103], v7, s[14:15] offset:-4096 sc1
    s_waitcnt vmcnt(10)
    ds_write2_b64 v69, v[142:143], v[144:145] offset0:96 offset1:98
    v_bitop3_b32 v71, v141, v145, v71 bitop3:0x80
    v_dot2_f32_bf16 v62, v142, s7, v62
    v_dot2_f32_bf16 v63, v142, v142, v63
    v_dot2_f32_bf16 v64, v144, s7, v64
    v_dot2_f32_bf16 v65, v144, v144, v65
    v_dot2_f32_bf16 v62, v143, s7, v62
    v_dot2_f32_bf16 v63, v143, v143, v63
    v_dot2_f32_bf16 v64, v145, s7, v64
    v_dot2_f32_bf16 v65, v145, v145, v65
    global_load_dwordx4 a[104:107], v4, s[8:9] offset:-3072 sc1
    v_add_u32 v69, 12480, v68
    s_waitcnt vmcnt(10)
    ds_write2_b64 v69, v[146:147], v[148:149] offset0:0 offset1:2
    v_dot2_f32_bf16 v62, v146, s7, v62
    v_dot2_f32_bf16 v63, v146, v146, v63
    v_dot2_f32_bf16 v64, v148, s7, v64
    v_dot2_f32_bf16 v65, v148, v148, v65
    v_dot2_f32_bf16 v62, v147, s7, v62
    v_dot2_f32_bf16 v63, v147, v147, v63
    v_dot2_f32_bf16 v64, v149, s7, v64
    v_dot2_f32_bf16 v65, v149, v149, v65
    global_load_dwordx4 a[108:111], v7, s[14:15] offset:-3072 sc1
    s_waitcnt vmcnt(10)
    ds_write2_b64 v69, v[150:151], v[152:153] offset0:32 offset1:34
    v_bitop3_b32 v71, v149, v153, v71 bitop3:0x80
    v_dot2_f32_bf16 v62, v150, s7, v62
    v_dot2_f32_bf16 v63, v150, v150, v63
    v_dot2_f32_bf16 v64, v152, s7, v64
    v_dot2_f32_bf16 v65, v152, v152, v65
    v_dot2_f32_bf16 v62, v151, s7, v62
    v_dot2_f32_bf16 v63, v151, v151, v63
    v_dot2_f32_bf16 v64, v153, s7, v64
    v_dot2_f32_bf16 v65, v153, v153, v65
    global_load_dwordx4 a[112:115], v4, s[8:9] offset:-2048 sc1
    s_waitcnt vmcnt(10)
    ds_write2_b64 v69, v[154:155], v[156:157] offset0:64 offset1:66
    v_dot2_f32_bf16 v62, v154, s7, v62
    v_dot2_f32_bf16 v63, v154, v154, v63
    v_dot2_f32_bf16 v64, v156, s7, v64
    v_dot2_f32_bf16 v65, v156, v156, v65
    v_dot2_f32_bf16 v62, v155, s7, v62
    v_dot2_f32_bf16 v63, v155, v155, v63
    v_dot2_f32_bf16 v64, v157, s7, v64
    v_dot2_f32_bf16 v65, v157, v157, v65
    global_load_dwordx4 a[116:119], v7, s[14:15] offset:-2048 sc1
    s_waitcnt vmcnt(10)
    ds_write2_b64 v69, v[158:159], v[160:161] offset0:96 offset1:98
    v_bitop3_b32 v71, v157, v161, v71 bitop3:0x80
    v_dot2_f32_bf16 v62, v158, s7, v62
    v_dot2_f32_bf16 v63, v158, v158, v63
    v_dot2_f32_bf16 v64, v160, s7, v64
    v_dot2_f32_bf16 v65, v160, v160, v65
    v_dot2_f32_bf16 v62, v159, s7, v62
    v_dot2_f32_bf16 v63, v159, v159, v63
    v_dot2_f32_bf16 v64, v161, s7, v64
    v_dot2_f32_bf16 v65, v161, v161, v65
    global_load_dwordx4 a[120:123], v4, s[8:9] offset:-1024 sc1
    v_add_u32 v69, 16640, v68
    s_waitcnt vmcnt(10)
    ds_write2_b64 v69, v[162:163], v[164:165] offset0:0 offset1:2
    v_dot2_f32_bf16 v62, v162, s7, v62
    v_dot2_f32_bf16 v63, v162, v162, v63
    v_dot2_f32_bf16 v64, v164, s7, v64
    v_dot2_f32_bf16 v65, v164, v164, v65
    v_dot2_f32_bf16 v62, v163, s7, v62
    v_dot2_f32_bf16 v63, v163, v163, v63
    v_dot2_f32_bf16 v64, v165, s7, v64
    v_dot2_f32_bf16 v65, v165, v165, v65
    global_load_dwordx4 a[124:127], v7, s[14:15] offset:-1024 sc1
    s_waitcnt vmcnt(10)
    ds_write2_b64 v69, v[166:167], v[168:169] offset0:32 offset1:34
    v_bitop3_b32 v71, v165, v169, v71 bitop3:0x80
    v_dot2_f32_bf16 v62, v166, s7, v62
    v_dot2_f32_bf16 v63, v166, v166, v63
    v_dot2_f32_bf16 v64, v168, s7, v64
    v_dot2_f32_bf16 v65, v168, v168, v65
    v_dot2_f32_bf16 v62, v167, s7, v62
    v_dot2_f32_bf16 v63, v167, v167, v63
    v_dot2_f32_bf16 v64, v169, s7, v64
    v_dot2_f32_bf16 v65, v169, v169, v65
    s_waitcnt vmcnt(9)
    ds_write2_b64 v69, v[170:171], v[172:173] offset0:64 offset1:66
    v_dot2_f32_bf16 v62, v170, s7, v62
    v_dot2_f32_bf16 v63, v170, v170, v63
    v_dot2_f32_bf16 v64, v172, s7, v64
    v_dot2_f32_bf16 v65, v172, v172, v65
    v_dot2_f32_bf16 v62, v171, s7, v62
    v_dot2_f32_bf16 v63, v171, v171, v63
    v_dot2_f32_bf16 v64, v173, s7, v64
    v_dot2_f32_bf16 v65, v173, v173, v65
    s_waitcnt vmcnt(8)
    ds_write2_b64 v69, v[174:175], v[176:177] offset0:96 offset1:98
    v_bitop3_b32 v71, v173, v177, v71 bitop3:0x80
    v_dot2_f32_bf16 v62, v174, s7, v62
    v_dot2_f32_bf16 v63, v174, v174, v63
    v_dot2_f32_bf16 v64, v176, s7, v64
    v_dot2_f32_bf16 v65, v176, v176, v65
    v_dot2_f32_bf16 v62, v175, s7, v62
    v_dot2_f32_bf16 v63, v175, v175, v63
    v_dot2_f32_bf16 v64, v177, s7, v64
    v_dot2_f32_bf16 v65, v177, v177, v65
    v_and_b32 v71, 1, v71
    v_cmp_ne_u32 vcc, 1, v71
    s_cmp_ge_u32 s100, 262144
    s_cbranch_scc1 Lx_go
    s_cbranch_vccnz Lx_redo
Lx_go:
    v_add_f32_dpp v90, v62, v62 row_ror:8 row_mask:0xf bank_mask:0x3
    s_nop 1
    v_add_f32_dpp v90, v64, v64 row_ror:8 row_mask:0xf bank_mask:0xc
    v_add_f32_dpp v91, v63, v63 row_ror:8 row_mask:0xf bank_mask:0x3
    s_nop 1
    v_add_f32_dpp v91, v65, v65 row_ror:8 row_mask:0xf bank_mask:0xc
    s_add_u32 s4, s88, 148736
    v_lshl_add_u32 v28, v70, 3, s4
    ds_write_b64 v28, v[90:91]
    s_waitcnt lgkmcnt(0)
    s_barrier
    v_add_u32 v173, 41600, v4
    ds_read_b128 v[48:51], v173 offset:37440
    ds_read_b128 v[52:55], v173 offset:38480
    ds_read_b128 v[56:59], v173 offset:39520
    ds_read_b128 v[60:63], v173 offset:40560
    ds_read_b128 v[64:67], v173 offset:33280
    s_waitcnt lgkmcnt(3)
    v_mfma_f32_16x16x32_bf16 v[178:181], v[48:51], a[248:251], 0
    ds_read_b128 v[68:71], v173 offset:34320
    s_add_u32 m0, s89, 8192
    v_mfma_f32_16x16x32_bf16 v[194:197], v[48:51], a[252:255], 0
    v_mfma_f32_16x16x32_bf16 v[182:185], v[52:55], a[248:251], 0
    ds_read_b128 v[48:51], v173 offset:35360
    v_mfma_f32_16x16x32_bf16 v[198:201], v[52:55], a[252:255], 0
    s_waitcnt lgkmcnt(3)
    v_mfma_f32_16x16x32_bf16 v[186:189], v[56:59], a[248:251], 0
    ds_read_b128 v[52:55], v173 offset:36400
    v_add_u32 v28, 148736, v30
    v_mfma_f32_16x16x32_bf16 v[202:205], v[56:59], a[252:255], 0
    global_load_lds_dwordx4 v74, s[70:71] offset:0
    ds_read_b64 v[90:91], v28 offset:0
    v_mfma_f32_16x16x32_bf16 v[190:193], v[60:63], a[248:251], 0
    ds_read_b128 v[56:59], v173 offset:29120
    v_mfma_f32_16x16x32_bf16 v[206:209], v[60:63], a[252:255], 0
    ds_read_b64 v[92:93], v28 offset:512
    s_waitcnt lgkmcnt(5)
    v_mfma_f32_16x16x32_bf16 v[178:181], v[64:67], a[240:243], v[178:181]
    ds_read_b128 v[60:63], v173 offset:30160
    v_mfma_f32_16x16x32_bf16 v[194:197], v[64:67], a[244:247], v[194:197]
    ds_read_b64 v[94:95], v28 offset:1024
    v_mfma_f32_16x16x32_bf16 v[182:185], v[68:71], a[240:243], v[182:185]
    ds_read_b128 v[64:67], v173 offset:31200
    global_load_lds_dwordx4 v75, s[70:71] offset:1024
    v_mfma_f32_16x16x32_bf16 v[198:201], v[68:71], a[244:247], v[198:201]
    ds_read_b64 v[96:97], v28 offset:1536
    s_waitcnt lgkmcnt(7)
    v_mfma_f32_16x16x32_bf16 v[186:189], v[48:51], a[240:243], v[186:189]
    ds_read_b128 v[68:71], v173 offset:32240
    v_mfma_f32_16x16x32_bf16 v[202:205], v[48:51], a[244:247], v[202:205]
    s_add_u32 s4, s88, 150784
    v_mfma_f32_16x16x32_bf16 v[190:193], v[52:55], a[240:243], v[190:193]
    ds_read_b128 v[48:51], v173 offset:24960
    v_mfma_f32_16x16x32_bf16 v[206:209], v[52:55], a[244:247], v[206:209]
    v_lshl_add_u32 v170, v1, 2, s4
    s_waitcnt lgkmcnt(5)
    v_mfma_f32_16x16x32_bf16 v[178:181], v[56:59], a[232:235], v[178:181]
    ds_read_b128 v[52:55], v173 offset:26000
    global_load_lds_dwordx4 v76, s[70:71] offset:2048
    v_mfma_f32_16x16x32_bf16 v[194:197], v[56:59], a[236:239], v[194:197]
    v_lshl_add_u32 v171, v3, 5, s4
    v_mfma_f32_16x16x32_bf16 v[182:185], v[60:63], a[232:235], v[182:185]
    ds_read_b128 v[56:59], v173 offset:27040
    v_lshl_add_u32 v172, v5, 2, s4
    v_mfma_f32_16x16x32_bf16 v[198:201], v[60:63], a[236:239], v[198:201]
    s_waitcnt lgkmcnt(3)
    v_mfma_f32_16x16x32_bf16 v[186:189], v[64:67], a[232:235], v[186:189]
    ds_read_b128 v[60:63], v173 offset:28080
    v_add_f32 v90, v90, v92
    v_mfma_f32_16x16x32_bf16 v[202:205], v[64:67], a[236:239], v[202:205]
    global_load_lds_dwordx4 v77, s[70:71] offset:3072
    v_mfma_f32_16x16x32_bf16 v[190:193], v[68:71], a[232:235], v[190:193]
    ds_read_b128 v[64:67], v173 offset:20800
    v_add_f32 v91, v91, v93
    v_mfma_f32_16x16x32_bf16 v[206:209], v[68:71], a[236:239], v[206:209]
    s_waitcnt lgkmcnt(3)
    v_mfma_f32_16x16x32_bf16 v[178:181], v[48:51], a[224:227], v[178:181]
    ds_read_b128 v[68:71], v173 offset:21840
    v_add_f32 v94, v94, v96
    v_mfma_f32_16x16x32_bf16 v[194:197], v[48:51], a[228:231], v[194:197]
    v_mfma_f32_16x16x32_bf16 v[182:185], v[52:55], a[224:227], v[182:185]
    ds_read_b128 v[48:51], v173 offset:22880
    v_add_f32 v95, v95, v97
    s_add_u32 m0, s89, 12288
    v_mfma_f32_16x16x32_bf16 v[198:201], v[52:55], a[228:231], v[198:201]
    s_waitcnt lgkmcnt(3)
    v_mfma_f32_16x16x32_bf16 v[186:189], v[56:59], a[224:227], v[186:189]
    ds_read_b128 v[52:55], v173 offset:23920
    v_add_f32 v90, v90, v94
    v_mfma_f32_16x16x32_bf16 v[202:205], v[56:59], a[228:231], v[202:205]
    v_add_f32 v91, v91, v95
    v_mfma_f32_16x16x32_bf16 v[190:193], v[60:63], a[224:227], v[190:193]
    ds_read_b128 v[56:59], v173 offset:16640
    v_mfma_f32_16x16x32_bf16 v[206:209], v[60:63], a[228:231], v[206:209]
    v_mul_f32 v90, 0x3acccccd, v90
    s_waitcnt lgkmcnt(3)
    v_mfma_f32_16x16x32_bf16 v[178:181], v[64:67], a[216:219], v[178:181]
    ds_read_b128 v[60:63], v173 offset:17680
    global_load_lds_dwordx4 v78, s[70:71] offset:0
    v_mfma_f32_16x16x32_bf16 v[194:197], v[64:67], a[220:223], v[194:197]
    v_mul_f32 v91, 0x3acccccd, v91
    v_mfma_f32_16x16x32_bf16 v[182:185], v[68:71], a[216:219], v[182:185]
    ds_read_b128 v[64:67], v173 offset:18720
    v_mfma_f32_16x16x32_bf16 v[198:201], v[68:71], a[220:223], v[198:201]
    v_fma_f32 v91, -v90, v90, v91
    s_waitcnt lgkmcnt(3)
    v_mfma_f32_16x16x32_bf16 v[186:189], v[48:51], a[216:219], v[186:189]
    ds_read_b128 v[68:71], v173 offset:19760
    v_mfma_f32_16x16x32_bf16 v[202:205], v[48:51], a[220:223], v[202:205]
    v_max_f32 v91, 0, v91
    global_load_lds_dwordx4 v79, s[70:71] offset:1024
    v_mfma_f32_16x16x32_bf16 v[190:193], v[52:55], a[216:219], v[190:193]
    ds_read_b128 v[48:51], v173 offset:12480
    v_mfma_f32_16x16x32_bf16 v[206:209], v[52:55], a[220:223], v[206:209]
    v_add_f32 v91, 0x3727c5ac, v91
    s_waitcnt lgkmcnt(3)
    v_mfma_f32_16x16x32_bf16 v[178:181], v[56:59], a[208:211], v[178:181]
    ds_read_b128 v[52:55], v173 offset:13520
    v_mfma_f32_16x16x32_bf16 v[194:197], v[56:59], a[212:215], v[194:197]
    v_rsq_f32 v92, v91
    v_mfma_f32_16x16x32_bf16 v[182:185], v[60:63], a[208:211], v[182:185]
    ds_read_b128 v[56:59], v173 offset:14560
    global_load_lds_dwordx4 v80, s[70:71] offset:2048
    v_mfma_f32_16x16x32_bf16 v[198:201], v[60:63], a[212:215], v[198:201]
    s_waitcnt lgkmcnt(3)
    v_mfma_f32_16x16x32_bf16 v[186:189], v[64:67], a[208:211], v[186:189]
    ds_read_b128 v[60:63], v173 offset:15600
    v_mul_f32_e64 v91, -v90, v92
    v_mfma_f32_16x16x32_bf16 v[202:205], v[64:67], a[212:215], v[202:205]
    v_mfma_f32_16x16x32_bf16 v[190:193], v[68:71], a[208:211], v[190:193]
    ds_read_b128 v[64:67], v173 offset:8320
    v_mov_b32 v90, v92
    v_mfma_f32_16x16x32_bf16 v[206:209], v[68:71], a[212:215], v[206:209]
    s_waitcnt lgkmcnt(3)
    v_mfma_f32_16x16x32_bf16 v[178:181], v[48:51], a[200:203], v[178:181]
    ds_read_b128 v[68:71], v173 offset:9360
    global_load_lds_dwordx4 v81, s[70:71] offset:3072
    v_mfma_f32_16x16x32_bf16 v[194:197], v[48:51], a[204:207], v[194:197]
    ds_write2st64_b32 v170, v90, v91 offset0:0 offset1:1
    v_mfma_f32_16x16x32_bf16 v[182:185], v[52:55], a[200:203], v[182:185]
    ds_read_b128 v[48:51], v173 offset:10400
    ds_read_b128 v[98:101], v171 offset:0
    v_mfma_f32_16x16x32_bf16 v[198:201], v[52:55], a[204:207], v[198:201]
    s_waitcnt lgkmcnt(5)
    v_mfma_f32_16x16x32_bf16 v[186:189], v[56:59], a[200:203], v[186:189]
    ds_read_b128 v[52:55], v173 offset:11440
    ds_read_b128 v[102:105], v171 offset:16
    v_mfma_f32_16x16x32_bf16 v[202:205], v[56:59], a[204:207], v[202:205]
    global_load_dwordx4 a[0:3], v4, s[52:53] offset:-4096 sc1
    v_mfma_f32_16x16x32_bf16 v[190:193], v[60:63], a[200:203], v[190:193]
    ds_read_b128 v[56:59], v173 offset:4160
    ds_read_b128 v[106:109], v171 offset:128
    v_mfma_f32_16x16x32_bf16 v[206:209], v[60:63], a[204:207], v[206:209]
    ds_read_b128 v[110:113], v171 offset:144
    s_waitcnt lgkmcnt(8)
    v_mfma_f32_16x16x32_bf16 v[178:181], v[64:67], a[192:195], v[178:181]
    ds_read_b128 v[60:63], v173 offset:5200
    v_mfma_f32_16x16x32_bf16 v[194:197], v[64:67], a[196:199], v[194:197]
    ds_read_b128 v[114:117], v171 offset:256
    v_mfma_f32_16x16x32_bf16 v[182:185], v[68:71], a[192:195], v[182:185]
    ds_read_b128 v[64:67], v173 offset:6240
    global_load_dwordx4 a[4:7], v7, s[58:59] offset:-4096 sc1
    v_mfma_f32_16x16x32_bf16 v[198:201], v[68:71], a[196:199], v[198:201]
    ds_read_b128 v[118:121], v171 offset:272
    s_waitcnt lgkmcnt(8)
    v_mfma_f32_16x16x32_bf16 v[186:189], v[48:51], a[192:195], v[186:189]
    ds_read_b128 v[68:71], v173 offset:7280
    v_mfma_f32_16x16x32_bf16 v[202:205], v[48:51], a[196:199], v[202:205]
    ds_read_b128 v[122:125], v171 offset:384
    v_mfma_f32_16x16x32_bf16 v[190:193], v[52:55], a[192:195], v[190:193]
    ds_read_b128 v[48:51], v173 offset:0
    v_mfma_f32_16x16x32_bf16 v[206:209], v[52:55], a[196:199], v[206:209]
    ds_read_b128 v[126:129], v171 offset:400
    s_waitcnt lgkmcnt(7)
    v_mfma_f32_16x16x32_bf16 v[178:181], v[56:59], a[184:187], v[178:181]
    ds_read_b128 v[52:55], v173 offset:1040
    global_load_dwordx4 a[8:11], v4, s[52:53] offset:-3072 sc1
    v_mfma_f32_16x16x32_bf16 v[194:197], v[56:59], a[188:191], v[194:197]
    ds_read_b32 v162, v172 offset:0
    v_mfma_f32_16x16x32_bf16 v[182:185], v[60:63], a[184:187], v[182:185]
    ds_read_b128 v[56:59], v173 offset:2080
    v_mfma_f32_16x16x32_bf16 v[198:201], v[60:63], a[188:191], v[198:201]
    ds_read_b32 v163, v172 offset:256
    s_waitcnt lgkmcnt(7)
    v_mfma_f32_16x16x32_bf16 v[186:189], v[64:67], a[184:187], v[186:189]
    ds_read_b128 v[60:63], v173 offset:3120
    ds_read_b32 v164, v172 offset:16
    v_mfma_f32_16x16x32_bf16 v[202:205], v[64:67], a[188:191], v[202:205]
    global_load_dwordx4 a[12:15], v7, s[58:59] offset:-3072 sc1
    v_mfma_f32_16x16x32_bf16 v[190:193], v[68:71], a[184:187], v[190:193]
    ds_read_b128 v[64:67], v4 offset:37440
    ds_read_b32 v165, v172 offset:272
    v_mfma_f32_16x16x32_bf16 v[206:209], v[68:71], a[188:191], v[206:209]
    s_waitcnt lgkmcnt(7)
    v_mfma_f32_16x16x32_bf16 v[178:181], v[48:51], a[176:179], v[178:181]
    ds_read_b128 v[68:71], v4 offset:38480
    ds_read_b32 v166, v172 offset:128
    v_mfma_f32_16x16x32_bf16 v[194:197], v[48:51], a[180:183], v[194:197]
    v_mfma_f32_16x16x32_bf16 v[182:185], v[52:55], a[176:179], v[182:185]
    ds_read_b128 v[48:51], v4 offset:39520
    ds_read_b32 v167, v172 offset:384
    v_mfma_f32_16x16x32_bf16 v[198:201], v[52:55], a[180:183], v[198:201]
    global_load_dwordx4 a[16:19], v4, s[52:53] offset:-2048 sc1
    s_waitcnt lgkmcnt(7)
    v_mfma_f32_16x16x32_bf16 v[186:189], v[56:59], a[176:179], v[186:189]
    ds_read_b128 v[52:55], v4 offset:40560
    ds_read_b32 v168, v172 offset:144
    v_mfma_f32_16x16x32_bf16 v[202:205], v[56:59], a[180:183], v[202:205]
    v_mfma_f32_16x16x32_bf16 v[190:193], v[60:63], a[176:179], v[190:193]
    ds_read_b128 v[56:59], v4 offset:33280
    ds_read_b32 v169, v172 offset:400
    v_mfma_f32_16x16x32_bf16 v[206:209], v[60:63], a[180:183], v[206:209]
    s_waitcnt lgkmcnt(7)
    v_mfma_f32_16x16x32_bf16 v[178:181], v[64:67], a[168:171], v[178:181]
    ds_read_b128 v[60:63], v4 offset:34320
    s_add_u32 s4, s88, 156672
    global_load_dwordx4 a[20:23], v7, s[58:59] offset:-2048 sc1
    v_mfma_f32_16x16x32_bf16 v[194:197], v[64:67], a[172:175], v[194:197]
    v_lshl_add_u32 v28, v2, 2, s4
    v_mfma_f32_16x16x32_bf16 v[182:185], v[68:71], a[168:171], v[182:185]
    ds_read_b128 v[64:67], v4 offset:35360
    v_mfma_f32_16x16x32_bf16 v[198:201], v[68:71], a[172:175], v[198:201]
    ds_read2_b32 v[8:9], v28 offset0:0 offset1:16
    s_waitcnt lgkmcnt(6)
    v_mfma_f32_16x16x32_bf16 v[186:189], v[48:51], a[168:171], v[186:189]
    ds_read_b128 v[68:71], v4 offset:36400
    v_mfma_f32_16x16x32_bf16 v[202:205], v[48:51], a[172:175], v[202:205]
    global_load_dwordx4 a[24:27], v4, s[52:53] offset:-1024 sc1
    ds_read2_b32 v[10:11], v28 offset0:32 offset1:48
    v_mfma_f32_16x16x32_bf16 v[190:193], v[52:55], a[168:171], v[190:193]
    ds_read_b128 v[48:51], v4 offset:29120
    v_mfma_f32_16x16x32_bf16 v[206:209], v[52:55], a[172:175], v[206:209]
    v_lshl_add_u32 v28, v3, 4, s4
    s_waitcnt lgkmcnt(5)
    v_mfma_f32_16x16x32_bf16 v[178:181], v[56:59], a[160:163], v[178:181]
    ds_read_b128 v[52:55], v4 offset:30160
    v_mfma_f32_16x16x32_bf16 v[194:197], v[56:59], a[164:167], v[194:197]
    ds_read_b128 v[12:15], v28 offset:256
    v_mfma_f32_16x16x32_bf16 v[182:185], v[60:63], a[160:163], v[182:185]
    ds_read_b128 v[56:59], v4 offset:31200
    global_load_dwordx4 a[28:31], v7, s[58:59] offset:-1024 sc1
    v_mfma_f32_16x16x32_bf16 v[198:201], v[60:63], a[164:167], v[198:201]
    ds_read_b128 v[16:19], v28 offset:320
    s_waitcnt lgkmcnt(6)
    v_mfma_f32_16x16x32_bf16 v[186:189], v[64:67], a[160:163], v[186:189]
    ds_read_b128 v[60:63], v4 offset:32240
    ds_read_b128 v[20:23], v28 offset:384
    v_mfma_f32_16x16x32_bf16 v[202:205], v[64:67], a[164:167], v[202:205]
    v_mfma_f32_16x16x32_bf16 v[190:193], v[68:71], a[160:163], v[190:193]
    ds_read_b128 v[64:67], v4 offset:24960
    ds_read_b128 v[24:27], v28 offset:448
    v_mfma_f32_16x16x32_bf16 v[206:209], v[68:71], a[164:167], v[206:209]
    s_waitcnt lgkmcnt(7)
    v_mfma_f32_16x16x32_bf16 v[178:181], v[48:51], a[152:155], v[178:181]
    ds_read_b128 v[68:71], v4 offset:26000
    global_load_dwordx4 a[32:35], v4, s[52:53] offset:0 sc1
    v_mfma_f32_16x16x32_bf16 v[194:197], v[48:51], a[156:159], v[194:197]
    v_fma_f32 v130, v114, v8, v9
    v_mfma_f32_16x16x32_bf16 v[182:185], v[52:55], a[152:155], v[182:185]
    ds_read_b128 v[48:51], v4 offset:27040
    v_fma_f32 v131, v115, v8, v9
    v_mfma_f32_16x16x32_bf16 v[198:201], v[52:55], a[156:159], v[198:201]
    s_waitcnt lgkmcnt(5)
    v_mfma_f32_16x16x32_bf16 v[186:189], v[56:59], a[152:155], v[186:189]
    ds_read_b128 v[52:55], v4 offset:28080
    v_fma_f32 v132, v116, v8, v9
    v_mfma_f32_16x16x32_bf16 v[202:205], v[56:59], a[156:159], v[202:205]
    global_load_dwordx4 a[36:39], v7, s[58:59] offset:0 sc1
    v_mfma_f32_16x16x32_bf16 v[190:193], v[60:63], a[152:155], v[190:193]
    ds_read_b128 v[56:59], v4 offset:20800
    v_fma_f32 v133, v117, v8, v9
    v_mfma_f32_16x16x32_bf16 v[206:209], v[60:63], a[156:159], v[206:209]
    s_waitcnt lgkmcnt(3)
    v_mfma_f32_16x16x32_bf16 v[178:181], v[64:67], a[144:147], v[178:181]
    ds_read_b128 v[60:63], v4 offset:21840
    v_fma_f32 v134, v118, v8, v9
    v_mfma_f32_16x16x32_bf16 v[194:197], v[64:67], a[148:151], v[194:197]
    v_fma_f32 v135, v119, v8, v9
    v_mfma_f32_16x16x32_bf16 v[182:185], v[68:71], a[144:147], v[182:185]
    ds_read_b128 v[64:67], v4 offset:22880
    global_load_dwordx4 a[40:43], v4, s[52:53] offset:1024 sc1
    v_mfma_f32_16x16x32_bf16 v[198:201], v[68:71], a[148:151], v[198:201]
    v_fma_f32 v136, v120, v8, v9
    s_waitcnt lgkmcnt(3)
    v_mfma_f32_16x16x32_bf16 v[186:189], v[48:51], a[144:147], v[186:189]
    ds_read_b128 v[68:71], v4 offset:23920
    v_mfma_f32_16x16x32_bf16 v[202:205], v[48:51], a[148:151], v[202:205]
    v_fma_f32 v137, v121, v8, v9
    v_mfma_f32_16x16x32_bf16 v[190:193], v[52:55], a[144:147], v[190:193]
    ds_read_b128 v[48:51], v4 offset:16640
    v_mfma_f32_16x16x32_bf16 v[206:209], v[52:55], a[148:151], v[206:209]
    v_fma_f32 v138, v122, v8, v9
    s_waitcnt lgkmcnt(3)
    v_mfma_f32_16x16x32_bf16 v[178:181], v[56:59], a[136:139], v[178:181]
    ds_read_b128 v[52:55], v4 offset:17680
    global_load_dwordx4 a[44:47], v7, s[58:59] offset:1024 sc1
    v_mfma_f32_16x16x32_bf16 v[194:197], v[56:59], a[140:143], v[194:197]
    v_fma_f32 v139, v123, v8, v9
    v_mfma_f32_16x16x32_bf16 v[182:185], v[60:63], a[136:139], v[182:185]
    ds_read_b128 v[56:59], v4 offset:18720
    v_mfma_f32_16x16x32_bf16 v[198:201], v[60:63], a[140:143], v[198:201]
    v_fma_f32 v140, v124, v8, v9
    s_waitcnt lgkmcnt(3)
    v_mfma_f32_16x16x32_bf16 v[186:189], v[64:67], a[136:139], v[186:189]
    ds_read_b128 v[60:63], v4 offset:19760
    v_mfma_f32_16x16x32_bf16 v[202:205], v[64:67], a[140:143], v[202:205]
    v_fma_f32 v141, v125, v8, v9
    global_load_dwordx4 a[48:51], v4, s[52:53] offset:2048 sc1
    v_mfma_f32_16x16x32_bf16 v[190:193], v[68:71], a[136:139], v[190:193]
    ds_read_b128 v[64:67], v4 offset:0
    v_fma_f32 v142, v126, v8, v9
    v_mfma_f32_16x16x32_bf16 v[206:209], v[68:71], a[140:143], v[206:209]
    s_waitcnt lgkmcnt(3)
    v_mfma_f32_16x16x32_bf16 v[178:181], v[48:51], a[128:131], v[178:181]
    ds_read_b128 v[68:71], v4 offset:1040
    v_fma_f32 v143, v127, v8, v9
    v_mfma_f32_16x16x32_bf16 v[194:197], v[48:51], a[132:135], v[194:197]
    v_mfma_f32_16x16x32_bf16 v[182:185], v[52:55], a[128:131], v[182:185]
    ds_read_b128 v[48:51], v4 offset:2080
    v_fma_f32 v144, v128, v8, v9
    v_mfma_f32_16x16x32_bf16 v[198:201], v[52:55], a[132:135], v[198:201]
    global_load_dwordx4 a[52:55], v7, s[58:59] offset:2048 sc1
    s_waitcnt lgkmcnt(3)
    v_mfma_f32_16x16x32_bf16 v[186:189], v[56:59], a[128:131], v[186:189]
    ds_read_b128 v[52:55], v4 offset:3120
    v_fma_f32 v145, v129, v8, v9
    v_mfma_f32_16x16x32_bf16 v[202:205], v[56:59], a[132:135], v[202:205]
    v_mfma_f32_16x16x32_bf16 v[190:193], v[60:63], a[128:131], v[190:193]
    ds_read_b128 v[56:59], v4 offset:4160
    v_fma_f32 v146, v114, v10, v11
    v_mfma_f32_16x16x32_bf16 v[206:209], v[60:63], a[132:135], v[206:209]
    s_waitcnt lgkmcnt(3)
    s_waitcnt vmcnt(29)
    v_mfma_f32_16x16x32_bf16 v[178:181], v[64:67], a[96:99], v[178:181]
    ds_read_b128 v[60:63], v4 offset:5200
    global_load_dwordx4 a[56:59], v4, s[52:53] offset:3072 sc1
    s_waitcnt vmcnt(29)
    v_mfma_f32_16x16x32_bf16 v[194:197], v[64:67], a[100:103], v[194:197]
    v_fma_f32 v147, v115, v10, v11
    v_mfma_f32_16x16x32_bf16 v[182:185], v[68:71], a[96:99], v[182:185]
    ds_read_b128 v[64:67], v4 offset:6240
    v_fma_f32 v148, v116, v10, v11
    v_mfma_f32_16x16x32_bf16 v[198:201], v[68:71], a[100:103], v[198:201]
    v_fma_f32 v149, v117, v10, v11
    s_waitcnt lgkmcnt(3)
    v_mfma_f32_16x16x32_bf16 v[186:189], v[48:51], a[96:99], v[186:189]
    ds_read_b128 v[68:71], v4 offset:7280
    v_mfma_f32_16x16x32_bf16 v[202:205], v[48:51], a[100:103], v[202:205]
    global_load_dwordx4 a[60:63], v7, s[58:59] offset:3072 sc1
    v_fma_f32 v150, v118, v10, v11
    v_mfma_f32_16x16x32_bf16 v[190:193], v[52:55], a[96:99], v[190:193]
    ds_read_b128 v[48:51], v4 offset:8320
    v_mfma_f32_16x16x32_bf16 v[206:209], v[52:55], a[100:103], v[206:209]
    v_fma_f32 v151, v119, v10, v11
    s_waitcnt lgkmcnt(3)
    s_waitcnt vmcnt(29)
    v_mfma_f32_16x16x32_bf16 v[178:181], v[56:59], a[104:107], v[178:181]
    ds_read_b128 v[52:55], v4 offset:9360
    s_waitcnt vmcnt(28)
    v_mfma_f32_16x16x32_bf16 v[194:197], v[56:59], a[108:111], v[194:197]
    v_fma_f32 v152, v120, v10, v11
    v_mfma_f32_16x16x32_bf16 v[182:185], v[60:63], a[104:107], v[182:185]
    ds_read_b128 v[56:59], v4 offset:10400
    global_load_dwordx4 a[64:67], v4, s[54:55] offset:-4096 sc1
    v_mfma_f32_16x16x32_bf16 v[198:201], v[60:63], a[108:111], v[198:201]
    v_fma_f32 v153, v121, v10, v11
    s_waitcnt lgkmcnt(3)
    v_mfma_f32_16x16x32_bf16 v[186:189], v[64:67], a[104:107], v[186:189]
    ds_read_b128 v[60:63], v4 offset:11440
    v_mfma_f32_16x16x32_bf16 v[202:205], v[64:67], a[108:111], v[202:205]
    v_fma_f32 v154, v122, v10, v11
    v_mfma_f32_16x16x32_bf16 v[190:193], v[68:71], a[104:107], v[190:193]
    ds_read_b128 v[64:67], v4 offset:12480
    v_mfma_f32_16x16x32_bf16 v[206:209], v[68:71], a[108:111], v[206:209]
    v_fma_f32 v155, v123, v10, v11
    s_waitcnt lgkmcnt(3)
    s_waitcnt vmcnt(28)
    v_mfma_f32_16x16x32_bf16 v[178:181], v[48:51], a[112:115], v[178:181]
    ds_read_b128 v[68:71], v4 offset:13520
    global_load_dwordx4 a[68:71], v7, s[60:61] offset:-4096 sc1
    s_waitcnt vmcnt(28)
    v_mfma_f32_16x16x32_bf16 v[194:197], v[48:51], a[116:119], v[194:197]
    v_fma_f32 v156, v124, v10, v11
    v_mfma_f32_16x16x32_bf16 v[182:185], v[52:55], a[112:115], v[182:185]
    ds_read_b128 v[48:51], v4 offset:14560
    v_fma_f32 v157, v125, v10, v11
    v_mfma_f32_16x16x32_bf16 v[198:201], v[52:55], a[116:119], v[198:201]
    s_waitcnt lgkmcnt(3)
    v_mfma_f32_16x16x32_bf16 v[186:189], v[56:59], a[112:115], v[186:189]
    ds_read_b128 v[52:55], v4 offset:15600
    v_fma_f32 v158, v126, v10, v11
    v_mfma_f32_16x16x32_bf16 v[202:205], v[56:59], a[116:119], v[202:205]
    global_load_dwordx4 a[72:75], v4, s[54:55] offset:-3072 sc1
    v_mfma_f32_16x16x32_bf16 v[190:193], v[60:63], a[112:115], v[190:193]
    v_fma_f32 v159, v127, v10, v11
    v_mfma_f32_16x16x32_bf16 v[206:209], v[60:63], a[116:119], v[206:209]
    s_waitcnt lgkmcnt(2)
    s_waitcnt vmcnt(28)
    v_mfma_f32_16x16x32_bf16 v[178:181], v[64:67], a[120:123], v[178:181]
    v_fma_f32 v160, v128, v10, v11
    s_waitcnt vmcnt(27)
    v_mfma_f32_16x16x32_bf16 v[194:197], v[64:67], a[124:127], v[194:197]
    v_mfma_f32_16x16x32_bf16 v[182:185], v[68:71], a[120:123], v[182:185]
    v_fma_f32 v161, v129, v10, v11
    global_load_dwordx4 a[76:79], v7, s[60:61] offset:-3072 sc1
    v_mfma_f32_16x16x32_bf16 v[198:201], v[68:71], a[124:127], v[198:201]
    s_waitcnt lgkmcnt(0)
    v_mfma_f32_16x16x32_bf16 v[186:189], v[48:51], a[120:123], v[186:189]
    v_mfma_f32_16x16x32_bf16 v[202:205], v[48:51], a[124:127], v[202:205]
    v_mfma_f32_16x16x32_bf16 v[190:193], v[52:55], a[120:123], v[190:193]
    v_mfma_f32_16x16x32_bf16 v[206:209], v[52:55], a[124:127], v[206:209]
    s_nop 7
    s_cmp_eq_u32 s101, 2
    s_cbranch_scc1 Lz_keep
    v_mov_b32 v194, 0
    v_mov_b32 v195, 0
    v_mov_b32 v196, 0
    v_mov_b32 v197, 0
    v_mov_b32 v198, 0
    v_mov_b32 v199, 0
    v_mov_b32 v200, 0
    v_mov_b32 v201, 0
    v_mov_b32 v202, 0
    v_mov_b32 v203, 0
    v_mov_b32 v204, 0
    v_mov_b32 v205, 0
    v_mov_b32 v206, 0
    v_mov_b32 v207, 0
    v_mov_b32 v208, 0
    v_mov_b32 v209, 0
    s_cmp_eq_u32 s101, 1
    s_cbranch_scc1 Lz_keep
    v_mov_b32 v178, 0
    v_mov_b32 v179, 0
    v_mov_b32 v180, 0
    v_mov_b32 v181, 0
    v_mov_b32 v182, 0
    v_mov_b32 v183, 0
    v_mov_b32 v184, 0
    v_mov_b32 v185, 0
    v_mov_b32 v186, 0
    v_mov_b32 v187, 0
    v_mov_b32 v188, 0
    v_mov_b32 v189, 0
    v_mov_b32 v190, 0
    v_mov_b32 v191, 0
    v_mov_b32 v192, 0
    v_mov_b32 v193, 0
Lz_keep:
    global_load_dwordx4 a[80:83], v4, s[54:55] offset:-2048 sc1
    v_pk_fma_f32 v[178:179], v[178:179], v[98:99], v[130:131] op_sel:[0,0,0] op_sel_hi:[1,1,1]
    v_pk_fma_f32 v[180:181], v[180:181], v[100:101], v[132:133] op_sel:[0,0,0] op_sel_hi:[1,1,1]
    v_pk_fma_f32 v[182:183], v[182:183], v[102:103], v[134:135] op_sel:[0,0,0] op_sel_hi:[1,1,1]
    v_pk_fma_f32 v[184:185], v[184:185], v[104:105], v[136:137] op_sel:[0,0,0] op_sel_hi:[1,1,1]
    global_load_dwordx4 a[84:87], v7, s[60:61] offset:-2048 sc1
    v_pk_fma_f32 v[186:187], v[186:187], v[106:107], v[138:139] op_sel:[0,0,0] op_sel_hi:[1,1,1]
    v_pk_fma_f32 v[188:189], v[188:189], v[108:109], v[140:141] op_sel:[0,0,0] op_sel_hi:[1,1,1]
    v_pk_fma_f32 v[190:191], v[190:191], v[110:111], v[142:143] op_sel:[0,0,0] op_sel_hi:[1,1,1]
    v_pk_fma_f32 v[192:193], v[192:193], v[112:113], v[144:145] op_sel:[0,0,0] op_sel_hi:[1,1,1]
    global_load_dwordx4 a[88:91], v4, s[54:55] offset:-1024 sc1
    v_pk_fma_f32 v[194:195], v[194:195], v[98:99], v[146:147] op_sel:[0,0,0] op_sel_hi:[1,1,1]
    v_pk_fma_f32 v[196:197], v[196:197], v[100:101], v[148:149] op_sel:[0,0,0] op_sel_hi:[1,1,1]
    v_pk_fma_f32 v[198:199], v[198:199], v[102:103], v[150:151] op_sel:[0,0,0] op_sel_hi:[1,1,1]
    v_pk_fma_f32 v[200:201], v[200:201], v[104:105], v[152:153] op_sel:[0,0,0] op_sel_hi:[1,1,1]
    v_pk_fma_f32 v[202:203], v[202:203], v[106:107], v[154:155] op_sel:[0,0,0] op_sel_hi:[1,1,1]
    global_load_dwordx4 a[92:95], v7, s[60:61] offset:-1024 sc1
    v_pk_fma_f32 v[204:205], v[204:205], v[108:109], v[156:157] op_sel:[0,0,0] op_sel_hi:[1,1,1]
    v_pk_fma_f32 v[206:207], v[206:207], v[110:111], v[158:159] op_sel:[0,0,0] op_sel_hi:[1,1,1]
    v_pk_fma_f32 v[208:209], v[208:209], v[112:113], v[160:161] op_sel:[0,0,0] op_sel_hi:[1,1,1]
    v_pk_mul_f32 v[130:131], v[178:179], v[178:179] op_sel:[0,0] op_sel_hi:[1,1]
    global_load_dwordx4 a[96:99], v4, s[54:55] offset:0 sc1
    v_pk_mul_f32 v[132:133], v[180:181], v[180:181] op_sel:[0,0] op_sel_hi:[1,1]
    v_pk_mul_f32 v[134:135], v[182:183], v[182:183] op_sel:[0,0] op_sel_hi:[1,1]
    v_pk_mul_f32 v[136:137], v[184:185], v[184:185] op_sel:[0,0] op_sel_hi:[1,1]
    v_pk_mul_f32 v[138:139], v[186:187], v[186:187] op_sel:[0,0] op_sel_hi:[1,1]
    global_load_dwordx4 a[100:103], v7, s[60:61] offset:0 sc1
    v_pk_mul_f32 v[140:141], v[188:189], v[188:189] op_sel:[0,0] op_sel_hi:[1,1]
    v_pk_mul_f32 v[142:143], v[190:191], v[190:191] op_sel:[0,0] op_sel_hi:[1,1]
    v_pk_mul_f32 v[144:145], v[192:193], v[192:193] op_sel:[0,0] op_sel_hi:[1,1]
    v_pk_mul_f32 v[146:147], v[194:195], v[194:195] op_sel:[0,0] op_sel_hi:[1,1]
    v_pk_mul_f32 v[148:149], v[196:197], v[196:197] op_sel:[0,0] op_sel_hi:[1,1]
    global_load_dwordx4 a[104:107], v4, s[54:55] offset:1024 sc1
    v_pk_mul_f32 v[150:151], v[198:199], v[198:199] op_sel:[0,0] op_sel_hi:[1,1]
    v_pk_mul_f32 v[152:153], v[200:201], v[200:201] op_sel:[0,0] op_sel_hi:[1,1]
    v_pk_mul_f32 v[154:155], v[202:203], v[202:203] op_sel:[0,0] op_sel_hi:[1,1]
    v_pk_mul_f32 v[156:157], v[204:205], v[204:205] op_sel:[0,0] op_sel_hi:[1,1]
    global_load_dwordx4 a[108:111], v7, s[60:61] offset:1024 sc1
    v_pk_mul_f32 v[158:159], v[206:207], v[206:207] op_sel:[0,0] op_sel_hi:[1,1]
    v_pk_mul_f32 v[160:161], v[208:209], v[208:209] op_sel:[0,0] op_sel_hi:[1,1]
    v_pk_fma_f32 v[130:131], v[130:131], s[84:85], s[84:85] op_sel:[0,1,0] op_sel_hi:[1,1,0]
    v_pk_fma_f32 v[132:133], v[132:133], s[84:85], s[84:85] op_sel:[0,1,0] op_sel_hi:[1,1,0]
    global_load_dwordx4 a[112:115], v4, s[54:55] offset:2048 sc1
    v_pk_fma_f32 v[134:135], v[134:135], s[84:85], s[84:85] op_sel:[0,1,0] op_sel_hi:[1,1,0]
    v_pk_fma_f32 v[136:137], v[136:137], s[84:85], s[84:85] op_sel:[0,1,0] op_sel_hi:[1,1,0]
    v_pk_fma_f32 v[138:139], v[138:139], s[84:85], s[84:85] op_sel:[0,1,0] op_sel_hi:[1,1,0]
    v_pk_fma_f32 v[140:141], v[140:141], s[84:85], s[84:85] op_sel:[0,1,0] op_sel_hi:[1,1,0]
    v_pk_fma_f32 v[142:143], v[142:143], s[84:85], s[84:85] op_sel:[0,1,0] op_sel_hi:[1,1,0]
    global_load_dwordx4 a[116:119], v7, s[60:61] offset:2048 sc1
    v_pk_fma_f32 v[144:145], v[144:145], s[84:85], s[84:85] op_sel:[0,1,0] op_sel_hi:[1,1,0]
    v_pk_fma_f32 v[146:147], v[146:147], s[84:85], s[84:85] op_sel:[0,1,0] op_sel_hi:[1,1,0]
    v_pk_fma_f32 v[148:149], v[148:149], s[84:85], s[84:85] op_sel:[0,1,0] op_sel_hi:[1,1,0]
    v_pk_fma_f32 v[150:151], v[150:151], s[84:85], s[84:85] op_sel:[0,1,0] op_sel_hi:[1,1,0]
    global_load_dwordx4 a[120:123], v4, s[54:55] offset:3072 sc1
    v_pk_fma_f32 v[152:153], v[152:153], s[84:85], s[84:85] op_sel:[0,1,0] op_sel_hi:[1,1,0]
    v_pk_fma_f32 v[154:155], v[154:155], s[84:85], s[84:85] op_sel:[0,1,0] op_sel_hi:[1,1,0]
    v_pk_fma_f32 v[156:157], v[156:157], s[84:85], s[84:85] op_sel:[0,1,0] op_sel_hi:[1,1,0]
    v_pk_fma_f32 v[158:159], v[158:159], s[84:85], s[84:85] op_sel:[0,1,0] op_sel_hi:[1,1,0]
    global_load_dwordx4 a[124:127], v7, s[60:61] offset:3072 sc1
    v_pk_fma_f32 v[160:161], v[160:161], s[84:85], s[84:85] op_sel:[0,1,0] op_sel_hi:[1,1,0]
    v_pk_mul_f32 v[130:131], v[130:131], v[178:179] op_sel:[0,0] op_sel_hi:[1,1]
    v_pk_mul_f32 v[132:133], v[132:133], v[180:181] op_sel:[0,0] op_sel_hi:[1,1]
    v_pk_mul_f32 v[134:135], v[134:135], v[182:183] op_sel:[0,0] op_sel_hi:[1,1]
    v_pk_mul_f32 v[136:137], v[136:137], v[184:185] op_sel:[0,0] op_sel_hi:[1,1]
    global_load_dwordx4 a[128:131], v4, s[56:57] offset:-4096 sc1
    v_pk_mul_f32 v[138:139], v[138:139], v[186:187] op_sel:[0,0] op_sel_hi:[1,1]
    v_pk_mul_f32 v[140:141], v[140:141], v[188:189] op_sel:[0,0] op_sel_hi:[1,1]
    v_pk_mul_f32 v[142:143], v[142:143], v[190:191] op_sel:[0,0] op_sel_hi:[1,1]
    v_pk_mul_f32 v[144:145], v[144:145], v[192:193] op_sel:[0,0] op_sel_hi:[1,1]
    global_load_dwordx4 a[132:135], v7, s[62:63] offset:-4096 sc1
    v_pk_mul_f32 v[146:147], v[146:147], v[194:195] op_sel:[0,0] op_sel_hi:[1,1]
    v_pk_mul_f32 v[148:149], v[148:149], v[196:197] op_sel:[0,0] op_sel_hi:[1,1]
    v_pk_mul_f32 v[150:151], v[150:151], v[198:199] op_sel:[0,0] op_sel_hi:[1,1]
    v_pk_mul_f32 v[152:153], v[152:153], v[200:201] op_sel:[0,0] op_sel_hi:[1,1]
    global_load_dwordx4 a[136:139], v4, s[56:57] offset:-3072 sc1
    v_pk_mul_f32 v[154:155], v[154:155], v[202:203] op_sel:[0,0] op_sel_hi:[1,1]
    v_pk_mul_f32 v[156:157], v[156:157], v[204:205] op_sel:[0,0] op_sel_hi:[1,1]
    v_pk_mul_f32 v[158:159], v[158:159], v[206:207] op_sel:[0,0] op_sel_hi:[1,1]
    v_pk_mul_f32 v[160:161], v[160:161], v[208:209] op_sel:[0,0] op_sel_hi:[1,1]
    v_exp_f32 v130, v130
    global_load_dwordx4 a[140:143], v7, s[62:63] offset:-3072 sc1
    v_exp_f32 v131, v131
    v_exp_f32 v132, v132
    v_exp_f32 v133, v133
    v_exp_f32 v134, v134
    global_load_dwordx4 a[144:147], v4, s[56:57] offset:-2048 sc1
    v_exp_f32 v135, v135
    v_exp_f32 v136, v136
    v_exp_f32 v137, v137
    v_exp_f32 v138, v138
    global_load_dwordx4 a[148:151], v7, s[62:63] offset:-2048 sc1
    v_exp_f32 v139, v139
    v_exp_f32 v140, v140
    v_exp_f32 v141, v141
    v_exp_f32 v142, v142
    v_exp_f32 v143, v143
    global_load_dwordx4 a[152:155], v4, s[56:57] offset:-1024 sc1
    v_exp_f32 v144, v144
    v_exp_f32 v145, v145
    v_exp_f32 v146, v146
    v_exp_f32 v147, v147
    global_load_dwordx4 a[156:159], v7, s[62:63] offset:-1024 sc1
    v_exp_f32 v148, v148
    v_exp_f32 v149, v149
    v_exp_f32 v150, v150
    v_exp_f32 v151, v151
    ds_read_b128 a[224:227], v82 offset:0
    v_exp_f32 v152, v152
    v_exp_f32 v153, v153
    v_exp_f32 v154, v154
    v_exp_f32 v155, v155
    v_exp_f32 v156, v156
    ds_read_b128 a[228:231], v84 offset:0
    v_exp_f32 v157, v157
    v_exp_f32 v158, v158
    v_exp_f32 v159, v159
    v_exp_f32 v160, v160
    ds_read_b128 a[232:235], v86 offset:0
    v_exp_f32 v161, v161
    v_pk_add_f32 v[130:131], v[130:131], 1.0 op_sel:[0,0] op_sel_hi:[1,0]
    v_pk_add_f32 v[132:133], v[132:133], 1.0 op_sel:[0,0] op_sel_hi:[1,0]
    v_pk_add_f32 v[134:135], v[134:135], 1.0 op_sel:[0,0] op_sel_hi:[1,0]
    ds_read_b128 a[236:239], v88 offset:0
    v_pk_add_f32 v[136:137], v[136:137], 1.0 op_sel:[0,0] op_sel_hi:[1,0]
    v_pk_add_f32 v[138:139], v[138:139], 1.0 op_sel:[0,0] op_sel_hi:[1,0]
    v_pk_add_f32 v[140:141], v[140:141], 1.0 op_sel:[0,0] op_sel_hi:[1,0]
    v_pk_add_f32 v[142:143], v[142:143], 1.0 op_sel:[0,0] op_sel_hi:[1,0]
    v_pk_add_f32 v[144:145], v[144:145], 1.0 op_sel:[0,0] op_sel_hi:[1,0]
    ds_read_b128 a[240:243], v83 offset:0
    v_pk_add_f32 v[146:147], v[146:147], 1.0 op_sel:[0,0] op_sel_hi:[1,0]
    v_pk_add_f32 v[148:149], v[148:149], 1.0 op_sel:[0,0] op_sel_hi:[1,0]
    v_pk_add_f32 v[150:151], v[150:151], 1.0 op_sel:[0,0] op_sel_hi:[1,0]
    v_pk_add_f32 v[152:153], v[152:153], 1.0 op_sel:[0,0] op_sel_hi:[1,0]
    ds_read_b128 a[244:247], v85 offset:0
    v_pk_add_f32 v[154:155], v[154:155], 1.0 op_sel:[0,0] op_sel_hi:[1,0]
    v_pk_add_f32 v[156:157], v[156:157], 1.0 op_sel:[0,0] op_sel_hi:[1,0]
    v_pk_add_f32 v[158:159], v[158:159], 1.0 op_sel:[0,0] op_sel_hi:[1,0]
    v_pk_add_f32 v[160:161], v[160:161], 1.0 op_sel:[0,0] op_sel_hi:[1,0]
    v_rcp_f32 v130, v130
    ds_read_b128 a[248:251], v87 offset:0
    v_rcp_f32 v131, v131
    v_rcp_f32 v132, v132
    v_rcp_f32 v133, v133
    v_rcp_f32 v134, v134
    ds_read_b128 a[252:255], v89 offset:0
    v_rcp_f32 v135, v135
    v_rcp_f32 v136, v136
    v_rcp_f32 v137, v137
    v_rcp_f32 v138, v138
    s_waitcnt lgkmcnt(0)
    s_add_u32 m0, s89, 0
    s_nop 0
    global_load_lds_dwordx4 v74, s[72:73] offset:0
    v_rcp_f32 v139, v139
    v_rcp_f32 v140, v140
    v_rcp_f32 v141, v141
    v_rcp_f32 v142, v142
    v_rcp_f32 v143, v143
    global_load_lds_dwordx4 v75, s[72:73] offset:1024
    v_rcp_f32 v144, v144
    v_rcp_f32 v145, v145
    v_rcp_f32 v146, v146
    v_rcp_f32 v147, v147
    global_load_lds_dwordx4 v76, s[72:73] offset:2048
    v_rcp_f32 v148, v148
    v_rcp_f32 v149, v149
    v_rcp_f32 v150, v150
    v_rcp_f32 v151, v151
    global_load_lds_dwordx4 v77, s[72:73] offset:3072
    v_rcp_f32 v152, v152
    v_rcp_f32 v153, v153
    v_rcp_f32 v154, v154
    v_rcp_f32 v155, v155
    v_rcp_f32 v156, v156
    s_add_u32 m0, s89, 4096
    s_nop 0
    global_load_lds_dwordx4 v78, s[72:73] offset:0
    v_rcp_f32 v157, v157
    v_rcp_f32 v158, v158
    v_rcp_f32 v159, v159
    v_rcp_f32 v160, v160
    global_load_lds_dwordx4 v79, s[72:73] offset:1024
    v_rcp_f32 v161, v161
    v_pk_mul_f32 v[178:179], v[178:179], v[130:131] op_sel:[0,0] op_sel_hi:[1,1]
    v_pk_mul_f32 v[180:181], v[180:181], v[132:133] op_sel:[0,0] op_sel_hi:[1,1]
    v_pk_mul_f32 v[182:183], v[182:183], v[134:135] op_sel:[0,0] op_sel_hi:[1,1]
    global_load_lds_dwordx4 v80, s[72:73] offset:2048
    v_pk_mul_f32 v[184:185], v[184:185], v[136:137] op_sel:[0,0] op_sel_hi:[1,1]
    v_pk_mul_f32 v[186:187], v[186:187], v[138:139] op_sel:[0,0] op_sel_hi:[1,1]
    v_pk_mul_f32 v[188:189], v[188:189], v[140:141] op_sel:[0,0] op_sel_hi:[1,1]
    v_pk_mul_f32 v[190:191], v[190:191], v[142:143] op_sel:[0,0] op_sel_hi:[1,1]
    v_pk_mul_f32 v[192:193], v[192:193], v[144:145] op_sel:[0,0] op_sel_hi:[1,1]
    global_load_lds_dwordx4 v81, s[72:73] offset:3072
    v_pk_mul_f32 v[194:195], v[194:195], v[146:147] op_sel:[0,0] op_sel_hi:[1,1]
    v_pk_mul_f32 v[196:197], v[196:197], v[148:149] op_sel:[0,0] op_sel_hi:[1,1]
    v_pk_mul_f32 v[198:199], v[198:199], v[150:151] op_sel:[0,0] op_sel_hi:[1,1]
    v_pk_mul_f32 v[200:201], v[200:201], v[152:153] op_sel:[0,0] op_sel_hi:[1,1]
    s_waitcnt vmcnt(48)
    ds_read_b128 a[192:195], v82 offset:8192
    v_pk_mul_f32 v[202:203], v[202:203], v[154:155] op_sel:[0,0] op_sel_hi:[1,1]
    v_pk_mul_f32 v[204:205], v[204:205], v[156:157] op_sel:[0,0] op_sel_hi:[1,1]
    v_pk_mul_f32 v[206:207], v[206:207], v[158:159] op_sel:[0,0] op_sel_hi:[1,1]
    v_pk_mul_f32 v[208:209], v[208:209], v[160:161] op_sel:[0,0] op_sel_hi:[1,1]
    ds_read_b128 a[196:199], v84 offset:8192
    v_pk_add_f32 v[130:131], v[178:179], v[194:195] op_sel:[0,0] op_sel_hi:[1,1]
    v_pk_mul_f32 v[146:147], v[178:179], v[178:179] op_sel:[0,0] op_sel_hi:[1,1]
    v_pk_add_f32 v[132:133], v[180:181], v[196:197] op_sel:[0,0] op_sel_hi:[1,1]
    v_pk_mul_f32 v[148:149], v[180:181], v[180:181] op_sel:[0,0] op_sel_hi:[1,1]
    v_pk_add_f32 v[134:135], v[182:183], v[198:199] op_sel:[0,0] op_sel_hi:[1,1]
    ds_read_b128 a[200:203], v86 offset:8192
    v_pk_mul_f32 v[150:151], v[182:183], v[182:183] op_sel:[0,0] op_sel_hi:[1,1]
    v_pk_add_f32 v[136:137], v[184:185], v[200:201] op_sel:[0,0] op_sel_hi:[1,1]
    v_pk_mul_f32 v[152:153], v[184:185], v[184:185] op_sel:[0,0] op_sel_hi:[1,1]
    v_pk_add_f32 v[138:139], v[186:187], v[202:203] op_sel:[0,0] op_sel_hi:[1,1]
    ds_read_b128 a[204:207], v88 offset:8192
    v_pk_mul_f32 v[154:155], v[186:187], v[186:187] op_sel:[0,0] op_sel_hi:[1,1]
    v_pk_add_f32 v[140:141], v[188:189], v[204:205] op_sel:[0,0] op_sel_hi:[1,1]
    v_pk_mul_f32 v[156:157], v[188:189], v[188:189] op_sel:[0,0] op_sel_hi:[1,1]
    v_pk_add_f32 v[142:143], v[190:191], v[206:207] op_sel:[0,0] op_sel_hi:[1,1]
    ds_read_b128 a[208:211], v83 offset:8192
    v_pk_mul_f32 v[158:159], v[190:191], v[190:191] op_sel:[0,0] op_sel_hi:[1,1]
    v_pk_add_f32 v[144:145], v[192:193], v[208:209] op_sel:[0,0] op_sel_hi:[1,1]
    v_pk_mul_f32 v[160:161], v[192:193], v[192:193] op_sel:[0,0] op_sel_hi:[1,1]
    v_pk_fma_f32 v[146:147], v[194:195], v[194:195], v[146:147] op_sel:[0,0,0] op_sel_hi:[1,1,1]
    v_pk_fma_f32 v[148:149], v[196:197], v[196:197], v[148:149] op_sel:[0,0,0] op_sel_hi:[1,1,1]
    ds_read_b128 a[212:215], v85 offset:8192
    v_pk_fma_f32 v[150:151], v[198:199], v[198:199], v[150:151] op_sel:[0,0,0] op_sel_hi:[1,1,1]
    v_pk_fma_f32 v[152:153], v[200:201], v[200:201], v[152:153] op_sel:[0,0,0] op_sel_hi:[1,1,1]
    v_pk_fma_f32 v[154:155], v[202:203], v[202:203], v[154:155] op_sel:[0,0,0] op_sel_hi:[1,1,1]
    v_pk_fma_f32 v[156:157], v[204:205], v[204:205], v[156:157] op_sel:[0,0,0] op_sel_hi:[1,1,1]
    ds_read_b128 a[216:219], v87 offset:8192
    v_pk_fma_f32 v[158:159], v[206:207], v[206:207], v[158:159] op_sel:[0,0,0] op_sel_hi:[1,1,1]
    v_pk_fma_f32 v[160:161], v[208:209], v[208:209], v[160:161] op_sel:[0,0,0] op_sel_hi:[1,1,1]
    v_add_f32_dpp v98, v130, v130 row_ror:8 row_mask:0xf bank_mask:0x3
    v_add_f32_dpp v99, v131, v131 row_ror:8 row_mask:0xf bank_mask:0x3
    ds_read_b128 a[220:223], v89 offset:8192
    v_add_f32_dpp v100, v132, v132 row_ror:8 row_mask:0xf bank_mask:0x3
    v_add_f32_dpp v101, v133, v133 row_ror:8 row_mask:0xf bank_mask:0x3
    v_add_f32_dpp v102, v134, v134 row_ror:8 row_mask:0xf bank_mask:0x3
    v_add_f32_dpp v103, v135, v135 row_ror:8 row_mask:0xf bank_mask:0x3
    v_add_f32_dpp v104, v136, v136 row_ror:8 row_mask:0xf bank_mask:0x3
    s_waitcnt lgkmcnt(0)
    s_add_u32 m0, s89, 8192
    s_nop 0
    global_load_lds_dwordx4 v74, s[74:75] offset:0
    v_add_f32_dpp v105, v137, v137 row_ror:8 row_mask:0xf bank_mask:0x3
    v_add_f32_dpp v106, v138, v138 row_ror:8 row_mask:0xf bank_mask:0x3
    v_add_f32_dpp v107, v139, v139 row_ror:8 row_mask:0xf bank_mask:0x3
    v_add_f32_dpp v108, v140, v140 row_ror:8 row_mask:0xf bank_mask:0x3
    global_load_lds_dwordx4 v75, s[74:75] offset:1024
    v_add_f32_dpp v109, v141, v141 row_ror:8 row_mask:0xf bank_mask:0x3
    v_add_f32_dpp v110, v142, v142 row_ror:8 row_mask:0xf bank_mask:0x3
    v_add_f32_dpp v111, v143, v143 row_ror:8 row_mask:0xf bank_mask:0x3
    v_add_f32_dpp v112, v144, v144 row_ror:8 row_mask:0xf bank_mask:0x3
    global_load_lds_dwordx4 v76, s[74:75] offset:2048
    v_add_f32_dpp v113, v145, v145 row_ror:8 row_mask:0xf bank_mask:0x3
    v_add_f32_dpp v98, v146, v146 row_ror:8 row_mask:0xf bank_mask:0xc
    v_add_f32_dpp v99, v147, v147 row_ror:8 row_mask:0xf bank_mask:0xc
    v_add_f32_dpp v100, v148, v148 row_ror:8 row_mask:0xf bank_mask:0xc
    v_add_f32_dpp v101, v149, v149 row_ror:8 row_mask:0xf bank_mask:0xc
    global_load_lds_dwordx4 v77, s[74:75] offset:3072
    v_add_f32_dpp v102, v150, v150 row_ror:8 row_mask:0xf bank_mask:0xc
    v_add_f32_dpp v103, v151, v151 row_ror:8 row_mask:0xf bank_mask:0xc
    v_add_f32_dpp v104, v152, v152 row_ror:8 row_mask:0xf bank_mask:0xc
    v_add_f32_dpp v105, v153, v153 row_ror:8 row_mask:0xf bank_mask:0xc
    s_add_u32 m0, s89, 12288
    s_nop 0
    global_load_lds_dwordx4 v78, s[74:75] offset:0
    v_add_f32_dpp v106, v154, v154 row_ror:8 row_mask:0xf bank_mask:0xc
    v_add_f32_dpp v107, v155, v155 row_ror:8 row_mask:0xf bank_mask:0xc
    v_add_f32_dpp v108, v156, v156 row_ror:8 row_mask:0xf bank_mask:0xc
    v_add_f32_dpp v109, v157, v157 row_ror:8 row_mask:0xf bank_mask:0xc
    global_load_lds_dwordx4 v79, s[74:75] offset:1024
    v_add_f32_dpp v110, v158, v158 row_ror:8 row_mask:0xf bank_mask:0xc
    v_add_f32_dpp v111, v159, v159 row_ror:8 row_mask:0xf bank_mask:0xc
    v_add_f32_dpp v112, v160, v160 row_ror:8 row_mask:0xf bank_mask:0xc
    v_add_f32_dpp v113, v161, v161 row_ror:8 row_mask:0xf bank_mask:0xc
    v_add_f32_dpp v130, v98, v98 row_half_mirror row_mask:0xf bank_mask:0x5
    global_load_lds_dwordx4 v80, s[74:75] offset:2048
    v_add_f32_dpp v131, v99, v99 row_half_mirror row_mask:0xf bank_mask:0x5
    v_add_f32_dpp v132, v100, v100 row_half_mirror row_mask:0xf bank_mask:0x5
    v_add_f32_dpp v133, v101, v101 row_half_mirror row_mask:0xf bank_mask:0x5
    v_add_f32_dpp v134, v102, v102 row_half_mirror row_mask:0xf bank_mask:0x5
    global_load_lds_dwordx4 v81, s[74:75] offset:3072
    v_add_f32_dpp v135, v103, v103 row_half_mirror row_mask:0xf bank_mask:0x5
    v_add_f32_dpp v136, v104, v104 row_half_mirror row_mask:0xf bank_mask:0x5
    v_add_f32_dpp v137, v105, v105 row_half_mirror row_mask:0xf bank_mask:0x5
    v_add_f32_dpp v130, v106, v106 row_half_mirror row_mask:0xf bank_mask:0xa
    v_add_f32_dpp v131, v107, v107 row_half_mirror row_mask:0xf bank_mask:0xa
    v_add_f32_dpp v132, v108, v108 row_half_mirror row_mask:0xf bank_mask:0xa
    v_add_f32_dpp v133, v109, v109 row_half_mirror row_mask:0xf bank_mask:0xa
    v_add_f32_dpp v134, v110, v110 row_half_mirror row_mask:0xf bank_mask:0xa
    v_add_f32_dpp v135, v111, v111 row_half_mirror row_mask:0xf bank_mask:0xa
    v_add_f32_dpp v136, v112, v112 row_half_mirror row_mask:0xf bank_mask:0xa
    v_add_f32_dpp v137, v113, v113 row_half_mirror row_mask:0xf bank_mask:0xa
    v_add_f32_dpp v130, v130, v130 quad_perm:[1,0,3,2] row_mask:0xf bank_mask:0xf
    v_add_f32_dpp v131, v131, v131 quad_perm:[1,0,3,2] row_mask:0xf bank_mask:0xf
    v_add_f32_dpp v132, v132, v132 quad_perm:[1,0,3,2] row_mask:0xf bank_mask:0xf
    v_add_f32_dpp v133, v133, v133 quad_perm:[1,0,3,2] row_mask:0xf bank_mask:0xf
    v_add_f32_dpp v134, v134, v134 quad_perm:[1,0,3,2] row_mask:0xf bank_mask:0xf
    v_add_f32_dpp v135, v135, v135 quad_perm:[1,0,3,2] row_mask:0xf bank_mask:0xf
    v_add_f32_dpp v136, v136, v136 quad_perm:[1,0,3,2] row_mask:0xf bank_mask:0xf
    v_add_f32_dpp v137, v137, v137 quad_perm:[1,0,3,2] row_mask:0xf bank_mask:0xf
    v_add_f32_dpp v130, v130, v130 quad_perm:[2,3,0,1] row_mask:0xf bank_mask:0xf
    v_add_f32_dpp v131, v131, v131 quad_perm:[2,3,0,1] row_mask:0xf bank_mask:0xf
    v_add_f32_dpp v132, v132, v132 quad_perm:[2,3,0,1] row_mask:0xf bank_mask:0xf
    v_add_f32_dpp v133, v133, v133 quad_perm:[2,3,0,1] row_mask:0xf bank_mask:0xf
    v_add_f32_dpp v134, v134, v134 quad_perm:[2,3,0,1] row_mask:0xf bank_mask:0xf
    v_add_f32_dpp v135, v135, v135 quad_perm:[2,3,0,1] row_mask:0xf bank_mask:0xf
    v_add_f32_dpp v136, v136, v136 quad_perm:[2,3,0,1] row_mask:0xf bank_mask:0xf
    v_add_f32_dpp v137, v137, v137 quad_perm:[2,3,0,1] row_mask:0xf bank_mask:0xf
    v_lshrrev_b32 v28, 2, v2
    v_lshl_add_u32 v28, v28, 7, v171
    ds_write_b128 v28, v[130:133]
    ds_write_b128 v28, v[134:137] offset:16
    s_waitcnt lgkmcnt(0)
    s_barrier
    v_lshlrev_b32 v28, 2, v1
    v_add_u32 v28, 150784, v28
    ds_read2st64_b32 v[90:91], v28 offset0:0 offset1:1
    ds_read2st64_b32 v[92:93], v28 offset0:2 offset1:3
    ds_read2st64_b32 v[94:95], v28 offset0:4 offset1:5
    ds_read2st64_b32 v[96:97], v28 offset0:6 offset1:7
    s_lshl_b32 s4, s40, 12
    s_add_u32 s4, s4, 12451840
    v_add_u32 v174, s4, v30
    s_lshl_b32 s4, s41, 9
    v_add_u32 v28, s4, v174
    v_subrev_u32 v170, 2048, v170
    v_subrev_u32 v171, 2048, v171
    s_waitcnt lgkmcnt(2)
    v_pk_add_f32 v[90:91], v[90:91], v[92:93] op_sel:[0,0] op_sel_hi:[1,1]
    s_waitcnt lgkmcnt(0)
    v_pk_add_f32 v[94:95], v[94:95], v[96:97] op_sel:[0,0] op_sel_hi:[1,1]
    v_pk_add_f32 v[90:91], v[90:91], v[94:95] op_sel:[0,0] op_sel_hi:[1,1]
    v_min_u32 v90, -2, v90
    v_min_u32 v91, -2, v91
    s_lshl_b32 s4, s3, 4
    s_lshl_b64 exec, 0xffff, s4
    global_store_dwordx2 v28, v[90:91], s[38:39] sc1
    s_mov_b64 exec, -1
    ds_read_b128 v[48:51], v4 offset:0
    ds_read_b128 v[52:55], v4 offset:1040
    ds_read_b128 v[56:59], v4 offset:2080
    ds_read_b128 v[60:63], v4 offset:3120
    ds_read_b128 v[64:67], v4 offset:4160
    s_waitcnt lgkmcnt(3)
    s_waitcnt vmcnt(56)
    v_mfma_f32_16x16x32_bf16 v[210:213], a[0:3], v[48:51], 0
    ds_read_b128 v[68:71], v4 offset:5200
    s_waitcnt vmcnt(55)
    v_mfma_f32_16x16x32_bf16 v[226:229], a[4:7], v[48:51], 0
    v_mfma_f32_16x16x32_bf16 v[214:217], a[0:3], v[52:55], 0
    ds_read_b128 v[48:51], v4 offset:6240
    s_waitcnt vmcnt(9)
    ds_read_b128 a[160:163], v82 offset:0
    v_mfma_f32_16x16x32_bf16 v[230:233], a[4:7], v[52:55], 0
    v_min_u32 v175, 26, v1
    s_waitcnt lgkmcnt(4)
    v_mfma_f32_16x16x32_bf16 v[218:221], a[0:3], v[56:59], 0
    ds_read_b128 v[52:55], v4 offset:7280
    v_lshlrev_b32 v175, 7, v175
    v_mfma_f32_16x16x32_bf16 v[234:237], a[4:7], v[56:59], 0
    ds_read_b128 a[164:167], v84 offset:0
    v_mfma_f32_16x16x32_bf16 v[222:225], a[0:3], v[60:63], 0
    ds_read_b128 v[56:59], v4 offset:8320
    v_add_u32 v175, 98304, v175
    v_mfma_f32_16x16x32_bf16 v[238:241], a[4:7], v[60:63], 0
    ds_read_b128 a[168:171], v86 offset:0
    s_waitcnt lgkmcnt(6)
    v_mfma_f32_16x16x32_bf16 v[210:213], a[8:11], v[64:67], v[210:213]
    ds_read_b128 v[60:63], v4 offset:9360
    ds_read_b128 a[172:175], v88 offset:0
    v_mfma_f32_16x16x32_bf16 v[226:229], a[12:15], v[64:67], v[226:229]
    global_load_dword v250, v175, s[38:39] sc1
    v_mfma_f32_16x16x32_bf16 v[214:217], a[8:11], v[68:71], v[214:217]
    ds_read_b128 v[64:67], v4 offset:10400
    ds_read_b128 a[176:179], v83 offset:0
    s_mul_i32 s7, s41, 320
    v_mfma_f32_16x16x32_bf16 v[230:233], a[12:15], v[68:71], v[230:233]
    ds_read_b128 a[180:183], v85 offset:0
    s_waitcnt lgkmcnt(8)
    v_mfma_f32_16x16x32_bf16 v[218:221], a[8:11], v[48:51], v[218:221]
    ds_read_b128 v[68:71], v4 offset:11440
    s_add_u32 s7, s7, 12800
    v_mfma_f32_16x16x32_bf16 v[234:237], a[12:15], v[48:51], v[234:237]
    ds_read_b128 a[184:187], v87 offset:0
    v_mfma_f32_16x16x32_bf16 v[222:225], a[8:11], v[52:55], v[222:225]
    ds_read_b128 v[48:51], v4 offset:12480
    v_min_u32 v175, 304, v4
    v_mfma_f32_16x16x32_bf16 v[238:241], a[12:15], v[52:55], v[238:241]
    ds_read_b128 a[188:191], v89 offset:0
    s_waitcnt lgkmcnt(8)
    v_mfma_f32_16x16x32_bf16 v[210:213], a[16:19], v[56:59], v[210:213]
    ds_read_b128 v[52:55], v4 offset:13520
    s_waitcnt lgkmcnt(1)
    s_add_u32 m0, s89, 0
    v_mfma_f32_16x16x32_bf16 v[226:229], a[20:23], v[56:59], v[226:229]
    v_add_u32 v175, s7, v175
    v_mfma_f32_16x16x32_bf16 v[214:217], a[16:19], v[60:63], v[214:217]
    ds_read_b128 v[56:59], v4 offset:14560
    global_load_dwordx4 v[242:245], v175, s[38:39] sc1
    v_mfma_f32_16x16x32_bf16 v[230:233], a[20:23], v[60:63], v[230:233]
    global_load_lds_dwordx4 v74, s[76:77] offset:0
    v_mfma_f32_16x16x32_bf16 v[218:221], a[16:19], v[64:67], v[218:221]
    ds_read_b128 v[60:63], v4 offset:15600
    v_add_u32 v175, 15360, v175
    v_mfma_f32_16x16x32_bf16 v[234:237], a[20:23], v[64:67], v[234:237]
    global_load_lds_dwordx4 v75, s[76:77] offset:1024
    v_mfma_f32_16x16x32_bf16 v[222:225], a[16:19], v[68:71], v[222:225]
    ds_read_b128 v[64:67], v4 offset:16640
    global_load_lds_dwordx4 v76, s[76:77] offset:2048
    v_mfma_f32_16x16x32_bf16 v[238:241], a[20:23], v[68:71], v[238:241]
    global_load_dwordx4 v[246:249], v175, s[38:39] sc1
    s_waitcnt lgkmcnt(3)
    v_mfma_f32_16x16x32_bf16 v[210:213], a[24:27], v[48:51], v[210:213]
    ds_read_b128 v[68:71], v4 offset:17680
    global_load_lds_dwordx4 v77, s[76:77] offset:3072
    v_mfma_f32_16x16x32_bf16 v[226:229], a[28:31], v[48:51], v[226:229]
    ds_read_b128 v[36:39], v46 offset:0
    v_mfma_f32_16x16x32_bf16 v[214:217], a[24:27], v[52:55], v[214:217]
    ds_read_b128 v[48:51], v4 offset:18720
    s_add_u32 m0, s89, 4096
    ds_read_b128 v[40:43], v46 offset:4160
    v_mfma_f32_16x16x32_bf16 v[230:233], a[28:31], v[52:55], v[230:233]
    global_load_lds_dwordx4 v78, s[76:77] offset:0
    s_waitcnt lgkmcnt(5)
    v_mfma_f32_16x16x32_bf16 v[218:221], a[24:27], v[56:59], v[218:221]
    ds_read_b128 v[52:55], v4 offset:19760
    ds_read_b64 v[44:45], v47 offset:8320
    v_mfma_f32_16x16x32_bf16 v[234:237], a[28:31], v[56:59], v[234:237]
    global_load_lds_dwordx4 v79, s[76:77] offset:1024
    v_mfma_f32_16x16x32_bf16 v[222:225], a[24:27], v[60:63], v[222:225]
    ds_read_b128 v[56:59], v4 offset:20800
    global_load_lds_dwordx4 v80, s[76:77] offset:2048
    v_mfma_f32_16x16x32_bf16 v[238:241], a[28:31], v[60:63], v[238:241]
    s_waitcnt vmcnt(8)
    v_max3_u32 v28, v242, v243, v244
    s_waitcnt lgkmcnt(6)
    v_mfma_f32_16x16x32_bf16 v[210:213], a[32:35], v[64:67], v[210:213]
    ds_read_b128 v[60:63], v4 offset:21840
    global_load_lds_dwordx4 v81, s[76:77] offset:3072
    v_mfma_f32_16x16x32_bf16 v[226:229], a[36:39], v[64:67], v[226:229]
    s_waitcnt vmcnt(5)
    v_max3_u32 v28, v245, v246, v28
    v_mfma_f32_16x16x32_bf16 v[214:217], a[32:35], v[68:71], v[214:217]
    ds_read_b128 v[64:67], v4 offset:22880
    ds_read_b128 a[0:3], v82 offset:8192
    v_mfma_f32_16x16x32_bf16 v[230:233], a[36:39], v[68:71], v[230:233]
    v_max3_u32 v28, v247, v248, v28
    s_waitcnt lgkmcnt(5)
    v_mfma_f32_16x16x32_bf16 v[218:221], a[32:35], v[48:51], v[218:221]
    ds_read_b128 v[68:71], v4 offset:23920
    v_max3_u32 v28, v249, v250, v28
    v_mfma_f32_16x16x32_bf16 v[234:237], a[36:39], v[48:51], v[234:237]
    ds_read_b128 a[4:7], v84 offset:8192
    v_mfma_f32_16x16x32_bf16 v[222:225], a[32:35], v[52:55], v[222:225]
    ds_read_b128 v[48:51], v4 offset:24960
    ds_read_b128 a[8:11], v86 offset:8192
    v_mfma_f32_16x16x32_bf16 v[238:241], a[36:39], v[52:55], v[238:241]
    v_cmp_eq_u32 vcc, -1, v28
    s_waitcnt lgkmcnt(6)
    v_mfma_f32_16x16x32_bf16 v[210:213], a[40:43], v[56:59], v[210:213]
    ds_read_b128 v[52:55], v4 offset:26000
    ds_read_b128 a[12:15], v88 offset:8192
    v_mfma_f32_16x16x32_bf16 v[226:229], a[44:47], v[56:59], v[226:229]
    s_cbranch_vccnz Lgb_r
Lgb_ok:
    v_mfma_f32_16x16x32_bf16 v[214:217], a[40:43], v[60:63], v[214:217]
    ds_read_b128 v[56:59], v4 offset:27040
    ds_read_b128 a[16:19], v83 offset:8192
    v_mfma_f32_16x16x32_bf16 v[230:233], a[44:47], v[60:63], v[230:233]
    ds_read_b128 a[20:23], v85 offset:8192
    v_add_f32 v242, v242, v246
    s_waitcnt lgkmcnt(8)
    v_mfma_f32_16x16x32_bf16 v[218:221], a[40:43], v[64:67], v[218:221]
    ds_read_b128 v[60:63], v4 offset:28080
    v_mfma_f32_16x16x32_bf16 v[234:237], a[44:47], v[64:67], v[234:237]
    ds_read_b128 a[24:27], v87 offset:8192
    v_add_f32 v243, v243, v247
    v_mfma_f32_16x16x32_bf16 v[222:225], a[40:43], v[68:71], v[222:225]
    ds_read_b128 v[64:67], v4 offset:29120
    ds_read_b128 a[28:31], v89 offset:8192
    v_mfma_f32_16x16x32_bf16 v[238:241], a[44:47], v[68:71], v[238:241]
    v_add_f32 v244, v244, v248
    s_waitcnt lgkmcnt(8)
    v_mfma_f32_16x16x32_bf16 v[210:213], a[48:51], v[48:51], v[210:213]
    ds_read_b128 v[68:71], v4 offset:30160
    s_waitcnt lgkmcnt(1)
    s_add_u32 m0, s89, 8192
    v_mfma_f32_16x16x32_bf16 v[226:229], a[52:55], v[48:51], v[226:229]
    v_add_f32 v245, v245, v249
    v_mfma_f32_16x16x32_bf16 v[214:217], a[48:51], v[52:55], v[214:217]
    ds_read_b128 v[48:51], v4 offset:31200
    v_mfma_f32_16x16x32_bf16 v[230:233], a[52:55], v[52:55], v[230:233]
    global_load_lds_dwordx4 v74, s[78:79] offset:0
    v_cvt_pk_bf16_f32 v242, v242, v242
    v_mfma_f32_16x16x32_bf16 v[218:221], a[48:51], v[56:59], v[218:221]
    ds_read_b128 v[52:55], v4 offset:32240
    v_mfma_f32_16x16x32_bf16 v[234:237], a[52:55], v[56:59], v[234:237]
    global_load_lds_dwordx4 v75, s[78:79] offset:1024
    v_lshlrev_b32 v242, 16, v242
    v_mfma_f32_16x16x32_bf16 v[222:225], a[48:51], v[60:63], v[222:225]
    ds_read_b128 v[56:59], v4 offset:33280
    global_load_lds_dwordx4 v76, s[78:79] offset:2048
    v_mfma_f32_16x16x32_bf16 v[238:241], a[52:55], v[60:63], v[238:241]
    v_cvt_pk_bf16_f32 v243, v243, v243
    s_waitcnt lgkmcnt(3)
    v_mfma_f32_16x16x32_bf16 v[210:213], a[56:59], v[64:67], v[210:213]
    ds_read_b128 v[60:63], v4 offset:34320
    global_load_lds_dwordx4 v77, s[78:79] offset:3072
    v_mfma_f32_16x16x32_bf16 v[226:229], a[60:63], v[64:67], v[226:229]
    v_lshlrev_b32 v243, 16, v243
    v_mfma_f32_16x16x32_bf16 v[214:217], a[56:59], v[68:71], v[214:217]
    ds_read_b128 v[64:67], v4 offset:35360
    s_add_u32 m0, s89, 12288
    v_mfma_f32_16x16x32_bf16 v[230:233], a[60:63], v[68:71], v[230:233]
    global_load_lds_dwordx4 v78, s[78:79] offset:0
    v_cvt_pk_bf16_f32 v244, v244, v244
    s_waitcnt lgkmcnt(3)
    v_mfma_f32_16x16x32_bf16 v[218:221], a[56:59], v[48:51], v[218:221]
    ds_read_b128 v[68:71], v4 offset:36400
    v_mfma_f32_16x16x32_bf16 v[234:237], a[60:63], v[48:51], v[234:237]
    global_load_lds_dwordx4 v79, s[78:79] offset:1024
    v_lshlrev_b32 v244, 16, v244
    v_mfma_f32_16x16x32_bf16 v[222:225], a[56:59], v[52:55], v[222:225]
    ds_read_b128 v[48:51], v4 offset:37440
    global_load_lds_dwordx4 v80, s[78:79] offset:2048
    v_mfma_f32_16x16x32_bf16 v[238:241], a[60:63], v[52:55], v[238:241]
    v_cvt_pk_bf16_f32 v245, v245, v245
    s_waitcnt lgkmcnt(3)
    v_mfma_f32_16x16x32_bf16 v[210:213], a[64:67], v[56:59], v[210:213]
    ds_read_b128 v[52:55], v4 offset:38480
    global_load_lds_dwordx4 v81, s[78:79] offset:3072
    v_mfma_f32_16x16x32_bf16 v[226:229], a[68:71], v[56:59], v[226:229]
    v_lshlrev_b32 v245, 16, v245
    v_mfma_f32_16x16x32_bf16 v[214:217], a[64:67], v[60:63], v[214:217]
    ds_read_b128 v[56:59], v4 offset:39520
    s_waitcnt vmcnt(8)
    ds_read_b128 a[32:35], v82 offset:0
    v_mfma_f32_16x16x32_bf16 v[230:233], a[68:71], v[60:63], v[230:233]
    v_min_u32 v175, 304, v4
    s_waitcnt lgkmcnt(4)
    v_mfma_f32_16x16x32_bf16 v[218:221], a[64:67], v[64:67], v[218:221]
    ds_read_b128 v[60:63], v4 offset:40560
    v_mfma_f32_16x16x32_bf16 v[234:237], a[68:71], v[64:67], v[234:237]
    ds_read_b128 a[36:39], v84 offset:0
    v_add_u32 v175, 162816, v175
    v_mfma_f32_16x16x32_bf16 v[222:225], a[64:67], v[68:71], v[222:225]
    ds_read_b128 v[64:67], v173 offset:0
    ds_read_b128 a[40:43], v86 offset:0
    v_mfma_f32_16x16x32_bf16 v[238:241], a[68:71], v[68:71], v[238:241]
    s_waitcnt lgkmcnt(6)
    v_mfma_f32_16x16x32_bf16 v[210:213], a[72:75], v[48:51], v[210:213]
    ds_read_b128 v[68:71], v173 offset:1040
    ds_read_b128 a[44:47], v88 offset:0
    v_mfma_f32_16x16x32_bf16 v[226:229], a[76:79], v[48:51], v[226:229]
    ds_write_b128 v175, v[242:245]
    v_mfma_f32_16x16x32_bf16 v[214:217], a[72:75], v[52:55], v[214:217]
    ds_read_b128 v[48:51], v173 offset:2080
    ds_read_b128 a[48:51], v83 offset:0
    v_mfma_f32_16x16x32_bf16 v[230:233], a[76:79], v[52:55], v[230:233]
    ds_read_b128 a[52:55], v85 offset:0
    s_waitcnt lgkmcnt(9)
    v_mfma_f32_16x16x32_bf16 v[218:221], a[72:75], v[56:59], v[218:221]
    ds_read_b128 v[52:55], v173 offset:3120
    v_mfma_f32_16x16x32_bf16 v[234:237], a[76:79], v[56:59], v[234:237]
    ds_read_b128 a[56:59], v87 offset:0
    v_mfma_f32_16x16x32_bf16 v[222:225], a[72:75], v[60:63], v[222:225]
    ds_read_b128 v[56:59], v173 offset:4160
    global_load_dwordx2 v[130:131], v174, s[38:39] offset:0 sc1
    v_mfma_f32_16x16x32_bf16 v[238:241], a[76:79], v[60:63], v[238:241]
    global_load_dwordx2 v[132:133], v174, s[38:39] offset:512 sc1
    ds_read_b128 a[60:63], v89 offset:0
    s_waitcnt lgkmcnt(9)
    v_mfma_f32_16x16x32_bf16 v[210:213], a[80:83], v[64:67], v[210:213]
    ds_read_b128 v[60:63], v173 offset:5200
    global_load_dwordx2 v[134:135], v174, s[38:39] offset:1024 sc1
    v_mfma_f32_16x16x32_bf16 v[226:229], a[84:87], v[64:67], v[226:229]
    global_load_dwordx2 v[136:137], v174, s[38:39] offset:1536 sc1
    s_waitcnt lgkmcnt(1)
    s_add_u32 m0, s89, 0
    v_mfma_f32_16x16x32_bf16 v[214:217], a[80:83], v[68:71], v[214:217]
    ds_read_b128 v[64:67], v173 offset:6240
    global_load_dwordx2 v[138:139], v174, s[38:39] offset:2048 sc1
    v_mfma_f32_16x16x32_bf16 v[230:233], a[84:87], v[68:71], v[230:233]
    global_load_dwordx2 v[140:141], v174, s[38:39] offset:2560 sc1
    global_load_dwordx2 v[142:143], v174, s[38:39] offset:3072 sc1
    v_mfma_f32_16x16x32_bf16 v[218:221], a[80:83], v[48:51], v[218:221]
    ds_read_b128 v[68:71], v173 offset:7280
    global_load_lds_dwordx4 v74, s[80:81] offset:0
    v_mfma_f32_16x16x32_bf16 v[234:237], a[84:87], v[48:51], v[234:237]
    global_load_dwordx2 v[144:145], v174, s[38:39] offset:3584 sc1
    s_bfe_u32 s6, s2, 0x30003
    global_load_lds_dwordx4 v75, s[80:81] offset:1024
    v_mfma_f32_16x16x32_bf16 v[222:225], a[80:83], v[52:55], v[222:225]
    ds_read_b128 v[48:51], v173 offset:8320
    v_mul_u32_u24 v254, 8, v0
    v_mfma_f32_16x16x32_bf16 v[238:241], a[84:87], v[52:55], v[238:241]
    v_add_lshl_u32 v254, v254, s6, 7
    global_load_lds_dwordx4 v76, s[80:81] offset:2048
    s_waitcnt lgkmcnt(3)
    v_mfma_f32_16x16x32_bf16 v[210:213], a[88:91], v[56:59], v[210:213]
    ds_read_b128 v[52:55], v173 offset:9360
    v_min_u32 v254, (Lend-Lmid-4), v254
    v_mfma_f32_16x16x32_bf16 v[226:229], a[92:95], v[56:59], v[226:229]
    v_add_u32 v254, (Lmid-adaLN_cond__ssm_conv_h3__mixer_gmlp__prompt_kernel), v254
    global_load_lds_dwordx4 v77, s[80:81] offset:3072
    v_mfma_f32_16x16x32_bf16 v[214:217], a[88:91], v[60:63], v[214:217]
    ds_read_b128 v[56:59], v173 offset:10400
    global_load_dword v254, v254, s[0:1]
    s_add_u32 m0, s89, 4096
    v_mfma_f32_16x16x32_bf16 v[230:233], a[92:95], v[60:63], v[230:233]
    global_load_lds_dwordx4 v78, s[80:81] offset:0
    s_waitcnt lgkmcnt(3)
    v_mfma_f32_16x16x32_bf16 v[218:221], a[88:91], v[64:67], v[218:221]
    ds_read_b128 v[60:63], v173 offset:11440
    v_mfma_f32_16x16x32_bf16 v[234:237], a[92:95], v[64:67], v[234:237]
    global_load_lds_dwordx4 v79, s[80:81] offset:1024
    v_mfma_f32_16x16x32_bf16 v[222:225], a[88:91], v[68:71], v[222:225]
    ds_read_b128 v[64:67], v173 offset:12480
    global_load_lds_dwordx4 v80, s[80:81] offset:2048
    v_mfma_f32_16x16x32_bf16 v[238:241], a[92:95], v[68:71], v[238:241]
    s_waitcnt lgkmcnt(3)
    v_mfma_f32_16x16x32_bf16 v[210:213], a[96:99], v[48:51], v[210:213]
    ds_read_b128 v[68:71], v173 offset:13520
    global_load_lds_dwordx4 v81, s[80:81] offset:3072
    v_mfma_f32_16x16x32_bf16 v[226:229], a[100:103], v[48:51], v[226:229]
    v_mfma_f32_16x16x32_bf16 v[214:217], a[96:99], v[52:55], v[214:217]
    ds_read_b128 v[48:51], v173 offset:14560
    s_waitcnt vmcnt(17)
    ds_read_b128 a[64:67], v82 offset:8192
    v_mfma_f32_16x16x32_bf16 v[230:233], a[100:103], v[52:55], v[230:233]
    s_waitcnt lgkmcnt(4)
    v_mfma_f32_16x16x32_bf16 v[218:221], a[96:99], v[56:59], v[218:221]
    ds_read_b128 v[52:55], v173 offset:15600
    v_mfma_f32_16x16x32_bf16 v[234:237], a[100:103], v[56:59], v[234:237]
    ds_read_b128 a[68:71], v84 offset:8192
    v_mfma_f32_16x16x32_bf16 v[222:225], a[96:99], v[60:63], v[222:225]
    ds_read_b128 v[56:59], v173 offset:16640
    ds_read_b128 a[72:75], v86 offset:8192
    v_mfma_f32_16x16x32_bf16 v[238:241], a[100:103], v[60:63], v[238:241]
    s_waitcnt lgkmcnt(6)
    v_mfma_f32_16x16x32_bf16 v[210:213], a[104:107], v[64:67], v[210:213]
    ds_read_b128 v[60:63], v173 offset:17680
    ds_read_b128 a[76:79], v88 offset:8192
    v_mfma_f32_16x16x32_bf16 v[226:229], a[108:111], v[64:67], v[226:229]
    v_mfma_f32_16x16x32_bf16 v[214:217], a[104:107], v[68:71], v[214:217]
    ds_read_b128 v[64:67], v173 offset:18720
    ds_read_b128 a[80:83], v83 offset:8192
    v_mfma_f32_16x16x32_bf16 v[230:233], a[108:111], v[68:71], v[230:233]
    ds_read_b128 a[84:87], v85 offset:8192
    s_waitcnt lgkmcnt(8)
    s_waitcnt vmcnt(15)
    v_max_u32 v28, v131, v133
    s_waitcnt vmcnt(13)
    v_max3_u32 v28, v135, v137, v28
    s_waitcnt vmcnt(11)
    v_max3_u32 v28, v139, v141, v28
    s_waitcnt vmcnt(8)
    v_max3_u32 v28, v143, v145, v28
    v_cmp_eq_u32 vcc, -1, v28
    s_nop 0
    s_cbranch_vccnz Ls3_r
Ls3_ok:
    v_pk_add_f32 v[130:131], v[130:131], v[132:133] op_sel:[0,0] op_sel_hi:[1,1]
    v_pk_add_f32 v[134:135], v[134:135], v[136:137] op_sel:[0,0] op_sel_hi:[1,1]
    v_pk_add_f32 v[138:139], v[138:139], v[140:141] op_sel:[0,0] op_sel_hi:[1,1]
    v_pk_add_f32 v[142:143], v[142:143], v[144:145] op_sel:[0,0] op_sel_hi:[1,1]
    v_pk_add_f32 v[130:131], v[130:131], v[134:135] op_sel:[0,0] op_sel_hi:[1,1]
    v_pk_add_f32 v[138:139], v[138:139], v[142:143] op_sel:[0,0] op_sel_hi:[1,1]
    v_pk_add_f32 v[130:131], v[130:131], v[138:139] op_sel:[0,0] op_sel_hi:[1,1]
    v_mul_f32 v130, 0x3a97b426, v130
    v_mul_f32 v131, 0x3a97b426, v131
    v_fma_f32 v131, -v130, v130, v131
    v_max_f32 v131, 0, v131
    v_add_f32 v131, 0x3727c5ac, v131
    v_rsq_f32 v132, v131
    s_nop 0
    v_mul_f32_e64 v131, -v130, v132
    v_mov_b32 v130, v132
    ds_write2st64_b32 v170, v130, v131 offset0:0 offset1:1
    ds_read_b128 v[98:101], v171 offset:0
    ds_read_b128 v[102:105], v171 offset:16
    ds_read_b128 v[106:109], v171 offset:128
    ds_read_b128 v[110:113], v171 offset:144
    ds_read_b128 v[114:117], v171 offset:256
    ds_read_b128 v[118:121], v171 offset:272
    ds_read_b128 v[122:125], v171 offset:384
    ds_read_b128 v[126:129], v171 offset:400
    s_lshl_b32 s4, s41, 6
    s_lshl_b32 s5, s40, 1
    s_add_u32 s4, s4, s5
    s_mul_i32 s4, s4, 7168
    s_lshl_b32 s5, s3, 11
    s_add_u32 s4, s4, s5
    s_add_u32 s4, s4, 12582912
    v_add_u32 v28, s4, v4
    v_add_u32 v29, 7168, v28
    s_waitcnt lgkmcnt(3)
    v_pk_fma_f32 v[178:179], v[178:179], v[98:99], v[114:115] op_sel:[0,0,0] op_sel_hi:[1,1,1]
    v_pk_fma_f32 v[180:181], v[180:181], v[100:101], v[116:117] op_sel:[0,0,0] op_sel_hi:[1,1,1]
    s_waitcnt lgkmcnt(2)
    v_pk_fma_f32 v[182:183], v[182:183], v[102:103], v[118:119] op_sel:[0,0,0] op_sel_hi:[1,1,1]
    v_pk_fma_f32 v[184:185], v[184:185], v[104:105], v[120:121] op_sel:[0,0,0] op_sel_hi:[1,1,1]
    v_cvt_pk_bf16_f32 v130, v178, v179
    v_cvt_pk_bf16_f32 v131, v180, v181
    v_cvt_pk_bf16_f32 v132, v182, v183
    v_cvt_pk_bf16_f32 v133, v184, v185
    v_or_b32 v133, 1, v133
    global_store_dwordx4 v28, v[130:133], s[38:39] offset:0 sc1
    s_waitcnt lgkmcnt(1)
    v_pk_fma_f32 v[186:187], v[186:187], v[106:107], v[122:123] op_sel:[0,0,0] op_sel_hi:[1,1,1]
    v_pk_fma_f32 v[188:189], v[188:189], v[108:109], v[124:125] op_sel:[0,0,0] op_sel_hi:[1,1,1]
    s_waitcnt lgkmcnt(0)
    v_pk_fma_f32 v[190:191], v[190:191], v[110:111], v[126:127] op_sel:[0,0,0] op_sel_hi:[1,1,1]
    v_pk_fma_f32 v[192:193], v[192:193], v[112:113], v[128:129] op_sel:[0,0,0] op_sel_hi:[1,1,1]
    v_cvt_pk_bf16_f32 v134, v186, v187
    v_cvt_pk_bf16_f32 v135, v188, v189
    v_cvt_pk_bf16_f32 v136, v190, v191
    v_cvt_pk_bf16_f32 v137, v192, v193
    v_or_b32 v137, 1, v137
    global_store_dwordx4 v29, v[134:137], s[38:39] offset:0 sc1
    v_pk_fma_f32 v[194:195], v[194:195], v[98:99], v[114:115] op_sel:[0,0,0] op_sel_hi:[1,1,1]
    v_pk_fma_f32 v[196:197], v[196:197], v[100:101], v[116:117] op_sel:[0,0,0] op_sel_hi:[1,1,1]
    v_pk_fma_f32 v[198:199], v[198:199], v[102:103], v[118:119] op_sel:[0,0,0] op_sel_hi:[1,1,1]
    v_pk_fma_f32 v[200:201], v[200:201], v[104:105], v[120:121] op_sel:[0,0,0] op_sel_hi:[1,1,1]
    v_cvt_pk_bf16_f32 v138, v194, v195
    v_cvt_pk_bf16_f32 v139, v196, v197
    v_cvt_pk_bf16_f32 v140, v198, v199
    v_cvt_pk_bf16_f32 v141, v200, v201
    v_or_b32 v141, 1, v141
    s_cmp_eq_u32 s3, 3
    s_cbranch_scc1 Lzs_0
    global_store_dwordx4 v28, v[138:141], s[38:39] offset:1024 sc1
Lzs_0:
    v_pk_fma_f32 v[202:203], v[202:203], v[106:107], v[122:123] op_sel:[0,0,0] op_sel_hi:[1,1,1]
    v_pk_fma_f32 v[204:205], v[204:205], v[108:109], v[124:125] op_sel:[0,0,0] op_sel_hi:[1,1,1]
    v_pk_fma_f32 v[206:207], v[206:207], v[110:111], v[126:127] op_sel:[0,0,0] op_sel_hi:[1,1,1]
    v_pk_fma_f32 v[208:209], v[208:209], v[112:113], v[128:129] op_sel:[0,0,0] op_sel_hi:[1,1,1]
    v_cvt_pk_bf16_f32 v142, v202, v203
    v_cvt_pk_bf16_f32 v143, v204, v205
    v_cvt_pk_bf16_f32 v144, v206, v207
    v_cvt_pk_bf16_f32 v145, v208, v209
    v_or_b32 v145, 1, v145
    s_cmp_eq_u32 s3, 3
    s_cbranch_scc1 Lzs_1
    global_store_dwordx4 v29, v[142:145], s[38:39] offset:1024 sc1
Lzs_1:
    v_mfma_f32_16x16x32_bf16 v[218:221], a[104:107], v[48:51], v[218:221]
    ds_read_b128 v[68:71], v173 offset:19760
    v_mfma_f32_16x16x32_bf16 v[234:237], a[108:111], v[48:51], v[234:237]
    ds_read_b128 a[88:91], v87 offset:8192
    s_mul_i32 s91, s41, 458752
    v_mfma_f32_16x16x32_bf16 v[222:225], a[104:107], v[52:55], v[222:225]
    ds_read_b128 v[48:51], v173 offset:20800
    ds_read_b128 a[92:95], v89 offset:8192
    s_add_u32 s91, s91, 12582912
    v_mfma_f32_16x16x32_bf16 v[238:241], a[108:111], v[52:55], v[238:241]
    v_mfma_f32_16x16x32_bf16 v[210:213], a[112:115], v[56:59], v[210:213]
    ds_read_b128 v[52:55], v173 offset:21840
    s_waitcnt lgkmcnt(1)
    s_add_u32 m0, s89, 8192
    v_mfma_f32_16x16x32_bf16 v[226:229], a[116:119], v[56:59], v[226:229]
    s_mul_i32 s6, s44, 14336
    v_mfma_f32_16x16x32_bf16 v[214:217], a[112:115], v[60:63], v[214:217]
    ds_read_b128 v[56:59], v173 offset:22880
    s_add_u32 s6, s6, s91
    v_mfma_f32_16x16x32_bf16 v[230:233], a[116:119], v[60:63], v[230:233]
    global_load_lds_dwordx4 v74, s[82:83] offset:0
    v_mfma_f32_16x16x32_bf16 v[218:221], a[112:115], v[64:67], v[218:221]
    ds_read_b128 v[60:63], v173 offset:23920
    s_add_u32 s52, s38, s6
    s_addc_u32 s53, s39, 0
    v_mfma_f32_16x16x32_bf16 v[234:237], a[116:119], v[64:67], v[234:237]
    global_load_lds_dwordx4 v75, s[82:83] offset:1024
    v_mfma_f32_16x16x32_bf16 v[222:225], a[112:115], v[68:71], v[222:225]
    ds_read_b128 v[64:67], v173 offset:24960
    global_load_lds_dwordx4 v76, s[82:83] offset:2048
    v_mfma_f32_16x16x32_bf16 v[238:241], a[116:119], v[68:71], v[238:241]
    s_waitcnt lgkmcnt(3)
    v_mfma_f32_16x16x32_bf16 v[210:213], a[120:123], v[48:51], v[210:213]
    ds_read_b128 v[68:71], v173 offset:26000
    global_load_lds_dwordx4 v77, s[82:83] offset:3072
    v_mfma_f32_16x16x32_bf16 v[226:229], a[124:127], v[48:51], v[226:229]
    s_add_u32 s54, s52, 14336
    s_addc_u32 s55, s53, 0
    v_mfma_f32_16x16x32_bf16 v[214:217], a[120:123], v[52:55], v[214:217]
    ds_read_b128 v[48:51], v173 offset:27040
    s_add_u32 m0, s89, 12288
    v_mfma_f32_16x16x32_bf16 v[230:233], a[124:127], v[52:55], v[230:233]
    global_load_lds_dwordx4 v78, s[82:83] offset:0
    s_waitcnt lgkmcnt(3)
    v_mfma_f32_16x16x32_bf16 v[218:221], a[120:123], v[56:59], v[218:221]
    ds_read_b128 v[52:55], v173 offset:28080
    s_mul_i32 s6, s46, 14336
    v_mfma_f32_16x16x32_bf16 v[234:237], a[124:127], v[56:59], v[234:237]
    global_load_lds_dwordx4 v79, s[82:83] offset:1024
    v_mfma_f32_16x16x32_bf16 v[222:225], a[120:123], v[60:63], v[222:225]
    ds_read_b128 v[56:59], v173 offset:29120
    s_add_u32 s6, s6, s91
    global_load_lds_dwordx4 v80, s[82:83] offset:2048
    v_mfma_f32_16x16x32_bf16 v[238:241], a[124:127], v[60:63], v[238:241]
    s_waitcnt lgkmcnt(3)
    v_mfma_f32_16x16x32_bf16 v[210:213], a[128:131], v[64:67], v[210:213]
    ds_read_b128 v[60:63], v173 offset:30160
    global_load_lds_dwordx4 v81, s[82:83] offset:3072
    v_mfma_f32_16x16x32_bf16 v[226:229], a[132:135], v[64:67], v[226:229]
    s_add_u32 s56, s38, s6
    s_addc_u32 s57, s39, 0
    v_mfma_f32_16x16x32_bf16 v[214:217], a[128:131], v[68:71], v[214:217]
    ds_read_b128 v[64:67], v173 offset:31200
    s_waitcnt vmcnt(10)
    ds_read_b128 a[96:99], v82 offset:0
    v_mfma_f32_16x16x32_bf16 v[230:233], a[132:135], v[68:71], v[230:233]
    s_waitcnt lgkmcnt(4)
    v_mfma_f32_16x16x32_bf16 v[218:221], a[128:131], v[48:51], v[218:221]
    ds_read_b128 v[68:71], v173 offset:32240
    s_add_u32 s58, s56, 14336
    s_addc_u32 s59, s57, 0
    v_mfma_f32_16x16x32_bf16 v[234:237], a[132:135], v[48:51], v[234:237]
    v_mfma_f32_16x16x32_bf16 v[222:225], a[128:131], v[52:55], v[222:225]
    ds_read_b128 v[48:51], v173 offset:33280
    ds_read_b128 a[100:103], v84 offset:0
    v_mfma_f32_16x16x32_bf16 v[238:241], a[132:135], v[52:55], v[238:241]
    s_mul_i32 s6, s48, 14336
    s_waitcnt lgkmcnt(5)
    v_mfma_f32_16x16x32_bf16 v[210:213], a[136:139], v[56:59], v[210:213]
    ds_read_b128 v[52:55], v173 offset:34320
    v_mfma_f32_16x16x32_bf16 v[226:229], a[140:143], v[56:59], v[226:229]
    ds_read_b128 a[104:107], v86 offset:0
    s_add_u32 s6, s6, s91
    v_mfma_f32_16x16x32_bf16 v[214:217], a[136:139], v[60:63], v[214:217]
    ds_read_b128 v[56:59], v173 offset:35360
    v_mfma_f32_16x16x32_bf16 v[230:233], a[140:143], v[60:63], v[230:233]
    ds_read_b128 a[108:111], v88 offset:0
    s_waitcnt lgkmcnt(6)
    v_mfma_f32_16x16x32_bf16 v[218:221], a[136:139], v[64:67], v[218:221]
    ds_read_b128 v[60:63], v173 offset:36400
    s_add_u32 s60, s38, s6
    s_addc_u32 s61, s39, 0
    v_mfma_f32_16x16x32_bf16 v[234:237], a[140:143], v[64:67], v[234:237]
    ds_read_b128 a[112:115], v83 offset:0
    v_mfma_f32_16x16x32_bf16 v[222:225], a[136:139], v[68:71], v[222:225]
    ds_read_b128 v[64:67], v173 offset:37440
    v_mfma_f32_16x16x32_bf16 v[238:241], a[140:143], v[68:71], v[238:241]
    s_add_u32 s62, s60, 14336
    s_addc_u32 s63, s61, 0
    s_waitcnt lgkmcnt(6)
    v_mfma_f32_16x16x32_bf16 v[210:213], a[144:147], v[48:51], v[210:213]
    ds_read_b128 v[68:71], v173 offset:38480
    ds_read_b128 a[116:119], v85 offset:0
    v_mfma_f32_16x16x32_bf16 v[226:229], a[148:151], v[48:51], v[226:229]
    v_mfma_f32_16x16x32_bf16 v[214:217], a[144:147], v[52:55], v[214:217]
    ds_read_b128 v[48:51], v173 offset:39520
    ds_read_b128 a[120:123], v87 offset:0
    v_mfma_f32_16x16x32_bf16 v[230:233], a[148:151], v[52:55], v[230:233]
    s_mul_i32 s6, s50, 14336
    s_waitcnt lgkmcnt(6)
    v_mfma_f32_16x16x32_bf16 v[218:221], a[144:147], v[56:59], v[218:221]
    ds_read_b128 v[52:55], v173 offset:40560
    ds_read_b128 a[124:127], v89 offset:0
    v_mfma_f32_16x16x32_bf16 v[234:237], a[148:151], v[56:59], v[234:237]
    s_add_u32 s6, s6, s91
    v_mfma_f32_16x16x32_bf16 v[222:225], a[144:147], v[60:63], v[222:225]
    v_mfma_f32_16x16x32_bf16 v[238:241], a[148:151], v[60:63], v[238:241]
    s_add_u32 s64, s38, s6
    s_addc_u32 s65, s39, 0
    s_waitcnt lgkmcnt(5)
    v_mfma_f32_16x16x32_bf16 v[210:213], a[152:155], v[64:67], v[210:213]
    v_mfma_f32_16x16x32_bf16 v[226:229], a[156:159], v[64:67], v[226:229]
    v_mfma_f32_16x16x32_bf16 v[214:217], a[152:155], v[68:71], v[214:217]
    v_mfma_f32_16x16x32_bf16 v[230:233], a[156:159], v[68:71], v[230:233]
    s_add_u32 s66, s64, 14336
    s_addc_u32 s67, s65, 0
    s_waitcnt lgkmcnt(1)
    v_mfma_f32_16x16x32_bf16 v[218:221], a[152:155], v[48:51], v[218:221]
    v_mfma_f32_16x16x32_bf16 v[234:237], a[156:159], v[48:51], v[234:237]
    v_mfma_f32_16x16x32_bf16 v[222:225], a[152:155], v[52:55], v[222:225]
    v_mfma_f32_16x16x32_bf16 v[238:241], a[156:159], v[52:55], v[238:241]
    s_waitcnt vmcnt(0)
    ds_read_b128 a[128:131], v82 offset:8192
    ds_read_b128 a[132:135], v84 offset:8192
    ds_read_b128 a[136:139], v86 offset:8192
    ds_read_b128 a[140:143], v88 offset:8192
    ds_read_b128 a[144:147], v83 offset:8192
    ds_read_b128 a[148:151], v85 offset:8192
    ds_read_b128 a[152:155], v87 offset:8192
    ds_read_b128 a[156:159], v89 offset:8192
    s_waitcnt lgkmcnt(0)
    s_barrier
    s_mul_i32 s5, s41, 138240
    s_add_u32 s5, s5, 10485760
    s_add_u32 s92, s38, s5
    s_addc_u32 s93, s39, 0
    s_mul_i32 s95, s3, 34816
    s_min_u32 s95, s95, 103424
    s_add_u32 s92, s92, s95
    s_addc_u32 s93, s93, 0
    s_add_u32 m0, s95, 0
    s_nop 0
    global_load_lds_dwordx4 v4, s[92:93] offset:0 sc1
    s_lshl_b32 s4, s3, 10
    s_add_u32 s4, s4, 138240
    v_add_u32 v170, s4, v30
    s_lshl_b32 s4, s3, 12
    s_add_u32 s4, s4, 138240
    v_add_u32 v171, s4, v30
    v_add_u32 v30, 3072, v4
    v_add_u32 v31, 10240, v4
    v_min_u32 v29, 27, v1
    v_lshlrev_b32 v29, 10, v29
    v_pk_fma_f32 v[178:179], v[162:163], v[12:13], v[16:17] op_sel:[1,0,0] op_sel_hi:[1,1,1]
    v_pk_fma_f32 v[180:181], v[162:163], v[14:15], v[18:19] op_sel:[1,0,0] op_sel_hi:[1,1,1]
    v_pk_fma_f32 v[182:183], v[164:165], v[12:13], v[16:17] op_sel:[1,0,0] op_sel_hi:[1,1,1]
    v_pk_fma_f32 v[184:185], v[164:165], v[14:15], v[18:19] op_sel:[1,0,0] op_sel_hi:[1,1,1]
    v_pk_fma_f32 v[186:187], v[166:167], v[12:13], v[16:17] op_sel:[1,0,0] op_sel_hi:[1,1,1]
    v_pk_fma_f32 v[188:189], v[166:167], v[14:15], v[18:19] op_sel:[1,0,0] op_sel_hi:[1,1,1]
    v_pk_fma_f32 v[190:191], v[168:169], v[12:13], v[16:17] op_sel:[1,0,0] op_sel_hi:[1,1,1]
    v_pk_fma_f32 v[192:193], v[168:169], v[14:15], v[18:19] op_sel:[1,0,0] op_sel_hi:[1,1,1]
    v_pk_fma_f32 v[210:211], v[162:163], v[210:211], v[178:179] op_sel:[0,0,0] op_sel_hi:[0,1,1]
    global_load_lds_dwordx4 v4, s[92:93] offset:1024 sc1
    v_pk_fma_f32 v[212:213], v[162:163], v[212:213], v[180:181] op_sel:[0,0,0] op_sel_hi:[0,1,1]
    v_pk_fma_f32 v[214:215], v[164:165], v[214:215], v[182:183] op_sel:[0,0,0] op_sel_hi:[0,1,1]
    v_pk_fma_f32 v[216:217], v[164:165], v[216:217], v[184:185] op_sel:[0,0,0] op_sel_hi:[0,1,1]
    v_pk_fma_f32 v[218:219], v[166:167], v[218:219], v[186:187] op_sel:[0,0,0] op_sel_hi:[0,1,1]
    v_pk_fma_f32 v[220:221], v[166:167], v[220:221], v[188:189] op_sel:[0,0,0] op_sel_hi:[0,1,1]
    v_pk_fma_f32 v[222:223], v[168:169], v[222:223], v[190:191] op_sel:[0,0,0] op_sel_hi:[0,1,1]
    v_pk_fma_f32 v[224:225], v[168:169], v[224:225], v[192:193] op_sel:[0,0,0] op_sel_hi:[0,1,1]
    v_pk_fma_f32 v[178:179], v[162:163], v[20:21], v[24:25] op_sel:[1,0,0] op_sel_hi:[1,1,1]
    v_pk_fma_f32 v[180:181], v[162:163], v[22:23], v[26:27] op_sel:[1,0,0] op_sel_hi:[1,1,1]
    v_pk_fma_f32 v[182:183], v[164:165], v[20:21], v[24:25] op_sel:[1,0,0] op_sel_hi:[1,1,1]
    v_pk_fma_f32 v[184:185], v[164:165], v[22:23], v[26:27] op_sel:[1,0,0] op_sel_hi:[1,1,1]
    v_pk_fma_f32 v[186:187], v[166:167], v[20:21], v[24:25] op_sel:[1,0,0] op_sel_hi:[1,1,1]
    v_pk_fma_f32 v[188:189], v[166:167], v[22:23], v[26:27] op_sel:[1,0,0] op_sel_hi:[1,1,1]
    v_pk_fma_f32 v[190:191], v[168:169], v[20:21], v[24:25] op_sel:[1,0,0] op_sel_hi:[1,1,1]
    v_pk_fma_f32 v[192:193], v[168:169], v[22:23], v[26:27] op_sel:[1,0,0] op_sel_hi:[1,1,1]
    v_pk_fma_f32 v[226:227], v[162:163], v[226:227], v[178:179] op_sel:[0,0,0] op_sel_hi:[0,1,1]
    v_pk_fma_f32 v[228:229], v[162:163], v[228:229], v[180:181] op_sel:[0,0,0] op_sel_hi:[0,1,1]
    v_pk_fma_f32 v[230:231], v[164:165], v[230:231], v[182:183] op_sel:[0,0,0] op_sel_hi:[0,1,1]
    v_pk_fma_f32 v[232:233], v[164:165], v[232:233], v[184:185] op_sel:[0,0,0] op_sel_hi:[0,1,1]
    global_load_lds_dwordx4 v4, s[92:93] offset:2048 sc1
    v_pk_fma_f32 v[234:235], v[166:167], v[234:235], v[186:187] op_sel:[0,0,0] op_sel_hi:[0,1,1]
    v_pk_fma_f32 v[236:237], v[166:167], v[236:237], v[188:189] op_sel:[0,0,0] op_sel_hi:[0,1,1]
    v_pk_fma_f32 v[238:239], v[168:169], v[238:239], v[190:191] op_sel:[0,0,0] op_sel_hi:[0,1,1]
    v_pk_fma_f32 v[240:241], v[168:169], v[240:241], v[192:193] op_sel:[0,0,0] op_sel_hi:[0,1,1]
    v_pk_mul_f32 v[178:179], v[210:211], v[210:211] op_sel:[0,0] op_sel_hi:[1,1]
    v_pk_mul_f32 v[180:181], v[212:213], v[212:213] op_sel:[0,0] op_sel_hi:[1,1]
    v_pk_mul_f32 v[182:183], v[214:215], v[214:215] op_sel:[0,0] op_sel_hi:[1,1]
    v_pk_mul_f32 v[184:185], v[216:217], v[216:217] op_sel:[0,0] op_sel_hi:[1,1]
    v_pk_mul_f32 v[186:187], v[218:219], v[218:219] op_sel:[0,0] op_sel_hi:[1,1]
    v_pk_mul_f32 v[188:189], v[220:221], v[220:221] op_sel:[0,0] op_sel_hi:[1,1]
    v_pk_mul_f32 v[190:191], v[222:223], v[222:223] op_sel:[0,0] op_sel_hi:[1,1]
    v_pk_mul_f32 v[192:193], v[224:225], v[224:225] op_sel:[0,0] op_sel_hi:[1,1]
    v_pk_mul_f32 v[194:195], v[226:227], v[226:227] op_sel:[0,0] op_sel_hi:[1,1]
    v_pk_mul_f32 v[196:197], v[228:229], v[228:229] op_sel:[0,0] op_sel_hi:[1,1]
    v_pk_mul_f32 v[198:199], v[230:231], v[230:231] op_sel:[0,0] op_sel_hi:[1,1]
    v_pk_mul_f32 v[200:201], v[232:233], v[232:233] op_sel:[0,0] op_sel_hi:[1,1]
    v_pk_mul_f32 v[202:203], v[234:235], v[234:235] op_sel:[0,0] op_sel_hi:[1,1]
    v_pk_mul_f32 v[204:205], v[236:237], v[236:237] op_sel:[0,0] op_sel_hi:[1,1]
    v_pk_mul_f32 v[206:207], v[238:239], v[238:239] op_sel:[0,0] op_sel_hi:[1,1]
    global_load_lds_dwordx4 v4, s[92:93] offset:3072 sc1
    v_pk_mul_f32 v[208:209], v[240:241], v[240:241] op_sel:[0,0] op_sel_hi:[1,1]
    v_pk_fma_f32 v[178:179], v[178:179], s[84:85], s[84:85] op_sel:[0,1,0] op_sel_hi:[1,1,0]
    v_pk_fma_f32 v[180:181], v[180:181], s[84:85], s[84:85] op_sel:[0,1,0] op_sel_hi:[1,1,0]
    v_pk_fma_f32 v[182:183], v[182:183], s[84:85], s[84:85] op_sel:[0,1,0] op_sel_hi:[1,1,0]
    v_pk_fma_f32 v[184:185], v[184:185], s[84:85], s[84:85] op_sel:[0,1,0] op_sel_hi:[1,1,0]
    v_pk_fma_f32 v[186:187], v[186:187], s[84:85], s[84:85] op_sel:[0,1,0] op_sel_hi:[1,1,0]
    v_pk_fma_f32 v[188:189], v[188:189], s[84:85], s[84:85] op_sel:[0,1,0] op_sel_hi:[1,1,0]
    v_pk_fma_f32 v[190:191], v[190:191], s[84:85], s[84:85] op_sel:[0,1,0] op_sel_hi:[1,1,0]
    v_pk_fma_f32 v[192:193], v[192:193], s[84:85], s[84:85] op_sel:[0,1,0] op_sel_hi:[1,1,0]
    v_pk_fma_f32 v[194:195], v[194:195], s[84:85], s[84:85] op_sel:[0,1,0] op_sel_hi:[1,1,0]
    v_pk_fma_f32 v[196:197], v[196:197], s[84:85], s[84:85] op_sel:[0,1,0] op_sel_hi:[1,1,0]
    v_pk_fma_f32 v[198:199], v[198:199], s[84:85], s[84:85] op_sel:[0,1,0] op_sel_hi:[1,1,0]
    v_pk_fma_f32 v[200:201], v[200:201], s[84:85], s[84:85] op_sel:[0,1,0] op_sel_hi:[1,1,0]
    v_pk_fma_f32 v[202:203], v[202:203], s[84:85], s[84:85] op_sel:[0,1,0] op_sel_hi:[1,1,0]
    v_pk_fma_f32 v[204:205], v[204:205], s[84:85], s[84:85] op_sel:[0,1,0] op_sel_hi:[1,1,0]
    v_pk_fma_f32 v[206:207], v[206:207], s[84:85], s[84:85] op_sel:[0,1,0] op_sel_hi:[1,1,0]
    v_pk_fma_f32 v[208:209], v[208:209], s[84:85], s[84:85] op_sel:[0,1,0] op_sel_hi:[1,1,0]
    v_pk_mul_f32 v[178:179], v[178:179], v[210:211] op_sel:[0,0] op_sel_hi:[1,1]
    v_pk_mul_f32 v[180:181], v[180:181], v[212:213] op_sel:[0,0] op_sel_hi:[1,1]
    s_add_u32 m0, s95, 4096
    s_add_u32 s92, s92, 4096
    s_addc_u32 s93, s93, 0
    global_load_lds_dwordx4 v4, s[92:93] offset:0 sc1
    v_pk_mul_f32 v[182:183], v[182:183], v[214:215] op_sel:[0,0] op_sel_hi:[1,1]
    v_pk_mul_f32 v[184:185], v[184:185], v[216:217] op_sel:[0,0] op_sel_hi:[1,1]
    v_pk_mul_f32 v[186:187], v[186:187], v[218:219] op_sel:[0,0] op_sel_hi:[1,1]
    v_pk_mul_f32 v[188:189], v[188:189], v[220:221] op_sel:[0,0] op_sel_hi:[1,1]
    v_pk_mul_f32 v[190:191], v[190:191], v[222:223] op_sel:[0,0] op_sel_hi:[1,1]
    v_pk_mul_f32 v[192:193], v[192:193], v[224:225] op_sel:[0,0] op_sel_hi:[1,1]
    v_pk_mul_f32 v[194:195], v[194:195], v[226:227] op_sel:[0,0] op_sel_hi:[1,1]
    v_pk_mul_f32 v[196:197], v[196:197], v[228:229] op_sel:[0,0] op_sel_hi:[1,1]
    v_pk_mul_f32 v[198:199], v[198:199], v[230:231] op_sel:[0,0] op_sel_hi:[1,1]
    v_pk_mul_f32 v[200:201], v[200:201], v[232:233] op_sel:[0,0] op_sel_hi:[1,1]
    v_pk_mul_f32 v[202:203], v[202:203], v[234:235] op_sel:[0,0] op_sel_hi:[1,1]
    v_pk_mul_f32 v[204:205], v[204:205], v[236:237] op_sel:[0,0] op_sel_hi:[1,1]
    v_pk_mul_f32 v[206:207], v[206:207], v[238:239] op_sel:[0,0] op_sel_hi:[1,1]
    v_pk_mul_f32 v[208:209], v[208:209], v[240:241] op_sel:[0,0] op_sel_hi:[1,1]
    v_exp_f32 v178, v178
    v_exp_f32 v179, v179
    v_exp_f32 v180, v180
    v_exp_f32 v181, v181
    v_exp_f32 v182, v182
    global_load_lds_dwordx4 v4, s[92:93] offset:1024 sc1
    v_exp_f32 v183, v183
    v_exp_f32 v184, v184
    v_exp_f32 v185, v185
    v_exp_f32 v186, v186
    v_exp_f32 v187, v187
    v_exp_f32 v188, v188
    v_exp_f32 v189, v189
    v_exp_f32 v190, v190
    v_exp_f32 v191, v191
    v_exp_f32 v192, v192
    v_exp_f32 v193, v193
    v_exp_f32 v194, v194
    global_load_dwordx4 v[62:65], v30, s[56:57] offset:-3072 sc1
    v_exp_f32 v195, v195
    v_exp_f32 v196, v196
    v_exp_f32 v197, v197
    v_exp_f32 v198, v198
    v_exp_f32 v199, v199
    v_exp_f32 v200, v200
    global_load_dwordx4 v[66:69], v30, s[56:57] offset:-2048 sc1
    v_exp_f32 v201, v201
    v_exp_f32 v202, v202
    v_exp_f32 v203, v203
    v_exp_f32 v204, v204
    v_exp_f32 v205, v205
    v_exp_f32 v206, v206
    global_load_dwordx4 v[70:73], v30, s[56:57] offset:-1024 sc1
    v_exp_f32 v207, v207
    v_exp_f32 v208, v208
    v_exp_f32 v209, v209
    v_pk_add_f32 v[178:179], v[178:179], 1.0 op_sel:[0,0] op_sel_hi:[1,0]
    v_pk_add_f32 v[180:181], v[180:181], 1.0 op_sel:[0,0] op_sel_hi:[1,0]
    v_pk_add_f32 v[182:183], v[182:183], 1.0 op_sel:[0,0] op_sel_hi:[1,0]
    v_pk_add_f32 v[184:185], v[184:185], 1.0 op_sel:[0,0] op_sel_hi:[1,0]
    global_load_dwordx4 v[74:77], v30, s[56:57] offset:0 sc1
    v_pk_add_f32 v[186:187], v[186:187], 1.0 op_sel:[0,0] op_sel_hi:[1,0]
    v_pk_add_f32 v[188:189], v[188:189], 1.0 op_sel:[0,0] op_sel_hi:[1,0]
    v_pk_add_f32 v[190:191], v[190:191], 1.0 op_sel:[0,0] op_sel_hi:[1,0]
    v_pk_add_f32 v[192:193], v[192:193], 1.0 op_sel:[0,0] op_sel_hi:[1,0]
    v_pk_add_f32 v[194:195], v[194:195], 1.0 op_sel:[0,0] op_sel_hi:[1,0]
    v_pk_add_f32 v[196:197], v[196:197], 1.0 op_sel:[0,0] op_sel_hi:[1,0]
    global_load_dwordx4 v[78:81], v30, s[56:57] offset:1024 sc1
    v_pk_add_f32 v[198:199], v[198:199], 1.0 op_sel:[0,0] op_sel_hi:[1,0]
    v_pk_add_f32 v[200:201], v[200:201], 1.0 op_sel:[0,0] op_sel_hi:[1,0]
    v_pk_add_f32 v[202:203], v[202:203], 1.0 op_sel:[0,0] op_sel_hi:[1,0]
    v_pk_add_f32 v[204:205], v[204:205], 1.0 op_sel:[0,0] op_sel_hi:[1,0]
    v_pk_add_f32 v[206:207], v[206:207], 1.0 op_sel:[0,0] op_sel_hi:[1,0]
    v_pk_add_f32 v[208:209], v[208:209], 1.0 op_sel:[0,0] op_sel_hi:[1,0]
    v_rcp_f32 v178, v178
    global_load_dwordx4 v[82:85], v30, s[56:57] offset:2048 sc1
    v_rcp_f32 v179, v179
    v_rcp_f32 v180, v180
    v_rcp_f32 v181, v181
    v_rcp_f32 v182, v182
    v_rcp_f32 v183, v183
    v_rcp_f32 v184, v184
    global_load_dwordx4 v[86:89], v30, s[56:57] offset:3072 sc1
    v_rcp_f32 v185, v185
    v_rcp_f32 v186, v186
    v_rcp_f32 v187, v187
    v_rcp_f32 v188, v188
    v_rcp_f32 v189, v189
    v_rcp_f32 v190, v190
    v_rcp_f32 v191, v191
    global_load_dwordx4 v[90:93], v31, s[56:57] offset:-3072 sc1
    v_rcp_f32 v192, v192
    v_rcp_f32 v193, v193
    v_rcp_f32 v194, v194
    v_rcp_f32 v195, v195
    v_rcp_f32 v196, v196
    v_rcp_f32 v197, v197
    global_load_dwordx4 v[94:97], v31, s[56:57] offset:-2048 sc1
    v_rcp_f32 v198, v198
    v_rcp_f32 v199, v199
    v_rcp_f32 v200, v200
    v_rcp_f32 v201, v201
    v_rcp_f32 v202, v202
    v_rcp_f32 v203, v203
    global_load_dwordx4 v[98:101], v31, s[56:57] offset:-1024 sc1
    v_rcp_f32 v204, v204
    v_rcp_f32 v205, v205
    v_rcp_f32 v206, v206
    v_rcp_f32 v207, v207
    v_rcp_f32 v208, v208
    v_rcp_f32 v209, v209
    v_pk_mul_f32 v[210:211], v[210:211], v[178:179] op_sel:[0,0] op_sel_hi:[1,1]
    global_load_dwordx4 v[102:105], v31, s[56:57] offset:0 sc1
    v_pk_mul_f32 v[212:213], v[212:213], v[180:181] op_sel:[0,0] op_sel_hi:[1,1]
    v_pk_mul_f32 v[214:215], v[214:215], v[182:183] op_sel:[0,0] op_sel_hi:[1,1]
    v_pk_mul_f32 v[216:217], v[216:217], v[184:185] op_sel:[0,0] op_sel_hi:[1,1]
    v_pk_mul_f32 v[218:219], v[218:219], v[186:187] op_sel:[0,0] op_sel_hi:[1,1]
    v_pk_mul_f32 v[220:221], v[220:221], v[188:189] op_sel:[0,0] op_sel_hi:[1,1]
    v_pk_mul_f32 v[222:223], v[222:223], v[190:191] op_sel:[0,0] op_sel_hi:[1,1]
    global_load_dwordx4 v[106:109], v31, s[56:57] offset:1024 sc1
    v_pk_mul_f32 v[224:225], v[224:225], v[192:193] op_sel:[0,0] op_sel_hi:[1,1]
    v_pk_mul_f32 v[226:227], v[226:227], v[194:195] op_sel:[0,0] op_sel_hi:[1,1]
    v_pk_mul_f32 v[228:229], v[228:229], v[196:197] op_sel:[0,0] op_sel_hi:[1,1]
    v_pk_mul_f32 v[230:231], v[230:231], v[198:199] op_sel:[0,0] op_sel_hi:[1,1]
    v_pk_mul_f32 v[232:233], v[232:233], v[200:201] op_sel:[0,0] op_sel_hi:[1,1]
    v_pk_mul_f32 v[234:235], v[234:235], v[202:203] op_sel:[0,0] op_sel_hi:[1,1]
    v_pk_mul_f32 v[236:237], v[236:237], v[204:205] op_sel:[0,0] op_sel_hi:[1,1]
    global_load_dwordx4 v[110:113], v31, s[56:57] offset:2048 sc1
    v_pk_mul_f32 v[238:239], v[238:239], v[206:207] op_sel:[0,0] op_sel_hi:[1,1]
    v_pk_mul_f32 v[240:241], v[240:241], v[208:209] op_sel:[0,0] op_sel_hi:[1,1]
    v_cvt_pk_bf16_f32 v178, v210, v211
    v_cvt_pk_bf16_f32 v179, v212, v213
    v_cvt_pk_bf16_f32 v180, v214, v215
    v_cvt_pk_bf16_f32 v181, v216, v217
    global_load_dwordx4 v[114:117], v31, s[56:57] offset:3072 sc1
    v_cvt_pk_bf16_f32 v182, v218, v219
    v_cvt_pk_bf16_f32 v183, v220, v221
    v_cvt_pk_bf16_f32 v184, v222, v223
    v_cvt_pk_bf16_f32 v185, v224, v225
    v_cvt_pk_bf16_f32 v186, v226, v227
    v_cvt_pk_bf16_f32 v187, v228, v229
    v_cvt_pk_bf16_f32 v188, v230, v231
    global_load_dwordx4 v[118:121], v30, s[58:59] offset:-3072 sc1
    v_cvt_pk_bf16_f32 v189, v232, v233
    v_cvt_pk_bf16_f32 v190, v234, v235
    v_cvt_pk_bf16_f32 v191, v236, v237
    v_cvt_pk_bf16_f32 v192, v238, v239
    v_cvt_pk_bf16_f32 v193, v240, v241
    ds_write_b64 v170, v[178:179] offset:0
    global_load_dwordx4 v[122:125], v30, s[58:59] offset:-2048 sc1
    ds_write_b64 v170, v[180:181] offset:4096
    ds_write_b64 v170, v[182:183] offset:8192
    ds_write_b64 v170, v[184:185] offset:12288
    ds_write_b64 v170, v[186:187] offset:512
    ds_write_b64 v170, v[188:189] offset:4608
    ds_write_b64 v170, v[190:191] offset:8704
    ds_write_b64 v170, v[192:193] offset:12800
    s_waitcnt lgkmcnt(0)
    s_barrier
    ds_read_b64 v[48:49], v171 offset:0
    ds_read_b64 v[50:51], v171 offset:512
    ds_read_b64 v[52:53], v171 offset:1024
    ds_read_b64 v[54:55], v171 offset:1536
    ds_read_b64 v[56:57], v171 offset:2048
    ds_read_b64 v[58:59], v171 offset:2560
    ds_read_b64 v[60:61], v171 offset:3072
Lmid:
    s_waitcnt vmcnt(14)
    v_and_b32 v28, v65, v69
    s_waitcnt vmcnt(12)
    v_bitop3_b32 v28, v73, v77, v28 bitop3:0x80
    v_and_b32 v28, 1, v28
    v_cmp_ne_u32 vcc, 1, v28
    s_nop 0
    s_cbranch_vccnz Lz0_r
Lz0_ok:
    v_mfma_f32_16x16x32_bf16 v[142:145], v[62:65], a[160:163], v[32:35]
    global_load_dwordx4 v[126:129], v30, s[58:59] offset:-1024 sc1
    v_mfma_f32_16x16x32_bf16 v[146:149], v[62:65], a[164:167], 0
    v_mfma_f32_16x16x32_bf16 v[150:153], v[62:65], a[168:171], 0
    v_mfma_f32_16x16x32_bf16 v[154:157], v[62:65], a[172:175], 0
    v_mfma_f32_16x16x32_bf16 v[158:161], v[66:69], a[160:163], v[32:35]
    global_load_dwordx4 v[130:133], v30, s[58:59] offset:0 sc1
    v_mfma_f32_16x16x32_bf16 v[162:165], v[66:69], a[164:167], 0
    v_mfma_f32_16x16x32_bf16 v[166:169], v[66:69], a[168:171], 0
    v_mfma_f32_16x16x32_bf16 v[170:173], v[66:69], a[172:175], 0
    v_mfma_f32_16x16x32_bf16 v[174:177], v[70:73], a[160:163], v[32:35]
    global_load_dwordx4 v[134:137], v30, s[58:59] offset:1024 sc1
    v_mfma_f32_16x16x32_bf16 v[178:181], v[70:73], a[164:167], 0
    v_mfma_f32_16x16x32_bf16 v[182:185], v[70:73], a[168:171], 0
    s_waitcnt vmcnt(13)
    v_and_b32 v28, v81, v85
    v_mfma_f32_16x16x32_bf16 v[186:189], v[70:73], a[172:175], 0
    s_waitcnt vmcnt(11)
    v_bitop3_b32 v28, v89, v93, v28 bitop3:0x80
    v_mfma_f32_16x16x32_bf16 v[190:193], v[74:77], a[160:163], v[32:35]
    v_and_b32 v28, 1, v28
    global_load_dwordx4 v[138:141], v30, s[58:59] offset:2048 sc1
    v_mfma_f32_16x16x32_bf16 v[194:197], v[74:77], a[164:167], 0
    v_cmp_ne_u32 vcc, 1, v28
    v_mfma_f32_16x16x32_bf16 v[198:201], v[74:77], a[168:171], 0
    v_mfma_f32_16x16x32_bf16 v[202:205], v[74:77], a[172:175], 0
    s_cbranch_vccnz Lz1_r
Lz1_ok:
    v_mfma_f32_16x16x32_bf16 v[206:209], v[78:81], a[160:163], v[32:35]
    global_load_dwordx4 v[62:65], v30, s[58:59] offset:3072 sc1
    s_xor_b32 s4, s3, 1
    s_mul_i32 s4, s4, 3072
    v_mfma_f32_16x16x32_bf16 v[210:213], v[78:81], a[164:167], 0
    s_add_u32 s4, s4, 138240
    v_add_u32 v20, s4, v4
    s_xor_b32 s4, s3, 2
    v_mfma_f32_16x16x32_bf16 v[214:217], v[78:81], a[168:171], 0
    s_mul_i32 s4, s4, 3072
    s_add_u32 s4, s4, 139264
    v_add_u32 v21, s4, v4
    v_mfma_f32_16x16x32_bf16 v[218:221], v[78:81], a[172:175], 0
    s_xor_b32 s4, s3, 3
    s_mul_i32 s4, s4, 3072
    v_mfma_f32_16x16x32_bf16 v[222:225], v[82:85], a[160:163], v[32:35]
    global_load_dwordx4 v[66:69], v31, s[58:59] offset:-3072 sc1
    s_add_u32 s4, s4, 140288
    v_add_u32 v22, s4, v4
    v_mfma_f32_16x16x32_bf16 v[226:229], v[82:85], a[164:167], 0
    s_mul_i32 s4, s3, 3072
    s_add_u32 s4, s4, 138240
    v_add_u32 v23, s4, v4
    v_mfma_f32_16x16x32_bf16 v[230:233], v[82:85], a[168:171], 0
    s_mul_i32 s4, s40, 114688
    s_add_u32 s4, s4, 1052672
    v_mfma_f32_16x16x32_bf16 v[234:237], v[82:85], a[172:175], 0
    s_lshl_b32 s5, s3, 13
    s_add_u32 s5, s5, s4
    v_mfma_f32_16x16x32_bf16 v[238:241], v[86:89], a[160:163], v[32:35]
    global_load_dwordx4 v[70:73], v31, s[58:59] offset:-2048 sc1
    v_add_u32 v6, s5, v4
    v_mfma_f32_16x16x32_bf16 v[242:245], v[86:89], a[164:167], 0
    v_add_u32 v7, 32768, v6
    v_add_u32 v26, 65536, v6
    s_lshl_b32 s5, s3, 12
    v_mfma_f32_16x16x32_bf16 v[246:249], v[86:89], a[168:171], 0
    s_waitcnt vmcnt(13)
    v_and_b32 v28, v97, v101
    s_add_u32 s5, s5, s4
    s_add_u32 s5, s5, 98304
    v_mfma_f32_16x16x32_bf16 v[250:253], v[86:89], a[172:175], 0
    s_waitcnt vmcnt(11)
    v_bitop3_b32 v28, v105, v109, v28 bitop3:0x80
    v_add_u32 v27, s5, v4
    s_lshl_b32 s4, s41, 10
    v_mfma_f32_16x16x32_bf16 v[142:145], v[90:93], a[176:179], v[142:145]
    s_add_u32 s8, s38, s4
    s_addc_u32 s9, s39, 0
    v_and_b32 v28, 1, v28
    v_mfma_f32_16x16x32_bf16 v[146:149], v[90:93], a[180:183], v[146:149]
    global_load_dwordx4 v[74:77], v31, s[58:59] offset:-1024 sc1
    s_lshr_b32 s4, s41, 1
    s_lshl_b32 s4, s4, 10
    s_and_b32 s5, s41, 1
    v_mfma_f32_16x16x32_bf16 v[150:153], v[90:93], a[184:187], v[150:153]
    v_cmp_ne_u32 vcc, 1, v28
    s_lshl_b32 s5, s5, 3
    s_add_u32 s4, s4, s5
    s_add_u32 s10, s38, s4
    s_addc_u32 s11, s39, 0
    v_mfma_f32_16x16x32_bf16 v[154:157], v[90:93], a[188:191], v[154:157]
    s_waitcnt lgkmcnt(0)
    s_barrier
    s_cbranch_vccnz Lz2_r
Lz2_ok:
    v_mfma_f32_16x16x32_bf16 v[158:161], v[94:97], a[176:179], v[158:161]
    global_load_dwordx4 v[78:81], v31, s[58:59] offset:0 sc1
    v_mfma_f32_16x16x32_bf16 v[162:165], v[94:97], a[180:183], v[162:165]
    v_mfma_f32_16x16x32_bf16 v[166:169], v[94:97], a[184:187], v[166:169]
    v_mfma_f32_16x16x32_bf16 v[170:173], v[94:97], a[188:191], v[170:173]
    v_mfma_f32_16x16x32_bf16 v[174:177], v[98:101], a[176:179], v[174:177]
    global_load_dwordx4 v[82:85], v31, s[58:59] offset:1024 sc1
    v_mfma_f32_16x16x32_bf16 v[178:181], v[98:101], a[180:183], v[178:181]
    v_mfma_f32_16x16x32_bf16 v[182:185], v[98:101], a[184:187], v[182:185]
    v_mfma_f32_16x16x32_bf16 v[186:189], v[98:101], a[188:191], v[186:189]
    v_mfma_f32_16x16x32_bf16 v[190:193], v[102:105], a[176:179], v[190:193]
    global_load_dwordx4 v[86:89], v31, s[58:59] offset:2048 sc1
    v_mfma_f32_16x16x32_bf16 v[194:197], v[102:105], a[180:183], v[194:197]
    v_mfma_f32_16x16x32_bf16 v[198:201], v[102:105], a[184:187], v[198:201]
    s_waitcnt vmcnt(13)
    v_and_b32 v28, v113, v117
    v_mfma_f32_16x16x32_bf16 v[202:205], v[102:105], a[188:191], v[202:205]
    s_waitcnt vmcnt(11)
    v_bitop3_b32 v28, v121, v125, v28 bitop3:0x80
    v_mfma_f32_16x16x32_bf16 v[206:209], v[106:109], a[176:179], v[206:209]
    v_and_b32 v28, 1, v28
    global_load_dwordx4 v[90:93], v31, s[58:59] offset:3072 sc1
    v_mfma_f32_16x16x32_bf16 v[210:213], v[106:109], a[180:183], v[210:213]
    v_cmp_ne_u32 vcc, 1, v28
    v_mfma_f32_16x16x32_bf16 v[214:217], v[106:109], a[184:187], v[214:217]
    v_mfma_f32_16x16x32_bf16 v[218:221], v[106:109], a[188:191], v[218:221]
    s_cbranch_vccnz Lz3_r
Lz3_ok:
    v_mfma_f32_16x16x32_bf16 v[222:225], v[110:113], a[176:179], v[222:225]
    global_load_dwordx4 v[94:97], v30, s[60:61] offset:-3072 sc1
    v_mfma_f32_16x16x32_bf16 v[226:229], v[110:113], a[180:183], v[226:229]
    v_mfma_f32_16x16x32_bf16 v[230:233], v[110:113], a[184:187], v[230:233]
    v_mfma_f32_16x16x32_bf16 v[234:237], v[110:113], a[188:191], v[234:237]
    v_mfma_f32_16x16x32_bf16 v[238:241], v[114:117], a[176:179], v[238:241]
    global_load_dwordx4 v[98:101], v31, s[60:61] offset:-3072 sc1
    v_mfma_f32_16x16x32_bf16 v[242:245], v[114:117], a[180:183], v[242:245]
    v_mfma_f32_16x16x32_bf16 v[246:249], v[114:117], a[184:187], v[246:249]
    v_mfma_f32_16x16x32_bf16 v[250:253], v[114:117], a[188:191], v[250:253]
    v_mfma_f32_16x16x32_bf16 v[142:145], v[118:121], a[0:3], v[142:145]
    global_load_dwordx4 v[102:105], v30, s[62:63] offset:-3072 sc1
    v_mfma_f32_16x16x32_bf16 v[146:149], v[118:121], a[4:7], v[146:149]
    v_mfma_f32_16x16x32_bf16 v[150:153], v[118:121], a[8:11], v[150:153]
    s_waitcnt vmcnt(13)
    v_and_b32 v28, v129, v133
    v_mfma_f32_16x16x32_bf16 v[154:157], v[118:121], a[12:15], v[154:157]
    s_waitcnt vmcnt(11)
    v_bitop3_b32 v28, v137, v141, v28 bitop3:0x80
    v_mfma_f32_16x16x32_bf16 v[158:161], v[122:125], a[0:3], v[158:161]
    v_and_b32 v28, 1, v28
    global_load_dwordx4 v[106:109], v31, s[62:63] offset:-3072 sc1
    v_mfma_f32_16x16x32_bf16 v[162:165], v[122:125], a[4:7], v[162:165]
    v_cmp_ne_u32 vcc, 1, v28
    v_mfma_f32_16x16x32_bf16 v[166:169], v[122:125], a[8:11], v[166:169]
    v_mfma_f32_16x16x32_bf16 v[170:173], v[122:125], a[12:15], v[170:173]
    s_cbranch_vccnz Lz4_r
Lz4_ok:
    v_mfma_f32_16x16x32_bf16 v[174:177], v[126:129], a[0:3], v[174:177]
    global_load_dwordx4 v[110:113], v30, s[52:53] offset:-3072 sc1
    v_mfma_f32_16x16x32_bf16 v[178:181], v[126:129], a[4:7], v[178:181]
    v_mfma_f32_16x16x32_bf16 v[182:185], v[126:129], a[8:11], v[182:185]
    v_mfma_f32_16x16x32_bf16 v[186:189], v[126:129], a[12:15], v[186:189]
    v_mfma_f32_16x16x32_bf16 v[190:193], v[130:133], a[0:3], v[190:193]
    global_load_dwordx4 v[114:117], v31, s[52:53] offset:-3072 sc1
    v_mfma_f32_16x16x32_bf16 v[194:197], v[130:133], a[4:7], v[194:197]
    v_mfma_f32_16x16x32_bf16 v[198:201], v[130:133], a[8:11], v[198:201]
    v_mfma_f32_16x16x32_bf16 v[202:205], v[130:133], a[12:15], v[202:205]
    v_mfma_f32_16x16x32_bf16 v[206:209], v[134:137], a[0:3], v[206:209]
    global_load_dwordx4 v[118:121], v30, s[54:55] offset:-3072 sc1
    v_mfma_f32_16x16x32_bf16 v[210:213], v[134:137], a[4:7], v[210:213]
    v_mfma_f32_16x16x32_bf16 v[214:217], v[134:137], a[8:11], v[214:217]
    s_waitcnt vmcnt(13)
    v_and_b32 v28, v65, v69
    v_mfma_f32_16x16x32_bf16 v[218:221], v[134:137], a[12:15], v[218:221]
    s_waitcnt vmcnt(11)
    v_bitop3_b32 v28, v73, v77, v28 bitop3:0x80
    v_mfma_f32_16x16x32_bf16 v[222:225], v[138:141], a[0:3], v[222:225]
    v_and_b32 v28, 1, v28
    global_load_dwordx4 v[122:125], v31, s[54:55] offset:-3072 sc1
    v_mfma_f32_16x16x32_bf16 v[226:229], v[138:141], a[4:7], v[226:229]
    v_cmp_ne_u32 vcc, 1, v28
    v_mfma_f32_16x16x32_bf16 v[230:233], v[138:141], a[8:11], v[230:233]
    v_mfma_f32_16x16x32_bf16 v[234:237], v[138:141], a[12:15], v[234:237]
    s_cbranch_vccnz Lz5_r
Lz5_ok:
    v_mfma_f32_16x16x32_bf16 v[238:241], v[62:65], a[0:3], v[238:241]
    global_load_dwordx4 v[126:129], v30, s[64:65] offset:-3072 sc1
    v_mfma_f32_16x16x32_bf16 v[242:245], v[62:65], a[4:7], v[242:245]
    v_mfma_f32_16x16x32_bf16 v[246:249], v[62:65], a[8:11], v[246:249]
    v_mfma_f32_16x16x32_bf16 v[250:253], v[62:65], a[12:15], v[250:253]
    v_mfma_f32_16x16x32_bf16 v[142:145], v[66:69], a[16:19], v[142:145]
    global_load_dwordx4 v[130:133], v31, s[64:65] offset:-3072 sc1
    v_mfma_f32_16x16x32_bf16 v[146:149], v[66:69], a[20:23], v[146:149]
    v_mfma_f32_16x16x32_bf16 v[150:153], v[66:69], a[24:27], v[150:153]
    v_mfma_f32_16x16x32_bf16 v[154:157], v[66:69], a[28:31], v[154:157]
    v_mfma_f32_16x16x32_bf16 v[158:161], v[70:73], a[16:19], v[158:161]
    global_load_dwordx4 v[134:137], v30, s[66:67] offset:-3072 sc1
    v_mfma_f32_16x16x32_bf16 v[162:165], v[70:73], a[20:23], v[162:165]
    v_mfma_f32_16x16x32_bf16 v[166:169], v[70:73], a[24:27], v[166:169]
    s_waitcnt vmcnt(13)
    v_and_b32 v28, v81, v85
    v_mfma_f32_16x16x32_bf16 v[170:173], v[70:73], a[28:31], v[170:173]
    s_waitcnt vmcnt(11)
    v_bitop3_b32 v28, v89, v93, v28 bitop3:0x80
    v_mfma_f32_16x16x32_bf16 v[174:177], v[74:77], a[16:19], v[174:177]
    v_and_b32 v28, 1, v28
    global_load_dwordx4 v[138:141], v31, s[66:67] offset:-3072 sc1
    v_mfma_f32_16x16x32_bf16 v[178:181], v[74:77], a[20:23], v[178:181]
    v_cmp_ne_u32 vcc, 1, v28
    v_mfma_f32_16x16x32_bf16 v[182:185], v[74:77], a[24:27], v[182:185]
    v_mfma_f32_16x16x32_bf16 v[186:189], v[74:77], a[28:31], v[186:189]
    s_cbranch_vccnz Lz6_r
Lz6_ok:
    v_mfma_f32_16x16x32_bf16 v[190:193], v[78:81], a[16:19], v[190:193]
    global_load_dwordx4 v[62:65], v30, s[60:61] offset:-2048 sc1
    v_mfma_f32_16x16x32_bf16 v[194:197], v[78:81], a[20:23], v[194:197]
    v_mfma_f32_16x16x32_bf16 v[198:201], v[78:81], a[24:27], v[198:201]
    v_mfma_f32_16x16x32_bf16 v[202:205], v[78:81], a[28:31], v[202:205]
    v_mfma_f32_16x16x32_bf16 v[206:209], v[82:85], a[16:19], v[206:209]
    global_load_dwordx4 v[66:69], v31, s[60:61] offset:-2048 sc1
    v_mfma_f32_16x16x32_bf16 v[210:213], v[82:85], a[20:23], v[210:213]
    v_mfma_f32_16x16x32_bf16 v[214:217], v[82:85], a[24:27], v[214:217]
    v_mfma_f32_16x16x32_bf16 v[218:221], v[82:85], a[28:31], v[218:221]
    v_mfma_f32_16x16x32_bf16 v[222:225], v[86:89], a[16:19], v[222:225]
    global_load_dwordx4 v[70:73], v30, s[62:63] offset:-2048 sc1
    v_mfma_f32_16x16x32_bf16 v[226:229], v[86:89], a[20:23], v[226:229]
    v_mfma_f32_16x16x32_bf16 v[230:233], v[86:89], a[24:27], v[230:233]
    s_waitcnt vmcnt(13)
    v_and_b32 v28, v97, v101
    v_mfma_f32_16x16x32_bf16 v[234:237], v[86:89], a[28:31], v[234:237]
    s_waitcnt vmcnt(11)
    v_bitop3_b32 v28, v105, v109, v28 bitop3:0x80
    v_mfma_f32_16x16x32_bf16 v[238:241], v[90:93], a[16:19], v[238:241]
    v_and_b32 v28, 1, v28
    global_load_dwordx4 v[74:77], v31, s[62:63] offset:-2048 sc1
    v_mfma_f32_16x16x32_bf16 v[242:245], v[90:93], a[20:23], v[242:245]
    v_cmp_ne_u32 vcc, 1, v28
    v_mfma_f32_16x16x32_bf16 v[246:249], v[90:93], a[24:27], v[246:249]
    v_mfma_f32_16x16x32_bf16 v[250:253], v[90:93], a[28:31], v[250:253]
    s_cbranch_vccnz Lz7_r
Lz7_ok:
    v_mfma_f32_16x16x32_bf16 v[142:145], v[94:97], a[32:35], v[142:145]
    global_load_dwordx4 v[78:81], v30, s[52:53] offset:-2048 sc1
    v_mfma_f32_16x16x32_bf16 v[146:149], v[94:97], a[36:39], v[146:149]
    v_mfma_f32_16x16x32_bf16 v[150:153], v[94:97], a[40:43], v[150:153]
    v_mfma_f32_16x16x32_bf16 v[154:157], v[94:97], a[44:47], v[154:157]
    v_mfma_f32_16x16x32_bf16 v[142:145], v[98:101], a[48:51], v[142:145]
    global_load_dwordx4 v[82:85], v31, s[52:53] offset:-2048 sc1
    v_mfma_f32_16x16x32_bf16 v[146:149], v[98:101], a[52:55], v[146:149]
    v_mfma_f32_16x16x32_bf16 v[150:153], v[98:101], a[56:59], v[150:153]
    v_mfma_f32_16x16x32_bf16 v[154:157], v[98:101], a[60:63], v[154:157]
    v_mfma_f32_16x16x32_bf16 v[142:145], v[102:105], a[64:67], v[142:145]
    global_load_dwordx4 v[86:89], v30, s[54:55] offset:-2048 sc1
    v_mfma_f32_16x16x32_bf16 v[146:149], v[102:105], a[68:71], v[146:149]
    v_mfma_f32_16x16x32_bf16 v[150:153], v[102:105], a[72:75], v[150:153]
    s_waitcnt vmcnt(13)
    v_and_b32 v28, v113, v117
    v_mfma_f32_16x16x32_bf16 v[154:157], v[102:105], a[76:79], v[154:157]
    s_waitcnt vmcnt(11)
    v_bitop3_b32 v28, v121, v125, v28 bitop3:0x80
    v_mfma_f32_16x16x32_bf16 v[142:145], v[106:109], a[80:83], v[142:145]
    v_and_b32 v28, 1, v28
    global_load_dwordx4 v[90:93], v31, s[54:55] offset:-2048 sc1
    v_mfma_f32_16x16x32_bf16 v[146:149], v[106:109], a[84:87], v[146:149]
    v_cmp_ne_u32 vcc, 1, v28
    v_mfma_f32_16x16x32_bf16 v[150:153], v[106:109], a[88:91], v[150:153]
    v_mfma_f32_16x16x32_bf16 v[154:157], v[106:109], a[92:95], v[154:157]
    s_cbranch_vccnz Lz8_r
Lz8_ok:
    v_mfma_f32_16x16x32_bf16 v[142:145], v[110:113], a[224:227], v[142:145]
    global_load_dwordx4 v[94:97], v30, s[64:65] offset:-2048 sc1
    v_mfma_f32_16x16x32_bf16 v[146:149], v[110:113], a[228:231], v[146:149]
    v_mfma_f32_16x16x32_bf16 v[150:153], v[110:113], a[232:235], v[150:153]
    v_mfma_f32_16x16x32_bf16 v[154:157], v[110:113], a[236:239], v[154:157]
    v_mfma_f32_16x16x32_bf16 v[142:145], v[114:117], a[240:243], v[142:145]
    global_load_dwordx4 v[98:101], v31, s[64:65] offset:-2048 sc1
    v_mfma_f32_16x16x32_bf16 v[146:149], v[114:117], a[244:247], v[146:149]
    v_mfma_f32_16x16x32_bf16 v[150:153], v[114:117], a[248:251], v[150:153]
    v_mfma_f32_16x16x32_bf16 v[154:157], v[114:117], a[252:255], v[154:157]
    v_mfma_f32_16x16x32_bf16 v[142:145], v[118:121], a[192:195], v[142:145]
    global_load_dwordx4 v[102:105], v30, s[66:67] offset:-2048 sc1
    v_mfma_f32_16x16x32_bf16 v[146:149], v[118:121], a[196:199], v[146:149]
    v_mfma_f32_16x16x32_bf16 v[150:153], v[118:121], a[200:203], v[150:153]
    s_waitcnt vmcnt(13)
    v_and_b32 v28, v129, v133
    v_mfma_f32_16x16x32_bf16 v[154:157], v[118:121], a[204:207], v[154:157]
    s_waitcnt vmcnt(11)
    v_bitop3_b32 v28, v137, v141, v28 bitop3:0x80
    v_mfma_f32_16x16x32_bf16 v[142:145], v[122:125], a[208:211], v[142:145]
    v_and_b32 v28, 1, v28
    global_load_dwordx4 v[106:109], v31, s[66:67] offset:-2048 sc1
    v_mfma_f32_16x16x32_bf16 v[146:149], v[122:125], a[212:215], v[146:149]
    v_cmp_ne_u32 vcc, 1, v28
    v_mfma_f32_16x16x32_bf16 v[150:153], v[122:125], a[216:219], v[150:153]
    v_mfma_f32_16x16x32_bf16 v[154:157], v[122:125], a[220:223], v[154:157]
    s_cbranch_vccnz Lz9_r
Lz9_ok:
    v_mfma_f32_16x16x32_bf16 v[142:145], v[126:129], a[96:99], v[142:145]
    global_load_dwordx4 v[110:113], v30, s[60:61] offset:-1024 sc1
    v_mfma_f32_16x16x32_bf16 v[146:149], v[126:129], a[100:103], v[146:149]
    v_mfma_f32_16x16x32_bf16 v[150:153], v[126:129], a[104:107], v[150:153]
    v_mfma_f32_16x16x32_bf16 v[154:157], v[126:129], a[108:111], v[154:157]
    v_mfma_f32_16x16x32_bf16 v[142:145], v[130:133], a[112:115], v[142:145]
    global_load_dwordx4 v[114:117], v31, s[60:61] offset:-1024 sc1
    v_mfma_f32_16x16x32_bf16 v[146:149], v[130:133], a[116:119], v[146:149]
    v_mfma_f32_16x16x32_bf16 v[150:153], v[130:133], a[120:123], v[150:153]
    v_mfma_f32_16x16x32_bf16 v[154:157], v[130:133], a[124:127], v[154:157]
    v_mfma_f32_16x16x32_bf16 v[142:145], v[134:137], a[128:131], v[142:145]
    global_load_dwordx4 v[118:121], v30, s[62:63] offset:-1024 sc1
    v_mfma_f32_16x16x32_bf16 v[146:149], v[134:137], a[132:135], v[146:149]
    v_mfma_f32_16x16x32_bf16 v[150:153], v[134:137], a[136:139], v[150:153]
    s_waitcnt vmcnt(13)
    v_and_b32 v28, v65, v69
    v_mfma_f32_16x16x32_bf16 v[154:157], v[134:137], a[140:143], v[154:157]
    s_waitcnt vmcnt(11)
    v_bitop3_b32 v28, v73, v77, v28 bitop3:0x80
    v_mfma_f32_16x16x32_bf16 v[142:145], v[138:141], a[144:147], v[142:145]
    v_and_b32 v28, 1, v28
    global_load_dwordx4 v[122:125], v31, s[62:63] offset:-1024 sc1
    v_mfma_f32_16x16x32_bf16 v[146:149], v[138:141], a[148:151], v[146:149]
    v_cmp_ne_u32 vcc, 1, v28
    v_mfma_f32_16x16x32_bf16 v[150:153], v[138:141], a[152:155], v[150:153]
    v_mfma_f32_16x16x32_bf16 v[154:157], v[138:141], a[156:159], v[154:157]
    s_cbranch_vccnz Lz10_r
Lz10_ok:
    v_mfma_f32_16x16x32_bf16 v[158:161], v[62:65], a[32:35], v[158:161]
    global_load_dwordx4 v[126:129], v30, s[52:53] offset:-1024 sc1
    v_mfma_f32_16x16x32_bf16 v[162:165], v[62:65], a[36:39], v[162:165]
    v_mfma_f32_16x16x32_bf16 v[166:169], v[62:65], a[40:43], v[166:169]
    v_mfma_f32_16x16x32_bf16 v[170:173], v[62:65], a[44:47], v[170:173]
    ds_write_b128 v20, v[146:149] offset:0
    v_mfma_f32_16x16x32_bf16 v[158:161], v[66:69], a[48:51], v[158:161]
    global_load_dwordx4 v[130:133], v31, s[52:53] offset:-1024 sc1
    v_mfma_f32_16x16x32_bf16 v[162:165], v[66:69], a[52:55], v[162:165]
    v_mfma_f32_16x16x32_bf16 v[166:169], v[66:69], a[56:59], v[166:169]
    ds_write_b128 v21, v[150:153] offset:0
    v_mfma_f32_16x16x32_bf16 v[170:173], v[66:69], a[60:63], v[170:173]
    v_mfma_f32_16x16x32_bf16 v[158:161], v[70:73], a[64:67], v[158:161]
    global_load_dwordx4 v[134:137], v30, s[54:55] offset:-1024 sc1
    v_mfma_f32_16x16x32_bf16 v[162:165], v[70:73], a[68:71], v[162:165]
    ds_write_b128 v22, v[154:157] offset:0
    v_mfma_f32_16x16x32_bf16 v[166:169], v[70:73], a[72:75], v[166:169]
    s_waitcnt vmcnt(13)
    v_and_b32 v28, v81, v85
    v_mfma_f32_16x16x32_bf16 v[170:173], v[70:73], a[76:79], v[170:173]
    s_waitcnt vmcnt(11)
    v_bitop3_b32 v28, v89, v93, v28 bitop3:0x80
    v_mfma_f32_16x16x32_bf16 v[158:161], v[74:77], a[80:83], v[158:161]
    v_and_b32 v28, 1, v28
    global_load_dwordx4 v[138:141], v31, s[54:55] offset:-1024 sc1
    v_mfma_f32_16x16x32_bf16 v[162:165], v[74:77], a[84:87], v[162:165]
    s_waitcnt lgkmcnt(0)
    s_barrier
    v_cmp_ne_u32 vcc, 1, v28
    v_mfma_f32_16x16x32_bf16 v[166:169], v[74:77], a[88:91], v[166:169]
    v_mfma_f32_16x16x32_bf16 v[170:173], v[74:77], a[92:95], v[170:173]
    s_cbranch_vccnz Lz11_r
Lz11_ok:
    v_mfma_f32_16x16x32_bf16 v[158:161], v[78:81], a[224:227], v[158:161]
    global_load_dwordx4 v[62:65], v30, s[64:65] offset:-1024 sc1
    ds_read_b128 v[146:149], v23 offset:0
    v_mfma_f32_16x16x32_bf16 v[162:165], v[78:81], a[228:231], v[162:165]
    ds_read_b128 v[150:153], v23 offset:1024
    v_mfma_f32_16x16x32_bf16 v[166:169], v[78:81], a[232:235], v[166:169]
    ds_read_b128 v[154:157], v23 offset:2048
    v_mfma_f32_16x16x32_bf16 v[170:173], v[78:81], a[236:239], v[170:173]
    v_lshlrev_b32 v12, 16, v48
    v_mfma_f32_16x16x32_bf16 v[158:161], v[82:85], a[240:243], v[158:161]
    global_load_dwordx4 v[66:69], v31, s[64:65] offset:-1024 sc1
    v_and_b32 v13, 0xffff0000, v48
    v_mfma_f32_16x16x32_bf16 v[162:165], v[82:85], a[244:247], v[162:165]
    v_mfma_f32_16x16x32_bf16 v[166:169], v[82:85], a[248:251], v[166:169]
    v_lshlrev_b32 v14, 16, v49
    v_mfma_f32_16x16x32_bf16 v[170:173], v[82:85], a[252:255], v[170:173]
    v_and_b32 v15, 0xffff0000, v49
    v_mfma_f32_16x16x32_bf16 v[158:161], v[86:89], a[192:195], v[158:161]
    global_load_dwordx4 v[70:73], v30, s[66:67] offset:-1024 sc1
    s_waitcnt lgkmcnt(2)
    v_add_f32 v142, v142, v146
    v_mfma_f32_16x16x32_bf16 v[162:165], v[86:89], a[196:199], v[162:165]
    v_add_f32 v143, v143, v147
    v_mfma_f32_16x16x32_bf16 v[166:169], v[86:89], a[200:203], v[166:169]
    s_waitcnt vmcnt(13)
    v_and_b32 v28, v97, v101
    v_mfma_f32_16x16x32_bf16 v[170:173], v[86:89], a[204:207], v[170:173]
    s_waitcnt vmcnt(11)
    v_bitop3_b32 v28, v105, v109, v28 bitop3:0x80
    v_add_f32 v144, v144, v148
    v_mfma_f32_16x16x32_bf16 v[158:161], v[90:93], a[208:211], v[158:161]
    v_and_b32 v28, 1, v28
    global_load_dwordx4 v[74:77], v31, s[66:67] offset:-1024 sc1
    v_mfma_f32_16x16x32_bf16 v[162:165], v[90:93], a[212:215], v[162:165]
    v_add_f32 v145, v145, v149
    v_cmp_ne_u32 vcc, 1, v28
    v_mfma_f32_16x16x32_bf16 v[166:169], v[90:93], a[216:219], v[166:169]
    s_waitcnt lgkmcnt(1)
    v_add_f32 v142, v142, v150
    v_add_f32 v143, v143, v151
    v_mfma_f32_16x16x32_bf16 v[170:173], v[90:93], a[220:223], v[170:173]
    s_cbranch_vccnz Lz12_r
Lz12_ok:
    v_mfma_f32_16x16x32_bf16 v[158:161], v[94:97], a[96:99], v[158:161]
    global_load_dwordx4 v[78:81], v30, s[60:61] offset:0 sc1
    v_add_f32 v144, v144, v152
    v_mfma_f32_16x16x32_bf16 v[162:165], v[94:97], a[100:103], v[162:165]
    v_add_f32 v145, v145, v153
    v_mfma_f32_16x16x32_bf16 v[166:169], v[94:97], a[104:107], v[166:169]
    s_waitcnt lgkmcnt(0)
    v_add_f32 v142, v142, v154
    v_mfma_f32_16x16x32_bf16 v[170:173], v[94:97], a[108:111], v[170:173]
    v_mfma_f32_16x16x32_bf16 v[158:161], v[98:101], a[112:115], v[158:161]
    global_load_dwordx4 v[82:85], v31, s[60:61] offset:0 sc1
    v_add_f32 v143, v143, v155
    v_mfma_f32_16x16x32_bf16 v[162:165], v[98:101], a[116:119], v[162:165]
    v_add_f32 v144, v144, v156
    v_mfma_f32_16x16x32_bf16 v[166:169], v[98:101], a[120:123], v[166:169]
    v_add_f32 v145, v145, v157
    v_mfma_f32_16x16x32_bf16 v[170:173], v[98:101], a[124:127], v[170:173]
    v_mfma_f32_16x16x32_bf16 v[158:161], v[102:105], a[128:131], v[158:161]
    global_load_dwordx4 v[86:89], v30, s[62:63] offset:0 sc1
    v_mul_f32 v142, v142, v12
    v_mfma_f32_16x16x32_bf16 v[162:165], v[102:105], a[132:135], v[162:165]
    v_mul_f32 v143, v143, v13
    v_mfma_f32_16x16x32_bf16 v[166:169], v[102:105], a[136:139], v[166:169]
    s_waitcnt vmcnt(13)
    v_and_b32 v28, v113, v117
    v_mul_f32 v144, v144, v14
    v_mfma_f32_16x16x32_bf16 v[170:173], v[102:105], a[140:143], v[170:173]
    s_waitcnt vmcnt(11)
    v_bitop3_b32 v28, v121, v125, v28 bitop3:0x80
    v_mfma_f32_16x16x32_bf16 v[158:161], v[106:109], a[144:147], v[158:161]
    v_and_b32 v28, 1, v28
    global_load_dwordx4 v[90:93], v31, s[62:63] offset:0 sc1
    v_mfma_f32_16x16x32_bf16 v[162:165], v[106:109], a[148:151], v[162:165]
    v_mul_f32 v145, v145, v15
    v_cmp_ne_u32 vcc, 1, v28
    v_mfma_f32_16x16x32_bf16 v[166:169], v[106:109], a[152:155], v[166:169]
    v_cvt_pk_bf16_f32 v48, v142, v143
    v_cvt_pk_bf16_f32 v49, v144, v145
    v_mfma_f32_16x16x32_bf16 v[170:173], v[106:109], a[156:159], v[170:173]
    s_cbranch_vccnz Lz13_r
Lz13_ok:
    v_mfma_f32_16x16x32_bf16 v[174:177], v[110:113], a[32:35], v[174:177]
    global_load_dwordx4 v[94:97], v30, s[52:53] offset:0 sc1
    v_mfma_f32_16x16x32_bf16 v[178:181], v[110:113], a[36:39], v[178:181]
    v_mfma_f32_16x16x32_bf16 v[182:185], v[110:113], a[40:43], v[182:185]
    v_mfma_f32_16x16x32_bf16 v[186:189], v[110:113], a[44:47], v[186:189]
    ds_write_b128 v20, v[162:165] offset:12288
    v_mfma_f32_16x16x32_bf16 v[174:177], v[114:117], a[48:51], v[174:177]
    global_load_dwordx4 v[98:101], v31, s[52:53] offset:0 sc1
    v_mfma_f32_16x16x32_bf16 v[178:181], v[114:117], a[52:55], v[178:181]
    v_mfma_f32_16x16x32_bf16 v[182:185], v[114:117], a[56:59], v[182:185]
    ds_write_b128 v21, v[166:169] offset:12288
    v_mfma_f32_16x16x32_bf16 v[186:189], v[114:117], a[60:63], v[186:189]
    v_mfma_f32_16x16x32_bf16 v[174:177], v[118:121], a[64:67], v[174:177]
    global_load_dwordx4 v[102:105], v30, s[54:55] offset:0 sc1
    v_mfma_f32_16x16x32_bf16 v[178:181], v[118:121], a[68:71], v[178:181]
    ds_write_b128 v22, v[170:173] offset:12288
    v_mfma_f32_16x16x32_bf16 v[182:185], v[118:121], a[72:75], v[182:185]
    s_waitcnt vmcnt(13)
    v_and_b32 v28, v129, v133
    v_mfma_f32_16x16x32_bf16 v[186:189], v[118:121], a[76:79], v[186:189]
    s_waitcnt vmcnt(11)
    v_bitop3_b32 v28, v137, v141, v28 bitop3:0x80
    v_mfma_f32_16x16x32_bf16 v[174:177], v[122:125], a[80:83], v[174:177]
    v_and_b32 v28, 1, v28
    global_load_dwordx4 v[106:109], v31, s[54:55] offset:0 sc1
    v_mfma_f32_16x16x32_bf16 v[178:181], v[122:125], a[84:87], v[178:181]
    s_waitcnt lgkmcnt(0)
    s_barrier
    v_cmp_ne_u32 vcc, 1, v28
    v_mfma_f32_16x16x32_bf16 v[182:185], v[122:125], a[88:91], v[182:185]
    v_mfma_f32_16x16x32_bf16 v[186:189], v[122:125], a[92:95], v[186:189]
    s_cbranch_vccnz Lz14_r
Lz14_ok:
    v_mfma_f32_16x16x32_bf16 v[174:177], v[126:129], a[224:227], v[174:177]
    global_load_dwordx4 v[110:113], v30, s[64:65] offset:0 sc1
    ds_read_b128 v[162:165], v23 offset:12288
    v_mfma_f32_16x16x32_bf16 v[178:181], v[126:129], a[228:231], v[178:181]
    ds_read_b128 v[166:169], v23 offset:13312
    v_mfma_f32_16x16x32_bf16 v[182:185], v[126:129], a[232:235], v[182:185]
    ds_read_b128 v[170:173], v23 offset:14336
    global_load_dwordx4 v[114:117], v31, s[64:65] offset:0 sc1
    v_mfma_f32_16x16x32_bf16 v[186:189], v[126:129], a[236:239], v[186:189]
    v_lshlrev_b32 v12, 16, v50
    v_mfma_f32_16x16x32_bf16 v[174:177], v[130:133], a[240:243], v[174:177]
    v_and_b32 v13, 0xffff0000, v50
    v_mfma_f32_16x16x32_bf16 v[178:181], v[130:133], a[244:247], v[178:181]
    global_load_dwordx4 v[118:121], v30, s[66:67] offset:0 sc1
    v_mfma_f32_16x16x32_bf16 v[182:185], v[130:133], a[248:251], v[182:185]
    v_lshlrev_b32 v14, 16, v51
    v_mfma_f32_16x16x32_bf16 v[186:189], v[130:133], a[252:255], v[186:189]
    v_and_b32 v15, 0xffff0000, v51
    v_mfma_f32_16x16x32_bf16 v[174:177], v[134:137], a[192:195], v[174:177]
    global_load_dwordx4 v[122:125], v31, s[66:67] offset:0 sc1
    s_waitcnt lgkmcnt(2)
    v_add_f32 v158, v158, v162
    v_mfma_f32_16x16x32_bf16 v[178:181], v[134:137], a[196:199], v[178:181]
    v_add_f32 v159, v159, v163
    v_mfma_f32_16x16x32_bf16 v[182:185], v[134:137], a[200:203], v[182:185]
    s_waitcnt vmcnt(14)
    v_and_b32 v28, v65, v69
    global_load_lds_dwordx4 v4, s[92:93] offset:2048 sc1
    v_mfma_f32_16x16x32_bf16 v[186:189], v[134:137], a[204:207], v[186:189]
    s_waitcnt vmcnt(13)
    v_bitop3_b32 v28, v73, v77, v28 bitop3:0x80
    v_add_f32 v160, v160, v164
    v_mfma_f32_16x16x32_bf16 v[174:177], v[138:141], a[208:211], v[174:177]
    v_and_b32 v28, 1, v28
    v_add_f32 v161, v161, v165
    v_mfma_f32_16x16x32_bf16 v[178:181], v[138:141], a[212:215], v[178:181]
    v_cmp_ne_u32 vcc, 1, v28
    global_load_lds_dwordx4 v4, s[92:93] offset:3072 sc1
    v_mfma_f32_16x16x32_bf16 v[182:185], v[138:141], a[216:219], v[182:185]
    s_waitcnt lgkmcnt(1)
    v_add_f32 v158, v158, v166
    v_add_f32 v159, v159, v167
    v_mfma_f32_16x16x32_bf16 v[186:189], v[138:141], a[220:223], v[186:189]
    s_cbranch_vccnz Lz15_r
Lz15_ok:
    v_mfma_f32_16x16x32_bf16 v[174:177], v[62:65], a[96:99], v[174:177]
    global_load_dwordx4 v[126:129], v30, s[60:61] offset:1024 sc1
    v_add_f32 v160, v160, v168
    v_mfma_f32_16x16x32_bf16 v[178:181], v[62:65], a[100:103], v[178:181]
    v_add_f32 v161, v161, v169
    global_load_dwordx4 v[130:133], v31, s[60:61] offset:1024 sc1
    v_mfma_f32_16x16x32_bf16 v[182:185], v[62:65], a[104:107], v[182:185]
    s_waitcnt lgkmcnt(0)
    v_add_f32 v158, v158, v170
    v_mfma_f32_16x16x32_bf16 v[186:189], v[62:65], a[108:111], v[186:189]
    global_load_dwordx4 v[134:137], v30, s[62:63] offset:1024 sc1
    v_add_f32 v159, v159, v171
    v_mfma_f32_16x16x32_bf16 v[174:177], v[66:69], a[112:115], v[174:177]
    v_add_f32 v160, v160, v172
    v_mfma_f32_16x16x32_bf16 v[178:181], v[66:69], a[116:119], v[178:181]
    global_load_dwordx4 v[138:141], v31, s[62:63] offset:1024 sc1
    v_mfma_f32_16x16x32_bf16 v[182:185], v[66:69], a[120:123], v[182:185]
    v_add_f32 v161, v161, v173
    v_mfma_f32_16x16x32_bf16 v[186:189], v[66:69], a[124:127], v[186:189]
    s_add_u32 m0, s95, 8192
    v_mul_f32 v158, v158, v12
    v_mfma_f32_16x16x32_bf16 v[174:177], v[70:73], a[128:131], v[174:177]
    v_mul_f32 v159, v159, v13
    s_add_u32 s92, s92, 4096
    s_addc_u32 s93, s93, 0
    v_mfma_f32_16x16x32_bf16 v[178:181], v[70:73], a[132:135], v[178:181]
    v_mul_f32 v160, v160, v14
    v_mfma_f32_16x16x32_bf16 v[182:185], v[70:73], a[136:139], v[182:185]
    s_waitcnt vmcnt(16)
    v_and_b32 v28, v81, v85
    v_mfma_f32_16x16x32_bf16 v[186:189], v[70:73], a[140:143], v[186:189]
    s_waitcnt vmcnt(14)
    v_bitop3_b32 v28, v89, v93, v28 bitop3:0x80
    v_mul_f32 v161, v161, v15
    v_mfma_f32_16x16x32_bf16 v[174:177], v[74:77], a[144:147], v[174:177]
    v_and_b32 v28, 1, v28
    v_cvt_pk_bf16_f32 v50, v158, v159
    v_mfma_f32_16x16x32_bf16 v[178:181], v[74:77], a[148:151], v[178:181]
    global_load_lds_dwordx4 v4, s[92:93] offset:0 sc1
    v_cmp_ne_u32 vcc, 1, v28
    v_mfma_f32_16x16x32_bf16 v[182:185], v[74:77], a[152:155], v[182:185]
    v_cvt_pk_bf16_f32 v51, v160, v161
    global_load_lds_dwordx4 v4, s[92:93] offset:1024 sc1
    v_mfma_f32_16x16x32_bf16 v[186:189], v[74:77], a[156:159], v[186:189]
    v_and_b32 v51, -2, v51
    s_cbranch_vccnz Lz16_r
Lz16_ok:
    v_mfma_f32_16x16x32_bf16 v[190:193], v[78:81], a[32:35], v[190:193]
    global_load_dwordx4 v[62:65], v30, s[52:53] offset:1024 sc1
    v_mfma_f32_16x16x32_bf16 v[194:197], v[78:81], a[36:39], v[194:197]
    v_mfma_f32_16x16x32_bf16 v[198:201], v[78:81], a[40:43], v[198:201]
    global_load_dwordx4 v[66:69], v31, s[52:53] offset:1024 sc1
    v_mfma_f32_16x16x32_bf16 v[202:205], v[78:81], a[44:47], v[202:205]
    ds_write_b128 v20, v[178:181] offset:0
    v_mfma_f32_16x16x32_bf16 v[190:193], v[82:85], a[48:51], v[190:193]
    v_mfma_f32_16x16x32_bf16 v[194:197], v[82:85], a[52:55], v[194:197]
    global_load_dwordx4 v[70:73], v30, s[54:55] offset:1024 sc1
    v_mfma_f32_16x16x32_bf16 v[198:201], v[82:85], a[56:59], v[198:201]
    ds_write_b128 v21, v[182:185] offset:0
    v_mfma_f32_16x16x32_bf16 v[202:205], v[82:85], a[60:63], v[202:205]
    v_mfma_f32_16x16x32_bf16 v[190:193], v[86:89], a[64:67], v[190:193]
    global_load_dwordx4 v[74:77], v31, s[54:55] offset:1024 sc1
    v_mfma_f32_16x16x32_bf16 v[194:197], v[86:89], a[68:71], v[194:197]
    ds_write_b128 v22, v[186:189] offset:0
    v_mfma_f32_16x16x32_bf16 v[198:201], v[86:89], a[72:75], v[198:201]
    s_waitcnt vmcnt(18)
    v_and_b32 v28, v97, v101
    global_load_lds_dwordx4 v4, s[92:93] offset:2048 sc1
    v_mfma_f32_16x16x32_bf16 v[202:205], v[86:89], a[76:79], v[202:205]
    s_waitcnt vmcnt(17)
    v_bitop3_b32 v28, v105, v109, v28 bitop3:0x80
    v_mfma_f32_16x16x32_bf16 v[190:193], v[90:93], a[80:83], v[190:193]
    v_and_b32 v28, 1, v28
    s_waitcnt lgkmcnt(0)
    s_barrier
    v_mfma_f32_16x16x32_bf16 v[194:197], v[90:93], a[84:87], v[194:197]
    v_cmp_ne_u32 vcc, 1, v28
    global_load_lds_dwordx4 v4, s[92:93] offset:3072 sc1
    v_mfma_f32_16x16x32_bf16 v[198:201], v[90:93], a[88:91], v[198:201]
    v_mfma_f32_16x16x32_bf16 v[202:205], v[90:93], a[92:95], v[202:205]
    s_cbranch_vccnz Lz17_r
Lz17_ok:
    v_mfma_f32_16x16x32_bf16 v[190:193], v[94:97], a[224:227], v[190:193]
    global_load_dwordx4 v[78:81], v30, s[64:65] offset:1024 sc1
    ds_read_b128 v[178:181], v23 offset:0
    v_mfma_f32_16x16x32_bf16 v[194:197], v[94:97], a[228:231], v[194:197]
    ds_read_b128 v[182:185], v23 offset:1024
    global_load_dwordx4 v[82:85], v31, s[64:65] offset:1024 sc1
    v_mfma_f32_16x16x32_bf16 v[198:201], v[94:97], a[232:235], v[198:201]
    ds_read_b128 v[186:189], v23 offset:2048
    v_mfma_f32_16x16x32_bf16 v[202:205], v[94:97], a[236:239], v[202:205]
    global_load_dwordx4 v[86:89], v30, s[66:67] offset:1024 sc1
    v_lshlrev_b32 v12, 16, v52
    v_mfma_f32_16x16x32_bf16 v[190:193], v[98:101], a[240:243], v[190:193]
    v_and_b32 v13, 0xffff0000, v52
    v_mfma_f32_16x16x32_bf16 v[194:197], v[98:101], a[244:247], v[194:197]
    global_load_dwordx4 v[90:93], v31, s[66:67] offset:1024 sc1
    v_mfma_f32_16x16x32_bf16 v[198:201], v[98:101], a[248:251], v[198:201]
    v_lshlrev_b32 v14, 16, v53
    v_mfma_f32_16x16x32_bf16 v[202:205], v[98:101], a[252:255], v[202:205]
    s_add_u32 m0, s95, 12288
    v_and_b32 v15, 0xffff0000, v53
    v_mfma_f32_16x16x32_bf16 v[190:193], v[102:105], a[192:195], v[190:193]
    s_waitcnt lgkmcnt(2)
    v_add_f32 v174, v174, v178
    s_add_u32 s92, s92, 4096
    s_addc_u32 s93, s93, 0
    v_mfma_f32_16x16x32_bf16 v[194:197], v[102:105], a[196:199], v[194:197]
    v_add_f32 v175, v175, v179
    v_mfma_f32_16x16x32_bf16 v[198:201], v[102:105], a[200:203], v[198:201]
    s_waitcnt vmcnt(20)
    v_and_b32 v28, v113, v117
    v_mfma_f32_16x16x32_bf16 v[202:205], v[102:105], a[204:207], v[202:205]
    s_waitcnt vmcnt(18)
    v_bitop3_b32 v28, v121, v125, v28 bitop3:0x80
    v_add_f32 v176, v176, v180
    v_mfma_f32_16x16x32_bf16 v[190:193], v[106:109], a[208:211], v[190:193]
    v_and_b32 v28, 1, v28
    v_add_f32 v177, v177, v181
    v_mfma_f32_16x16x32_bf16 v[194:197], v[106:109], a[212:215], v[194:197]
    global_load_lds_dwordx4 v4, s[92:93] offset:0 sc1
    v_cmp_ne_u32 vcc, 1, v28
    v_mfma_f32_16x16x32_bf16 v[198:201], v[106:109], a[216:219], v[198:201]
    s_waitcnt lgkmcnt(1)
    v_add_f32 v174, v174, v182
    global_load_lds_dwordx4 v4, s[92:93] offset:1024 sc1
    v_mfma_f32_16x16x32_bf16 v[202:205], v[106:109], a[220:223], v[202:205]
    v_add_f32 v175, v175, v183
    s_cbranch_vccnz Lz18_r
Lz18_ok:
    v_mfma_f32_16x16x32_bf16 v[190:193], v[110:113], a[96:99], v[190:193]
    global_load_dwordx4 v[94:97], v30, s[60:61] offset:2048 sc1
    v_add_f32 v176, v176, v184
    v_mfma_f32_16x16x32_bf16 v[194:197], v[110:113], a[100:103], v[194:197]
    v_add_f32 v177, v177, v185
    v_mfma_f32_16x16x32_bf16 v[198:201], v[110:113], a[104:107], v[198:201]
    global_load_dwordx4 v[98:101], v31, s[60:61] offset:2048 sc1
    s_waitcnt lgkmcnt(0)
    v_add_f32 v174, v174, v186
    v_mfma_f32_16x16x32_bf16 v[202:205], v[110:113], a[108:111], v[202:205]
    v_mfma_f32_16x16x32_bf16 v[190:193], v[114:117], a[112:115], v[190:193]
    v_add_f32 v175, v175, v187
    v_mfma_f32_16x16x32_bf16 v[194:197], v[114:117], a[116:119], v[194:197]
    global_load_dwordx4 v[102:105], v30, s[62:63] offset:2048 sc1
    v_add_f32 v176, v176, v188
    v_mfma_f32_16x16x32_bf16 v[198:201], v[114:117], a[120:123], v[198:201]
    v_add_f32 v177, v177, v189
    v_mfma_f32_16x16x32_bf16 v[202:205], v[114:117], a[124:127], v[202:205]
    v_mfma_f32_16x16x32_bf16 v[190:193], v[118:121], a[128:131], v[190:193]
    global_load_dwordx4 v[106:109], v31, s[62:63] offset:2048 sc1
    v_mul_f32 v174, v174, v12
    v_mfma_f32_16x16x32_bf16 v[194:197], v[118:121], a[132:135], v[194:197]
    v_mul_f32 v175, v175, v13
    v_mfma_f32_16x16x32_bf16 v[198:201], v[118:121], a[136:139], v[198:201]
    s_waitcnt vmcnt(20)
    v_and_b32 v28, v129, v133
    global_load_lds_dwordx4 v4, s[92:93] offset:2048 sc1
    v_mfma_f32_16x16x32_bf16 v[202:205], v[118:121], a[140:143], v[202:205]
    s_waitcnt vmcnt(19)
    v_bitop3_b32 v28, v137, v141, v28 bitop3:0x80
    v_mul_f32 v176, v176, v14
    v_mfma_f32_16x16x32_bf16 v[190:193], v[122:125], a[144:147], v[190:193]
    v_and_b32 v28, 1, v28
    v_mul_f32 v177, v177, v15
    v_mfma_f32_16x16x32_bf16 v[194:197], v[122:125], a[148:151], v[194:197]
    v_cmp_ne_u32 vcc, 1, v28
    global_load_lds_dwordx4 v4, s[92:93] offset:3072 sc1
    v_mfma_f32_16x16x32_bf16 v[198:201], v[122:125], a[152:155], v[198:201]
    v_cvt_pk_bf16_f32 v52, v174, v175
    v_cvt_pk_bf16_f32 v53, v176, v177
    v_mfma_f32_16x16x32_bf16 v[202:205], v[122:125], a[156:159], v[202:205]
    s_cbranch_vccnz Lz19_r
Lz19_ok:
    v_mfma_f32_16x16x32_bf16 v[206:209], v[126:129], a[32:35], v[206:209]
    global_load_dwordx4 v[110:113], v30, s[52:53] offset:2048 sc1
    v_mfma_f32_16x16x32_bf16 v[210:213], v[126:129], a[36:39], v[210:213]
    global_load_dwordx4 v[114:117], v31, s[52:53] offset:2048 sc1
    v_mfma_f32_16x16x32_bf16 v[214:217], v[126:129], a[40:43], v[214:217]
    v_mfma_f32_16x16x32_bf16 v[218:221], v[126:129], a[44:47], v[218:221]
    ds_write_b128 v20, v[194:197] offset:12288
    v_mfma_f32_16x16x32_bf16 v[206:209], v[130:133], a[48:51], v[206:209]
    global_load_dwordx4 v[118:121], v30, s[54:55] offset:2048 sc1
    v_mfma_f32_16x16x32_bf16 v[210:213], v[130:133], a[52:55], v[210:213]
    global_load_dwordx4 v[122:125], v31, s[54:55] offset:2048 sc1
    v_mfma_f32_16x16x32_bf16 v[214:217], v[130:133], a[56:59], v[214:217]
    ds_write_b128 v21, v[198:201] offset:12288
    v_mfma_f32_16x16x32_bf16 v[218:221], v[130:133], a[60:63], v[218:221]
    s_add_u32 m0, s95, 16384
    v_mfma_f32_16x16x32_bf16 v[206:209], v[134:137], a[64:67], v[206:209]
    s_add_u32 s92, s92, 4096
    s_addc_u32 s93, s93, 0
    v_mfma_f32_16x16x32_bf16 v[210:213], v[134:137], a[68:71], v[210:213]
    ds_write_b128 v22, v[202:205] offset:12288
    v_mfma_f32_16x16x32_bf16 v[214:217], v[134:137], a[72:75], v[214:217]
    s_waitcnt vmcnt(20)
    v_and_b32 v28, v65, v69
    v_mfma_f32_16x16x32_bf16 v[218:221], v[134:137], a[76:79], v[218:221]
    s_waitcnt vmcnt(18)
    v_bitop3_b32 v28, v73, v77, v28 bitop3:0x80
    v_mfma_f32_16x16x32_bf16 v[206:209], v[138:141], a[80:83], v[206:209]
    v_and_b32 v28, 1, v28
    global_load_lds_dwordx4 v4, s[92:93] offset:0 sc1
    v_mfma_f32_16x16x32_bf16 v[210:213], v[138:141], a[84:87], v[210:213]
    s_waitcnt lgkmcnt(0)
    s_barrier
    v_cmp_ne_u32 vcc, 1, v28
    v_mfma_f32_16x16x32_bf16 v[214:217], v[138:141], a[88:91], v[214:217]
    global_load_lds_dwordx4 v4, s[92:93] offset:1024 sc1
    v_mfma_f32_16x16x32_bf16 v[218:221], v[138:141], a[92:95], v[218:221]
    s_cbranch_vccnz Lz20_r
Lz20_ok:
    v_mfma_f32_16x16x32_bf16 v[206:209], v[62:65], a[224:227], v[206:209]
    global_load_dwordx4 v[126:129], v30, s[64:65] offset:2048 sc1
    ds_read_b128 v[194:197], v23 offset:12288
    v_mfma_f32_16x16x32_bf16 v[210:213], v[62:65], a[228:231], v[210:213]
    ds_read_b128 v[198:201], v23 offset:13312
    v_mfma_f32_16x16x32_bf16 v[214:217], v[62:65], a[232:235], v[214:217]
    ds_read_b128 v[202:205], v23 offset:14336
    global_load_dwordx4 v[130:133], v31, s[64:65] offset:2048 sc1
    v_mfma_f32_16x16x32_bf16 v[218:221], v[62:65], a[236:239], v[218:221]
    v_lshlrev_b32 v12, 16, v54
    v_mfma_f32_16x16x32_bf16 v[206:209], v[66:69], a[240:243], v[206:209]
    v_and_b32 v13, 0xffff0000, v54
    v_mfma_f32_16x16x32_bf16 v[210:213], v[66:69], a[244:247], v[210:213]
    global_load_dwordx4 v[134:137], v30, s[66:67] offset:2048 sc1
    v_mfma_f32_16x16x32_bf16 v[214:217], v[66:69], a[248:251], v[214:217]
    v_lshlrev_b32 v14, 16, v55
    v_mfma_f32_16x16x32_bf16 v[218:221], v[66:69], a[252:255], v[218:221]
    v_and_b32 v15, 0xffff0000, v55
    v_mfma_f32_16x16x32_bf16 v[206:209], v[70:73], a[192:195], v[206:209]
    global_load_dwordx4 v[138:141], v31, s[66:67] offset:2048 sc1
    s_waitcnt lgkmcnt(2)
    v_add_f32 v190, v190, v194
    v_mfma_f32_16x16x32_bf16 v[210:213], v[70:73], a[196:199], v[210:213]
    v_add_f32 v191, v191, v195
    v_mfma_f32_16x16x32_bf16 v[214:217], v[70:73], a[200:203], v[214:217]
    s_waitcnt vmcnt(20)
    v_and_b32 v28, v81, v85
    global_load_lds_dwordx4 v4, s[92:93] offset:2048 sc1
    v_mfma_f32_16x16x32_bf16 v[218:221], v[70:73], a[204:207], v[218:221]
    s_waitcnt vmcnt(19)
    v_bitop3_b32 v28, v89, v93, v28 bitop3:0x80
    v_add_f32 v192, v192, v196
    v_mfma_f32_16x16x32_bf16 v[206:209], v[74:77], a[208:211], v[206:209]
    v_and_b32 v28, 1, v28
    v_add_f32 v193, v193, v197
    v_mfma_f32_16x16x32_bf16 v[210:213], v[74:77], a[212:215], v[210:213]
    v_cmp_ne_u32 vcc, 1, v28
    global_load_lds_dwordx4 v4, s[92:93] offset:3072 sc1
    v_mfma_f32_16x16x32_bf16 v[214:217], v[74:77], a[216:219], v[214:217]
    s_waitcnt lgkmcnt(1)
    v_add_f32 v190, v190, v198
    v_add_f32 v191, v191, v199
    v_mfma_f32_16x16x32_bf16 v[218:221], v[74:77], a[220:223], v[218:221]
    s_cbranch_vccnz Lz21_r
Lz21_ok:
    v_mfma_f32_16x16x32_bf16 v[206:209], v[78:81], a[96:99], v[206:209]
    global_load_dwordx4 v[62:65], v30, s[60:61] offset:3072 sc1
    v_add_f32 v192, v192, v200
    v_mfma_f32_16x16x32_bf16 v[210:213], v[78:81], a[100:103], v[210:213]
    v_add_f32 v193, v193, v201
    global_load_dwordx4 v[66:69], v31, s[60:61] offset:3072 sc1
    v_mfma_f32_16x16x32_bf16 v[214:217], v[78:81], a[104:107], v[214:217]
    s_waitcnt lgkmcnt(0)
    v_add_f32 v190, v190, v202
    v_mfma_f32_16x16x32_bf16 v[218:221], v[78:81], a[108:111], v[218:221]
    global_load_dwordx4 v[70:73], v30, s[62:63] offset:3072 sc1
    v_add_f32 v191, v191, v203
    v_mfma_f32_16x16x32_bf16 v[206:209], v[82:85], a[112:115], v[206:209]
    v_add_f32 v192, v192, v204
    v_mfma_f32_16x16x32_bf16 v[210:213], v[82:85], a[116:119], v[210:213]
    global_load_dwordx4 v[74:77], v31, s[62:63] offset:3072 sc1
    v_mfma_f32_16x16x32_bf16 v[214:217], v[82:85], a[120:123], v[214:217]
    v_add_f32 v193, v193, v205
    v_mfma_f32_16x16x32_bf16 v[218:221], v[82:85], a[124:127], v[218:221]
    s_add_u32 m0, s95, 20480
    v_mul_f32 v190, v190, v12
    v_mfma_f32_16x16x32_bf16 v[206:209], v[86:89], a[128:131], v[206:209]
    v_mul_f32 v191, v191, v13
    s_add_u32 s92, s92, 4096
    s_addc_u32 s93, s93, 0
    v_mfma_f32_16x16x32_bf16 v[210:213], v[86:89], a[132:135], v[210:213]
    v_mul_f32 v192, v192, v14
    v_mfma_f32_16x16x32_bf16 v[214:217], v[86:89], a[136:139], v[214:217]
    s_waitcnt vmcnt(20)
    v_and_b32 v28, v97, v101
    v_mfma_f32_16x16x32_bf16 v[218:221], v[86:89], a[140:143], v[218:221]
    s_waitcnt vmcnt(18)
    v_bitop3_b32 v28, v105, v109, v28 bitop3:0x80
    v_mul_f32 v193, v193, v15
    v_mfma_f32_16x16x32_bf16 v[206:209], v[90:93], a[144:147], v[206:209]
    v_and_b32 v28, 1, v28
    v_cvt_pk_bf16_f32 v54, v190, v191
    v_mfma_f32_16x16x32_bf16 v[210:213], v[90:93], a[148:151], v[210:213]
    global_load_lds_dwordx4 v4, s[92:93] offset:0 sc1
    v_cmp_ne_u32 vcc, 1, v28
    v_mfma_f32_16x16x32_bf16 v[214:217], v[90:93], a[152:155], v[214:217]
    v_cvt_pk_bf16_f32 v55, v192, v193
    global_load_lds_dwordx4 v4, s[92:93] offset:1024 sc1
    v_mfma_f32_16x16x32_bf16 v[218:221], v[90:93], a[156:159], v[218:221]
    v_and_b32 v55, -2, v55
    s_cbranch_vccnz Lz22_r
Lz22_ok:
    v_mfma_f32_16x16x32_bf16 v[222:225], v[94:97], a[32:35], v[222:225]
    global_load_dwordx4 v[78:81], v30, s[52:53] offset:3072 sc1
    v_mfma_f32_16x16x32_bf16 v[226:229], v[94:97], a[36:39], v[226:229]
    v_mfma_f32_16x16x32_bf16 v[230:233], v[94:97], a[40:43], v[230:233]
    global_load_dwordx4 v[82:85], v31, s[52:53] offset:3072 sc1
    v_mfma_f32_16x16x32_bf16 v[234:237], v[94:97], a[44:47], v[234:237]
    ds_write_b128 v20, v[210:213] offset:0
    v_mfma_f32_16x16x32_bf16 v[222:225], v[98:101], a[48:51], v[222:225]
    global_load_dwordx4 v[86:89], v30, s[54:55] offset:3072 sc1
    v_mfma_f32_16x16x32_bf16 v[226:229], v[98:101], a[52:55], v[226:229]
    v_mfma_f32_16x16x32_bf16 v[230:233], v[98:101], a[56:59], v[230:233]
    global_load_dwordx4 v[90:93], v31, s[54:55] offset:3072 sc1
    v_mfma_f32_16x16x32_bf16 v[234:237], v[98:101], a[60:63], v[234:237]
    ds_write_b128 v21, v[214:217] offset:0
    v_mfma_f32_16x16x32_bf16 v[222:225], v[102:105], a[64:67], v[222:225]
    global_store_dwordx4 v6, v[48:51], s[8:9] offset:-4096 sc1
    v_mfma_f32_16x16x32_bf16 v[226:229], v[102:105], a[68:71], v[226:229]
    ds_write_b128 v22, v[218:221] offset:0
    v_mfma_f32_16x16x32_bf16 v[230:233], v[102:105], a[72:75], v[230:233]
    s_waitcnt vmcnt(21)
    v_and_b32 v28, v113, v117
    global_store_dwordx4 v7, v[52:55], s[8:9] offset:-4096 sc1
    v_mfma_f32_16x16x32_bf16 v[234:237], v[102:105], a[76:79], v[234:237]
    s_waitcnt vmcnt(20)
    v_bitop3_b32 v28, v121, v125, v28 bitop3:0x80
    v_mfma_f32_16x16x32_bf16 v[222:225], v[106:109], a[80:83], v[222:225]
    v_and_b32 v28, 1, v28
    global_load_lds_dwordx4 v4, s[92:93] offset:2048 sc1
    v_mfma_f32_16x16x32_bf16 v[226:229], v[106:109], a[84:87], v[226:229]
    s_waitcnt lgkmcnt(0)
    s_barrier
    v_cmp_ne_u32 vcc, 1, v28
    v_mfma_f32_16x16x32_bf16 v[230:233], v[106:109], a[88:91], v[230:233]
    global_load_lds_dwordx4 v4, s[92:93] offset:3072 sc1
    v_mfma_f32_16x16x32_bf16 v[234:237], v[106:109], a[92:95], v[234:237]
    s_cbranch_vccnz Lz23_r
Lz23_ok:
    v_mfma_f32_16x16x32_bf16 v[222:225], v[110:113], a[224:227], v[222:225]
    global_load_dwordx4 v[94:97], v30, s[64:65] offset:3072 sc1
    ds_read_b128 v[210:213], v23 offset:0
    v_mfma_f32_16x16x32_bf16 v[226:229], v[110:113], a[228:231], v[226:229]
    ds_read_b128 v[214:217], v23 offset:1024
    global_load_dwordx4 v[98:101], v31, s[64:65] offset:3072 sc1
    v_mfma_f32_16x16x32_bf16 v[230:233], v[110:113], a[232:235], v[230:233]
    ds_read_b128 v[218:221], v23 offset:2048
    v_mfma_f32_16x16x32_bf16 v[234:237], v[110:113], a[236:239], v[234:237]
    global_load_dwordx4 v[102:105], v30, s[66:67] offset:3072 sc1
    v_lshlrev_b32 v12, 16, v56
    v_mfma_f32_16x16x32_bf16 v[222:225], v[114:117], a[240:243], v[222:225]
    v_and_b32 v13, 0xffff0000, v56
    v_mfma_f32_16x16x32_bf16 v[226:229], v[114:117], a[244:247], v[226:229]
    global_load_dwordx4 v[106:109], v31, s[66:67] offset:3072 sc1
    v_mfma_f32_16x16x32_bf16 v[230:233], v[114:117], a[248:251], v[230:233]
    v_lshlrev_b32 v14, 16, v57
    v_mfma_f32_16x16x32_bf16 v[234:237], v[114:117], a[252:255], v[234:237]
    s_add_u32 m0, s95, 24576
    v_and_b32 v15, 0xffff0000, v57
    v_mfma_f32_16x16x32_bf16 v[222:225], v[118:121], a[192:195], v[222:225]
    s_waitcnt lgkmcnt(2)
    v_add_f32 v206, v206, v210
    s_add_u32 s92, s92, 4096
    s_addc_u32 s93, s93, 0
    v_mfma_f32_16x16x32_bf16 v[226:229], v[118:121], a[196:199], v[226:229]
    v_add_f32 v207, v207, v211
    v_mfma_f32_16x16x32_bf16 v[230:233], v[118:121], a[200:203], v[230:233]
    s_waitcnt vmcnt(22)
    v_and_b32 v28, v129, v133
    v_mfma_f32_16x16x32_bf16 v[234:237], v[118:121], a[204:207], v[234:237]
    s_waitcnt vmcnt(20)
    v_bitop3_b32 v28, v137, v141, v28 bitop3:0x80
    v_add_f32 v208, v208, v212
    v_mfma_f32_16x16x32_bf16 v[222:225], v[122:125], a[208:211], v[222:225]
    v_and_b32 v28, 1, v28
    v_add_f32 v209, v209, v213
    v_mfma_f32_16x16x32_bf16 v[226:229], v[122:125], a[212:215], v[226:229]
    global_load_lds_dwordx4 v4, s[92:93] offset:0 sc1
    v_cmp_ne_u32 vcc, 1, v28
    v_mfma_f32_16x16x32_bf16 v[230:233], v[122:125], a[216:219], v[230:233]
    s_waitcnt lgkmcnt(1)
    v_add_f32 v206, v206, v214
    global_load_lds_dwordx4 v4, s[92:93] offset:1024 sc1
    v_mfma_f32_16x16x32_bf16 v[234:237], v[122:125], a[220:223], v[234:237]
    v_add_f32 v207, v207, v215
    s_cbranch_vccnz Lz24_r
Lz24_ok:
    v_mfma_f32_16x16x32_bf16 v[222:225], v[126:129], a[96:99], v[222:225]
    global_load_lds_dwordx4 v4, s[92:93] offset:2048 sc1
    v_add_f32 v208, v208, v216
    v_mfma_f32_16x16x32_bf16 v[226:229], v[126:129], a[100:103], v[226:229]
    v_add_f32 v209, v209, v217
    v_mfma_f32_16x16x32_bf16 v[230:233], v[126:129], a[104:107], v[230:233]
    s_waitcnt lgkmcnt(0)
    v_add_f32 v206, v206, v218
    v_mfma_f32_16x16x32_bf16 v[234:237], v[126:129], a[108:111], v[234:237]
    v_mfma_f32_16x16x32_bf16 v[222:225], v[130:133], a[112:115], v[222:225]
    v_add_f32 v207, v207, v219
    v_mfma_f32_16x16x32_bf16 v[226:229], v[130:133], a[116:119], v[226:229]
    v_add_f32 v208, v208, v220
    v_mfma_f32_16x16x32_bf16 v[230:233], v[130:133], a[120:123], v[230:233]
    v_add_f32 v209, v209, v221
    v_mfma_f32_16x16x32_bf16 v[234:237], v[130:133], a[124:127], v[234:237]
    v_mfma_f32_16x16x32_bf16 v[222:225], v[134:137], a[128:131], v[222:225]
    global_load_lds_dwordx4 v4, s[92:93] offset:3072 sc1
    v_mul_f32 v206, v206, v12
    v_mfma_f32_16x16x32_bf16 v[226:229], v[134:137], a[132:135], v[226:229]
    v_mul_f32 v207, v207, v13
    v_mfma_f32_16x16x32_bf16 v[230:233], v[134:137], a[136:139], v[230:233]
    s_waitcnt vmcnt(20)
    v_and_b32 v28, v65, v69
    v_mul_f32 v208, v208, v14
    v_mfma_f32_16x16x32_bf16 v[234:237], v[134:137], a[140:143], v[234:237]
    s_waitcnt vmcnt(18)
    v_bitop3_b32 v28, v73, v77, v28 bitop3:0x80
    v_mfma_f32_16x16x32_bf16 v[222:225], v[138:141], a[144:147], v[222:225]
    v_and_b32 v28, 1, v28
    v_mul_f32 v209, v209, v15
    v_mfma_f32_16x16x32_bf16 v[226:229], v[138:141], a[148:151], v[226:229]
    v_cmp_ne_u32 vcc, 1, v28
    v_cvt_pk_bf16_f32 v56, v206, v207
    v_mfma_f32_16x16x32_bf16 v[230:233], v[138:141], a[152:155], v[230:233]
    v_cvt_pk_bf16_f32 v57, v208, v209
    v_mfma_f32_16x16x32_bf16 v[234:237], v[138:141], a[156:159], v[234:237]
    s_cbranch_vccnz Lz25_r
Lz25_ok:
    v_mfma_f32_16x16x32_bf16 v[238:241], v[62:65], a[32:35], v[238:241]
    s_add_u32 m0, s95, 28672
    v_mfma_f32_16x16x32_bf16 v[242:245], v[62:65], a[36:39], v[242:245]
    v_mfma_f32_16x16x32_bf16 v[246:249], v[62:65], a[40:43], v[246:249]
    v_mfma_f32_16x16x32_bf16 v[250:253], v[62:65], a[44:47], v[250:253]
    ds_write_b128 v20, v[226:229] offset:12288
    v_mfma_f32_16x16x32_bf16 v[238:241], v[66:69], a[48:51], v[238:241]
    s_add_u32 s92, s92, 4096
    s_addc_u32 s93, s93, 0
    v_mfma_f32_16x16x32_bf16 v[242:245], v[66:69], a[52:55], v[242:245]
    v_mfma_f32_16x16x32_bf16 v[246:249], v[66:69], a[56:59], v[246:249]
    ds_write_b128 v21, v[230:233] offset:12288
    v_mfma_f32_16x16x32_bf16 v[250:253], v[66:69], a[60:63], v[250:253]
    v_mfma_f32_16x16x32_bf16 v[238:241], v[70:73], a[64:67], v[238:241]
    v_mfma_f32_16x16x32_bf16 v[242:245], v[70:73], a[68:71], v[242:245]
    ds_write_b128 v22, v[234:237] offset:12288
    v_mfma_f32_16x16x32_bf16 v[246:249], v[70:73], a[72:75], v[246:249]
    s_waitcnt vmcnt(14)
    v_and_b32 v28, v81, v85
    global_load_lds_dwordx4 v4, s[92:93] offset:0 sc1
    v_mfma_f32_16x16x32_bf16 v[250:253], v[70:73], a[76:79], v[250:253]
    s_waitcnt vmcnt(13)
    v_bitop3_b32 v28, v89, v93, v28 bitop3:0x80
    v_mfma_f32_16x16x32_bf16 v[238:241], v[74:77], a[80:83], v[238:241]
    v_and_b32 v28, 1, v28
    s_waitcnt lgkmcnt(0)
    s_barrier
    v_mfma_f32_16x16x32_bf16 v[242:245], v[74:77], a[84:87], v[242:245]
    global_load_lds_dwordx4 v4, s[92:93] offset:1024 sc1
    v_cmp_ne_u32 vcc, 1, v28
    v_mfma_f32_16x16x32_bf16 v[246:249], v[74:77], a[88:91], v[246:249]
    v_mfma_f32_16x16x32_bf16 v[250:253], v[74:77], a[92:95], v[250:253]
    s_cbranch_vccnz Lz26_r
Lz26_ok:
    v_mfma_f32_16x16x32_bf16 v[238:241], v[78:81], a[224:227], v[238:241]
    global_load_lds_dwordx4 v4, s[92:93] offset:2048 sc1
    ds_read_b128 v[226:229], v23 offset:12288
    v_mfma_f32_16x16x32_bf16 v[242:245], v[78:81], a[228:231], v[242:245]
    ds_read_b128 v[230:233], v23 offset:13312
    v_mfma_f32_16x16x32_bf16 v[246:249], v[78:81], a[232:235], v[246:249]
    ds_read_b128 v[234:237], v23 offset:14336
    v_mfma_f32_16x16x32_bf16 v[250:253], v[78:81], a[236:239], v[250:253]
    v_lshlrev_b32 v12, 16, v58
    v_mfma_f32_16x16x32_bf16 v[238:241], v[82:85], a[240:243], v[238:241]
    v_and_b32 v13, 0xffff0000, v58
    v_mfma_f32_16x16x32_bf16 v[242:245], v[82:85], a[244:247], v[242:245]
    v_mfma_f32_16x16x32_bf16 v[246:249], v[82:85], a[248:251], v[246:249]
    v_lshlrev_b32 v14, 16, v59
    v_mfma_f32_16x16x32_bf16 v[250:253], v[82:85], a[252:255], v[250:253]
    v_and_b32 v15, 0xffff0000, v59
    v_mfma_f32_16x16x32_bf16 v[238:241], v[86:89], a[192:195], v[238:241]
    global_load_lds_dwordx4 v4, s[92:93] offset:3072 sc1
    s_waitcnt lgkmcnt(2)
    v_add_f32 v222, v222, v226
    v_mfma_f32_16x16x32_bf16 v[242:245], v[86:89], a[196:199], v[242:245]
    v_add_f32 v223, v223, v227
    v_mfma_f32_16x16x32_bf16 v[246:249], v[86:89], a[200:203], v[246:249]
    s_waitcnt vmcnt(10)
    v_and_b32 v28, v97, v101
    v_mfma_f32_16x16x32_bf16 v[250:253], v[86:89], a[204:207], v[250:253]
    s_waitcnt vmcnt(8)
    v_bitop3_b32 v28, v105, v109, v28 bitop3:0x80
    v_add_f32 v224, v224, v228
    v_mfma_f32_16x16x32_bf16 v[238:241], v[90:93], a[208:211], v[238:241]
    v_and_b32 v28, 1, v28
    v_add_f32 v225, v225, v229
    v_mfma_f32_16x16x32_bf16 v[242:245], v[90:93], a[212:215], v[242:245]
    v_cmp_ne_u32 vcc, 1, v28
    s_waitcnt lgkmcnt(1)
    v_add_f32 v222, v222, v230
    v_mfma_f32_16x16x32_bf16 v[246:249], v[90:93], a[216:219], v[246:249]
    v_add_f32 v223, v223, v231
    v_mfma_f32_16x16x32_bf16 v[250:253], v[90:93], a[220:223], v[250:253]
    s_cbranch_vccnz Lz27_r
Lz27_ok:
    v_mfma_f32_16x16x32_bf16 v[238:241], v[94:97], a[96:99], v[238:241]
    s_add_u32 m0, s95, 32768
    v_add_f32 v224, v224, v232
    v_mfma_f32_16x16x32_bf16 v[242:245], v[94:97], a[100:103], v[242:245]
    v_add_f32 v225, v225, v233
    v_mfma_f32_16x16x32_bf16 v[246:249], v[94:97], a[104:107], v[246:249]
    s_waitcnt lgkmcnt(0)
    v_add_f32 v222, v222, v234
    v_mfma_f32_16x16x32_bf16 v[250:253], v[94:97], a[108:111], v[250:253]
    s_add_u32 s92, s92, 4096
    s_addc_u32 s93, s93, 0
    v_add_f32 v223, v223, v235
    v_mfma_f32_16x16x32_bf16 v[238:241], v[98:101], a[112:115], v[238:241]
    v_add_f32 v224, v224, v236
    v_mfma_f32_16x16x32_bf16 v[242:245], v[98:101], a[116:119], v[242:245]
    v_mfma_f32_16x16x32_bf16 v[246:249], v[98:101], a[120:123], v[246:249]
    v_add_f32 v225, v225, v237
    v_mfma_f32_16x16x32_bf16 v[250:253], v[98:101], a[124:127], v[250:253]
    v_mul_f32 v222, v222, v12
    v_mfma_f32_16x16x32_bf16 v[238:241], v[102:105], a[128:131], v[238:241]
    v_mul_f32 v223, v223, v13
    v_mfma_f32_16x16x32_bf16 v[242:245], v[102:105], a[132:135], v[242:245]
    global_load_lds_dwordx4 v4, s[92:93] offset:0 sc1
    v_mul_f32 v224, v224, v14
    v_mfma_f32_16x16x32_bf16 v[246:249], v[102:105], a[136:139], v[246:249]
    v_mfma_f32_16x16x32_bf16 v[250:253], v[102:105], a[140:143], v[250:253]
    v_mul_f32 v225, v225, v15
    v_mfma_f32_16x16x32_bf16 v[238:241], v[106:109], a[144:147], v[238:241]
    v_cvt_pk_bf16_f32 v58, v222, v223
    global_load_lds_dwordx4 v4, s[92:93] offset:1024 sc1
    v_mfma_f32_16x16x32_bf16 v[242:245], v[106:109], a[148:151], v[242:245]
    v_cvt_pk_bf16_f32 v59, v224, v225
    v_mfma_f32_16x16x32_bf16 v[246:249], v[106:109], a[152:155], v[246:249]
    v_and_b32 v59, -2, v59
    v_mfma_f32_16x16x32_bf16 v[250:253], v[106:109], a[156:159], v[250:253]
    global_load_dwordx4 v[142:145], v6, s[38:39] offset:-4096 sc1
    s_nop 2
    ds_write_b128 v20, v[242:245] offset:0
    s_nop 0
    ds_write_b128 v21, v[246:249] offset:0
    global_load_dwordx4 v[146:149], v6, s[38:39] offset:-3072 sc1
    ds_write_b128 v22, v[250:253] offset:0
    s_waitcnt lgkmcnt(0)
    s_barrier
    global_load_dwordx4 v[150:153], v6, s[38:39] offset:-2048 sc1
    ds_read_b128 v[242:245], v23 offset:0
    ds_read_b128 v[246:249], v23 offset:1024
    global_load_dwordx4 v[154:157], v6, s[38:39] offset:-1024 sc1
    ds_read_b128 v[250:253], v23 offset:2048
    v_lshlrev_b32 v12, 16, v60
    v_and_b32 v13, 0xffff0000, v60
    global_load_dwordx4 v[158:161], v6, s[38:39] offset:0 sc1
    v_lshlrev_b32 v14, 16, v61
    v_and_b32 v15, 0xffff0000, v61
    global_load_dwordx4 v[162:165], v6, s[38:39] offset:1024 sc1
    s_waitcnt lgkmcnt(2)
    v_pk_add_f32 v[238:239], v[238:239], v[242:243] op_sel:[0,0] op_sel_hi:[1,1]
    v_pk_add_f32 v[240:241], v[240:241], v[244:245] op_sel:[0,0] op_sel_hi:[1,1]
    s_waitcnt lgkmcnt(1)
    v_pk_add_f32 v[238:239], v[238:239], v[246:247] op_sel:[0,0] op_sel_hi:[1,1]
    global_load_dwordx4 v[166:169], v6, s[38:39] offset:2048 sc1
    v_pk_add_f32 v[240:241], v[240:241], v[248:249] op_sel:[0,0] op_sel_hi:[1,1]
    s_waitcnt lgkmcnt(0)
    v_pk_add_f32 v[238:239], v[238:239], v[250:251] op_sel:[0,0] op_sel_hi:[1,1]
    global_load_dwordx4 v[170:173], v6, s[38:39] offset:3072 sc1
    v_pk_add_f32 v[240:241], v[240:241], v[252:253] op_sel:[0,0] op_sel_hi:[1,1]
    v_pk_mul_f32 v[238:239], v[238:239], v[12:13] op_sel:[0,0] op_sel_hi:[1,1]
    v_pk_mul_f32 v[240:241], v[240:241], v[14:15] op_sel:[0,0] op_sel_hi:[1,1]
    v_cvt_pk_bf16_f32 v60, v238, v239
    v_cvt_pk_bf16_f32 v61, v240, v241
    v_and_b32 v61, -2, v61
    global_store_dwordx4 v26, v[56:59], s[8:9] offset:-4096 sc1
    global_store_dwordx2 v27, v[60:61], s[10:11] offset:-4096 sc1
    v_add_u32 v30, 61440, v4
    v_add_u32 v31, 122880, v4
    global_load_dwordx4 v[174:177], v7, s[38:39] offset:-4096 sc1
    global_load_dwordx4 v[178:181], v7, s[38:39] offset:-3072 sc1
    global_load_dwordx4 v[182:185], v7, s[38:39] offset:-2048 sc1
    global_load_dwordx4 v[186:189], v7, s[38:39] offset:-1024 sc1
    global_load_dwordx4 v[190:193], v7, s[38:39] offset:0 sc1
    global_load_dwordx4 v[194:197], v7, s[38:39] offset:1024 sc1
    global_load_dwordx4 v[198:201], v7, s[38:39] offset:2048 sc1
    global_load_dwordx4 v[202:205], v7, s[38:39] offset:3072 sc1
    s_waitcnt vmcnt(18)
    s_barrier
    ds_read_b128 v[82:85], v4 offset:0
    ds_read_b128 v[86:89], v4 offset:1024
    ds_read_b128 v[90:93], v4 offset:2048
    ds_read_b128 v[94:97], v4 offset:3072
    ds_read_b128 v[98:101], v4 offset:4096
    s_waitcnt vmcnt(16)
    v_or_b32 v28, v145, v149
    s_waitcnt vmcnt(14)
    v_or3_b32 v28, v153, v157, v28
    s_waitcnt vmcnt(12)
    v_or3_b32 v28, v161, v165, v28
    s_waitcnt vmcnt(10)
    v_or3_b32 v28, v169, v173, v28
    v_and_b32 v28, 1, v28
    v_cmp_ne_u32 vcc, 0, v28
    s_nop 0
    s_cbranch_vccnz Lp0_r
Lp0_ok:
    s_waitcnt lgkmcnt(4)
    v_mfma_f32_16x16x32_bf16 v[62:65], v[82:85], v[142:145], 0
    ds_read_b128 v[102:105], v4 offset:20480
    s_waitcnt lgkmcnt(4)
    v_mfma_f32_16x16x32_bf16 v[66:69], v[86:89], v[142:145], 0
    ds_read_b128 v[82:85], v4 offset:21504
    s_waitcnt lgkmcnt(4)
    v_mfma_f32_16x16x32_bf16 v[70:73], v[90:93], v[142:145], 0
    ds_read_b128 v[86:89], v4 offset:22528
    s_waitcnt lgkmcnt(4)
    v_mfma_f32_16x16x32_bf16 v[74:77], v[94:97], v[142:145], 0
    ds_read_b128 v[90:93], v4 offset:23552
    s_waitcnt lgkmcnt(4)
    v_mfma_f32_16x16x32_bf16 v[78:81], v[98:101], v[142:145], 0
    ds_read_b128 v[94:97], v4 offset:24576
    s_waitcnt lgkmcnt(4)
    v_mfma_f32_16x16x32_bf16 v[62:65], v[102:105], v[146:149], v[62:65]
    ds_read_b128 v[98:101], v4 offset:35840
    s_waitcnt lgkmcnt(4)
    v_mfma_f32_16x16x32_bf16 v[66:69], v[82:85], v[146:149], v[66:69]
    ds_read_b128 v[102:105], v4 offset:36864
    s_waitcnt lgkmcnt(4)
    v_mfma_f32_16x16x32_bf16 v[70:73], v[86:89], v[146:149], v[70:73]
    ds_read_b128 v[82:85], v4 offset:37888
    s_waitcnt lgkmcnt(4)
    v_mfma_f32_16x16x32_bf16 v[74:77], v[90:93], v[146:149], v[74:77]
    ds_read_b128 v[86:89], v4 offset:38912
    s_waitcnt lgkmcnt(4)
    v_mfma_f32_16x16x32_bf16 v[78:81], v[94:97], v[146:149], v[78:81]
    ds_read_b128 v[90:93], v4 offset:39936
    s_waitcnt lgkmcnt(4)
    v_mfma_f32_16x16x32_bf16 v[62:65], v[98:101], v[150:153], v[62:65]
    ds_read_b128 v[94:97], v4 offset:56320
    s_waitcnt lgkmcnt(4)
    v_mfma_f32_16x16x32_bf16 v[66:69], v[102:105], v[150:153], v[66:69]
    ds_read_b128 v[98:101], v4 offset:57344
    s_waitcnt lgkmcnt(4)
    v_mfma_f32_16x16x32_bf16 v[70:73], v[82:85], v[150:153], v[70:73]
    ds_read_b128 v[102:105], v4 offset:58368
    s_waitcnt lgkmcnt(4)
    v_mfma_f32_16x16x32_bf16 v[74:77], v[86:89], v[150:153], v[74:77]
    ds_read_b128 v[82:85], v4 offset:59392
    s_waitcnt lgkmcnt(4)
    v_mfma_f32_16x16x32_bf16 v[78:81], v[90:93], v[150:153], v[78:81]
    ds_read_b128 v[86:89], v4 offset:60416
    s_waitcnt lgkmcnt(4)
    v_mfma_f32_16x16x32_bf16 v[62:65], v[94:97], v[154:157], v[62:65]
    ds_read_b128 v[90:93], v30 offset:10240
    s_waitcnt lgkmcnt(4)
    v_mfma_f32_16x16x32_bf16 v[66:69], v[98:101], v[154:157], v[66:69]
    ds_read_b128 v[94:97], v30 offset:11264
    s_waitcnt lgkmcnt(4)
    v_mfma_f32_16x16x32_bf16 v[70:73], v[102:105], v[154:157], v[70:73]
    ds_read_b128 v[98:101], v30 offset:12288
    s_waitcnt lgkmcnt(4)
    v_mfma_f32_16x16x32_bf16 v[74:77], v[82:85], v[154:157], v[74:77]
    ds_read_b128 v[102:105], v30 offset:13312
    s_waitcnt lgkmcnt(4)
    v_mfma_f32_16x16x32_bf16 v[78:81], v[86:89], v[154:157], v[78:81]
    ds_read_b128 v[82:85], v30 offset:14336
    s_waitcnt lgkmcnt(4)
    v_mfma_f32_16x16x32_bf16 v[62:65], v[90:93], v[158:161], v[62:65]
    ds_read_b128 v[86:89], v30 offset:30720
    s_waitcnt lgkmcnt(4)
    v_mfma_f32_16x16x32_bf16 v[66:69], v[94:97], v[158:161], v[66:69]
    ds_read_b128 v[90:93], v30 offset:31744
    s_waitcnt lgkmcnt(4)
    v_mfma_f32_16x16x32_bf16 v[70:73], v[98:101], v[158:161], v[70:73]
    ds_read_b128 v[94:97], v30 offset:32768
    s_waitcnt lgkmcnt(4)
    v_mfma_f32_16x16x32_bf16 v[74:77], v[102:105], v[158:161], v[74:77]
    ds_read_b128 v[98:101], v30 offset:33792
    s_waitcnt lgkmcnt(4)
    v_mfma_f32_16x16x32_bf16 v[78:81], v[82:85], v[158:161], v[78:81]
    ds_read_b128 v[102:105], v30 offset:34816
    s_waitcnt lgkmcnt(4)
    v_mfma_f32_16x16x32_bf16 v[62:65], v[86:89], v[162:165], v[62:65]
    ds_read_b128 v[82:85], v30 offset:46080
    s_waitcnt lgkmcnt(4)
    v_mfma_f32_16x16x32_bf16 v[66:69], v[90:93], v[162:165], v[66:69]
    ds_read_b128 v[86:89], v30 offset:47104
    s_waitcnt lgkmcnt(4)
    v_mfma_f32_16x16x32_bf16 v[70:73], v[94:97], v[162:165], v[70:73]
    ds_read_b128 v[90:93], v30 offset:48128
    s_waitcnt lgkmcnt(4)
    v_mfma_f32_16x16x32_bf16 v[74:77], v[98:101], v[162:165], v[74:77]
    ds_read_b128 v[94:97], v30 offset:49152
    s_waitcnt lgkmcnt(4)
    v_mfma_f32_16x16x32_bf16 v[78:81], v[102:105], v[162:165], v[78:81]
    ds_read_b128 v[98:101], v30 offset:50176
    s_waitcnt lgkmcnt(4)
    v_mfma_f32_16x16x32_bf16 v[62:65], v[82:85], v[166:169], v[62:65]
    ds_read_b128 v[102:105], v31 offset:5120
    s_waitcnt lgkmcnt(4)
    v_mfma_f32_16x16x32_bf16 v[66:69], v[86:89], v[166:169], v[66:69]
    ds_read_b128 v[82:85], v31 offset:6144
    s_waitcnt lgkmcnt(4)
    v_mfma_f32_16x16x32_bf16 v[70:73], v[90:93], v[166:169], v[70:73]
    ds_read_b128 v[86:89], v31 offset:7168
    s_waitcnt lgkmcnt(4)
    v_mfma_f32_16x16x32_bf16 v[74:77], v[94:97], v[166:169], v[74:77]
    ds_read_b128 v[90:93], v31 offset:8192
    s_waitcnt lgkmcnt(4)
    v_mfma_f32_16x16x32_bf16 v[78:81], v[98:101], v[166:169], v[78:81]
    ds_read_b128 v[94:97], v31 offset:9216
    s_waitcnt lgkmcnt(4)
    v_mfma_f32_16x16x32_bf16 v[62:65], v[102:105], v[170:173], v[62:65]
    ds_read_b128 v[98:101], v4 offset:5120
    s_waitcnt lgkmcnt(4)
    v_mfma_f32_16x16x32_bf16 v[66:69], v[82:85], v[170:173], v[66:69]
    ds_read_b128 v[102:105], v4 offset:6144
    s_waitcnt lgkmcnt(4)
    v_mfma_f32_16x16x32_bf16 v[70:73], v[86:89], v[170:173], v[70:73]
    ds_read_b128 v[82:85], v4 offset:7168
    s_waitcnt lgkmcnt(4)
    v_mfma_f32_16x16x32_bf16 v[74:77], v[90:93], v[170:173], v[74:77]
    ds_read_b128 v[86:89], v4 offset:8192
    s_waitcnt lgkmcnt(4)
    v_mfma_f32_16x16x32_bf16 v[78:81], v[94:97], v[170:173], v[78:81]
    ds_read_b128 v[90:93], v4 offset:9216
    s_waitcnt vmcnt(6)
    v_or_b32 v28, v177, v181
    s_waitcnt vmcnt(4)
    v_or3_b32 v28, v185, v189, v28
    s_waitcnt vmcnt(2)
    v_or3_b32 v28, v193, v197, v28
    s_waitcnt vmcnt(0)
    v_or3_b32 v28, v201, v205, v28
    v_and_b32 v28, 1, v28
    v_cmp_ne_u32 vcc, 0, v28
    s_nop 0
    s_cbranch_vccnz Lp1_r
Lp1_ok:
    s_waitcnt lgkmcnt(4)
    v_mfma_f32_16x16x32_bf16 v[62:65], v[98:101], v[174:177], v[62:65]
    ds_read_b128 v[94:97], v4 offset:25600
    s_waitcnt lgkmcnt(4)
    v_mfma_f32_16x16x32_bf16 v[66:69], v[102:105], v[174:177], v[66:69]
    ds_read_b128 v[98:101], v4 offset:26624
    s_waitcnt lgkmcnt(4)
    v_mfma_f32_16x16x32_bf16 v[70:73], v[82:85], v[174:177], v[70:73]
    ds_read_b128 v[102:105], v4 offset:27648
    s_waitcnt lgkmcnt(4)
    v_mfma_f32_16x16x32_bf16 v[74:77], v[86:89], v[174:177], v[74:77]
    ds_read_b128 v[82:85], v4 offset:28672
    s_waitcnt lgkmcnt(4)
    v_mfma_f32_16x16x32_bf16 v[78:81], v[90:93], v[174:177], v[78:81]
    ds_read_b128 v[86:89], v4 offset:29696
    s_waitcnt lgkmcnt(4)
    v_mfma_f32_16x16x32_bf16 v[62:65], v[94:97], v[178:181], v[62:65]
    ds_read_b128 v[90:93], v4 offset:40960
    s_waitcnt lgkmcnt(4)
    v_mfma_f32_16x16x32_bf16 v[66:69], v[98:101], v[178:181], v[66:69]
    ds_read_b128 v[94:97], v4 offset:41984
    s_waitcnt lgkmcnt(4)
    v_mfma_f32_16x16x32_bf16 v[70:73], v[102:105], v[178:181], v[70:73]
    ds_read_b128 v[98:101], v4 offset:43008
    s_waitcnt lgkmcnt(4)
    v_mfma_f32_16x16x32_bf16 v[74:77], v[82:85], v[178:181], v[74:77]
    ds_read_b128 v[102:105], v4 offset:44032
    s_waitcnt lgkmcnt(4)
    v_mfma_f32_16x16x32_bf16 v[78:81], v[86:89], v[178:181], v[78:81]
    ds_read_b128 v[82:85], v4 offset:45056
    s_waitcnt lgkmcnt(4)
    v_mfma_f32_16x16x32_bf16 v[62:65], v[90:93], v[182:185], v[62:65]
    ds_read_b128 v[86:89], v30 offset:0
    global_load_dwordx4 v[206:209], v26, s[38:39] offset:-4096 sc1
    s_waitcnt lgkmcnt(4)
    v_mfma_f32_16x16x32_bf16 v[66:69], v[94:97], v[182:185], v[66:69]
    ds_read_b128 v[90:93], v30 offset:1024
    s_waitcnt lgkmcnt(4)
    v_mfma_f32_16x16x32_bf16 v[70:73], v[98:101], v[182:185], v[70:73]
    ds_read_b128 v[94:97], v30 offset:2048
    global_load_dwordx4 v[210:213], v26, s[38:39] offset:-3072 sc1
    s_waitcnt lgkmcnt(4)
    v_mfma_f32_16x16x32_bf16 v[74:77], v[102:105], v[182:185], v[74:77]
    ds_read_b128 v[98:101], v30 offset:3072
    s_waitcnt lgkmcnt(4)
    v_mfma_f32_16x16x32_bf16 v[78:81], v[82:85], v[182:185], v[78:81]
    ds_read_b128 v[102:105], v30 offset:4096
    s_waitcnt lgkmcnt(4)
    v_mfma_f32_16x16x32_bf16 v[62:65], v[86:89], v[186:189], v[62:65]
    ds_read_b128 v[82:85], v30 offset:15360
    global_load_dwordx4 v[214:217], v26, s[38:39] offset:-2048 sc1
    s_waitcnt lgkmcnt(4)
    v_mfma_f32_16x16x32_bf16 v[66:69], v[90:93], v[186:189], v[66:69]
    ds_read_b128 v[86:89], v30 offset:16384
    s_waitcnt lgkmcnt(4)
    v_mfma_f32_16x16x32_bf16 v[70:73], v[94:97], v[186:189], v[70:73]
    ds_read_b128 v[90:93], v30 offset:17408
    s_waitcnt lgkmcnt(4)
    v_mfma_f32_16x16x32_bf16 v[74:77], v[98:101], v[186:189], v[74:77]
    ds_read_b128 v[94:97], v30 offset:18432
    global_load_dwordx4 v[218:221], v26, s[38:39] offset:-1024 sc1
    s_waitcnt lgkmcnt(4)
    v_mfma_f32_16x16x32_bf16 v[78:81], v[102:105], v[186:189], v[78:81]
    ds_read_b128 v[98:101], v30 offset:19456
    s_waitcnt lgkmcnt(4)
    v_mfma_f32_16x16x32_bf16 v[62:65], v[82:85], v[190:193], v[62:65]
    ds_read_b128 v[102:105], v30 offset:35840
    global_load_dwordx4 v[222:225], v26, s[38:39] offset:0 sc1
    s_waitcnt lgkmcnt(4)
    v_mfma_f32_16x16x32_bf16 v[66:69], v[86:89], v[190:193], v[66:69]
    ds_read_b128 v[82:85], v30 offset:36864
    s_waitcnt lgkmcnt(4)
    v_mfma_f32_16x16x32_bf16 v[70:73], v[90:93], v[190:193], v[70:73]
    ds_read_b128 v[86:89], v30 offset:37888
    s_waitcnt lgkmcnt(4)
    v_mfma_f32_16x16x32_bf16 v[74:77], v[94:97], v[190:193], v[74:77]
    ds_read_b128 v[90:93], v30 offset:38912
    global_load_dwordx4 v[226:229], v26, s[38:39] offset:1024 sc1
    s_waitcnt lgkmcnt(4)
    v_mfma_f32_16x16x32_bf16 v[78:81], v[98:101], v[190:193], v[78:81]
    ds_read_b128 v[94:97], v30 offset:39936
    s_waitcnt lgkmcnt(4)
    v_mfma_f32_16x16x32_bf16 v[62:65], v[102:105], v[194:197], v[62:65]
    ds_read_b128 v[98:101], v30 offset:51200
    s_waitcnt lgkmcnt(4)
    v_mfma_f32_16x16x32_bf16 v[66:69], v[82:85], v[194:197], v[66:69]
    ds_read_b128 v[102:105], v30 offset:52224
    global_load_dwordx4 v[230:233], v26, s[38:39] offset:2048 sc1
    s_waitcnt lgkmcnt(4)
    v_mfma_f32_16x16x32_bf16 v[70:73], v[86:89], v[194:197], v[70:73]
    ds_read_b128 v[82:85], v30 offset:53248
    s_waitcnt lgkmcnt(4)
    v_mfma_f32_16x16x32_bf16 v[74:77], v[90:93], v[194:197], v[74:77]
    ds_read_b128 v[86:89], v30 offset:54272
    s_waitcnt lgkmcnt(4)
    v_mfma_f32_16x16x32_bf16 v[78:81], v[94:97], v[194:197], v[78:81]
    ds_read_b128 v[90:93], v30 offset:55296
    global_load_dwordx4 v[238:241], v27, s[38:39] offset:-4096 sc1
    s_waitcnt lgkmcnt(4)
    v_mfma_f32_16x16x32_bf16 v[62:65], v[98:101], v[198:201], v[62:65]
    ds_read_b128 v[94:97], v31 offset:10240
    s_waitcnt lgkmcnt(4)
    v_mfma_f32_16x16x32_bf16 v[66:69], v[102:105], v[198:201], v[66:69]
    ds_read_b128 v[98:101], v31 offset:11264
    global_load_dwordx4 v[242:245], v27, s[38:39] offset:-3072 sc1
    s_waitcnt lgkmcnt(4)
    v_mfma_f32_16x16x32_bf16 v[70:73], v[82:85], v[198:201], v[70:73]
    ds_read_b128 v[102:105], v31 offset:12288
    s_waitcnt lgkmcnt(4)
    v_mfma_f32_16x16x32_bf16 v[74:77], v[86:89], v[198:201], v[74:77]
    ds_read_b128 v[82:85], v31 offset:13312
    s_waitcnt lgkmcnt(4)
    v_mfma_f32_16x16x32_bf16 v[78:81], v[90:93], v[198:201], v[78:81]
    ds_read_b128 v[86:89], v31 offset:14336
    global_load_dwordx4 v[246:249], v27, s[38:39] offset:-2048 sc1
    s_waitcnt lgkmcnt(4)
    v_mfma_f32_16x16x32_bf16 v[62:65], v[94:97], v[202:205], v[62:65]
    ds_read_b128 v[90:93], v4 offset:10240
    s_waitcnt lgkmcnt(4)
    v_mfma_f32_16x16x32_bf16 v[66:69], v[98:101], v[202:205], v[66:69]
    ds_read_b128 v[94:97], v4 offset:11264
    s_waitcnt lgkmcnt(4)
    v_mfma_f32_16x16x32_bf16 v[70:73], v[102:105], v[202:205], v[70:73]
    ds_read_b128 v[98:101], v4 offset:12288
    global_load_dwordx4 v[250:253], v27, s[38:39] offset:-1024 sc1
    s_waitcnt lgkmcnt(4)
    v_mfma_f32_16x16x32_bf16 v[74:77], v[82:85], v[202:205], v[74:77]
    ds_read_b128 v[102:105], v4 offset:13312
    s_waitcnt lgkmcnt(4)
    v_mfma_f32_16x16x32_bf16 v[78:81], v[86:89], v[202:205], v[78:81]
    ds_read_b128 v[82:85], v4 offset:14336
    v_lshlrev_b32 v29, 5, v3
    v_add_u32 v29, 162816, v29
    ds_read_b128 v[106:109], v29 offset:0
    ds_read_b128 v[110:113], v29 offset:16
    ds_read_b128 v[114:117], v29 offset:128
    ds_read_b128 v[118:121], v29 offset:144
    v_lshlrev_b32 v29, 4, v3
    v_add_u32 v29, 162816, v29
    ds_read_b128 v[122:125], v29 offset:256
    v_lshlrev_b32 v126, 16, v36
    v_and_b32 v127, 0xffff0000, v36
    v_lshlrev_b32 v128, 16, v37
    v_and_b32 v129, 0xffff0000, v37
    v_lshlrev_b32 v130, 16, v38
    v_and_b32 v131, 0xffff0000, v38
    v_lshlrev_b32 v132, 16, v39
    v_and_b32 v133, 0xffff0000, v39
    v_lshlrev_b32 v134, 16, v40
    v_and_b32 v135, 0xffff0000, v40
    v_lshlrev_b32 v136, 16, v41
    v_and_b32 v137, 0xffff0000, v41
    v_lshlrev_b32 v138, 16, v42
    v_and_b32 v139, 0xffff0000, v42
    v_lshlrev_b32 v140, 16, v43
    v_and_b32 v141, 0xffff0000, v43
    v_lshlrev_b32 v12, 16, v44
    v_and_b32 v13, 0xffff0000, v44
    v_lshlrev_b32 v14, 16, v45
    v_and_b32 v15, 0xffff0000, v45
    v_add_u32 v46, s90, v5
    v_mul_u32_u24 v46, 1280, v46
    s_mul_i32 s4, s41, 160
    v_add_u32 v46, s4, v46
    v_lshl_add_u32 v47, v3, 4, v46
    v_lshl_add_u32 v46, v3, 3, v46
    s_waitcnt vmcnt(8)
    v_or3_b32 v28, v209, v213, v217
    s_waitcnt vmcnt(6)
    v_or3_b32 v28, v221, v225, v28
    s_waitcnt vmcnt(4)
    v_or3_b32 v28, v229, v233, v28
    v_and_b32 v28, 1, v28
    v_cmp_ne_u32 vcc, 0, v28
    s_nop 0
    s_cbranch_vccnz Lp2_r
Lp2_ok:
    s_waitcnt lgkmcnt(9)
    v_mfma_f32_16x16x32_bf16 v[62:65], v[90:93], v[206:209], v[62:65]
    ds_read_b128 v[86:89], v4 offset:30720
    s_waitcnt lgkmcnt(9)
    v_mfma_f32_16x16x32_bf16 v[66:69], v[94:97], v[206:209], v[66:69]
    ds_read_b128 v[90:93], v4 offset:31744
    s_waitcnt lgkmcnt(9)
    v_mfma_f32_16x16x32_bf16 v[70:73], v[98:101], v[206:209], v[70:73]
    ds_read_b128 v[94:97], v4 offset:32768
    s_waitcnt lgkmcnt(9)
    v_mfma_f32_16x16x32_bf16 v[74:77], v[102:105], v[206:209], v[74:77]
    ds_read_b128 v[98:101], v4 offset:33792
    s_waitcnt lgkmcnt(9)
    v_mfma_f32_16x16x32_bf16 v[78:81], v[82:85], v[206:209], v[78:81]
    ds_read_b128 v[102:105], v4 offset:34816
    s_waitcnt lgkmcnt(4)
    v_mfma_f32_16x16x32_bf16 v[62:65], v[86:89], v[210:213], v[62:65]
    ds_read_b128 v[82:85], v4 offset:46080
    s_waitcnt lgkmcnt(4)
    v_mfma_f32_16x16x32_bf16 v[66:69], v[90:93], v[210:213], v[66:69]
    ds_read_b128 v[86:89], v4 offset:47104
    s_waitcnt lgkmcnt(4)
    v_mfma_f32_16x16x32_bf16 v[70:73], v[94:97], v[210:213], v[70:73]
    ds_read_b128 v[90:93], v4 offset:48128
    s_waitcnt lgkmcnt(4)
    v_mfma_f32_16x16x32_bf16 v[74:77], v[98:101], v[210:213], v[74:77]
    ds_read_b128 v[94:97], v4 offset:49152
    s_waitcnt lgkmcnt(4)
    v_mfma_f32_16x16x32_bf16 v[78:81], v[102:105], v[210:213], v[78:81]
    ds_read_b128 v[98:101], v4 offset:50176
    s_waitcnt lgkmcnt(4)
    v_mfma_f32_16x16x32_bf16 v[62:65], v[82:85], v[214:217], v[62:65]
    ds_read_b128 v[102:105], v30 offset:5120
    s_waitcnt lgkmcnt(4)
    v_mfma_f32_16x16x32_bf16 v[66:69], v[86:89], v[214:217], v[66:69]
    ds_read_b128 v[82:85], v30 offset:6144
    s_waitcnt lgkmcnt(4)
    v_mfma_f32_16x16x32_bf16 v[70:73], v[90:93], v[214:217], v[70:73]
    ds_read_b128 v[86:89], v30 offset:7168
    s_waitcnt lgkmcnt(4)
    v_mfma_f32_16x16x32_bf16 v[74:77], v[94:97], v[214:217], v[74:77]
    ds_read_b128 v[90:93], v30 offset:8192
    s_waitcnt lgkmcnt(4)
    v_mfma_f32_16x16x32_bf16 v[78:81], v[98:101], v[214:217], v[78:81]
    ds_read_b128 v[94:97], v30 offset:9216
    s_waitcnt lgkmcnt(4)
    v_mfma_f32_16x16x32_bf16 v[62:65], v[102:105], v[218:221], v[62:65]
    ds_read_b128 v[98:101], v30 offset:20480
    s_waitcnt lgkmcnt(4)
    v_mfma_f32_16x16x32_bf16 v[66:69], v[82:85], v[218:221], v[66:69]
    ds_read_b128 v[102:105], v30 offset:21504
    s_waitcnt lgkmcnt(4)
    v_mfma_f32_16x16x32_bf16 v[70:73], v[86:89], v[218:221], v[70:73]
    ds_read_b128 v[82:85], v30 offset:22528
    s_waitcnt lgkmcnt(4)
    v_mfma_f32_16x16x32_bf16 v[74:77], v[90:93], v[218:221], v[74:77]
    ds_read_b128 v[86:89], v30 offset:23552
    s_waitcnt lgkmcnt(4)
    v_mfma_f32_16x16x32_bf16 v[78:81], v[94:97], v[218:221], v[78:81]
    ds_read_b128 v[90:93], v30 offset:24576
    s_waitcnt lgkmcnt(4)
    v_mfma_f32_16x16x32_bf16 v[62:65], v[98:101], v[222:225], v[62:65]
    ds_read_b128 v[94:97], v30 offset:40960
    s_waitcnt lgkmcnt(4)
    v_mfma_f32_16x16x32_bf16 v[66:69], v[102:105], v[222:225], v[66:69]
    ds_read_b128 v[98:101], v30 offset:41984
    s_waitcnt lgkmcnt(4)
    v_mfma_f32_16x16x32_bf16 v[70:73], v[82:85], v[222:225], v[70:73]
    ds_read_b128 v[102:105], v30 offset:43008
    s_waitcnt lgkmcnt(4)
    v_mfma_f32_16x16x32_bf16 v[74:77], v[86:89], v[222:225], v[74:77]
    ds_read_b128 v[82:85], v30 offset:44032
    s_waitcnt lgkmcnt(4)
    v_mfma_f32_16x16x32_bf16 v[78:81], v[90:93], v[222:225], v[78:81]
    ds_read_b128 v[86:89], v30 offset:45056
    s_waitcnt lgkmcnt(4)
    v_mfma_f32_16x16x32_bf16 v[62:65], v[94:97], v[226:229], v[62:65]
    ds_read_b128 v[90:93], v30 offset:56320
    s_waitcnt lgkmcnt(4)
    v_mfma_f32_16x16x32_bf16 v[66:69], v[98:101], v[226:229], v[66:69]
    ds_read_b128 v[94:97], v30 offset:57344
    s_waitcnt lgkmcnt(4)
    v_mfma_f32_16x16x32_bf16 v[70:73], v[102:105], v[226:229], v[70:73]
    ds_read_b128 v[98:101], v30 offset:58368
    s_waitcnt lgkmcnt(4)
    v_mfma_f32_16x16x32_bf16 v[74:77], v[82:85], v[226:229], v[74:77]
    ds_read_b128 v[102:105], v30 offset:59392
    s_waitcnt lgkmcnt(4)
    v_mfma_f32_16x16x32_bf16 v[78:81], v[86:89], v[226:229], v[78:81]
    ds_read_b128 v[82:85], v30 offset:60416
    s_waitcnt lgkmcnt(4)
    v_mfma_f32_16x16x32_bf16 v[62:65], v[90:93], v[230:233], v[62:65]
    ds_read_b128 v[86:89], v4 offset:15360
    s_waitcnt lgkmcnt(4)
    v_mfma_f32_16x16x32_bf16 v[66:69], v[94:97], v[230:233], v[66:69]
    ds_read_b128 v[90:93], v4 offset:16384
    s_waitcnt lgkmcnt(4)
    v_mfma_f32_16x16x32_bf16 v[70:73], v[98:101], v[230:233], v[70:73]
    ds_read_b128 v[94:97], v4 offset:17408
    s_waitcnt lgkmcnt(4)
    v_mfma_f32_16x16x32_bf16 v[74:77], v[102:105], v[230:233], v[74:77]
    ds_read_b128 v[98:101], v4 offset:18432
    s_waitcnt lgkmcnt(4)
    v_mfma_f32_16x16x32_bf16 v[78:81], v[82:85], v[230:233], v[78:81]
    ds_read_b128 v[102:105], v4 offset:19456
    s_waitcnt vmcnt(3)
    v_or_b32 v28, v239, v241
    s_waitcnt vmcnt(2)
    v_or3_b32 v28, v243, v245, v28
    s_waitcnt vmcnt(1)
    v_or3_b32 v28, v247, v249, v28
    s_waitcnt vmcnt(0)
    v_or3_b32 v28, v251, v253, v28
    v_and_b32 v28, 1, v28
    v_cmp_ne_u32 vcc, 0, v28
    s_nop 0
    s_cbranch_vccnz Lp3_r
Lp3_ok:
    s_waitcnt lgkmcnt(4)
    v_mfma_f32_16x16x32_bf16 v[62:65], v[86:89], v[238:241], v[62:65]
    ds_read_b128 v[82:85], v4 offset:51200
    s_waitcnt lgkmcnt(4)
    v_mfma_f32_16x16x32_bf16 v[66:69], v[90:93], v[238:241], v[66:69]
    ds_read_b128 v[86:89], v4 offset:52224
    s_waitcnt lgkmcnt(4)
    v_mfma_f32_16x16x32_bf16 v[70:73], v[94:97], v[238:241], v[70:73]
    ds_read_b128 v[90:93], v4 offset:53248
    s_waitcnt lgkmcnt(4)
    v_mfma_f32_16x16x32_bf16 v[74:77], v[98:101], v[238:241], v[74:77]
    ds_read_b128 v[94:97], v4 offset:54272
    s_waitcnt lgkmcnt(4)
    v_mfma_f32_16x16x32_bf16 v[78:81], v[102:105], v[238:241], v[78:81]
    ds_read_b128 v[98:101], v4 offset:55296
    s_waitcnt lgkmcnt(4)
    v_mfma_f32_16x16x32_bf16 v[62:65], v[82:85], v[242:245], v[62:65]
    ds_read_b128 v[102:105], v30 offset:25600
    s_waitcnt lgkmcnt(4)
    v_mfma_f32_16x16x32_bf16 v[66:69], v[86:89], v[242:245], v[66:69]
    ds_read_b128 v[82:85], v30 offset:26624
    s_waitcnt lgkmcnt(4)
    v_mfma_f32_16x16x32_bf16 v[70:73], v[90:93], v[242:245], v[70:73]
    ds_read_b128 v[86:89], v30 offset:27648
    s_waitcnt lgkmcnt(4)
    v_mfma_f32_16x16x32_bf16 v[74:77], v[94:97], v[242:245], v[74:77]
    ds_read_b128 v[90:93], v30 offset:28672
    s_waitcnt lgkmcnt(4)
    v_mfma_f32_16x16x32_bf16 v[78:81], v[98:101], v[242:245], v[78:81]
    ds_read_b128 v[94:97], v30 offset:29696
    s_waitcnt lgkmcnt(4)
    v_mfma_f32_16x16x32_bf16 v[62:65], v[102:105], v[246:249], v[62:65]
    ds_read_b128 v[98:101], v31 offset:0
    s_waitcnt lgkmcnt(4)
    v_mfma_f32_16x16x32_bf16 v[66:69], v[82:85], v[246:249], v[66:69]
    ds_read_b128 v[102:105], v31 offset:1024
    s_waitcnt lgkmcnt(4)
    v_mfma_f32_16x16x32_bf16 v[70:73], v[86:89], v[246:249], v[70:73]
    ds_read_b128 v[82:85], v31 offset:2048
    s_waitcnt lgkmcnt(4)
    v_mfma_f32_16x16x32_bf16 v[74:77], v[90:93], v[246:249], v[74:77]
    ds_read_b128 v[86:89], v31 offset:3072
    s_waitcnt lgkmcnt(4)
    v_mfma_f32_16x16x32_bf16 v[78:81], v[94:97], v[246:249], v[78:81]
    ds_read_b128 v[90:93], v31 offset:4096
    s_waitcnt lgkmcnt(4)
    v_mfma_f32_16x16x32_bf16 v[62:65], v[98:101], v[250:253], v[62:65]
    s_waitcnt lgkmcnt(3)
    v_mfma_f32_16x16x32_bf16 v[66:69], v[102:105], v[250:253], v[66:69]
    s_waitcnt lgkmcnt(2)
    v_mfma_f32_16x16x32_bf16 v[70:73], v[82:85], v[250:253], v[70:73]
    s_waitcnt lgkmcnt(1)
    v_mfma_f32_16x16x32_bf16 v[74:77], v[86:89], v[250:253], v[74:77]
    s_waitcnt lgkmcnt(0)
    v_mfma_f32_16x16x32_bf16 v[78:81], v[90:93], v[250:253], v[78:81]
    v_fmac_f32 v126, v62, v106
    s_nop 0
    v_fmac_f32 v127, v66, v107
    v_fmac_f32 v128, v63, v108
    v_fmac_f32 v129, v67, v109
    v_fmac_f32 v130, v64, v110
    v_fmac_f32 v131, v68, v111
    v_fmac_f32 v132, v65, v112
    v_fmac_f32 v133, v69, v113
    v_cvt_pk_bf16_f32 v142, v126, v127
    v_cvt_pk_bf16_f32 v143, v128, v129
    v_cvt_pk_bf16_f32 v144, v130, v131
    v_cvt_pk_bf16_f32 v145, v132, v133
    global_store_dwordx4 v47, v[142:145], s[34:35] offset:0
    v_fmac_f32 v134, v70, v114
    v_fmac_f32 v135, v74, v115
    v_fmac_f32 v136, v71, v116
    v_fmac_f32 v137, v75, v117
    v_fmac_f32 v138, v72, v118
    v_fmac_f32 v139, v76, v119
    v_fmac_f32 v140, v73, v120
    v_fmac_f32 v141, v77, v121
    v_cvt_pk_bf16_f32 v146, v134, v135
    v_cvt_pk_bf16_f32 v147, v136, v137
    v_cvt_pk_bf16_f32 v148, v138, v139
    v_cvt_pk_bf16_f32 v149, v140, v141
    global_store_dwordx4 v47, v[146:149], s[34:35] offset:64
    v_fmac_f32 v12, v78, v122
    v_fmac_f32 v13, v79, v123
    v_fmac_f32 v14, v80, v124
    v_fmac_f32 v15, v81, v125
    v_cvt_pk_bf16_f32 v150, v12, v13
    v_cvt_pk_bf16_f32 v151, v14, v15
    global_store_dwordx2 v46, v[150:151], s[34:35] offset:128
Lflush:
Lend:
    s_endpgm
Lspare:
    s_sub_u32 s42, s2, 160
    s_cmp_lt_u32 s42, 54
    s_cbranch_scc0 Lsp_b
    s_cmp_ge_u32 s42, 8
    s_cbranch_scc1 Lsp_a2
    s_mov_b32 s48, s42
    v_mov_b32 v8, -1
    v_mov_b32 v9, -1
    v_mov_b32 v10, -1
    v_mov_b32 v11, -1
    s_mul_i32 s4, s48, 9216
    s_mul_i32 s5, s3, 2304
    s_add_u32 s4, s4, s5
    s_add_u32 s4, s4, 32768
    v_add_u32 v6, s4, v4
    global_store_dwordx4 v6, v[8:11], s[38:39] offset:0 sc1
    global_store_dwordx4 v6, v[8:11], s[38:39] offset:1024 sc1
    global_store_dwordx4 v6, v[8:11], s[38:39] offset:1280 sc1
    s_lshl_b32 s4, s48, 2
    v_mov_b32 v6, s4
    s_waitcnt vmcnt(0)
    s_barrier
    s_cmp_lg_u32 s3, 0
    s_cbranch_scc1 Linit_skip
    global_store_dword v6, v8, s[36:37] sc1
Linit_skip:
    s_branch Lsp_a2
Lsp_b:
    s_sub_u32 s48, s42, 54
    s_add_u32 s49, s48, 42
    s_add_u32 s50, s48, 84
    s_cmp_ge_u32 s50, 120
    s_cselect_b32 s50, s49, s50
    s_cmp_eq_u32 s3, 1
    s_cselect_b32 s51, s49, s48
    s_cmp_eq_u32 s3, 2
    s_cselect_b32 s51, s50, s51
    s_lshr_b32 s4, s51, 1
    s_and_b32 s5, s51, 1
    s_cmp_lt_u32 s4, 50
    s_cselect_b32 s6, -20, 0
    s_cmp_lt_u32 s4, 20
    s_cselect_b32 s6, 30, s6
    s_add_u32 s4, s4, s6
    s_mul_i32 s6, s5, 15360
    s_lshl_b32 s7, s4, 8
    s_add_u32 s51, s6, s7
    v_lshl_add_u32 v164, v1, 2, s51
    v_mov_b32 v165, -1
    global_store_dword v164, v165, s[38:39] offset:0 sc1
    s_lshr_b32 s4, s48, 1
    s_and_b32 s5, s48, 1
    s_cmp_lt_u32 s4, 50
    s_cselect_b32 s6, -20, 0
    s_cmp_lt_u32 s4, 20
    s_cselect_b32 s6, 30, s6
    s_add_u32 s4, s4, s6
    s_mul_i32 s6, s5, 15360
    s_lshl_b32 s7, s4, 8
    s_add_u32 s44, s6, s7
    s_lshl_b32 s5, s5, 2
    s_add_u32 s5, s5, s3
    s_mul_i32 s5, s5, 80
    s_lshl_b32 s4, s4, 7
    s_mul_i32 s6, s5, 7680
    s_add_u32 s4, s4, s6
    v_min_u32 v28, 39, v1
    s_lshl_b32 s5, s5, 1
    v_lshl_add_u32 v28, v28, 2, s5
    global_load_dword v80, v28, s[30:31]
    v_lshrrev_b32 v29, 3, v1
    v_mul_u32_u24 v28, 15232, v29
    v_add3_u32 v28, v28, v4, s4
    global_load_dwordx4 v[40:43], v28, s[32:33] nt
    v_add_u32 v28, 7680, v28
    global_load_dwordx4 v[44:47], v28, s[32:33] nt
    v_add_u32 v28, 115200, v28
    global_load_dwordx4 v[48:51], v28, s[32:33] nt
    v_add_u32 v28, 7680, v28
    global_load_dwordx4 v[52:55], v28, s[32:33] nt
    v_add_u32 v28, 115200, v28
    global_load_dwordx4 v[56:59], v28, s[32:33] nt
    v_add_u32 v28, 7680, v28
    global_load_dwordx4 v[60:63], v28, s[32:33] nt
    v_add_u32 v28, 115200, v28
    global_load_dwordx4 v[64:67], v28, s[32:33] nt
    v_add_u32 v28, 7680, v28
    global_load_dwordx4 v[68:71], v28, s[32:33] nt
    v_add_u32 v28, 115200, v28
    global_load_dwordx4 v[72:75], v28, s[32:33] nt
    v_add_u32 v28, 7680, v28
    global_load_dwordx4 v[76:79], v28, s[32:33] nt
    s_lshl_b32 s4, s48, 2
    s_add_u32 s4, s4, 60
    v_mov_b32 v164, s4
    s_waitcnt vmcnt(10)
    s_barrier
    s_cmp_lg_u32 s3, 0
    s_cbranch_scc1 Lsb_skip
    global_store_dword v164, v165, s[36:37] sc1
    s_branch Lsb_skip2
Lsb_skip:
    global_load_dword v165, v164, s[30:31]
Lsb_skip2:
    s_lshr_b32 s4, s49, 1
    s_and_b32 s5, s49, 1
    s_cmp_lt_u32 s4, 50
    s_cselect_b32 s6, -20, 0
    s_cmp_lt_u32 s4, 20
    s_cselect_b32 s6, 30, s6
    s_add_u32 s4, s4, s6
    s_mul_i32 s6, s5, 15360
    s_lshl_b32 s7, s4, 8
    s_add_u32 s45, s6, s7
    s_lshl_b32 s5, s5, 2
    s_add_u32 s5, s5, s3
    s_mul_i32 s5, s5, 80
    s_lshl_b32 s4, s4, 7
    s_mul_i32 s6, s5, 7680
    s_add_u32 s4, s4, s6
    v_min_u32 v96, 39, v1
    s_lshl_b32 s5, s5, 1
    v_lshl_add_u32 v96, v96, 2, s5
    global_load_dword v148, v96, s[30:31]
    v_lshrrev_b32 v97, 3, v1
    v_mul_u32_u24 v96, 15232, v97
    v_add3_u32 v96, v96, v4, s4
    global_load_dwordx4 v[108:111], v96, s[32:33] nt
    v_add_u32 v96, 7680, v96
    global_load_dwordx4 v[112:115], v96, s[32:33] nt
    v_add_u32 v96, 115200, v96
    global_load_dwordx4 v[116:119], v96, s[32:33] nt
    v_add_u32 v96, 7680, v96
    global_load_dwordx4 v[120:123], v96, s[32:33] nt
    v_add_u32 v96, 115200, v96
    global_load_dwordx4 v[124:127], v96, s[32:33] nt
    v_add_u32 v96, 7680, v96
    global_load_dwordx4 v[128:131], v96, s[32:33] nt
    v_add_u32 v96, 115200, v96
    global_load_dwordx4 v[132:135], v96, s[32:33] nt
    v_add_u32 v96, 7680, v96
    global_load_dwordx4 v[136:139], v96, s[32:33] nt
    v_add_u32 v96, 115200, v96
    global_load_dwordx4 v[140:143], v96, s[32:33] nt
    v_add_u32 v96, 7680, v96
    v_lshlrev_b32 v82, 16, v80
    v_and_b32 v83, 0xffff0000, v80
    v_lshlrev_b32 v29, 2, v29
    v_mul_f32 v84, 0xbfb8aa3b, v82
    v_mul_f32 v85, 0xbfb8aa3b, v83
    v_exp_f32 v84, v84
    v_exp_f32 v85, v85
    v_add_f32 v84, 1.0, v84
    v_add_f32 v85, 1.0, v85
    v_rcp_f32 v84, v84
    v_rcp_f32 v85, v85
    v_mul_f32 v82, v82, v84
    v_mul_f32 v83, v83, v85
    v_cvt_pk_bf16_f32 v80, v82, v83
    ds_bpermute_b32 v88, v29, v80 offset:0
    ds_bpermute_b32 v89, v29, v80 offset:32
    ds_bpermute_b32 v90, v29, v80 offset:64
    ds_bpermute_b32 v91, v29, v80 offset:96
    ds_bpermute_b32 v92, v29, v80 offset:128
    s_waitcnt lgkmcnt(4)
    v_lshlrev_b32 v30, 16, v88
    v_and_b32 v31, 0xffff0000, v88
    s_waitcnt lgkmcnt(3)
    v_lshlrev_b32 v32, 16, v89
    v_and_b32 v33, 0xffff0000, v89
    s_waitcnt lgkmcnt(2)
    v_lshlrev_b32 v34, 16, v90
    v_and_b32 v35, 0xffff0000, v90
    s_waitcnt lgkmcnt(1)
    v_lshlrev_b32 v36, 16, v91
    v_and_b32 v37, 0xffff0000, v91
    s_waitcnt lgkmcnt(0)
    v_lshlrev_b32 v38, 16, v92
    v_and_b32 v39, 0xffff0000, v92
    s_waitcnt vmcnt(20)
    v_lshlrev_b32 v80, 16, v40
    v_and_b32 v81, 0xffff0000, v40
    v_lshlrev_b32 v82, 16, v41
    v_and_b32 v83, 0xffff0000, v41
    v_lshlrev_b32 v84, 16, v42
    v_and_b32 v85, 0xffff0000, v42
    v_lshlrev_b32 v86, 16, v43
    v_and_b32 v87, 0xffff0000, v43
    v_pk_mul_f32 v[88:89], v[30:31], v[80:81] op_sel:[0,0] op_sel_hi:[0,1]
    v_pk_mul_f32 v[90:91], v[30:31], v[82:83] op_sel:[0,0] op_sel_hi:[0,1]
    v_pk_mul_f32 v[92:93], v[30:31], v[84:85] op_sel:[0,0] op_sel_hi:[0,1]
    v_pk_mul_f32 v[94:95], v[30:31], v[86:87] op_sel:[0,0] op_sel_hi:[0,1]
    s_waitcnt vmcnt(19)
    v_lshlrev_b32 v80, 16, v44
    v_and_b32 v81, 0xffff0000, v44
    v_lshlrev_b32 v82, 16, v45
    v_and_b32 v83, 0xffff0000, v45
    v_lshlrev_b32 v84, 16, v46
    v_and_b32 v85, 0xffff0000, v46
    v_lshlrev_b32 v86, 16, v47
    v_and_b32 v87, 0xffff0000, v47
    v_pk_fma_f32 v[88:89], v[30:31], v[80:81], v[88:89] op_sel:[1,0,0] op_sel_hi:[1,1,1]
    v_pk_fma_f32 v[90:91], v[30:31], v[82:83], v[90:91] op_sel:[1,0,0] op_sel_hi:[1,1,1]
    v_pk_fma_f32 v[92:93], v[30:31], v[84:85], v[92:93] op_sel:[1,0,0] op_sel_hi:[1,1,1]
    v_pk_fma_f32 v[94:95], v[30:31], v[86:87], v[94:95] op_sel:[1,0,0] op_sel_hi:[1,1,1]
    s_waitcnt vmcnt(18)
    v_lshlrev_b32 v80, 16, v48
    v_and_b32 v81, 0xffff0000, v48
    v_lshlrev_b32 v82, 16, v49
    v_and_b32 v83, 0xffff0000, v49
    v_lshlrev_b32 v84, 16, v50
    v_and_b32 v85, 0xffff0000, v50
    v_lshlrev_b32 v86, 16, v51
    v_and_b32 v87, 0xffff0000, v51
    v_pk_fma_f32 v[88:89], v[32:33], v[80:81], v[88:89] op_sel:[0,0,0] op_sel_hi:[0,1,1]
    v_pk_fma_f32 v[90:91], v[32:33], v[82:83], v[90:91] op_sel:[0,0,0] op_sel_hi:[0,1,1]
    v_pk_fma_f32 v[92:93], v[32:33], v[84:85], v[92:93] op_sel:[0,0,0] op_sel_hi:[0,1,1]
    v_pk_fma_f32 v[94:95], v[32:33], v[86:87], v[94:95] op_sel:[0,0,0] op_sel_hi:[0,1,1]
    s_waitcnt vmcnt(17)
    v_lshlrev_b32 v80, 16, v52
    v_and_b32 v81, 0xffff0000, v52
    v_lshlrev_b32 v82, 16, v53
    v_and_b32 v83, 0xffff0000, v53
    v_lshlrev_b32 v84, 16, v54
    v_and_b32 v85, 0xffff0000, v54
    v_lshlrev_b32 v86, 16, v55
    v_and_b32 v87, 0xffff0000, v55
    v_pk_fma_f32 v[88:89], v[32:33], v[80:81], v[88:89] op_sel:[1,0,0] op_sel_hi:[1,1,1]
    v_pk_fma_f32 v[90:91], v[32:33], v[82:83], v[90:91] op_sel:[1,0,0] op_sel_hi:[1,1,1]
    v_pk_fma_f32 v[92:93], v[32:33], v[84:85], v[92:93] op_sel:[1,0,0] op_sel_hi:[1,1,1]
    v_pk_fma_f32 v[94:95], v[32:33], v[86:87], v[94:95] op_sel:[1,0,0] op_sel_hi:[1,1,1]
    s_waitcnt vmcnt(16)
    v_lshlrev_b32 v80, 16, v56
    v_and_b32 v81, 0xffff0000, v56
    v_lshlrev_b32 v82, 16, v57
    v_and_b32 v83, 0xffff0000, v57
    v_lshlrev_b32 v84, 16, v58
    v_and_b32 v85, 0xffff0000, v58
    v_lshlrev_b32 v86, 16, v59
    v_and_b32 v87, 0xffff0000, v59
    v_pk_fma_f32 v[88:89], v[34:35], v[80:81], v[88:89] op_sel:[0,0,0] op_sel_hi:[0,1,1]
    v_pk_fma_f32 v[90:91], v[34:35], v[82:83], v[90:91] op_sel:[0,0,0] op_sel_hi:[0,1,1]
    v_pk_fma_f32 v[92:93], v[34:35], v[84:85], v[92:93] op_sel:[0,0,0] op_sel_hi:[0,1,1]
    v_pk_fma_f32 v[94:95], v[34:35], v[86:87], v[94:95] op_sel:[0,0,0] op_sel_hi:[0,1,1]
    s_waitcnt vmcnt(15)
    v_lshlrev_b32 v80, 16, v60
    v_and_b32 v81, 0xffff0000, v60
    v_lshlrev_b32 v82, 16, v61
    v_and_b32 v83, 0xffff0000, v61
    v_lshlrev_b32 v84, 16, v62
    v_and_b32 v85, 0xffff0000, v62
    v_lshlrev_b32 v86, 16, v63
    v_and_b32 v87, 0xffff0000, v63
    v_pk_fma_f32 v[88:89], v[34:35], v[80:81], v[88:89] op_sel:[1,0,0] op_sel_hi:[1,1,1]
    v_pk_fma_f32 v[90:91], v[34:35], v[82:83], v[90:91] op_sel:[1,0,0] op_sel_hi:[1,1,1]
    v_pk_fma_f32 v[92:93], v[34:35], v[84:85], v[92:93] op_sel:[1,0,0] op_sel_hi:[1,1,1]
    v_pk_fma_f32 v[94:95], v[34:35], v[86:87], v[94:95] op_sel:[1,0,0] op_sel_hi:[1,1,1]
    s_waitcnt vmcnt(14)
    v_lshlrev_b32 v80, 16, v64
    v_and_b32 v81, 0xffff0000, v64
    v_lshlrev_b32 v82, 16, v65
    v_and_b32 v83, 0xffff0000, v65
    v_lshlrev_b32 v84, 16, v66
    v_and_b32 v85, 0xffff0000, v66
    v_lshlrev_b32 v86, 16, v67
    v_and_b32 v87, 0xffff0000, v67
    v_pk_fma_f32 v[88:89], v[36:37], v[80:81], v[88:89] op_sel:[0,0,0] op_sel_hi:[0,1,1]
    v_pk_fma_f32 v[90:91], v[36:37], v[82:83], v[90:91] op_sel:[0,0,0] op_sel_hi:[0,1,1]
    v_pk_fma_f32 v[92:93], v[36:37], v[84:85], v[92:93] op_sel:[0,0,0] op_sel_hi:[0,1,1]
    v_pk_fma_f32 v[94:95], v[36:37], v[86:87], v[94:95] op_sel:[0,0,0] op_sel_hi:[0,1,1]
    s_waitcnt vmcnt(13)
    v_lshlrev_b32 v80, 16, v68
    v_and_b32 v81, 0xffff0000, v68
    v_lshlrev_b32 v82, 16, v69
    v_and_b32 v83, 0xffff0000, v69
    v_lshlrev_b32 v84, 16, v70
    v_and_b32 v85, 0xffff0000, v70
    v_lshlrev_b32 v86, 16, v71
    v_and_b32 v87, 0xffff0000, v71
    v_pk_fma_f32 v[88:89], v[36:37], v[80:81], v[88:89] op_sel:[1,0,0] op_sel_hi:[1,1,1]
    v_pk_fma_f32 v[90:91], v[36:37], v[82:83], v[90:91] op_sel:[1,0,0] op_sel_hi:[1,1,1]
    v_pk_fma_f32 v[92:93], v[36:37], v[84:85], v[92:93] op_sel:[1,0,0] op_sel_hi:[1,1,1]
    v_pk_fma_f32 v[94:95], v[36:37], v[86:87], v[94:95] op_sel:[1,0,0] op_sel_hi:[1,1,1]
    s_waitcnt vmcnt(12)
    v_lshlrev_b32 v80, 16, v72
    v_and_b32 v81, 0xffff0000, v72
    v_lshlrev_b32 v82, 16, v73
    v_and_b32 v83, 0xffff0000, v73
    v_lshlrev_b32 v84, 16, v74
    v_and_b32 v85, 0xffff0000, v74
    v_lshlrev_b32 v86, 16, v75
    v_and_b32 v87, 0xffff0000, v75
    v_pk_fma_f32 v[88:89], v[38:39], v[80:81], v[88:89] op_sel:[0,0,0] op_sel_hi:[0,1,1]
    v_pk_fma_f32 v[90:91], v[38:39], v[82:83], v[90:91] op_sel:[0,0,0] op_sel_hi:[0,1,1]
    v_pk_fma_f32 v[92:93], v[38:39], v[84:85], v[92:93] op_sel:[0,0,0] op_sel_hi:[0,1,1]
    v_pk_fma_f32 v[94:95], v[38:39], v[86:87], v[94:95] op_sel:[0,0,0] op_sel_hi:[0,1,1]
    s_waitcnt vmcnt(11)
    v_lshlrev_b32 v80, 16, v76
    v_and_b32 v81, 0xffff0000, v76
    v_lshlrev_b32 v82, 16, v77
    v_and_b32 v83, 0xffff0000, v77
    v_lshlrev_b32 v84, 16, v78
    v_and_b32 v85, 0xffff0000, v78
    v_lshlrev_b32 v86, 16, v79
    v_and_b32 v87, 0xffff0000, v79
    v_pk_fma_f32 v[88:89], v[38:39], v[80:81], v[88:89] op_sel:[1,0,0] op_sel_hi:[1,1,1]
    v_pk_fma_f32 v[90:91], v[38:39], v[82:83], v[90:91] op_sel:[1,0,0] op_sel_hi:[1,1,1]
    v_pk_fma_f32 v[92:93], v[38:39], v[84:85], v[92:93] op_sel:[1,0,0] op_sel_hi:[1,1,1]
    v_pk_fma_f32 v[94:95], v[38:39], v[86:87], v[94:95] op_sel:[1,0,0] op_sel_hi:[1,1,1]
    s_nop 0
    v_permlane32_swap_b32 v88, v92
    v_permlane32_swap_b32 v89, v93
    v_permlane32_swap_b32 v90, v94
    v_permlane32_swap_b32 v91, v95
    v_add_f32 v88, v88, v92
    v_add_f32 v89, v89, v93
    v_add_f32 v90, v90, v94
    v_add_f32 v91, v91, v95
    s_nop 0
    v_permlane16_swap_b32 v88, v90
    v_permlane16_swap_b32 v89, v91
    v_add_f32 v88, v88, v90
    v_add_f32 v89, v89, v91
    v_and_b32 v81, 7, v1
    v_lshrrev_b32 v82, 3, v1
    v_add_f32_dpp v80, v88, v88 row_ror:8 row_mask:0xf bank_mask:0x3
    s_nop 1
    v_add_f32_dpp v80, v89, v89 row_ror:8 row_mask:0xf bank_mask:0xc
    v_lshl_add_u32 v81, v81, 3, v82
    s_lshl_b32 s7, s3, 8
    s_add_u32 s7, s7, 122880
    v_lshl_add_u32 v81, v81, 2, s7
    ds_write_b32 v81, v80
    s_waitcnt lgkmcnt(0)
    s_barrier
    v_lshlrev_b32 v81, 2, v1
    v_add_u32 v82, 122880, v81
    ds_read_b32 v88, v82 offset:0
    ds_read_b32 v89, v82 offset:256
    ds_read_b32 v90, v82 offset:512
    ds_read_b32 v91, v82 offset:768
    v_add_u32 v81, s44, v81
    s_waitcnt lgkmcnt(2)
    v_add_f32 v88, v88, v89
    s_waitcnt lgkmcnt(0)
    v_add_f32 v90, v90, v91
    v_add_f32 v88, v88, v90
    v_min_u32 v88, -2, v88
    s_cmp_lg_u32 s3, 0
    s_cbranch_scc1 Lmod_skip_s1
    global_store_dword v81, v88, s[38:39] offset:0 sc1
Lmod_skip_s1:
    global_load_dwordx4 v[144:147], v96, s[32:33] nt
    s_cmp_ge_u32 s48, 27
    s_cbranch_scc1 Lsb_n3
    s_mul_i32 s4, s48, 40960
    s_mul_i32 s5, s3, 10240
    s_add_u32 s4, s4, s5
    v_lshl_add_u32 v164, v1, 4, s4
    s_add_u32 m0, s5, 0
    s_nop 0
    global_load_lds_dwordx4 v164, s[28:29] offset:0 nt
    global_load_lds_dwordx4 v164, s[28:29] offset:1024 nt
    global_load_lds_dwordx4 v164, s[28:29] offset:2048 nt
    global_load_lds_dwordx4 v164, s[28:29] offset:3072 nt
    s_add_u32 m0, s5, 4096
    v_add_u32 v164, 4096, v164
    global_load_lds_dwordx4 v164, s[28:29] offset:0 nt
    global_load_lds_dwordx4 v164, s[28:29] offset:1024 nt
    global_load_lds_dwordx4 v164, s[28:29] offset:2048 nt
    global_load_lds_dwordx4 v164, s[28:29] offset:3072 nt
    s_add_u32 m0, s5, 8192
    v_add_u32 v164, 4096, v164
    global_load_lds_dwordx4 v164, s[28:29] offset:0 nt
    global_load_lds_dwordx4 v164, s[28:29] offset:1024 nt
    s_waitcnt vmcnt(10)
    s_branch Lsb_n4
Lsb_n3:
    s_add_u32 s50, s48, 78
    s_lshr_b32 s4, s50, 1
    s_and_b32 s5, s50, 1
    s_cmp_lt_u32 s4, 50
    s_cselect_b32 s6, -20, 0
    s_cmp_lt_u32 s4, 20
    s_cselect_b32 s6, 30, s6
    s_add_u32 s4, s4, s6
    s_mul_i32 s6, s5, 15360
    s_lshl_b32 s7, s4, 8
    s_add_u32 s44, s6, s7
    s_lshl_b32 s5, s5, 2
    s_add_u32 s5, s5, s3
    s_mul_i32 s5, s5, 80
    s_lshl_b32 s4, s4, 7
    s_mul_i32 s6, s5, 7680
    s_add_u32 s4, s4, s6
    v_min_u32 v28, 39, v1
    s_lshl_b32 s5, s5, 1
    v_lshl_add_u32 v28, v28, 2, s5
    global_load_dword v80, v28, s[30:31]
    v_lshrrev_b32 v29, 3, v1
    v_mul_u32_u24 v28, 15232, v29
    v_add3_u32 v28, v28, v4, s4
    global_load_dwordx4 v[40:43], v28, s[32:33] nt
    v_add_u32 v28, 7680, v28
    global_load_dwordx4 v[44:47], v28, s[32:33] nt
    v_add_u32 v28, 115200, v28
    global_load_dwordx4 v[48:51], v28, s[32:33] nt
    v_add_u32 v28, 7680, v28
    global_load_dwordx4 v[52:55], v28, s[32:33] nt
    v_add_u32 v28, 115200, v28
    global_load_dwordx4 v[56:59], v28, s[32:33] nt
    v_add_u32 v28, 7680, v28
    global_load_dwordx4 v[60:63], v28, s[32:33] nt
    v_add_u32 v28, 115200, v28
    global_load_dwordx4 v[64:67], v28, s[32:33] nt
    v_add_u32 v28, 7680, v28
    global_load_dwordx4 v[68:71], v28, s[32:33] nt
    v_add_u32 v28, 115200, v28
    global_load_dwordx4 v[72:75], v28, s[32:33] nt
    v_add_u32 v28, 7680, v28
    global_load_dwordx4 v[76:79], v28, s[32:33] nt
    s_waitcnt vmcnt(11)
Lsb_n4:
    v_lshlrev_b32 v150, 16, v148
    v_and_b32 v151, 0xffff0000, v148
    v_lshlrev_b32 v97, 2, v97
    v_mul_f32 v152, 0xbfb8aa3b, v150
    v_mul_f32 v153, 0xbfb8aa3b, v151
    v_exp_f32 v152, v152
    v_exp_f32 v153, v153
    v_add_f32 v152, 1.0, v152
    v_add_f32 v153, 1.0, v153
    v_rcp_f32 v152, v152
    v_rcp_f32 v153, v153
    v_mul_f32 v150, v150, v152
    v_mul_f32 v151, v151, v153
    v_cvt_pk_bf16_f32 v148, v150, v151
    ds_bpermute_b32 v156, v97, v148 offset:0
    ds_bpermute_b32 v157, v97, v148 offset:32
    ds_bpermute_b32 v158, v97, v148 offset:64
    ds_bpermute_b32 v159, v97, v148 offset:96
    ds_bpermute_b32 v160, v97, v148 offset:128
    s_waitcnt lgkmcnt(4)
    v_lshlrev_b32 v98, 16, v156
    v_and_b32 v99, 0xffff0000, v156
    s_waitcnt lgkmcnt(3)
    v_lshlrev_b32 v100, 16, v157
    v_and_b32 v101, 0xffff0000, v157
    s_waitcnt lgkmcnt(2)
    v_lshlrev_b32 v102, 16, v158
    v_and_b32 v103, 0xffff0000, v158
    s_waitcnt lgkmcnt(1)
    v_lshlrev_b32 v104, 16, v159
    v_and_b32 v105, 0xffff0000, v159
    s_waitcnt lgkmcnt(0)
    v_lshlrev_b32 v106, 16, v160
    v_and_b32 v107, 0xffff0000, v160
    v_lshlrev_b32 v148, 16, v108
    v_and_b32 v149, 0xffff0000, v108
    v_lshlrev_b32 v150, 16, v109
    v_and_b32 v151, 0xffff0000, v109
    v_lshlrev_b32 v152, 16, v110
    v_and_b32 v153, 0xffff0000, v110
    v_lshlrev_b32 v154, 16, v111
    v_and_b32 v155, 0xffff0000, v111
    v_pk_mul_f32 v[156:157], v[98:99], v[148:149] op_sel:[0,0] op_sel_hi:[0,1]
    v_pk_mul_f32 v[158:159], v[98:99], v[150:151] op_sel:[0,0] op_sel_hi:[0,1]
    v_pk_mul_f32 v[160:161], v[98:99], v[152:153] op_sel:[0,0] op_sel_hi:[0,1]
    v_pk_mul_f32 v[162:163], v[98:99], v[154:155] op_sel:[0,0] op_sel_hi:[0,1]
    v_lshlrev_b32 v148, 16, v112
    v_and_b32 v149, 0xffff0000, v112
    v_lshlrev_b32 v150, 16, v113
    v_and_b32 v151, 0xffff0000, v113
    v_lshlrev_b32 v152, 16, v114
    v_and_b32 v153, 0xffff0000, v114
    v_lshlrev_b32 v154, 16, v115
    v_and_b32 v155, 0xffff0000, v115
    v_pk_fma_f32 v[156:157], v[98:99], v[148:149], v[156:157] op_sel:[1,0,0] op_sel_hi:[1,1,1]
    v_pk_fma_f32 v[158:159], v[98:99], v[150:151], v[158:159] op_sel:[1,0,0] op_sel_hi:[1,1,1]
    v_pk_fma_f32 v[160:161], v[98:99], v[152:153], v[160:161] op_sel:[1,0,0] op_sel_hi:[1,1,1]
    v_pk_fma_f32 v[162:163], v[98:99], v[154:155], v[162:163] op_sel:[1,0,0] op_sel_hi:[1,1,1]
    v_lshlrev_b32 v148, 16, v116
    v_and_b32 v149, 0xffff0000, v116
    v_lshlrev_b32 v150, 16, v117
    v_and_b32 v151, 0xffff0000, v117
    v_lshlrev_b32 v152, 16, v118
    v_and_b32 v153, 0xffff0000, v118
    v_lshlrev_b32 v154, 16, v119
    v_and_b32 v155, 0xffff0000, v119
    v_pk_fma_f32 v[156:157], v[100:101], v[148:149], v[156:157] op_sel:[0,0,0] op_sel_hi:[0,1,1]
    v_pk_fma_f32 v[158:159], v[100:101], v[150:151], v[158:159] op_sel:[0,0,0] op_sel_hi:[0,1,1]
    v_pk_fma_f32 v[160:161], v[100:101], v[152:153], v[160:161] op_sel:[0,0,0] op_sel_hi:[0,1,1]
    v_pk_fma_f32 v[162:163], v[100:101], v[154:155], v[162:163] op_sel:[0,0,0] op_sel_hi:[0,1,1]
    v_lshlrev_b32 v148, 16, v120
    v_and_b32 v149, 0xffff0000, v120
    v_lshlrev_b32 v150, 16, v121
    v_and_b32 v151, 0xffff0000, v121
    v_lshlrev_b32 v152, 16, v122
    v_and_b32 v153, 0xffff0000, v122
    v_lshlrev_b32 v154, 16, v123
    v_and_b32 v155, 0xffff0000, v123
    v_pk_fma_f32 v[156:157], v[100:101], v[148:149], v[156:157] op_sel:[1,0,0] op_sel_hi:[1,1,1]
    v_pk_fma_f32 v[158:159], v[100:101], v[150:151], v[158:159] op_sel:[1,0,0] op_sel_hi:[1,1,1]
    v_pk_fma_f32 v[160:161], v[100:101], v[152:153], v[160:161] op_sel:[1,0,0] op_sel_hi:[1,1,1]
    v_pk_fma_f32 v[162:163], v[100:101], v[154:155], v[162:163] op_sel:[1,0,0] op_sel_hi:[1,1,1]
    v_lshlrev_b32 v148, 16, v124
    v_and_b32 v149, 0xffff0000, v124
    v_lshlrev_b32 v150, 16, v125
    v_and_b32 v151, 0xffff0000, v125
    v_lshlrev_b32 v152, 16, v126
    v_and_b32 v153, 0xffff0000, v126
    v_lshlrev_b32 v154, 16, v127
    v_and_b32 v155, 0xffff0000, v127
    v_pk_fma_f32 v[156:157], v[102:103], v[148:149], v[156:157] op_sel:[0,0,0] op_sel_hi:[0,1,1]
    v_pk_fma_f32 v[158:159], v[102:103], v[150:151], v[158:159] op_sel:[0,0,0] op_sel_hi:[0,1,1]
    v_pk_fma_f32 v[160:161], v[102:103], v[152:153], v[160:161] op_sel:[0,0,0] op_sel_hi:[0,1,1]
    v_pk_fma_f32 v[162:163], v[102:103], v[154:155], v[162:163] op_sel:[0,0,0] op_sel_hi:[0,1,1]
    v_lshlrev_b32 v148, 16, v128
    v_and_b32 v149, 0xffff0000, v128
    v_lshlrev_b32 v150, 16, v129
    v_and_b32 v151, 0xffff0000, v129
    v_lshlrev_b32 v152, 16, v130
    v_and_b32 v153, 0xffff0000, v130
    v_lshlrev_b32 v154, 16, v131
    v_and_b32 v155, 0xffff0000, v131
    v_pk_fma_f32 v[156:157], v[102:103], v[148:149], v[156:157] op_sel:[1,0,0] op_sel_hi:[1,1,1]
    v_pk_fma_f32 v[158:159], v[102:103], v[150:151], v[158:159] op_sel:[1,0,0] op_sel_hi:[1,1,1]
    v_pk_fma_f32 v[160:161], v[102:103], v[152:153], v[160:161] op_sel:[1,0,0] op_sel_hi:[1,1,1]
    v_pk_fma_f32 v[162:163], v[102:103], v[154:155], v[162:163] op_sel:[1,0,0] op_sel_hi:[1,1,1]
    v_lshlrev_b32 v148, 16, v132
    v_and_b32 v149, 0xffff0000, v132
    v_lshlrev_b32 v150, 16, v133
    v_and_b32 v151, 0xffff0000, v133
    v_lshlrev_b32 v152, 16, v134
    v_and_b32 v153, 0xffff0000, v134
    v_lshlrev_b32 v154, 16, v135
    v_and_b32 v155, 0xffff0000, v135
    v_pk_fma_f32 v[156:157], v[104:105], v[148:149], v[156:157] op_sel:[0,0,0] op_sel_hi:[0,1,1]
    v_pk_fma_f32 v[158:159], v[104:105], v[150:151], v[158:159] op_sel:[0,0,0] op_sel_hi:[0,1,1]
    v_pk_fma_f32 v[160:161], v[104:105], v[152:153], v[160:161] op_sel:[0,0,0] op_sel_hi:[0,1,1]
    v_pk_fma_f32 v[162:163], v[104:105], v[154:155], v[162:163] op_sel:[0,0,0] op_sel_hi:[0,1,1]
    v_lshlrev_b32 v148, 16, v136
    v_and_b32 v149, 0xffff0000, v136
    v_lshlrev_b32 v150, 16, v137
    v_and_b32 v151, 0xffff0000, v137
    v_lshlrev_b32 v152, 16, v138
    v_and_b32 v153, 0xffff0000, v138
    v_lshlrev_b32 v154, 16, v139
    v_and_b32 v155, 0xffff0000, v139
    v_pk_fma_f32 v[156:157], v[104:105], v[148:149], v[156:157] op_sel:[1,0,0] op_sel_hi:[1,1,1]
    v_pk_fma_f32 v[158:159], v[104:105], v[150:151], v[158:159] op_sel:[1,0,0] op_sel_hi:[1,1,1]
    v_pk_fma_f32 v[160:161], v[104:105], v[152:153], v[160:161] op_sel:[1,0,0] op_sel_hi:[1,1,1]
    v_pk_fma_f32 v[162:163], v[104:105], v[154:155], v[162:163] op_sel:[1,0,0] op_sel_hi:[1,1,1]
    v_lshlrev_b32 v148, 16, v140
    v_and_b32 v149, 0xffff0000, v140
    v_lshlrev_b32 v150, 16, v141
    v_and_b32 v151, 0xffff0000, v141
    v_lshlrev_b32 v152, 16, v142
    v_and_b32 v153, 0xffff0000, v142
    v_lshlrev_b32 v154, 16, v143
    v_and_b32 v155, 0xffff0000, v143
    v_pk_fma_f32 v[156:157], v[106:107], v[148:149], v[156:157] op_sel:[0,0,0] op_sel_hi:[0,1,1]
    v_pk_fma_f32 v[158:159], v[106:107], v[150:151], v[158:159] op_sel:[0,0,0] op_sel_hi:[0,1,1]
    v_pk_fma_f32 v[160:161], v[106:107], v[152:153], v[160:161] op_sel:[0,0,0] op_sel_hi:[0,1,1]
    v_pk_fma_f32 v[162:163], v[106:107], v[154:155], v[162:163] op_sel:[0,0,0] op_sel_hi:[0,1,1]
    v_lshlrev_b32 v148, 16, v144
    v_and_b32 v149, 0xffff0000, v144
    v_lshlrev_b32 v150, 16, v145
    v_and_b32 v151, 0xffff0000, v145
    v_lshlrev_b32 v152, 16, v146
    v_and_b32 v153, 0xffff0000, v146
    v_lshlrev_b32 v154, 16, v147
    v_and_b32 v155, 0xffff0000, v147
    v_pk_fma_f32 v[156:157], v[106:107], v[148:149], v[156:157] op_sel:[1,0,0] op_sel_hi:[1,1,1]
    v_pk_fma_f32 v[158:159], v[106:107], v[150:151], v[158:159] op_sel:[1,0,0] op_sel_hi:[1,1,1]
    v_pk_fma_f32 v[160:161], v[106:107], v[152:153], v[160:161] op_sel:[1,0,0] op_sel_hi:[1,1,1]
    v_pk_fma_f32 v[162:163], v[106:107], v[154:155], v[162:163] op_sel:[1,0,0] op_sel_hi:[1,1,1]
    s_nop 0
    v_permlane32_swap_b32 v156, v160
    v_permlane32_swap_b32 v157, v161
    v_permlane32_swap_b32 v158, v162
    v_permlane32_swap_b32 v159, v163
    v_add_f32 v156, v156, v160
    v_add_f32 v157, v157, v161
    v_add_f32 v158, v158, v162
    v_add_f32 v159, v159, v163
    s_nop 0
    v_permlane16_swap_b32 v156, v158
    v_permlane16_swap_b32 v157, v159
    v_add_f32 v156, v156, v158
    v_add_f32 v157, v157, v159
    v_and_b32 v149, 7, v1
    v_lshrrev_b32 v150, 3, v1
    v_add_f32_dpp v148, v156, v156 row_ror:8 row_mask:0xf bank_mask:0x3
    s_nop 1
    v_add_f32_dpp v148, v157, v157 row_ror:8 row_mask:0xf bank_mask:0xc
    v_lshl_add_u32 v149, v149, 3, v150
    s_lshl_b32 s7, s3, 8
    s_add_u32 s7, s7, 123904
    v_lshl_add_u32 v149, v149, 2, s7
    ds_write_b32 v149, v148
    s_waitcnt lgkmcnt(0)
    s_barrier
    v_lshlrev_b32 v149, 2, v1
    v_add_u32 v150, 123904, v149
    ds_read_b32 v156, v150 offset:0
    ds_read_b32 v157, v150 offset:256
    ds_read_b32 v158, v150 offset:512
    ds_read_b32 v159, v150 offset:768
    v_add_u32 v149, s45, v149
    s_waitcnt lgkmcnt(2)
    v_add_f32 v156, v156, v157
    s_waitcnt lgkmcnt(0)
    v_add_f32 v158, v158, v159
    v_add_f32 v156, v156, v158
    v_min_u32 v156, -2, v156
    s_cmp_lg_u32 s3, 0
    s_cbranch_scc1 Lmod_skip_s2
    global_store_dword v149, v156, s[38:39] offset:0 sc1
Lmod_skip_s2:
    s_cmp_lg_u32 s3, 0
    s_cbranch_scc1 Lbic_x
    v_min_u32 v164, 49, v1
    v_cmp_lt_u32 vcc, 7, v164
    s_nop 1
    v_cndmask_b32_e64 v165, 0, 7, vcc
    v_add_lshl_u32 v164, v164, v165, 2
    s_branch Lbic_f
Lbic:
    s_sleep 4
Lbic_f:
    global_load_dword v165, v164, s[36:37] sc1
    s_waitcnt vmcnt(0)
    v_cmp_eq_u32 vcc, 0, v165
    s_add_u32 s100, s100, 1
    s_cmp_ge_u32 s100, 262144
    s_cbranch_scc1 Lbic_x
    s_cbranch_vccnz Lbic
Lbic_x:
    s_waitcnt vmcnt(0)
    s_cmp_ge_u32 s48, 27
    s_cbranch_scc1 Lsp_b3
    s_barrier
    v_and_b32 v33, 15, v1
    v_lshrrev_b32 v34, 4, v1
    v_mul_u32_u24 v34, 10240, v34
    s_mul_i32 s5, s3, 320
    s_add_u32 s5, s5, 0
    v_add_u32 v34, s5, v34
    v_lshl_add_u32 v31, v33, 2, v34
    v_lshl_add_u32 v32, v33, 1, v34
    s_mul_i32 s5, s3, 276480
    s_mul_i32 s6, s48, 5120
    s_add_u32 s5, s5, s6
    s_add_u32 s5, s5, 10487808
    v_lshl_add_u32 v30, v1, 4, s5
    s_mov_b32 s6, 0x5040100
    s_mov_b32 s7, 0x7060302
    ds_read_b32 v36, v31 offset:0
    ds_read_b32 v37, v31 offset:2560
    ds_read_b32 v38, v31 offset:5120
    ds_read_b32 v39, v31 offset:7680
    ds_read_b32 v40, v31 offset:1280
    ds_read_b32 v41, v31 offset:3840
    ds_read_b32 v42, v31 offset:6400
    ds_read_b32 v43, v31 offset:8960
    ds_read_b32 v44, v31 offset:64
    ds_read_b32 v45, v31 offset:2624
    ds_read_b32 v46, v31 offset:5184
    ds_read_b32 v47, v31 offset:7744
    ds_read_b32 v48, v31 offset:1344
    ds_read_b32 v49, v31 offset:3904
    ds_read_b32 v50, v31 offset:6464
    ds_read_b32 v51, v31 offset:9024
    ds_read_u16 v52, v32 offset:128
    ds_read_u16 v53, v32 offset:2688
    ds_read_u16 v54, v32 offset:5248
    ds_read_u16 v55, v32 offset:7808
    ds_read_u16 v56, v32 offset:1408
    ds_read_u16 v57, v32 offset:3968
    ds_read_u16 v58, v32 offset:6528
    ds_read_u16 v59, v32 offset:9088
    s_waitcnt lgkmcnt(15)
    v_perm_b32 v60, v37, v36, s6
    v_perm_b32 v61, v39, v38, s6
    v_perm_b32 v62, v41, v40, s6
    v_perm_b32 v63, v43, v42, s6
    v_perm_b32 v64, v37, v36, s7
    v_perm_b32 v65, v39, v38, s7
    v_perm_b32 v66, v41, v40, s7
    v_perm_b32 v67, v43, v42, s7
    s_waitcnt lgkmcnt(14)
    v_perm_b32 v68, v45, v44, s6
    s_waitcnt lgkmcnt(12)
    v_perm_b32 v69, v47, v46, s6
    s_waitcnt lgkmcnt(10)
    v_perm_b32 v70, v49, v48, s6
    s_waitcnt lgkmcnt(8)
    v_perm_b32 v71, v51, v50, s6
    v_perm_b32 v72, v45, v44, s7
    v_perm_b32 v73, v47, v46, s7
    v_perm_b32 v74, v49, v48, s7
    v_perm_b32 v75, v51, v50, s7
    s_waitcnt lgkmcnt(6)
    v_perm_b32 v76, v53, v52, s6
    s_waitcnt lgkmcnt(4)
    v_perm_b32 v77, v55, v54, s6
    s_waitcnt lgkmcnt(2)
    v_perm_b32 v78, v57, v56, s6
    s_waitcnt lgkmcnt(0)
    v_perm_b32 v79, v59, v58, s6
    global_store_dwordx4 v30, v[60:63], s[38:39] offset:-2048 sc1
    global_store_dwordx4 v30, v[64:67], s[38:39] offset:-1024 sc1
    global_store_dwordx4 v30, v[68:71], s[38:39] offset:0 sc1
    global_store_dwordx4 v30, v[72:75], s[38:39] offset:1024 sc1
    global_store_dwordx4 v30, v[76:79], s[38:39] offset:2048 sc1
    v_add_u32 v30, 138240, v30
    ds_read_b32 v80, v31 offset:160
    ds_read_b32 v81, v31 offset:2720
    ds_read_b32 v82, v31 offset:5280
    ds_read_b32 v83, v31 offset:7840
    ds_read_b32 v84, v31 offset:1440
    ds_read_b32 v85, v31 offset:4000
    ds_read_b32 v86, v31 offset:6560
    ds_read_b32 v87, v31 offset:9120
    ds_read_b32 v88, v31 offset:224
    ds_read_b32 v89, v31 offset:2784
    ds_read_b32 v90, v31 offset:5344
    ds_read_b32 v91, v31 offset:7904
    ds_read_b32 v92, v31 offset:1504
    ds_read_b32 v93, v31 offset:4064
    ds_read_b32 v94, v31 offset:6624
    ds_read_b32 v95, v31 offset:9184
    ds_read_u16 v96, v32 offset:288
    ds_read_u16 v97, v32 offset:2848
    ds_read_u16 v98, v32 offset:5408
    ds_read_u16 v99, v32 offset:7968
    ds_read_u16 v100, v32 offset:1568
    ds_read_u16 v101, v32 offset:4128
    ds_read_u16 v102, v32 offset:6688
    ds_read_u16 v103, v32 offset:9248
    s_waitcnt lgkmcnt(15)
    v_perm_b32 v104, v81, v80, s6
    v_perm_b32 v105, v83, v82, s6
    v_perm_b32 v106, v85, v84, s6
    v_perm_b32 v107, v87, v86, s6
    v_perm_b32 v108, v81, v80, s7
    v_perm_b32 v109, v83, v82, s7
    v_perm_b32 v110, v85, v84, s7
    v_perm_b32 v111, v87, v86, s7
    s_waitcnt lgkmcnt(14)
    v_perm_b32 v112, v89, v88, s6
    s_waitcnt lgkmcnt(12)
    v_perm_b32 v113, v91, v90, s6
    s_waitcnt lgkmcnt(10)
    v_perm_b32 v114, v93, v92, s6
    s_waitcnt lgkmcnt(8)
    v_perm_b32 v115, v95, v94, s6
    v_perm_b32 v116, v89, v88, s7
    v_perm_b32 v117, v91, v90, s7
    v_perm_b32 v118, v93, v92, s7
    v_perm_b32 v119, v95, v94, s7
    s_waitcnt lgkmcnt(6)
    v_perm_b32 v120, v97, v96, s6
    s_waitcnt lgkmcnt(4)
    v_perm_b32 v121, v99, v98, s6
    s_waitcnt lgkmcnt(2)
    v_perm_b32 v122, v101, v100, s6
    s_waitcnt lgkmcnt(0)
    v_perm_b32 v123, v103, v102, s6
    global_store_dwordx4 v30, v[104:107], s[38:39] offset:-2048 sc1
    global_store_dwordx4 v30, v[108:111], s[38:39] offset:-1024 sc1
    global_store_dwordx4 v30, v[112:115], s[38:39] offset:0 sc1
    global_store_dwordx4 v30, v[116:119], s[38:39] offset:1024 sc1
    global_store_dwordx4 v30, v[120:123], s[38:39] offset:2048 sc1
    s_lshl_b32 s4, s48, 7
    s_add_u32 s51, s4, 98304
    s_branch Lsp_d
Lsp_a2:
    s_and_b32 s4, s42, 1
    s_lshl_b32 s4, s4, 1
    s_and_b32 s5, s3, 1
    s_add_u32 s44, s4, s5
    s_and_b32 s4, s42, -2
    s_lshr_b32 s5, s3, 1
    s_add_u32 s45, s4, s5
    s_and_b32 s4, s42, 1
    s_lshl_b32 s4, s4, 2
    s_add_u32 s4, s4, s3
    s_mul_i32 s4, s4, 276480
    s_lshr_b32 s5, s42, 1
    s_lshl_b32 s5, s5, 7
    s_add_u32 s4, s4, s5
    v_lshrrev_b32 v28, 3, v1
    v_mul_u32_u24 v28, 3328, v28
    v_add3_u32 v28, v28, v4, s4
    s_mul_i32 s5, s3, 10240
    s_add_u32 m0, s5, 0
    s_nop 0
    global_load_lds_dwordx4 v28, s[22:23] nt
    v_add_u32 v28, 27648, v28
    s_add_u32 m0, s5, 1024
    s_nop 0
    global_load_lds_dwordx4 v28, s[22:23] nt
    v_add_u32 v28, 27648, v28
    s_add_u32 m0, s5, 2048
    s_nop 0
    global_load_lds_dwordx4 v28, s[22:23] nt
    v_add_u32 v28, 27648, v28
    s_add_u32 m0, s5, 3072
    s_nop 0
    global_load_lds_dwordx4 v28, s[22:23] nt
    v_add_u32 v28, 27648, v28
    s_add_u32 m0, s5, 4096
    s_nop 0
    global_load_lds_dwordx4 v28, s[22:23] nt
    v_add_u32 v28, 27648, v28
    s_add_u32 m0, s5, 5120
    s_nop 0
    global_load_lds_dwordx4 v28, s[22:23] nt
    v_add_u32 v28, 27648, v28
    s_add_u32 m0, s5, 6144
    s_nop 0
    global_load_lds_dwordx4 v28, s[22:23] nt
    v_add_u32 v28, 27648, v28
    s_add_u32 m0, s5, 7168
    s_nop 0
    global_load_lds_dwordx4 v28, s[22:23] nt
    v_add_u32 v28, 27648, v28
    s_add_u32 m0, s5, 8192
    s_nop 0
    global_load_lds_dwordx4 v28, s[22:23] nt
    v_add_u32 v28, 27648, v28
    s_add_u32 m0, s5, 9216
    s_nop 0
    global_load_lds_dwordx4 v28, s[22:23] nt
    v_add_u32 v28, 27648, v28
    v_min_u32 v72, 624, v4
    s_mul_i32 s5, s44, 640
    s_add_u32 s5, s5, 7680
    v_add_u32 v73, s5, v72
    s_mul_i32 s5, s3, 1280
    s_add_u32 s5, s5, 124928
    v_add_u32 v72, s5, v72
    v_lshl_add_u32 v74, v3, 5, s5
    s_cmp_ge_u32 s45, 27
    s_cselect_b32 s6, -54, 56
    s_lshl_b32 s7, s45, 1
    s_add_u32 s46, s6, s7
    s_mul_i32 s4, s46, 20480
    s_mul_i32 s5, s44, 5120
    s_add_u32 s4, s4, s5
    s_add_u32 s4, s4, 7342080
    v_add_u32 v75, s4, v4
    v_add_u32 v76, 20480, v75
    s_and_b32 s4, s3, 1
    s_mul_i32 s4, s4, 20480
    s_lshr_b32 s5, s3, 1
    s_lshl_b32 s5, s5, 6
    s_add_u32 s4, s4, s5
    v_lshl_add_u32 v28, v3, 10, s4
    v_lshl_add_u32 v28, v2, 2, v28
    s_cmp_lt_u32 s42, 8
    s_cselect_b32 s48, 21, 0
    s_add_u32 s48, s48, s42
    s_add_u32 s48, s48, 76
    s_sub_u32 s4, s42, 5
    s_cmp_ge_u32 s4, 21
    s_cbranch_scc1 Lwp_n1
    s_lshr_b32 s4, s48, 1
    s_and_b32 s5, s48, 1
    s_cmp_lt_u32 s4, 50
    s_cselect_b32 s6, -20, 0
    s_cmp_lt_u32 s4, 20
    s_cselect_b32 s6, 30, s6
    s_add_u32 s4, s4, s6
    s_mul_i32 s6, s5, 15360
    s_lshl_b32 s7, s4, 8
    s_add_u32 s47, s6, s7
    s_lshl_b32 s5, s5, 2
    s_add_u32 s5, s5, s3
    s_mul_i32 s5, s5, 80
    s_lshl_b32 s4, s4, 7
    s_mul_i32 s6, s5, 7680
    s_add_u32 s4, s4, s6
    v_min_u32 v78, 39, v1
    s_lshl_b32 s5, s5, 1
    v_lshl_add_u32 v78, v78, 2, s5
    global_load_dword v132, v78, s[30:31]
    v_lshrrev_b32 v79, 3, v1
    v_mul_u32_u24 v78, 15232, v79
    v_add3_u32 v78, v78, v4, s4
    global_load_dwordx4 v[92:95], v78, s[32:33] nt
    v_add_u32 v78, 7680, v78
    global_load_dwordx4 v[96:99], v78, s[32:33] nt
    v_add_u32 v78, 115200, v78
    global_load_dwordx4 v[100:103], v78, s[32:33] nt
    v_add_u32 v78, 7680, v78
    global_load_dwordx4 v[104:107], v78, s[32:33] nt
    v_add_u32 v78, 115200, v78
    global_load_dwordx4 v[108:111], v78, s[32:33] nt
    v_add_u32 v78, 7680, v78
    global_load_dwordx4 v[112:115], v78, s[32:33] nt
    v_add_u32 v78, 115200, v78
    global_load_dwordx4 v[116:119], v78, s[32:33] nt
    v_add_u32 v78, 7680, v78
    global_load_dwordx4 v[120:123], v78, s[32:33] nt
    v_add_u32 v78, 115200, v78
    global_load_dwordx4 v[124:127], v78, s[32:33] nt
    v_add_u32 v78, 7680, v78
    global_load_dwordx4 v[128:131], v78, s[32:33] nt
    s_waitcnt vmcnt(11)
    s_branch Lwp_n2
Lwp_n1:
    s_waitcnt vmcnt(0)
Lwp_n2:
    s_barrier
    ds_read_b32 v32, v28 offset:0
    ds_read_b32 v33, v28 offset:128
    ds_read_b32 v34, v28 offset:256
    ds_read_b32 v35, v28 offset:384
    ds_read_b32 v36, v28 offset:512
    ds_read_b32 v37, v28 offset:640
    ds_read_b32 v38, v28 offset:768
    ds_read_b32 v39, v28 offset:896
    ds_read_b32 v40, v28 offset:4096
    ds_read_b32 v41, v28 offset:4224
    ds_read_b32 v42, v28 offset:4352
    ds_read_b32 v43, v28 offset:4480
    ds_read_b32 v44, v28 offset:4608
    ds_read_b32 v45, v28 offset:4736
    ds_read_b32 v46, v28 offset:4864
    ds_read_b32 v47, v28 offset:4992
    ds_read_b32 v48, v28 offset:8192
    ds_read_b32 v49, v28 offset:8320
    ds_read_b32 v50, v28 offset:8448
    ds_read_b32 v51, v28 offset:8576
    ds_read_b32 v52, v28 offset:8704
    ds_read_b32 v53, v28 offset:8832
    ds_read_b32 v54, v28 offset:8960
    ds_read_b32 v55, v28 offset:9088
    ds_read_b32 v56, v28 offset:12288
    ds_read_b32 v57, v28 offset:12416
    ds_read_b32 v58, v28 offset:12544
    ds_read_b32 v59, v28 offset:12672
    ds_read_b32 v60, v28 offset:12800
    ds_read_b32 v61, v28 offset:12928
    ds_read_b32 v62, v28 offset:13056
    ds_read_b32 v63, v28 offset:13184
    ds_read_b32 v64, v28 offset:16384
    ds_read_b32 v65, v28 offset:16512
    ds_read_b32 v66, v28 offset:16640
    ds_read_b32 v67, v28 offset:16768
    ds_read_b32 v68, v28 offset:16896
    ds_read_b32 v69, v28 offset:17024
    ds_read_b32 v70, v28 offset:17152
    ds_read_b32 v71, v28 offset:17280
    s_waitcnt lgkmcnt(15)
    v_lshlrev_b32 v152, 16, v32
    v_and_b32 v153, 0xffff0000, v32
    v_lshlrev_b32 v154, 16, v33
    v_and_b32 v155, 0xffff0000, v33
    v_lshlrev_b32 v156, 16, v34
    v_and_b32 v157, 0xffff0000, v34
    v_lshlrev_b32 v158, 16, v35
    v_and_b32 v159, 0xffff0000, v35
    v_lshlrev_b32 v160, 16, v36
    v_and_b32 v161, 0xffff0000, v36
    v_lshlrev_b32 v162, 16, v37
    v_and_b32 v163, 0xffff0000, v37
    v_lshlrev_b32 v164, 16, v38
    v_and_b32 v165, 0xffff0000, v38
    v_lshlrev_b32 v166, 16, v39
    v_and_b32 v167, 0xffff0000, v39
    v_lshlrev_b32 v168, 16, v40
    v_and_b32 v169, 0xffff0000, v40
    v_lshlrev_b32 v170, 16, v41
    v_and_b32 v171, 0xffff0000, v41
    v_lshlrev_b32 v172, 16, v42
    v_and_b32 v173, 0xffff0000, v42
    v_lshlrev_b32 v174, 16, v43
    v_and_b32 v175, 0xffff0000, v43
    v_lshlrev_b32 v176, 16, v44
    v_and_b32 v177, 0xffff0000, v44
    v_lshlrev_b32 v178, 16, v45
    v_and_b32 v179, 0xffff0000, v45
    v_lshlrev_b32 v180, 16, v46
    v_and_b32 v181, 0xffff0000, v46
    v_lshlrev_b32 v182, 16, v47
    v_and_b32 v183, 0xffff0000, v47
    v_lshlrev_b32 v184, 16, v48
    v_and_b32 v185, 0xffff0000, v48
    v_lshlrev_b32 v186, 16, v49
    v_and_b32 v187, 0xffff0000, v49
    v_lshlrev_b32 v188, 16, v50
    v_and_b32 v189, 0xffff0000, v50
    v_lshlrev_b32 v190, 16, v51
    v_and_b32 v191, 0xffff0000, v51
    v_lshlrev_b32 v192, 16, v52
    v_and_b32 v193, 0xffff0000, v52
    v_lshlrev_b32 v194, 16, v53
    v_and_b32 v195, 0xffff0000, v53
    v_lshlrev_b32 v196, 16, v54
    v_and_b32 v197, 0xffff0000, v54
    v_lshlrev_b32 v198, 16, v55
    v_and_b32 v199, 0xffff0000, v55
    v_lshlrev_b32 v200, 16, v56
    v_and_b32 v201, 0xffff0000, v56
    s_waitcnt lgkmcnt(14)
    v_lshlrev_b32 v202, 16, v57
    v_and_b32 v203, 0xffff0000, v57
    s_waitcnt lgkmcnt(13)
    v_lshlrev_b32 v204, 16, v58
    v_and_b32 v205, 0xffff0000, v58
    s_waitcnt lgkmcnt(12)
    v_lshlrev_b32 v206, 16, v59
    v_and_b32 v207, 0xffff0000, v59
    s_waitcnt lgkmcnt(11)
    v_lshlrev_b32 v208, 16, v60
    v_and_b32 v209, 0xffff0000, v60
    s_waitcnt lgkmcnt(10)
    v_lshlrev_b32 v210, 16, v61
    v_and_b32 v211, 0xffff0000, v61
    s_waitcnt lgkmcnt(9)
    v_lshlrev_b32 v212, 16, v62
    v_and_b32 v213, 0xffff0000, v62
    s_waitcnt lgkmcnt(8)
    v_lshlrev_b32 v214, 16, v63
    v_and_b32 v215, 0xffff0000, v63
    s_waitcnt lgkmcnt(7)
    v_lshlrev_b32 v216, 16, v64
    v_and_b32 v217, 0xffff0000, v64
    s_waitcnt lgkmcnt(6)
    v_lshlrev_b32 v218, 16, v65
    v_and_b32 v219, 0xffff0000, v65
    s_waitcnt lgkmcnt(5)
    v_lshlrev_b32 v220, 16, v66
    v_and_b32 v221, 0xffff0000, v66
    s_waitcnt lgkmcnt(4)
    v_lshlrev_b32 v222, 16, v67
    v_and_b32 v223, 0xffff0000, v67
    s_waitcnt lgkmcnt(3)
    v_lshlrev_b32 v224, 16, v68
    v_and_b32 v225, 0xffff0000, v68
    s_waitcnt lgkmcnt(2)
    v_lshlrev_b32 v226, 16, v69
    v_and_b32 v227, 0xffff0000, v69
    s_waitcnt lgkmcnt(1)
    v_lshlrev_b32 v228, 16, v70
    v_and_b32 v229, 0xffff0000, v70
    s_waitcnt lgkmcnt(0)
    v_lshlrev_b32 v230, 16, v71
    v_and_b32 v231, 0xffff0000, v71
    s_cmp_lg_u32 s3, 0
    s_cbranch_scc1 Lwic_x
    v_min_u32 v32, 49, v1
    v_cmp_lt_u32 vcc, 7, v32
    s_nop 1
    v_cndmask_b32_e64 v33, 0, 7, vcc
    v_add_lshl_u32 v32, v32, v33, 2
    s_branch Lwic_f
Lwic:
    s_sleep 4
Lwic_f:
    global_load_dword v33, v32, s[36:37] sc1
    s_waitcnt vmcnt(0)
    v_cmp_eq_u32 vcc, 0, v33
    s_add_u32 s100, s100, 1
    s_cmp_ge_u32 s100, 262144
    s_cbranch_scc1 Lwic_x
    s_cbranch_vccnz Lwic
Lwic_x:
    s_waitcnt vmcnt(0)
    s_barrier
    s_sub_u32 s4, s42, 5
    s_cmp_ge_u32 s4, 21
    s_cbranch_scc1 Lwp_n3
    v_lshlrev_b32 v134, 16, v132
    v_and_b32 v135, 0xffff0000, v132
    v_lshlrev_b32 v79, 2, v79
    v_mul_f32 v136, 0xbfb8aa3b, v134
    v_mul_f32 v137, 0xbfb8aa3b, v135
    v_exp_f32 v136, v136
    v_exp_f32 v137, v137
    v_add_f32 v136, 1.0, v136
    v_add_f32 v137, 1.0, v137
    v_rcp_f32 v136, v136
    v_rcp_f32 v137, v137
    v_mul_f32 v134, v134, v136
    v_mul_f32 v135, v135, v137
    v_cvt_pk_bf16_f32 v132, v134, v135
    ds_bpermute_b32 v140, v79, v132 offset:0
    ds_bpermute_b32 v141, v79, v132 offset:32
    ds_bpermute_b32 v142, v79, v132 offset:64
    ds_bpermute_b32 v143, v79, v132 offset:96
    ds_bpermute_b32 v144, v79, v132 offset:128
    s_waitcnt lgkmcnt(4)
    v_lshlrev_b32 v80, 16, v140
    v_and_b32 v81, 0xffff0000, v140
    s_waitcnt lgkmcnt(3)
    v_lshlrev_b32 v82, 16, v141
    v_and_b32 v83, 0xffff0000, v141
    s_waitcnt lgkmcnt(2)
    v_lshlrev_b32 v84, 16, v142
    v_and_b32 v85, 0xffff0000, v142
    s_waitcnt lgkmcnt(1)
    v_lshlrev_b32 v86, 16, v143
    v_and_b32 v87, 0xffff0000, v143
    s_waitcnt lgkmcnt(0)
    v_lshlrev_b32 v88, 16, v144
    v_and_b32 v89, 0xffff0000, v144
    v_lshlrev_b32 v132, 16, v92
    v_and_b32 v133, 0xffff0000, v92
    v_lshlrev_b32 v134, 16, v93
    v_and_b32 v135, 0xffff0000, v93
    v_lshlrev_b32 v136, 16, v94
    v_and_b32 v137, 0xffff0000, v94
    v_lshlrev_b32 v138, 16, v95
    v_and_b32 v139, 0xffff0000, v95
    v_pk_mul_f32 v[140:141], v[80:81], v[132:133] op_sel:[0,0] op_sel_hi:[0,1]
    v_pk_mul_f32 v[142:143], v[80:81], v[134:135] op_sel:[0,0] op_sel_hi:[0,1]
    v_pk_mul_f32 v[144:145], v[80:81], v[136:137] op_sel:[0,0] op_sel_hi:[0,1]
    v_pk_mul_f32 v[146:147], v[80:81], v[138:139] op_sel:[0,0] op_sel_hi:[0,1]
    v_lshlrev_b32 v132, 16, v96
    v_and_b32 v133, 0xffff0000, v96
    v_lshlrev_b32 v134, 16, v97
    v_and_b32 v135, 0xffff0000, v97
    v_lshlrev_b32 v136, 16, v98
    v_and_b32 v137, 0xffff0000, v98
    v_lshlrev_b32 v138, 16, v99
    v_and_b32 v139, 0xffff0000, v99
    v_pk_fma_f32 v[140:141], v[80:81], v[132:133], v[140:141] op_sel:[1,0,0] op_sel_hi:[1,1,1]
    v_pk_fma_f32 v[142:143], v[80:81], v[134:135], v[142:143] op_sel:[1,0,0] op_sel_hi:[1,1,1]
    v_pk_fma_f32 v[144:145], v[80:81], v[136:137], v[144:145] op_sel:[1,0,0] op_sel_hi:[1,1,1]
    v_pk_fma_f32 v[146:147], v[80:81], v[138:139], v[146:147] op_sel:[1,0,0] op_sel_hi:[1,1,1]
    v_lshlrev_b32 v132, 16, v100
    v_and_b32 v133, 0xffff0000, v100
    v_lshlrev_b32 v134, 16, v101
    v_and_b32 v135, 0xffff0000, v101
    v_lshlrev_b32 v136, 16, v102
    v_and_b32 v137, 0xffff0000, v102
    v_lshlrev_b32 v138, 16, v103
    v_and_b32 v139, 0xffff0000, v103
    v_pk_fma_f32 v[140:141], v[82:83], v[132:133], v[140:141] op_sel:[0,0,0] op_sel_hi:[0,1,1]
    v_pk_fma_f32 v[142:143], v[82:83], v[134:135], v[142:143] op_sel:[0,0,0] op_sel_hi:[0,1,1]
    v_pk_fma_f32 v[144:145], v[82:83], v[136:137], v[144:145] op_sel:[0,0,0] op_sel_hi:[0,1,1]
    v_pk_fma_f32 v[146:147], v[82:83], v[138:139], v[146:147] op_sel:[0,0,0] op_sel_hi:[0,1,1]
    v_lshlrev_b32 v132, 16, v104
    v_and_b32 v133, 0xffff0000, v104
    v_lshlrev_b32 v134, 16, v105
    v_and_b32 v135, 0xffff0000, v105
    v_lshlrev_b32 v136, 16, v106
    v_and_b32 v137, 0xffff0000, v106
    v_lshlrev_b32 v138, 16, v107
    v_and_b32 v139, 0xffff0000, v107
    v_pk_fma_f32 v[140:141], v[82:83], v[132:133], v[140:141] op_sel:[1,0,0] op_sel_hi:[1,1,1]
    v_pk_fma_f32 v[142:143], v[82:83], v[134:135], v[142:143] op_sel:[1,0,0] op_sel_hi:[1,1,1]
    v_pk_fma_f32 v[144:145], v[82:83], v[136:137], v[144:145] op_sel:[1,0,0] op_sel_hi:[1,1,1]
    v_pk_fma_f32 v[146:147], v[82:83], v[138:139], v[146:147] op_sel:[1,0,0] op_sel_hi:[1,1,1]
    v_lshlrev_b32 v132, 16, v108
    v_and_b32 v133, 0xffff0000, v108
    v_lshlrev_b32 v134, 16, v109
    v_and_b32 v135, 0xffff0000, v109
    v_lshlrev_b32 v136, 16, v110
    v_and_b32 v137, 0xffff0000, v110
    v_lshlrev_b32 v138, 16, v111
    v_and_b32 v139, 0xffff0000, v111
    v_pk_fma_f32 v[140:141], v[84:85], v[132:133], v[140:141] op_sel:[0,0,0] op_sel_hi:[0,1,1]
    v_pk_fma_f32 v[142:143], v[84:85], v[134:135], v[142:143] op_sel:[0,0,0] op_sel_hi:[0,1,1]
    v_pk_fma_f32 v[144:145], v[84:85], v[136:137], v[144:145] op_sel:[0,0,0] op_sel_hi:[0,1,1]
    v_pk_fma_f32 v[146:147], v[84:85], v[138:139], v[146:147] op_sel:[0,0,0] op_sel_hi:[0,1,1]
    v_lshlrev_b32 v132, 16, v112
    v_and_b32 v133, 0xffff0000, v112
    v_lshlrev_b32 v134, 16, v113
    v_and_b32 v135, 0xffff0000, v113
    v_lshlrev_b32 v136, 16, v114
    v_and_b32 v137, 0xffff0000, v114
    v_lshlrev_b32 v138, 16, v115
    v_and_b32 v139, 0xffff0000, v115
    v_pk_fma_f32 v[140:141], v[84:85], v[132:133], v[140:141] op_sel:[1,0,0] op_sel_hi:[1,1,1]
    v_pk_fma_f32 v[142:143], v[84:85], v[134:135], v[142:143] op_sel:[1,0,0] op_sel_hi:[1,1,1]
    v_pk_fma_f32 v[144:145], v[84:85], v[136:137], v[144:145] op_sel:[1,0,0] op_sel_hi:[1,1,1]
    v_pk_fma_f32 v[146:147], v[84:85], v[138:139], v[146:147] op_sel:[1,0,0] op_sel_hi:[1,1,1]
    v_lshlrev_b32 v132, 16, v116
    v_and_b32 v133, 0xffff0000, v116
    v_lshlrev_b32 v134, 16, v117
    v_and_b32 v135, 0xffff0000, v117
    v_lshlrev_b32 v136, 16, v118
    v_and_b32 v137, 0xffff0000, v118
    v_lshlrev_b32 v138, 16, v119
    v_and_b32 v139, 0xffff0000, v119
    v_pk_fma_f32 v[140:141], v[86:87], v[132:133], v[140:141] op_sel:[0,0,0] op_sel_hi:[0,1,1]
    v_pk_fma_f32 v[142:143], v[86:87], v[134:135], v[142:143] op_sel:[0,0,0] op_sel_hi:[0,1,1]
    v_pk_fma_f32 v[144:145], v[86:87], v[136:137], v[144:145] op_sel:[0,0,0] op_sel_hi:[0,1,1]
    v_pk_fma_f32 v[146:147], v[86:87], v[138:139], v[146:147] op_sel:[0,0,0] op_sel_hi:[0,1,1]
    v_lshlrev_b32 v132, 16, v120
    v_and_b32 v133, 0xffff0000, v120
    v_lshlrev_b32 v134, 16, v121
    v_and_b32 v135, 0xffff0000, v121
    v_lshlrev_b32 v136, 16, v122
    v_and_b32 v137, 0xffff0000, v122
    v_lshlrev_b32 v138, 16, v123
    v_and_b32 v139, 0xffff0000, v123
    v_pk_fma_f32 v[140:141], v[86:87], v[132:133], v[140:141] op_sel:[1,0,0] op_sel_hi:[1,1,1]
    v_pk_fma_f32 v[142:143], v[86:87], v[134:135], v[142:143] op_sel:[1,0,0] op_sel_hi:[1,1,1]
    v_pk_fma_f32 v[144:145], v[86:87], v[136:137], v[144:145] op_sel:[1,0,0] op_sel_hi:[1,1,1]
    v_pk_fma_f32 v[146:147], v[86:87], v[138:139], v[146:147] op_sel:[1,0,0] op_sel_hi:[1,1,1]
    v_lshlrev_b32 v132, 16, v124
    v_and_b32 v133, 0xffff0000, v124
    v_lshlrev_b32 v134, 16, v125
    v_and_b32 v135, 0xffff0000, v125
    v_lshlrev_b32 v136, 16, v126
    v_and_b32 v137, 0xffff0000, v126
    v_lshlrev_b32 v138, 16, v127
    v_and_b32 v139, 0xffff0000, v127
    v_pk_fma_f32 v[140:141], v[88:89], v[132:133], v[140:141] op_sel:[0,0,0] op_sel_hi:[0,1,1]
    v_pk_fma_f32 v[142:143], v[88:89], v[134:135], v[142:143] op_sel:[0,0,0] op_sel_hi:[0,1,1]
    v_pk_fma_f32 v[144:145], v[88:89], v[136:137], v[144:145] op_sel:[0,0,0] op_sel_hi:[0,1,1]
    v_pk_fma_f32 v[146:147], v[88:89], v[138:139], v[146:147] op_sel:[0,0,0] op_sel_hi:[0,1,1]
    v_lshlrev_b32 v132, 16, v128
    v_and_b32 v133, 0xffff0000, v128
    v_lshlrev_b32 v134, 16, v129
    v_and_b32 v135, 0xffff0000, v129
    v_lshlrev_b32 v136, 16, v130
    v_and_b32 v137, 0xffff0000, v130
    v_lshlrev_b32 v138, 16, v131
    v_and_b32 v139, 0xffff0000, v131
    v_pk_fma_f32 v[140:141], v[88:89], v[132:133], v[140:141] op_sel:[1,0,0] op_sel_hi:[1,1,1]
    v_pk_fma_f32 v[142:143], v[88:89], v[134:135], v[142:143] op_sel:[1,0,0] op_sel_hi:[1,1,1]
    v_pk_fma_f32 v[144:145], v[88:89], v[136:137], v[144:145] op_sel:[1,0,0] op_sel_hi:[1,1,1]
    v_pk_fma_f32 v[146:147], v[88:89], v[138:139], v[146:147] op_sel:[1,0,0] op_sel_hi:[1,1,1]
    s_nop 0
    v_permlane32_swap_b32 v140, v144
    v_permlane32_swap_b32 v141, v145
    v_permlane32_swap_b32 v142, v146
    v_permlane32_swap_b32 v143, v147
    v_add_f32 v140, v140, v144
    v_add_f32 v141, v141, v145
    v_add_f32 v142, v142, v146
    v_add_f32 v143, v143, v147
    s_nop 0
    v_permlane16_swap_b32 v140, v142
    v_permlane16_swap_b32 v141, v143
    v_add_f32 v140, v140, v142
    v_add_f32 v141, v141, v143
    v_and_b32 v133, 7, v1
    v_lshrrev_b32 v134, 3, v1
    v_add_f32_dpp v132, v140, v140 row_ror:8 row_mask:0xf bank_mask:0x3
    s_nop 1
    v_add_f32_dpp v132, v141, v141 row_ror:8 row_mask:0xf bank_mask:0xc
    v_lshl_add_u32 v133, v133, 3, v134
    s_lshl_b32 s7, s3, 8
    s_add_u32 s7, s7, 122880
    v_lshl_add_u32 v133, v133, 2, s7
    ds_write_b32 v133, v132
    s_waitcnt lgkmcnt(0)
    s_barrier
    v_lshlrev_b32 v133, 2, v1
    v_add_u32 v134, 122880, v133
    ds_read_b32 v140, v134 offset:0
    ds_read_b32 v141, v134 offset:256
    ds_read_b32 v142, v134 offset:512
    ds_read_b32 v143, v134 offset:768
    v_add_u32 v133, s47, v133
    s_waitcnt lgkmcnt(2)
    v_add_f32 v140, v140, v141
    s_waitcnt lgkmcnt(0)
    v_add_f32 v142, v142, v143
    v_add_f32 v140, v140, v142
    v_min_u32 v140, -2, v140
    s_cmp_lg_u32 s3, 0
    s_cbranch_scc1 Lmod_skip_w
    global_store_dword v133, v140, s[38:39] offset:0 sc1
Lmod_skip_w:
Lwp_n3:
    s_branch Lwm_f
Lwm:
    s_sleep 4
Lwm_f:
    v_add_u32 v77, 0, v73
    global_load_dwordx4 v[80:83], v77, s[38:39] sc1
    global_load_dwordx4 v[84:87], v77, s[38:39] offset:2560 sc1
    v_add_u32 v77, 15360, v73
    global_load_dwordx4 v[88:91], v77, s[38:39] sc1
    global_load_dwordx4 v[92:95], v77, s[38:39] offset:2560 sc1
    s_waitcnt vmcnt(0)
    v_max_u32 v77, v80, v81
    v_max3_u32 v77, v82, v83, v77
    v_max3_u32 v77, v84, v85, v77
    v_max3_u32 v77, v86, v87, v77
    v_max3_u32 v77, v88, v89, v77
    v_max3_u32 v77, v90, v91, v77
    v_max3_u32 v77, v92, v93, v77
    v_max3_u32 v77, v94, v95, v77
    v_cmp_eq_u32 vcc, -1, v77
    s_add_u32 s100, s100, 1
    s_cmp_ge_u32 s100, 262144
    s_cbranch_scc1 Lwm_x
    s_cbranch_vccnz Lwm
Lwm_x:
    v_pk_add_f32 v[80:81], v[80:81], v[88:89] op_sel:[0,0] op_sel_hi:[1,1]
    v_pk_add_f32 v[82:83], v[82:83], v[90:91] op_sel:[0,0] op_sel_hi:[1,1]
    v_pk_add_f32 v[84:85], v[84:85], v[92:93] op_sel:[0,0] op_sel_hi:[1,1]
    v_pk_add_f32 v[86:87], v[86:87], v[94:95] op_sel:[0,0] op_sel_hi:[1,1]
    v_cvt_pk_bf16_f32 v80, v80, v80
    v_lshlrev_b32 v80, 16, v80
    v_cvt_pk_bf16_f32 v81, v81, v81
    v_lshlrev_b32 v81, 16, v81
    v_cvt_pk_bf16_f32 v82, v82, v82
    v_lshlrev_b32 v82, 16, v82
    v_cvt_pk_bf16_f32 v83, v83, v83
    v_lshlrev_b32 v83, 16, v83
    v_cvt_pk_bf16_f32 v84, v84, v84
    v_lshlrev_b32 v84, 16, v84
    v_cvt_pk_bf16_f32 v85, v85, v85
    v_lshlrev_b32 v85, 16, v85
    v_cvt_pk_bf16_f32 v86, v86, v86
    v_lshlrev_b32 v86, 16, v86
    v_cvt_pk_bf16_f32 v87, v87, v87
    v_lshlrev_b32 v87, 16, v87
    v_add_f32 v84, 1.0, v84
    v_add_f32 v85, 1.0, v85
    v_add_f32 v86, 1.0, v86
    v_add_f32 v87, 1.0, v87
    v_cvt_pk_bf16_f32 v84, v84, v84
    v_lshlrev_b32 v84, 16, v84
    v_cvt_pk_bf16_f32 v85, v85, v85
    v_lshlrev_b32 v85, 16, v85
    v_cvt_pk_bf16_f32 v86, v86, v86
    v_lshlrev_b32 v86, 16, v86
    v_cvt_pk_bf16_f32 v87, v87, v87
    v_lshlrev_b32 v87, 16, v87
    ds_write_b128 v72, v[84:87]
    ds_write_b128 v72, v[80:83] offset:640
    ds_read_b128 v[32:35], v74 offset:0
    ds_read_b128 v[36:39], v74 offset:16
    ds_read_b128 v[40:43], v74 offset:128
    ds_read_b128 v[44:47], v74 offset:144
    ds_read_b128 v[48:51], v74 offset:256
    ds_read_b128 v[52:55], v74 offset:272
    ds_read_b128 v[56:59], v74 offset:384
    ds_read_b128 v[60:63], v74 offset:400
    ds_read_b128 v[64:67], v74 offset:512
    ds_read_b128 v[68:71], v74 offset:528
    s_waitcnt lgkmcnt(9)
    v_pk_mul_f32 v[96:97], v[32:33], v[152:153] op_sel:[0,0] op_sel_hi:[0,1]
    v_pk_mul_f32 v[98:99], v[32:33], v[154:155] op_sel:[1,0] op_sel_hi:[1,1]
    v_pk_mul_f32 v[100:101], v[34:35], v[156:157] op_sel:[0,0] op_sel_hi:[0,1]
    v_pk_mul_f32 v[102:103], v[34:35], v[158:159] op_sel:[1,0] op_sel_hi:[1,1]
    s_waitcnt lgkmcnt(8)
    v_pk_mul_f32 v[104:105], v[36:37], v[160:161] op_sel:[0,0] op_sel_hi:[0,1]
    v_pk_mul_f32 v[106:107], v[36:37], v[162:163] op_sel:[1,0] op_sel_hi:[1,1]
    v_pk_mul_f32 v[108:109], v[38:39], v[164:165] op_sel:[0,0] op_sel_hi:[0,1]
    v_pk_mul_f32 v[110:111], v[38:39], v[166:167] op_sel:[1,0] op_sel_hi:[1,1]
    v_cvt_pk_bf16_f32 v112, v96, v98
    v_cvt_pk_bf16_f32 v113, v100, v102
    v_cvt_pk_bf16_f32 v114, v104, v106
    v_cvt_pk_bf16_f32 v115, v108, v110
    v_cvt_pk_bf16_f32 v116, v97, v99
    v_cvt_pk_bf16_f32 v117, v101, v103
    v_cvt_pk_bf16_f32 v118, v105, v107
    v_cvt_pk_bf16_f32 v119, v109, v111
    global_store_dwordx4 v75, v[112:115], s[38:39] offset:-2048 sc1
    global_store_dwordx4 v76, v[116:119], s[38:39] offset:-2048 sc1
    s_waitcnt lgkmcnt(7)
    v_pk_mul_f32 v[96:97], v[40:41], v[168:169] op_sel:[0,0] op_sel_hi:[0,1]
    v_pk_mul_f32 v[98:99], v[40:41], v[170:171] op_sel:[1,0] op_sel_hi:[1,1]
    v_pk_mul_f32 v[100:101], v[42:43], v[172:173] op_sel:[0,0] op_sel_hi:[0,1]
    v_pk_mul_f32 v[102:103], v[42:43], v[174:175] op_sel:[1,0] op_sel_hi:[1,1]
    s_waitcnt lgkmcnt(6)
    v_pk_mul_f32 v[104:105], v[44:45], v[176:177] op_sel:[0,0] op_sel_hi:[0,1]
    v_pk_mul_f32 v[106:107], v[44:45], v[178:179] op_sel:[1,0] op_sel_hi:[1,1]
    v_pk_mul_f32 v[108:109], v[46:47], v[180:181] op_sel:[0,0] op_sel_hi:[0,1]
    v_pk_mul_f32 v[110:111], v[46:47], v[182:183] op_sel:[1,0] op_sel_hi:[1,1]
    v_cvt_pk_bf16_f32 v120, v96, v98
    v_cvt_pk_bf16_f32 v121, v100, v102
    v_cvt_pk_bf16_f32 v122, v104, v106
    v_cvt_pk_bf16_f32 v123, v108, v110
    v_cvt_pk_bf16_f32 v124, v97, v99
    v_cvt_pk_bf16_f32 v125, v101, v103
    v_cvt_pk_bf16_f32 v126, v105, v107
    v_cvt_pk_bf16_f32 v127, v109, v111
    global_store_dwordx4 v75, v[120:123], s[38:39] offset:-1024 sc1
    global_store_dwordx4 v76, v[124:127], s[38:39] offset:-1024 sc1
    s_waitcnt lgkmcnt(5)
    v_pk_mul_f32 v[96:97], v[48:49], v[184:185] op_sel:[0,0] op_sel_hi:[0,1]
    v_pk_mul_f32 v[98:99], v[48:49], v[186:187] op_sel:[1,0] op_sel_hi:[1,1]
    v_pk_mul_f32 v[100:101], v[50:51], v[188:189] op_sel:[0,0] op_sel_hi:[0,1]
    v_pk_mul_f32 v[102:103], v[50:51], v[190:191] op_sel:[1,0] op_sel_hi:[1,1]
    s_waitcnt lgkmcnt(4)
    v_pk_mul_f32 v[104:105], v[52:53], v[192:193] op_sel:[0,0] op_sel_hi:[0,1]
    v_pk_mul_f32 v[106:107], v[52:53], v[194:195] op_sel:[1,0] op_sel_hi:[1,1]
    v_pk_mul_f32 v[108:109], v[54:55], v[196:197] op_sel:[0,0] op_sel_hi:[0,1]
    v_pk_mul_f32 v[110:111], v[54:55], v[198:199] op_sel:[1,0] op_sel_hi:[1,1]
    v_cvt_pk_bf16_f32 v128, v96, v98
    v_cvt_pk_bf16_f32 v129, v100, v102
    v_cvt_pk_bf16_f32 v130, v104, v106
    v_cvt_pk_bf16_f32 v131, v108, v110
    v_cvt_pk_bf16_f32 v132, v97, v99
    v_cvt_pk_bf16_f32 v133, v101, v103
    v_cvt_pk_bf16_f32 v134, v105, v107
    v_cvt_pk_bf16_f32 v135, v109, v111
    global_store_dwordx4 v75, v[128:131], s[38:39] offset:0 sc1
    global_store_dwordx4 v76, v[132:135], s[38:39] offset:0 sc1
    s_waitcnt lgkmcnt(3)
    v_pk_mul_f32 v[96:97], v[56:57], v[200:201] op_sel:[0,0] op_sel_hi:[0,1]
    v_pk_mul_f32 v[98:99], v[56:57], v[202:203] op_sel:[1,0] op_sel_hi:[1,1]
    v_pk_mul_f32 v[100:101], v[58:59], v[204:205] op_sel:[0,0] op_sel_hi:[0,1]
    v_pk_mul_f32 v[102:103], v[58:59], v[206:207] op_sel:[1,0] op_sel_hi:[1,1]
    s_waitcnt lgkmcnt(2)
    v_pk_mul_f32 v[104:105], v[60:61], v[208:209] op_sel:[0,0] op_sel_hi:[0,1]
    v_pk_mul_f32 v[106:107], v[60:61], v[210:211] op_sel:[1,0] op_sel_hi:[1,1]
    v_pk_mul_f32 v[108:109], v[62:63], v[212:213] op_sel:[0,0] op_sel_hi:[0,1]
    v_pk_mul_f32 v[110:111], v[62:63], v[214:215] op_sel:[1,0] op_sel_hi:[1,1]
    v_cvt_pk_bf16_f32 v136, v96, v98
    v_cvt_pk_bf16_f32 v137, v100, v102
    v_cvt_pk_bf16_f32 v138, v104, v106
    v_cvt_pk_bf16_f32 v139, v108, v110
    v_cvt_pk_bf16_f32 v140, v97, v99
    v_cvt_pk_bf16_f32 v141, v101, v103
    v_cvt_pk_bf16_f32 v142, v105, v107
    v_cvt_pk_bf16_f32 v143, v109, v111
    global_store_dwordx4 v75, v[136:139], s[38:39] offset:1024 sc1
    global_store_dwordx4 v76, v[140:143], s[38:39] offset:1024 sc1
    s_waitcnt lgkmcnt(1)
    v_pk_mul_f32 v[96:97], v[64:65], v[216:217] op_sel:[0,0] op_sel_hi:[0,1]
    v_pk_mul_f32 v[98:99], v[64:65], v[218:219] op_sel:[1,0] op_sel_hi:[1,1]
    v_pk_mul_f32 v[100:101], v[66:67], v[220:221] op_sel:[0,0] op_sel_hi:[0,1]
    v_pk_mul_f32 v[102:103], v[66:67], v[222:223] op_sel:[1,0] op_sel_hi:[1,1]
    s_waitcnt lgkmcnt(0)
    v_pk_mul_f32 v[104:105], v[68:69], v[224:225] op_sel:[0,0] op_sel_hi:[0,1]
    v_pk_mul_f32 v[106:107], v[68:69], v[226:227] op_sel:[1,0] op_sel_hi:[1,1]
    v_pk_mul_f32 v[108:109], v[70:71], v[228:229] op_sel:[0,0] op_sel_hi:[0,1]
    v_pk_mul_f32 v[110:111], v[70:71], v[230:231] op_sel:[1,0] op_sel_hi:[1,1]
    v_cvt_pk_bf16_f32 v144, v96, v98
    v_cvt_pk_bf16_f32 v145, v100, v102
    v_cvt_pk_bf16_f32 v146, v104, v106
    v_cvt_pk_bf16_f32 v147, v108, v110
    v_cvt_pk_bf16_f32 v148, v97, v99
    v_cvt_pk_bf16_f32 v149, v101, v103
    v_cvt_pk_bf16_f32 v150, v105, v107
    v_cvt_pk_bf16_f32 v151, v109, v111
    global_store_dwordx4 v75, v[144:147], s[38:39] offset:2048 sc1
    global_store_dwordx4 v76, v[148:151], s[38:39] offset:2048 sc1
    ds_read_b128 v[32:35], v74 offset:640
    ds_read_b128 v[36:39], v74 offset:656
    ds_read_b128 v[40:43], v74 offset:768
    ds_read_b128 v[44:47], v74 offset:784
    ds_read_b128 v[48:51], v74 offset:896
    ds_read_b128 v[52:55], v74 offset:912
    ds_read_b128 v[56:59], v74 offset:1024
    ds_read_b128 v[60:63], v74 offset:1040
    ds_read_b128 v[64:67], v74 offset:1152
    ds_read_b128 v[68:71], v74 offset:1168
    s_mov_b32 s7, 0x3f803f80
    v_mov_b32 v88, 0
    v_mov_b32 v89, 0
    v_mov_b32 v90, 0
    v_mov_b32 v91, 0
    v_mov_b32 v92, 0
    v_mov_b32 v93, 0
    v_mov_b32 v94, 0
    v_mov_b32 v95, 0
    v_dot2_f32_bf16 v88, v112, s7, v88
    v_dot2_f32_bf16 v89, v116, s7, v89
    v_dot2_f32_bf16 v88, v113, s7, v88
    v_dot2_f32_bf16 v89, v117, s7, v89
    v_dot2_f32_bf16 v88, v114, s7, v88
    v_dot2_f32_bf16 v89, v118, s7, v89
    v_dot2_f32_bf16 v88, v115, s7, v88
    v_dot2_f32_bf16 v89, v119, s7, v89
    v_dot2_f32_bf16 v88, v120, s7, v88
    v_dot2_f32_bf16 v89, v124, s7, v89
    v_dot2_f32_bf16 v88, v121, s7, v88
    v_dot2_f32_bf16 v89, v125, s7, v89
    v_dot2_f32_bf16 v88, v122, s7, v88
    v_dot2_f32_bf16 v89, v126, s7, v89
    v_dot2_f32_bf16 v88, v123, s7, v88
    v_dot2_f32_bf16 v89, v127, s7, v89
    v_dot2_f32_bf16 v88, v128, s7, v88
    v_dot2_f32_bf16 v89, v132, s7, v89
    v_dot2_f32_bf16 v88, v129, s7, v88
    v_dot2_f32_bf16 v89, v133, s7, v89
    v_dot2_f32_bf16 v88, v130, s7, v88
    v_dot2_f32_bf16 v89, v134, s7, v89
    v_dot2_f32_bf16 v88, v131, s7, v88
    v_dot2_f32_bf16 v89, v135, s7, v89
    v_dot2_f32_bf16 v88, v136, s7, v88
    v_dot2_f32_bf16 v89, v140, s7, v89
    v_dot2_f32_bf16 v88, v137, s7, v88
    v_dot2_f32_bf16 v89, v141, s7, v89
    v_dot2_f32_bf16 v88, v138, s7, v88
    v_dot2_f32_bf16 v89, v142, s7, v89
    v_dot2_f32_bf16 v88, v139, s7, v88
    v_dot2_f32_bf16 v89, v143, s7, v89
    v_dot2_f32_bf16 v88, v144, s7, v88
    v_dot2_f32_bf16 v89, v148, s7, v89
    v_dot2_f32_bf16 v88, v145, s7, v88
    v_dot2_f32_bf16 v89, v149, s7, v89
    v_dot2_f32_bf16 v88, v146, s7, v88
    v_dot2_f32_bf16 v89, v150, s7, v89
    v_dot2_f32_bf16 v88, v147, s7, v88
    v_dot2_f32_bf16 v89, v151, s7, v89
    s_waitcnt lgkmcnt(9)
    v_pk_fma_f32 v[90:91], v[32:33], v[152:153], v[90:91] op_sel:[0,0,0] op_sel_hi:[0,1,1]
    v_pk_fma_f32 v[92:93], v[32:33], v[154:155], v[92:93] op_sel:[1,0,0] op_sel_hi:[1,1,1]
    v_pk_fma_f32 v[94:95], v[34:35], v[156:157], v[94:95] op_sel:[0,0,0] op_sel_hi:[0,1,1]
    v_pk_fma_f32 v[90:91], v[34:35], v[158:159], v[90:91] op_sel:[1,0,0] op_sel_hi:[1,1,1]
    s_waitcnt lgkmcnt(8)
    v_pk_fma_f32 v[92:93], v[36:37], v[160:161], v[92:93] op_sel:[0,0,0] op_sel_hi:[0,1,1]
    v_pk_fma_f32 v[94:95], v[36:37], v[162:163], v[94:95] op_sel:[1,0,0] op_sel_hi:[1,1,1]
    v_pk_fma_f32 v[90:91], v[38:39], v[164:165], v[90:91] op_sel:[0,0,0] op_sel_hi:[0,1,1]
    v_pk_fma_f32 v[92:93], v[38:39], v[166:167], v[92:93] op_sel:[1,0,0] op_sel_hi:[1,1,1]
    s_waitcnt lgkmcnt(7)
    v_pk_fma_f32 v[94:95], v[40:41], v[168:169], v[94:95] op_sel:[0,0,0] op_sel_hi:[0,1,1]
    v_pk_fma_f32 v[90:91], v[40:41], v[170:171], v[90:91] op_sel:[1,0,0] op_sel_hi:[1,1,1]
    v_pk_fma_f32 v[92:93], v[42:43], v[172:173], v[92:93] op_sel:[0,0,0] op_sel_hi:[0,1,1]
    v_pk_fma_f32 v[94:95], v[42:43], v[174:175], v[94:95] op_sel:[1,0,0] op_sel_hi:[1,1,1]
    s_waitcnt lgkmcnt(6)
    v_pk_fma_f32 v[90:91], v[44:45], v[176:177], v[90:91] op_sel:[0,0,0] op_sel_hi:[0,1,1]
    v_pk_fma_f32 v[92:93], v[44:45], v[178:179], v[92:93] op_sel:[1,0,0] op_sel_hi:[1,1,1]
    v_pk_fma_f32 v[94:95], v[46:47], v[180:181], v[94:95] op_sel:[0,0,0] op_sel_hi:[0,1,1]
    v_pk_fma_f32 v[90:91], v[46:47], v[182:183], v[90:91] op_sel:[1,0,0] op_sel_hi:[1,1,1]
    s_waitcnt lgkmcnt(5)
    v_pk_fma_f32 v[92:93], v[48:49], v[184:185], v[92:93] op_sel:[0,0,0] op_sel_hi:[0,1,1]
    v_pk_fma_f32 v[94:95], v[48:49], v[186:187], v[94:95] op_sel:[1,0,0] op_sel_hi:[1,1,1]
    v_pk_fma_f32 v[90:91], v[50:51], v[188:189], v[90:91] op_sel:[0,0,0] op_sel_hi:[0,1,1]
    v_pk_fma_f32 v[92:93], v[50:51], v[190:191], v[92:93] op_sel:[1,0,0] op_sel_hi:[1,1,1]
    s_waitcnt lgkmcnt(4)
    v_pk_fma_f32 v[94:95], v[52:53], v[192:193], v[94:95] op_sel:[0,0,0] op_sel_hi:[0,1,1]
    v_pk_fma_f32 v[90:91], v[52:53], v[194:195], v[90:91] op_sel:[1,0,0] op_sel_hi:[1,1,1]
    v_pk_fma_f32 v[92:93], v[54:55], v[196:197], v[92:93] op_sel:[0,0,0] op_sel_hi:[0,1,1]
    v_pk_fma_f32 v[94:95], v[54:55], v[198:199], v[94:95] op_sel:[1,0,0] op_sel_hi:[1,1,1]
    s_waitcnt lgkmcnt(3)
    v_pk_fma_f32 v[90:91], v[56:57], v[200:201], v[90:91] op_sel:[0,0,0] op_sel_hi:[0,1,1]
    v_pk_fma_f32 v[92:93], v[56:57], v[202:203], v[92:93] op_sel:[1,0,0] op_sel_hi:[1,1,1]
    v_pk_fma_f32 v[94:95], v[58:59], v[204:205], v[94:95] op_sel:[0,0,0] op_sel_hi:[0,1,1]
    v_pk_fma_f32 v[90:91], v[58:59], v[206:207], v[90:91] op_sel:[1,0,0] op_sel_hi:[1,1,1]
    s_waitcnt lgkmcnt(2)
    v_pk_fma_f32 v[92:93], v[60:61], v[208:209], v[92:93] op_sel:[0,0,0] op_sel_hi:[0,1,1]
    v_pk_fma_f32 v[94:95], v[60:61], v[210:211], v[94:95] op_sel:[1,0,0] op_sel_hi:[1,1,1]
    v_pk_fma_f32 v[90:91], v[62:63], v[212:213], v[90:91] op_sel:[0,0,0] op_sel_hi:[0,1,1]
    v_pk_fma_f32 v[92:93], v[62:63], v[214:215], v[92:93] op_sel:[1,0,0] op_sel_hi:[1,1,1]
    s_waitcnt lgkmcnt(1)
    v_pk_fma_f32 v[94:95], v[64:65], v[216:217], v[94:95] op_sel:[0,0,0] op_sel_hi:[0,1,1]
    v_pk_fma_f32 v[90:91], v[64:65], v[218:219], v[90:91] op_sel:[1,0,0] op_sel_hi:[1,1,1]
    v_pk_fma_f32 v[92:93], v[66:67], v[220:221], v[92:93] op_sel:[0,0,0] op_sel_hi:[0,1,1]
    v_pk_fma_f32 v[94:95], v[66:67], v[222:223], v[94:95] op_sel:[1,0,0] op_sel_hi:[1,1,1]
    s_waitcnt lgkmcnt(0)
    v_pk_fma_f32 v[90:91], v[68:69], v[224:225], v[90:91] op_sel:[0,0,0] op_sel_hi:[0,1,1]
    v_pk_fma_f32 v[92:93], v[68:69], v[226:227], v[92:93] op_sel:[1,0,0] op_sel_hi:[1,1,1]
    v_pk_fma_f32 v[94:95], v[70:71], v[228:229], v[94:95] op_sel:[0,0,0] op_sel_hi:[0,1,1]
    v_pk_fma_f32 v[90:91], v[70:71], v[230:231], v[90:91] op_sel:[1,0,0] op_sel_hi:[1,1,1]
    v_pk_add_f32 v[90:91], v[90:91], v[92:93] op_sel:[0,0] op_sel_hi:[1,1]
    v_pk_add_f32 v[90:91], v[90:91], v[94:95] op_sel:[0,0] op_sel_hi:[1,1]
    v_permlane32_swap_b32 v88, v89
    s_nop 0
    v_permlane32_swap_b32 v90, v91
    v_add_f32 v88, v88, v89
    v_add_f32 v90, v90, v91
    s_nop 1
    v_permlane16_swap_b32 v88, v90
    v_add_f32 v88, v88, v90
    v_lshlrev_b32 v74, 2, v0
    v_add_u32 v74, 131072, v74
    ds_write_b32 v74, v88
    v_xor_b32 v74, 256, v74
    s_waitcnt vmcnt(0) lgkmcnt(0)
    s_barrier
    ds_read_b32 v89, v74
    s_lshl_b32 s6, s46, 7
    s_lshr_b32 s5, s44, 1
    s_mul_i32 s5, s5, 14336
    s_add_u32 s6, s6, s5
    s_add_u32 s6, s6, 49152
    v_lshl_add_u32 v74, v1, 2, s6
    s_waitcnt lgkmcnt(0)
    v_add_f32 v88, v88, v89
    v_min_u32 v88, -2, v88
    s_bitcmp1_b32 s3, 0
    s_cbranch_scc1 Lwp_skip
    global_store_dword v74, v88, s[38:39] sc1
Lwp_skip:
    s_branch Lsp_c
Lsp_b3:
    v_lshlrev_b32 v82, 16, v80
    v_and_b32 v83, 0xffff0000, v80
    v_lshlrev_b32 v29, 2, v29
    v_mul_f32 v84, 0xbfb8aa3b, v82
    v_mul_f32 v85, 0xbfb8aa3b, v83
    v_exp_f32 v84, v84
    v_exp_f32 v85, v85
    v_add_f32 v84, 1.0, v84
    v_add_f32 v85, 1.0, v85
    v_rcp_f32 v84, v84
    v_rcp_f32 v85, v85
    v_mul_f32 v82, v82, v84
    v_mul_f32 v83, v83, v85
    v_cvt_pk_bf16_f32 v80, v82, v83
    ds_bpermute_b32 v88, v29, v80 offset:0
    ds_bpermute_b32 v89, v29, v80 offset:32
    ds_bpermute_b32 v90, v29, v80 offset:64
    ds_bpermute_b32 v91, v29, v80 offset:96
    ds_bpermute_b32 v92, v29, v80 offset:128
    s_waitcnt lgkmcnt(4)
    v_lshlrev_b32 v30, 16, v88
    v_and_b32 v31, 0xffff0000, v88
    s_waitcnt lgkmcnt(3)
    v_lshlrev_b32 v32, 16, v89
    v_and_b32 v33, 0xffff0000, v89
    s_waitcnt lgkmcnt(2)
    v_lshlrev_b32 v34, 16, v90
    v_and_b32 v35, 0xffff0000, v90
    s_waitcnt lgkmcnt(1)
    v_lshlrev_b32 v36, 16, v91
    v_and_b32 v37, 0xffff0000, v91
    s_waitcnt lgkmcnt(0)
    v_lshlrev_b32 v38, 16, v92
    v_and_b32 v39, 0xffff0000, v92
    v_lshlrev_b32 v80, 16, v40
    v_and_b32 v81, 0xffff0000, v40
    v_lshlrev_b32 v82, 16, v41
    v_and_b32 v83, 0xffff0000, v41
    v_lshlrev_b32 v84, 16, v42
    v_and_b32 v85, 0xffff0000, v42
    v_lshlrev_b32 v86, 16, v43
    v_and_b32 v87, 0xffff0000, v43
    v_pk_mul_f32 v[88:89], v[30:31], v[80:81] op_sel:[0,0] op_sel_hi:[0,1]
    v_pk_mul_f32 v[90:91], v[30:31], v[82:83] op_sel:[0,0] op_sel_hi:[0,1]
    v_pk_mul_f32 v[92:93], v[30:31], v[84:85] op_sel:[0,0] op_sel_hi:[0,1]
    v_pk_mul_f32 v[94:95], v[30:31], v[86:87] op_sel:[0,0] op_sel_hi:[0,1]
    v_lshlrev_b32 v80, 16, v44
    v_and_b32 v81, 0xffff0000, v44
    v_lshlrev_b32 v82, 16, v45
    v_and_b32 v83, 0xffff0000, v45
    v_lshlrev_b32 v84, 16, v46
    v_and_b32 v85, 0xffff0000, v46
    v_lshlrev_b32 v86, 16, v47
    v_and_b32 v87, 0xffff0000, v47
    v_pk_fma_f32 v[88:89], v[30:31], v[80:81], v[88:89] op_sel:[1,0,0] op_sel_hi:[1,1,1]
    v_pk_fma_f32 v[90:91], v[30:31], v[82:83], v[90:91] op_sel:[1,0,0] op_sel_hi:[1,1,1]
    v_pk_fma_f32 v[92:93], v[30:31], v[84:85], v[92:93] op_sel:[1,0,0] op_sel_hi:[1,1,1]
    v_pk_fma_f32 v[94:95], v[30:31], v[86:87], v[94:95] op_sel:[1,0,0] op_sel_hi:[1,1,1]
    v_lshlrev_b32 v80, 16, v48
    v_and_b32 v81, 0xffff0000, v48
    v_lshlrev_b32 v82, 16, v49
    v_and_b32 v83, 0xffff0000, v49
    v_lshlrev_b32 v84, 16, v50
    v_and_b32 v85, 0xffff0000, v50
    v_lshlrev_b32 v86, 16, v51
    v_and_b32 v87, 0xffff0000, v51
    v_pk_fma_f32 v[88:89], v[32:33], v[80:81], v[88:89] op_sel:[0,0,0] op_sel_hi:[0,1,1]
    v_pk_fma_f32 v[90:91], v[32:33], v[82:83], v[90:91] op_sel:[0,0,0] op_sel_hi:[0,1,1]
    v_pk_fma_f32 v[92:93], v[32:33], v[84:85], v[92:93] op_sel:[0,0,0] op_sel_hi:[0,1,1]
    v_pk_fma_f32 v[94:95], v[32:33], v[86:87], v[94:95] op_sel:[0,0,0] op_sel_hi:[0,1,1]
    v_lshlrev_b32 v80, 16, v52
    v_and_b32 v81, 0xffff0000, v52
    v_lshlrev_b32 v82, 16, v53
    v_and_b32 v83, 0xffff0000, v53
    v_lshlrev_b32 v84, 16, v54
    v_and_b32 v85, 0xffff0000, v54
    v_lshlrev_b32 v86, 16, v55
    v_and_b32 v87, 0xffff0000, v55
    v_pk_fma_f32 v[88:89], v[32:33], v[80:81], v[88:89] op_sel:[1,0,0] op_sel_hi:[1,1,1]
    v_pk_fma_f32 v[90:91], v[32:33], v[82:83], v[90:91] op_sel:[1,0,0] op_sel_hi:[1,1,1]
    v_pk_fma_f32 v[92:93], v[32:33], v[84:85], v[92:93] op_sel:[1,0,0] op_sel_hi:[1,1,1]
    v_pk_fma_f32 v[94:95], v[32:33], v[86:87], v[94:95] op_sel:[1,0,0] op_sel_hi:[1,1,1]
    v_lshlrev_b32 v80, 16, v56
    v_and_b32 v81, 0xffff0000, v56
    v_lshlrev_b32 v82, 16, v57
    v_and_b32 v83, 0xffff0000, v57
    v_lshlrev_b32 v84, 16, v58
    v_and_b32 v85, 0xffff0000, v58
    v_lshlrev_b32 v86, 16, v59
    v_and_b32 v87, 0xffff0000, v59
    v_pk_fma_f32 v[88:89], v[34:35], v[80:81], v[88:89] op_sel:[0,0,0] op_sel_hi:[0,1,1]
    v_pk_fma_f32 v[90:91], v[34:35], v[82:83], v[90:91] op_sel:[0,0,0] op_sel_hi:[0,1,1]
    v_pk_fma_f32 v[92:93], v[34:35], v[84:85], v[92:93] op_sel:[0,0,0] op_sel_hi:[0,1,1]
    v_pk_fma_f32 v[94:95], v[34:35], v[86:87], v[94:95] op_sel:[0,0,0] op_sel_hi:[0,1,1]
    v_lshlrev_b32 v80, 16, v60
    v_and_b32 v81, 0xffff0000, v60
    v_lshlrev_b32 v82, 16, v61
    v_and_b32 v83, 0xffff0000, v61
    v_lshlrev_b32 v84, 16, v62
    v_and_b32 v85, 0xffff0000, v62
    v_lshlrev_b32 v86, 16, v63
    v_and_b32 v87, 0xffff0000, v63
    v_pk_fma_f32 v[88:89], v[34:35], v[80:81], v[88:89] op_sel:[1,0,0] op_sel_hi:[1,1,1]
    v_pk_fma_f32 v[90:91], v[34:35], v[82:83], v[90:91] op_sel:[1,0,0] op_sel_hi:[1,1,1]
    v_pk_fma_f32 v[92:93], v[34:35], v[84:85], v[92:93] op_sel:[1,0,0] op_sel_hi:[1,1,1]
    v_pk_fma_f32 v[94:95], v[34:35], v[86:87], v[94:95] op_sel:[1,0,0] op_sel_hi:[1,1,1]
    v_lshlrev_b32 v80, 16, v64
    v_and_b32 v81, 0xffff0000, v64
    v_lshlrev_b32 v82, 16, v65
    v_and_b32 v83, 0xffff0000, v65
    v_lshlrev_b32 v84, 16, v66
    v_and_b32 v85, 0xffff0000, v66
    v_lshlrev_b32 v86, 16, v67
    v_and_b32 v87, 0xffff0000, v67
    v_pk_fma_f32 v[88:89], v[36:37], v[80:81], v[88:89] op_sel:[0,0,0] op_sel_hi:[0,1,1]
    v_pk_fma_f32 v[90:91], v[36:37], v[82:83], v[90:91] op_sel:[0,0,0] op_sel_hi:[0,1,1]
    v_pk_fma_f32 v[92:93], v[36:37], v[84:85], v[92:93] op_sel:[0,0,0] op_sel_hi:[0,1,1]
    v_pk_fma_f32 v[94:95], v[36:37], v[86:87], v[94:95] op_sel:[0,0,0] op_sel_hi:[0,1,1]
    v_lshlrev_b32 v80, 16, v68
    v_and_b32 v81, 0xffff0000, v68
    v_lshlrev_b32 v82, 16, v69
    v_and_b32 v83, 0xffff0000, v69
    v_lshlrev_b32 v84, 16, v70
    v_and_b32 v85, 0xffff0000, v70
    v_lshlrev_b32 v86, 16, v71
    v_and_b32 v87, 0xffff0000, v71
    v_pk_fma_f32 v[88:89], v[36:37], v[80:81], v[88:89] op_sel:[1,0,0] op_sel_hi:[1,1,1]
    v_pk_fma_f32 v[90:91], v[36:37], v[82:83], v[90:91] op_sel:[1,0,0] op_sel_hi:[1,1,1]
    v_pk_fma_f32 v[92:93], v[36:37], v[84:85], v[92:93] op_sel:[1,0,0] op_sel_hi:[1,1,1]
    v_pk_fma_f32 v[94:95], v[36:37], v[86:87], v[94:95] op_sel:[1,0,0] op_sel_hi:[1,1,1]
    v_lshlrev_b32 v80, 16, v72
    v_and_b32 v81, 0xffff0000, v72
    v_lshlrev_b32 v82, 16, v73
    v_and_b32 v83, 0xffff0000, v73
    v_lshlrev_b32 v84, 16, v74
    v_and_b32 v85, 0xffff0000, v74
    v_lshlrev_b32 v86, 16, v75
    v_and_b32 v87, 0xffff0000, v75
    v_pk_fma_f32 v[88:89], v[38:39], v[80:81], v[88:89] op_sel:[0,0,0] op_sel_hi:[0,1,1]
    v_pk_fma_f32 v[90:91], v[38:39], v[82:83], v[90:91] op_sel:[0,0,0] op_sel_hi:[0,1,1]
    v_pk_fma_f32 v[92:93], v[38:39], v[84:85], v[92:93] op_sel:[0,0,0] op_sel_hi:[0,1,1]
    v_pk_fma_f32 v[94:95], v[38:39], v[86:87], v[94:95] op_sel:[0,0,0] op_sel_hi:[0,1,1]
    v_lshlrev_b32 v80, 16, v76
    v_and_b32 v81, 0xffff0000, v76
    v_lshlrev_b32 v82, 16, v77
    v_and_b32 v83, 0xffff0000, v77
    v_lshlrev_b32 v84, 16, v78
    v_and_b32 v85, 0xffff0000, v78
    v_lshlrev_b32 v86, 16, v79
    v_and_b32 v87, 0xffff0000, v79
    v_pk_fma_f32 v[88:89], v[38:39], v[80:81], v[88:89] op_sel:[1,0,0] op_sel_hi:[1,1,1]
    v_pk_fma_f32 v[90:91], v[38:39], v[82:83], v[90:91] op_sel:[1,0,0] op_sel_hi:[1,1,1]
    v_pk_fma_f32 v[92:93], v[38:39], v[84:85], v[92:93] op_sel:[1,0,0] op_sel_hi:[1,1,1]
    v_pk_fma_f32 v[94:95], v[38:39], v[86:87], v[94:95] op_sel:[1,0,0] op_sel_hi:[1,1,1]
    s_nop 0
    v_permlane32_swap_b32 v88, v92
    v_permlane32_swap_b32 v89, v93
    v_permlane32_swap_b32 v90, v94
    v_permlane32_swap_b32 v91, v95
    v_add_f32 v88, v88, v92
    v_add_f32 v89, v89, v93
    v_add_f32 v90, v90, v94
    v_add_f32 v91, v91, v95
    s_nop 0
    v_permlane16_swap_b32 v88, v90
    v_permlane16_swap_b32 v89, v91
    v_add_f32 v88, v88, v90
    v_add_f32 v89, v89, v91
    v_and_b32 v81, 7, v1
    v_lshrrev_b32 v82, 3, v1
    v_add_f32_dpp v80, v88, v88 row_ror:8 row_mask:0xf bank_mask:0x3
    s_nop 1
    v_add_f32_dpp v80, v89, v89 row_ror:8 row_mask:0xf bank_mask:0xc
    v_lshl_add_u32 v81, v81, 3, v82
    s_lshl_b32 s7, s3, 8
    s_add_u32 s7, s7, 124928
    v_lshl_add_u32 v81, v81, 2, s7
    ds_write_b32 v81, v80
    s_waitcnt lgkmcnt(0)
    s_barrier
    v_lshlrev_b32 v81, 2, v1
    v_add_u32 v82, 124928, v81
    ds_read_b32 v88, v82 offset:0
    ds_read_b32 v89, v82 offset:256
    ds_read_b32 v90, v82 offset:512
    ds_read_b32 v91, v82 offset:768
    v_add_u32 v81, s44, v81
    s_waitcnt lgkmcnt(2)
    v_add_f32 v88, v88, v89
    s_waitcnt lgkmcnt(0)
    v_add_f32 v90, v90, v91
    v_add_f32 v88, v88, v90
    v_min_u32 v88, -2, v88
    s_cmp_lg_u32 s3, 0
    s_cbranch_scc1 Lmod_skip_s3
    global_store_dword v81, v88, s[38:39] offset:0 sc1
Lmod_skip_s3:
Lsp_c:
    s_mov_b32 s51, 102400
Lsp_d:
    s_mov_b32 s93, s51
    s_waitcnt lgkmcnt(0)
    s_barrier
    s_lshr_b32 s5, s3, 1
    s_lshl_b32 s5, s5, 5
    s_and_b32 s6, s3, 1
    s_lshl_b32 s6, s6, 2
    s_add_u32 s6, s6, s5
    s_lshl_b32 s5, s40, 6
    s_add_u32 s90, s6, s5
    v_add_lshl_u32 v27, v5, s90, 1
    global_load_ushort v27, v27, s[26:27]
    s_and_b32 s4, s41, 3
    s_cmp_eq_u32 s4, 0
    s_cselect_b32 s5, 8, 0
    s_cmp_le_u32 s4, 1
    s_cselect_b32 s6, 16, 8
    s_cmp_eq_u32 s4, 3
    s_cselect_b32 s50, 16, 24
    s_lshl_b32 s44, s4, 3
    s_bitcmp1_b32 s43, 0
    s_cselect_b32 s46, s6, s5
    s_cselect_b32 s48, s5, s6
    s_lshl_b32 s5, s3, 1
    s_add_u32 s44, s44, s5
    s_add_u32 s45, s44, 1
    s_add_u32 s46, s46, s5
    s_add_u32 s47, s46, 1
    s_add_u32 s48, s48, s5
    s_add_u32 s49, s48, 1
    s_add_u32 s50, s50, s5
    s_add_u32 s51, s50, 1
    s_lshl_b32 s5, s40, 18
    s_lshl_b32 s6, s44, 7
    s_add_u32 s6, s6, s5
    s_add_u32 s68, s24, s6
    s_addc_u32 s69, s25, 0
    s_lshl_b32 s6, s45, 7
    s_add_u32 s6, s6, s5
    s_add_u32 s70, s24, s6
    s_addc_u32 s71, s25, 0
    s_lshl_b32 s6, s46, 7
    s_add_u32 s6, s6, s5
    s_add_u32 s72, s24, s6
    s_addc_u32 s73, s25, 0
    s_lshl_b32 s6, s47, 7
    s_add_u32 s6, s6, s5
    s_add_u32 s74, s24, s6
    s_addc_u32 s75, s25, 0
    s_lshl_b32 s6, s48, 7
    s_add_u32 s6, s6, s5
    s_add_u32 s76, s24, s6
    s_addc_u32 s77, s25, 0
    s_lshl_b32 s6, s49, 7
    s_add_u32 s6, s6, s5
    s_add_u32 s78, s24, s6
    s_addc_u32 s79, s25, 0
    s_lshl_b32 s6, s50, 7
    s_add_u32 s6, s6, s5
    s_add_u32 s80, s24, s6
    s_addc_u32 s81, s25, 0
    s_lshl_b32 s6, s51, 7
    s_add_u32 s6, s6, s5
    s_add_u32 s82, s24, s6
    s_addc_u32 s83, s25, 0
    s_lshl_b32 s89, s3, 14
    s_add_u32 s89, s89, 83200
    v_lshrrev_b32 v28, 3, v1
    v_lshlrev_b32 v28, 12, v28
    v_bfe_u32 v29, v1, 4, 1
    v_xor_b32 v29, v29, v1
    v_and_b32 v29, 7, v29
    v_xor_b32 v64, 0, v29
    v_lshl_add_u32 v64, v64, 4, v28
    v_add_u32 v68, 131072, v64
    v_xor_b32 v65, 2, v29
    v_lshl_add_u32 v65, v65, 4, v28
    v_add_u32 v65, 31744, v65
    v_add_u32 v69, 131072, v65
    v_xor_b32 v66, 4, v29
    v_lshl_add_u32 v66, v66, 4, v28
    v_add_u32 v66, 63488, v66
    v_add_u32 v70, 131072, v66
    v_xor_b32 v67, 6, v29
    v_lshl_add_u32 v67, v67, 4, v28
    v_add_u32 v67, 95232, v67
    v_add_u32 v71, 131072, v67
    s_and_b32 s4, s41, 1
    s_lshl_b32 s5, s3, 1
    s_add_u32 s5, s5, s4
    s_cmp_eq_u32 s5, 7
    s_cselect_b32 s5, 0, s5
    s_mul_i32 s96, s41, 7
    s_add_u32 s96, s96, s5
    s_cmp_lt_u32 s96, 54
    s_cselect_b32 s101, 2, 0
    s_min_u32 s96, s96, 53
    s_cmp_eq_u32 s3, 3
    s_cselect_b32 s101, 1, s101
    s_lshr_b32 s97, s101, 1
    s_cselect_b32 s5, -1, 0
    v_and_b32 v7, s5, v4
    s_add_u32 s97, s97, s96
    s_mul_i32 s4, s96, 20480
    s_add_u32 s5, s4, 7344128
    s_add_u32 s8, s38, s5
    s_addc_u32 s9, s39, 0
    s_add_u32 s5, s4, 7352320
    s_add_u32 s10, s38, s5
    s_addc_u32 s11, s39, 0
    s_add_u32 s5, s4, 7360512
    s_add_u32 s12, s38, s5
    s_addc_u32 s13, s39, 0
    s_mul_i32 s4, s97, 20480
    s_add_u32 s5, s4, 7344128
    s_add_u32 s14, s38, s5
    s_addc_u32 s15, s39, 0
    s_add_u32 s5, s4, 7352320
    s_add_u32 s16, s38, s5
    s_addc_u32 s17, s39, 0
    s_add_u32 s5, s4, 7360512
    s_add_u32 s18, s38, s5
    s_addc_u32 s19, s39, 0
    v_bfe_u32 v34, v1, 3, 1
    s_sub_u32 s4, s97, s96
    v_mul_u32_u24 v34, s4, v34
    v_add_lshl_u32 v34, v34, s96, 7
    v_mul_u32_u24 v29, 7168, v3
    v_add_u32 v34, v34, v29
    v_and_b32 v29, 112, v4
    v_add_u32 v34, v34, v29
    v_add_u32 v34, 49152, v34
    v_and_b32 v28, 1, v3
    v_mul_u32_u24 v28, 7168, v28
    v_sub_u32 v28, v34, v28
    s_branch Lsp_f
Lsp:
    s_sleep 16
Lsp_f:
    global_load_dword v40, v28, s[38:39] sc1
    s_waitcnt vmcnt(0)
    v_cmp_eq_u32 vcc, -1, v40
    s_add_u32 s100, s100, 1
    s_cmp_ge_u32 s100, 262144
    s_cbranch_scc1 Lsp_x
    s_cbranch_vccnz Lsp
Lsp_x:
    s_barrier
    s_cmp_eq_u32 s93, 102400
    s_cbranch_scc1 Lsd_none
    v_mov_b32 v31, s93
    s_cmp_lg_u32 s3, 0
    s_cbranch_scc1 Lsd_skip
    global_store_dword v31, v31, s[38:39] sc1
Lsd_skip:
Lsd_none:
    global_load_dwordx4 a[248:251], v4, s[12:13] offset:-1024 sc1
    global_load_dwordx4 a[252:255], v7, s[18:19] offset:-1024 sc1
    global_load_dwordx4 a[240:243], v4, s[12:13] offset:-2048 sc1
    global_load_dwordx4 a[244:247], v7, s[18:19] offset:-2048 sc1
    global_load_dwordx4 a[232:235], v4, s[12:13] offset:-3072 sc1
    global_load_dwordx4 a[236:239], v7, s[18:19] offset:-3072 sc1
    global_load_dwordx4 a[224:227], v4, s[12:13] offset:-4096 sc1
    global_load_dwordx4 a[228:231], v7, s[18:19] offset:-4096 sc1
    global_load_dwordx4 a[216:219], v4, s[10:11] offset:3072 sc1
    global_load_dwordx4 a[220:223], v7, s[16:17] offset:3072 sc1
    global_load_dwordx4 a[208:211], v4, s[10:11] offset:2048 sc1
    global_load_dwordx4 a[212:215], v7, s[16:17] offset:2048 sc1
    global_load_dwordx4 a[200:203], v4, s[10:11] offset:1024 sc1
    global_load_dwordx4 a[204:207], v7, s[16:17] offset:1024 sc1
    global_load_dwordx4 a[192:195], v4, s[10:11] offset:0 sc1
    global_load_dwordx4 a[196:199], v7, s[16:17] offset:0 sc1
    global_load_dwordx4 a[184:187], v4, s[10:11] offset:-1024 sc1
    global_load_dwordx4 a[188:191], v7, s[16:17] offset:-1024 sc1
    global_load_dwordx4 a[176:179], v4, s[10:11] offset:-2048 sc1
    global_load_dwordx4 a[180:183], v7, s[16:17] offset:-2048 sc1
    global_load_dwordx4 a[168:171], v4, s[10:11] offset:-3072 sc1
    global_load_dwordx4 a[172:175], v7, s[16:17] offset:-3072 sc1
    global_load_dwordx4 a[160:163], v4, s[10:11] offset:-4096 sc1
    global_load_dwordx4 a[164:167], v7, s[16:17] offset:-4096 sc1
    global_load_dwordx4 a[152:155], v4, s[8:9] offset:3072 sc1
    global_load_dwordx4 a[156:159], v7, s[14:15] offset:3072 sc1
    global_load_dwordx4 a[144:147], v4, s[8:9] offset:2048 sc1
    global_load_dwordx4 a[148:151], v7, s[14:15] offset:2048 sc1
    global_load_dwordx4 a[136:139], v4, s[8:9] offset:1024 sc1
    global_load_dwordx4 a[140:143], v7, s[14:15] offset:1024 sc1
    global_load_dwordx4 a[128:131], v4, s[8:9] offset:0 sc1
    global_load_dwordx4 a[132:135], v7, s[14:15] offset:0 sc1
    s_add_u32 m0, s89, 0
    s_nop 0
    global_load_lds_dwordx4 v64, s[68:69] offset:0
    global_load_lds_dwordx4 v65, s[68:69] offset:1024
    global_load_lds_dwordx4 v66, s[68:69] offset:2048
    global_load_lds_dwordx4 v67, s[68:69] offset:3072
    s_add_u32 m0, s89, 4096
    s_nop 0
    global_load_lds_dwordx4 v68, s[68:69] offset:0
    global_load_lds_dwordx4 v69, s[68:69] offset:1024
    global_load_lds_dwordx4 v70, s[68:69] offset:2048
    global_load_lds_dwordx4 v71, s[68:69] offset:3072
    s_lshl_b32 s4, s40, 9
    s_add_u32 s4, s4, 32772
    v_lshl_add_u32 v30, v1, 3, s4
    s_branch Lsu_f
Lsu:
    s_sleep 16
Lsu_f:
    global_load_dwordx4 v[40:43], v34, s[38:39] sc1
    global_load_dword v44, v30, s[38:39] sc1
    s_waitcnt vmcnt(0)
    v_max3_u32 v29, v40, v41, v42
    v_max3_u32 v29, v43, v44, v29
    v_cmp_eq_u32 vcc, -1, v29
    s_add_u32 s100, s100, 1
    s_cmp_ge_u32 s100, 262144
    s_cbranch_scc1 Lsu_x
    s_cbranch_vccnz Lsu
Lsu_x:
    v_permlane32_swap_b32 v40, v42
    v_permlane32_swap_b32 v41, v43
    s_lshl_b32 s4, s3, 9
    s_add_u32 s4, s4, 156672
    v_and_b32 v34, 496, v4
    v_add_f32 v40, v40, v42
    v_add_f32 v41, v41, v43
    v_bfe_u32 v42, v1, 3, 1
    v_cmp_gt_u32 vcc, s101, v42
    v_lshrrev_b32 v42, 5, v1
    v_lshl_add_u32 v34, v42, 3, v34
    v_cndmask_b32 v40, 0, v40, vcc
    v_cndmask_b32 v41, 0, v41, vcc
    v_add_u32 v34, s4, v34
    ds_write_b64 v34, v[40:41]
    s_barrier
    s_branch Ljoin
Lic_r:
    s_branch Lic_p_f
Lic_p:
    s_sleep 4
Lic_p_f:
    global_load_dword v213, v212, s[36:37] sc1
    s_waitcnt vmcnt(0)
    v_cmp_eq_u32 vcc, 0, v213
    s_add_u32 s100, s100, 1
    s_cmp_ge_u32 s100, 262144
    s_cbranch_scc1 Lic_p_x
    s_cbranch_vccnz Lic_p
Lic_p_x:
    s_branch Lic_ok
Lic2_r:
    s_branch Lic2_p_f
Lic2_p:
    s_sleep 4
Lic2_p_f:
    global_load_dword v42, v41, s[36:37] sc1
    s_waitcnt vmcnt(0)
    v_cmp_eq_u32 vcc, 0, v42
    s_add_u32 s100, s100, 1
    s_cmp_ge_u32 s100, 262144
    s_cbranch_scc1 Lic2_p_x
    s_cbranch_vccnz Lic2_p
Lic2_p_x:
    s_branch Lic2_ok
Lkf_r:
    s_nop 7
Lkf_p:
    global_load_dword v137, v136, s[38:39] sc1
    s_waitcnt vmcnt(0)
    v_cmp_eq_u32 vcc, -1, v137
    s_add_u32 s100, s100, 1
    s_cmp_ge_u32 s100, 262144
    s_cbranch_scc1 Lkf_p_x
    s_cbranch_vccnz Lkf_p
Lkf_p_x:
    s_nop 1
    s_branch Lkf_ok
Lcu_r:
    s_nop 7
Lcu_p:
    global_load_dword v222, v137, s[38:39] sc1
    s_waitcnt vmcnt(0)
    v_cmp_eq_u32 vcc, -1, v222
    s_add_u32 s100, s100, 1
    s_cmp_ge_u32 s100, 262144
    s_cbranch_scc1 Lcu_p_x
    s_cbranch_vccnz Lcu_p
Lcu_p_x:
    s_nop 1
    s_branch Lcu_ok
Lax_r:
    s_nop 7
Lax_p:
    v_lshlrev_b32 v28, 4, v0
    v_add_u32 v28, 36864, v28
    global_load_dwordx4 v[202:205], v28, s[38:39] offset:-4096 sc1
    global_load_dwordx4 v[206:209], v28, s[38:39] offset:0 sc1
    v_add_u32 v28, 8192, v28
    global_load_dwordx4 v[210:213], v28, s[38:39] offset:-4096 sc1
    global_load_dwordx4 v[214:217], v28, s[38:39] offset:0 sc1
    v_min_u32 v28, 11, v1
    v_lshrrev_b32 v29, 2, v28
    v_mul_u32_u24 v29, 2544, v29
    v_lshl_add_u32 v28, v28, 2, v29
    s_lshl_b32 s4, s42, 4
    s_add_u32 s4, s4, 0
    v_add_u32 v28, s4, v28
    global_load_dword v182, v28, s[38:39] sc1
    v_add_u32 v28, 15360, v28
    global_load_dword v183, v28, s[38:39] sc1
    s_waitcnt vmcnt(0)
    v_max_u32 v224, v203, v205
    v_max3_u32 v224, v207, v209, v224
    v_max3_u32 v224, v211, v213, v224
    v_max3_u32 v224, v215, v217, v224
    v_max3_u32 v224, v182, v183, v224
    v_cmp_eq_u32 vcc, -1, v224
    s_add_u32 s100, s100, 1
    s_cmp_ge_u32 s100, 262144
    s_cbranch_scc1 Lax_p_x
    s_cbranch_vccnz Lax_p
Lax_p_x:
    s_nop 1
    s_branch Lax_ok
Lcv_r:
    s_nop 7
Lcv_p:
    global_load_dwordx4 v[218:221], v223, s[38:39] sc1
    s_waitcnt vmcnt(0)
    v_max_u32 v224, v218, v219
    v_max3_u32 v224, v220, v221, v224
    v_cmp_eq_u32 vcc, -1, v224
    s_add_u32 s100, s100, 1
    s_cmp_ge_u32 s100, 262144
    s_cbranch_scc1 Lcv_p_x
    s_cbranch_vccnz Lcv_p
Lcv_p_x:
    s_nop 1
    s_branch Lcv_ok
Lgb_r:
    s_nop 7
Lgb_p:
    v_min_u32 v175, 26, v1
    v_lshlrev_b32 v175, 7, v175
    v_add_u32 v175, 98304, v175
    global_load_dword v250, v175, s[38:39] sc1
    s_mul_i32 s7, s41, 320
    s_add_u32 s7, s7, 12800
    v_min_u32 v175, 304, v4
    v_add_u32 v175, s7, v175
    global_load_dwordx4 v[242:245], v175, s[38:39] sc1
    v_add_u32 v175, 15360, v175
    global_load_dwordx4 v[246:249], v175, s[38:39] sc1
    s_waitcnt vmcnt(0)
    v_max3_u32 v28, v242, v243, v244
    v_max3_u32 v28, v245, v246, v28
    v_max3_u32 v28, v247, v248, v28
    v_max3_u32 v28, v249, v250, v28
    v_cmp_eq_u32 vcc, -1, v28
    s_add_u32 s100, s100, 1
    s_cmp_ge_u32 s100, 262144
    s_cbranch_scc1 Lgb_p_x
    s_cbranch_vccnz Lgb_p
Lgb_p_x:
    s_nop 1
    s_branch Lgb_ok
Ls3_r:
    s_nop 7
Ls3_p:
    global_load_dwordx2 v[130:131], v174, s[38:39] offset:0 sc1
    global_load_dwordx2 v[132:133], v174, s[38:39] offset:512 sc1
    global_load_dwordx2 v[134:135], v174, s[38:39] offset:1024 sc1
    global_load_dwordx2 v[136:137], v174, s[38:39] offset:1536 sc1
    global_load_dwordx2 v[138:139], v174, s[38:39] offset:2048 sc1
    global_load_dwordx2 v[140:141], v174, s[38:39] offset:2560 sc1
    global_load_dwordx2 v[142:143], v174, s[38:39] offset:3072 sc1
    global_load_dwordx2 v[144:145], v174, s[38:39] offset:3584 sc1
    s_waitcnt vmcnt(0)
    v_max_u32 v28, v131, v133
    v_max3_u32 v28, v135, v137, v28
    v_max3_u32 v28, v139, v141, v28
    v_max3_u32 v28, v143, v145, v28
    v_cmp_eq_u32 vcc, -1, v28
    s_add_u32 s100, s100, 1
    s_cmp_ge_u32 s100, 262144
    s_cbranch_scc1 Ls3_p_x
    s_cbranch_vccnz Ls3_p
Ls3_p_x:
    s_nop 1
    s_branch Ls3_ok
Lz0_r:
    s_nop 7
Lz0_p:
    global_load_dwordx4 v[62:65], v30, s[56:57] offset:-3072 sc1
    global_load_dwordx4 v[66:69], v30, s[56:57] offset:-2048 sc1
    global_load_dwordx4 v[70:73], v30, s[56:57] offset:-1024 sc1
    global_load_dwordx4 v[74:77], v30, s[56:57] offset:0 sc1
    global_load_dwordx4 v[78:81], v30, s[56:57] offset:1024 sc1
    global_load_dwordx4 v[82:85], v30, s[56:57] offset:2048 sc1
    global_load_dwordx4 v[86:89], v30, s[56:57] offset:3072 sc1
    global_load_dwordx4 v[90:93], v31, s[56:57] offset:-3072 sc1
    global_load_dwordx4 v[94:97], v31, s[56:57] offset:-2048 sc1
    global_load_dwordx4 v[98:101], v31, s[56:57] offset:-1024 sc1
    global_load_dwordx4 v[102:105], v31, s[56:57] offset:0 sc1
    global_load_dwordx4 v[106:109], v31, s[56:57] offset:1024 sc1
    global_load_dwordx4 v[110:113], v31, s[56:57] offset:2048 sc1
    global_load_dwordx4 v[114:117], v31, s[56:57] offset:3072 sc1
    global_load_dwordx4 v[118:121], v30, s[58:59] offset:-3072 sc1
    global_load_dwordx4 v[122:125], v30, s[58:59] offset:-2048 sc1
    s_waitcnt vmcnt(0)
    v_and_b32 v28, v65, v69
    v_bitop3_b32 v28, v73, v77, v28 bitop3:0x80
    v_and_b32 v28, 1, v28
    v_cmp_ne_u32 vcc, 1, v28
    s_add_u32 s100, s100, 1
    s_cmp_ge_u32 s100, 262144
    s_cbranch_scc1 Lz0_p_x
    s_cbranch_vccnz Lz0_p
Lz0_p_x:
    s_nop 1
    s_branch Lz0_ok
Lz1_r:
    s_nop 7
Lz1_p:
    global_load_dwordx4 v[78:81], v30, s[56:57] offset:1024 sc1
    global_load_dwordx4 v[82:85], v30, s[56:57] offset:2048 sc1
    global_load_dwordx4 v[86:89], v30, s[56:57] offset:3072 sc1
    global_load_dwordx4 v[90:93], v31, s[56:57] offset:-3072 sc1
    s_waitcnt vmcnt(0)
    v_and_b32 v28, v81, v85
    v_bitop3_b32 v28, v89, v93, v28 bitop3:0x80
    v_and_b32 v28, 1, v28
    v_cmp_ne_u32 vcc, 1, v28
    s_add_u32 s100, s100, 1
    s_cmp_ge_u32 s100, 262144
    s_cbranch_scc1 Lz1_p_x
    s_cbranch_vccnz Lz1_p
Lz1_p_x:
    s_nop 1
    s_branch Lz1_ok
Lz2_r:
    s_nop 7
Lz2_p:
    global_load_dwordx4 v[94:97], v31, s[56:57] offset:-2048 sc1
    global_load_dwordx4 v[98:101], v31, s[56:57] offset:-1024 sc1
    global_load_dwordx4 v[102:105], v31, s[56:57] offset:0 sc1
    global_load_dwordx4 v[106:109], v31, s[56:57] offset:1024 sc1
    s_waitcnt vmcnt(0)
    v_and_b32 v28, v97, v101
    v_bitop3_b32 v28, v105, v109, v28 bitop3:0x80
    v_and_b32 v28, 1, v28
    v_cmp_ne_u32 vcc, 1, v28
    s_add_u32 s100, s100, 1
    s_cmp_ge_u32 s100, 262144
    s_cbranch_scc1 Lz2_p_x
    s_cbranch_vccnz Lz2_p
Lz2_p_x:
    s_nop 1
    s_branch Lz2_ok
Lz3_r:
    s_nop 7
Lz3_p:
    global_load_dwordx4 v[110:113], v31, s[56:57] offset:2048 sc1
    global_load_dwordx4 v[114:117], v31, s[56:57] offset:3072 sc1
    global_load_dwordx4 v[118:121], v30, s[58:59] offset:-3072 sc1
    global_load_dwordx4 v[122:125], v30, s[58:59] offset:-2048 sc1
    s_waitcnt vmcnt(0)
    v_and_b32 v28, v113, v117
    v_bitop3_b32 v28, v121, v125, v28 bitop3:0x80
    v_and_b32 v28, 1, v28
    v_cmp_ne_u32 vcc, 1, v28
    s_add_u32 s100, s100, 1
    s_cmp_ge_u32 s100, 262144
    s_cbranch_scc1 Lz3_p_x
    s_cbranch_vccnz Lz3_p
Lz3_p_x:
    s_nop 1
    s_branch Lz3_ok
Lz4_r:
    s_nop 7
Lz4_p:
    global_load_dwordx4 v[126:129], v30, s[58:59] offset:-1024 sc1
    global_load_dwordx4 v[130:133], v30, s[58:59] offset:0 sc1
    global_load_dwordx4 v[134:137], v30, s[58:59] offset:1024 sc1
    global_load_dwordx4 v[138:141], v30, s[58:59] offset:2048 sc1
    s_waitcnt vmcnt(0)
    v_and_b32 v28, v129, v133
    v_bitop3_b32 v28, v137, v141, v28 bitop3:0x80
    v_and_b32 v28, 1, v28
    v_cmp_ne_u32 vcc, 1, v28
    s_add_u32 s100, s100, 1
    s_cmp_ge_u32 s100, 262144
    s_cbranch_scc1 Lz4_p_x
    s_cbranch_vccnz Lz4_p
Lz4_p_x:
    s_nop 1
    s_branch Lz4_ok
Lz5_r:
    s_nop 7
Lz5_p:
    global_load_dwordx4 v[62:65], v30, s[58:59] offset:3072 sc1
    global_load_dwordx4 v[66:69], v31, s[58:59] offset:-3072 sc1
    global_load_dwordx4 v[70:73], v31, s[58:59] offset:-2048 sc1
    global_load_dwordx4 v[74:77], v31, s[58:59] offset:-1024 sc1
    s_waitcnt vmcnt(0)
    v_and_b32 v28, v65, v69
    v_bitop3_b32 v28, v73, v77, v28 bitop3:0x80
    v_and_b32 v28, 1, v28
    v_cmp_ne_u32 vcc, 1, v28
    s_add_u32 s100, s100, 1
    s_cmp_ge_u32 s100, 262144
    s_cbranch_scc1 Lz5_p_x
    s_cbranch_vccnz Lz5_p
Lz5_p_x:
    s_nop 1
    s_branch Lz5_ok
Lz6_r:
    s_nop 7
Lz6_p:
    global_load_dwordx4 v[78:81], v31, s[58:59] offset:0 sc1
    global_load_dwordx4 v[82:85], v31, s[58:59] offset:1024 sc1
    global_load_dwordx4 v[86:89], v31, s[58:59] offset:2048 sc1
    global_load_dwordx4 v[90:93], v31, s[58:59] offset:3072 sc1
    s_waitcnt vmcnt(0)
    v_and_b32 v28, v81, v85
    v_bitop3_b32 v28, v89, v93, v28 bitop3:0x80
    v_and_b32 v28, 1, v28
    v_cmp_ne_u32 vcc, 1, v28
    s_add_u32 s100, s100, 1
    s_cmp_ge_u32 s100, 262144
    s_cbranch_scc1 Lz6_p_x
    s_cbranch_vccnz Lz6_p
Lz6_p_x:
    s_nop 1
    s_branch Lz6_ok
Lz7_r:
    s_nop 7
Lz7_p:
    global_load_dwordx4 v[94:97], v30, s[60:61] offset:-3072 sc1
    global_load_dwordx4 v[98:101], v31, s[60:61] offset:-3072 sc1
    global_load_dwordx4 v[102:105], v30, s[62:63] offset:-3072 sc1
    global_load_dwordx4 v[106:109], v31, s[62:63] offset:-3072 sc1
    s_waitcnt vmcnt(0)
    v_and_b32 v28, v97, v101
    v_bitop3_b32 v28, v105, v109, v28 bitop3:0x80
    v_and_b32 v28, 1, v28
    v_cmp_ne_u32 vcc, 1, v28
    s_add_u32 s100, s100, 1
    s_cmp_ge_u32 s100, 262144
    s_cbranch_scc1 Lz7_p_x
    s_cbranch_vccnz Lz7_p
Lz7_p_x:
    s_nop 1
    s_branch Lz7_ok
Lz8_r:
    s_nop 7
Lz8_p:
    global_load_dwordx4 v[110:113], v30, s[52:53] offset:-3072 sc1
    global_load_dwordx4 v[114:117], v31, s[52:53] offset:-3072 sc1
    global_load_dwordx4 v[118:121], v30, s[54:55] offset:-3072 sc1
    global_load_dwordx4 v[122:125], v31, s[54:55] offset:-3072 sc1
    s_waitcnt vmcnt(0)
    v_and_b32 v28, v113, v117
    v_bitop3_b32 v28, v121, v125, v28 bitop3:0x80
    v_and_b32 v28, 1, v28
    v_cmp_ne_u32 vcc, 1, v28
    s_add_u32 s100, s100, 1
    s_cmp_ge_u32 s100, 262144
    s_cbranch_scc1 Lz8_p_x
    s_cbranch_vccnz Lz8_p
Lz8_p_x:
    s_nop 1
    s_branch Lz8_ok
Lz9_r:
    s_nop 7
Lz9_p:
    global_load_dwordx4 v[126:129], v30, s[64:65] offset:-3072 sc1
    global_load_dwordx4 v[130:133], v31, s[64:65] offset:-3072 sc1
    global_load_dwordx4 v[134:137], v30, s[66:67] offset:-3072 sc1
    global_load_dwordx4 v[138:141], v31, s[66:67] offset:-3072 sc1
    s_waitcnt vmcnt(0)
    v_and_b32 v28, v129, v133
    v_bitop3_b32 v28, v137, v141, v28 bitop3:0x80
    v_and_b32 v28, 1, v28
    v_cmp_ne_u32 vcc, 1, v28
    s_add_u32 s100, s100, 1
    s_cmp_ge_u32 s100, 262144
    s_cbranch_scc1 Lz9_p_x
    s_cbranch_vccnz Lz9_p
Lz9_p_x:
    s_nop 1
    s_branch Lz9_ok
Lz10_r:
    s_nop 7
Lz10_p:
    global_load_dwordx4 v[62:65], v30, s[60:61] offset:-2048 sc1
    global_load_dwordx4 v[66:69], v31, s[60:61] offset:-2048 sc1
    global_load_dwordx4 v[70:73], v30, s[62:63] offset:-2048 sc1
    global_load_dwordx4 v[74:77], v31, s[62:63] offset:-2048 sc1
    s_waitcnt vmcnt(0)
    v_and_b32 v28, v65, v69
    v_bitop3_b32 v28, v73, v77, v28 bitop3:0x80
    v_and_b32 v28, 1, v28
    v_cmp_ne_u32 vcc, 1, v28
    s_add_u32 s100, s100, 1
    s_cmp_ge_u32 s100, 262144
    s_cbranch_scc1 Lz10_p_x
    s_cbranch_vccnz Lz10_p
Lz10_p_x:
    s_nop 1
    s_branch Lz10_ok
Lz11_r:
    s_nop 7
Lz11_p:
    global_load_dwordx4 v[78:81], v30, s[52:53] offset:-2048 sc1
    global_load_dwordx4 v[82:85], v31, s[52:53] offset:-2048 sc1
    global_load_dwordx4 v[86:89], v30, s[54:55] offset:-2048 sc1
    global_load_dwordx4 v[90:93], v31, s[54:55] offset:-2048 sc1
    s_waitcnt vmcnt(0)
    v_and_b32 v28, v81, v85
    v_bitop3_b32 v28, v89, v93, v28 bitop3:0x80
    v_and_b32 v28, 1, v28
    v_cmp_ne_u32 vcc, 1, v28
    s_add_u32 s100, s100, 1
    s_cmp_ge_u32 s100, 262144
    s_cbranch_scc1 Lz11_p_x
    s_cbranch_vccnz Lz11_p
Lz11_p_x:
    s_nop 1
    s_branch Lz11_ok
Lz12_r:
    s_nop 7
Lz12_p:
    global_load_dwordx4 v[94:97], v30, s[64:65] offset:-2048 sc1
    global_load_dwordx4 v[98:101], v31, s[64:65] offset:-2048 sc1
    global_load_dwordx4 v[102:105], v30, s[66:67] offset:-2048 sc1
    global_load_dwordx4 v[106:109], v31, s[66:67] offset:-2048 sc1
    s_waitcnt vmcnt(0)
    v_and_b32 v28, v97, v101
    v_bitop3_b32 v28, v105, v109, v28 bitop3:0x80
    v_and_b32 v28, 1, v28
    v_cmp_ne_u32 vcc, 1, v28
    s_add_u32 s100, s100, 1
    s_cmp_ge_u32 s100, 262144
    s_cbranch_scc1 Lz12_p_x
    s_cbranch_vccnz Lz12_p
Lz12_p_x:
    s_nop 1
    s_branch Lz12_ok
Lz13_r:
    s_nop 7
Lz13_p:
    global_load_dwordx4 v[110:113], v30, s[60:61] offset:-1024 sc1
    global_load_dwordx4 v[114:117], v31, s[60:61] offset:-1024 sc1
    global_load_dwordx4 v[118:121], v30, s[62:63] offset:-1024 sc1
    global_load_dwordx4 v[122:125], v31, s[62:63] offset:-1024 sc1
    s_waitcnt vmcnt(0)
    v_and_b32 v28, v113, v117
    v_bitop3_b32 v28, v121, v125, v28 bitop3:0x80
    v_and_b32 v28, 1, v28
    v_cmp_ne_u32 vcc, 1, v28
    s_add_u32 s100, s100, 1
    s_cmp_ge_u32 s100, 262144
    s_cbranch_scc1 Lz13_p_x
    s_cbranch_vccnz Lz13_p
Lz13_p_x:
    s_nop 1
    s_branch Lz13_ok
Lz14_r:
    s_nop 7
Lz14_p:
    global_load_dwordx4 v[126:129], v30, s[52:53] offset:-1024 sc1
    global_load_dwordx4 v[130:133], v31, s[52:53] offset:-1024 sc1
    global_load_dwordx4 v[134:137], v30, s[54:55] offset:-1024 sc1
    global_load_dwordx4 v[138:141], v31, s[54:55] offset:-1024 sc1
    s_waitcnt vmcnt(0)
    v_and_b32 v28, v129, v133
    v_bitop3_b32 v28, v137, v141, v28 bitop3:0x80
    v_and_b32 v28, 1, v28
    v_cmp_ne_u32 vcc, 1, v28
    s_add_u32 s100, s100, 1
    s_cmp_ge_u32 s100, 262144
    s_cbranch_scc1 Lz14_p_x
    s_cbranch_vccnz Lz14_p
Lz14_p_x:
    s_nop 1
    s_branch Lz14_ok
Lz15_r:
    s_nop 7
Lz15_p:
    global_load_dwordx4 v[62:65], v30, s[64:65] offset:-1024 sc1
    global_load_dwordx4 v[66:69], v31, s[64:65] offset:-1024 sc1
    global_load_dwordx4 v[70:73], v30, s[66:67] offset:-1024 sc1
    global_load_dwordx4 v[74:77], v31, s[66:67] offset:-1024 sc1
    s_waitcnt vmcnt(0)
    v_and_b32 v28, v65, v69
    v_bitop3_b32 v28, v73, v77, v28 bitop3:0x80
    v_and_b32 v28, 1, v28
    v_cmp_ne_u32 vcc, 1, v28
    s_add_u32 s100, s100, 1
    s_cmp_ge_u32 s100, 262144
    s_cbranch_scc1 Lz15_p_x
    s_cbranch_vccnz Lz15_p
Lz15_p_x:
    s_nop 1
    s_branch Lz15_ok
Lz16_r:
    s_nop 7
Lz16_p:
    global_load_dwordx4 v[78:81], v30, s[60:61] offset:0 sc1
    global_load_dwordx4 v[82:85], v31, s[60:61] offset:0 sc1
    global_load_dwordx4 v[86:89], v30, s[62:63] offset:0 sc1
    global_load_dwordx4 v[90:93], v31, s[62:63] offset:0 sc1
    s_waitcnt vmcnt(0)
    v_and_b32 v28, v81, v85
    v_bitop3_b32 v28, v89, v93, v28 bitop3:0x80
    v_and_b32 v28, 1, v28
    v_cmp_ne_u32 vcc, 1, v28
    s_add_u32 s100, s100, 1
    s_cmp_ge_u32 s100, 262144
    s_cbranch_scc1 Lz16_p_x
    s_cbranch_vccnz Lz16_p
Lz16_p_x:
    s_nop 1
    s_branch Lz16_ok
Lz17_r:
    s_nop 7
Lz17_p:
    global_load_dwordx4 v[94:97], v30, s[52:53] offset:0 sc1
    global_load_dwordx4 v[98:101], v31, s[52:53] offset:0 sc1
    global_load_dwordx4 v[102:105], v30, s[54:55] offset:0 sc1
    global_load_dwordx4 v[106:109], v31, s[54:55] offset:0 sc1
    s_waitcnt vmcnt(0)
    v_and_b32 v28, v97, v101
    v_bitop3_b32 v28, v105, v109, v28 bitop3:0x80
    v_and_b32 v28, 1, v28
    v_cmp_ne_u32 vcc, 1, v28
    s_add_u32 s100, s100, 1
    s_cmp_ge_u32 s100, 262144
    s_cbranch_scc1 Lz17_p_x
    s_cbranch_vccnz Lz17_p
Lz17_p_x:
    s_nop 1
    s_branch Lz17_ok
Lz18_r:
    s_nop 7
Lz18_p:
    global_load_dwordx4 v[110:113], v30, s[64:65] offset:0 sc1
    global_load_dwordx4 v[114:117], v31, s[64:65] offset:0 sc1
    global_load_dwordx4 v[118:121], v30, s[66:67] offset:0 sc1
    global_load_dwordx4 v[122:125], v31, s[66:67] offset:0 sc1
    s_waitcnt vmcnt(0)
    v_and_b32 v28, v113, v117
    v_bitop3_b32 v28, v121, v125, v28 bitop3:0x80
    v_and_b32 v28, 1, v28
    v_cmp_ne_u32 vcc, 1, v28
    s_add_u32 s100, s100, 1
    s_cmp_ge_u32 s100, 262144
    s_cbranch_scc1 Lz18_p_x
    s_cbranch_vccnz Lz18_p
Lz18_p_x:
    s_nop 1
    s_branch Lz18_ok
Lz19_r:
    s_nop 7
Lz19_p:
    global_load_dwordx4 v[126:129], v30, s[60:61] offset:1024 sc1
    global_load_dwordx4 v[130:133], v31, s[60:61] offset:1024 sc1
    global_load_dwordx4 v[134:137], v30, s[62:63] offset:1024 sc1
    global_load_dwordx4 v[138:141], v31, s[62:63] offset:1024 sc1
    s_waitcnt vmcnt(0)
    v_and_b32 v28, v129, v133
    v_bitop3_b32 v28, v137, v141, v28 bitop3:0x80
    v_and_b32 v28, 1, v28
    v_cmp_ne_u32 vcc, 1, v28
    s_add_u32 s100, s100, 1
    s_cmp_ge_u32 s100, 262144
    s_cbranch_scc1 Lz19_p_x
    s_cbranch_vccnz Lz19_p
Lz19_p_x:
    s_nop 1
    s_branch Lz19_ok
Lz20_r:
    s_nop 7
Lz20_p:
    global_load_dwordx4 v[62:65], v30, s[52:53] offset:1024 sc1
    global_load_dwordx4 v[66:69], v31, s[52:53] offset:1024 sc1
    global_load_dwordx4 v[70:73], v30, s[54:55] offset:1024 sc1
    global_load_dwordx4 v[74:77], v31, s[54:55] offset:1024 sc1
    s_waitcnt vmcnt(0)
    v_and_b32 v28, v65, v69
    v_bitop3_b32 v28, v73, v77, v28 bitop3:0x80
    v_and_b32 v28, 1, v28
    v_cmp_ne_u32 vcc, 1, v28
    s_add_u32 s100, s100, 1
    s_cmp_ge_u32 s100, 262144
    s_cbranch_scc1 Lz20_p_x
    s_cbranch_vccnz Lz20_p
Lz20_p_x:
    s_nop 1
    s_branch Lz20_ok
Lz21_r:
    s_nop 7
Lz21_p:
    global_load_dwordx4 v[78:81], v30, s[64:65] offset:1024 sc1
    global_load_dwordx4 v[82:85], v31, s[64:65] offset:1024 sc1
    global_load_dwordx4 v[86:89], v30, s[66:67] offset:1024 sc1
    global_load_dwordx4 v[90:93], v31, s[66:67] offset:1024 sc1
    s_waitcnt vmcnt(0)
    v_and_b32 v28, v81, v85
    v_bitop3_b32 v28, v89, v93, v28 bitop3:0x80
    v_and_b32 v28, 1, v28
    v_cmp_ne_u32 vcc, 1, v28
    s_add_u32 s100, s100, 1
    s_cmp_ge_u32 s100, 262144
    s_cbranch_scc1 Lz21_p_x
    s_cbranch_vccnz Lz21_p
Lz21_p_x:
    s_nop 1
    s_branch Lz21_ok
Lz22_r:
    s_nop 7
Lz22_p:
    global_load_dwordx4 v[94:97], v30, s[60:61] offset:2048 sc1
    global_load_dwordx4 v[98:101], v31, s[60:61] offset:2048 sc1
    global_load_dwordx4 v[102:105], v30, s[62:63] offset:2048 sc1
    global_load_dwordx4 v[106:109], v31, s[62:63] offset:2048 sc1
    s_waitcnt vmcnt(0)
    v_and_b32 v28, v97, v101
    v_bitop3_b32 v28, v105, v109, v28 bitop3:0x80
    v_and_b32 v28, 1, v28
    v_cmp_ne_u32 vcc, 1, v28
    s_add_u32 s100, s100, 1
    s_cmp_ge_u32 s100, 262144
    s_cbranch_scc1 Lz22_p_x
    s_cbranch_vccnz Lz22_p
Lz22_p_x:
    s_nop 1
    s_branch Lz22_ok
Lz23_r:
    s_nop 7
Lz23_p:
    global_load_dwordx4 v[110:113], v30, s[52:53] offset:2048 sc1
    global_load_dwordx4 v[114:117], v31, s[52:53] offset:2048 sc1
    global_load_dwordx4 v[118:121], v30, s[54:55] offset:2048 sc1
    global_load_dwordx4 v[122:125], v31, s[54:55] offset:2048 sc1
    s_waitcnt vmcnt(0)
    v_and_b32 v28, v113, v117
    v_bitop3_b32 v28, v121, v125, v28 bitop3:0x80
    v_and_b32 v28, 1, v28
    v_cmp_ne_u32 vcc, 1, v28
    s_add_u32 s100, s100, 1
    s_cmp_ge_u32 s100, 262144
    s_cbranch_scc1 Lz23_p_x
    s_cbranch_vccnz Lz23_p
Lz23_p_x:
    s_nop 1
    s_branch Lz23_ok
Lz24_r:
    s_nop 7
Lz24_p:
    global_load_dwordx4 v[126:129], v30, s[64:65] offset:2048 sc1
    global_load_dwordx4 v[130:133], v31, s[64:65] offset:2048 sc1
    global_load_dwordx4 v[134:137], v30, s[66:67] offset:2048 sc1
    global_load_dwordx4 v[138:141], v31, s[66:67] offset:2048 sc1
    s_waitcnt vmcnt(0)
    v_and_b32 v28, v129, v133
    v_bitop3_b32 v28, v137, v141, v28 bitop3:0x80
    v_and_b32 v28, 1, v28
    v_cmp_ne_u32 vcc, 1, v28
    s_add_u32 s100, s100, 1
    s_cmp_ge_u32 s100, 262144
    s_cbranch_scc1 Lz24_p_x
    s_cbranch_vccnz Lz24_p
Lz24_p_x:
    s_nop 1
    s_branch Lz24_ok
Lz25_r:
    s_nop 7
Lz25_p:
    global_load_dwordx4 v[62:65], v30, s[60:61] offset:3072 sc1
    global_load_dwordx4 v[66:69], v31, s[60:61] offset:3072 sc1
    global_load_dwordx4 v[70:73], v30, s[62:63] offset:3072 sc1
    global_load_dwordx4 v[74:77], v31, s[62:63] offset:3072 sc1
    s_waitcnt vmcnt(0)
    v_and_b32 v28, v65, v69
    v_bitop3_b32 v28, v73, v77, v28 bitop3:0x80
    v_and_b32 v28, 1, v28
    v_cmp_ne_u32 vcc, 1, v28
    s_add_u32 s100, s100, 1
    s_cmp_ge_u32 s100, 262144
    s_cbranch_scc1 Lz25_p_x
    s_cbranch_vccnz Lz25_p
Lz25_p_x:
    s_nop 1
    s_branch Lz25_ok
Lz26_r:
    s_nop 7
Lz26_p:
    global_load_dwordx4 v[78:81], v30, s[52:53] offset:3072 sc1
    global_load_dwordx4 v[82:85], v31, s[52:53] offset:3072 sc1
    global_load_dwordx4 v[86:89], v30, s[54:55] offset:3072 sc1
    global_load_dwordx4 v[90:93], v31, s[54:55] offset:3072 sc1
    s_waitcnt vmcnt(0)
    v_and_b32 v28, v81, v85
    v_bitop3_b32 v28, v89, v93, v28 bitop3:0x80
    v_and_b32 v28, 1, v28
    v_cmp_ne_u32 vcc, 1, v28
    s_add_u32 s100, s100, 1
    s_cmp_ge_u32 s100, 262144
    s_cbranch_scc1 Lz26_p_x
    s_cbranch_vccnz Lz26_p
Lz26_p_x:
    s_nop 1
    s_branch Lz26_ok
Lz27_r:
    s_nop 7
Lz27_p:
    global_load_dwordx4 v[94:97], v30, s[64:65] offset:3072 sc1
    global_load_dwordx4 v[98:101], v31, s[64:65] offset:3072 sc1
    global_load_dwordx4 v[102:105], v30, s[66:67] offset:3072 sc1
    global_load_dwordx4 v[106:109], v31, s[66:67] offset:3072 sc1
    s_waitcnt vmcnt(0)
    v_and_b32 v28, v97, v101
    v_bitop3_b32 v28, v105, v109, v28 bitop3:0x80
    v_and_b32 v28, 1, v28
    v_cmp_ne_u32 vcc, 1, v28
    s_add_u32 s100, s100, 1
    s_cmp_ge_u32 s100, 262144
    s_cbranch_scc1 Lz27_p_x
    s_cbranch_vccnz Lz27_p
Lz27_p_x:
    s_nop 1
    s_branch Lz27_ok
Lp0_r:
    s_nop 7
Lp0_p:
    global_load_dwordx4 v[142:145], v6, s[38:39] offset:-4096 sc1
    global_load_dwordx4 v[146:149], v6, s[38:39] offset:-3072 sc1
    global_load_dwordx4 v[150:153], v6, s[38:39] offset:-2048 sc1
    global_load_dwordx4 v[154:157], v6, s[38:39] offset:-1024 sc1
    global_load_dwordx4 v[158:161], v6, s[38:39] offset:0 sc1
    global_load_dwordx4 v[162:165], v6, s[38:39] offset:1024 sc1
    global_load_dwordx4 v[166:169], v6, s[38:39] offset:2048 sc1
    global_load_dwordx4 v[170:173], v6, s[38:39] offset:3072 sc1
    s_waitcnt vmcnt(0)
    v_or_b32 v28, v145, v149
    v_or3_b32 v28, v153, v157, v28
    v_or3_b32 v28, v161, v165, v28
    v_or3_b32 v28, v169, v173, v28
    v_and_b32 v28, 1, v28
    v_cmp_ne_u32 vcc, 0, v28
    s_add_u32 s100, s100, 1
    s_cmp_ge_u32 s100, 262144
    s_cbranch_scc1 Lp0_p_x
    s_cbranch_vccnz Lp0_p
Lp0_p_x:
    s_nop 1
    s_branch Lp0_ok
Lp1_r:
    s_nop 7
Lp1_p:
    global_load_dwordx4 v[174:177], v7, s[38:39] offset:-4096 sc1
    global_load_dwordx4 v[178:181], v7, s[38:39] offset:-3072 sc1
    global_load_dwordx4 v[182:185], v7, s[38:39] offset:-2048 sc1
    global_load_dwordx4 v[186:189], v7, s[38:39] offset:-1024 sc1
    global_load_dwordx4 v[190:193], v7, s[38:39] offset:0 sc1
    global_load_dwordx4 v[194:197], v7, s[38:39] offset:1024 sc1
    global_load_dwordx4 v[198:201], v7, s[38:39] offset:2048 sc1
    global_load_dwordx4 v[202:205], v7, s[38:39] offset:3072 sc1
    s_waitcnt vmcnt(0)
    v_or_b32 v28, v177, v181
    v_or3_b32 v28, v185, v189, v28
    v_or3_b32 v28, v193, v197, v28
    v_or3_b32 v28, v201, v205, v28
    v_and_b32 v28, 1, v28
    v_cmp_ne_u32 vcc, 0, v28
    s_add_u32 s100, s100, 1
    s_cmp_ge_u32 s100, 262144
    s_cbranch_scc1 Lp1_p_x
    s_cbranch_vccnz Lp1_p
Lp1_p_x:
    s_nop 1
    s_branch Lp1_ok
Lp2_r:
    s_nop 7
Lp2_p:
    global_load_dwordx4 v[206:209], v26, s[38:39] offset:-4096 sc1
    global_load_dwordx4 v[210:213], v26, s[38:39] offset:-3072 sc1
    global_load_dwordx4 v[214:217], v26, s[38:39] offset:-2048 sc1
    global_load_dwordx4 v[218:221], v26, s[38:39] offset:-1024 sc1
    global_load_dwordx4 v[222:225], v26, s[38:39] offset:0 sc1
    global_load_dwordx4 v[226:229], v26, s[38:39] offset:1024 sc1
    global_load_dwordx4 v[230:233], v26, s[38:39] offset:2048 sc1
    s_waitcnt vmcnt(0)
    v_or3_b32 v28, v209, v213, v217
    v_or3_b32 v28, v221, v225, v28
    v_or3_b32 v28, v229, v233, v28
    v_and_b32 v28, 1, v28
    v_cmp_ne_u32 vcc, 0, v28
    s_add_u32 s100, s100, 1
    s_cmp_ge_u32 s100, 262144
    s_cbranch_scc1 Lp2_p_x
    s_cbranch_vccnz Lp2_p
Lp2_p_x:
    s_nop 1
    s_branch Lp2_ok
Lp3_r:
    s_nop 7
Lp3_p:
    global_load_dwordx4 v[238:241], v27, s[38:39] offset:-4096 sc1
    global_load_dwordx4 v[242:245], v27, s[38:39] offset:-3072 sc1
    global_load_dwordx4 v[246:249], v27, s[38:39] offset:-2048 sc1
    global_load_dwordx4 v[250:253], v27, s[38:39] offset:-1024 sc1
    s_waitcnt vmcnt(0)
    v_or_b32 v28, v239, v241
    v_or3_b32 v28, v243, v245, v28
    v_or3_b32 v28, v247, v249, v28
    v_or3_b32 v28, v251, v253, v28
    v_and_b32 v28, 1, v28
    v_cmp_ne_u32 vcc, 0, v28
    s_add_u32 s100, s100, 1
    s_cmp_ge_u32 s100, 262144
    s_cbranch_scc1 Lp3_p_x
    s_cbranch_vccnz Lp3_p
Lp3_p_x:
    s_nop 1
    s_branch Lp3_ok
Lcode_end:
    s_endpgm
.section .rodata,"a"
.p2align 6
.amdhsa_kernel adaLN_cond__ssm_conv_h3__mixer_gmlp__prompt_kernel
  .amdhsa_next_free_vgpr 512
  .amdhsa_next_free_sgpr 102
  .amdhsa_accum_offset 256
  .amdhsa_group_segment_fixed_size 0
  .amdhsa_kernarg_size 128
  .amdhsa_user_sgpr_count 2
  .amdhsa_user_sgpr_kernarg_segment_ptr 1
  .amdhsa_system_sgpr_workgroup_id_x 1
  .amdhsa_float_denorm_mode_32 3
.end_amdhsa_kernel
```

```asm
; @launch grid=(256,1,1) block=(256,1,1) lds=163840
.amdgcn_target "amdgcn-amd-amdhsa--gfx950"
.text
.p2align 8
.globl adaLN_cond__ssm_conv_h3__mixer_gmlp__prompt_kernel
.type adaLN_cond__ssm_conv_h3__mixer_gmlp__prompt_kernel,@function
adaLN_cond__ssm_conv_h3__mixer_gmlp__prompt_kernel:
    s_cmp_ge_u32 s2, 256
    s_cbranch_scc1 Lend
    s_load_dwordx16 s[8:23], s[0:1], 0
    s_load_dwordx16 s[24:39], s[0:1], 64
    v_lshrrev_b32 v2, 6, v0
    v_and_b32 v1, 63, v0
    v_readfirstlane_b32 s3, v2
    s_getpc_b64 s[4:5]
Lpf_adaLN_cond__ssm_conv_h3__mixer_gmlp__prompt_kernel_9:
    s_add_u32 s4, s4, adaLN_cond__ssm_conv_h3__mixer_gmlp__prompt_kernel-Lpf_adaLN_cond__ssm_conv_h3__mixer_gmlp__prompt_kernel_9
    s_addc_u32 s5, s5, -1
    s_lshr_b32 s6, s2, 3
    s_and_b32 s6, s6, 31
    v_mul_u32_u24 v254, 32, v0
    v_add_lshl_u32 v254, v254, s6, 7
    v_min_u32 v254, (Lcode_end-adaLN_cond__ssm_conv_h3__mixer_gmlp__prompt_kernel-4), v254
    global_load_dword v254, v254, s[4:5]
    s_mov_b64 s[58:59], s[4:5]
    v_and_b32 v2, 15, v1
    v_lshrrev_b32 v3, 4, v1
    v_lshlrev_b32 v4, 4, v1
    v_lshrrev_b32 v6, 2, v2
    v_and_b32 v5, 3, v2
    v_lshl_add_u32 v5, v6, 3, v5
    s_mov_b32 s100, 0
    s_and_b32 s4, s2, 7
    s_lshr_b32 s5, s2, 3
    s_lshr_b32 s43, s5, 2
    s_lshr_b32 s6, s43, 1
    s_lshl_b32 s6, s6, 3
    s_and_b32 s7, s4, 6
    s_add_u32 s6, s6, s7
    s_and_b32 s7, s43, 1
    s_add_u32 s40, s6, s7
    s_and_b32 s6, s4, 1
    s_lshl_b32 s6, s6, 2
    s_and_b32 s7, s5, 3
    s_add_u32 s41, s6, s7
    s_mul_i32 s4, s4, 20
    s_add_u32 s42, s4, s5
    s_waitcnt lgkmcnt(0)
    s_mov_b64 s[0:1], s[58:59]
    s_cmp_ge_u32 s2, 160
    s_cbranch_scc1 Lspare
Lconv:
    s_and_b32 s4, s42, 15
    s_lshl_b32 s4, s4, 2
    s_add_u32 s4, s4, s3
    s_mul_i32 s4, s4, 40960
    s_lshr_b32 s5, s42, 4
    s_lshl_b32 s6, s5, 7
    s_add_u32 s4, s4, s6
    v_mul_u32_u24 v46, 10240, v3
    v_lshl_add_u32 v46, v2, 3, v46
    v_add_u32 v46, s4, v46
    v_add_u32 v47, 5120, v46
    global_load_dwordx2 v[56:57], v46, s[10:11] offset:0
    global_load_dwordx2 v[58:59], v46, s[10:11] offset:1280
    global_load_dwordx2 v[60:61], v46, s[10:11] offset:2560
    global_load_dwordx2 v[62:63], v46, s[10:11] offset:3840
    global_load_dwordx2 v[64:65], v47, s[10:11] offset:0
    global_load_dwordx2 v[66:67], v47, s[10:11] offset:1280
    global_load_dwordx2 v[68:69], v47, s[10:11] offset:2560
    global_load_dwordx2 v[70:71], v47, s[10:11] offset:3840
    v_max_u32 v48, 3840, v46
    global_load_dwordx2 v[50:51], v48, s[10:11] offset:-3840
    global_load_dwordx2 v[52:53], v48, s[10:11] offset:-2560
    global_load_dwordx2 v[54:55], v48, s[10:11] offset:-1280
    s_lshl_b32 s5, s5, 9
    v_lshl_add_u32 v48, v2, 5, s5
    global_load_dwordx4 v[88:91], v48, s[14:15] offset:0
    global_load_dwordx4 v[92:95], v48, s[14:15] offset:16
    global_load_dwordx2 v[72:73], v46, s[12:13] offset:0 nt
    global_load_dwordx2 v[74:75], v46, s[12:13] offset:1280 nt
    global_load_dwordx2 v[76:77], v46, s[12:13] offset:2560 nt
    global_load_dwordx2 v[78:79], v46, s[12:13] offset:3840 nt
    global_load_dwordx2 v[80:81], v47, s[12:13] offset:0 nt
    global_load_dwordx2 v[82:83], v47, s[12:13] offset:1280 nt
    global_load_dwordx2 v[84:85], v47, s[12:13] offset:2560 nt
    global_load_dwordx2 v[86:87], v47, s[12:13] offset:3840 nt
    s_lshl_b32 s7, s42, 3
    s_load_dwordx2 s[92:93], s[18:19], s7
    v_mov_b32 v156, 0
    v_mov_b32 v157, 0
    v_mov_b32 v158, 0
    v_mov_b32 v159, 0
    s_mul_i32 s5, s3, 8448
    v_and_b32 v28, 48, v4
    v_add_u32 v28, s5, v28
    ds_write_b128 v28, v[156:159] offset:0
    ds_write_b128 v28, v[156:159] offset:4224
    v_min_u32 v28, 448, v4
    s_mul_i32 s4, s3, 9280
    v_add_u32 v28, s4, v28
    ds_write_b128 v28, v[156:159] offset:37888
    ds_write_b128 v28, v[156:159] offset:42528
    v_add_u32 v37, s5, v4
    v_and_b32 v28, 1, v2
    v_lshrrev_b32 v29, 1, v2
    v_mul_u32_u24 v36, 4224, v28
    v_lshl_add_u32 v36, v29, 3, v36
    v_lshl_add_u32 v36, v3, 4, v36
    v_add_u32 v36, s5, v36
    v_mul_u32_u24 v38, 4640, v28
    v_lshlrev_b32 v29, 6, v29
    v_sub_u32 v38, v38, v29
    v_lshl_add_u32 v38, v3, 4, v38
    s_add_u32 s4, s4, 34256
    v_add_u32 v38, s4, v38
    v_lshl_add_u32 v40, v28, 2, v29
    v_lshl_add_u32 v40, v3, 4, v40
    s_mul_i32 s4, s3, 1056
    s_add_u32 s4, s4, 0
    v_add_u32 v40, s4, v40
    v_lshlrev_b32 v28, 2, v0
    v_sub_u32 v39, 34824, v28
    v_add_u32 v41, 0, v28
    v_lshrrev_b32 v28, 5, v0
    v_mul_u32_u24 v43, 114688, v28
    v_and_b32 v28, 31, v0
    v_lshl_add_u32 v43, v28, 4, v43
    s_lshl_b32 s4, s42, 9
    s_add_u32 s4, s4, 1048576
    v_add_u32 v43, s4, v43
    s_waitcnt lgkmcnt(0)
    s_lshl_b32 s20, s92, 16
    s_lshr_b32 s28, s20, 16
    s_and_b32 s21, s92, 0xffff0000
    s_lshr_b32 s29, s21, 16
    s_lshl_b32 s22, s93, 16
    s_lshr_b32 s30, s22, 16
    s_and_b32 s23, s93, 0xffff0000
    s_lshr_b32 s31, s23, 16
    v_and_b32 v211, 7, v1
    v_lshrrev_b32 v212, 3, v1
    s_lshl_b32 s4, s42, 2
    s_add_u32 s4, s4, s3
    s_lshl_b32 s94, s4, 12
    v_add_u32 v28, s94, v4
    s_mul_i32 s5, s3, 8448
    s_add_u32 m0, s5, 4288
    s_nop 0
    global_load_lds_dwordx4 v28, s[16:17] offset:0 nt
    global_load_lds_dwordx4 v28, s[16:17] offset:1024 nt
    global_load_lds_dwordx4 v28, s[16:17] offset:2048 nt
    global_load_lds_dwordx4 v28, s[16:17] offset:3072 nt
    s_lshr_b32 s5, s3, 1
    s_lshl_b32 s5, s5, 5
    s_and_b32 s6, s3, 1
    s_lshl_b32 s6, s6, 2
    s_add_u32 s6, s6, s5
    s_lshl_b32 s5, s40, 6
    s_add_u32 s90, s6, s5
    v_add_lshl_u32 v27, v5, s90, 1
    global_load_ushort v27, v27, s[26:27]
    s_waitcnt vmcnt(25)
    v_lshlrev_b32 v124, 16, v56
    v_and_b32 v125, 0xffff0000, v56
    v_lshlrev_b32 v126, 16, v57
    v_and_b32 v127, 0xffff0000, v57
    s_waitcnt vmcnt(24)
    v_lshlrev_b32 v128, 16, v58
    v_and_b32 v129, 0xffff0000, v58
    v_lshlrev_b32 v130, 16, v59
    v_and_b32 v131, 0xffff0000, v59
    s_waitcnt vmcnt(23)
    v_lshlrev_b32 v132, 16, v60
    v_and_b32 v133, 0xffff0000, v60
    v_lshlrev_b32 v134, 16, v61
    v_and_b32 v135, 0xffff0000, v61
    s_waitcnt vmcnt(22)
    v_lshlrev_b32 v136, 16, v62
    v_and_b32 v137, 0xffff0000, v62
    v_lshlrev_b32 v138, 16, v63
    v_and_b32 v139, 0xffff0000, v63
    s_waitcnt vmcnt(21)
    v_lshlrev_b32 v140, 16, v64
    v_and_b32 v141, 0xffff0000, v64
    v_lshlrev_b32 v142, 16, v65
    v_and_b32 v143, 0xffff0000, v65
    s_waitcnt vmcnt(20)
    v_lshlrev_b32 v144, 16, v66
    v_and_b32 v145, 0xffff0000, v66
    v_lshlrev_b32 v146, 16, v67
    v_and_b32 v147, 0xffff0000, v67
    s_waitcnt vmcnt(19)
    v_lshlrev_b32 v148, 16, v68
    v_and_b32 v149, 0xffff0000, v68
    v_lshlrev_b32 v150, 16, v69
    v_and_b32 v151, 0xffff0000, v69
    s_waitcnt vmcnt(18)
    v_lshlrev_b32 v152, 16, v70
    v_and_b32 v153, 0xffff0000, v70
    v_lshlrev_b32 v154, 16, v71
    v_and_b32 v155, 0xffff0000, v71
    s_lshl_b32 s4, s42, 2
    s_add_u32 s4, s4, s3
    s_mul_i32 s4, s4, 5120
    s_cmp_lt_u32 s42, 128
    s_cselect_b32 s5, -1, 0
    v_add_u32 v209, s4, v4
    v_and_b32 v209, s5, v209
    v_add_u32 v209, 2048, v209
    global_load_dwordx4 v[188:191], v209, s[8:9] offset:-2048 nt
    global_load_dwordx4 v[192:195], v209, s[8:9] offset:-1024 nt
    global_load_dwordx4 v[196:199], v209, s[8:9] offset:0 nt
    global_load_dwordx4 v[200:203], v209, s[8:9] offset:1024 nt
    global_load_dwordx4 v[204:207], v209, s[8:9] offset:2048 nt
    v_cmp_le_u32 vcc, 1280, v46
    s_waitcnt vmcnt(22)
    s_nop 0
    v_cndmask_b32 v50, 0, v50, vcc
    v_cndmask_b32 v51, 0, v51, vcc
    s_waitcnt vmcnt(21)
    v_cndmask_b32 v52, 0, v52, vcc
    v_cndmask_b32 v53, 0, v53, vcc
    s_waitcnt vmcnt(20)
    v_cndmask_b32 v54, 0, v54, vcc
    v_cndmask_b32 v55, 0, v55, vcc
    v_lshlrev_b32 v112, 16, v50
    v_and_b32 v113, 0xffff0000, v50
    v_lshlrev_b32 v114, 16, v51
    v_and_b32 v115, 0xffff0000, v51
    v_lshlrev_b32 v116, 16, v52
    v_and_b32 v117, 0xffff0000, v52
    v_lshlrev_b32 v118, 16, v53
    v_and_b32 v119, 0xffff0000, v53
    v_lshlrev_b32 v120, 16, v54
    v_and_b32 v121, 0xffff0000, v54
    v_lshlrev_b32 v122, 16, v55
    v_and_b32 v123, 0xffff0000, v55
    s_waitcnt vmcnt(19)
    v_lshlrev_b32 v96, 16, v88
    v_and_b32 v100, 0xffff0000, v88
    v_lshlrev_b32 v104, 16, v89
    v_and_b32 v108, 0xffff0000, v89
    v_lshlrev_b32 v97, 16, v90
    v_and_b32 v101, 0xffff0000, v90
    v_lshlrev_b32 v105, 16, v91
    v_and_b32 v109, 0xffff0000, v91
    s_waitcnt vmcnt(18)
    v_lshlrev_b32 v98, 16, v92
    v_and_b32 v102, 0xffff0000, v92
    v_lshlrev_b32 v106, 16, v93
    v_and_b32 v110, 0xffff0000, v93
    v_lshlrev_b32 v99, 16, v94
    v_and_b32 v103, 0xffff0000, v94
    v_lshlrev_b32 v107, 16, v95
    v_and_b32 v111, 0xffff0000, v95
    v_pk_mul_f32 v[156:157], v[124:125], v[96:97] op_sel:[0,0] op_sel_hi:[1,1]
    v_pk_mul_f32 v[158:159], v[126:127], v[98:99] op_sel:[0,0] op_sel_hi:[1,1]
    v_pk_mul_f32 v[160:161], v[128:129], v[96:97] op_sel:[0,0] op_sel_hi:[1,1]
    v_pk_mul_f32 v[162:163], v[130:131], v[98:99] op_sel:[0,0] op_sel_hi:[1,1]
    v_pk_mul_f32 v[164:165], v[132:133], v[96:97] op_sel:[0,0] op_sel_hi:[1,1]
    v_pk_mul_f32 v[166:167], v[134:135], v[98:99] op_sel:[0,0] op_sel_hi:[1,1]
    v_pk_mul_f32 v[168:169], v[136:137], v[96:97] op_sel:[0,0] op_sel_hi:[1,1]
    v_pk_mul_f32 v[170:171], v[138:139], v[98:99] op_sel:[0,0] op_sel_hi:[1,1]
    v_pk_mul_f32 v[172:173], v[140:141], v[96:97] op_sel:[0,0] op_sel_hi:[1,1]
    v_pk_mul_f32 v[174:175], v[142:143], v[98:99] op_sel:[0,0] op_sel_hi:[1,1]
    v_pk_mul_f32 v[176:177], v[144:145], v[96:97] op_sel:[0,0] op_sel_hi:[1,1]
    v_pk_mul_f32 v[178:179], v[146:147], v[98:99] op_sel:[0,0] op_sel_hi:[1,1]
    v_pk_mul_f32 v[180:181], v[148:149], v[96:97] op_sel:[0,0] op_sel_hi:[1,1]
    v_pk_mul_f32 v[182:183], v[150:151], v[98:99] op_sel:[0,0] op_sel_hi:[1,1]
    v_pk_mul_f32 v[184:185], v[152:153], v[96:97] op_sel:[0,0] op_sel_hi:[1,1]
    v_pk_mul_f32 v[186:187], v[154:155], v[98:99] op_sel:[0,0] op_sel_hi:[1,1]
    v_pk_fma_f32 v[156:157], v[120:121], v[100:101], v[156:157] op_sel:[0,0,0] op_sel_hi:[1,1,1]
    v_pk_fma_f32 v[158:159], v[122:123], v[102:103], v[158:159] op_sel:[0,0,0] op_sel_hi:[1,1,1]
    v_pk_fma_f32 v[160:161], v[124:125], v[100:101], v[160:161] op_sel:[0,0,0] op_sel_hi:[1,1,1]
    v_pk_fma_f32 v[162:163], v[126:127], v[102:103], v[162:163] op_sel:[0,0,0] op_sel_hi:[1,1,1]
    v_pk_fma_f32 v[164:165], v[128:129], v[100:101], v[164:165] op_sel:[0,0,0] op_sel_hi:[1,1,1]
    v_pk_fma_f32 v[166:167], v[130:131], v[102:103], v[166:167] op_sel:[0,0,0] op_sel_hi:[1,1,1]
    v_pk_fma_f32 v[168:169], v[132:133], v[100:101], v[168:169] op_sel:[0,0,0] op_sel_hi:[1,1,1]
    v_pk_fma_f32 v[170:171], v[134:135], v[102:103], v[170:171] op_sel:[0,0,0] op_sel_hi:[1,1,1]
    v_pk_fma_f32 v[172:173], v[136:137], v[100:101], v[172:173] op_sel:[0,0,0] op_sel_hi:[1,1,1]
    v_pk_fma_f32 v[174:175], v[138:139], v[102:103], v[174:175] op_sel:[0,0,0] op_sel_hi:[1,1,1]
    v_pk_fma_f32 v[176:177], v[140:141], v[100:101], v[176:177] op_sel:[0,0,0] op_sel_hi:[1,1,1]
    v_pk_fma_f32 v[178:179], v[142:143], v[102:103], v[178:179] op_sel:[0,0,0] op_sel_hi:[1,1,1]
    v_pk_fma_f32 v[180:181], v[144:145], v[100:101], v[180:181] op_sel:[0,0,0] op_sel_hi:[1,1,1]
    v_pk_fma_f32 v[182:183], v[146:147], v[102:103], v[182:183] op_sel:[0,0,0] op_sel_hi:[1,1,1]
    v_pk_fma_f32 v[184:185], v[148:149], v[100:101], v[184:185] op_sel:[0,0,0] op_sel_hi:[1,1,1]
    v_pk_fma_f32 v[186:187], v[150:151], v[102:103], v[186:187] op_sel:[0,0,0] op_sel_hi:[1,1,1]
    v_pk_fma_f32 v[156:157], v[116:117], v[104:105], v[156:157] op_sel:[0,0,0] op_sel_hi:[1,1,1]
    v_pk_fma_f32 v[158:159], v[118:119], v[106:107], v[158:159] op_sel:[0,0,0] op_sel_hi:[1,1,1]
    v_pk_fma_f32 v[160:161], v[120:121], v[104:105], v[160:161] op_sel:[0,0,0] op_sel_hi:[1,1,1]
    v_pk_fma_f32 v[162:163], v[122:123], v[106:107], v[162:163] op_sel:[0,0,0] op_sel_hi:[1,1,1]
    v_pk_fma_f32 v[164:165], v[124:125], v[104:105], v[164:165] op_sel:[0,0,0] op_sel_hi:[1,1,1]
    v_pk_fma_f32 v[166:167], v[126:127], v[106:107], v[166:167] op_sel:[0,0,0] op_sel_hi:[1,1,1]
    v_pk_fma_f32 v[168:169], v[128:129], v[104:105], v[168:169] op_sel:[0,0,0] op_sel_hi:[1,1,1]
    v_pk_fma_f32 v[170:171], v[130:131], v[106:107], v[170:171] op_sel:[0,0,0] op_sel_hi:[1,1,1]
    v_pk_fma_f32 v[172:173], v[132:133], v[104:105], v[172:173] op_sel:[0,0,0] op_sel_hi:[1,1,1]
    v_pk_fma_f32 v[174:175], v[134:135], v[106:107], v[174:175] op_sel:[0,0,0] op_sel_hi:[1,1,1]
    v_pk_fma_f32 v[176:177], v[136:137], v[104:105], v[176:177] op_sel:[0,0,0] op_sel_hi:[1,1,1]
    v_pk_fma_f32 v[178:179], v[138:139], v[106:107], v[178:179] op_sel:[0,0,0] op_sel_hi:[1,1,1]
    v_pk_fma_f32 v[180:181], v[140:141], v[104:105], v[180:181] op_sel:[0,0,0] op_sel_hi:[1,1,1]
    v_pk_fma_f32 v[182:183], v[142:143], v[106:107], v[182:183] op_sel:[0,0,0] op_sel_hi:[1,1,1]
    v_pk_fma_f32 v[184:185], v[144:145], v[104:105], v[184:185] op_sel:[0,0,0] op_sel_hi:[1,1,1]
    v_pk_fma_f32 v[186:187], v[146:147], v[106:107], v[186:187] op_sel:[0,0,0] op_sel_hi:[1,1,1]
    v_pk_fma_f32 v[156:157], v[112:113], v[108:109], v[156:157] op_sel:[0,0,0] op_sel_hi:[1,1,1]
    v_pk_fma_f32 v[158:159], v[114:115], v[110:111], v[158:159] op_sel:[0,0,0] op_sel_hi:[1,1,1]
    v_pk_fma_f32 v[160:161], v[116:117], v[108:109], v[160:161] op_sel:[0,0,0] op_sel_hi:[1,1,1]
    v_pk_fma_f32 v[162:163], v[118:119], v[110:111], v[162:163] op_sel:[0,0,0] op_sel_hi:[1,1,1]
    v_pk_fma_f32 v[164:165], v[120:121], v[108:109], v[164:165] op_sel:[0,0,0] op_sel_hi:[1,1,1]
    v_pk_fma_f32 v[166:167], v[122:123], v[110:111], v[166:167] op_sel:[0,0,0] op_sel_hi:[1,1,1]
    v_pk_fma_f32 v[168:169], v[124:125], v[108:109], v[168:169] op_sel:[0,0,0] op_sel_hi:[1,1,1]
    v_pk_fma_f32 v[170:171], v[126:127], v[110:111], v[170:171] op_sel:[0,0,0] op_sel_hi:[1,1,1]
    v_pk_fma_f32 v[172:173], v[128:129], v[108:109], v[172:173] op_sel:[0,0,0] op_sel_hi:[1,1,1]
    v_pk_fma_f32 v[174:175], v[130:131], v[110:111], v[174:175] op_sel:[0,0,0] op_sel_hi:[1,1,1]
    v_pk_fma_f32 v[176:177], v[132:133], v[108:109], v[176:177] op_sel:[0,0,0] op_sel_hi:[1,1,1]
    v_pk_fma_f32 v[178:179], v[134:135], v[110:111], v[178:179] op_sel:[0,0,0] op_sel_hi:[1,1,1]
    v_pk_fma_f32 v[180:181], v[136:137], v[108:109], v[180:181] op_sel:[0,0,0] op_sel_hi:[1,1,1]
    v_pk_fma_f32 v[182:183], v[138:139], v[110:111], v[182:183] op_sel:[0,0,0] op_sel_hi:[1,1,1]
    v_pk_fma_f32 v[184:185], v[140:141], v[108:109], v[184:185] op_sel:[0,0,0] op_sel_hi:[1,1,1]
    v_pk_fma_f32 v[186:187], v[142:143], v[110:111], v[186:187] op_sel:[0,0,0] op_sel_hi:[1,1,1]
    s_lshl_b32 s4, s3, 6
    s_sub_u32 s4, 104688, s4
    v_mul_u32_u24 v48, 272, v2
    v_add_u32 v48, s4, v48
    v_lshlrev_b32 v47, 4, v3
    v_sub_u32 v48, v48, v47
    s_waitcnt vmcnt(17)
    v_lshlrev_b32 v112, 16, v72
    v_and_b32 v113, 0xffff0000, v72
    v_lshlrev_b32 v114, 16, v73
    v_and_b32 v115, 0xffff0000, v73
    v_pk_mul_f32 v[156:157], v[156:157], v[112:113] op_sel:[0,0] op_sel_hi:[1,1]
    v_pk_mul_f32 v[158:159], v[158:159], v[114:115] op_sel:[0,0] op_sel_hi:[1,1]
    s_waitcnt vmcnt(16)
    v_lshlrev_b32 v116, 16, v74
    v_and_b32 v117, 0xffff0000, v74
    v_lshlrev_b32 v118, 16, v75
    v_and_b32 v119, 0xffff0000, v75
    v_pk_mul_f32 v[160:161], v[160:161], v[116:117] op_sel:[0,0] op_sel_hi:[1,1]
    v_pk_mul_f32 v[162:163], v[162:163], v[118:119] op_sel:[0,0] op_sel_hi:[1,1]
    s_waitcnt vmcnt(15)
    v_lshlrev_b32 v120, 16, v76
    v_and_b32 v121, 0xffff0000, v76
    v_lshlrev_b32 v122, 16, v77
    v_and_b32 v123, 0xffff0000, v77
    v_pk_mul_f32 v[164:165], v[164:165], v[120:121] op_sel:[0,0] op_sel_hi:[1,1]
    v_pk_mul_f32 v[166:167], v[166:167], v[122:123] op_sel:[0,0] op_sel_hi:[1,1]
    s_waitcnt vmcnt(14)
    v_lshlrev_b32 v124, 16, v78
    v_and_b32 v125, 0xffff0000, v78
    v_lshlrev_b32 v126, 16, v79
    v_and_b32 v127, 0xffff0000, v79
    v_pk_mul_f32 v[168:169], v[168:169], v[124:125] op_sel:[0,0] op_sel_hi:[1,1]
    v_pk_mul_f32 v[170:171], v[170:171], v[126:127] op_sel:[0,0] op_sel_hi:[1,1]
    s_waitcnt vmcnt(13)
    v_lshlrev_b32 v128, 16, v80
    v_and_b32 v129, 0xffff0000, v80
    v_lshlrev_b32 v130, 16, v81
    v_and_b32 v131, 0xffff0000, v81
    v_pk_mul_f32 v[172:173], v[172:173], v[128:129] op_sel:[0,0] op_sel_hi:[1,1]
    v_pk_mul_f32 v[174:175], v[174:175], v[130:131] op_sel:[0,0] op_sel_hi:[1,1]
    s_waitcnt vmcnt(12)
    v_lshlrev_b32 v132, 16, v82
    v_and_b32 v133, 0xffff0000, v82
    v_lshlrev_b32 v134, 16, v83
    v_and_b32 v135, 0xffff0000, v83
    v_pk_mul_f32 v[176:177], v[176:177], v[132:133] op_sel:[0,0] op_sel_hi:[1,1]
    v_pk_mul_f32 v[178:179], v[178:179], v[134:135] op_sel:[0,0] op_sel_hi:[1,1]
    s_waitcnt vmcnt(11)
    v_lshlrev_b32 v136, 16, v84
    v_and_b32 v137, 0xffff0000, v84
    v_lshlrev_b32 v138, 16, v85
    v_and_b32 v139, 0xffff0000, v85
    v_pk_mul_f32 v[180:181], v[180:181], v[136:137] op_sel:[0,0] op_sel_hi:[1,1]
    v_pk_mul_f32 v[182:183], v[182:183], v[138:139] op_sel:[0,0] op_sel_hi:[1,1]
    s_waitcnt vmcnt(10)
    v_lshlrev_b32 v140, 16, v86
    v_and_b32 v141, 0xffff0000, v86
    v_lshlrev_b32 v142, 16, v87
    v_and_b32 v143, 0xffff0000, v87
    v_pk_mul_f32 v[184:185], v[184:185], v[140:141] op_sel:[0,0] op_sel_hi:[1,1]
    v_pk_mul_f32 v[186:187], v[186:187], v[142:143] op_sel:[0,0] op_sel_hi:[1,1]
    v_cvt_pk_bf16_f32 v96, v184, v180
    v_cvt_pk_bf16_f32 v97, v176, v172
    v_cvt_pk_bf16_f32 v98, v168, v164
    v_cvt_pk_bf16_f32 v99, v160, v156
    v_and_b32 v99, -2, v99
    ds_write_b128 v48, v[96:99] offset:0
    v_cvt_pk_bf16_f32 v100, v185, v181
    v_cvt_pk_bf16_f32 v101, v177, v173
    v_cvt_pk_bf16_f32 v102, v169, v165
    v_cvt_pk_bf16_f32 v103, v161, v157
    v_and_b32 v103, -2, v103
    ds_write_b128 v48, v[100:103] offset:4352
    v_cvt_pk_bf16_f32 v104, v186, v182
    v_cvt_pk_bf16_f32 v105, v178, v174
    v_cvt_pk_bf16_f32 v106, v170, v166
    v_cvt_pk_bf16_f32 v107, v162, v158
    v_and_b32 v107, -2, v107
    ds_write_b128 v48, v[104:107] offset:8704
    v_cvt_pk_bf16_f32 v108, v187, v183
    v_cvt_pk_bf16_f32 v109, v179, v175
    v_cvt_pk_bf16_f32 v110, v171, v167
    v_cvt_pk_bf16_f32 v111, v163, v159
    v_and_b32 v111, -2, v111
    ds_write_b128 v48, v[108:111] offset:13056
    s_waitcnt lgkmcnt(0)
    s_barrier
    s_mul_i32 s4, s3, 4352
    s_add_u32 s4, s4, 104448
    v_mul_u32_u24 v48, 272, v3
    v_lshl_add_u32 v48, v2, 4, v48
    v_add_u32 v48, s4, v48
    ds_read_b128 v[156:159], v48 offset:0
    ds_read_b128 v[160:163], v48 offset:1088
    ds_read_b128 v[164:167], v48 offset:2176
    ds_read_b128 v[168:171], v48 offset:3264
    s_lshr_b32 s4, s42, 4
    s_lshl_b32 s4, s4, 6
    s_add_u32 s4, s4, s3
    s_lshl_b32 s4, s4, 12
    s_and_b32 s5, s42, 15
    s_lshl_b32 s5, s5, 8
    s_sub_u32 s4, s4, s5
    s_add_u32 s4, s4, 12586752
    v_lshl_add_u32 v46, v3, 14, s4
    v_lshl_add_u32 v46, v2, 4, v46
    s_waitcnt lgkmcnt(3)
    global_store_dwordx4 v46, v[156:159], s[38:39] sc1
    v_add_u32 v46, 65536, v46
    s_waitcnt lgkmcnt(2)
    global_store_dwordx4 v46, v[160:163], s[38:39] sc1
    v_add_u32 v46, 65536, v46
    s_waitcnt lgkmcnt(1)
    global_store_dwordx4 v46, v[164:167], s[38:39] sc1
    v_add_u32 v46, 65536, v46
    s_waitcnt lgkmcnt(0)
    global_store_dwordx4 v46, v[168:171], s[38:39] sc1
    v_and_b32 v220, 7, v1
    v_lshlrev_b32 v220, 2, v220
    v_mov_b32 v221, 1
    s_cmp_lg_u32 s3, 0
    s_cbranch_scc1 Ldb1
    global_load_dword v221, v220, s[36:37] sc1
Ldb1:
    s_waitcnt vmcnt(10)
    ds_read_b128 v[50:53], v37 offset:4288
    ds_read_b32 v49, v37 offset:4284
    ds_read_b128 v[58:61], v37 offset:5312
    ds_read_b32 v57, v37 offset:5308
    ds_read_b128 v[66:69], v37 offset:6336
    ds_read_b32 v65, v37 offset:6332
    ds_read_b128 v[74:77], v37 offset:7360
    ds_read_b32 v73, v37 offset:7356
    s_waitcnt lgkmcnt(6)
    v_alignbit_b32 v80, v50, v49, 16
    v_alignbit_b32 v81, v51, v50, 16
    v_alignbit_b32 v82, v52, v51, 16
    v_alignbit_b32 v83, v53, v52, 16
    ds_write_b128 v37, v[80:83] offset:64
    s_waitcnt lgkmcnt(5)
    v_alignbit_b32 v84, v58, v57, 16
    v_alignbit_b32 v85, v59, v58, 16
    v_alignbit_b32 v86, v60, v59, 16
    v_alignbit_b32 v87, v61, v60, 16
    ds_write_b128 v37, v[84:87] offset:1088
    s_waitcnt lgkmcnt(4)
    v_alignbit_b32 v88, v66, v65, 16
    v_alignbit_b32 v89, v67, v66, 16
    v_alignbit_b32 v90, v68, v67, 16
    v_alignbit_b32 v91, v69, v68, 16
    ds_write_b128 v37, v[88:91] offset:2112
    s_waitcnt lgkmcnt(3)
    v_alignbit_b32 v92, v74, v73, 16
    v_alignbit_b32 v93, v75, v74, 16
    v_alignbit_b32 v94, v76, v75, 16
    v_alignbit_b32 v95, v77, v76, 16
    ds_write_b128 v37, v[92:95] offset:3136
    ds_read_b64 a[0:1], v36 offset:8
    ds_read_b64 a[2:3], v36 offset:16
    ds_read_b64 a[4:5], v36 offset:72
    ds_read_b64 a[6:7], v36 offset:80
    ds_read_b64 a[8:9], v36 offset:136
    ds_read_b64 a[10:11], v36 offset:144
    ds_read_b64 a[12:13], v36 offset:200
    ds_read_b64 a[14:15], v36 offset:208
    ds_read_b64 a[16:17], v36 offset:264
    ds_read_b64 a[18:19], v36 offset:272
    ds_read_b64 a[20:21], v36 offset:328
    ds_read_b64 a[22:23], v36 offset:336
    ds_read_b64 a[24:25], v36 offset:392
    ds_read_b64 a[26:27], v36 offset:400
    ds_read_b64 a[28:29], v36 offset:456
    ds_read_b64 a[30:31], v36 offset:464
    ds_read_b64 a[32:33], v36 offset:520
    ds_read_b64 a[34:35], v36 offset:528
    ds_read_b64 a[36:37], v36 offset:584
    ds_read_b64 a[38:39], v36 offset:592
    ds_read_b64 a[40:41], v36 offset:648
    ds_read_b64 a[42:43], v36 offset:656
    ds_read_b64 a[44:45], v36 offset:712
    ds_read_b64 a[46:47], v36 offset:720
    ds_read_b64 a[48:49], v36 offset:776
    ds_read_b64 a[50:51], v36 offset:784
    ds_read_b64 a[52:53], v36 offset:840
    ds_read_b64 a[54:55], v36 offset:848
    ds_read_b64 a[56:57], v36 offset:904
    ds_read_b64 a[58:59], v36 offset:912
    ds_read_b64 a[60:61], v36 offset:968
    ds_read_b64 a[62:63], v36 offset:976
    ds_read_b64 a[64:65], v36 offset:1032
    ds_read_b64 a[66:67], v36 offset:1040
    ds_read_b64 a[68:69], v36 offset:1096
    ds_read_b64 a[70:71], v36 offset:1104
    ds_read_b64 a[72:73], v36 offset:1160
    ds_read_b64 a[74:75], v36 offset:1168
    ds_read_b64 a[76:77], v36 offset:1224
    ds_read_b64 a[78:79], v36 offset:1232
    ds_read_b64 a[80:81], v36 offset:1288
    ds_read_b64 a[82:83], v36 offset:1296
    ds_read_b64 a[84:85], v36 offset:1352
    ds_read_b64 a[86:87], v36 offset:1360
    ds_read_b64 a[88:89], v36 offset:1416
    ds_read_b64 a[90:91], v36 offset:1424
    ds_read_b64 a[92:93], v36 offset:1480
    ds_read_b64 a[94:95], v36 offset:1488
    s_mul_i32 s5, s3, 5152
    s_add_u32 s5, s5, 122880
    v_add_u32 v209, s5, v4
    v_lshrrev_b32 v210, 5, v1
    v_lshl_add_u32 v210, v210, 4, v209
    s_waitcnt vmcnt(8)
    ds_write_b128 v209, v[188:191] offset:0
    s_waitcnt vmcnt(7)
    ds_write_b128 v209, v[192:195] offset:1024
    s_waitcnt vmcnt(6)
    ds_write_b128 v210, v[196:199] offset:2048
    s_waitcnt vmcnt(5)
    ds_write_b128 v209, v[200:203] offset:3088
    s_waitcnt vmcnt(4)
    ds_write_b128 v209, v[204:207] offset:4112
    s_lshl_b32 s95, s42, 7
    s_add_u32 s95, s95, 77824
    v_max_u32 v44, 1, v2
    v_lshlrev_b32 v44, 7, v44
    v_xor_b32 v44, s95, v44
    s_add_u32 s4, s94, 12582912
    v_add_u32 v28, s4, v4
    s_mul_i32 s93, s3, 9280
    s_waitcnt vmcnt(0)
    v_cmp_eq_u32 vcc, 0, v221
    s_nop 0
    s_cbranch_vccnz Lic_r
Lic_ok:
    s_waitcnt lgkmcnt(0)
    s_barrier
    v_mov_b32 v29, s95
    s_cmp_lg_u32 s3, 0
    s_cbranch_scc1 Lkf_skip
    global_store_dword v29, v29, s[38:39] sc1
Lkf_skip:
    s_cmp_ge_u32 s42, 128
    s_cbranch_scc1 Lc_j2
    v_mul_u32_u24 v209, 2576, v211
    v_lshl_add_u32 v209, v212, 3, v209
    s_mul_i32 s5, s3, 320
    s_add_u32 s5, s5, 122880
    v_add_u32 v209, s5, v209
    ds_read2_b64 v[188:191], v209 offset0:0 offset1:160
    ds_read2_b64 v[192:195], v209 offset0:8 offset1:168
    ds_read2_b64 v[196:199], v209 offset0:16 offset1:176
    ds_read2_b64 v[200:203], v209 offset0:24 offset1:184
    ds_read2_b64 v[204:207], v209 offset0:32 offset1:192
    s_lshr_b32 s4, s42, 2
    s_mul_i32 s4, s4, 114688
    s_and_b32 s5, s42, 3
    s_lshl_b32 s5, s5, 7
    s_add_u32 s4, s4, s5
    s_mul_i32 s5, s3, 20480
    s_add_u32 s4, s4, s5
    s_add_u32 s4, s4, 1052672
    v_lshl_add_u32 v208, v212, 9, s4
    v_lshl_add_u32 v208, v211, 4, v208
    s_mov_b32 s7, 0x3f803f80
    v_mov_b32 v216, 0
    v_mov_b32 v217, 0
    v_mov_b32 v218, 0
    v_mov_b32 v219, 0
    s_waitcnt lgkmcnt(4)
    v_and_b32 v191, -2, v191
    global_store_dwordx4 v208, v[188:191], s[38:39] offset:-4096 sc1
    s_waitcnt lgkmcnt(3)
    v_and_b32 v195, -2, v195
    global_store_dwordx4 v208, v[192:195], s[38:39] offset:0 sc1
    v_add_u32 v208, 8192, v208
    s_waitcnt lgkmcnt(2)
    v_and_b32 v199, -2, v199
    global_store_dwordx4 v208, v[196:199], s[38:39] offset:-4096 sc1
    s_waitcnt lgkmcnt(1)
    v_and_b32 v203, -2, v203
    global_store_dwordx4 v208, v[200:203], s[38:39] offset:0 sc1
    v_add_u32 v208, 8192, v208
    s_waitcnt lgkmcnt(0)
    v_and_b32 v207, -2, v207
    global_store_dwordx4 v208, v[204:207], s[38:39] offset:-4096 sc1
    v_dot2_f32_bf16 v216, v188, s7, v216
    v_dot2_f32_bf16 v217, v188, v188, v217
    v_dot2_f32_bf16 v218, v190, s7, v218
    v_dot2_f32_bf16 v219, v190, v190, v219
    v_dot2_f32_bf16 v216, v189, s7, v216
    v_dot2_f32_bf16 v217, v189, v189, v217
    v_dot2_f32_bf16 v218, v191, s7, v218
    v_dot2_f32_bf16 v219, v191, v191, v219
    v_dot2_f32_bf16 v216, v192, s7, v216
    v_dot2_f32_bf16 v217, v192, v192, v217
    v_dot2_f32_bf16 v218, v194, s7, v218
    v_dot2_f32_bf16 v219, v194, v194, v219
    v_dot2_f32_bf16 v216, v193, s7, v216
    v_dot2_f32_bf16 v217, v193, v193, v217
    v_dot2_f32_bf16 v218, v195, s7, v218
    v_dot2_f32_bf16 v219, v195, v195, v219
    v_dot2_f32_bf16 v216, v196, s7, v216
    v_dot2_f32_bf16 v217, v196, v196, v217
    v_dot2_f32_bf16 v218, v198, s7, v218
    v_dot2_f32_bf16 v219, v198, v198, v219
    v_dot2_f32_bf16 v216, v197, s7, v216
    v_dot2_f32_bf16 v217, v197, v197, v217
    v_dot2_f32_bf16 v218, v199, s7, v218
    v_dot2_f32_bf16 v219, v199, v199, v219
    v_dot2_f32_bf16 v216, v200, s7, v216
    v_dot2_f32_bf16 v217, v200, v200, v217
    v_dot2_f32_bf16 v218, v202, s7, v218
    v_dot2_f32_bf16 v219, v202, v202, v219
    v_dot2_f32_bf16 v216, v201, s7, v216
    v_dot2_f32_bf16 v217, v201, v201, v217
    v_dot2_f32_bf16 v218, v203, s7, v218
    v_dot2_f32_bf16 v219, v203, v203, v219
    v_dot2_f32_bf16 v216, v204, s7, v216
    v_dot2_f32_bf16 v217, v204, v204, v217
    v_dot2_f32_bf16 v218, v206, s7, v218
    v_dot2_f32_bf16 v219, v206, v206, v219
    v_dot2_f32_bf16 v216, v205, s7, v216
    v_dot2_f32_bf16 v217, v205, v205, v217
    v_dot2_f32_bf16 v218, v207, s7, v218
    v_dot2_f32_bf16 v219, v207, v207, v219
    s_nop 1
    v_permlane32_swap_b32 v216, v218
    v_permlane32_swap_b32 v217, v219
    v_add_f32 v216, v216, v218
    v_add_f32 v217, v217, v219
    s_nop 1
    v_permlane16_swap_b32 v216, v217
    v_add_f32 v216, v216, v217
    v_lshlrev_b32 v209, 4, v211
    v_lshl_add_u32 v209, v3, 2, v209
    v_add_f32_dpp v216, v216, v216 row_ror:8 row_mask:0xf bank_mask:0xf
    s_lshl_b32 s5, s3, 7
    s_add_u32 s5, s5, 143616
    v_add_u32 v209, s5, v209
    ds_write_b32 v209, v216
    s_waitcnt vmcnt(5)
    s_branch Lc_j3
Lc_j2:
    s_waitcnt vmcnt(0)
Lc_j3:
    s_mov_b32 s95, 0
    ds_read_b64 a[96:97], v36 offset:1544
    ds_read_b64 a[98:99], v36 offset:1552
    ds_read_b64 a[100:101], v36 offset:1608
    ds_read_b64 a[102:103], v36 offset:1616
    ds_read_b64 a[104:105], v36 offset:1672
    ds_read_b64 a[106:107], v36 offset:1680
    ds_read_b64 a[108:109], v36 offset:1736
    ds_read_b64 a[110:111], v36 offset:1744
    ds_read_b64 a[112:113], v36 offset:1800
    ds_read_b64 a[114:115], v36 offset:1808
    ds_read_b64 a[116:117], v36 offset:1864
    ds_read_b64 a[118:119], v36 offset:1872
    ds_read_b64 a[120:121], v36 offset:1928
    ds_read_b64 a[122:123], v36 offset:1936
    ds_read_b64 a[124:125], v36 offset:1992
    ds_read_b64 a[126:127], v36 offset:2000
    ds_read_b64 a[128:129], v36 offset:2056
    ds_read_b64 a[130:131], v36 offset:2064
    ds_read_b64 a[132:133], v36 offset:2120
    ds_read_b64 a[134:135], v36 offset:2128
    ds_read_b64 a[136:137], v36 offset:2184
    ds_read_b64 a[138:139], v36 offset:2192
    ds_read_b64 a[140:141], v36 offset:2248
    ds_read_b64 a[142:143], v36 offset:2256
    ds_read_b64 a[144:145], v36 offset:2312
    ds_read_b64 a[146:147], v36 offset:2320
    ds_read_b64 a[148:149], v36 offset:2376
    ds_read_b64 a[150:151], v36 offset:2384
    ds_read_b64 a[152:153], v36 offset:2440
    ds_read_b64 a[154:155], v36 offset:2448
    ds_read_b64 a[156:157], v36 offset:2504
    ds_read_b64 a[158:159], v36 offset:2512
    ds_read_b64 a[160:161], v36 offset:2568
    ds_read_b64 a[162:163], v36 offset:2576
    ds_read_b64 a[164:165], v36 offset:2632
    ds_read_b64 a[166:167], v36 offset:2640
    ds_read_b64 a[168:169], v36 offset:2696
    ds_read_b64 a[170:171], v36 offset:2704
    ds_read_b64 a[172:173], v36 offset:2760
    ds_read_b64 a[174:175], v36 offset:2768
    ds_read_b64 a[176:177], v36 offset:2824
    ds_read_b64 a[178:179], v36 offset:2832
    ds_read_b64 a[180:181], v36 offset:2888
    ds_read_b64 a[182:183], v36 offset:2896
    ds_read_b64 a[184:185], v36 offset:2952
    ds_read_b64 a[186:187], v36 offset:2960
    ds_read_b64 a[188:189], v36 offset:3016
    ds_read_b64 a[190:191], v36 offset:3024
    ds_read_b64 a[192:193], v36 offset:3080
    ds_read_b64 a[194:195], v36 offset:3088
    ds_read_b64 a[196:197], v36 offset:3144
    ds_read_b64 a[198:199], v36 offset:3152
    ds_read_b64 a[200:201], v36 offset:3208
    ds_read_b64 a[202:203], v36 offset:3216
    ds_read_b64 a[204:205], v36 offset:3272
    ds_read_b64 a[206:207], v36 offset:3280
    ds_read_b64 a[208:209], v36 offset:3336
    ds_read_b64 a[210:211], v36 offset:3344
    ds_read_b64 a[212:213], v36 offset:3400
    ds_read_b64 a[214:215], v36 offset:3408
    ds_read_b64 a[216:217], v36 offset:3464
    ds_read_b64 a[218:219], v36 offset:3472
    ds_read_b64 a[220:221], v36 offset:3528
    ds_read_b64 a[222:223], v36 offset:3536
    ds_read_b64 a[224:225], v36 offset:3592
    ds_read_b64 a[226:227], v36 offset:3600
    ds_read_b64 a[228:229], v36 offset:3656
    ds_read_b64 a[230:231], v36 offset:3664
    ds_read_b64 a[232:233], v36 offset:3720
    ds_read_b64 a[234:235], v36 offset:3728
    ds_read_b64 a[236:237], v36 offset:3784
    ds_read_b64 a[238:239], v36 offset:3792
    global_load_dword v45, v44, s[38:39] sc1
    v_min_u32 v99, 49, v1
    v_cmp_lt_u32 vcc, 7, v99
    s_nop 1
    v_cndmask_b32_e64 v100, 0, 7, vcc
    v_add_lshl_u32 v99, v99, v100, 2
    v_mov_b32 v100, 1
    s_cmp_lg_u32 s3, 0
    s_cbranch_scc1 Ldb2
    global_load_dword v100, v99, s[36:37] sc1
Ldb2:
    ds_read_b64 a[240:241], v36 offset:3848
    ds_read_b64 a[242:243], v36 offset:3856
    ds_read_b64 a[244:245], v36 offset:3912
    ds_read_b64 a[246:247], v36 offset:3920
    ds_read_b64 a[248:249], v36 offset:3976
    ds_read_b64 a[250:251], v36 offset:3984
    ds_read_b64 a[252:253], v36 offset:4040
    ds_read_b64 a[254:255], v36 offset:4048
    s_and_b32 s4, s41, 1
    s_lshl_b32 s5, s3, 1
    s_add_u32 s5, s5, s4
    s_cmp_eq_u32 s5, 7
    s_cselect_b32 s5, 0, s5
    s_mul_i32 s96, s41, 7
    s_add_u32 s96, s96, s5
    s_cmp_lt_u32 s96, 54
    s_cselect_b32 s101, 2, 0
    s_min_u32 s96, s96, 53
    s_cmp_eq_u32 s3, 3
    s_cselect_b32 s101, 1, s101
    s_lshr_b32 s97, s101, 1
    s_cselect_b32 s5, -1, 0
    v_and_b32 v7, s5, v4
    s_add_u32 s97, s97, s96
    s_mul_i32 s4, s96, 20480
    s_add_u32 s5, s4, 7344128
    s_add_u32 s8, s38, s5
    s_addc_u32 s9, s39, 0
    s_add_u32 s5, s4, 7352320
    s_add_u32 s10, s38, s5
    s_addc_u32 s11, s39, 0
    s_add_u32 s5, s4, 7360512
    s_add_u32 s12, s38, s5
    s_addc_u32 s13, s39, 0
    s_mul_i32 s4, s97, 20480
    s_add_u32 s5, s4, 7344128
    s_add_u32 s14, s38, s5
    s_addc_u32 s15, s39, 0
    s_add_u32 s5, s4, 7352320
    s_add_u32 s16, s38, s5
    s_addc_u32 s17, s39, 0
    s_add_u32 s5, s4, 7360512
    s_add_u32 s18, s38, s5
    s_addc_u32 s19, s39, 0
    s_and_b32 s4, s41, 3
    s_cmp_eq_u32 s4, 0
    s_cselect_b32 s5, 8, 0
    s_cmp_le_u32 s4, 1
    s_cselect_b32 s6, 16, 8
    s_cmp_eq_u32 s4, 3
    s_cselect_b32 s50, 16, 24
    s_lshl_b32 s44, s4, 3
    s_bitcmp1_b32 s43, 0
    s_cselect_b32 s46, s6, s5
    s_cselect_b32 s48, s5, s6
    s_lshl_b32 s5, s3, 1
    s_add_u32 s44, s44, s5
    s_add_u32 s45, s44, 1
    s_add_u32 s46, s46, s5
    s_add_u32 s47, s46, 1
    s_add_u32 s48, s48, s5
    s_add_u32 s49, s48, 1
    s_add_u32 s50, s50, s5
    s_add_u32 s51, s50, 1
    s_lshl_b32 s5, s40, 18
    s_lshl_b32 s6, s44, 7
    s_add_u32 s6, s6, s5
    s_add_u32 s68, s24, s6
    s_addc_u32 s69, s25, 0
    s_lshl_b32 s6, s45, 7
    s_add_u32 s6, s6, s5
    s_add_u32 s70, s24, s6
    s_addc_u32 s71, s25, 0
    s_lshl_b32 s6, s46, 7
    s_add_u32 s6, s6, s5
    s_add_u32 s72, s24, s6
    s_addc_u32 s73, s25, 0
    s_lshl_b32 s6, s47, 7
    s_add_u32 s6, s6, s5
    s_add_u32 s74, s24, s6
    s_addc_u32 s75, s25, 0
    s_lshl_b32 s6, s48, 7
    s_add_u32 s6, s6, s5
    s_add_u32 s76, s24, s6
    s_addc_u32 s77, s25, 0
    s_lshl_b32 s6, s49, 7
    s_add_u32 s6, s6, s5
    s_add_u32 s78, s24, s6
    s_addc_u32 s79, s25, 0
    s_lshl_b32 s6, s50, 7
    s_add_u32 s6, s6, s5
    s_add_u32 s80, s24, s6
    s_addc_u32 s81, s25, 0
    s_lshl_b32 s6, s51, 7
    s_add_u32 s6, s6, s5
    s_add_u32 s82, s24, s6
    s_addc_u32 s83, s25, 0
    s_lshl_b32 s89, s3, 14
    s_add_u32 s89, s89, 83200
    s_waitcnt vmcnt(0) lgkmcnt(0)
    v_cmp_eq_u32 vcc, 0, v100
    s_nop 0
    s_cbranch_vccnz Lic2_r
Lic2_ok:
    s_barrier
    s_cmp_ge_u32 s42, 128
    s_cbranch_scc1 Lc_j5
    s_cmp_lg_u32 s3, 0
    s_cbranch_scc1 Lc_j5
    v_lshlrev_b32 v209, 3, v2
    v_add_u32 v210, 143616, v209
    ds_read_b64 v[220:221], v210 offset:0
    ds_read_b64 v[222:223], v210 offset:128
    ds_read_b64 v[224:225], v210 offset:256
    ds_read_b64 v[226:227], v210 offset:384
    s_waitcnt lgkmcnt(2)
    v_pk_add_f32 v[220:221], v[220:221], v[222:223] op_sel:[0,0] op_sel_hi:[1,1]
    s_waitcnt lgkmcnt(0)
    v_pk_add_f32 v[224:225], v[224:225], v[226:227] op_sel:[0,0] op_sel_hi:[1,1]
    v_pk_add_f32 v[220:221], v[220:221], v[224:225] op_sel:[0,0] op_sel_hi:[1,1]
    v_mul_f32 v220, 0x3acccccd, v220
    v_mul_f32 v221, 0x3acccccd, v221
    v_fma_f32 v221, -v220, v220, v221
    v_max_f32 v221, 0, v221
    v_add_f32 v221, 0x3727c5ac, v221
    v_rsq_f32 v222, v221
    s_nop 0
    v_mul_f32_e64 v221, -v220, v222
    v_mov_b32 v220, v222
    v_min_u32 v220, -2, v220
    v_min_u32 v221, -2, v221
    s_lshl_b32 s5, s42, 7
    s_add_u32 s5, s5, 32768
    v_add_u32 v209, s5, v209
    global_store_dwordx2 v209, v[220:221], s[38:39] sc1
Lc_j5:
    s_cmp_eq_u32 s95, 1
    s_cbranch_scc1 Lc_k2
    v_cmp_eq_u32 vcc, -1, v45
    s_nop 0
    s_cbranch_vccnz Lkf_r
Lkf_ok:
    s_add_u32 m0, s93, 33804
    s_nop 0
    global_load_lds_dwordx4 v28, s[38:39] offset:0 sc1
    global_load_lds_dwordx4 v28, s[38:39] offset:1024 sc1
    global_load_lds_dwordx4 v28, s[38:39] offset:2048 sc1
    global_load_lds_dwordx4 v28, s[38:39] offset:3072 sc1
    s_add_u32 m0, s93, 38448
    s_nop 0
    global_load_lds_dwordx4 v28, s[38:39] offset:0 sc1
    global_load_lds_dwordx4 v28, s[38:39] offset:1024 sc1
    global_load_lds_dwordx4 v28, s[38:39] offset:2048 sc1
    global_load_lds_dwordx4 v28, s[38:39] offset:3072 sc1
Lc_k2:
    v_bfe_u32 v235, v1, 3, 1
    s_sub_u32 s4, s97, s96
    v_mul_u32_u24 v235, s4, v235
    v_add_lshl_u32 v235, v235, s96, 7
    v_mul_u32_u24 v174, 7168, v3
    v_add_u32 v235, v235, v174
    v_and_b32 v174, 112, v4
    v_add_u32 v235, v235, v174
    v_add_u32 v235, 49152, v235
    v_and_b32 v45, 1, v3
    v_mul_u32_u24 v45, 7168, v45
    v_sub_u32 v45, v235, v45
    s_cmp_eq_u32 s95, 1
    s_cbranch_scc1 Lc_k3
    s_waitcnt vmcnt(0)
Lc_k3:
    ds_read_b128 v[122:125], v38 offset:3584
    ds_read_b128 v[126:129], v38 offset:3648
    s_waitcnt lgkmcnt(1)
    v_mfma_f32_16x16x32_bf16 v[90:93], a[0:3], v[122:125], 0
    ds_read_b128 v[130:133], v38 offset:3712
    v_mfma_f32_16x16x32_bf16 v[94:97], a[32:35], v[122:125], 0
    ds_read_b128 v[134:137], v38 offset:3776
    v_mfma_f32_16x16x32_bf16 v[98:101], a[64:67], v[122:125], 0
    ds_read_b128 v[138:141], v38 offset:3840
    v_mov_b32 v166, 0
    v_mfma_f32_16x16x32_bf16 v[102:105], a[96:99], v[122:125], 0
    v_mov_b32 v167, 0
    v_mov_b32 v168, 0
    v_mfma_f32_16x16x32_bf16 v[106:109], a[128:131], v[122:125], 0
    v_mov_b32 v169, 0
    v_mfma_f32_16x16x32_bf16 v[110:113], a[160:163], v[122:125], 0
    s_min_u32 s5, s42, 127
    s_waitcnt lgkmcnt(3)
    v_mfma_f32_16x16x32_bf16 v[90:93], a[4:7], v[126:129], v[90:93]
    ds_read_b128 v[142:145], v38 offset:3904
    s_lshl_b32 s4, s5, 13
    v_mfma_f32_16x16x32_bf16 v[94:97], a[36:39], v[126:129], v[94:97]
    s_add_u32 s4, s4, 15208448
    v_mfma_f32_16x16x32_bf16 v[98:101], a[68:71], v[126:129], v[98:101]
    v_lshl_add_u32 v236, v0, 4, s4
    v_mfma_f32_16x16x32_bf16 v[102:105], a[100:103], v[126:129], v[102:105]
    global_store_dwordx4 v236, v[166:169], s[38:39] offset:-4096 sc1
    v_mfma_f32_16x16x32_bf16 v[106:109], a[132:135], v[126:129], v[106:109]
    global_store_dwordx4 v236, v[166:169], s[38:39] offset:0 sc1
    v_mov_b32 v162, -1
    v_mfma_f32_16x16x32_bf16 v[110:113], a[164:167], v[126:129], v[110:113]
    v_mov_b32 v163, -1
    s_waitcnt lgkmcnt(3)
    v_mfma_f32_16x16x32_bf16 v[90:93], a[8:11], v[130:133], v[90:93]
    ds_read_b128 v[146:149], v38 offset:3968
    v_mov_b32 v164, -1
    v_mfma_f32_16x16x32_bf16 v[94:97], a[40:43], v[130:133], v[94:97]
    v_mov_b32 v165, -1
    v_mfma_f32_16x16x32_bf16 v[98:101], a[72:75], v[130:133], v[98:101]
    s_lshr_b32 s4, s5, 2
    v_mfma_f32_16x16x32_bf16 v[102:105], a[104:107], v[130:133], v[102:105]
    s_mul_i32 s4, s4, 114688
    v_mfma_f32_16x16x32_bf16 v[106:109], a[136:139], v[130:133], v[106:109]
    s_and_b32 s5, s5, 3
    v_mfma_f32_16x16x32_bf16 v[110:113], a[168:171], v[130:133], v[110:113]
    s_lshl_b32 s5, s5, 13
    s_waitcnt lgkmcnt(3)
    v_mfma_f32_16x16x32_bf16 v[90:93], a[12:15], v[134:137], v[90:93]
    ds_read_b128 v[150:153], v38 offset:4032
    s_add_u32 s4, s4, s5
    s_add_u32 s4, s4, 1134592
    v_mfma_f32_16x16x32_bf16 v[94:97], a[44:47], v[134:137], v[94:97]
    v_lshl_add_u32 v236, v0, 4, s4
    v_mfma_f32_16x16x32_bf16 v[98:101], a[76:79], v[134:137], v[98:101]
    global_store_dwordx4 v236, v[162:165], s[38:39] offset:-4096 sc1
    v_mfma_f32_16x16x32_bf16 v[102:105], a[108:111], v[134:137], v[102:105]
    global_store_dwordx4 v236, v[162:165], s[38:39] offset:0 sc1
    v_mfma_f32_16x16x32_bf16 v[106:109], a[140:143], v[134:137], v[106:109]
    s_min_u32 s4, s42, 127
    v_mfma_f32_16x16x32_bf16 v[110:113], a[172:175], v[134:137], v[110:113]
    s_lshl_b32 s4, s4, 10
    s_waitcnt lgkmcnt(3)
    v_mfma_f32_16x16x32_bf16 v[90:93], a[16:19], v[138:141], v[90:93]
    ds_read_b128 v[154:157], v38 offset:3072
    s_add_u32 s4, s4, 12451840
    v_mfma_f32_16x16x32_bf16 v[94:97], a[48:51], v[138:141], v[94:97]
    v_lshl_add_u32 v236, v0, 2, s4
    v_mfma_f32_16x16x32_bf16 v[98:101], a[80:83], v[138:141], v[98:101]
    global_store_dword v236, v162, s[38:39] sc1
    v_mfma_f32_16x16x32_bf16 v[102:105], a[112:115], v[138:141], v[102:105]
    v_and_b32 v67, 7, v1
    v_lshl_add_u32 v67, v3, 3, v67
    v_mfma_f32_16x16x32_bf16 v[106:109], a[144:147], v[138:141], v[106:109]
    v_bfe_u32 v69, v1, 3, 1
    v_lshlrev_b32 v66, 9, v69
    v_mfma_f32_16x16x32_bf16 v[110:113], a[176:179], v[138:141], v[110:113]
    ds_read_b128 v[158:161], v38 offset:3136
    v_lshl_add_u32 v66, v67, 4, v66
    s_mul_i32 s4, s3, 20480
    s_waitcnt lgkmcnt(4)
    v_mfma_f32_16x16x32_bf16 v[90:93], a[20:23], v[142:145], v[90:93]
    s_mul_i32 s5, s40, 114688
    s_add_u32 s4, s4, s5
    s_add_u32 s4, s4, 1048576
    v_mfma_f32_16x16x32_bf16 v[94:97], a[52:55], v[142:145], v[94:97]
    v_add_u32 v66, s4, v66
    v_lshl_add_u32 v70, v67, 1, v69
    v_mfma_f32_16x16x32_bf16 v[98:101], a[84:87], v[142:145], v[98:101]
    v_min_u32 v72, 9, v1
    v_lshl_add_u32 v72, v72, 11, s4
    v_mfma_f32_16x16x32_bf16 v[102:105], a[116:119], v[142:145], v[102:105]
    v_lshrrev_b32 v67, 5, v1
    v_bfe_u32 v68, v1, 1, 1
    v_mfma_f32_16x16x32_bf16 v[106:109], a[148:151], v[142:145], v[106:109]
    ds_read_b128 v[122:125], v38 offset:3200
    v_lshl_add_u32 v67, v67, 1, v68
    v_mfma_f32_16x16x32_bf16 v[110:113], a[180:183], v[142:145], v[110:113]
    v_mul_u32_u24 v68, 1040, v67
    v_bfe_u32 v67, v1, 3, 1
    s_waitcnt lgkmcnt(4)
    v_mfma_f32_16x16x32_bf16 v[90:93], a[24:27], v[146:149], v[90:93]
    v_lshl_add_u32 v68, v67, 3, v68
    v_bfe_u32 v67, v1, 2, 1
    v_mfma_f32_16x16x32_bf16 v[94:97], a[56:59], v[146:149], v[94:97]
    v_lshl_add_u32 v68, v67, 6, v68
    v_bfe_u32 v67, v1, 4, 1
    v_mfma_f32_16x16x32_bf16 v[98:101], a[88:91], v[146:149], v[98:101]
    v_lshl_add_u32 v68, v67, 7, v68
    v_bfe_u32 v67, v1, 0, 1
    v_mfma_f32_16x16x32_bf16 v[102:105], a[120:123], v[146:149], v[102:105]
    ds_read_b128 v[126:129], v38 offset:3264
    v_lshl_add_u32 v68, v67, 5, v68
    s_mul_i32 s5, s3, 20800
    v_mfma_f32_16x16x32_bf16 v[106:109], a[152:155], v[146:149], v[106:109]
    v_add_u32 v68, s5, v68
    v_lshlrev_b32 v30, 3, v1
    s_lshl_b32 s88, s3, 9
    v_mfma_f32_16x16x32_bf16 v[110:113], a[184:187], v[146:149], v[110:113]
    v_lshrrev_b32 v67, 3, v1
    v_lshlrev_b32 v67, 12, v67
    s_waitcnt lgkmcnt(4)
    v_mfma_f32_16x16x32_bf16 v[90:93], a[28:31], v[150:153], v[90:93]
    v_bfe_u32 v69, v1, 4, 1
    v_xor_b32 v69, v69, v1
    v_mfma_f32_16x16x32_bf16 v[94:97], a[60:63], v[150:153], v[94:97]
    v_and_b32 v69, 7, v69
    v_xor_b32 v74, 0, v69
    v_mfma_f32_16x16x32_bf16 v[98:101], a[92:95], v[150:153], v[98:101]
    ds_read_b128 v[130:133], v38 offset:3328
    v_lshl_add_u32 v74, v74, 4, v67
    v_mfma_f32_16x16x32_bf16 v[102:105], a[124:127], v[150:153], v[102:105]
    v_add_u32 v78, 131072, v74
    v_xor_b32 v75, 2, v69
    v_mfma_f32_16x16x32_bf16 v[106:109], a[156:159], v[150:153], v[106:109]
    v_lshl_add_u32 v75, v75, 4, v67
    v_add_u32 v75, 31744, v75
    v_mfma_f32_16x16x32_bf16 v[110:113], a[188:191], v[150:153], v[110:113]
    v_add_u32 v79, 131072, v75
    v_xor_b32 v76, 4, v69
    s_waitcnt lgkmcnt(4)
    v_mfma_f32_16x16x32_bf16 v[94:97], a[0:3], v[154:157], v[94:97]
    v_lshl_add_u32 v76, v76, 4, v67
    v_add_u32 v76, 63488, v76
    v_mfma_f32_16x16x32_bf16 v[98:101], a[32:35], v[154:157], v[98:101]
    ds_read_b128 v[134:137], v38 offset:3392
    v_add_u32 v80, 131072, v76
    v_mfma_f32_16x16x32_bf16 v[102:105], a[64:67], v[154:157], v[102:105]
    v_xor_b32 v77, 6, v69
    v_lshl_add_u32 v77, v77, 4, v67
    v_mfma_f32_16x16x32_bf16 v[106:109], a[96:99], v[154:157], v[106:109]
    v_add_u32 v77, 95232, v77
    v_add_u32 v81, 131072, v77
    v_mfma_f32_16x16x32_bf16 v[110:113], a[128:131], v[154:157], v[110:113]
    v_lshrrev_b32 v69, 1, v2
    v_xor_b32 v69, v69, v3
    s_waitcnt lgkmcnt(4)
    v_mfma_f32_16x16x32_bf16 v[94:97], a[4:7], v[158:161], v[94:97]
    v_lshlrev_b32 v69, 4, v69
    v_lshl_add_u32 v69, v5, 7, v69
    s_xor_b32 s4, s3, 0
    v_mfma_f32_16x16x32_bf16 v[98:101], a[36:39], v[158:161], v[98:101]
    ds_read_b128 v[138:141], v38 offset:3456
    s_lshr_b32 s5, s4, 1
    s_lshl_b32 s5, s5, 12
    v_mfma_f32_16x16x32_bf16 v[102:105], a[68:71], v[158:161], v[102:105]
    s_and_b32 s4, s4, 1
    s_lshl_b32 s4, s4, 9
    s_add_u32 s4, s4, s5
    v_mfma_f32_16x16x32_bf16 v[106:109], a[100:103], v[158:161], v[106:109]
    s_add_u32 s4, s4, s89
    v_add_u32 v82, s4, v69
    v_xor_b32 v83, 64, v82
    v_mfma_f32_16x16x32_bf16 v[110:113], a[132:135], v[158:161], v[110:113]
    s_xor_b32 s4, s3, 1
    s_lshr_b32 s5, s4, 1
    s_lshl_b32 s5, s5, 12
    s_waitcnt lgkmcnt(4)
    v_mfma_f32_16x16x32_bf16 v[94:97], a[8:11], v[122:125], v[94:97]
    s_and_b32 s4, s4, 1
    s_lshl_b32 s4, s4, 9
    s_add_u32 s4, s4, s5
    v_mfma_f32_16x16x32_bf16 v[98:101], a[40:43], v[122:125], v[98:101]
    ds_read_b128 v[142:145], v38 offset:3520
    s_add_u32 s4, s4, s89
    v_add_u32 v84, s4, v69
    v_mfma_f32_16x16x32_bf16 v[102:105], a[72:75], v[122:125], v[102:105]
    v_xor_b32 v85, 64, v84
    s_xor_b32 s4, s3, 2
    s_lshr_b32 s5, s4, 1
    v_mfma_f32_16x16x32_bf16 v[106:109], a[104:107], v[122:125], v[106:109]
    s_lshl_b32 s5, s5, 12
    s_and_b32 s4, s4, 1
    s_lshl_b32 s4, s4, 9
    v_mfma_f32_16x16x32_bf16 v[110:113], a[136:139], v[122:125], v[110:113]
    s_add_u32 s4, s4, s5
    s_add_u32 s4, s4, s89
    v_add_u32 v86, s4, v69
    s_waitcnt lgkmcnt(4)
    v_mfma_f32_16x16x32_bf16 v[94:97], a[12:15], v[126:129], v[94:97]
    v_xor_b32 v87, 64, v86
    s_xor_b32 s4, s3, 3
    s_lshr_b32 s5, s4, 1
    v_mfma_f32_16x16x32_bf16 v[98:101], a[44:47], v[126:129], v[98:101]
    ds_read_b128 v[146:149], v38 offset:2560
    s_lshl_b32 s5, s5, 12
    s_and_b32 s4, s4, 1
    v_mfma_f32_16x16x32_bf16 v[102:105], a[76:79], v[126:129], v[102:105]
    s_lshl_b32 s4, s4, 9
    s_add_u32 s4, s4, s5
    s_add_u32 s4, s4, s89
    v_mfma_f32_16x16x32_bf16 v[106:109], a[108:111], v[126:129], v[106:109]
    v_add_u32 v88, s4, v69
    v_xor_b32 v89, 64, v88
    v_mfma_f32_16x16x32_bf16 v[110:113], a[140:143], v[126:129], v[110:113]
    s_add_u32 s52, s8, 1146880
    s_addc_u32 s53, s9, 0
    s_waitcnt lgkmcnt(4)
    v_mfma_f32_16x16x32_bf16 v[94:97], a[16:19], v[130:133], v[94:97]
    ds_read_b128 v[150:153], v38 offset:2624
    s_add_u32 s54, s10, 1146880
    s_addc_u32 s55, s11, 0
    v_mfma_f32_16x16x32_bf16 v[98:101], a[48:51], v[130:133], v[98:101]
    s_add_u32 s56, s12, 1146880
    s_addc_u32 s57, s13, 0
    v_mfma_f32_16x16x32_bf16 v[102:105], a[80:83], v[130:133], v[102:105]
    s_add_u32 s58, s14, 1146880
    s_addc_u32 s59, s15, 0
    v_mfma_f32_16x16x32_bf16 v[106:109], a[112:115], v[130:133], v[106:109]
    s_add_u32 s60, s16, 1146880
    s_addc_u32 s61, s17, 0
    s_add_u32 s62, s18, 1146880
    s_addc_u32 s63, s19, 0
    v_mfma_f32_16x16x32_bf16 v[110:113], a[144:147], v[130:133], v[110:113]
    ds_read_b128 v[154:157], v38 offset:2688
    s_mov_b32 s84, 0xc0135761
    s_mov_b32 s85, 0xbdd2d3e8
    s_waitcnt lgkmcnt(5)
    v_mfma_f32_16x16x32_bf16 v[94:97], a[20:23], v[134:137], v[94:97]
    v_lshlrev_b32 v32, 16, v27
    v_lshlrev_b32 v33, 16, v27
    v_lshlrev_b32 v34, 16, v27
    v_mfma_f32_16x16x32_bf16 v[98:101], a[52:55], v[134:137], v[98:101]
    v_lshlrev_b32 v35, 16, v27
    s_mul_i32 s5, s41, 10
    s_mul_i32 s6, s3, 1040
    v_mfma_f32_16x16x32_bf16 v[102:105], a[84:87], v[134:137], v[102:105]
    v_add_u32 v67, s5, v3
    v_lshrrev_b32 v69, 2, v67
    v_mul_u32_u24 v69, 3136, v69
    v_mfma_f32_16x16x32_bf16 v[106:109], a[116:119], v[134:137], v[106:109]
    ds_read_b128 v[158:161], v38 offset:2752
    v_lshl_add_u32 v69, v67, 8, v69
    v_lshl_add_u32 v69, v2, 4, v69
    v_add_u32 v46, s6, v69
    v_mfma_f32_16x16x32_bf16 v[110:113], a[148:151], v[134:137], v[110:113]
    v_lshrrev_b32 v67, 1, v3
    v_add_u32 v67, s5, v67
    v_lshrrev_b32 v69, 2, v67
    s_waitcnt lgkmcnt(5)
    v_mfma_f32_16x16x32_bf16 v[94:97], a[24:27], v[138:141], v[94:97]
    v_mul_u32_u24 v69, 3136, v69
    v_lshl_add_u32 v69, v67, 8, v69
    v_lshl_add_u32 v69, v2, 4, v69
    v_mfma_f32_16x16x32_bf16 v[98:101], a[56:59], v[138:141], v[98:101]
    v_add_u32 v47, s6, v69
    v_and_b32 v67, 1, v3
    v_lshl_add_u32 v47, v67, 3, v47
    v_mfma_f32_16x16x32_bf16 v[102:105], a[88:91], v[138:141], v[102:105]
    ds_read_b128 v[122:125], v38 offset:2816
    v_lshlrev_b32 v28, 4, v0
    v_mfma_f32_16x16x32_bf16 v[106:109], a[120:123], v[138:141], v[106:109]
    v_add_u32 v28, 36864, v28
    global_load_dwordx4 v[214:217], v28, s[38:39] offset:-4096 sc1
    v_mfma_f32_16x16x32_bf16 v[110:113], a[152:155], v[138:141], v[110:113]
    global_load_dwordx4 v[218:221], v28, s[38:39] offset:0 sc1
    s_waitcnt lgkmcnt(5)
    v_mfma_f32_16x16x32_bf16 v[94:97], a[28:31], v[142:145], v[94:97]
    v_add_u32 v28, 8192, v28
    global_load_dwordx4 v[222:225], v28, s[38:39] offset:-4096 sc1
    v_mfma_f32_16x16x32_bf16 v[98:101], a[60:63], v[142:145], v[98:101]
    ds_read_b128 v[126:129], v38 offset:2880
    global_load_dwordx4 v[226:229], v28, s[38:39] offset:0 sc1
    v_mfma_f32_16x16x32_bf16 v[102:105], a[92:95], v[142:145], v[102:105]
    v_min_u32 v28, 11, v1
    v_mfma_f32_16x16x32_bf16 v[106:109], a[124:127], v[142:145], v[106:109]
    v_lshrrev_b32 v29, 2, v28
    v_mul_u32_u24 v29, 2544, v29
    v_mfma_f32_16x16x32_bf16 v[110:113], a[156:159], v[142:145], v[110:113]
    v_lshl_add_u32 v28, v28, 2, v29
    s_waitcnt lgkmcnt(5)
    v_mfma_f32_16x16x32_bf16 v[98:101], a[0:3], v[146:149], v[98:101]
    ds_read_b128 v[130:133], v38 offset:2944
    s_lshl_b32 s4, s42, 4
    v_mfma_f32_16x16x32_bf16 v[102:105], a[32:35], v[146:149], v[102:105]
    s_add_u32 s4, s4, 0
    v_add_u32 v28, s4, v28
    v_mfma_f32_16x16x32_bf16 v[106:109], a[64:67], v[146:149], v[106:109]
    global_load_dword v64, v28, s[38:39] sc1
    v_mfma_f32_16x16x32_bf16 v[110:113], a[96:99], v[146:149], v[110:113]
    v_add_u32 v28, 15360, v28
    s_waitcnt lgkmcnt(5)
    v_mfma_f32_16x16x32_bf16 v[98:101], a[4:7], v[150:153], v[98:101]
    ds_read_b128 v[134:137], v38 offset:3008
    global_load_dword v65, v28, s[38:39] sc1
    v_mfma_f32_16x16x32_bf16 v[102:105], a[36:39], v[150:153], v[102:105]
    v_cvt_pk_bf16_f32 v48, v90, v91
    v_cvt_pk_bf16_f32 v49, v92, v93
    v_mfma_f32_16x16x32_bf16 v[106:109], a[68:71], v[150:153], v[106:109]
    ds_write2_b32 v40, v48, v49 offset0:0 offset1:2
    v_mfma_f32_16x16x32_bf16 v[110:113], a[100:103], v[150:153], v[110:113]
    v_cvt_pk_bf16_f32 v50, v94, v95
    s_waitcnt lgkmcnt(6)
    v_mfma_f32_16x16x32_bf16 v[98:101], a[8:11], v[154:157], v[98:101]
    ds_read_b128 v[138:141], v38 offset:2048
    v_cvt_pk_bf16_f32 v51, v96, v97
    v_mfma_f32_16x16x32_bf16 v[102:105], a[40:43], v[154:157], v[102:105]
    ds_write2_b32 v40, v50, v51 offset0:128 offset1:130
    v_mfma_f32_16x16x32_bf16 v[106:109], a[72:75], v[154:157], v[106:109]
    v_add_u32 v40, 4224, v40
    v_mfma_f32_16x16x32_bf16 v[110:113], a[104:107], v[154:157], v[110:113]
    ds_read_b128 v[142:145], v38 offset:2112
    s_waitcnt lgkmcnt(8)
    v_mfma_f32_16x16x32_bf16 v[98:101], a[12:15], v[158:161], v[98:101]
    s_waitcnt lgkmcnt(0)
    s_barrier
    v_mfma_f32_16x16x32_bf16 v[102:105], a[44:47], v[158:161], v[102:105]
    v_mfma_f32_16x16x32_bf16 v[106:109], a[76:79], v[158:161], v[106:109]
    ds_read_b128 v[146:149], v38 offset:2176
    ds_read_b32 v52, v41 offset:0
    v_mfma_f32_16x16x32_bf16 v[110:113], a[108:111], v[158:161], v[110:113]
    ds_read_b32 v53, v41 offset:1056
    v_mfma_f32_16x16x32_bf16 v[98:101], a[16:19], v[122:125], v[98:101]
    ds_read_b32 v54, v41 offset:2112
    v_mfma_f32_16x16x32_bf16 v[102:105], a[48:51], v[122:125], v[102:105]
    ds_read_b128 v[150:153], v38 offset:2240
    ds_read_b32 v55, v41 offset:3168
    v_mfma_f32_16x16x32_bf16 v[106:109], a[80:83], v[122:125], v[106:109]
    ds_read_b32 v56, v39 offset:3072
    v_mfma_f32_16x16x32_bf16 v[110:113], a[112:115], v[122:125], v[110:113]
    v_mfma_f32_16x16x32_bf16 v[98:101], a[20:23], v[126:129], v[98:101]
    ds_read_b128 v[154:157], v38 offset:2304
    ds_read_b32 v57, v39 offset:12352
    v_mfma_f32_16x16x32_bf16 v[102:105], a[52:55], v[126:129], v[102:105]
    ds_read_b32 v58, v39 offset:21632
    v_mfma_f32_16x16x32_bf16 v[106:109], a[84:87], v[126:129], v[106:109]
    ds_read_b32 v59, v39 offset:30912
    v_mfma_f32_16x16x32_bf16 v[110:113], a[116:119], v[126:129], v[110:113]
    ds_read_b128 v[158:161], v38 offset:2368
    s_waitcnt lgkmcnt(10)
    v_lshlrev_b32 v90, 16, v52
    v_mfma_f32_16x16x32_bf16 v[98:101], a[24:27], v[130:133], v[98:101]
    v_and_b32 v94, 0xffff0000, v52
    v_mfma_f32_16x16x32_bf16 v[102:105], a[56:59], v[130:133], v[102:105]
    s_waitcnt lgkmcnt(9)
    v_lshlrev_b32 v91, 16, v53
    v_mfma_f32_16x16x32_bf16 v[106:109], a[88:91], v[130:133], v[106:109]
    ds_read_b128 v[122:125], v38 offset:2432
    v_and_b32 v95, 0xffff0000, v53
    v_mfma_f32_16x16x32_bf16 v[110:113], a[120:123], v[130:133], v[110:113]
    v_mfma_f32_16x16x32_bf16 v[98:101], a[28:31], v[134:137], v[98:101]
    s_waitcnt lgkmcnt(9)
    v_lshlrev_b32 v92, 16, v54
    v_mfma_f32_16x16x32_bf16 v[102:105], a[60:63], v[134:137], v[102:105]
    ds_read_b128 v[126:129], v38 offset:2496
    v_and_b32 v96, 0xffff0000, v54
    v_mfma_f32_16x16x32_bf16 v[106:109], a[92:95], v[134:137], v[106:109]
    s_waitcnt lgkmcnt(8)
    v_lshlrev_b32 v93, 16, v55
    v_mfma_f32_16x16x32_bf16 v[110:113], a[124:127], v[134:137], v[110:113]
    v_and_b32 v97, 0xffff0000, v55
    v_mfma_f32_16x16x32_bf16 v[102:105], a[0:3], v[138:141], v[102:105]
    ds_read_b128 v[130:133], v38 offset:1536
    global_load_dword v234, v45, s[38:39] sc1
    v_mfma_f32_16x16x32_bf16 v[106:109], a[32:35], v[138:141], v[106:109]
    s_waitcnt lgkmcnt(8)
    v_and_b32 v194, 0xffff0000, v56
    s_waitcnt lgkmcnt(6)
    v_and_b32 v195, 0xffff0000, v57
    v_mfma_f32_16x16x32_bf16 v[110:113], a[64:67], v[138:141], v[110:113]
    ds_read_b128 v[134:137], v38 offset:1600
    s_waitcnt vmcnt(6)
    v_max_u32 v236, v215, v217
    v_mfma_f32_16x16x32_bf16 v[102:105], a[4:7], v[142:145], v[102:105]
    s_waitcnt vmcnt(5)
    v_max3_u32 v236, v219, v221, v236
    s_waitcnt vmcnt(4)
    v_max3_u32 v236, v223, v225, v236
    v_mfma_f32_16x16x32_bf16 v[106:109], a[36:39], v[142:145], v[106:109]
    ds_read_b128 v[138:141], v38 offset:1664
    s_waitcnt lgkmcnt(7)
    v_and_b32 v196, 0xffff0000, v58
    v_mfma_f32_16x16x32_bf16 v[110:113], a[68:71], v[142:145], v[110:113]
    s_waitcnt vmcnt(3)
    v_max3_u32 v236, v227, v229, v236
    s_waitcnt vmcnt(1)
    v_max3_u32 v236, v64, v65, v236
    v_mfma_f32_16x16x32_bf16 v[102:105], a[8:11], v[146:149], v[102:105]
    ds_read_b128 v[142:145], v38 offset:1728
    s_waitcnt lgkmcnt(7)
    v_and_b32 v197, 0xffff0000, v59
    v_mfma_f32_16x16x32_bf16 v[106:109], a[40:43], v[146:149], v[106:109]
    v_cmp_eq_u32 vcc, -1, v236
    s_nop 0
    s_cbranch_vccnz Lax_r
Lax_ok:
    v_fmac_f32 v90, s20, v194
    v_mfma_f32_16x16x32_bf16 v[110:113], a[72:75], v[146:149], v[110:113]
    ds_read_b128 v[146:149], v38 offset:1792
    v_add_u32 v42, 0, v43
    v_mfma_f32_16x16x32_bf16 v[102:105], a[12:15], v[150:153], v[102:105]
    global_load_dwordx4 v[198:201], v42, s[38:39] sc1
    v_fmac_f32 v91, s21, v195
    v_mfma_f32_16x16x32_bf16 v[106:109], a[44:47], v[150:153], v[106:109]
    v_add_u32 v42, 917504, v43
    global_load_dwordx4 v[202:205], v42, s[38:39] sc1
    v_mfma_f32_16x16x32_bf16 v[110:113], a[76:79], v[150:153], v[110:113]
    ds_read_b128 v[150:153], v38 offset:1856
    v_fmac_f32 v92, s22, v196
    v_mfma_f32_16x16x32_bf16 v[102:105], a[16:19], v[154:157], v[102:105]
    v_add_u32 v42, 1835008, v43
    global_load_dwordx4 v[206:209], v42, s[38:39] sc1
    v_mfma_f32_16x16x32_bf16 v[106:109], a[48:51], v[154:157], v[106:109]
    v_add_u32 v42, 2752512, v43
    v_fmac_f32 v93, s23, v197
    v_mfma_f32_16x16x32_bf16 v[110:113], a[80:83], v[154:157], v[110:113]
    ds_read_b128 v[154:157], v38 offset:1920
    global_load_dwordx4 v[210:213], v42, s[38:39] sc1
    s_waitcnt lgkmcnt(9)
    v_mfma_f32_16x16x32_bf16 v[102:105], a[20:23], v[158:161], v[102:105]
    v_add_f32 v64, v64, v65
    v_lshlrev_b32 v194, 16, v56
    v_mfma_f32_16x16x32_bf16 v[106:109], a[52:55], v[158:161], v[106:109]
    v_cvt_pk_bf16_f32 v64, v64, v64
    v_lshlrev_b32 v195, 16, v57
    v_mfma_f32_16x16x32_bf16 v[110:113], a[84:87], v[158:161], v[110:113]
    ds_read_b128 v[158:161], v38 offset:1984
    v_lshlrev_b32 v64, 16, v64
    v_lshlrev_b32 v196, 16, v58
    v_lshlrev_b32 v197, 16, v59
    v_fmac_f32 v94, s20, v194
    s_waitcnt lgkmcnt(9)
    v_mfma_f32_16x16x32_bf16 v[102:105], a[24:27], v[122:125], v[102:105]
    v_fmac_f32 v95, s21, v195
    v_fmac_f32 v96, s22, v196
    v_fmac_f32 v97, s23, v197
    v_mfma_f32_16x16x32_bf16 v[106:109], a[56:59], v[122:125], v[106:109]
    v_mov_b32 v29, 1.0
    s_nop 1
    v_add_f32_dpp v64, v64, v29 quad_perm:[0,1,2,3] row_mask:0xf bank_mask:0x2
    v_mfma_f32_16x16x32_bf16 v[110:113], a[88:91], v[122:125], v[110:113]
    ds_read_b128 v[122:125], v38 offset:1024
    v_cvt_pk_bf16_f32 v64, v64, v64
    s_waitcnt lgkmcnt(9)
    v_mfma_f32_16x16x32_bf16 v[102:105], a[28:31], v[126:129], v[102:105]
    v_lshlrev_b32 v64, 16, v64
    s_nop 1
    v_mul_f32_dpp v65, v64, v64 row_shl:8 row_mask:0xf bank_mask:0x1
    v_mfma_f32_16x16x32_bf16 v[106:109], a[60:63], v[126:129], v[106:109]
    s_nop 0
    v_mul_f32_dpp v65, v64, v64 row_shl:4 row_mask:0xf bank_mask:0x2
    s_nop 0
    v_readlane_b32 s32, v65, 0
    v_mfma_f32_16x16x32_bf16 v[110:113], a[92:95], v[126:129], v[110:113]
    ds_read_b128 v[126:129], v38 offset:1088
    v_readlane_b32 s33, v65, 1
    v_readlane_b32 s86, v65, 2
    s_waitcnt lgkmcnt(9)
    v_mfma_f32_16x16x32_bf16 v[106:109], a[0:3], v[130:133], v[106:109]
    v_readlane_b32 s87, v65, 3
    v_readlane_b32 s64, v65, 4
    v_readlane_b32 s65, v65, 5
    v_mfma_f32_16x16x32_bf16 v[110:113], a[32:35], v[130:133], v[110:113]
    ds_read_b128 v[130:133], v38 offset:1152
    v_readlane_b32 s66, v65, 6
    v_readlane_b32 s67, v65, 7
    v_mov_b32 v60, s32
    s_waitcnt lgkmcnt(9)
    v_mfma_f32_16x16x32_bf16 v[106:109], a[4:7], v[134:137], v[106:109]
    v_mov_b32 v61, s33
    v_mov_b32 v62, s86
    v_mov_b32 v63, s87
    v_mfma_f32_16x16x32_bf16 v[110:113], a[36:39], v[134:137], v[110:113]
    ds_read_b128 v[134:137], v38 offset:1216
    s_waitcnt lgkmcnt(9)
    v_mfma_f32_16x16x32_bf16 v[106:109], a[8:11], v[138:141], v[106:109]
    v_cvt_pk_bf16_f32 v48, v98, v99
    s_barrier
    v_cvt_pk_bf16_f32 v49, v100, v101
    v_mfma_f32_16x16x32_bf16 v[110:113], a[40:43], v[138:141], v[110:113]
    ds_read_b128 v[138:141], v38 offset:1280
    ds_write2_b32 v40, v48, v49 offset0:0 offset1:2
    s_waitcnt lgkmcnt(10)
    v_mfma_f32_16x16x32_bf16 v[106:109], a[12:15], v[142:145], v[106:109]
    v_cvt_pk_bf16_f32 v50, v102, v103
    v_cvt_pk_bf16_f32 v51, v104, v105
    v_mfma_f32_16x16x32_bf16 v[110:113], a[44:47], v[142:145], v[110:113]
    ds_read_b128 v[142:145], v38 offset:1344
    ds_write2_b32 v40, v50, v51 offset0:128 offset1:130
    s_waitcnt lgkmcnt(11)
    v_mfma_f32_16x16x32_bf16 v[106:109], a[16:19], v[146:149], v[106:109]
    v_add_u32 v40, 4224, v40
    s_add_u32 m0, s89, 0
    v_mfma_f32_16x16x32_bf16 v[110:113], a[48:51], v[146:149], v[110:113]
    ds_read_b128 v[146:149], v38 offset:1408
    s_waitcnt lgkmcnt(11)
    v_mfma_f32_16x16x32_bf16 v[106:109], a[20:23], v[150:153], v[106:109]
    s_waitcnt lgkmcnt(0)
    s_barrier
    v_mfma_f32_16x16x32_bf16 v[110:113], a[52:55], v[150:153], v[110:113]
    ds_read_b128 v[150:153], v38 offset:1472
    ds_read_b32 v52, v41 offset:4224
    v_mfma_f32_16x16x32_bf16 v[106:109], a[24:27], v[154:157], v[106:109]
    ds_read_b32 v53, v41 offset:5280
    ds_read_b32 v54, v41 offset:6336
    v_mfma_f32_16x16x32_bf16 v[110:113], a[56:59], v[154:157], v[110:113]
    ds_read_b128 v[154:157], v38 offset:3584
    ds_read_b32 v55, v41 offset:7392
    v_mfma_f32_16x16x32_bf16 v[106:109], a[28:31], v[158:161], v[106:109]
    ds_read_b32 v56, v39 offset:2048
    ds_read_b32 v57, v39 offset:11328
    v_mfma_f32_16x16x32_bf16 v[110:113], a[60:63], v[158:161], v[110:113]
    ds_read_b128 v[158:161], v38 offset:3648
    ds_read_b32 v58, v39 offset:20608
    v_mfma_f32_16x16x32_bf16 v[110:113], a[0:3], v[122:125], v[110:113]
    ds_read_b128 v[122:125], v38 offset:3712
    ds_read_b32 v59, v39 offset:29888
    v_mfma_f32_16x16x32_bf16 v[110:113], a[4:7], v[126:129], v[110:113]
    ds_read_b128 v[126:129], v38 offset:3776
    s_waitcnt lgkmcnt(11)
    v_lshlrev_b32 v98, 16, v52
    v_mfma_f32_16x16x32_bf16 v[110:113], a[8:11], v[130:133], v[110:113]
    ds_read_b128 v[130:133], v38 offset:3840
    v_and_b32 v102, 0xffff0000, v52
    v_mfma_f32_16x16x32_bf16 v[110:113], a[12:15], v[134:137], v[110:113]
    ds_read_b128 v[134:137], v38 offset:3904
    global_load_lds_dwordx4 v74, s[68:69] offset:0
    v_mfma_f32_16x16x32_bf16 v[110:113], a[16:19], v[138:141], v[110:113]
    ds_read_b128 v[138:141], v38 offset:3968
    s_waitcnt lgkmcnt(13)
    v_lshlrev_b32 v99, 16, v53
    v_mfma_f32_16x16x32_bf16 v[110:113], a[20:23], v[142:145], v[110:113]
    ds_read_b128 v[142:145], v38 offset:4032
    v_and_b32 v103, 0xffff0000, v53
    v_mfma_f32_16x16x32_bf16 v[110:113], a[24:27], v[146:149], v[110:113]
    ds_read_b128 v[146:149], v38 offset:3072
    s_waitcnt lgkmcnt(14)
    v_lshlrev_b32 v100, 16, v54
    v_mfma_f32_16x16x32_bf16 v[110:113], a[28:31], v[150:153], v[110:113]
    ds_read_b128 v[150:153], v38 offset:3136
    v_and_b32 v104, 0xffff0000, v54
    s_waitcnt lgkmcnt(14)
    v_mfma_f32_16x16x32_bf16 v[118:121], a[224:227], v[154:157], 0
    s_waitcnt lgkmcnt(13)
    v_lshlrev_b32 v101, 16, v55
    v_and_b32 v105, 0xffff0000, v55
    v_mfma_f32_16x16x32_bf16 v[114:117], a[192:195], v[154:157], 0
    ds_read_b128 v[154:157], v38 offset:3200
    s_waitcnt lgkmcnt(13)
    v_and_b32 v194, 0xffff0000, v56
    s_waitcnt lgkmcnt(11)
    v_mfma_f32_16x16x32_bf16 v[118:121], a[228:231], v[158:161], v[118:121]
    s_waitcnt vmcnt(5)
    v_cmp_eq_u32 vcc, -1, v234
    v_and_b32 v195, 0xffff0000, v57
    s_waitcnt lgkmcnt(10)
    v_and_b32 v196, 0xffff0000, v58
    s_waitcnt lgkmcnt(8)
    v_and_b32 v197, 0xffff0000, v59
    v_mfma_f32_16x16x32_bf16 v[114:117], a[196:199], v[158:161], v[114:117]
    ds_read_b128 v[158:161], v38 offset:3264
    global_load_lds_dwordx4 v75, s[68:69] offset:1024
    v_fmac_f32 v98, s20, v194
    v_fmac_f32 v99, s21, v195
    v_fmac_f32 v100, s22, v196
    v_mfma_f32_16x16x32_bf16 v[118:121], a[232:235], v[122:125], v[118:121]
    s_cbranch_vccnz Lcu_r
Lcu_ok:
    v_fmac_f32 v101, s23, v197
    v_lshlrev_b32 v194, 16, v56
    v_lshlrev_b32 v195, 16, v57
    v_mfma_f32_16x16x32_bf16 v[114:117], a[200:203], v[122:125], v[114:117]
    ds_read_b128 v[122:125], v38 offset:3328
    global_load_lds_dwordx4 v76, s[68:69] offset:2048
    v_lshlrev_b32 v196, 16, v58
    v_lshlrev_b32 v197, 16, v59
    v_fmac_f32 v102, s20, v194
    s_waitcnt lgkmcnt(9)
    v_mfma_f32_16x16x32_bf16 v[118:121], a[236:239], v[126:129], v[118:121]
    v_fmac_f32 v103, s21, v195
    v_fmac_f32 v104, s22, v196
    v_fmac_f32 v105, s23, v197
    v_mfma_f32_16x16x32_bf16 v[114:117], a[204:207], v[126:129], v[114:117]
    ds_read_b128 v[126:129], v38 offset:3392
    global_load_lds_dwordx4 v77, s[68:69] offset:3072
    s_waitcnt lgkmcnt(9)
    v_mfma_f32_16x16x32_bf16 v[118:121], a[240:243], v[130:133], v[118:121]
    v_cvt_pk_bf16_f32 v48, v106, v107
    v_cvt_pk_bf16_f32 v49, v108, v109
    s_add_u32 m0, s89, 4096
    v_mfma_f32_16x16x32_bf16 v[114:117], a[208:211], v[130:133], v[114:117]
    ds_read_b128 v[130:133], v38 offset:3456
    ds_write2_b32 v40, v48, v49 offset0:0 offset1:2
    s_waitcnt lgkmcnt(10)
    v_mfma_f32_16x16x32_bf16 v[118:121], a[244:247], v[134:137], v[118:121]
    v_cvt_pk_bf16_f32 v50, v110, v111
    v_cvt_pk_bf16_f32 v51, v112, v113
    v_mfma_f32_16x16x32_bf16 v[114:117], a[212:215], v[134:137], v[114:117]
    ds_read_b128 v[134:137], v38 offset:3520
    ds_write2_b32 v40, v50, v51 offset0:128 offset1:130
    s_waitcnt lgkmcnt(11)
    v_mfma_f32_16x16x32_bf16 v[118:121], a[248:251], v[138:141], v[118:121]
    v_add_u32 v40, 4224, v40
    s_waitcnt lgkmcnt(0)
    s_barrier
    v_mfma_f32_16x16x32_bf16 v[114:117], a[216:219], v[138:141], v[114:117]
    ds_read_b128 v[138:141], v38 offset:2560
    ds_read_b32 v52, v41 offset:8448
    v_mfma_f32_16x16x32_bf16 v[118:121], a[252:255], v[142:145], v[118:121]
    ds_read_b32 v53, v41 offset:9504
    global_load_lds_dwordx4 v78, s[68:69] offset:0
    v_mfma_f32_16x16x32_bf16 v[114:117], a[220:223], v[142:145], v[114:117]
    ds_read_b128 v[142:145], v38 offset:2624
    ds_read_b32 v54, v41 offset:10560
    v_mfma_f32_16x16x32_bf16 v[118:121], a[192:195], v[146:149], v[118:121]
    ds_read_b32 v55, v41 offset:11616
    ds_read_b32 v56, v39 offset:1024
    v_mfma_f32_16x16x32_bf16 v[114:117], a[160:163], v[146:149], v[114:117]
    ds_read_b128 v[146:149], v38 offset:2688
    ds_read_b32 v57, v39 offset:10304
    v_mfma_f32_16x16x32_bf16 v[118:121], a[196:199], v[150:153], v[118:121]
    ds_read_b32 v58, v39 offset:19584
    ds_read_b32 v59, v39 offset:28864
    v_mfma_f32_16x16x32_bf16 v[114:117], a[164:167], v[150:153], v[114:117]
    ds_read_b128 v[150:153], v38 offset:2752
    s_waitcnt lgkmcnt(10)
    v_lshlrev_b32 v106, 16, v52
    v_mfma_f32_16x16x32_bf16 v[118:121], a[200:203], v[154:157], v[118:121]
    global_load_lds_dwordx4 v79, s[68:69] offset:1024
    v_and_b32 v110, 0xffff0000, v52
    v_mfma_f32_16x16x32_bf16 v[114:117], a[168:171], v[154:157], v[114:117]
    ds_read_b128 v[154:157], v38 offset:2816
    s_waitcnt lgkmcnt(10)
    v_lshlrev_b32 v107, 16, v53
    v_mfma_f32_16x16x32_bf16 v[118:121], a[204:207], v[158:161], v[118:121]
    v_and_b32 v111, 0xffff0000, v53
    s_waitcnt lgkmcnt(8)
    v_lshlrev_b32 v108, 16, v54
    v_mfma_f32_16x16x32_bf16 v[114:117], a[172:175], v[158:161], v[114:117]
    ds_read_b128 v[158:161], v38 offset:2880
    v_and_b32 v112, 0xffff0000, v54
    v_mfma_f32_16x16x32_bf16 v[118:121], a[208:211], v[122:125], v[118:121]
    s_waitcnt lgkmcnt(8)
    v_lshlrev_b32 v109, 16, v55
    v_and_b32 v113, 0xffff0000, v55
    v_mfma_f32_16x16x32_bf16 v[114:117], a[176:179], v[122:125], v[114:117]
    ds_read_b128 v[122:125], v38 offset:2944
    global_load_lds_dwordx4 v80, s[68:69] offset:2048
    v_mfma_f32_16x16x32_bf16 v[118:121], a[212:215], v[126:129], v[118:121]
    s_waitcnt lgkmcnt(8)
    v_and_b32 v194, 0xffff0000, v56
    s_waitcnt lgkmcnt(6)
    v_and_b32 v195, 0xffff0000, v57
    v_mfma_f32_16x16x32_bf16 v[114:117], a[180:183], v[126:129], v[114:117]
    ds_read_b128 v[126:129], v38 offset:3008
    s_waitcnt lgkmcnt(6)
    v_and_b32 v196, 0xffff0000, v58
    v_mfma_f32_16x16x32_bf16 v[118:121], a[216:219], v[130:133], v[118:121]
    s_waitcnt lgkmcnt(5)
    v_and_b32 v197, 0xffff0000, v59
    v_fmac_f32 v106, s20, v194
    v_mfma_f32_16x16x32_bf16 v[114:117], a[184:187], v[130:133], v[114:117]
    ds_read_b128 v[130:133], v38 offset:2048
    v_fmac_f32 v107, s21, v195
    v_mfma_f32_16x16x32_bf16 v[118:121], a[220:223], v[134:137], v[118:121]
    v_fmac_f32 v108, s22, v196
    global_load_lds_dwordx4 v81, s[68:69] offset:3072
    v_mfma_f32_16x16x32_bf16 v[114:117], a[188:191], v[134:137], v[114:117]
    ds_read_b128 v[134:137], v38 offset:2112
    v_fmac_f32 v109, s23, v197
    v_mfma_f32_16x16x32_bf16 v[118:121], a[160:163], v[138:141], v[118:121]
    v_lshlrev_b32 v194, 16, v56
    v_lshlrev_b32 v195, 16, v57
    v_mfma_f32_16x16x32_bf16 v[114:117], a[128:131], v[138:141], v[114:117]
    ds_read_b128 v[138:141], v38 offset:2176
    v_lshlrev_b32 v196, 16, v58
    v_mfma_f32_16x16x32_bf16 v[118:121], a[164:167], v[142:145], v[118:121]
    v_lshlrev_b32 v197, 16, v59
    v_fmac_f32 v110, s20, v194
    v_mfma_f32_16x16x32_bf16 v[114:117], a[132:135], v[142:145], v[114:117]
    ds_read_b128 v[142:145], v38 offset:2240
    v_fmac_f32 v111, s21, v195
    v_fmac_f32 v112, s22, v196
    v_fmac_f32 v113, s23, v197
    v_mfma_f32_16x16x32_bf16 v[118:121], a[168:171], v[146:149], v[118:121]
    s_waitcnt vmcnt(11)
    v_lshlrev_b32 v162, 16, v198
    global_load_dwordx4 a[248:251], v4, s[12:13] offset:-1024 sc1
    v_mfma_f32_16x16x32_bf16 v[114:117], a[136:139], v[146:149], v[114:117]
    ds_read_b128 v[146:149], v38 offset:2304
    v_and_b32 v163, 0xffff0000, v198
    s_waitcnt lgkmcnt(9)
    v_mfma_f32_16x16x32_bf16 v[118:121], a[172:175], v[150:153], v[118:121]
    v_lshlrev_b32 v164, 16, v199
    v_and_b32 v165, 0xffff0000, v199
    v_mfma_f32_16x16x32_bf16 v[114:117], a[140:143], v[150:153], v[114:117]
    ds_read_b128 v[150:153], v38 offset:2368
    v_lshlrev_b32 v166, 16, v200
    s_waitcnt lgkmcnt(9)
    v_mfma_f32_16x16x32_bf16 v[118:121], a[176:179], v[154:157], v[118:121]
    v_and_b32 v167, 0xffff0000, v200
    v_lshlrev_b32 v168, 16, v201
    v_mfma_f32_16x16x32_bf16 v[114:117], a[144:147], v[154:157], v[114:117]
    ds_read_b128 v[154:157], v38 offset:2432
    v_and_b32 v169, 0xffff0000, v201
    s_waitcnt lgkmcnt(9)
    v_mfma_f32_16x16x32_bf16 v[118:121], a[180:183], v[158:161], v[118:121]
    v_fma_f32 v170, v162, v214, v215
    v_fma_f32 v171, v163, v214, v215
    v_mfma_f32_16x16x32_bf16 v[114:117], a[148:151], v[158:161], v[114:117]
    ds_read_b128 v[158:161], v38 offset:2496
    v_fma_f32 v172, v164, v214, v215
    s_waitcnt lgkmcnt(9)
    v_mfma_f32_16x16x32_bf16 v[118:121], a[184:187], v[122:125], v[118:121]
    v_fma_f32 v173, v165, v214, v215
    v_fma_f32 v174, v166, v216, v217
    v_mfma_f32_16x16x32_bf16 v[114:117], a[152:155], v[122:125], v[114:117]
    ds_read_b128 v[122:125], v38 offset:1536
    v_fma_f32 v175, v167, v216, v217
    s_waitcnt lgkmcnt(9)
    v_mfma_f32_16x16x32_bf16 v[118:121], a[188:191], v[126:129], v[118:121]
    v_fma_f32 v176, v168, v216, v217
    global_load_dwordx4 a[252:255], v7, s[18:19] offset:-1024 sc1
    v_mfma_f32_16x16x32_bf16 v[114:117], a[156:159], v[126:129], v[114:117]
    ds_read_b128 v[126:129], v38 offset:1600
    v_fma_f32 v177, v169, v216, v217
    s_waitcnt lgkmcnt(9)
    v_mfma_f32_16x16x32_bf16 v[118:121], a[128:131], v[130:133], v[118:121]
    v_fma_f32 v170, v170, s64, v60
    v_fma_f32 v171, v171, s65, v61
    v_mfma_f32_16x16x32_bf16 v[114:117], a[96:99], v[130:133], v[114:117]
    ds_read_b128 v[130:133], v38 offset:1664
    v_fma_f32 v172, v172, s66, v62
    s_waitcnt lgkmcnt(9)
    v_mfma_f32_16x16x32_bf16 v[118:121], a[132:135], v[134:137], v[118:121]
    v_fma_f32 v173, v173, s67, v63
    v_fma_f32 v174, v174, s64, v60
    v_mfma_f32_16x16x32_bf16 v[114:117], a[100:103], v[134:137], v[114:117]
    ds_read_b128 v[134:137], v38 offset:1728
    v_fma_f32 v175, v175, s65, v61
    s_waitcnt lgkmcnt(9)
    v_mfma_f32_16x16x32_bf16 v[118:121], a[136:139], v[138:141], v[118:121]
    v_fma_f32 v176, v176, s66, v62
    v_fma_f32 v177, v177, s67, v63
    v_mfma_f32_16x16x32_bf16 v[114:117], a[104:107], v[138:141], v[114:117]
    ds_read_b128 v[138:141], v38 offset:1792
    v_fma_f32 v162, v170, v90, v162
    s_waitcnt lgkmcnt(9)
    v_mfma_f32_16x16x32_bf16 v[118:121], a[140:143], v[142:145], v[118:121]
    v_fma_f32 v163, v171, v91, v163
    v_fma_f32 v164, v172, v92, v164
    v_mfma_f32_16x16x32_bf16 v[114:117], a[108:111], v[142:145], v[114:117]
    ds_read_b128 v[142:145], v38 offset:1856
    v_fma_f32 v165, v173, v93, v165
    s_waitcnt lgkmcnt(9)
    v_mfma_f32_16x16x32_bf16 v[118:121], a[144:147], v[146:149], v[118:121]
    v_fma_f32 v166, v174, v94, v166
    global_load_dwordx4 a[240:243], v4, s[12:13] offset:-2048 sc1
    v_mfma_f32_16x16x32_bf16 v[114:117], a[112:115], v[146:149], v[114:117]
    ds_read_b128 v[146:149], v38 offset:1920
    v_fma_f32 v167, v175, v95, v167
    s_waitcnt lgkmcnt(9)
    v_mfma_f32_16x16x32_bf16 v[118:121], a[148:151], v[150:153], v[118:121]
    v_fma_f32 v168, v176, v96, v168
    v_fma_f32 v169, v177, v97, v169
    v_mfma_f32_16x16x32_bf16 v[114:117], a[116:119], v[150:153], v[114:117]
    ds_read_b128 v[150:153], v38 offset:1984
    v_cvt_pk_bf16_f32 v198, v162, v163
    s_waitcnt lgkmcnt(9)
    v_mfma_f32_16x16x32_bf16 v[118:121], a[152:155], v[154:157], v[118:121]
    v_cvt_pk_bf16_f32 v199, v164, v165
    v_cvt_pk_bf16_f32 v200, v166, v167
    v_mfma_f32_16x16x32_bf16 v[114:117], a[120:123], v[154:157], v[114:117]
    ds_read_b128 v[154:157], v38 offset:1024
    v_cvt_pk_bf16_f32 v201, v168, v169
    s_waitcnt lgkmcnt(9)
    v_mfma_f32_16x16x32_bf16 v[118:121], a[156:159], v[158:161], v[118:121]
    v_or_b32 v201, 1, v201
    v_add_u32 v44, 0, v43
    v_mfma_f32_16x16x32_bf16 v[114:117], a[124:127], v[158:161], v[114:117]
    ds_read_b128 v[158:161], v38 offset:1088
    global_store_dwordx4 v44, v[198:201], s[38:39] sc1
    s_waitcnt lgkmcnt(9)
    v_mfma_f32_16x16x32_bf16 v[118:121], a[96:99], v[122:125], v[118:121]
    s_waitcnt vmcnt(14)
    v_lshlrev_b32 v162, 16, v202
    v_and_b32 v163, 0xffff0000, v202
    v_mfma_f32_16x16x32_bf16 v[114:117], a[64:67], v[122:125], v[114:117]
    ds_read_b128 v[122:125], v38 offset:1152
    v_lshlrev_b32 v164, 16, v203
    s_waitcnt lgkmcnt(9)
    v_mfma_f32_16x16x32_bf16 v[118:121], a[100:103], v[126:129], v[118:121]
    v_and_b32 v165, 0xffff0000, v203
    v_lshlrev_b32 v166, 16, v204
    v_mfma_f32_16x16x32_bf16 v[114:117], a[68:71], v[126:129], v[114:117]
    ds_read_b128 v[126:129], v38 offset:1216
    global_load_dwordx4 a[244:247], v7, s[18:19] offset:-2048 sc1
    s_waitcnt lgkmcnt(9)
    v_mfma_f32_16x16x32_bf16 v[118:121], a[104:107], v[130:133], v[118:121]
    v_and_b32 v167, 0xffff0000, v204
    v_lshlrev_b32 v168, 16, v205
    v_mfma_f32_16x16x32_bf16 v[114:117], a[72:75], v[130:133], v[114:117]
    ds_read_b128 v[130:133], v38 offset:1280
    v_and_b32 v169, 0xffff0000, v205
    s_waitcnt lgkmcnt(9)
    v_mfma_f32_16x16x32_bf16 v[118:121], a[108:111], v[134:137], v[118:121]
    v_fma_f32 v170, v162, v218, v219
    v_fma_f32 v171, v163, v218, v219
    v_mfma_f32_16x16x32_bf16 v[114:117], a[76:79], v[134:137], v[114:117]
    ds_read_b128 v[134:137], v38 offset:1344
    v_fma_f32 v172, v164, v218, v219
    s_waitcnt lgkmcnt(9)
    v_mfma_f32_16x16x32_bf16 v[118:121], a[112:115], v[138:141], v[118:121]
    v_fma_f32 v173, v165, v218, v219
    v_fma_f32 v174, v166, v220, v221
    v_mfma_f32_16x16x32_bf16 v[114:117], a[80:83], v[138:141], v[114:117]
    ds_read_b128 v[138:141], v38 offset:1408
    v_fma_f32 v175, v167, v220, v221
    s_waitcnt lgkmcnt(9)
    v_mfma_f32_16x16x32_bf16 v[118:121], a[116:119], v[142:145], v[118:121]
    v_fma_f32 v176, v168, v220, v221
    v_fma_f32 v177, v169, v220, v221
    v_mfma_f32_16x16x32_bf16 v[114:117], a[84:87], v[142:145], v[114:117]
    ds_read_b128 v[142:145], v38 offset:1472
    v_fma_f32 v170, v170, s64, v60
    s_waitcnt lgkmcnt(9)
    v_mfma_f32_16x16x32_bf16 v[118:121], a[120:123], v[146:149], v[118:121]
    v_fma_f32 v171, v171, s65, v61
    v_fma_f32 v172, v172, s66, v62
    v_mfma_f32_16x16x32_bf16 v[114:117], a[88:91], v[146:149], v[114:117]
    ds_read_b128 v[146:149], v38 offset:512
    global_load_dwordx4 a[232:235], v4, s[12:13] offset:-3072 sc1
    s_waitcnt lgkmcnt(9)
    v_mfma_f32_16x16x32_bf16 v[118:121], a[124:127], v[150:153], v[118:121]
    v_fma_f32 v173, v173, s67, v63
    v_fma_f32 v174, v174, s64, v60
    v_mfma_f32_16x16x32_bf16 v[114:117], a[92:95], v[150:153], v[114:117]
    ds_read_b128 v[150:153], v38 offset:576
    v_fma_f32 v175, v175, s65, v61
    s_waitcnt lgkmcnt(9)
    v_mfma_f32_16x16x32_bf16 v[118:121], a[64:67], v[154:157], v[118:121]
    v_fma_f32 v176, v176, s66, v62
    v_fma_f32 v177, v177, s67, v63
    v_mfma_f32_16x16x32_bf16 v[114:117], a[32:35], v[154:157], v[114:117]
    ds_read_b128 v[154:157], v38 offset:640
    v_fma_f32 v162, v170, v98, v162
    s_waitcnt lgkmcnt(9)
    v_mfma_f32_16x16x32_bf16 v[118:121], a[68:71], v[158:161], v[118:121]
    v_fma_f32 v163, v171, v99, v163
    v_fma_f32 v164, v172, v100, v164
    v_mfma_f32_16x16x32_bf16 v[114:117], a[36:39], v[158:161], v[114:117]
    ds_read_b128 v[158:161], v38 offset:704
    v_fma_f32 v165, v173, v101, v165
    s_waitcnt lgkmcnt(9)
    v_mfma_f32_16x16x32_bf16 v[118:121], a[72:75], v[122:125], v[118:121]
    v_fma_f32 v166, v174, v102, v166
    v_fma_f32 v167, v175, v103, v167
    v_mfma_f32_16x16x32_bf16 v[114:117], a[40:43], v[122:125], v[114:117]
    ds_read_b128 v[122:125], v38 offset:768
    v_fma_f32 v168, v176, v104, v168
    s_waitcnt lgkmcnt(9)
    v_mfma_f32_16x16x32_bf16 v[118:121], a[76:79], v[126:129], v[118:121]
    v_fma_f32 v169, v177, v105, v169
    v_cvt_pk_bf16_f32 v202, v162, v163
    v_mfma_f32_16x16x32_bf16 v[114:117], a[44:47], v[126:129], v[114:117]
    ds_read_b128 v[126:129], v38 offset:832
    v_cvt_pk_bf16_f32 v203, v164, v165
    s_waitcnt lgkmcnt(9)
    v_mfma_f32_16x16x32_bf16 v[118:121], a[80:83], v[130:133], v[118:121]
    global_load_dwordx4 a[236:239], v7, s[18:19] offset:-3072 sc1
    v_cvt_pk_bf16_f32 v204, v166, v167
    v_mfma_f32_16x16x32_bf16 v[114:117], a[48:51], v[130:133], v[114:117]
    ds_read_b128 v[130:133], v38 offset:896
    v_cvt_pk_bf16_f32 v205, v168, v169
    s_waitcnt lgkmcnt(9)
    v_mfma_f32_16x16x32_bf16 v[118:121], a[84:87], v[134:137], v[118:121]
    v_or_b32 v205, 1, v205
    v_add_u32 v44, 917504, v43
    v_mfma_f32_16x16x32_bf16 v[114:117], a[52:55], v[134:137], v[114:117]
    ds_read_b128 v[134:137], v38 offset:960
    global_store_dwordx4 v44, v[202:205], s[38:39] sc1
    s_waitcnt lgkmcnt(9)
    v_mfma_f32_16x16x32_bf16 v[118:121], a[88:91], v[138:141], v[118:121]
    s_waitcnt vmcnt(17)
    v_lshlrev_b32 v162, 16, v206
    v_and_b32 v163, 0xffff0000, v206
    v_mfma_f32_16x16x32_bf16 v[114:117], a[56:59], v[138:141], v[114:117]
    ds_read_b128 v[138:141], v38 offset:0
    v_lshlrev_b32 v164, 16, v207
    s_waitcnt lgkmcnt(9)
    v_mfma_f32_16x16x32_bf16 v[118:121], a[92:95], v[142:145], v[118:121]
    v_and_b32 v165, 0xffff0000, v207
    v_lshlrev_b32 v166, 16, v208
    v_mfma_f32_16x16x32_bf16 v[114:117], a[60:63], v[142:145], v[114:117]
    ds_read_b128 v[142:145], v38 offset:64
    v_and_b32 v167, 0xffff0000, v208
    s_waitcnt lgkmcnt(9)
    v_mfma_f32_16x16x32_bf16 v[118:121], a[32:35], v[146:149], v[118:121]
    v_lshlrev_b32 v168, 16, v209
    v_and_b32 v169, 0xffff0000, v209
    v_mfma_f32_16x16x32_bf16 v[114:117], a[0:3], v[146:149], v[114:117]
    ds_read_b128 v[146:149], v38 offset:128
    v_fma_f32 v170, v162, v222, v223
    s_waitcnt lgkmcnt(9)
    v_mfma_f32_16x16x32_bf16 v[118:121], a[36:39], v[150:153], v[118:121]
    global_load_dwordx4 a[224:227], v4, s[12:13] offset:-4096 sc1
    v_fma_f32 v171, v163, v222, v223
    v_mfma_f32_16x16x32_bf16 v[114:117], a[4:7], v[150:153], v[114:117]
    ds_read_b128 v[150:153], v38 offset:192
    v_fma_f32 v172, v164, v222, v223
    s_waitcnt lgkmcnt(9)
    v_mfma_f32_16x16x32_bf16 v[118:121], a[40:43], v[154:157], v[118:121]
    v_fma_f32 v173, v165, v222, v223
    v_fma_f32 v174, v166, v224, v225
    v_mfma_f32_16x16x32_bf16 v[114:117], a[8:11], v[154:157], v[114:117]
    ds_read_b128 v[154:157], v38 offset:256
    v_fma_f32 v175, v167, v224, v225
    s_waitcnt lgkmcnt(9)
    v_mfma_f32_16x16x32_bf16 v[118:121], a[44:47], v[158:161], v[118:121]
    v_fma_f32 v176, v168, v224, v225
    v_fma_f32 v177, v169, v224, v225
    v_mfma_f32_16x16x32_bf16 v[114:117], a[12:15], v[158:161], v[114:117]
    ds_read_b128 v[158:161], v38 offset:320
    v_fma_f32 v170, v170, s64, v60
    v_fma_f32 v171, v171, s65, v61
    v_fma_f32 v172, v172, s66, v62
    s_waitcnt lgkmcnt(9)
    v_mfma_f32_16x16x32_bf16 v[118:121], a[48:51], v[122:125], v[118:121]
    v_fma_f32 v173, v173, s67, v63
    v_fma_f32 v174, v174, s64, v60
    v_fma_f32 v175, v175, s65, v61
    v_mfma_f32_16x16x32_bf16 v[114:117], a[16:19], v[122:125], v[114:117]
    ds_read_b128 v[122:125], v38 offset:384
    v_fma_f32 v176, v176, s66, v62
    v_fma_f32 v177, v177, s67, v63
    v_fma_f32 v162, v170, v106, v162
    s_waitcnt lgkmcnt(9)
    v_mfma_f32_16x16x32_bf16 v[118:121], a[52:55], v[126:129], v[118:121]
    global_load_dwordx4 a[228:231], v7, s[18:19] offset:-4096 sc1
    v_fma_f32 v163, v171, v107, v163
    v_fma_f32 v164, v172, v108, v164
    v_fma_f32 v165, v173, v109, v165
    v_mfma_f32_16x16x32_bf16 v[114:117], a[20:23], v[126:129], v[114:117]
    ds_read_b128 v[126:129], v38 offset:448
    v_fma_f32 v166, v174, v110, v166
    v_fma_f32 v167, v175, v111, v167
    v_fma_f32 v168, v176, v112, v168
    s_waitcnt lgkmcnt(9)
    v_mfma_f32_16x16x32_bf16 v[118:121], a[56:59], v[130:133], v[118:121]
    v_fma_f32 v169, v177, v113, v169
    v_cvt_pk_bf16_f32 v206, v162, v163
    v_cvt_pk_bf16_f32 v207, v164, v165
    v_mfma_f32_16x16x32_bf16 v[114:117], a[24:27], v[130:133], v[114:117]
    v_cvt_pk_bf16_f32 v208, v166, v167
    v_cvt_pk_bf16_f32 v209, v168, v169
    v_or_b32 v209, 1, v209
    s_waitcnt lgkmcnt(8)
    v_mfma_f32_16x16x32_bf16 v[118:121], a[60:63], v[134:137], v[118:121]
    v_add_u32 v44, 1835008, v43
    global_store_dwordx4 v44, v[206:209], s[38:39] sc1
    s_waitcnt vmcnt(19)
    v_lshlrev_b32 v178, 16, v210
    v_mfma_f32_16x16x32_bf16 v[114:117], a[28:31], v[134:137], v[114:117]
    global_load_dwordx4 a[216:219], v4, s[10:11] offset:3072 sc1
    v_and_b32 v179, 0xffff0000, v210
    v_lshlrev_b32 v180, 16, v211
    v_and_b32 v181, 0xffff0000, v211
    s_waitcnt lgkmcnt(7)
    v_mfma_f32_16x16x32_bf16 v[118:121], a[0:3], v[138:141], v[118:121]
    v_lshlrev_b32 v182, 16, v212
    v_and_b32 v183, 0xffff0000, v212
    v_lshlrev_b32 v184, 16, v213
    s_waitcnt lgkmcnt(6)
    v_mfma_f32_16x16x32_bf16 v[118:121], a[4:7], v[142:145], v[118:121]
    v_and_b32 v185, 0xffff0000, v213
    v_fma_f32 v186, v178, v226, v227
    v_fma_f32 v187, v179, v226, v227
    s_waitcnt lgkmcnt(5)
    v_mfma_f32_16x16x32_bf16 v[118:121], a[8:11], v[146:149], v[118:121]
    v_fma_f32 v188, v180, v226, v227
    v_fma_f32 v189, v181, v226, v227
    v_fma_f32 v190, v182, v228, v229
    s_waitcnt lgkmcnt(4)
    v_mfma_f32_16x16x32_bf16 v[118:121], a[12:15], v[150:153], v[118:121]
    v_fma_f32 v191, v183, v228, v229
    global_load_dwordx4 a[220:223], v7, s[16:17] offset:3072 sc1
    v_fma_f32 v192, v184, v228, v229
    v_fma_f32 v193, v185, v228, v229
    s_waitcnt lgkmcnt(3)
    v_mfma_f32_16x16x32_bf16 v[118:121], a[16:19], v[154:157], v[118:121]
    v_fma_f32 v186, v186, s64, v60
    v_fma_f32 v187, v187, s65, v61
    v_fma_f32 v188, v188, s66, v62
    s_waitcnt lgkmcnt(2)
    v_mfma_f32_16x16x32_bf16 v[118:121], a[20:23], v[158:161], v[118:121]
    v_fma_f32 v189, v189, s67, v63
    v_fma_f32 v190, v190, s64, v60
    v_fma_f32 v191, v191, s65, v61
    s_waitcnt lgkmcnt(1)
    v_mfma_f32_16x16x32_bf16 v[118:121], a[24:27], v[122:125], v[118:121]
    v_fma_f32 v192, v192, s66, v62
    v_fma_f32 v193, v193, s67, v63
    ds_read_b32 v56, v39 offset:0
    s_waitcnt lgkmcnt(1)
    v_mfma_f32_16x16x32_bf16 v[118:121], a[28:31], v[126:129], v[118:121]
    ds_read_b32 v57, v39 offset:9280
    ds_read_b32 v58, v39 offset:18560
    ds_read_b32 v59, v39 offset:27840
    global_load_dwordx4 v[230:233], v235, s[38:39] sc1
    global_load_dwordx4 a[208:211], v4, s[10:11] offset:2048 sc1
    v_cvt_pk_bf16_f32 v48, v114, v115
    v_cvt_pk_bf16_f32 v49, v116, v117
    ds_write2_b32 v40, v48, v49 offset0:0 offset1:2
    v_cvt_pk_bf16_f32 v50, v118, v119
    v_cvt_pk_bf16_f32 v51, v120, v121
    global_load_dwordx4 a[212:215], v7, s[16:17] offset:2048 sc1
    ds_write2_b32 v40, v50, v51 offset0:128 offset1:130
    s_waitcnt lgkmcnt(0)
    s_barrier
    ds_read_b32 v52, v41 offset:12672
    ds_read_b32 v53, v41 offset:13728
    ds_read_b32 v54, v41 offset:14784
    global_load_dwordx4 a[200:203], v4, s[10:11] offset:1024 sc1
    ds_read_b32 v55, v41 offset:15840
    s_waitcnt lgkmcnt(3)
    v_lshlrev_b32 v114, 16, v52
    v_and_b32 v118, 0xffff0000, v52
    s_waitcnt lgkmcnt(2)
    v_lshlrev_b32 v115, 16, v53
    v_and_b32 v119, 0xffff0000, v53
    s_waitcnt lgkmcnt(1)
    v_lshlrev_b32 v116, 16, v54
    global_load_dwordx4 a[204:207], v7, s[16:17] offset:1024 sc1
    v_and_b32 v120, 0xffff0000, v54
    s_waitcnt lgkmcnt(0)
    v_lshlrev_b32 v117, 16, v55
    v_and_b32 v121, 0xffff0000, v55
    v_dot2_f32_bf16 v114, v56, s20, v114
    v_dot2_f32_bf16 v115, v57, s21, v115
    v_dot2_f32_bf16 v116, v58, s22, v116
    v_dot2_f32_bf16 v117, v59, s23, v117
    v_dot2_f32_bf16 v118, v56, s28, v118
    v_dot2_f32_bf16 v119, v57, s29, v119
    v_dot2_f32_bf16 v120, v58, s30, v120
    v_dot2_f32_bf16 v121, v59, s31, v121
    v_pk_fma_f32 v[178:179], v[186:187], v[114:115], v[178:179] op_sel:[0,0,0] op_sel_hi:[1,1,1]
    v_pk_fma_f32 v[180:181], v[188:189], v[116:117], v[180:181] op_sel:[0,0,0] op_sel_hi:[1,1,1]
    v_pk_fma_f32 v[182:183], v[190:191], v[118:119], v[182:183] op_sel:[0,0,0] op_sel_hi:[1,1,1]
    v_pk_fma_f32 v[184:185], v[192:193], v[120:121], v[184:185] op_sel:[0,0,0] op_sel_hi:[1,1,1]
    v_cvt_pk_bf16_f32 v210, v178, v179
    v_cvt_pk_bf16_f32 v211, v180, v181
    v_cvt_pk_bf16_f32 v212, v182, v183
    v_cvt_pk_bf16_f32 v213, v184, v185
    v_or_b32 v213, 1, v213
    v_add_u32 v44, 2752512, v43
    global_store_dwordx4 v44, v[210:213], s[38:39] sc1
    s_waitcnt lgkmcnt(0)
    s_barrier
    s_waitcnt vmcnt(5)
    v_max_u32 v236, v230, v231
    v_max3_u32 v236, v232, v233, v236
    v_cmp_eq_u32 vcc, -1, v236
    s_nop 0
    s_cbranch_vccnz Lcv_r
Lcv_ok:
    v_permlane32_swap_b32 v230, v232
    v_permlane32_swap_b32 v231, v233
    s_lshl_b32 s4, s3, 9
    s_add_u32 s4, s4, 156672
    v_and_b32 v235, 496, v4
    v_add_f32 v230, v230, v232
    v_add_f32 v231, v231, v233
    v_bfe_u32 v232, v1, 3, 1
    v_cmp_gt_u32 vcc, s101, v232
    v_lshrrev_b32 v232, 5, v1
    v_lshl_add_u32 v235, v232, 3, v235
    v_cndmask_b32 v230, 0, v230, vcc
    v_cndmask_b32 v231, 0, v231, vcc
    v_add_u32 v235, s4, v235
    ds_write_b64 v235, v[230:231]
    global_load_dwordx4 a[192:195], v4, s[10:11] offset:0 sc1
    global_load_dwordx4 a[196:199], v7, s[16:17] offset:0 sc1
    global_load_dwordx4 a[184:187], v4, s[10:11] offset:-1024 sc1
    global_load_dwordx4 a[188:191], v7, s[16:17] offset:-1024 sc1
    global_load_dwordx4 a[176:179], v4, s[10:11] offset:-2048 sc1
    global_load_dwordx4 a[180:183], v7, s[16:17] offset:-2048 sc1
    global_load_dwordx4 a[168:171], v4, s[10:11] offset:-3072 sc1
    global_load_dwordx4 a[172:175], v7, s[16:17] offset:-3072 sc1
    global_load_dwordx4 a[160:163], v4, s[10:11] offset:-4096 sc1
    global_load_dwordx4 a[164:167], v7, s[16:17] offset:-4096 sc1
    global_load_dwordx4 a[152:155], v4, s[8:9] offset:3072 sc1
    global_load_dwordx4 a[156:159], v7, s[14:15] offset:3072 sc1
    global_load_dwordx4 a[144:147], v4, s[8:9] offset:2048 sc1
    global_load_dwordx4 a[148:151], v7, s[14:15] offset:2048 sc1
    global_load_dwordx4 a[136:139], v4, s[8:9] offset:1024 sc1
    global_load_dwordx4 a[140:143], v7, s[14:15] offset:1024 sc1
    global_load_dwordx4 a[128:131], v4, s[8:9] offset:0 sc1
    global_load_dwordx4 a[132:135], v7, s[14:15] offset:0 sc1
Ljoin:
    s_bfe_u32 s6, s2, 0x30003
    v_mul_u32_u24 v254, 8, v0
    v_add_lshl_u32 v254, v254, s6, 7
    v_min_u32 v254, (Lmid-Lx_go-4), v254
    v_add_u32 v254, (Lx_go-adaLN_cond__ssm_conv_h3__mixer_gmlp__prompt_kernel), v254
    global_load_dword v254, v254, s[0:1]
    s_cmp_lt_u32 s43, 5
    s_cbranch_scc1 Lx_first
Lx_redo:
    s_branch Lxp_f
Lxp:
    s_sleep 1
Lxp_f:
    global_load_dword v71, v72, s[38:39] offset:508 sc1
    s_waitcnt vmcnt(0)
    v_and_b32 v71, 1, v71
    v_cmp_ne_u32 vcc, 1, v71
    s_add_u32 s100, s100, 1
    s_cmp_ge_u32 s100, 262144
    s_cbranch_scc1 Lxp_x
    s_cbranch_vccnz Lxp
Lxp_x:
Lx_first:
    s_mov_b32 s7, 0x3f803f80
    v_add_u32 v67, 4096, v66
    global_load_dwordx4 v[98:101], v67, s[38:39] offset:-4096 sc1
    global_load_dwordx4 v[102:105], v67, s[38:39] offset:-3072 sc1
    global_load_dwordx4 v[106:109], v67, s[38:39] offset:-2048 sc1
    global_load_dwordx4 v[110:113], v67, s[38:39] offset:-1024 sc1
    global_load_dwordx4 v[114:117], v67, s[38:39] offset:0 sc1
    global_load_dwordx4 v[118:121], v67, s[38:39] offset:1024 sc1
    global_load_dwordx4 v[122:125], v67, s[38:39] offset:2048 sc1
    global_load_dwordx4 v[126:129], v67, s[38:39] offset:3072 sc1
    v_add_u32 v67, 8192, v67
    global_load_dwordx4 v[130:133], v67, s[38:39] offset:-4096 sc1
    global_load_dwordx4 v[134:137], v67, s[38:39] offset:-3072 sc1
    v_mov_b32 v62, 0
    v_mov_b32 v63, 0
    v_mov_b32 v64, 0
    v_mov_b32 v65, 0
    v_mov_b32 v71, -1
    global_load_dwordx4 v[138:141], v67, s[38:39] offset:-2048 sc1
    v_add_u32 v69, 0, v68
    s_waitcnt vmcnt(10)
    ds_write2_b64 v69, v[98:99], v[100:101] offset0:0 offset1:2
    v_dot2_f32_bf16 v62, v98, s7, v62
    v_dot2_f32_bf16 v63, v98, v98, v63
    v_dot2_f32_bf16 v64, v100, s7, v64
    v_dot2_f32_bf16 v65, v100, v100, v65
    v_dot2_f32_bf16 v62, v99, s7, v62
    v_dot2_f32_bf16 v63, v99, v99, v63
    v_dot2_f32_bf16 v64, v101, s7, v64
    v_dot2_f32_bf16 v65, v101, v101, v65
    global_load_dwordx4 v[142:145], v67, s[38:39] offset:-1024 sc1
    s_waitcnt vmcnt(10)
    ds_write2_b64 v69, v[102:103], v[104:105] offset0:32 offset1:34
    v_bitop3_b32 v71, v101, v105, v71 bitop3:0x80
    v_dot2_f32_bf16 v62, v102, s7, v62
    v_dot2_f32_bf16 v63, v102, v102, v63
    v_dot2_f32_bf16 v64, v104, s7, v64
    v_dot2_f32_bf16 v65, v104, v104, v65
    v_dot2_f32_bf16 v62, v103, s7, v62
    v_dot2_f32_bf16 v63, v103, v103, v63
    v_dot2_f32_bf16 v64, v105, s7, v64
    v_dot2_f32_bf16 v65, v105, v105, v65
    global_load_dwordx4 v[146:149], v67, s[38:39] offset:0 sc1
    s_waitcnt vmcnt(10)
    ds_write2_b64 v69, v[106:107], v[108:109] offset0:64 offset1:66
    v_dot2_f32_bf16 v62, v106, s7, v62
    v_dot2_f32_bf16 v63, v106, v106, v63
    v_dot2_f32_bf16 v64, v108, s7, v64
    v_dot2_f32_bf16 v65, v108, v108, v65
    v_dot2_f32_bf16 v62, v107, s7, v62
    v_dot2_f32_bf16 v63, v107, v107, v63
    v_dot2_f32_bf16 v64, v109, s7, v64
    v_dot2_f32_bf16 v65, v109, v109, v65
    global_load_dwordx4 v[150:153], v67, s[38:39] offset:1024 sc1
    s_waitcnt vmcnt(10)
    ds_write2_b64 v69, v[110:111], v[112:113] offset0:96 offset1:98
    v_bitop3_b32 v71, v109, v113, v71 bitop3:0x80
    v_dot2_f32_bf16 v62, v110, s7, v62
    v_dot2_f32_bf16 v63, v110, v110, v63
    v_dot2_f32_bf16 v64, v112, s7, v64
    v_dot2_f32_bf16 v65, v112, v112, v65
    v_dot2_f32_bf16 v62, v111, s7, v62
    v_dot2_f32_bf16 v63, v111, v111, v63
    v_dot2_f32_bf16 v64, v113, s7, v64
    v_dot2_f32_bf16 v65, v113, v113, v65
    global_load_dwordx4 v[154:157], v67, s[38:39] offset:2048 sc1
    v_add_u32 v69, 4160, v68
    s_waitcnt vmcnt(10)
    ds_write2_b64 v69, v[114:115], v[116:117] offset0:0 offset1:2
    v_dot2_f32_bf16 v62, v114, s7, v62
    v_dot2_f32_bf16 v63, v114, v114, v63
    v_dot2_f32_bf16 v64, v116, s7, v64
    v_dot2_f32_bf16 v65, v116, v116, v65
    v_dot2_f32_bf16 v62, v115, s7, v62
    v_dot2_f32_bf16 v63, v115, v115, v63
    v_dot2_f32_bf16 v64, v117, s7, v64
    v_dot2_f32_bf16 v65, v117, v117, v65
    global_load_dwordx4 v[158:161], v67, s[38:39] offset:3072 sc1
    v_add_u32 v67, 8192, v67
    s_waitcnt vmcnt(10)
    ds_write2_b64 v69, v[118:119], v[120:121] offset0:32 offset1:34
    v_bitop3_b32 v71, v117, v121, v71 bitop3:0x80
    v_dot2_f32_bf16 v62, v118, s7, v62
    v_dot2_f32_bf16 v63, v118, v118, v63
    v_dot2_f32_bf16 v64, v120, s7, v64
    v_dot2_f32_bf16 v65, v120, v120, v65
    v_dot2_f32_bf16 v62, v119, s7, v62
    v_dot2_f32_bf16 v63, v119, v119, v63
    v_dot2_f32_bf16 v64, v121, s7, v64
    v_dot2_f32_bf16 v65, v121, v121, v65
    global_load_dwordx4 v[162:165], v67, s[38:39] offset:-4096 sc1
    s_waitcnt vmcnt(10)
    ds_write2_b64 v69, v[122:123], v[124:125] offset0:64 offset1:66
    v_dot2_f32_bf16 v62, v122, s7, v62
    v_dot2_f32_bf16 v63, v122, v122, v63
    v_dot2_f32_bf16 v64, v124, s7, v64
    v_dot2_f32_bf16 v65, v124, v124, v65
    v_dot2_f32_bf16 v62, v123, s7, v62
    v_dot2_f32_bf16 v63, v123, v123, v63
    v_dot2_f32_bf16 v64, v125, s7, v64
    v_dot2_f32_bf16 v65, v125, v125, v65
    global_load_dwordx4 v[166:169], v67, s[38:39] offset:-3072 sc1
    s_waitcnt vmcnt(10)
    ds_write2_b64 v69, v[126:127], v[128:129] offset0:96 offset1:98
    v_bitop3_b32 v71, v125, v129, v71 bitop3:0x80
    v_dot2_f32_bf16 v62, v126, s7, v62
    v_dot2_f32_bf16 v63, v126, v126, v63
    v_dot2_f32_bf16 v64, v128, s7, v64
    v_dot2_f32_bf16 v65, v128, v128, v65
    v_dot2_f32_bf16 v62, v127, s7, v62
    v_dot2_f32_bf16 v63, v127, v127, v63
    v_dot2_f32_bf16 v64, v129, s7, v64
    v_dot2_f32_bf16 v65, v129, v129, v65
    global_load_dwordx4 v[170:173], v67, s[38:39] offset:-2048 sc1
    v_add_u32 v69, 8320, v68
    s_waitcnt vmcnt(10)
    ds_write2_b64 v69, v[130:131], v[132:133] offset0:0 offset1:2
    v_dot2_f32_bf16 v62, v130, s7, v62
    v_dot2_f32_bf16 v63, v130, v130, v63
    v_dot2_f32_bf16 v64, v132, s7, v64
    v_dot2_f32_bf16 v65, v132, v132, v65
    v_dot2_f32_bf16 v62, v131, s7, v62
    v_dot2_f32_bf16 v63, v131, v131, v63
    v_dot2_f32_bf16 v64, v133, s7, v64
    v_dot2_f32_bf16 v65, v133, v133, v65
    global_load_dwordx4 v[174:177], v67, s[38:39] offset:-1024 sc1
    s_waitcnt vmcnt(10)
    ds_write2_b64 v69, v[134:135], v[136:137] offset0:32 offset1:34
    v_bitop3_b32 v71, v133, v137, v71 bitop3:0x80
    v_dot2_f32_bf16 v62, v134, s7, v62
    v_dot2_f32_bf16 v63, v134, v134, v63
    v_dot2_f32_bf16 v64, v136, s7, v64
    v_dot2_f32_bf16 v65, v136, v136, v65
    v_dot2_f32_bf16 v62, v135, s7, v62
    v_dot2_f32_bf16 v63, v135, v135, v63
    v_dot2_f32_bf16 v64, v137, s7, v64
    v_dot2_f32_bf16 v65, v137, v137, v65
    global_load_dwordx4 a[96:99], v4, s[8:9] offset:-4096 sc1
    s_waitcnt vmcnt(10)
    ds_write2_b64 v69, v[138:139], v[140:141] offset0:64 offset1:66
    v_dot2_f32_bf16 v62, v138, s7, v62
    v_dot2_f32_bf16 v63, v138, v138, v63
    v_dot2_f32_bf16 v64, v140, s7, v64
    v_dot2_f32_bf16 v65, v140, v140, v65
    v_dot2_f32_bf16 v62, v139, s7, v62
    v_dot2_f32_bf16 v63, v139, v139, v63
    v_dot2_f32_bf16 v64, v141, s7, v64
    v_dot2_f32_bf16 v65, v141, v141, v65
    global_load_dwordx4 a[100:103], v7, s[14:15] offset:-4096 sc1
    s_waitcnt vmcnt(10)
    ds_write2_b64 v69, v[142:143], v[144:145] offset0:96 offset1:98
    v_bitop3_b32 v71, v141, v145, v71 bitop3:0x80
    v_dot2_f32_bf16 v62, v142, s7, v62
    v_dot2_f32_bf16 v63, v142, v142, v63
    v_dot2_f32_bf16 v64, v144, s7, v64
    v_dot2_f32_bf16 v65, v144, v144, v65
    v_dot2_f32_bf16 v62, v143, s7, v62
    v_dot2_f32_bf16 v63, v143, v143, v63
    v_dot2_f32_bf16 v64, v145, s7, v64
    v_dot2_f32_bf16 v65, v145, v145, v65
    global_load_dwordx4 a[104:107], v4, s[8:9] offset:-3072 sc1
    v_add_u32 v69, 12480, v68
    s_waitcnt vmcnt(10)
    ds_write2_b64 v69, v[146:147], v[148:149] offset0:0 offset1:2
    v_dot2_f32_bf16 v62, v146, s7, v62
    v_dot2_f32_bf16 v63, v146, v146, v63
    v_dot2_f32_bf16 v64, v148, s7, v64
    v_dot2_f32_bf16 v65, v148, v148, v65
    v_dot2_f32_bf16 v62, v147, s7, v62
    v_dot2_f32_bf16 v63, v147, v147, v63
    v_dot2_f32_bf16 v64, v149, s7, v64
    v_dot2_f32_bf16 v65, v149, v149, v65
    global_load_dwordx4 a[108:111], v7, s[14:15] offset:-3072 sc1
    s_waitcnt vmcnt(10)
    ds_write2_b64 v69, v[150:151], v[152:153] offset0:32 offset1:34
    v_bitop3_b32 v71, v149, v153, v71 bitop3:0x80
    v_dot2_f32_bf16 v62, v150, s7, v62
    v_dot2_f32_bf16 v63, v150, v150, v63
    v_dot2_f32_bf16 v64, v152, s7, v64
    v_dot2_f32_bf16 v65, v152, v152, v65
    v_dot2_f32_bf16 v62, v151, s7, v62
    v_dot2_f32_bf16 v63, v151, v151, v63
    v_dot2_f32_bf16 v64, v153, s7, v64
    v_dot2_f32_bf16 v65, v153, v153, v65
    global_load_dwordx4 a[112:115], v4, s[8:9] offset:-2048 sc1
    s_waitcnt vmcnt(10)
    ds_write2_b64 v69, v[154:155], v[156:157] offset0:64 offset1:66
    v_dot2_f32_bf16 v62, v154, s7, v62
    v_dot2_f32_bf16 v63, v154, v154, v63
    v_dot2_f32_bf16 v64, v156, s7, v64
    v_dot2_f32_bf16 v65, v156, v156, v65
    v_dot2_f32_bf16 v62, v155, s7, v62
    v_dot2_f32_bf16 v63, v155, v155, v63
    v_dot2_f32_bf16 v64, v157, s7, v64
    v_dot2_f32_bf16 v65, v157, v157, v65
    global_load_dwordx4 a[116:119], v7, s[14:15] offset:-2048 sc1
    s_waitcnt vmcnt(10)
    ds_write2_b64 v69, v[158:159], v[160:161] offset0:96 offset1:98
    v_bitop3_b32 v71, v157, v161, v71 bitop3:0x80
    v_dot2_f32_bf16 v62, v158, s7, v62
    v_dot2_f32_bf16 v63, v158, v158, v63
    v_dot2_f32_bf16 v64, v160, s7, v64
    v_dot2_f32_bf16 v65, v160, v160, v65
    v_dot2_f32_bf16 v62, v159, s7, v62
    v_dot2_f32_bf16 v63, v159, v159, v63
    v_dot2_f32_bf16 v64, v161, s7, v64
    v_dot2_f32_bf16 v65, v161, v161, v65
    global_load_dwordx4 a[120:123], v4, s[8:9] offset:-1024 sc1
    v_add_u32 v69, 16640, v68
    s_waitcnt vmcnt(10)
    ds_write2_b64 v69, v[162:163], v[164:165] offset0:0 offset1:2
    v_dot2_f32_bf16 v62, v162, s7, v62
    v_dot2_f32_bf16 v63, v162, v162, v63
    v_dot2_f32_bf16 v64, v164, s7, v64
    v_dot2_f32_bf16 v65, v164, v164, v65
    v_dot2_f32_bf16 v62, v163, s7, v62
    v_dot2_f32_bf16 v63, v163, v163, v63
    v_dot2_f32_bf16 v64, v165, s7, v64
    v_dot2_f32_bf16 v65, v165, v165, v65
    global_load_dwordx4 a[124:127], v7, s[14:15] offset:-1024 sc1
    s_waitcnt vmcnt(10)
    ds_write2_b64 v69, v[166:167], v[168:169] offset0:32 offset1:34
    v_bitop3_b32 v71, v165, v169, v71 bitop3:0x80
    v_dot2_f32_bf16 v62, v166, s7, v62
    v_dot2_f32_bf16 v63, v166, v166, v63
    v_dot2_f32_bf16 v64, v168, s7, v64
    v_dot2_f32_bf16 v65, v168, v168, v65
    v_dot2_f32_bf16 v62, v167, s7, v62
    v_dot2_f32_bf16 v63, v167, v167, v63
    v_dot2_f32_bf16 v64, v169, s7, v64
    v_dot2_f32_bf16 v65, v169, v169, v65
    s_waitcnt vmcnt(9)
    ds_write2_b64 v69, v[170:171], v[172:173] offset0:64 offset1:66
    v_dot2_f32_bf16 v62, v170, s7, v62
    v_dot2_f32_bf16 v63, v170, v170, v63
    v_dot2_f32_bf16 v64, v172, s7, v64
    v_dot2_f32_bf16 v65, v172, v172, v65
    v_dot2_f32_bf16 v62, v171, s7, v62
    v_dot2_f32_bf16 v63, v171, v171, v63
    v_dot2_f32_bf16 v64, v173, s7, v64
    v_dot2_f32_bf16 v65, v173, v173, v65
    s_waitcnt vmcnt(8)
    ds_write2_b64 v69, v[174:175], v[176:177] offset0:96 offset1:98
    v_bitop3_b32 v71, v173, v177, v71 bitop3:0x80
    v_dot2_f32_bf16 v62, v174, s7, v62
    v_dot2_f32_bf16 v63, v174, v174, v63
    v_dot2_f32_bf16 v64, v176, s7, v64
    v_dot2_f32_bf16 v65, v176, v176, v65
    v_dot2_f32_bf16 v62, v175, s7, v62
    v_dot2_f32_bf16 v63, v175, v175, v63
    v_dot2_f32_bf16 v64, v177, s7, v64
    v_dot2_f32_bf16 v65, v177, v177, v65
    v_and_b32 v71, 1, v71
    v_cmp_ne_u32 vcc, 1, v71
    s_cmp_ge_u32 s100, 262144
    s_cbranch_scc1 Lx_go
    s_cbranch_vccnz Lx_redo
Lx_go:
    v_add_f32_dpp v90, v62, v62 row_ror:8 row_mask:0xf bank_mask:0x3
    s_nop 1
    v_add_f32_dpp v90, v64, v64 row_ror:8 row_mask:0xf bank_mask:0xc
    v_add_f32_dpp v91, v63, v63 row_ror:8 row_mask:0xf bank_mask:0x3
    s_nop 1
    v_add_f32_dpp v91, v65, v65 row_ror:8 row_mask:0xf bank_mask:0xc
    s_add_u32 s4, s88, 148736
    v_lshl_add_u32 v28, v70, 3, s4
    ds_write_b64 v28, v[90:91]
    s_waitcnt lgkmcnt(0)
    s_barrier
    v_add_u32 v173, 41600, v4
    ds_read_b128 v[48:51], v173 offset:37440
    ds_read_b128 v[52:55], v173 offset:38480
    ds_read_b128 v[56:59], v173 offset:39520
    ds_read_b128 v[60:63], v173 offset:40560
    ds_read_b128 v[64:67], v173 offset:33280
    s_waitcnt lgkmcnt(3)
    v_mfma_f32_16x16x32_bf16 v[178:181], v[48:51], a[248:251], 0
    ds_read_b128 v[68:71], v173 offset:34320
    s_add_u32 m0, s89, 8192
    v_mfma_f32_16x16x32_bf16 v[194:197], v[48:51], a[252:255], 0
    v_mfma_f32_16x16x32_bf16 v[182:185], v[52:55], a[248:251], 0
    ds_read_b128 v[48:51], v173 offset:35360
    v_mfma_f32_16x16x32_bf16 v[198:201], v[52:55], a[252:255], 0
    s_waitcnt lgkmcnt(3)
    v_mfma_f32_16x16x32_bf16 v[186:189], v[56:59], a[248:251], 0
    ds_read_b128 v[52:55], v173 offset:36400
    v_add_u32 v28, 148736, v30
    v_mfma_f32_16x16x32_bf16 v[202:205], v[56:59], a[252:255], 0
    global_load_lds_dwordx4 v74, s[70:71] offset:0
    ds_read_b64 v[90:91], v28 offset:0
    v_mfma_f32_16x16x32_bf16 v[190:193], v[60:63], a[248:251], 0
    ds_read_b128 v[56:59], v173 offset:29120
    v_mfma_f32_16x16x32_bf16 v[206:209], v[60:63], a[252:255], 0
    ds_read_b64 v[92:93], v28 offset:512
    s_waitcnt lgkmcnt(5)
    v_mfma_f32_16x16x32_bf16 v[178:181], v[64:67], a[240:243], v[178:181]
    ds_read_b128 v[60:63], v173 offset:30160
    v_mfma_f32_16x16x32_bf16 v[194:197], v[64:67], a[244:247], v[194:197]
    ds_read_b64 v[94:95], v28 offset:1024
    v_mfma_f32_16x16x32_bf16 v[182:185], v[68:71], a[240:243], v[182:185]
    ds_read_b128 v[64:67], v173 offset:31200
    global_load_lds_dwordx4 v75, s[70:71] offset:1024
    v_mfma_f32_16x16x32_bf16 v[198:201], v[68:71], a[244:247], v[198:201]
    ds_read_b64 v[96:97], v28 offset:1536
    s_waitcnt lgkmcnt(7)
    v_mfma_f32_16x16x32_bf16 v[186:189], v[48:51], a[240:243], v[186:189]
    ds_read_b128 v[68:71], v173 offset:32240
    v_mfma_f32_16x16x32_bf16 v[202:205], v[48:51], a[244:247], v[202:205]
    s_add_u32 s4, s88, 150784
    v_mfma_f32_16x16x32_bf16 v[190:193], v[52:55], a[240:243], v[190:193]
    ds_read_b128 v[48:51], v173 offset:24960
    v_mfma_f32_16x16x32_bf16 v[206:209], v[52:55], a[244:247], v[206:209]
    v_lshl_add_u32 v170, v1, 2, s4
    s_waitcnt lgkmcnt(5)
    v_mfma_f32_16x16x32_bf16 v[178:181], v[56:59], a[232:235], v[178:181]
    ds_read_b128 v[52:55], v173 offset:26000
    global_load_lds_dwordx4 v76, s[70:71] offset:2048
    v_mfma_f32_16x16x32_bf16 v[194:197], v[56:59], a[236:239], v[194:197]
    v_lshl_add_u32 v171, v3, 5, s4
    v_mfma_f32_16x16x32_bf16 v[182:185], v[60:63], a[232:235], v[182:185]
    ds_read_b128 v[56:59], v173 offset:27040
    v_lshl_add_u32 v172, v5, 2, s4
    v_mfma_f32_16x16x32_bf16 v[198:201], v[60:63], a[236:239], v[198:201]
    s_waitcnt lgkmcnt(3)
    v_mfma_f32_16x16x32_bf16 v[186:189], v[64:67], a[232:235], v[186:189]
    ds_read_b128 v[60:63], v173 offset:28080
    v_add_f32 v90, v90, v92
    v_mfma_f32_16x16x32_bf16 v[202:205], v[64:67], a[236:239], v[202:205]
    global_load_lds_dwordx4 v77, s[70:71] offset:3072
    v_mfma_f32_16x16x32_bf16 v[190:193], v[68:71], a[232:235], v[190:193]
    ds_read_b128 v[64:67], v173 offset:20800
    v_add_f32 v91, v91, v93
    v_mfma_f32_16x16x32_bf16 v[206:209], v[68:71], a[236:239], v[206:209]
    s_waitcnt lgkmcnt(3)
    v_mfma_f32_16x16x32_bf16 v[178:181], v[48:51], a[224:227], v[178:181]
    ds_read_b128 v[68:71], v173 offset:21840
    v_add_f32 v94, v94, v96
    v_mfma_f32_16x16x32_bf16 v[194:197], v[48:51], a[228:231], v[194:197]
    v_mfma_f32_16x16x32_bf16 v[182:185], v[52:55], a[224:227], v[182:185]
    ds_read_b128 v[48:51], v173 offset:22880
    v_add_f32 v95, v95, v97
    s_add_u32 m0, s89, 12288
    v_mfma_f32_16x16x32_bf16 v[198:201], v[52:55], a[228:231], v[198:201]
    s_waitcnt lgkmcnt(3)
    v_mfma_f32_16x16x32_bf16 v[186:189], v[56:59], a[224:227], v[186:189]
    ds_read_b128 v[52:55], v173 offset:23920
    v_add_f32 v90, v90, v94
    v_mfma_f32_16x16x32_bf16 v[202:205], v[56:59], a[228:231], v[202:205]
    v_add_f32 v91, v91, v95
    v_mfma_f32_16x16x32_bf16 v[190:193], v[60:63], a[224:227], v[190:193]
    ds_read_b128 v[56:59], v173 offset:16640
    v_mfma_f32_16x16x32_bf16 v[206:209], v[60:63], a[228:231], v[206:209]
    v_mul_f32 v90, 0x3acccccd, v90
    s_waitcnt lgkmcnt(3)
    v_mfma_f32_16x16x32_bf16 v[178:181], v[64:67], a[216:219], v[178:181]
    ds_read_b128 v[60:63], v173 offset:17680
    global_load_lds_dwordx4 v78, s[70:71] offset:0
    v_mfma_f32_16x16x32_bf16 v[194:197], v[64:67], a[220:223], v[194:197]
    v_mul_f32 v91, 0x3acccccd, v91
    v_mfma_f32_16x16x32_bf16 v[182:185], v[68:71], a[216:219], v[182:185]
    ds_read_b128 v[64:67], v173 offset:18720
    v_mfma_f32_16x16x32_bf16 v[198:201], v[68:71], a[220:223], v[198:201]
    v_fma_f32 v91, -v90, v90, v91
    s_waitcnt lgkmcnt(3)
    v_mfma_f32_16x16x32_bf16 v[186:189], v[48:51], a[216:219], v[186:189]
    ds_read_b128 v[68:71], v173 offset:19760
    v_mfma_f32_16x16x32_bf16 v[202:205], v[48:51], a[220:223], v[202:205]
    v_max_f32 v91, 0, v91
    global_load_lds_dwordx4 v79, s[70:71] offset:1024
    v_mfma_f32_16x16x32_bf16 v[190:193], v[52:55], a[216:219], v[190:193]
    ds_read_b128 v[48:51], v173 offset:12480
    v_mfma_f32_16x16x32_bf16 v[206:209], v[52:55], a[220:223], v[206:209]
    v_add_f32 v91, 0x3727c5ac, v91
    s_waitcnt lgkmcnt(3)
    v_mfma_f32_16x16x32_bf16 v[178:181], v[56:59], a[208:211], v[178:181]
    ds_read_b128 v[52:55], v173 offset:13520
    v_mfma_f32_16x16x32_bf16 v[194:197], v[56:59], a[212:215], v[194:197]
    v_rsq_f32 v92, v91
    v_mfma_f32_16x16x32_bf16 v[182:185], v[60:63], a[208:211], v[182:185]
    ds_read_b128 v[56:59], v173 offset:14560
    global_load_lds_dwordx4 v80, s[70:71] offset:2048
    v_mfma_f32_16x16x32_bf16 v[198:201], v[60:63], a[212:215], v[198:201]
    s_waitcnt lgkmcnt(3)
    v_mfma_f32_16x16x32_bf16 v[186:189], v[64:67], a[208:211], v[186:189]
    ds_read_b128 v[60:63], v173 offset:15600
    v_mul_f32_e64 v91, -v90, v92
    v_mfma_f32_16x16x32_bf16 v[202:205], v[64:67], a[212:215], v[202:205]
    v_mfma_f32_16x16x32_bf16 v[190:193], v[68:71], a[208:211], v[190:193]
    ds_read_b128 v[64:67], v173 offset:8320
    v_mov_b32 v90, v92
    v_mfma_f32_16x16x32_bf16 v[206:209], v[68:71], a[212:215], v[206:209]
    s_waitcnt lgkmcnt(3)
    v_mfma_f32_16x16x32_bf16 v[178:181], v[48:51], a[200:203], v[178:181]
    ds_read_b128 v[68:71], v173 offset:9360
    global_load_lds_dwordx4 v81, s[70:71] offset:3072
    v_mfma_f32_16x16x32_bf16 v[194:197], v[48:51], a[204:207], v[194:197]
    ds_write2st64_b32 v170, v90, v91 offset0:0 offset1:1
    v_mfma_f32_16x16x32_bf16 v[182:185], v[52:55], a[200:203], v[182:185]
    ds_read_b128 v[48:51], v173 offset:10400
    ds_read_b128 v[98:101], v171 offset:0
    v_mfma_f32_16x16x32_bf16 v[198:201], v[52:55], a[204:207], v[198:201]
    s_waitcnt lgkmcnt(5)
    v_mfma_f32_16x16x32_bf16 v[186:189], v[56:59], a[200:203], v[186:189]
    ds_read_b128 v[52:55], v173 offset:11440
    ds_read_b128 v[102:105], v171 offset:16
    v_mfma_f32_16x16x32_bf16 v[202:205], v[56:59], a[204:207], v[202:205]
    global_load_dwordx4 a[0:3], v4, s[52:53] offset:-4096 sc1
    v_mfma_f32_16x16x32_bf16 v[190:193], v[60:63], a[200:203], v[190:193]
    ds_read_b128 v[56:59], v173 offset:4160
    ds_read_b128 v[106:109], v171 offset:128
    v_mfma_f32_16x16x32_bf16 v[206:209], v[60:63], a[204:207], v[206:209]
    ds_read_b128 v[110:113], v171 offset:144
    s_waitcnt lgkmcnt(8)
    v_mfma_f32_16x16x32_bf16 v[178:181], v[64:67], a[192:195], v[178:181]
    ds_read_b128 v[60:63], v173 offset:5200
    v_mfma_f32_16x16x32_bf16 v[194:197], v[64:67], a[196:199], v[194:197]
    ds_read_b128 v[114:117], v171 offset:256
    v_mfma_f32_16x16x32_bf16 v[182:185], v[68:71], a[192:195], v[182:185]
    ds_read_b128 v[64:67], v173 offset:6240
    global_load_dwordx4 a[4:7], v7, s[58:59] offset:-4096 sc1
    v_mfma_f32_16x16x32_bf16 v[198:201], v[68:71], a[196:199], v[198:201]
    ds_read_b128 v[118:121], v171 offset:272
    s_waitcnt lgkmcnt(8)
    v_mfma_f32_16x16x32_bf16 v[186:189], v[48:51], a[192:195], v[186:189]
    ds_read_b128 v[68:71], v173 offset:7280
    v_mfma_f32_16x16x32_bf16 v[202:205], v[48:51], a[196:199], v[202:205]
    ds_read_b128 v[122:125], v171 offset:384
    v_mfma_f32_16x16x32_bf16 v[190:193], v[52:55], a[192:195], v[190:193]
    ds_read_b128 v[48:51], v173 offset:0
    v_mfma_f32_16x16x32_bf16 v[206:209], v[52:55], a[196:199], v[206:209]
    ds_read_b128 v[126:129], v171 offset:400
    s_waitcnt lgkmcnt(7)
    v_mfma_f32_16x16x32_bf16 v[178:181], v[56:59], a[184:187], v[178:181]
    ds_read_b128 v[52:55], v173 offset:1040
    global_load_dwordx4 a[8:11], v4, s[52:53] offset:-3072 sc1
    v_mfma_f32_16x16x32_bf16 v[194:197], v[56:59], a[188:191], v[194:197]
    ds_read_b32 v162, v172 offset:0
    v_mfma_f32_16x16x32_bf16 v[182:185], v[60:63], a[184:187], v[182:185]
    ds_read_b128 v[56:59], v173 offset:2080
    v_mfma_f32_16x16x32_bf16 v[198:201], v[60:63], a[188:191], v[198:201]
    ds_read_b32 v163, v172 offset:256
    s_waitcnt lgkmcnt(7)
    v_mfma_f32_16x16x32_bf16 v[186:189], v[64:67], a[184:187], v[186:189]
    ds_read_b128 v[60:63], v173 offset:3120
    ds_read_b32 v164, v172 offset:16
    v_mfma_f32_16x16x32_bf16 v[202:205], v[64:67], a[188:191], v[202:205]
    global_load_dwordx4 a[12:15], v7, s[58:59] offset:-3072 sc1
    v_mfma_f32_16x16x32_bf16 v[190:193], v[68:71], a[184:187], v[190:193]
    ds_read_b128 v[64:67], v4 offset:37440
    ds_read_b32 v165, v172 offset:272
    v_mfma_f32_16x16x32_bf16 v[206:209], v[68:71], a[188:191], v[206:209]
    s_waitcnt lgkmcnt(7)
    v_mfma_f32_16x16x32_bf16 v[178:181], v[48:51], a[176:179], v[178:181]
    ds_read_b128 v[68:71], v4 offset:38480
    ds_read_b32 v166, v172 offset:128
    v_mfma_f32_16x16x32_bf16 v[194:197], v[48:51], a[180:183], v[194:197]
    v_mfma_f32_16x16x32_bf16 v[182:185], v[52:55], a[176:179], v[182:185]
    ds_read_b128 v[48:51], v4 offset:39520
    ds_read_b32 v167, v172 offset:384
    v_mfma_f32_16x16x32_bf16 v[198:201], v[52:55], a[180:183], v[198:201]
    global_load_dwordx4 a[16:19], v4, s[52:53] offset:-2048 sc1
    s_waitcnt lgkmcnt(7)
    v_mfma_f32_16x16x32_bf16 v[186:189], v[56:59], a[176:179], v[186:189]
    ds_read_b128 v[52:55], v4 offset:40560
    ds_read_b32 v168, v172 offset:144
    v_mfma_f32_16x16x32_bf16 v[202:205], v[56:59], a[180:183], v[202:205]
    v_mfma_f32_16x16x32_bf16 v[190:193], v[60:63], a[176:179], v[190:193]
    ds_read_b128 v[56:59], v4 offset:33280
    ds_read_b32 v169, v172 offset:400
    v_mfma_f32_16x16x32_bf16 v[206:209], v[60:63], a[180:183], v[206:209]
    s_waitcnt lgkmcnt(7)
    v_mfma_f32_16x16x32_bf16 v[178:181], v[64:67], a[168:171], v[178:181]
    ds_read_b128 v[60:63], v4 offset:34320
    s_add_u32 s4, s88, 156672
    global_load_dwordx4 a[20:23], v7, s[58:59] offset:-2048 sc1
    v_mfma_f32_16x16x32_bf16 v[194:197], v[64:67], a[172:175], v[194:197]
    v_lshl_add_u32 v28, v2, 2, s4
    v_mfma_f32_16x16x32_bf16 v[182:185], v[68:71], a[168:171], v[182:185]
    ds_read_b128 v[64:67], v4 offset:35360
    v_mfma_f32_16x16x32_bf16 v[198:201], v[68:71], a[172:175], v[198:201]
    ds_read2_b32 v[8:9], v28 offset0:0 offset1:16
    s_waitcnt lgkmcnt(6)
    v_mfma_f32_16x16x32_bf16 v[186:189], v[48:51], a[168:171], v[186:189]
    ds_read_b128 v[68:71], v4 offset:36400
    v_mfma_f32_16x16x32_bf16 v[202:205], v[48:51], a[172:175], v[202:205]
    global_load_dwordx4 a[24:27], v4, s[52:53] offset:-1024 sc1
    ds_read2_b32 v[10:11], v28 offset0:32 offset1:48
    v_mfma_f32_16x16x32_bf16 v[190:193], v[52:55], a[168:171], v[190:193]
    ds_read_b128 v[48:51], v4 offset:29120
    v_mfma_f32_16x16x32_bf16 v[206:209], v[52:55], a[172:175], v[206:209]
    v_lshl_add_u32 v28, v3, 4, s4
    s_waitcnt lgkmcnt(5)
    v_mfma_f32_16x16x32_bf16 v[178:181], v[56:59], a[160:163], v[178:181]
    ds_read_b128 v[52:55], v4 offset:30160
    v_mfma_f32_16x16x32_bf16 v[194:197], v[56:59], a[164:167], v[194:197]
    ds_read_b128 v[12:15], v28 offset:256
    v_mfma_f32_16x16x32_bf16 v[182:185], v[60:63], a[160:163], v[182:185]
    ds_read_b128 v[56:59], v4 offset:31200
    global_load_dwordx4 a[28:31], v7, s[58:59] offset:-1024 sc1
    v_mfma_f32_16x16x32_bf16 v[198:201], v[60:63], a[164:167], v[198:201]
    ds_read_b128 v[16:19], v28 offset:320
    s_waitcnt lgkmcnt(6)
    v_mfma_f32_16x16x32_bf16 v[186:189], v[64:67], a[160:163], v[186:189]
    ds_read_b128 v[60:63], v4 offset:32240
    ds_read_b128 v[20:23], v28 offset:384
    v_mfma_f32_16x16x32_bf16 v[202:205], v[64:67], a[164:167], v[202:205]
    v_mfma_f32_16x16x32_bf16 v[190:193], v[68:71], a[160:163], v[190:193]
    ds_read_b128 v[64:67], v4 offset:24960
    ds_read_b128 v[24:27], v28 offset:448
    v_mfma_f32_16x16x32_bf16 v[206:209], v[68:71], a[164:167], v[206:209]
    s_waitcnt lgkmcnt(7)
    v_mfma_f32_16x16x32_bf16 v[178:181], v[48:51], a[152:155], v[178:181]
    ds_read_b128 v[68:71], v4 offset:26000
    global_load_dwordx4 a[32:35], v4, s[52:53] offset:0 sc1
    v_mfma_f32_16x16x32_bf16 v[194:197], v[48:51], a[156:159], v[194:197]
    v_fma_f32 v130, v114, v8, v9
    v_mfma_f32_16x16x32_bf16 v[182:185], v[52:55], a[152:155], v[182:185]
    ds_read_b128 v[48:51], v4 offset:27040
    v_fma_f32 v131, v115, v8, v9
    v_mfma_f32_16x16x32_bf16 v[198:201], v[52:55], a[156:159], v[198:201]
    s_waitcnt lgkmcnt(5)
    v_mfma_f32_16x16x32_bf16 v[186:189], v[56:59], a[152:155], v[186:189]
    ds_read_b128 v[52:55], v4 offset:28080
    v_fma_f32 v132, v116, v8, v9
    v_mfma_f32_16x16x32_bf16 v[202:205], v[56:59], a[156:159], v[202:205]
    global_load_dwordx4 a[36:39], v7, s[58:59] offset:0 sc1
    v_mfma_f32_16x16x32_bf16 v[190:193], v[60:63], a[152:155], v[190:193]
    ds_read_b128 v[56:59], v4 offset:20800
    v_fma_f32 v133, v117, v8, v9
    v_mfma_f32_16x16x32_bf16 v[206:209], v[60:63], a[156:159], v[206:209]
    s_waitcnt lgkmcnt(3)
    v_mfma_f32_16x16x32_bf16 v[178:181], v[64:67], a[144:147], v[178:181]
    ds_read_b128 v[60:63], v4 offset:21840
    v_fma_f32 v134, v118, v8, v9
    v_mfma_f32_16x16x32_bf16 v[194:197], v[64:67], a[148:151], v[194:197]
    v_fma_f32 v135, v119, v8, v9
    v_mfma_f32_16x16x32_bf16 v[182:185], v[68:71], a[144:147], v[182:185]
    ds_read_b128 v[64:67], v4 offset:22880
    global_load_dwordx4 a[40:43], v4, s[52:53] offset:1024 sc1
    v_mfma_f32_16x16x32_bf16 v[198:201], v[68:71], a[148:151], v[198:201]
    v_fma_f32 v136, v120, v8, v9
    s_waitcnt lgkmcnt(3)
    v_mfma_f32_16x16x32_bf16 v[186:189], v[48:51], a[144:147], v[186:189]
    ds_read_b128 v[68:71], v4 offset:23920
    v_mfma_f32_16x16x32_bf16 v[202:205], v[48:51], a[148:151], v[202:205]
    v_fma_f32 v137, v121, v8, v9
    v_mfma_f32_16x16x32_bf16 v[190:193], v[52:55], a[144:147], v[190:193]
    ds_read_b128 v[48:51], v4 offset:16640
    v_mfma_f32_16x16x32_bf16 v[206:209], v[52:55], a[148:151], v[206:209]
    v_fma_f32 v138, v122, v8, v9
    s_waitcnt lgkmcnt(3)
    v_mfma_f32_16x16x32_bf16 v[178:181], v[56:59], a[136:139], v[178:181]
    ds_read_b128 v[52:55], v4 offset:17680
    global_load_dwordx4 a[44:47], v7, s[58:59] offset:1024 sc1
    v_mfma_f32_16x16x32_bf16 v[194:197], v[56:59], a[140:143], v[194:197]
    v_fma_f32 v139, v123, v8, v9
    v_mfma_f32_16x16x32_bf16 v[182:185], v[60:63], a[136:139], v[182:185]
    ds_read_b128 v[56:59], v4 offset:18720
    v_mfma_f32_16x16x32_bf16 v[198:201], v[60:63], a[140:143], v[198:201]
    v_fma_f32 v140, v124, v8, v9
    s_waitcnt lgkmcnt(3)
    v_mfma_f32_16x16x32_bf16 v[186:189], v[64:67], a[136:139], v[186:189]
    ds_read_b128 v[60:63], v4 offset:19760
    v_mfma_f32_16x16x32_bf16 v[202:205], v[64:67], a[140:143], v[202:205]
    v_fma_f32 v141, v125, v8, v9
    global_load_dwordx4 a[48:51], v4, s[52:53] offset:2048 sc1
    v_mfma_f32_16x16x32_bf16 v[190:193], v[68:71], a[136:139], v[190:193]
    ds_read_b128 v[64:67], v4 offset:0
    v_fma_f32 v142, v126, v8, v9
    v_mfma_f32_16x16x32_bf16 v[206:209], v[68:71], a[140:143], v[206:209]
    s_waitcnt lgkmcnt(3)
    v_mfma_f32_16x16x32_bf16 v[178:181], v[48:51], a[128:131], v[178:181]
    ds_read_b128 v[68:71], v4 offset:1040
    v_fma_f32 v143, v127, v8, v9
    v_mfma_f32_16x16x32_bf16 v[194:197], v[48:51], a[132:135], v[194:197]
    v_mfma_f32_16x16x32_bf16 v[182:185], v[52:55], a[128:131], v[182:185]
    ds_read_b128 v[48:51], v4 offset:2080
    v_fma_f32 v144, v128, v8, v9
    v_mfma_f32_16x16x32_bf16 v[198:201], v[52:55], a[132:135], v[198:201]
    global_load_dwordx4 a[52:55], v7, s[58:59] offset:2048 sc1
    s_waitcnt lgkmcnt(3)
    v_mfma_f32_16x16x32_bf16 v[186:189], v[56:59], a[128:131], v[186:189]
    ds_read_b128 v[52:55], v4 offset:3120
    v_fma_f32 v145, v129, v8, v9
    v_mfma_f32_16x16x32_bf16 v[202:205], v[56:59], a[132:135], v[202:205]
    v_mfma_f32_16x16x32_bf16 v[190:193], v[60:63], a[128:131], v[190:193]
    ds_read_b128 v[56:59], v4 offset:4160
    v_fma_f32 v146, v114, v10, v11
    v_mfma_f32_16x16x32_bf16 v[206:209], v[60:63], a[132:135], v[206:209]
    s_waitcnt lgkmcnt(3)
    s_waitcnt vmcnt(29)
    v_mfma_f32_16x16x32_bf16 v[178:181], v[64:67], a[96:99], v[178:181]
    ds_read_b128 v[60:63], v4 offset:5200
    global_load_dwordx4 a[56:59], v4, s[52:53] offset:3072 sc1
    s_waitcnt vmcnt(29)
    v_mfma_f32_16x16x32_bf16 v[194:197], v[64:67], a[100:103], v[194:197]
    v_fma_f32 v147, v115, v10, v11
    v_mfma_f32_16x16x32_bf16 v[182:185], v[68:71], a[96:99], v[182:185]
    ds_read_b128 v[64:67], v4 offset:6240
    v_fma_f32 v148, v116, v10, v11
    v_mfma_f32_16x16x32_bf16 v[198:201], v[68:71], a[100:103], v[198:201]
    v_fma_f32 v149, v117, v10, v11
    s_waitcnt lgkmcnt(3)
    v_mfma_f32_16x16x32_bf16 v[186:189], v[48:51], a[96:99], v[186:189]
    ds_read_b128 v[68:71], v4 offset:7280
    v_mfma_f32_16x16x32_bf16 v[202:205], v[48:51], a[100:103], v[202:205]
    global_load_dwordx4 a[60:63], v7, s[58:59] offset:3072 sc1
    v_fma_f32 v150, v118, v10, v11
    v_mfma_f32_16x16x32_bf16 v[190:193], v[52:55], a[96:99], v[190:193]
    ds_read_b128 v[48:51], v4 offset:8320
    v_mfma_f32_16x16x32_bf16 v[206:209], v[52:55], a[100:103], v[206:209]
    v_fma_f32 v151, v119, v10, v11
    s_waitcnt lgkmcnt(3)
    s_waitcnt vmcnt(29)
    v_mfma_f32_16x16x32_bf16 v[178:181], v[56:59], a[104:107], v[178:181]
    ds_read_b128 v[52:55], v4 offset:9360
    s_waitcnt vmcnt(28)
    v_mfma_f32_16x16x32_bf16 v[194:197], v[56:59], a[108:111], v[194:197]
    v_fma_f32 v152, v120, v10, v11
    v_mfma_f32_16x16x32_bf16 v[182:185], v[60:63], a[104:107], v[182:185]
    ds_read_b128 v[56:59], v4 offset:10400
    global_load_dwordx4 a[64:67], v4, s[54:55] offset:-4096 sc1
    v_mfma_f32_16x16x32_bf16 v[198:201], v[60:63], a[108:111], v[198:201]
    v_fma_f32 v153, v121, v10, v11
    s_waitcnt lgkmcnt(3)
    v_mfma_f32_16x16x32_bf16 v[186:189], v[64:67], a[104:107], v[186:189]
    ds_read_b128 v[60:63], v4 offset:11440
    v_mfma_f32_16x16x32_bf16 v[202:205], v[64:67], a[108:111], v[202:205]
    v_fma_f32 v154, v122, v10, v11
    v_mfma_f32_16x16x32_bf16 v[190:193], v[68:71], a[104:107], v[190:193]
    ds_read_b128 v[64:67], v4 offset:12480
    v_mfma_f32_16x16x32_bf16 v[206:209], v[68:71], a[108:111], v[206:209]
    v_fma_f32 v155, v123, v10, v11
    s_waitcnt lgkmcnt(3)
    s_waitcnt vmcnt(28)
    v_mfma_f32_16x16x32_bf16 v[178:181], v[48:51], a[112:115], v[178:181]
    ds_read_b128 v[68:71], v4 offset:13520
    global_load_dwordx4 a[68:71], v7, s[60:61] offset:-4096 sc1
    s_waitcnt vmcnt(28)
    v_mfma_f32_16x16x32_bf16 v[194:197], v[48:51], a[116:119], v[194:197]
    v_fma_f32 v156, v124, v10, v11
    v_mfma_f32_16x16x32_bf16 v[182:185], v[52:55], a[112:115], v[182:185]
    ds_read_b128 v[48:51], v4 offset:14560
    v_fma_f32 v157, v125, v10, v11
    v_mfma_f32_16x16x32_bf16 v[198:201], v[52:55], a[116:119], v[198:201]
    s_waitcnt lgkmcnt(3)
    v_mfma_f32_16x16x32_bf16 v[186:189], v[56:59], a[112:115], v[186:189]
    ds_read_b128 v[52:55], v4 offset:15600
    v_fma_f32 v158, v126, v10, v11
    v_mfma_f32_16x16x32_bf16 v[202:205], v[56:59], a[116:119], v[202:205]
    global_load_dwordx4 a[72:75], v4, s[54:55] offset:-3072 sc1
    v_mfma_f32_16x16x32_bf16 v[190:193], v[60:63], a[112:115], v[190:193]
    v_fma_f32 v159, v127, v10, v11
    v_mfma_f32_16x16x32_bf16 v[206:209], v[60:63], a[116:119], v[206:209]
    s_waitcnt lgkmcnt(2)
    s_waitcnt vmcnt(28)
    v_mfma_f32_16x16x32_bf16 v[178:181], v[64:67], a[120:123], v[178:181]
    v_fma_f32 v160, v128, v10, v11
    s_waitcnt vmcnt(27)
    v_mfma_f32_16x16x32_bf16 v[194:197], v[64:67], a[124:127], v[194:197]
    v_mfma_f32_16x16x32_bf16 v[182:185], v[68:71], a[120:123], v[182:185]
    v_fma_f32 v161, v129, v10, v11
    global_load_dwordx4 a[76:79], v7, s[60:61] offset:-3072 sc1
    v_mfma_f32_16x16x32_bf16 v[198:201], v[68:71], a[124:127], v[198:201]
    s_waitcnt lgkmcnt(0)
    v_mfma_f32_16x16x32_bf16 v[186:189], v[48:51], a[120:123], v[186:189]
    v_mfma_f32_16x16x32_bf16 v[202:205], v[48:51], a[124:127], v[202:205]
    v_mfma_f32_16x16x32_bf16 v[190:193], v[52:55], a[120:123], v[190:193]
    v_mfma_f32_16x16x32_bf16 v[206:209], v[52:55], a[124:127], v[206:209]
    s_nop 7
    s_cmp_eq_u32 s101, 2
    s_cbranch_scc1 Lz_keep
    v_mov_b32 v194, 0
    v_mov_b32 v195, 0
    v_mov_b32 v196, 0
    v_mov_b32 v197, 0
    v_mov_b32 v198, 0
    v_mov_b32 v199, 0
    v_mov_b32 v200, 0
    v_mov_b32 v201, 0
    v_mov_b32 v202, 0
    v_mov_b32 v203, 0
    v_mov_b32 v204, 0
    v_mov_b32 v205, 0
    v_mov_b32 v206, 0
    v_mov_b32 v207, 0
    v_mov_b32 v208, 0
    v_mov_b32 v209, 0
    s_cmp_eq_u32 s101, 1
    s_cbranch_scc1 Lz_keep
    v_mov_b32 v178, 0
    v_mov_b32 v179, 0
    v_mov_b32 v180, 0
    v_mov_b32 v181, 0
    v_mov_b32 v182, 0
    v_mov_b32 v183, 0
    v_mov_b32 v184, 0
    v_mov_b32 v185, 0
    v_mov_b32 v186, 0
    v_mov_b32 v187, 0
    v_mov_b32 v188, 0
    v_mov_b32 v189, 0
    v_mov_b32 v190, 0
    v_mov_b32 v191, 0
    v_mov_b32 v192, 0
    v_mov_b32 v193, 0
Lz_keep:
    global_load_dwordx4 a[80:83], v4, s[54:55] offset:-2048 sc1
    v_pk_fma_f32 v[178:179], v[178:179], v[98:99], v[130:131] op_sel:[0,0,0] op_sel_hi:[1,1,1]
    v_pk_fma_f32 v[180:181], v[180:181], v[100:101], v[132:133] op_sel:[0,0,0] op_sel_hi:[1,1,1]
    v_pk_fma_f32 v[182:183], v[182:183], v[102:103], v[134:135] op_sel:[0,0,0] op_sel_hi:[1,1,1]
    v_pk_fma_f32 v[184:185], v[184:185], v[104:105], v[136:137] op_sel:[0,0,0] op_sel_hi:[1,1,1]
    global_load_dwordx4 a[84:87], v7, s[60:61] offset:-2048 sc1
    v_pk_fma_f32 v[186:187], v[186:187], v[106:107], v[138:139] op_sel:[0,0,0] op_sel_hi:[1,1,1]
    v_pk_fma_f32 v[188:189], v[188:189], v[108:109], v[140:141] op_sel:[0,0,0] op_sel_hi:[1,1,1]
    v_pk_fma_f32 v[190:191], v[190:191], v[110:111], v[142:143] op_sel:[0,0,0] op_sel_hi:[1,1,1]
    v_pk_fma_f32 v[192:193], v[192:193], v[112:113], v[144:145] op_sel:[0,0,0] op_sel_hi:[1,1,1]
    global_load_dwordx4 a[88:91], v4, s[54:55] offset:-1024 sc1
    v_pk_fma_f32 v[194:195], v[194:195], v[98:99], v[146:147] op_sel:[0,0,0] op_sel_hi:[1,1,1]
    v_pk_fma_f32 v[196:197], v[196:197], v[100:101], v[148:149] op_sel:[0,0,0] op_sel_hi:[1,1,1]
    v_pk_fma_f32 v[198:199], v[198:199], v[102:103], v[150:151] op_sel:[0,0,0] op_sel_hi:[1,1,1]
    v_pk_fma_f32 v[200:201], v[200:201], v[104:105], v[152:153] op_sel:[0,0,0] op_sel_hi:[1,1,1]
    v_pk_fma_f32 v[202:203], v[202:203], v[106:107], v[154:155] op_sel:[0,0,0] op_sel_hi:[1,1,1]
    global_load_dwordx4 a[92:95], v7, s[60:61] offset:-1024 sc1
    v_pk_fma_f32 v[204:205], v[204:205], v[108:109], v[156:157] op_sel:[0,0,0] op_sel_hi:[1,1,1]
    v_pk_fma_f32 v[206:207], v[206:207], v[110:111], v[158:159] op_sel:[0,0,0] op_sel_hi:[1,1,1]
    v_pk_fma_f32 v[208:209], v[208:209], v[112:113], v[160:161] op_sel:[0,0,0] op_sel_hi:[1,1,1]
    v_pk_mul_f32 v[130:131], v[178:179], v[178:179] op_sel:[0,0] op_sel_hi:[1,1]
    global_load_dwordx4 a[96:99], v4, s[54:55] offset:0 sc1
    v_pk_mul_f32 v[132:133], v[180:181], v[180:181] op_sel:[0,0] op_sel_hi:[1,1]
    v_pk_mul_f32 v[134:135], v[182:183], v[182:183] op_sel:[0,0] op_sel_hi:[1,1]
    v_pk_mul_f32 v[136:137], v[184:185], v[184:185] op_sel:[0,0] op_sel_hi:[1,1]
    v_pk_mul_f32 v[138:139], v[186:187], v[186:187] op_sel:[0,0] op_sel_hi:[1,1]
    global_load_dwordx4 a[100:103], v7, s[60:61] offset:0 sc1
    v_pk_mul_f32 v[140:141], v[188:189], v[188:189] op_sel:[0,0] op_sel_hi:[1,1]
    v_pk_mul_f32 v[142:143], v[190:191], v[190:191] op_sel:[0,0] op_sel_hi:[1,1]
    v_pk_mul_f32 v[144:145], v[192:193], v[192:193] op_sel:[0,0] op_sel_hi:[1,1]
    v_pk_mul_f32 v[146:147], v[194:195], v[194:195] op_sel:[0,0] op_sel_hi:[1,1]
    v_pk_mul_f32 v[148:149], v[196:197], v[196:197] op_sel:[0,0] op_sel_hi:[1,1]
    global_load_dwordx4 a[104:107], v4, s[54:55] offset:1024 sc1
    v_pk_mul_f32 v[150:151], v[198:199], v[198:199] op_sel:[0,0] op_sel_hi:[1,1]
    v_pk_mul_f32 v[152:153], v[200:201], v[200:201] op_sel:[0,0] op_sel_hi:[1,1]
    v_pk_mul_f32 v[154:155], v[202:203], v[202:203] op_sel:[0,0] op_sel_hi:[1,1]
    v_pk_mul_f32 v[156:157], v[204:205], v[204:205] op_sel:[0,0] op_sel_hi:[1,1]
    global_load_dwordx4 a[108:111], v7, s[60:61] offset:1024 sc1
    v_pk_mul_f32 v[158:159], v[206:207], v[206:207] op_sel:[0,0] op_sel_hi:[1,1]
    v_pk_mul_f32 v[160:161], v[208:209], v[208:209] op_sel:[0,0] op_sel_hi:[1,1]
    v_pk_fma_f32 v[130:131], v[130:131], s[84:85], s[84:85] op_sel:[0,1,0] op_sel_hi:[1,1,0]
    v_pk_fma_f32 v[132:133], v[132:133], s[84:85], s[84:85] op_sel:[0,1,0] op_sel_hi:[1,1,0]
    global_load_dwordx4 a[112:115], v4, s[54:55] offset:2048 sc1
    v_pk_fma_f32 v[134:135], v[134:135], s[84:85], s[84:85] op_sel:[0,1,0] op_sel_hi:[1,1,0]
    v_pk_fma_f32 v[136:137], v[136:137], s[84:85], s[84:85] op_sel:[0,1,0] op_sel_hi:[1,1,0]
    v_pk_fma_f32 v[138:139], v[138:139], s[84:85], s[84:85] op_sel:[0,1,0] op_sel_hi:[1,1,0]
    v_pk_fma_f32 v[140:141], v[140:141], s[84:85], s[84:85] op_sel:[0,1,0] op_sel_hi:[1,1,0]
    v_pk_fma_f32 v[142:143], v[142:143], s[84:85], s[84:85] op_sel:[0,1,0] op_sel_hi:[1,1,0]
    global_load_dwordx4 a[116:119], v7, s[60:61] offset:2048 sc1
    v_pk_fma_f32 v[144:145], v[144:145], s[84:85], s[84:85] op_sel:[0,1,0] op_sel_hi:[1,1,0]
    v_pk_fma_f32 v[146:147], v[146:147], s[84:85], s[84:85] op_sel:[0,1,0] op_sel_hi:[1,1,0]
    v_pk_fma_f32 v[148:149], v[148:149], s[84:85], s[84:85] op_sel:[0,1,0] op_sel_hi:[1,1,0]
    v_pk_fma_f32 v[150:151], v[150:151], s[84:85], s[84:85] op_sel:[0,1,0] op_sel_hi:[1,1,0]
    global_load_dwordx4 a[120:123], v4, s[54:55] offset:3072 sc1
    v_pk_fma_f32 v[152:153], v[152:153], s[84:85], s[84:85] op_sel:[0,1,0] op_sel_hi:[1,1,0]
    v_pk_fma_f32 v[154:155], v[154:155], s[84:85], s[84:85] op_sel:[0,1,0] op_sel_hi:[1,1,0]
    v_pk_fma_f32 v[156:157], v[156:157], s[84:85], s[84:85] op_sel:[0,1,0] op_sel_hi:[1,1,0]
    v_pk_fma_f32 v[158:159], v[158:159], s[84:85], s[84:85] op_sel:[0,1,0] op_sel_hi:[1,1,0]
    global_load_dwordx4 a[124:127], v7, s[60:61] offset:3072 sc1
    v_pk_fma_f32 v[160:161], v[160:161], s[84:85], s[84:85] op_sel:[0,1,0] op_sel_hi:[1,1,0]
    v_pk_mul_f32 v[130:131], v[130:131], v[178:179] op_sel:[0,0] op_sel_hi:[1,1]
    v_pk_mul_f32 v[132:133], v[132:133], v[180:181] op_sel:[0,0] op_sel_hi:[1,1]
    v_pk_mul_f32 v[134:135], v[134:135], v[182:183] op_sel:[0,0] op_sel_hi:[1,1]
    v_pk_mul_f32 v[136:137], v[136:137], v[184:185] op_sel:[0,0] op_sel_hi:[1,1]
    global_load_dwordx4 a[128:131], v4, s[56:57] offset:-4096 sc1
    v_pk_mul_f32 v[138:139], v[138:139], v[186:187] op_sel:[0,0] op_sel_hi:[1,1]
    v_pk_mul_f32 v[140:141], v[140:141], v[188:189] op_sel:[0,0] op_sel_hi:[1,1]
    v_pk_mul_f32 v[142:143], v[142:143], v[190:191] op_sel:[0,0] op_sel_hi:[1,1]
    v_pk_mul_f32 v[144:145], v[144:145], v[192:193] op_sel:[0,0] op_sel_hi:[1,1]
    global_load_dwordx4 a[132:135], v7, s[62:63] offset:-4096 sc1
    v_pk_mul_f32 v[146:147], v[146:147], v[194:195] op_sel:[0,0] op_sel_hi:[1,1]
    v_pk_mul_f32 v[148:149], v[148:149], v[196:197] op_sel:[0,0] op_sel_hi:[1,1]
    v_pk_mul_f32 v[150:151], v[150:151], v[198:199] op_sel:[0,0] op_sel_hi:[1,1]
    v_pk_mul_f32 v[152:153], v[152:153], v[200:201] op_sel:[0,0] op_sel_hi:[1,1]
    global_load_dwordx4 a[136:139], v4, s[56:57] offset:-3072 sc1
    v_pk_mul_f32 v[154:155], v[154:155], v[202:203] op_sel:[0,0] op_sel_hi:[1,1]
    v_pk_mul_f32 v[156:157], v[156:157], v[204:205] op_sel:[0,0] op_sel_hi:[1,1]
    v_pk_mul_f32 v[158:159], v[158:159], v[206:207] op_sel:[0,0] op_sel_hi:[1,1]
    v_pk_mul_f32 v[160:161], v[160:161], v[208:209] op_sel:[0,0] op_sel_hi:[1,1]
    v_exp_f32 v130, v130
    global_load_dwordx4 a[140:143], v7, s[62:63] offset:-3072 sc1
    v_exp_f32 v131, v131
    v_exp_f32 v132, v132
    v_exp_f32 v133, v133
    v_exp_f32 v134, v134
    global_load_dwordx4 a[144:147], v4, s[56:57] offset:-2048 sc1
    v_exp_f32 v135, v135
    v_exp_f32 v136, v136
    v_exp_f32 v137, v137
    v_exp_f32 v138, v138
    global_load_dwordx4 a[148:151], v7, s[62:63] offset:-2048 sc1
    v_exp_f32 v139, v139
    v_exp_f32 v140, v140
    v_exp_f32 v141, v141
    v_exp_f32 v142, v142
    v_exp_f32 v143, v143
    global_load_dwordx4 a[152:155], v4, s[56:57] offset:-1024 sc1
    v_exp_f32 v144, v144
    v_exp_f32 v145, v145
    v_exp_f32 v146, v146
    v_exp_f32 v147, v147
    global_load_dwordx4 a[156:159], v7, s[62:63] offset:-1024 sc1
    v_exp_f32 v148, v148
    v_exp_f32 v149, v149
    v_exp_f32 v150, v150
    v_exp_f32 v151, v151
    ds_read_b128 a[224:227], v82 offset:0
    v_exp_f32 v152, v152
    v_exp_f32 v153, v153
    v_exp_f32 v154, v154
    v_exp_f32 v155, v155
    v_exp_f32 v156, v156
    ds_read_b128 a[228:231], v84 offset:0
    v_exp_f32 v157, v157
    v_exp_f32 v158, v158
    v_exp_f32 v159, v159
    v_exp_f32 v160, v160
    ds_read_b128 a[232:235], v86 offset:0
    v_exp_f32 v161, v161
    v_pk_add_f32 v[130:131], v[130:131], 1.0 op_sel:[0,0] op_sel_hi:[1,0]
    v_pk_add_f32 v[132:133], v[132:133], 1.0 op_sel:[0,0] op_sel_hi:[1,0]
    v_pk_add_f32 v[134:135], v[134:135], 1.0 op_sel:[0,0] op_sel_hi:[1,0]
    ds_read_b128 a[236:239], v88 offset:0
    v_pk_add_f32 v[136:137], v[136:137], 1.0 op_sel:[0,0] op_sel_hi:[1,0]
    v_pk_add_f32 v[138:139], v[138:139], 1.0 op_sel:[0,0] op_sel_hi:[1,0]
    v_pk_add_f32 v[140:141], v[140:141], 1.0 op_sel:[0,0] op_sel_hi:[1,0]
    v_pk_add_f32 v[142:143], v[142:143], 1.0 op_sel:[0,0] op_sel_hi:[1,0]
    v_pk_add_f32 v[144:145], v[144:145], 1.0 op_sel:[0,0] op_sel_hi:[1,0]
    ds_read_b128 a[240:243], v83 offset:0
    v_pk_add_f32 v[146:147], v[146:147], 1.0 op_sel:[0,0] op_sel_hi:[1,0]
    v_pk_add_f32 v[148:149], v[148:149], 1.0 op_sel:[0,0] op_sel_hi:[1,0]
    v_pk_add_f32 v[150:151], v[150:151], 1.0 op_sel:[0,0] op_sel_hi:[1,0]
    v_pk_add_f32 v[152:153], v[152:153], 1.0 op_sel:[0,0] op_sel_hi:[1,0]
    ds_read_b128 a[244:247], v85 offset:0
    v_pk_add_f32 v[154:155], v[154:155], 1.0 op_sel:[0,0] op_sel_hi:[1,0]
    v_pk_add_f32 v[156:157], v[156:157], 1.0 op_sel:[0,0] op_sel_hi:[1,0]
    v_pk_add_f32 v[158:159], v[158:159], 1.0 op_sel:[0,0] op_sel_hi:[1,0]
    v_pk_add_f32 v[160:161], v[160:161], 1.0 op_sel:[0,0] op_sel_hi:[1,0]
    v_rcp_f32 v130, v130
    ds_read_b128 a[248:251], v87 offset:0
    v_rcp_f32 v131, v131
    v_rcp_f32 v132, v132
    v_rcp_f32 v133, v133
    v_rcp_f32 v134, v134
    ds_read_b128 a[252:255], v89 offset:0
    v_rcp_f32 v135, v135
    v_rcp_f32 v136, v136
    v_rcp_f32 v137, v137
    v_rcp_f32 v138, v138
    s_waitcnt lgkmcnt(0)
    s_add_u32 m0, s89, 0
    s_nop 0
    global_load_lds_dwordx4 v74, s[72:73] offset:0
    v_rcp_f32 v139, v139
    v_rcp_f32 v140, v140
    v_rcp_f32 v141, v141
    v_rcp_f32 v142, v142
    v_rcp_f32 v143, v143
    global_load_lds_dwordx4 v75, s[72:73] offset:1024
    v_rcp_f32 v144, v144
    v_rcp_f32 v145, v145
    v_rcp_f32 v146, v146
    v_rcp_f32 v147, v147
    global_load_lds_dwordx4 v76, s[72:73] offset:2048
    v_rcp_f32 v148, v148
    v_rcp_f32 v149, v149
    v_rcp_f32 v150, v150
    v_rcp_f32 v151, v151
    global_load_lds_dwordx4 v77, s[72:73] offset:3072
    v_rcp_f32 v152, v152
    v_rcp_f32 v153, v153
    v_rcp_f32 v154, v154
    v_rcp_f32 v155, v155
    v_rcp_f32 v156, v156
    s_add_u32 m0, s89, 4096
    s_nop 0
    global_load_lds_dwordx4 v78, s[72:73] offset:0
    v_rcp_f32 v157, v157
    v_rcp_f32 v158, v158
    v_rcp_f32 v159, v159
    v_rcp_f32 v160, v160
    global_load_lds_dwordx4 v79, s[72:73] offset:1024
    v_rcp_f32 v161, v161
    v_pk_mul_f32 v[178:179], v[178:179], v[130:131] op_sel:[0,0] op_sel_hi:[1,1]
    v_pk_mul_f32 v[180:181], v[180:181], v[132:133] op_sel:[0,0] op_sel_hi:[1,1]
    v_pk_mul_f32 v[182:183], v[182:183], v[134:135] op_sel:[0,0] op_sel_hi:[1,1]
    global_load_lds_dwordx4 v80, s[72:73] offset:2048
    v_pk_mul_f32 v[184:185], v[184:185], v[136:137] op_sel:[0,0] op_sel_hi:[1,1]
    v_pk_mul_f32 v[186:187], v[186:187], v[138:139] op_sel:[0,0] op_sel_hi:[1,1]
    v_pk_mul_f32 v[188:189], v[188:189], v[140:141] op_sel:[0,0] op_sel_hi:[1,1]
    v_pk_mul_f32 v[190:191], v[190:191], v[142:143] op_sel:[0,0] op_sel_hi:[1,1]
    v_pk_mul_f32 v[192:193], v[192:193], v[144:145] op_sel:[0,0] op_sel_hi:[1,1]
    global_load_lds_dwordx4 v81, s[72:73] offset:3072
    v_pk_mul_f32 v[194:195], v[194:195], v[146:147] op_sel:[0,0] op_sel_hi:[1,1]
    v_pk_mul_f32 v[196:197], v[196:197], v[148:149] op_sel:[0,0] op_sel_hi:[1,1]
    v_pk_mul_f32 v[198:199], v[198:199], v[150:151] op_sel:[0,0] op_sel_hi:[1,1]
    v_pk_mul_f32 v[200:201], v[200:201], v[152:153] op_sel:[0,0] op_sel_hi:[1,1]
    s_waitcnt vmcnt(48)
    ds_read_b128 a[192:195], v82 offset:8192
    v_pk_mul_f32 v[202:203], v[202:203], v[154:155] op_sel:[0,0] op_sel_hi:[1,1]
    v_pk_mul_f32 v[204:205], v[204:205], v[156:157] op_sel:[0,0] op_sel_hi:[1,1]
    v_pk_mul_f32 v[206:207], v[206:207], v[158:159] op_sel:[0,0] op_sel_hi:[1,1]
    v_pk_mul_f32 v[208:209], v[208:209], v[160:161] op_sel:[0,0] op_sel_hi:[1,1]
    ds_read_b128 a[196:199], v84 offset:8192
    v_pk_add_f32 v[130:131], v[178:179], v[194:195] op_sel:[0,0] op_sel_hi:[1,1]
    v_pk_mul_f32 v[146:147], v[178:179], v[178:179] op_sel:[0,0] op_sel_hi:[1,1]
    v_pk_add_f32 v[132:133], v[180:181], v[196:197] op_sel:[0,0] op_sel_hi:[1,1]
    v_pk_mul_f32 v[148:149], v[180:181], v[180:181] op_sel:[0,0] op_sel_hi:[1,1]
    v_pk_add_f32 v[134:135], v[182:183], v[198:199] op_sel:[0,0] op_sel_hi:[1,1]
    ds_read_b128 a[200:203], v86 offset:8192
    v_pk_mul_f32 v[150:151], v[182:183], v[182:183] op_sel:[0,0] op_sel_hi:[1,1]
    v_pk_add_f32 v[136:137], v[184:185], v[200:201] op_sel:[0,0] op_sel_hi:[1,1]
    v_pk_mul_f32 v[152:153], v[184:185], v[184:185] op_sel:[0,0] op_sel_hi:[1,1]
    v_pk_add_f32 v[138:139], v[186:187], v[202:203] op_sel:[0,0] op_sel_hi:[1,1]
    ds_read_b128 a[204:207], v88 offset:8192
    v_pk_mul_f32 v[154:155], v[186:187], v[186:187] op_sel:[0,0] op_sel_hi:[1,1]
    v_pk_add_f32 v[140:141], v[188:189], v[204:205] op_sel:[0,0] op_sel_hi:[1,1]
    v_pk_mul_f32 v[156:157], v[188:189], v[188:189] op_sel:[0,0] op_sel_hi:[1,1]
    v_pk_add_f32 v[142:143], v[190:191], v[206:207] op_sel:[0,0] op_sel_hi:[1,1]
    ds_read_b128 a[208:211], v83 offset:8192
    v_pk_mul_f32 v[158:159], v[190:191], v[190:191] op_sel:[0,0] op_sel_hi:[1,1]
    v_pk_add_f32 v[144:145], v[192:193], v[208:209] op_sel:[0,0] op_sel_hi:[1,1]
    v_pk_mul_f32 v[160:161], v[192:193], v[192:193] op_sel:[0,0] op_sel_hi:[1,1]
    v_pk_fma_f32 v[146:147], v[194:195], v[194:195], v[146:147] op_sel:[0,0,0] op_sel_hi:[1,1,1]
    v_pk_fma_f32 v[148:149], v[196:197], v[196:197], v[148:149] op_sel:[0,0,0] op_sel_hi:[1,1,1]
    ds_read_b128 a[212:215], v85 offset:8192
    v_pk_fma_f32 v[150:151], v[198:199], v[198:199], v[150:151] op_sel:[0,0,0] op_sel_hi:[1,1,1]
    v_pk_fma_f32 v[152:153], v[200:201], v[200:201], v[152:153] op_sel:[0,0,0] op_sel_hi:[1,1,1]
    v_pk_fma_f32 v[154:155], v[202:203], v[202:203], v[154:155] op_sel:[0,0,0] op_sel_hi:[1,1,1]
    v_pk_fma_f32 v[156:157], v[204:205], v[204:205], v[156:157] op_sel:[0,0,0] op_sel_hi:[1,1,1]
    ds_read_b128 a[216:219], v87 offset:8192
    v_pk_fma_f32 v[158:159], v[206:207], v[206:207], v[158:159] op_sel:[0,0,0] op_sel_hi:[1,1,1]
    v_pk_fma_f32 v[160:161], v[208:209], v[208:209], v[160:161] op_sel:[0,0,0] op_sel_hi:[1,1,1]
    v_add_f32_dpp v98, v130, v130 row_ror:8 row_mask:0xf bank_mask:0x3
    v_add_f32_dpp v99, v131, v131 row_ror:8 row_mask:0xf bank_mask:0x3
    ds_read_b128 a[220:223], v89 offset:8192
    v_add_f32_dpp v100, v132, v132 row_ror:8 row_mask:0xf bank_mask:0x3
    v_add_f32_dpp v101, v133, v133 row_ror:8 row_mask:0xf bank_mask:0x3
    v_add_f32_dpp v102, v134, v134 row_ror:8 row_mask:0xf bank_mask:0x3
    v_add_f32_dpp v103, v135, v135 row_ror:8 row_mask:0xf bank_mask:0x3
    v_add_f32_dpp v104, v136, v136 row_ror:8 row_mask:0xf bank_mask:0x3
    s_waitcnt lgkmcnt(0)
    s_add_u32 m0, s89, 8192
    s_nop 0
    global_load_lds_dwordx4 v74, s[74:75] offset:0
    v_add_f32_dpp v105, v137, v137 row_ror:8 row_mask:0xf bank_mask:0x3
    v_add_f32_dpp v106, v138, v138 row_ror:8 row_mask:0xf bank_mask:0x3
    v_add_f32_dpp v107, v139, v139 row_ror:8 row_mask:0xf bank_mask:0x3
    v_add_f32_dpp v108, v140, v140 row_ror:8 row_mask:0xf bank_mask:0x3
    global_load_lds_dwordx4 v75, s[74:75] offset:1024
    v_add_f32_dpp v109, v141, v141 row_ror:8 row_mask:0xf bank_mask:0x3
    v_add_f32_dpp v110, v142, v142 row_ror:8 row_mask:0xf bank_mask:0x3
    v_add_f32_dpp v111, v143, v143 row_ror:8 row_mask:0xf bank_mask:0x3
    v_add_f32_dpp v112, v144, v144 row_ror:8 row_mask:0xf bank_mask:0x3
    global_load_lds_dwordx4 v76, s[74:75] offset:2048
    v_add_f32_dpp v113, v145, v145 row_ror:8 row_mask:0xf bank_mask:0x3
    v_add_f32_dpp v98, v146, v146 row_ror:8 row_mask:0xf bank_mask:0xc
    v_add_f32_dpp v99, v147, v147 row_ror:8 row_mask:0xf bank_mask:0xc
    v_add_f32_dpp v100, v148, v148 row_ror:8 row_mask:0xf bank_mask:0xc
    v_add_f32_dpp v101, v149, v149 row_ror:8 row_mask:0xf bank_mask:0xc
    global_load_lds_dwordx4 v77, s[74:75] offset:3072
    v_add_f32_dpp v102, v150, v150 row_ror:8 row_mask:0xf bank_mask:0xc
    v_add_f32_dpp v103, v151, v151 row_ror:8 row_mask:0xf bank_mask:0xc
    v_add_f32_dpp v104, v152, v152 row_ror:8 row_mask:0xf bank_mask:0xc
    v_add_f32_dpp v105, v153, v153 row_ror:8 row_mask:0xf bank_mask:0xc
    s_add_u32 m0, s89, 12288
    s_nop 0
    global_load_lds_dwordx4 v78, s[74:75] offset:0
    v_add_f32_dpp v106, v154, v154 row_ror:8 row_mask:0xf bank_mask:0xc
    v_add_f32_dpp v107, v155, v155 row_ror:8 row_mask:0xf bank_mask:0xc
    v_add_f32_dpp v108, v156, v156 row_ror:8 row_mask:0xf bank_mask:0xc
    v_add_f32_dpp v109, v157, v157 row_ror:8 row_mask:0xf bank_mask:0xc
    global_load_lds_dwordx4 v79, s[74:75] offset:1024
    v_add_f32_dpp v110, v158, v158 row_ror:8 row_mask:0xf bank_mask:0xc
    v_add_f32_dpp v111, v159, v159 row_ror:8 row_mask:0xf bank_mask:0xc
    v_add_f32_dpp v112, v160, v160 row_ror:8 row_mask:0xf bank_mask:0xc
    v_add_f32_dpp v113, v161, v161 row_ror:8 row_mask:0xf bank_mask:0xc
    v_add_f32_dpp v130, v98, v98 row_half_mirror row_mask:0xf bank_mask:0x5
    global_load_lds_dwordx4 v80, s[74:75] offset:2048
    v_add_f32_dpp v131, v99, v99 row_half_mirror row_mask:0xf bank_mask:0x5
    v_add_f32_dpp v132, v100, v100 row_half_mirror row_mask:0xf bank_mask:0x5
    v_add_f32_dpp v133, v101, v101 row_half_mirror row_mask:0xf bank_mask:0x5
    v_add_f32_dpp v134, v102, v102 row_half_mirror row_mask:0xf bank_mask:0x5
    global_load_lds_dwordx4 v81, s[74:75] offset:3072
    v_add_f32_dpp v135, v103, v103 row_half_mirror row_mask:0xf bank_mask:0x5
    v_add_f32_dpp v136, v104, v104 row_half_mirror row_mask:0xf bank_mask:0x5
    v_add_f32_dpp v137, v105, v105 row_half_mirror row_mask:0xf bank_mask:0x5
    v_add_f32_dpp v130, v106, v106 row_half_mirror row_mask:0xf bank_mask:0xa
    v_add_f32_dpp v131, v107, v107 row_half_mirror row_mask:0xf bank_mask:0xa
    v_add_f32_dpp v132, v108, v108 row_half_mirror row_mask:0xf bank_mask:0xa
    v_add_f32_dpp v133, v109, v109 row_half_mirror row_mask:0xf bank_mask:0xa
    v_add_f32_dpp v134, v110, v110 row_half_mirror row_mask:0xf bank_mask:0xa
    v_add_f32_dpp v135, v111, v111 row_half_mirror row_mask:0xf bank_mask:0xa
    v_add_f32_dpp v136, v112, v112 row_half_mirror row_mask:0xf bank_mask:0xa
    v_add_f32_dpp v137, v113, v113 row_half_mirror row_mask:0xf bank_mask:0xa
    v_add_f32_dpp v130, v130, v130 quad_perm:[1,0,3,2] row_mask:0xf bank_mask:0xf
    v_add_f32_dpp v131, v131, v131 quad_perm:[1,0,3,2] row_mask:0xf bank_mask:0xf
    v_add_f32_dpp v132, v132, v132 quad_perm:[1,0,3,2] row_mask:0xf bank_mask:0xf
    v_add_f32_dpp v133, v133, v133 quad_perm:[1,0,3,2] row_mask:0xf bank_mask:0xf
    v_add_f32_dpp v134, v134, v134 quad_perm:[1,0,3,2] row_mask:0xf bank_mask:0xf
    v_add_f32_dpp v135, v135, v135 quad_perm:[1,0,3,2] row_mask:0xf bank_mask:0xf
    v_add_f32_dpp v136, v136, v136 quad_perm:[1,0,3,2] row_mask:0xf bank_mask:0xf
    v_add_f32_dpp v137, v137, v137 quad_perm:[1,0,3,2] row_mask:0xf bank_mask:0xf
    v_add_f32_dpp v130, v130, v130 quad_perm:[2,3,0,1] row_mask:0xf bank_mask:0xf
    v_add_f32_dpp v131, v131, v131 quad_perm:[2,3,0,1] row_mask:0xf bank_mask:0xf
    v_add_f32_dpp v132, v132, v132 quad_perm:[2,3,0,1] row_mask:0xf bank_mask:0xf
    v_add_f32_dpp v133, v133, v133 quad_perm:[2,3,0,1] row_mask:0xf bank_mask:0xf
    v_add_f32_dpp v134, v134, v134 quad_perm:[2,3,0,1] row_mask:0xf bank_mask:0xf
    v_add_f32_dpp v135, v135, v135 quad_perm:[2,3,0,1] row_mask:0xf bank_mask:0xf
    v_add_f32_dpp v136, v136, v136 quad_perm:[2,3,0,1] row_mask:0xf bank_mask:0xf
    v_add_f32_dpp v137, v137, v137 quad_perm:[2,3,0,1] row_mask:0xf bank_mask:0xf
    v_lshrrev_b32 v28, 2, v2
    v_lshl_add_u32 v28, v28, 7, v171
    ds_write_b128 v28, v[130:133]
    ds_write_b128 v28, v[134:137] offset:16
    s_waitcnt lgkmcnt(0)
    s_barrier
    v_lshlrev_b32 v28, 2, v1
    v_add_u32 v28, 150784, v28
    ds_read2st64_b32 v[90:91], v28 offset0:0 offset1:1
    ds_read2st64_b32 v[92:93], v28 offset0:2 offset1:3
    ds_read2st64_b32 v[94:95], v28 offset0:4 offset1:5
    ds_read2st64_b32 v[96:97], v28 offset0:6 offset1:7
    s_lshl_b32 s4, s40, 12
    s_add_u32 s4, s4, 12451840
    v_add_u32 v174, s4, v30
    s_lshl_b32 s4, s41, 9
    v_add_u32 v28, s4, v174
    v_subrev_u32 v170, 2048, v170
    v_subrev_u32 v171, 2048, v171
    s_waitcnt lgkmcnt(2)
    v_pk_add_f32 v[90:91], v[90:91], v[92:93] op_sel:[0,0] op_sel_hi:[1,1]
    s_waitcnt lgkmcnt(0)
    v_pk_add_f32 v[94:95], v[94:95], v[96:97] op_sel:[0,0] op_sel_hi:[1,1]
    v_pk_add_f32 v[90:91], v[90:91], v[94:95] op_sel:[0,0] op_sel_hi:[1,1]
    v_min_u32 v90, -2, v90
    v_min_u32 v91, -2, v91
    s_lshl_b32 s4, s3, 4
    s_lshl_b64 exec, 0xffff, s4
    global_store_dwordx2 v28, v[90:91], s[38:39] sc1
    s_mov_b64 exec, -1
    ds_read_b128 v[48:51], v4 offset:0
    ds_read_b128 v[52:55], v4 offset:1040
    ds_read_b128 v[56:59], v4 offset:2080
    ds_read_b128 v[60:63], v4 offset:3120
    ds_read_b128 v[64:67], v4 offset:4160
    s_waitcnt lgkmcnt(3)
    s_waitcnt vmcnt(56)
    v_mfma_f32_16x16x32_bf16 v[210:213], a[0:3], v[48:51], 0
    ds_read_b128 v[68:71], v4 offset:5200
    s_waitcnt vmcnt(55)
    v_mfma_f32_16x16x32_bf16 v[226:229], a[4:7], v[48:51], 0
    v_mfma_f32_16x16x32_bf16 v[214:217], a[0:3], v[52:55], 0
    ds_read_b128 v[48:51], v4 offset:6240
    s_waitcnt vmcnt(9)
    ds_read_b128 a[160:163], v82 offset:0
    v_mfma_f32_16x16x32_bf16 v[230:233], a[4:7], v[52:55], 0
    v_min_u32 v175, 26, v1
    s_waitcnt lgkmcnt(4)
    v_mfma_f32_16x16x32_bf16 v[218:221], a[0:3], v[56:59], 0
    ds_read_b128 v[52:55], v4 offset:7280
    v_lshlrev_b32 v175, 7, v175
    v_mfma_f32_16x16x32_bf16 v[234:237], a[4:7], v[56:59], 0
    ds_read_b128 a[164:167], v84 offset:0
    v_mfma_f32_16x16x32_bf16 v[222:225], a[0:3], v[60:63], 0
    ds_read_b128 v[56:59], v4 offset:8320
    v_add_u32 v175, 98304, v175
    v_mfma_f32_16x16x32_bf16 v[238:241], a[4:7], v[60:63], 0
    ds_read_b128 a[168:171], v86 offset:0
    s_waitcnt lgkmcnt(6)
    v_mfma_f32_16x16x32_bf16 v[210:213], a[8:11], v[64:67], v[210:213]
    ds_read_b128 v[60:63], v4 offset:9360
    ds_read_b128 a[172:175], v88 offset:0
    v_mfma_f32_16x16x32_bf16 v[226:229], a[12:15], v[64:67], v[226:229]
    global_load_dword v250, v175, s[38:39] sc1
    v_mfma_f32_16x16x32_bf16 v[214:217], a[8:11], v[68:71], v[214:217]
    ds_read_b128 v[64:67], v4 offset:10400
    ds_read_b128 a[176:179], v83 offset:0
    s_mul_i32 s7, s41, 320
    v_mfma_f32_16x16x32_bf16 v[230:233], a[12:15], v[68:71], v[230:233]
    ds_read_b128 a[180:183], v85 offset:0
    s_waitcnt lgkmcnt(8)
    v_mfma_f32_16x16x32_bf16 v[218:221], a[8:11], v[48:51], v[218:221]
    ds_read_b128 v[68:71], v4 offset:11440
    s_add_u32 s7, s7, 12800
    v_mfma_f32_16x16x32_bf16 v[234:237], a[12:15], v[48:51], v[234:237]
    ds_read_b128 a[184:187], v87 offset:0
    v_mfma_f32_16x16x32_bf16 v[222:225], a[8:11], v[52:55], v[222:225]
    ds_read_b128 v[48:51], v4 offset:12480
    v_min_u32 v175, 304, v4
    v_mfma_f32_16x16x32_bf16 v[238:241], a[12:15], v[52:55], v[238:241]
    ds_read_b128 a[188:191], v89 offset:0
    s_waitcnt lgkmcnt(8)
    v_mfma_f32_16x16x32_bf16 v[210:213], a[16:19], v[56:59], v[210:213]
    ds_read_b128 v[52:55], v4 offset:13520
    s_waitcnt lgkmcnt(1)
    s_add_u32 m0, s89, 0
    v_mfma_f32_16x16x32_bf16 v[226:229], a[20:23], v[56:59], v[226:229]
    v_add_u32 v175, s7, v175
    v_mfma_f32_16x16x32_bf16 v[214:217], a[16:19], v[60:63], v[214:217]
    ds_read_b128 v[56:59], v4 offset:14560
    global_load_dwordx4 v[242:245], v175, s[38:39] sc1
    v_mfma_f32_16x16x32_bf16 v[230:233], a[20:23], v[60:63], v[230:233]
    global_load_lds_dwordx4 v74, s[76:77] offset:0
    v_mfma_f32_16x16x32_bf16 v[218:221], a[16:19], v[64:67], v[218:221]
    ds_read_b128 v[60:63], v4 offset:15600
    v_add_u32 v175, 15360, v175
    v_mfma_f32_16x16x32_bf16 v[234:237], a[20:23], v[64:67], v[234:237]
    global_load_lds_dwordx4 v75, s[76:77] offset:1024
    v_mfma_f32_16x16x32_bf16 v[222:225], a[16:19], v[68:71], v[222:225]
    ds_read_b128 v[64:67], v4 offset:16640
    global_load_lds_dwordx4 v76, s[76:77] offset:2048
    v_mfma_f32_16x16x32_bf16 v[238:241], a[20:23], v[68:71], v[238:241]
    global_load_dwordx4 v[246:249], v175, s[38:39] sc1
    s_waitcnt lgkmcnt(3)
    v_mfma_f32_16x16x32_bf16 v[210:213], a[24:27], v[48:51], v[210:213]
    ds_read_b128 v[68:71], v4 offset:17680
    global_load_lds_dwordx4 v77, s[76:77] offset:3072
    v_mfma_f32_16x16x32_bf16 v[226:229], a[28:31], v[48:51], v[226:229]
    ds_read_b128 v[36:39], v46 offset:0
    v_mfma_f32_16x16x32_bf16 v[214:217], a[24:27], v[52:55], v[214:217]
    ds_read_b128 v[48:51], v4 offset:18720
    s_add_u32 m0, s89, 4096
    ds_read_b128 v[40:43], v46 offset:4160
    v_mfma_f32_16x16x32_bf16 v[230:233], a[28:31], v[52:55], v[230:233]
    global_load_lds_dwordx4 v78, s[76:77] offset:0
    s_waitcnt lgkmcnt(5)
    v_mfma_f32_16x16x32_bf16 v[218:221], a[24:27], v[56:59], v[218:221]
    ds_read_b128 v[52:55], v4 offset:19760
    ds_read_b64 v[44:45], v47 offset:8320
    v_mfma_f32_16x16x32_bf16 v[234:237], a[28:31], v[56:59], v[234:237]
    global_load_lds_dwordx4 v79, s[76:77] offset:1024
    v_mfma_f32_16x16x32_bf16 v[222:225], a[24:27], v[60:63], v[222:225]
    ds_read_b128 v[56:59], v4 offset:20800
    global_load_lds_dwordx4 v80, s[76:77] offset:2048
    v_mfma_f32_16x16x32_bf16 v[238:241], a[28:31], v[60:63], v[238:241]
    s_waitcnt vmcnt(8)
    v_max3_u32 v28, v242, v243, v244
    s_waitcnt lgkmcnt(6)
    v_mfma_f32_16x16x32_bf16 v[210:213], a[32:35], v[64:67], v[210:213]
    ds_read_b128 v[60:63], v4 offset:21840
    global_load_lds_dwordx4 v81, s[76:77] offset:3072
    v_mfma_f32_16x16x32_bf16 v[226:229], a[36:39], v[64:67], v[226:229]
    s_waitcnt vmcnt(5)
    v_max3_u32 v28, v245, v246, v28
    v_mfma_f32_16x16x32_bf16 v[214:217], a[32:35], v[68:71], v[214:217]
    ds_read_b128 v[64:67], v4 offset:22880
    ds_read_b128 a[0:3], v82 offset:8192
    v_mfma_f32_16x16x32_bf16 v[230:233], a[36:39], v[68:71], v[230:233]
    v_max3_u32 v28, v247, v248, v28
    s_waitcnt lgkmcnt(5)
    v_mfma_f32_16x16x32_bf16 v[218:221], a[32:35], v[48:51], v[218:221]
    ds_read_b128 v[68:71], v4 offset:23920
    v_max3_u32 v28, v249, v250, v28
    v_mfma_f32_16x16x32_bf16 v[234:237], a[36:39], v[48:51], v[234:237]
    ds_read_b128 a[4:7], v84 offset:8192
    v_mfma_f32_16x16x32_bf16 v[222:225], a[32:35], v[52:55], v[222:225]
    ds_read_b128 v[48:51], v4 offset:24960
    ds_read_b128 a[8:11], v86 offset:8192
    v_mfma_f32_16x16x32_bf16 v[238:241], a[36:39], v[52:55], v[238:241]
    v_cmp_eq_u32 vcc, -1, v28
    s_waitcnt lgkmcnt(6)
    v_mfma_f32_16x16x32_bf16 v[210:213], a[40:43], v[56:59], v[210:213]
    ds_read_b128 v[52:55], v4 offset:26000
    ds_read_b128 a[12:15], v88 offset:8192
    v_mfma_f32_16x16x32_bf16 v[226:229], a[44:47], v[56:59], v[226:229]
    s_cbranch_vccnz Lgb_r
Lgb_ok:
    v_mfma_f32_16x16x32_bf16 v[214:217], a[40:43], v[60:63], v[214:217]
    ds_read_b128 v[56:59], v4 offset:27040
    ds_read_b128 a[16:19], v83 offset:8192
    v_mfma_f32_16x16x32_bf16 v[230:233], a[44:47], v[60:63], v[230:233]
    ds_read_b128 a[20:23], v85 offset:8192
    v_add_f32 v242, v242, v246
    s_waitcnt lgkmcnt(8)
    v_mfma_f32_16x16x32_bf16 v[218:221], a[40:43], v[64:67], v[218:221]
    ds_read_b128 v[60:63], v4 offset:28080
    v_mfma_f32_16x16x32_bf16 v[234:237], a[44:47], v[64:67], v[234:237]
    ds_read_b128 a[24:27], v87 offset:8192
    v_add_f32 v243, v243, v247
    v_mfma_f32_16x16x32_bf16 v[222:225], a[40:43], v[68:71], v[222:225]
    ds_read_b128 v[64:67], v4 offset:29120
    ds_read_b128 a[28:31], v89 offset:8192
    v_mfma_f32_16x16x32_bf16 v[238:241], a[44:47], v[68:71], v[238:241]
    v_add_f32 v244, v244, v248
    s_waitcnt lgkmcnt(8)
    v_mfma_f32_16x16x32_bf16 v[210:213], a[48:51], v[48:51], v[210:213]
    ds_read_b128 v[68:71], v4 offset:30160
    s_waitcnt lgkmcnt(1)
    s_add_u32 m0, s89, 8192
    v_mfma_f32_16x16x32_bf16 v[226:229], a[52:55], v[48:51], v[226:229]
    v_add_f32 v245, v245, v249
    v_mfma_f32_16x16x32_bf16 v[214:217], a[48:51], v[52:55], v[214:217]
    ds_read_b128 v[48:51], v4 offset:31200
    v_mfma_f32_16x16x32_bf16 v[230:233], a[52:55], v[52:55], v[230:233]
    global_load_lds_dwordx4 v74, s[78:79] offset:0
    v_cvt_pk_bf16_f32 v242, v242, v242
    v_mfma_f32_16x16x32_bf16 v[218:221], a[48:51], v[56:59], v[218:221]
    ds_read_b128 v[52:55], v4 offset:32240
    v_mfma_f32_16x16x32_bf16 v[234:237], a[52:55], v[56:59], v[234:237]
    global_load_lds_dwordx4 v75, s[78:79] offset:1024
    v_lshlrev_b32 v242, 16, v242
    v_mfma_f32_16x16x32_bf16 v[222:225], a[48:51], v[60:63], v[222:225]
    ds_read_b128 v[56:59], v4 offset:33280
    global_load_lds_dwordx4 v76, s[78:79] offset:2048
    v_mfma_f32_16x16x32_bf16 v[238:241], a[52:55], v[60:63], v[238:241]
    v_cvt_pk_bf16_f32 v243, v243, v243
    s_waitcnt lgkmcnt(3)
    v_mfma_f32_16x16x32_bf16 v[210:213], a[56:59], v[64:67], v[210:213]
    ds_read_b128 v[60:63], v4 offset:34320
    global_load_lds_dwordx4 v77, s[78:79] offset:3072
    v_mfma_f32_16x16x32_bf16 v[226:229], a[60:63], v[64:67], v[226:229]
    v_lshlrev_b32 v243, 16, v243
    v_mfma_f32_16x16x32_bf16 v[214:217], a[56:59], v[68:71], v[214:217]
    ds_read_b128 v[64:67], v4 offset:35360
    s_add_u32 m0, s89, 12288
    v_mfma_f32_16x16x32_bf16 v[230:233], a[60:63], v[68:71], v[230:233]
    global_load_lds_dwordx4 v78, s[78:79] offset:0
    v_cvt_pk_bf16_f32 v244, v244, v244
    s_waitcnt lgkmcnt(3)
    v_mfma_f32_16x16x32_bf16 v[218:221], a[56:59], v[48:51], v[218:221]
    ds_read_b128 v[68:71], v4 offset:36400
    v_mfma_f32_16x16x32_bf16 v[234:237], a[60:63], v[48:51], v[234:237]
    global_load_lds_dwordx4 v79, s[78:79] offset:1024
    v_lshlrev_b32 v244, 16, v244
    v_mfma_f32_16x16x32_bf16 v[222:225], a[56:59], v[52:55], v[222:225]
    ds_read_b128 v[48:51], v4 offset:37440
    global_load_lds_dwordx4 v80, s[78:79] offset:2048
    v_mfma_f32_16x16x32_bf16 v[238:241], a[60:63], v[52:55], v[238:241]
    v_cvt_pk_bf16_f32 v245, v245, v245
    s_waitcnt lgkmcnt(3)
    v_mfma_f32_16x16x32_bf16 v[210:213], a[64:67], v[56:59], v[210:213]
    ds_read_b128 v[52:55], v4 offset:38480
    global_load_lds_dwordx4 v81, s[78:79] offset:3072
    v_mfma_f32_16x16x32_bf16 v[226:229], a[68:71], v[56:59], v[226:229]
    v_lshlrev_b32 v245, 16, v245
    v_mfma_f32_16x16x32_bf16 v[214:217], a[64:67], v[60:63], v[214:217]
    ds_read_b128 v[56:59], v4 offset:39520
    s_waitcnt vmcnt(8)
    ds_read_b128 a[32:35], v82 offset:0
    v_mfma_f32_16x16x32_bf16 v[230:233], a[68:71], v[60:63], v[230:233]
    v_min_u32 v175, 304, v4
    s_waitcnt lgkmcnt(4)
    v_mfma_f32_16x16x32_bf16 v[218:221], a[64:67], v[64:67], v[218:221]
    ds_read_b128 v[60:63], v4 offset:40560
    v_mfma_f32_16x16x32_bf16 v[234:237], a[68:71], v[64:67], v[234:237]
    ds_read_b128 a[36:39], v84 offset:0
    v_add_u32 v175, 162816, v175
    v_mfma_f32_16x16x32_bf16 v[222:225], a[64:67], v[68:71], v[222:225]
    ds_read_b128 v[64:67], v173 offset:0
    ds_read_b128 a[40:43], v86 offset:0
    v_mfma_f32_16x16x32_bf16 v[238:241], a[68:71], v[68:71], v[238:241]
    s_waitcnt lgkmcnt(6)
    v_mfma_f32_16x16x32_bf16 v[210:213], a[72:75], v[48:51], v[210:213]
    ds_read_b128 v[68:71], v173 offset:1040
    ds_read_b128 a[44:47], v88 offset:0
    v_mfma_f32_16x16x32_bf16 v[226:229], a[76:79], v[48:51], v[226:229]
    ds_write_b128 v175, v[242:245]
    v_mfma_f32_16x16x32_bf16 v[214:217], a[72:75], v[52:55], v[214:217]
    ds_read_b128 v[48:51], v173 offset:2080
    ds_read_b128 a[48:51], v83 offset:0
    v_mfma_f32_16x16x32_bf16 v[230:233], a[76:79], v[52:55], v[230:233]
    ds_read_b128 a[52:55], v85 offset:0
    s_waitcnt lgkmcnt(9)
    v_mfma_f32_16x16x32_bf16 v[218:221], a[72:75], v[56:59], v[218:221]
    ds_read_b128 v[52:55], v173 offset:3120
    v_mfma_f32_16x16x32_bf16 v[234:237], a[76:79], v[56:59], v[234:237]
    ds_read_b128 a[56:59], v87 offset:0
    v_mfma_f32_16x16x32_bf16 v[222:225], a[72:75], v[60:63], v[222:225]
    ds_read_b128 v[56:59], v173 offset:4160
    global_load_dwordx2 v[130:131], v174, s[38:39] offset:0 sc1
    v_mfma_f32_16x16x32_bf16 v[238:241], a[76:79], v[60:63], v[238:241]
    global_load_dwordx2 v[132:133], v174, s[38:39] offset:512 sc1
    ds_read_b128 a[60:63], v89 offset:0
    s_waitcnt lgkmcnt(9)
    v_mfma_f32_16x16x32_bf16 v[210:213], a[80:83], v[64:67], v[210:213]
    ds_read_b128 v[60:63], v173 offset:5200
    global_load_dwordx2 v[134:135], v174, s[38:39] offset:1024 sc1
    v_mfma_f32_16x16x32_bf16 v[226:229], a[84:87], v[64:67], v[226:229]
    global_load_dwordx2 v[136:137], v174, s[38:39] offset:1536 sc1
    s_waitcnt lgkmcnt(1)
    s_add_u32 m0, s89, 0
    v_mfma_f32_16x16x32_bf16 v[214:217], a[80:83], v[68:71], v[214:217]
    ds_read_b128 v[64:67], v173 offset:6240
    global_load_dwordx2 v[138:139], v174, s[38:39] offset:2048 sc1
    v_mfma_f32_16x16x32_bf16 v[230:233], a[84:87], v[68:71], v[230:233]
    global_load_dwordx2 v[140:141], v174, s[38:39] offset:2560 sc1
    global_load_dwordx2 v[142:143], v174, s[38:39] offset:3072 sc1
    v_mfma_f32_16x16x32_bf16 v[218:221], a[80:83], v[48:51], v[218:221]
    ds_read_b128 v[68:71], v173 offset:7280
    global_load_lds_dwordx4 v74, s[80:81] offset:0
    v_mfma_f32_16x16x32_bf16 v[234:237], a[84:87], v[48:51], v[234:237]
    global_load_dwordx2 v[144:145], v174, s[38:39] offset:3584 sc1
    s_bfe_u32 s6, s2, 0x30003
    global_load_lds_dwordx4 v75, s[80:81] offset:1024
    v_mfma_f32_16x16x32_bf16 v[222:225], a[80:83], v[52:55], v[222:225]
    ds_read_b128 v[48:51], v173 offset:8320
    v_mul_u32_u24 v254, 8, v0
    v_mfma_f32_16x16x32_bf16 v[238:241], a[84:87], v[52:55], v[238:241]
    v_add_lshl_u32 v254, v254, s6, 7
    global_load_lds_dwordx4 v76, s[80:81] offset:2048
    s_waitcnt lgkmcnt(3)
    v_mfma_f32_16x16x32_bf16 v[210:213], a[88:91], v[56:59], v[210:213]
    ds_read_b128 v[52:55], v173 offset:9360
    v_min_u32 v254, (Lend-Lmid-4), v254
    v_mfma_f32_16x16x32_bf16 v[226:229], a[92:95], v[56:59], v[226:229]
    v_add_u32 v254, (Lmid-adaLN_cond__ssm_conv_h3__mixer_gmlp__prompt_kernel), v254
    global_load_lds_dwordx4 v77, s[80:81] offset:3072
    v_mfma_f32_16x16x32_bf16 v[214:217], a[88:91], v[60:63], v[214:217]
    ds_read_b128 v[56:59], v173 offset:10400
    global_load_dword v254, v254, s[0:1]
    s_add_u32 m0, s89, 4096
    v_mfma_f32_16x16x32_bf16 v[230:233], a[92:95], v[60:63], v[230:233]
    global_load_lds_dwordx4 v78, s[80:81] offset:0
    s_waitcnt lgkmcnt(3)
    v_mfma_f32_16x16x32_bf16 v[218:221], a[88:91], v[64:67], v[218:221]
    ds_read_b128 v[60:63], v173 offset:11440
    v_mfma_f32_16x16x32_bf16 v[234:237], a[92:95], v[64:67], v[234:237]
    global_load_lds_dwordx4 v79, s[80:81] offset:1024
    v_mfma_f32_16x16x32_bf16 v[222:225], a[88:91], v[68:71], v[222:225]
    ds_read_b128 v[64:67], v173 offset:12480
    global_load_lds_dwordx4 v80, s[80:81] offset:2048
    v_mfma_f32_16x16x32_bf16 v[238:241], a[92:95], v[68:71], v[238:241]
    s_waitcnt lgkmcnt(3)
    v_mfma_f32_16x16x32_bf16 v[210:213], a[96:99], v[48:51], v[210:213]
    ds_read_b128 v[68:71], v173 offset:13520
    global_load_lds_dwordx4 v81, s[80:81] offset:3072
    v_mfma_f32_16x16x32_bf16 v[226:229], a[100:103], v[48:51], v[226:229]
    v_mfma_f32_16x16x32_bf16 v[214:217], a[96:99], v[52:55], v[214:217]
    ds_read_b128 v[48:51], v173 offset:14560
    s_waitcnt vmcnt(17)
    ds_read_b128 a[64:67], v82 offset:8192
    v_mfma_f32_16x16x32_bf16 v[230:233], a[100:103], v[52:55], v[230:233]
    s_waitcnt lgkmcnt(4)
    v_mfma_f32_16x16x32_bf16 v[218:221], a[96:99], v[56:59], v[218:221]
    ds_read_b128 v[52:55], v173 offset:15600
    v_mfma_f32_16x16x32_bf16 v[234:237], a[100:103], v[56:59], v[234:237]
    ds_read_b128 a[68:71], v84 offset:8192
    v_mfma_f32_16x16x32_bf16 v[222:225], a[96:99], v[60:63], v[222:225]
    ds_read_b128 v[56:59], v173 offset:16640
    ds_read_b128 a[72:75], v86 offset:8192
    v_mfma_f32_16x16x32_bf16 v[238:241], a[100:103], v[60:63], v[238:241]
    s_waitcnt lgkmcnt(6)
    v_mfma_f32_16x16x32_bf16 v[210:213], a[104:107], v[64:67], v[210:213]
    ds_read_b128 v[60:63], v173 offset:17680
    ds_read_b128 a[76:79], v88 offset:8192
    v_mfma_f32_16x16x32_bf16 v[226:229], a[108:111], v[64:67], v[226:229]
    v_mfma_f32_16x16x32_bf16 v[214:217], a[104:107], v[68:71], v[214:217]
    ds_read_b128 v[64:67], v173 offset:18720
    ds_read_b128 a[80:83], v83 offset:8192
    v_mfma_f32_16x16x32_bf16 v[230:233], a[108:111], v[68:71], v[230:233]
    ds_read_b128 a[84:87], v85 offset:8192
    s_waitcnt lgkmcnt(8)
    s_waitcnt vmcnt(15)
    v_max_u32 v28, v131, v133
    s_waitcnt vmcnt(13)
    v_max3_u32 v28, v135, v137, v28
    s_waitcnt vmcnt(11)
    v_max3_u32 v28, v139, v141, v28
    s_waitcnt vmcnt(8)
    v_max3_u32 v28, v143, v145, v28
    v_cmp_eq_u32 vcc, -1, v28
    s_nop 0
    s_cbranch_vccnz Ls3_r
Ls3_ok:
    v_pk_add_f32 v[130:131], v[130:131], v[132:133] op_sel:[0,0] op_sel_hi:[1,1]
    v_pk_add_f32 v[134:135], v[134:135], v[136:137] op_sel:[0,0] op_sel_hi:[1,1]
    v_pk_add_f32 v[138:139], v[138:139], v[140:141] op_sel:[0,0] op_sel_hi:[1,1]
    v_pk_add_f32 v[142:143], v[142:143], v[144:145] op_sel:[0,0] op_sel_hi:[1,1]
    v_pk_add_f32 v[130:131], v[130:131], v[134:135] op_sel:[0,0] op_sel_hi:[1,1]
    v_pk_add_f32 v[138:139], v[138:139], v[142:143] op_sel:[0,0] op_sel_hi:[1,1]
    v_pk_add_f32 v[130:131], v[130:131], v[138:139] op_sel:[0,0] op_sel_hi:[1,1]
    v_mul_f32 v130, 0x3a97b426, v130
    v_mul_f32 v131, 0x3a97b426, v131
    v_fma_f32 v131, -v130, v130, v131
    v_max_f32 v131, 0, v131
    v_add_f32 v131, 0x3727c5ac, v131
    v_rsq_f32 v132, v131
    s_nop 0
    v_mul_f32_e64 v131, -v130, v132
    v_mov_b32 v130, v132
    ds_write2st64_b32 v170, v130, v131 offset0:0 offset1:1
    ds_read_b128 v[98:101], v171 offset:0
    ds_read_b128 v[102:105], v171 offset:16
    ds_read_b128 v[106:109], v171 offset:128
    ds_read_b128 v[110:113], v171 offset:144
    ds_read_b128 v[114:117], v171 offset:256
    ds_read_b128 v[118:121], v171 offset:272
    ds_read_b128 v[122:125], v171 offset:384
    ds_read_b128 v[126:129], v171 offset:400
    s_lshl_b32 s4, s41, 6
    s_lshl_b32 s5, s40, 1
    s_add_u32 s4, s4, s5
    s_mul_i32 s4, s4, 7168
    s_lshl_b32 s5, s3, 11
    s_add_u32 s4, s4, s5
    s_add_u32 s4, s4, 12582912
    v_add_u32 v28, s4, v4
    v_add_u32 v29, 7168, v28
    s_waitcnt lgkmcnt(3)
    v_pk_fma_f32 v[178:179], v[178:179], v[98:99], v[114:115] op_sel:[0,0,0] op_sel_hi:[1,1,1]
    v_pk_fma_f32 v[180:181], v[180:181], v[100:101], v[116:117] op_sel:[0,0,0] op_sel_hi:[1,1,1]
    s_waitcnt lgkmcnt(2)
    v_pk_fma_f32 v[182:183], v[182:183], v[102:103], v[118:119] op_sel:[0,0,0] op_sel_hi:[1,1,1]
    v_pk_fma_f32 v[184:185], v[184:185], v[104:105], v[120:121] op_sel:[0,0,0] op_sel_hi:[1,1,1]
    v_cvt_pk_bf16_f32 v130, v178, v179
    v_cvt_pk_bf16_f32 v131, v180, v181
    v_cvt_pk_bf16_f32 v132, v182, v183
    v_cvt_pk_bf16_f32 v133, v184, v185
    v_or_b32 v133, 1, v133
    global_store_dwordx4 v28, v[130:133], s[38:39] offset:0 sc1
    s_waitcnt lgkmcnt(1)
    v_pk_fma_f32 v[186:187], v[186:187], v[106:107], v[122:123] op_sel:[0,0,0] op_sel_hi:[1,1,1]
    v_pk_fma_f32 v[188:189], v[188:189], v[108:109], v[124:125] op_sel:[0,0,0] op_sel_hi:[1,1,1]
    s_waitcnt lgkmcnt(0)
    v_pk_fma_f32 v[190:191], v[190:191], v[110:111], v[126:127] op_sel:[0,0,0] op_sel_hi:[1,1,1]
    v_pk_fma_f32 v[192:193], v[192:193], v[112:113], v[128:129] op_sel:[0,0,0] op_sel_hi:[1,1,1]
    v_cvt_pk_bf16_f32 v134, v186, v187
    v_cvt_pk_bf16_f32 v135, v188, v189
    v_cvt_pk_bf16_f32 v136, v190, v191
    v_cvt_pk_bf16_f32 v137, v192, v193
    v_or_b32 v137, 1, v137
    global_store_dwordx4 v29, v[134:137], s[38:39] offset:0 sc1
    v_pk_fma_f32 v[194:195], v[194:195], v[98:99], v[114:115] op_sel:[0,0,0] op_sel_hi:[1,1,1]
    v_pk_fma_f32 v[196:197], v[196:197], v[100:101], v[116:117] op_sel:[0,0,0] op_sel_hi:[1,1,1]
    v_pk_fma_f32 v[198:199], v[198:199], v[102:103], v[118:119] op_sel:[0,0,0] op_sel_hi:[1,1,1]
    v_pk_fma_f32 v[200:201], v[200:201], v[104:105], v[120:121] op_sel:[0,0,0] op_sel_hi:[1,1,1]
    v_cvt_pk_bf16_f32 v138, v194, v195
    v_cvt_pk_bf16_f32 v139, v196, v197
    v_cvt_pk_bf16_f32 v140, v198, v199
    v_cvt_pk_bf16_f32 v141, v200, v201
    v_or_b32 v141, 1, v141
    s_cmp_eq_u32 s3, 3
    s_cbranch_scc1 Lzs_0
    global_store_dwordx4 v28, v[138:141], s[38:39] offset:1024 sc1
Lzs_0:
    v_pk_fma_f32 v[202:203], v[202:203], v[106:107], v[122:123] op_sel:[0,0,0] op_sel_hi:[1,1,1]
    v_pk_fma_f32 v[204:205], v[204:205], v[108:109], v[124:125] op_sel:[0,0,0] op_sel_hi:[1,1,1]
    v_pk_fma_f32 v[206:207], v[206:207], v[110:111], v[126:127] op_sel:[0,0,0] op_sel_hi:[1,1,1]
    v_pk_fma_f32 v[208:209], v[208:209], v[112:113], v[128:129] op_sel:[0,0,0] op_sel_hi:[1,1,1]
    v_cvt_pk_bf16_f32 v142, v202, v203
    v_cvt_pk_bf16_f32 v143, v204, v205
    v_cvt_pk_bf16_f32 v144, v206, v207
    v_cvt_pk_bf16_f32 v145, v208, v209
    v_or_b32 v145, 1, v145
    s_cmp_eq_u32 s3, 3
    s_cbranch_scc1 Lzs_1
    global_store_dwordx4 v29, v[142:145], s[38:39] offset:1024 sc1
Lzs_1:
    v_mfma_f32_16x16x32_bf16 v[218:221], a[104:107], v[48:51], v[218:221]
    ds_read_b128 v[68:71], v173 offset:19760
    v_mfma_f32_16x16x32_bf16 v[234:237], a[108:111], v[48:51], v[234:237]
    ds_read_b128 a[88:91], v87 offset:8192
    s_mul_i32 s91, s41, 458752
    v_mfma_f32_16x16x32_bf16 v[222:225], a[104:107], v[52:55], v[222:225]
    ds_read_b128 v[48:51], v173 offset:20800
    ds_read_b128 a[92:95], v89 offset:8192
    s_add_u32 s91, s91, 12582912
    v_mfma_f32_16x16x32_bf16 v[238:241], a[108:111], v[52:55], v[238:241]
    v_mfma_f32_16x16x32_bf16 v[210:213], a[112:115], v[56:59], v[210:213]
    ds_read_b128 v[52:55], v173 offset:21840
    s_waitcnt lgkmcnt(1)
    s_add_u32 m0, s89, 8192
    v_mfma_f32_16x16x32_bf16 v[226:229], a[116:119], v[56:59], v[226:229]
    s_mul_i32 s6, s44, 14336
    v_mfma_f32_16x16x32_bf16 v[214:217], a[112:115], v[60:63], v[214:217]
    ds_read_b128 v[56:59], v173 offset:22880
    s_add_u32 s6, s6, s91
    v_mfma_f32_16x16x32_bf16 v[230:233], a[116:119], v[60:63], v[230:233]
    global_load_lds_dwordx4 v74, s[82:83] offset:0
    v_mfma_f32_16x16x32_bf16 v[218:221], a[112:115], v[64:67], v[218:221]
    ds_read_b128 v[60:63], v173 offset:23920
    s_add_u32 s52, s38, s6
    s_addc_u32 s53, s39, 0
    v_mfma_f32_16x16x32_bf16 v[234:237], a[116:119], v[64:67], v[234:237]
    global_load_lds_dwordx4 v75, s[82:83] offset:1024
    v_mfma_f32_16x16x32_bf16 v[222:225], a[112:115], v[68:71], v[222:225]
    ds_read_b128 v[64:67], v173 offset:24960
    global_load_lds_dwordx4 v76, s[82:83] offset:2048
    v_mfma_f32_16x16x32_bf16 v[238:241], a[116:119], v[68:71], v[238:241]
    s_waitcnt lgkmcnt(3)
    v_mfma_f32_16x16x32_bf16 v[210:213], a[120:123], v[48:51], v[210:213]
    ds_read_b128 v[68:71], v173 offset:26000
    global_load_lds_dwordx4 v77, s[82:83] offset:3072
    v_mfma_f32_16x16x32_bf16 v[226:229], a[124:127], v[48:51], v[226:229]
    s_add_u32 s54, s52, 14336
    s_addc_u32 s55, s53, 0
    v_mfma_f32_16x16x32_bf16 v[214:217], a[120:123], v[52:55], v[214:217]
    ds_read_b128 v[48:51], v173 offset:27040
    s_add_u32 m0, s89, 12288
    v_mfma_f32_16x16x32_bf16 v[230:233], a[124:127], v[52:55], v[230:233]
    global_load_lds_dwordx4 v78, s[82:83] offset:0
    s_waitcnt lgkmcnt(3)
    v_mfma_f32_16x16x32_bf16 v[218:221], a[120:123], v[56:59], v[218:221]
    ds_read_b128 v[52:55], v173 offset:28080
    s_mul_i32 s6, s46, 14336
    v_mfma_f32_16x16x32_bf16 v[234:237], a[124:127], v[56:59], v[234:237]
    global_load_lds_dwordx4 v79, s[82:83] offset:1024
    v_mfma_f32_16x16x32_bf16 v[222:225], a[120:123], v[60:63], v[222:225]
    ds_read_b128 v[56:59], v173 offset:29120
    s_add_u32 s6, s6, s91
    global_load_lds_dwordx4 v80, s[82:83] offset:2048
    v_mfma_f32_16x16x32_bf16 v[238:241], a[124:127], v[60:63], v[238:241]
    s_waitcnt lgkmcnt(3)
    v_mfma_f32_16x16x32_bf16 v[210:213], a[128:131], v[64:67], v[210:213]
    ds_read_b128 v[60:63], v173 offset:30160
    global_load_lds_dwordx4 v81, s[82:83] offset:3072
    v_mfma_f32_16x16x32_bf16 v[226:229], a[132:135], v[64:67], v[226:229]
    s_add_u32 s56, s38, s6
    s_addc_u32 s57, s39, 0
    v_mfma_f32_16x16x32_bf16 v[214:217], a[128:131], v[68:71], v[214:217]
    ds_read_b128 v[64:67], v173 offset:31200
    s_waitcnt vmcnt(10)
    ds_read_b128 a[96:99], v82 offset:0
    v_mfma_f32_16x16x32_bf16 v[230:233], a[132:135], v[68:71], v[230:233]
    s_waitcnt lgkmcnt(4)
    v_mfma_f32_16x16x32_bf16 v[218:221], a[128:131], v[48:51], v[218:221]
    ds_read_b128 v[68:71], v173 offset:32240
    s_add_u32 s58, s56, 14336
    s_addc_u32 s59, s57, 0
    v_mfma_f32_16x16x32_bf16 v[234:237], a[132:135], v[48:51], v[234:237]
    v_mfma_f32_16x16x32_bf16 v[222:225], a[128:131], v[52:55], v[222:225]
    ds_read_b128 v[48:51], v173 offset:33280
    ds_read_b128 a[100:103], v84 offset:0
    v_mfma_f32_16x16x32_bf16 v[238:241], a[132:135], v[52:55], v[238:241]
    s_mul_i32 s6, s48, 14336
    s_waitcnt lgkmcnt(5)
    v_mfma_f32_16x16x32_bf16 v[210:213], a[136:139], v[56:59], v[210:213]
    ds_read_b128 v[52:55], v173 offset:34320
    v_mfma_f32_16x16x32_bf16 v[226:229], a[140:143], v[56:59], v[226:229]
    ds_read_b128 a[104:107], v86 offset:0
    s_add_u32 s6, s6, s91
    v_mfma_f32_16x16x32_bf16 v[214:217], a[136:139], v[60:63], v[214:217]
    ds_read_b128 v[56:59], v173 offset:35360
    v_mfma_f32_16x16x32_bf16 v[230:233], a[140:143], v[60:63], v[230:233]
    ds_read_b128 a[108:111], v88 offset:0
    s_waitcnt lgkmcnt(6)
    v_mfma_f32_16x16x32_bf16 v[218:221], a[136:139], v[64:67], v[218:221]
    ds_read_b128 v[60:63], v173 offset:36400
    s_add_u32 s60, s38, s6
    s_addc_u32 s61, s39, 0
    v_mfma_f32_16x16x32_bf16 v[234:237], a[140:143], v[64:67], v[234:237]
    ds_read_b128 a[112:115], v83 offset:0
    v_mfma_f32_16x16x32_bf16 v[222:225], a[136:139], v[68:71], v[222:225]
    ds_read_b128 v[64:67], v173 offset:37440
    v_mfma_f32_16x16x32_bf16 v[238:241], a[140:143], v[68:71], v[238:241]
    s_add_u32 s62, s60, 14336
    s_addc_u32 s63, s61, 0
    s_waitcnt lgkmcnt(6)
    v_mfma_f32_16x16x32_bf16 v[210:213], a[144:147], v[48:51], v[210:213]
    ds_read_b128 v[68:71], v173 offset:38480
    ds_read_b128 a[116:119], v85 offset:0
    v_mfma_f32_16x16x32_bf16 v[226:229], a[148:151], v[48:51], v[226:229]
    v_mfma_f32_16x16x32_bf16 v[214:217], a[144:147], v[52:55], v[214:217]
    ds_read_b128 v[48:51], v173 offset:39520
    ds_read_b128 a[120:123], v87 offset:0
    v_mfma_f32_16x16x32_bf16 v[230:233], a[148:151], v[52:55], v[230:233]
    s_mul_i32 s6, s50, 14336
    s_waitcnt lgkmcnt(6)
    v_mfma_f32_16x16x32_bf16 v[218:221], a[144:147], v[56:59], v[218:221]
    ds_read_b128 v[52:55], v173 offset:40560
    ds_read_b128 a[124:127], v89 offset:0
    v_mfma_f32_16x16x32_bf16 v[234:237], a[148:151], v[56:59], v[234:237]
    s_add_u32 s6, s6, s91
    v_mfma_f32_16x16x32_bf16 v[222:225], a[144:147], v[60:63], v[222:225]
    v_mfma_f32_16x16x32_bf16 v[238:241], a[148:151], v[60:63], v[238:241]
    s_add_u32 s64, s38, s6
    s_addc_u32 s65, s39, 0
    s_waitcnt lgkmcnt(5)
    v_mfma_f32_16x16x32_bf16 v[210:213], a[152:155], v[64:67], v[210:213]
    v_mfma_f32_16x16x32_bf16 v[226:229], a[156:159], v[64:67], v[226:229]
    v_mfma_f32_16x16x32_bf16 v[214:217], a[152:155], v[68:71], v[214:217]
    v_mfma_f32_16x16x32_bf16 v[230:233], a[156:159], v[68:71], v[230:233]
    s_add_u32 s66, s64, 14336
    s_addc_u32 s67, s65, 0
    s_waitcnt lgkmcnt(1)
    v_mfma_f32_16x16x32_bf16 v[218:221], a[152:155], v[48:51], v[218:221]
    v_mfma_f32_16x16x32_bf16 v[234:237], a[156:159], v[48:51], v[234:237]
    v_mfma_f32_16x16x32_bf16 v[222:225], a[152:155], v[52:55], v[222:225]
    v_mfma_f32_16x16x32_bf16 v[238:241], a[156:159], v[52:55], v[238:241]
    s_waitcnt vmcnt(0)
    ds_read_b128 a[128:131], v82 offset:8192
    ds_read_b128 a[132:135], v84 offset:8192
    ds_read_b128 a[136:139], v86 offset:8192
    ds_read_b128 a[140:143], v88 offset:8192
    ds_read_b128 a[144:147], v83 offset:8192
    ds_read_b128 a[148:151], v85 offset:8192
    ds_read_b128 a[152:155], v87 offset:8192
    ds_read_b128 a[156:159], v89 offset:8192
    s_waitcnt lgkmcnt(0)
    s_barrier
    s_mul_i32 s5, s41, 138240
    s_add_u32 s5, s5, 10485760
    s_add_u32 s92, s38, s5
    s_addc_u32 s93, s39, 0
    s_mul_i32 s95, s3, 34816
    s_min_u32 s95, s95, 103424
    s_add_u32 s92, s92, s95
    s_addc_u32 s93, s93, 0
    s_add_u32 m0, s95, 0
    s_nop 0
    global_load_lds_dwordx4 v4, s[92:93] offset:0 sc1
    s_lshl_b32 s4, s3, 10
    s_add_u32 s4, s4, 138240
    v_add_u32 v170, s4, v30
    s_lshl_b32 s4, s3, 12
    s_add_u32 s4, s4, 138240
    v_add_u32 v171, s4, v30
    v_add_u32 v30, 3072, v4
    v_add_u32 v31, 10240, v4
    v_min_u32 v29, 27, v1
    v_lshlrev_b32 v29, 10, v29
    v_pk_fma_f32 v[178:179], v[162:163], v[12:13], v[16:17] op_sel:[1,0,0] op_sel_hi:[1,1,1]
    v_pk_fma_f32 v[180:181], v[162:163], v[14:15], v[18:19] op_sel:[1,0,0] op_sel_hi:[1,1,1]
    v_pk_fma_f32 v[182:183], v[164:165], v[12:13], v[16:17] op_sel:[1,0,0] op_sel_hi:[1,1,1]
    v_pk_fma_f32 v[184:185], v[164:165], v[14:15], v[18:19] op_sel:[1,0,0] op_sel_hi:[1,1,1]
    v_pk_fma_f32 v[186:187], v[166:167], v[12:13], v[16:17] op_sel:[1,0,0] op_sel_hi:[1,1,1]
    v_pk_fma_f32 v[188:189], v[166:167], v[14:15], v[18:19] op_sel:[1,0,0] op_sel_hi:[1,1,1]
    v_pk_fma_f32 v[190:191], v[168:169], v[12:13], v[16:17] op_sel:[1,0,0] op_sel_hi:[1,1,1]
    v_pk_fma_f32 v[192:193], v[168:169], v[14:15], v[18:19] op_sel:[1,0,0] op_sel_hi:[1,1,1]
    v_pk_fma_f32 v[210:211], v[162:163], v[210:211], v[178:179] op_sel:[0,0,0] op_sel_hi:[0,1,1]
    global_load_lds_dwordx4 v4, s[92:93] offset:1024 sc1
    v_pk_fma_f32 v[212:213], v[162:163], v[212:213], v[180:181] op_sel:[0,0,0] op_sel_hi:[0,1,1]
    v_pk_fma_f32 v[214:215], v[164:165], v[214:215], v[182:183] op_sel:[0,0,0] op_sel_hi:[0,1,1]
    v_pk_fma_f32 v[216:217], v[164:165], v[216:217], v[184:185] op_sel:[0,0,0] op_sel_hi:[0,1,1]
    v_pk_fma_f32 v[218:219], v[166:167], v[218:219], v[186:187] op_sel:[0,0,0] op_sel_hi:[0,1,1]
    v_pk_fma_f32 v[220:221], v[166:167], v[220:221], v[188:189] op_sel:[0,0,0] op_sel_hi:[0,1,1]
    v_pk_fma_f32 v[222:223], v[168:169], v[222:223], v[190:191] op_sel:[0,0,0] op_sel_hi:[0,1,1]
    v_pk_fma_f32 v[224:225], v[168:169], v[224:225], v[192:193] op_sel:[0,0,0] op_sel_hi:[0,1,1]
    v_pk_fma_f32 v[178:179], v[162:163], v[20:21], v[24:25] op_sel:[1,0,0] op_sel_hi:[1,1,1]
    v_pk_fma_f32 v[180:181], v[162:163], v[22:23], v[26:27] op_sel:[1,0,0] op_sel_hi:[1,1,1]
    v_pk_fma_f32 v[182:183], v[164:165], v[20:21], v[24:25] op_sel:[1,0,0] op_sel_hi:[1,1,1]
    v_pk_fma_f32 v[184:185], v[164:165], v[22:23], v[26:27] op_sel:[1,0,0] op_sel_hi:[1,1,1]
    v_pk_fma_f32 v[186:187], v[166:167], v[20:21], v[24:25] op_sel:[1,0,0] op_sel_hi:[1,1,1]
    v_pk_fma_f32 v[188:189], v[166:167], v[22:23], v[26:27] op_sel:[1,0,0] op_sel_hi:[1,1,1]
    v_pk_fma_f32 v[190:191], v[168:169], v[20:21], v[24:25] op_sel:[1,0,0] op_sel_hi:[1,1,1]
    v_pk_fma_f32 v[192:193], v[168:169], v[22:23], v[26:27] op_sel:[1,0,0] op_sel_hi:[1,1,1]
    v_pk_fma_f32 v[226:227], v[162:163], v[226:227], v[178:179] op_sel:[0,0,0] op_sel_hi:[0,1,1]
    v_pk_fma_f32 v[228:229], v[162:163], v[228:229], v[180:181] op_sel:[0,0,0] op_sel_hi:[0,1,1]
    v_pk_fma_f32 v[230:231], v[164:165], v[230:231], v[182:183] op_sel:[0,0,0] op_sel_hi:[0,1,1]
    v_pk_fma_f32 v[232:233], v[164:165], v[232:233], v[184:185] op_sel:[0,0,0] op_sel_hi:[0,1,1]
    global_load_lds_dwordx4 v4, s[92:93] offset:2048 sc1
    v_pk_fma_f32 v[234:235], v[166:167], v[234:235], v[186:187] op_sel:[0,0,0] op_sel_hi:[0,1,1]
    v_pk_fma_f32 v[236:237], v[166:167], v[236:237], v[188:189] op_sel:[0,0,0] op_sel_hi:[0,1,1]
    v_pk_fma_f32 v[238:239], v[168:169], v[238:239], v[190:191] op_sel:[0,0,0] op_sel_hi:[0,1,1]
    v_pk_fma_f32 v[240:241], v[168:169], v[240:241], v[192:193] op_sel:[0,0,0] op_sel_hi:[0,1,1]
    v_pk_mul_f32 v[178:179], v[210:211], v[210:211] op_sel:[0,0] op_sel_hi:[1,1]
    v_pk_mul_f32 v[180:181], v[212:213], v[212:213] op_sel:[0,0] op_sel_hi:[1,1]
    v_pk_mul_f32 v[182:183], v[214:215], v[214:215] op_sel:[0,0] op_sel_hi:[1,1]
    v_pk_mul_f32 v[184:185], v[216:217], v[216:217] op_sel:[0,0] op_sel_hi:[1,1]
    v_pk_mul_f32 v[186:187], v[218:219], v[218:219] op_sel:[0,0] op_sel_hi:[1,1]
    v_pk_mul_f32 v[188:189], v[220:221], v[220:221] op_sel:[0,0] op_sel_hi:[1,1]
    v_pk_mul_f32 v[190:191], v[222:223], v[222:223] op_sel:[0,0] op_sel_hi:[1,1]
    v_pk_mul_f32 v[192:193], v[224:225], v[224:225] op_sel:[0,0] op_sel_hi:[1,1]
    v_pk_mul_f32 v[194:195], v[226:227], v[226:227] op_sel:[0,0] op_sel_hi:[1,1]
    v_pk_mul_f32 v[196:197], v[228:229], v[228:229] op_sel:[0,0] op_sel_hi:[1,1]
    v_pk_mul_f32 v[198:199], v[230:231], v[230:231] op_sel:[0,0] op_sel_hi:[1,1]
    v_pk_mul_f32 v[200:201], v[232:233], v[232:233] op_sel:[0,0] op_sel_hi:[1,1]
    v_pk_mul_f32 v[202:203], v[234:235], v[234:235] op_sel:[0,0] op_sel_hi:[1,1]
    v_pk_mul_f32 v[204:205], v[236:237], v[236:237] op_sel:[0,0] op_sel_hi:[1,1]
    v_pk_mul_f32 v[206:207], v[238:239], v[238:239] op_sel:[0,0] op_sel_hi:[1,1]
    global_load_lds_dwordx4 v4, s[92:93] offset:3072 sc1
    v_pk_mul_f32 v[208:209], v[240:241], v[240:241] op_sel:[0,0] op_sel_hi:[1,1]
    v_pk_fma_f32 v[178:179], v[178:179], s[84:85], s[84:85] op_sel:[0,1,0] op_sel_hi:[1,1,0]
    v_pk_fma_f32 v[180:181], v[180:181], s[84:85], s[84:85] op_sel:[0,1,0] op_sel_hi:[1,1,0]
    v_pk_fma_f32 v[182:183], v[182:183], s[84:85], s[84:85] op_sel:[0,1,0] op_sel_hi:[1,1,0]
    v_pk_fma_f32 v[184:185], v[184:185], s[84:85], s[84:85] op_sel:[0,1,0] op_sel_hi:[1,1,0]
    v_pk_fma_f32 v[186:187], v[186:187], s[84:85], s[84:85] op_sel:[0,1,0] op_sel_hi:[1,1,0]
    v_pk_fma_f32 v[188:189], v[188:189], s[84:85], s[84:85] op_sel:[0,1,0] op_sel_hi:[1,1,0]
    v_pk_fma_f32 v[190:191], v[190:191], s[84:85], s[84:85] op_sel:[0,1,0] op_sel_hi:[1,1,0]
    v_pk_fma_f32 v[192:193], v[192:193], s[84:85], s[84:85] op_sel:[0,1,0] op_sel_hi:[1,1,0]
    v_pk_fma_f32 v[194:195], v[194:195], s[84:85], s[84:85] op_sel:[0,1,0] op_sel_hi:[1,1,0]
    v_pk_fma_f32 v[196:197], v[196:197], s[84:85], s[84:85] op_sel:[0,1,0] op_sel_hi:[1,1,0]
    v_pk_fma_f32 v[198:199], v[198:199], s[84:85], s[84:85] op_sel:[0,1,0] op_sel_hi:[1,1,0]
    v_pk_fma_f32 v[200:201], v[200:201], s[84:85], s[84:85] op_sel:[0,1,0] op_sel_hi:[1,1,0]
    v_pk_fma_f32 v[202:203], v[202:203], s[84:85], s[84:85] op_sel:[0,1,0] op_sel_hi:[1,1,0]
    v_pk_fma_f32 v[204:205], v[204:205], s[84:85], s[84:85] op_sel:[0,1,0] op_sel_hi:[1,1,0]
    v_pk_fma_f32 v[206:207], v[206:207], s[84:85], s[84:85] op_sel:[0,1,0] op_sel_hi:[1,1,0]
    v_pk_fma_f32 v[208:209], v[208:209], s[84:85], s[84:85] op_sel:[0,1,0] op_sel_hi:[1,1,0]
    v_pk_mul_f32 v[178:179], v[178:179], v[210:211] op_sel:[0,0] op_sel_hi:[1,1]
    v_pk_mul_f32 v[180:181], v[180:181], v[212:213] op_sel:[0,0] op_sel_hi:[1,1]
    s_add_u32 m0, s95, 4096
    s_add_u32 s92, s92, 4096
    s_addc_u32 s93, s93, 0
    global_load_lds_dwordx4 v4, s[92:93] offset:0 sc1
    v_pk_mul_f32 v[182:183], v[182:183], v[214:215] op_sel:[0,0] op_sel_hi:[1,1]
    v_pk_mul_f32 v[184:185], v[184:185], v[216:217] op_sel:[0,0] op_sel_hi:[1,1]
    v_pk_mul_f32 v[186:187], v[186:187], v[218:219] op_sel:[0,0] op_sel_hi:[1,1]
    v_pk_mul_f32 v[188:189], v[188:189], v[220:221] op_sel:[0,0] op_sel_hi:[1,1]
    v_pk_mul_f32 v[190:191], v[190:191], v[222:223] op_sel:[0,0] op_sel_hi:[1,1]
    v_pk_mul_f32 v[192:193], v[192:193], v[224:225] op_sel:[0,0] op_sel_hi:[1,1]
    v_pk_mul_f32 v[194:195], v[194:195], v[226:227] op_sel:[0,0] op_sel_hi:[1,1]
    v_pk_mul_f32 v[196:197], v[196:197], v[228:229] op_sel:[0,0] op_sel_hi:[1,1]
    v_pk_mul_f32 v[198:199], v[198:199], v[230:231] op_sel:[0,0] op_sel_hi:[1,1]
    v_pk_mul_f32 v[200:201], v[200:201], v[232:233] op_sel:[0,0] op_sel_hi:[1,1]
    v_pk_mul_f32 v[202:203], v[202:203], v[234:235] op_sel:[0,0] op_sel_hi:[1,1]
    v_pk_mul_f32 v[204:205], v[204:205], v[236:237] op_sel:[0,0] op_sel_hi:[1,1]
    v_pk_mul_f32 v[206:207], v[206:207], v[238:239] op_sel:[0,0] op_sel_hi:[1,1]
    v_pk_mul_f32 v[208:209], v[208:209], v[240:241] op_sel:[0,0] op_sel_hi:[1,1]
    v_exp_f32 v178, v178
    v_exp_f32 v179, v179
    v_exp_f32 v180, v180
    v_exp_f32 v181, v181
    v_exp_f32 v182, v182
    global_load_lds_dwordx4 v4, s[92:93] offset:1024 sc1
    v_exp_f32 v183, v183
    v_exp_f32 v184, v184
    v_exp_f32 v185, v185
    v_exp_f32 v186, v186
    v_exp_f32 v187, v187
    v_exp_f32 v188, v188
    v_exp_f32 v189, v189
    v_exp_f32 v190, v190
    v_exp_f32 v191, v191
    v_exp_f32 v192, v192
    v_exp_f32 v193, v193
    v_exp_f32 v194, v194
    global_load_dwordx4 v[62:65], v30, s[56:57] offset:-3072 sc1
    v_exp_f32 v195, v195
    v_exp_f32 v196, v196
    v_exp_f32 v197, v197
    v_exp_f32 v198, v198
    v_exp_f32 v199, v199
    v_exp_f32 v200, v200
    global_load_dwordx4 v[66:69], v30, s[56:57] offset:-2048 sc1
    v_exp_f32 v201, v201
    v_exp_f32 v202, v202
    v_exp_f32 v203, v203
    v_exp_f32 v204, v204
    v_exp_f32 v205, v205
    v_exp_f32 v206, v206
    global_load_dwordx4 v[70:73], v30, s[56:57] offset:-1024 sc1
    v_exp_f32 v207, v207
    v_exp_f32 v208, v208
    v_exp_f32 v209, v209
    v_pk_add_f32 v[178:179], v[178:179], 1.0 op_sel:[0,0] op_sel_hi:[1,0]
    v_pk_add_f32 v[180:181], v[180:181], 1.0 op_sel:[0,0] op_sel_hi:[1,0]
    v_pk_add_f32 v[182:183], v[182:183], 1.0 op_sel:[0,0] op_sel_hi:[1,0]
    v_pk_add_f32 v[184:185], v[184:185], 1.0 op_sel:[0,0] op_sel_hi:[1,0]
    global_load_dwordx4 v[74:77], v30, s[56:57] offset:0 sc1
    v_pk_add_f32 v[186:187], v[186:187], 1.0 op_sel:[0,0] op_sel_hi:[1,0]
    v_pk_add_f32 v[188:189], v[188:189], 1.0 op_sel:[0,0] op_sel_hi:[1,0]
    v_pk_add_f32 v[190:191], v[190:191], 1.0 op_sel:[0,0] op_sel_hi:[1,0]
    v_pk_add_f32 v[192:193], v[192:193], 1.0 op_sel:[0,0] op_sel_hi:[1,0]
    v_pk_add_f32 v[194:195], v[194:195], 1.0 op_sel:[0,0] op_sel_hi:[1,0]
    v_pk_add_f32 v[196:197], v[196:197], 1.0 op_sel:[0,0] op_sel_hi:[1,0]
    global_load_dwordx4 v[78:81], v30, s[56:57] offset:1024 sc1
    v_pk_add_f32 v[198:199], v[198:199], 1.0 op_sel:[0,0] op_sel_hi:[1,0]
    v_pk_add_f32 v[200:201], v[200:201], 1.0 op_sel:[0,0] op_sel_hi:[1,0]
    v_pk_add_f32 v[202:203], v[202:203], 1.0 op_sel:[0,0] op_sel_hi:[1,0]
    v_pk_add_f32 v[204:205], v[204:205], 1.0 op_sel:[0,0] op_sel_hi:[1,0]
    v_pk_add_f32 v[206:207], v[206:207], 1.0 op_sel:[0,0] op_sel_hi:[1,0]
    v_pk_add_f32 v[208:209], v[208:209], 1.0 op_sel:[0,0] op_sel_hi:[1,0]
    v_rcp_f32 v178, v178
    global_load_dwordx4 v[82:85], v30, s[56:57] offset:2048 sc1
    v_rcp_f32 v179, v179
    v_rcp_f32 v180, v180
    v_rcp_f32 v181, v181
    v_rcp_f32 v182, v182
    v_rcp_f32 v183, v183
    v_rcp_f32 v184, v184
    global_load_dwordx4 v[86:89], v30, s[56:57] offset:3072 sc1
    v_rcp_f32 v185, v185
    v_rcp_f32 v186, v186
    v_rcp_f32 v187, v187
    v_rcp_f32 v188, v188
    v_rcp_f32 v189, v189
    v_rcp_f32 v190, v190
    v_rcp_f32 v191, v191
    global_load_dwordx4 v[90:93], v31, s[56:57] offset:-3072 sc1
    v_rcp_f32 v192, v192
    v_rcp_f32 v193, v193
    v_rcp_f32 v194, v194
    v_rcp_f32 v195, v195
    v_rcp_f32 v196, v196
    v_rcp_f32 v197, v197
    global_load_dwordx4 v[94:97], v31, s[56:57] offset:-2048 sc1
    v_rcp_f32 v198, v198
    v_rcp_f32 v199, v199
    v_rcp_f32 v200, v200
    v_rcp_f32 v201, v201
    v_rcp_f32 v202, v202
    v_rcp_f32 v203, v203
    global_load_dwordx4 v[98:101], v31, s[56:57] offset:-1024 sc1
    v_rcp_f32 v204, v204
    v_rcp_f32 v205, v205
    v_rcp_f32 v206, v206
    v_rcp_f32 v207, v207
    v_rcp_f32 v208, v208
    v_rcp_f32 v209, v209
    v_pk_mul_f32 v[210:211], v[210:211], v[178:179] op_sel:[0,0] op_sel_hi:[1,1]
    global_load_dwordx4 v[102:105], v31, s[56:57] offset:0 sc1
    v_pk_mul_f32 v[212:213], v[212:213], v[180:181] op_sel:[0,0] op_sel_hi:[1,1]
    v_pk_mul_f32 v[214:215], v[214:215], v[182:183] op_sel:[0,0] op_sel_hi:[1,1]
    v_pk_mul_f32 v[216:217], v[216:217], v[184:185] op_sel:[0,0] op_sel_hi:[1,1]
    v_pk_mul_f32 v[218:219], v[218:219], v[186:187] op_sel:[0,0] op_sel_hi:[1,1]
    v_pk_mul_f32 v[220:221], v[220:221], v[188:189] op_sel:[0,0] op_sel_hi:[1,1]
    v_pk_mul_f32 v[222:223], v[222:223], v[190:191] op_sel:[0,0] op_sel_hi:[1,1]
    global_load_dwordx4 v[106:109], v31, s[56:57] offset:1024 sc1
    v_pk_mul_f32 v[224:225], v[224:225], v[192:193] op_sel:[0,0] op_sel_hi:[1,1]
    v_pk_mul_f32 v[226:227], v[226:227], v[194:195] op_sel:[0,0] op_sel_hi:[1,1]
    v_pk_mul_f32 v[228:229], v[228:229], v[196:197] op_sel:[0,0] op_sel_hi:[1,1]
    v_pk_mul_f32 v[230:231], v[230:231], v[198:199] op_sel:[0,0] op_sel_hi:[1,1]
    v_pk_mul_f32 v[232:233], v[232:233], v[200:201] op_sel:[0,0] op_sel_hi:[1,1]
    v_pk_mul_f32 v[234:235], v[234:235], v[202:203] op_sel:[0,0] op_sel_hi:[1,1]
    v_pk_mul_f32 v[236:237], v[236:237], v[204:205] op_sel:[0,0] op_sel_hi:[1,1]
    global_load_dwordx4 v[110:113], v31, s[56:57] offset:2048 sc1
    v_pk_mul_f32 v[238:239], v[238:239], v[206:207] op_sel:[0,0] op_sel_hi:[1,1]
    v_pk_mul_f32 v[240:241], v[240:241], v[208:209] op_sel:[0,0] op_sel_hi:[1,1]
    v_cvt_pk_bf16_f32 v178, v210, v211
    v_cvt_pk_bf16_f32 v179, v212, v213
    v_cvt_pk_bf16_f32 v180, v214, v215
    v_cvt_pk_bf16_f32 v181, v216, v217
    global_load_dwordx4 v[114:117], v31, s[56:57] offset:3072 sc1
    v_cvt_pk_bf16_f32 v182, v218, v219
    v_cvt_pk_bf16_f32 v183, v220, v221
    v_cvt_pk_bf16_f32 v184, v222, v223
    v_cvt_pk_bf16_f32 v185, v224, v225
    v_cvt_pk_bf16_f32 v186, v226, v227
    v_cvt_pk_bf16_f32 v187, v228, v229
    v_cvt_pk_bf16_f32 v188, v230, v231
    global_load_dwordx4 v[118:121], v30, s[58:59] offset:-3072 sc1
    v_cvt_pk_bf16_f32 v189, v232, v233
    v_cvt_pk_bf16_f32 v190, v234, v235
    v_cvt_pk_bf16_f32 v191, v236, v237
    v_cvt_pk_bf16_f32 v192, v238, v239
    v_cvt_pk_bf16_f32 v193, v240, v241
    ds_write_b64 v170, v[178:179] offset:0
    global_load_dwordx4 v[122:125], v30, s[58:59] offset:-2048 sc1
    ds_write_b64 v170, v[180:181] offset:4096
    ds_write_b64 v170, v[182:183] offset:8192
    ds_write_b64 v170, v[184:185] offset:12288
    ds_write_b64 v170, v[186:187] offset:512
    ds_write_b64 v170, v[188:189] offset:4608
    ds_write_b64 v170, v[190:191] offset:8704
    ds_write_b64 v170, v[192:193] offset:12800
    s_waitcnt lgkmcnt(0)
    s_barrier
    ds_read_b64 v[48:49], v171 offset:0
    ds_read_b64 v[50:51], v171 offset:512
    ds_read_b64 v[52:53], v171 offset:1024
    ds_read_b64 v[54:55], v171 offset:1536
    ds_read_b64 v[56:57], v171 offset:2048
    ds_read_b64 v[58:59], v171 offset:2560
    ds_read_b64 v[60:61], v171 offset:3072
Lmid:
    s_waitcnt vmcnt(14)
    v_and_b32 v28, v65, v69
    s_waitcnt vmcnt(12)
    v_bitop3_b32 v28, v73, v77, v28 bitop3:0x80
    v_and_b32 v28, 1, v28
    v_cmp_ne_u32 vcc, 1, v28
    s_nop 0
    s_cbranch_vccnz Lz0_r
Lz0_ok:
    v_mfma_f32_16x16x32_bf16 v[142:145], v[62:65], a[160:163], v[32:35]
    global_load_dwordx4 v[126:129], v30, s[58:59] offset:-1024 sc1
    v_mfma_f32_16x16x32_bf16 v[146:149], v[62:65], a[164:167], 0
    v_mfma_f32_16x16x32_bf16 v[150:153], v[62:65], a[168:171], 0
    v_mfma_f32_16x16x32_bf16 v[154:157], v[62:65], a[172:175], 0
    v_mfma_f32_16x16x32_bf16 v[158:161], v[66:69], a[160:163], v[32:35]
    global_load_dwordx4 v[130:133], v30, s[58:59] offset:0 sc1
    v_mfma_f32_16x16x32_bf16 v[162:165], v[66:69], a[164:167], 0
    v_mfma_f32_16x16x32_bf16 v[166:169], v[66:69], a[168:171], 0
    v_mfma_f32_16x16x32_bf16 v[170:173], v[66:69], a[172:175], 0
    v_mfma_f32_16x16x32_bf16 v[174:177], v[70:73], a[160:163], v[32:35]
    global_load_dwordx4 v[134:137], v30, s[58:59] offset:1024 sc1
    v_mfma_f32_16x16x32_bf16 v[178:181], v[70:73], a[164:167], 0
    v_mfma_f32_16x16x32_bf16 v[182:185], v[70:73], a[168:171], 0
    s_waitcnt vmcnt(13)
    v_and_b32 v28, v81, v85
    v_mfma_f32_16x16x32_bf16 v[186:189], v[70:73], a[172:175], 0
    s_waitcnt vmcnt(11)
    v_bitop3_b32 v28, v89, v93, v28 bitop3:0x80
    v_mfma_f32_16x16x32_bf16 v[190:193], v[74:77], a[160:163], v[32:35]
    v_and_b32 v28, 1, v28
    global_load_dwordx4 v[138:141], v30, s[58:59] offset:2048 sc1
    v_mfma_f32_16x16x32_bf16 v[194:197], v[74:77], a[164:167], 0
    v_cmp_ne_u32 vcc, 1, v28
    v_mfma_f32_16x16x32_bf16 v[198:201], v[74:77], a[168:171], 0
    v_mfma_f32_16x16x32_bf16 v[202:205], v[74:77], a[172:175], 0
    s_cbranch_vccnz Lz1_r
Lz1_ok:
    v_mfma_f32_16x16x32_bf16 v[206:209], v[78:81], a[160:163], v[32:35]
    global_load_dwordx4 v[62:65], v30, s[58:59] offset:3072 sc1
    s_xor_b32 s4, s3, 1
    s_mul_i32 s4, s4, 3072
    v_mfma_f32_16x16x32_bf16 v[210:213], v[78:81], a[164:167], 0
    s_add_u32 s4, s4, 138240
    v_add_u32 v20, s4, v4
    s_xor_b32 s4, s3, 2
    v_mfma_f32_16x16x32_bf16 v[214:217], v[78:81], a[168:171], 0
    s_mul_i32 s4, s4, 3072
    s_add_u32 s4, s4, 139264
    v_add_u32 v21, s4, v4
    v_mfma_f32_16x16x32_bf16 v[218:221], v[78:81], a[172:175], 0
    s_xor_b32 s4, s3, 3
    s_mul_i32 s4, s4, 3072
    v_mfma_f32_16x16x32_bf16 v[222:225], v[82:85], a[160:163], v[32:35]
    global_load_dwordx4 v[66:69], v31, s[58:59] offset:-3072 sc1
    s_add_u32 s4, s4, 140288
    v_add_u32 v22, s4, v4
    v_mfma_f32_16x16x32_bf16 v[226:229], v[82:85], a[164:167], 0
    s_mul_i32 s4, s3, 3072
    s_add_u32 s4, s4, 138240
    v_add_u32 v23, s4, v4
    v_mfma_f32_16x16x32_bf16 v[230:233], v[82:85], a[168:171], 0
    s_mul_i32 s4, s40, 114688
    s_add_u32 s4, s4, 1052672
    v_mfma_f32_16x16x32_bf16 v[234:237], v[82:85], a[172:175], 0
    s_lshl_b32 s5, s3, 13
    s_add_u32 s5, s5, s4
    v_mfma_f32_16x16x32_bf16 v[238:241], v[86:89], a[160:163], v[32:35]
    global_load_dwordx4 v[70:73], v31, s[58:59] offset:-2048 sc1
    v_add_u32 v6, s5, v4
    v_mfma_f32_16x16x32_bf16 v[242:245], v[86:89], a[164:167], 0
    v_add_u32 v7, 32768, v6
    v_add_u32 v26, 65536, v6
    s_lshl_b32 s5, s3, 12
    v_mfma_f32_16x16x32_bf16 v[246:249], v[86:89], a[168:171], 0
    s_waitcnt vmcnt(13)
    v_and_b32 v28, v97, v101
    s_add_u32 s5, s5, s4
    s_add_u32 s5, s5, 98304
    v_mfma_f32_16x16x32_bf16 v[250:253], v[86:89], a[172:175], 0
    s_waitcnt vmcnt(11)
    v_bitop3_b32 v28, v105, v109, v28 bitop3:0x80
    v_add_u32 v27, s5, v4
    s_lshl_b32 s4, s41, 10
    v_mfma_f32_16x16x32_bf16 v[142:145], v[90:93], a[176:179], v[142:145]
    s_add_u32 s8, s38, s4
    s_addc_u32 s9, s39, 0
    v_and_b32 v28, 1, v28
    v_mfma_f32_16x16x32_bf16 v[146:149], v[90:93], a[180:183], v[146:149]
    global_load_dwordx4 v[74:77], v31, s[58:59] offset:-1024 sc1
    s_lshr_b32 s4, s41, 1
    s_lshl_b32 s4, s4, 10
    s_and_b32 s5, s41, 1
    v_mfma_f32_16x16x32_bf16 v[150:153], v[90:93], a[184:187], v[150:153]
    v_cmp_ne_u32 vcc, 1, v28
    s_lshl_b32 s5, s5, 3
    s_add_u32 s4, s4, s5
    s_add_u32 s10, s38, s4
    s_addc_u32 s11, s39, 0
    v_mfma_f32_16x16x32_bf16 v[154:157], v[90:93], a[188:191], v[154:157]
    s_waitcnt lgkmcnt(0)
    s_barrier
    s_cbranch_vccnz Lz2_r
Lz2_ok:
    v_mfma_f32_16x16x32_bf16 v[158:161], v[94:97], a[176:179], v[158:161]
    global_load_dwordx4 v[78:81], v31, s[58:59] offset:0 sc1
    v_mfma_f32_16x16x32_bf16 v[162:165], v[94:97], a[180:183], v[162:165]
    v_mfma_f32_16x16x32_bf16 v[166:169], v[94:97], a[184:187], v[166:169]
    v_mfma_f32_16x16x32_bf16 v[170:173], v[94:97], a[188:191], v[170:173]
    v_mfma_f32_16x16x32_bf16 v[174:177], v[98:101], a[176:179], v[174:177]
    global_load_dwordx4 v[82:85], v31, s[58:59] offset:1024 sc1
    v_mfma_f32_16x16x32_bf16 v[178:181], v[98:101], a[180:183], v[178:181]
    v_mfma_f32_16x16x32_bf16 v[182:185], v[98:101], a[184:187], v[182:185]
    v_mfma_f32_16x16x32_bf16 v[186:189], v[98:101], a[188:191], v[186:189]
    v_mfma_f32_16x16x32_bf16 v[190:193], v[102:105], a[176:179], v[190:193]
    global_load_dwordx4 v[86:89], v31, s[58:59] offset:2048 sc1
    v_mfma_f32_16x16x32_bf16 v[194:197], v[102:105], a[180:183], v[194:197]
    v_mfma_f32_16x16x32_bf16 v[198:201], v[102:105], a[184:187], v[198:201]
    s_waitcnt vmcnt(13)
    v_and_b32 v28, v113, v117
    v_mfma_f32_16x16x32_bf16 v[202:205], v[102:105], a[188:191], v[202:205]
    s_waitcnt vmcnt(11)
    v_bitop3_b32 v28, v121, v125, v28 bitop3:0x80
    v_mfma_f32_16x16x32_bf16 v[206:209], v[106:109], a[176:179], v[206:209]
    v_and_b32 v28, 1, v28
    global_load_dwordx4 v[90:93], v31, s[58:59] offset:3072 sc1
    v_mfma_f32_16x16x32_bf16 v[210:213], v[106:109], a[180:183], v[210:213]
    v_cmp_ne_u32 vcc, 1, v28
    v_mfma_f32_16x16x32_bf16 v[214:217], v[106:109], a[184:187], v[214:217]
    v_mfma_f32_16x16x32_bf16 v[218:221], v[106:109], a[188:191], v[218:221]
    s_cbranch_vccnz Lz3_r
Lz3_ok:
    v_mfma_f32_16x16x32_bf16 v[222:225], v[110:113], a[176:179], v[222:225]
    global_load_dwordx4 v[94:97], v30, s[60:61] offset:-3072 sc1
    v_mfma_f32_16x16x32_bf16 v[226:229], v[110:113], a[180:183], v[226:229]
    v_mfma_f32_16x16x32_bf16 v[230:233], v[110:113], a[184:187], v[230:233]
    v_mfma_f32_16x16x32_bf16 v[234:237], v[110:113], a[188:191], v[234:237]
    v_mfma_f32_16x16x32_bf16 v[238:241], v[114:117], a[176:179], v[238:241]
    global_load_dwordx4 v[98:101], v31, s[60:61] offset:-3072 sc1
    v_mfma_f32_16x16x32_bf16 v[242:245], v[114:117], a[180:183], v[242:245]
    v_mfma_f32_16x16x32_bf16 v[246:249], v[114:117], a[184:187], v[246:249]
    v_mfma_f32_16x16x32_bf16 v[250:253], v[114:117], a[188:191], v[250:253]
    v_mfma_f32_16x16x32_bf16 v[142:145], v[118:121], a[0:3], v[142:145]
    global_load_dwordx4 v[102:105], v30, s[62:63] offset:-3072 sc1
    v_mfma_f32_16x16x32_bf16 v[146:149], v[118:121], a[4:7], v[146:149]
    v_mfma_f32_16x16x32_bf16 v[150:153], v[118:121], a[8:11], v[150:153]
    s_waitcnt vmcnt(13)
    v_and_b32 v28, v129, v133
    v_mfma_f32_16x16x32_bf16 v[154:157], v[118:121], a[12:15], v[154:157]
    s_waitcnt vmcnt(11)
    v_bitop3_b32 v28, v137, v141, v28 bitop3:0x80
    v_mfma_f32_16x16x32_bf16 v[158:161], v[122:125], a[0:3], v[158:161]
    v_and_b32 v28, 1, v28
    global_load_dwordx4 v[106:109], v31, s[62:63] offset:-3072 sc1
    v_mfma_f32_16x16x32_bf16 v[162:165], v[122:125], a[4:7], v[162:165]
    v_cmp_ne_u32 vcc, 1, v28
    v_mfma_f32_16x16x32_bf16 v[166:169], v[122:125], a[8:11], v[166:169]
    v_mfma_f32_16x16x32_bf16 v[170:173], v[122:125], a[12:15], v[170:173]
    s_cbranch_vccnz Lz4_r
Lz4_ok:
    v_mfma_f32_16x16x32_bf16 v[174:177], v[126:129], a[0:3], v[174:177]
    global_load_dwordx4 v[110:113], v30, s[52:53] offset:-3072 sc1
    v_mfma_f32_16x16x32_bf16 v[178:181], v[126:129], a[4:7], v[178:181]
    v_mfma_f32_16x16x32_bf16 v[182:185], v[126:129], a[8:11], v[182:185]
    v_mfma_f32_16x16x32_bf16 v[186:189], v[126:129], a[12:15], v[186:189]
    v_mfma_f32_16x16x32_bf16 v[190:193], v[130:133], a[0:3], v[190:193]
    global_load_dwordx4 v[114:117], v31, s[52:53] offset:-3072 sc1
    v_mfma_f32_16x16x32_bf16 v[194:197], v[130:133], a[4:7], v[194:197]
    v_mfma_f32_16x16x32_bf16 v[198:201], v[130:133], a[8:11], v[198:201]
    v_mfma_f32_16x16x32_bf16 v[202:205], v[130:133], a[12:15], v[202:205]
    v_mfma_f32_16x16x32_bf16 v[206:209], v[134:137], a[0:3], v[206:209]
    global_load_dwordx4 v[118:121], v30, s[54:55] offset:-3072 sc1
    v_mfma_f32_16x16x32_bf16 v[210:213], v[134:137], a[4:7], v[210:213]
    v_mfma_f32_16x16x32_bf16 v[214:217], v[134:137], a[8:11], v[214:217]
    s_waitcnt vmcnt(13)
    v_and_b32 v28, v65, v69
    v_mfma_f32_16x16x32_bf16 v[218:221], v[134:137], a[12:15], v[218:221]
    s_waitcnt vmcnt(11)
    v_bitop3_b32 v28, v73, v77, v28 bitop3:0x80
    v_mfma_f32_16x16x32_bf16 v[222:225], v[138:141], a[0:3], v[222:225]
    v_and_b32 v28, 1, v28
    global_load_dwordx4 v[122:125], v31, s[54:55] offset:-3072 sc1
    v_mfma_f32_16x16x32_bf16 v[226:229], v[138:141], a[4:7], v[226:229]
    v_cmp_ne_u32 vcc, 1, v28
    v_mfma_f32_16x16x32_bf16 v[230:233], v[138:141], a[8:11], v[230:233]
    v_mfma_f32_16x16x32_bf16 v[234:237], v[138:141], a[12:15], v[234:237]
    s_cbranch_vccnz Lz5_r
Lz5_ok:
    v_mfma_f32_16x16x32_bf16 v[238:241], v[62:65], a[0:3], v[238:241]
    global_load_dwordx4 v[126:129], v30, s[64:65] offset:-3072 sc1
    v_mfma_f32_16x16x32_bf16 v[242:245], v[62:65], a[4:7], v[242:245]
    v_mfma_f32_16x16x32_bf16 v[246:249], v[62:65], a[8:11], v[246:249]
    v_mfma_f32_16x16x32_bf16 v[250:253], v[62:65], a[12:15], v[250:253]
    v_mfma_f32_16x16x32_bf16 v[142:145], v[66:69], a[16:19], v[142:145]
    global_load_dwordx4 v[130:133], v31, s[64:65] offset:-3072 sc1
    v_mfma_f32_16x16x32_bf16 v[146:149], v[66:69], a[20:23], v[146:149]
    v_mfma_f32_16x16x32_bf16 v[150:153], v[66:69], a[24:27], v[150:153]
    v_mfma_f32_16x16x32_bf16 v[154:157], v[66:69], a[28:31], v[154:157]
    v_mfma_f32_16x16x32_bf16 v[158:161], v[70:73], a[16:19], v[158:161]
    global_load_dwordx4 v[134:137], v30, s[66:67] offset:-3072 sc1
    v_mfma_f32_16x16x32_bf16 v[162:165], v[70:73], a[20:23], v[162:165]
    v_mfma_f32_16x16x32_bf16 v[166:169], v[70:73], a[24:27], v[166:169]
    s_waitcnt vmcnt(13)
    v_and_b32 v28, v81, v85
    v_mfma_f32_16x16x32_bf16 v[170:173], v[70:73], a[28:31], v[170:173]
    s_waitcnt vmcnt(11)
    v_bitop3_b32 v28, v89, v93, v28 bitop3:0x80
    v_mfma_f32_16x16x32_bf16 v[174:177], v[74:77], a[16:19], v[174:177]
    v_and_b32 v28, 1, v28
    global_load_dwordx4 v[138:141], v31, s[66:67] offset:-3072 sc1
    v_mfma_f32_16x16x32_bf16 v[178:181], v[74:77], a[20:23], v[178:181]
    v_cmp_ne_u32 vcc, 1, v28
    v_mfma_f32_16x16x32_bf16 v[182:185], v[74:77], a[24:27], v[182:185]
    v_mfma_f32_16x16x32_bf16 v[186:189], v[74:77], a[28:31], v[186:189]
    s_cbranch_vccnz Lz6_r
Lz6_ok:
    v_mfma_f32_16x16x32_bf16 v[190:193], v[78:81], a[16:19], v[190:193]
    global_load_dwordx4 v[62:65], v30, s[60:61] offset:-2048 sc1
    v_mfma_f32_16x16x32_bf16 v[194:197], v[78:81], a[20:23], v[194:197]
    v_mfma_f32_16x16x32_bf16 v[198:201], v[78:81], a[24:27], v[198:201]
    v_mfma_f32_16x16x32_bf16 v[202:205], v[78:81], a[28:31], v[202:205]
    v_mfma_f32_16x16x32_bf16 v[206:209], v[82:85], a[16:19], v[206:209]
    global_load_dwordx4 v[66:69], v31, s[60:61] offset:-2048 sc1
    v_mfma_f32_16x16x32_bf16 v[210:213], v[82:85], a[20:23], v[210:213]
    v_mfma_f32_16x16x32_bf16 v[214:217], v[82:85], a[24:27], v[214:217]
    v_mfma_f32_16x16x32_bf16 v[218:221], v[82:85], a[28:31], v[218:221]
    v_mfma_f32_16x16x32_bf16 v[222:225], v[86:89], a[16:19], v[222:225]
    global_load_dwordx4 v[70:73], v30, s[62:63] offset:-2048 sc1
    v_mfma_f32_16x16x32_bf16 v[226:229], v[86:89], a[20:23], v[226:229]
    v_mfma_f32_16x16x32_bf16 v[230:233], v[86:89], a[24:27], v[230:233]
    s_waitcnt vmcnt(13)
    v_and_b32 v28, v97, v101
    v_mfma_f32_16x16x32_bf16 v[234:237], v[86:89], a[28:31], v[234:237]
    s_waitcnt vmcnt(11)
    v_bitop3_b32 v28, v105, v109, v28 bitop3:0x80
    v_mfma_f32_16x16x32_bf16 v[238:241], v[90:93], a[16:19], v[238:241]
    v_and_b32 v28, 1, v28
    global_load_dwordx4 v[74:77], v31, s[62:63] offset:-2048 sc1
    v_mfma_f32_16x16x32_bf16 v[242:245], v[90:93], a[20:23], v[242:245]
    v_cmp_ne_u32 vcc, 1, v28
    v_mfma_f32_16x16x32_bf16 v[246:249], v[90:93], a[24:27], v[246:249]
    v_mfma_f32_16x16x32_bf16 v[250:253], v[90:93], a[28:31], v[250:253]
    s_cbranch_vccnz Lz7_r
Lz7_ok:
    v_mfma_f32_16x16x32_bf16 v[142:145], v[94:97], a[32:35], v[142:145]
    global_load_dwordx4 v[78:81], v30, s[52:53] offset:-2048 sc1
    v_mfma_f32_16x16x32_bf16 v[146:149], v[94:97], a[36:39], v[146:149]
    v_mfma_f32_16x16x32_bf16 v[150:153], v[94:97], a[40:43], v[150:153]
    v_mfma_f32_16x16x32_bf16 v[154:157], v[94:97], a[44:47], v[154:157]
    v_mfma_f32_16x16x32_bf16 v[142:145], v[98:101], a[48:51], v[142:145]
    global_load_dwordx4 v[82:85], v31, s[52:53] offset:-2048 sc1
    v_mfma_f32_16x16x32_bf16 v[146:149], v[98:101], a[52:55], v[146:149]
    v_mfma_f32_16x16x32_bf16 v[150:153], v[98:101], a[56:59], v[150:153]
    v_mfma_f32_16x16x32_bf16 v[154:157], v[98:101], a[60:63], v[154:157]
    v_mfma_f32_16x16x32_bf16 v[142:145], v[102:105], a[64:67], v[142:145]
    global_load_dwordx4 v[86:89], v30, s[54:55] offset:-2048 sc1
    v_mfma_f32_16x16x32_bf16 v[146:149], v[102:105], a[68:71], v[146:149]
    v_mfma_f32_16x16x32_bf16 v[150:153], v[102:105], a[72:75], v[150:153]
    s_waitcnt vmcnt(13)
    v_and_b32 v28, v113, v117
    v_mfma_f32_16x16x32_bf16 v[154:157], v[102:105], a[76:79], v[154:157]
    s_waitcnt vmcnt(11)
    v_bitop3_b32 v28, v121, v125, v28 bitop3:0x80
    v_mfma_f32_16x16x32_bf16 v[142:145], v[106:109], a[80:83], v[142:145]
    v_and_b32 v28, 1, v28
    global_load_dwordx4 v[90:93], v31, s[54:55] offset:-2048 sc1
    v_mfma_f32_16x16x32_bf16 v[146:149], v[106:109], a[84:87], v[146:149]
    v_cmp_ne_u32 vcc, 1, v28
    v_mfma_f32_16x16x32_bf16 v[150:153], v[106:109], a[88:91], v[150:153]
    v_mfma_f32_16x16x32_bf16 v[154:157], v[106:109], a[92:95], v[154:157]
    s_cbranch_vccnz Lz8_r
Lz8_ok:
    v_mfma_f32_16x16x32_bf16 v[142:145], v[110:113], a[224:227], v[142:145]
    global_load_dwordx4 v[94:97], v30, s[64:65] offset:-2048 sc1
    v_mfma_f32_16x16x32_bf16 v[146:149], v[110:113], a[228:231], v[146:149]
    v_mfma_f32_16x16x32_bf16 v[150:153], v[110:113], a[232:235], v[150:153]
    v_mfma_f32_16x16x32_bf16 v[154:157], v[110:113], a[236:239], v[154:157]
    v_mfma_f32_16x16x32_bf16 v[142:145], v[114:117], a[240:243], v[142:145]
    global_load_dwordx4 v[98:101], v31, s[64:65] offset:-2048 sc1
    v_mfma_f32_16x16x32_bf16 v[146:149], v[114:117], a[244:247], v[146:149]
    v_mfma_f32_16x16x32_bf16 v[150:153], v[114:117], a[248:251], v[150:153]
    v_mfma_f32_16x16x32_bf16 v[154:157], v[114:117], a[252:255], v[154:157]
    v_mfma_f32_16x16x32_bf16 v[142:145], v[118:121], a[192:195], v[142:145]
    global_load_dwordx4 v[102:105], v30, s[66:67] offset:-2048 sc1
    v_mfma_f32_16x16x32_bf16 v[146:149], v[118:121], a[196:199], v[146:149]
    v_mfma_f32_16x16x32_bf16 v[150:153], v[118:121], a[200:203], v[150:153]
    s_waitcnt vmcnt(13)
    v_and_b32 v28, v129, v133
    v_mfma_f32_16x16x32_bf16 v[154:157], v[118:121], a[204:207], v[154:157]
    s_waitcnt vmcnt(11)
    v_bitop3_b32 v28, v137, v141, v28 bitop3:0x80
    v_mfma_f32_16x16x32_bf16 v[142:145], v[122:125], a[208:211], v[142:145]
    v_and_b32 v28, 1, v28
    global_load_dwordx4 v[106:109], v31, s[66:67] offset:-2048 sc1
    v_mfma_f32_16x16x32_bf16 v[146:149], v[122:125], a[212:215], v[146:149]
    v_cmp_ne_u32 vcc, 1, v28
    v_mfma_f32_16x16x32_bf16 v[150:153], v[122:125], a[216:219], v[150:153]
    v_mfma_f32_16x16x32_bf16 v[154:157], v[122:125], a[220:223], v[154:157]
    s_cbranch_vccnz Lz9_r
Lz9_ok:
    v_mfma_f32_16x16x32_bf16 v[142:145], v[126:129], a[96:99], v[142:145]
    global_load_dwordx4 v[110:113], v30, s[60:61] offset:-1024 sc1
    v_mfma_f32_16x16x32_bf16 v[146:149], v[126:129], a[100:103], v[146:149]
    v_mfma_f32_16x16x32_bf16 v[150:153], v[126:129], a[104:107], v[150:153]
    v_mfma_f32_16x16x32_bf16 v[154:157], v[126:129], a[108:111], v[154:157]
    v_mfma_f32_16x16x32_bf16 v[142:145], v[130:133], a[112:115], v[142:145]
    global_load_dwordx4 v[114:117], v31, s[60:61] offset:-1024 sc1
    v_mfma_f32_16x16x32_bf16 v[146:149], v[130:133], a[116:119], v[146:149]
    v_mfma_f32_16x16x32_bf16 v[150:153], v[130:133], a[120:123], v[150:153]
    v_mfma_f32_16x16x32_bf16 v[154:157], v[130:133], a[124:127], v[154:157]
    v_mfma_f32_16x16x32_bf16 v[142:145], v[134:137], a[128:131], v[142:145]
    global_load_dwordx4 v[118:121], v30, s[62:63] offset:-1024 sc1
    v_mfma_f32_16x16x32_bf16 v[146:149], v[134:137], a[132:135], v[146:149]
    v_mfma_f32_16x16x32_bf16 v[150:153], v[134:137], a[136:139], v[150:153]
    s_waitcnt vmcnt(13)
    v_and_b32 v28, v65, v69
    v_mfma_f32_16x16x32_bf16 v[154:157], v[134:137], a[140:143], v[154:157]
    s_waitcnt vmcnt(11)
    v_bitop3_b32 v28, v73, v77, v28 bitop3:0x80
    v_mfma_f32_16x16x32_bf16 v[142:145], v[138:141], a[144:147], v[142:145]
    v_and_b32 v28, 1, v28
    global_load_dwordx4 v[122:125], v31, s[62:63] offset:-1024 sc1
    v_mfma_f32_16x16x32_bf16 v[146:149], v[138:141], a[148:151], v[146:149]
    v_cmp_ne_u32 vcc, 1, v28
    v_mfma_f32_16x16x32_bf16 v[150:153], v[138:141], a[152:155], v[150:153]
    v_mfma_f32_16x16x32_bf16 v[154:157], v[138:141], a[156:159], v[154:157]
    s_cbranch_vccnz Lz10_r
Lz10_ok:
    v_mfma_f32_16x16x32_bf16 v[158:161], v[62:65], a[32:35], v[158:161]
    global_load_dwordx4 v[126:129], v30, s[52:53] offset:-1024 sc1
    v_mfma_f32_16x16x32_bf16 v[162:165], v[62:65], a[36:39], v[162:165]
    v_mfma_f32_16x16x32_bf16 v[166:169], v[62:65], a[40:43], v[166:169]
    v_mfma_f32_16x16x32_bf16 v[170:173], v[62:65], a[44:47], v[170:173]
    ds_write_b128 v20, v[146:149] offset:0
    v_mfma_f32_16x16x32_bf16 v[158:161], v[66:69], a[48:51], v[158:161]
    global_load_dwordx4 v[130:133], v31, s[52:53] offset:-1024 sc1
    v_mfma_f32_16x16x32_bf16 v[162:165], v[66:69], a[52:55], v[162:165]
    v_mfma_f32_16x16x32_bf16 v[166:169], v[66:69], a[56:59], v[166:169]
    ds_write_b128 v21, v[150:153] offset:0
    v_mfma_f32_16x16x32_bf16 v[170:173], v[66:69], a[60:63], v[170:173]
    v_mfma_f32_16x16x32_bf16 v[158:161], v[70:73], a[64:67], v[158:161]
    global_load_dwordx4 v[134:137], v30, s[54:55] offset:-1024 sc1
    v_mfma_f32_16x16x32_bf16 v[162:165], v[70:73], a[68:71], v[162:165]
    ds_write_b128 v22, v[154:157] offset:0
    v_mfma_f32_16x16x32_bf16 v[166:169], v[70:73], a[72:75], v[166:169]
    s_waitcnt vmcnt(13)
    v_and_b32 v28, v81, v85
    v_mfma_f32_16x16x32_bf16 v[170:173], v[70:73], a[76:79], v[170:173]
    s_waitcnt vmcnt(11)
    v_bitop3_b32 v28, v89, v93, v28 bitop3:0x80
    v_mfma_f32_16x16x32_bf16 v[158:161], v[74:77], a[80:83], v[158:161]
    v_and_b32 v28, 1, v28
    global_load_dwordx4 v[138:141], v31, s[54:55] offset:-1024 sc1
    v_mfma_f32_16x16x32_bf16 v[162:165], v[74:77], a[84:87], v[162:165]
    s_waitcnt lgkmcnt(0)
    s_barrier
    v_cmp_ne_u32 vcc, 1, v28
    v_mfma_f32_16x16x32_bf16 v[166:169], v[74:77], a[88:91], v[166:169]
    v_mfma_f32_16x16x32_bf16 v[170:173], v[74:77], a[92:95], v[170:173]
    s_cbranch_vccnz Lz11_r
Lz11_ok:
    v_mfma_f32_16x16x32_bf16 v[158:161], v[78:81], a[224:227], v[158:161]
    global_load_dwordx4 v[62:65], v30, s[64:65] offset:-1024 sc1
    ds_read_b128 v[146:149], v23 offset:0
    v_mfma_f32_16x16x32_bf16 v[162:165], v[78:81], a[228:231], v[162:165]
    ds_read_b128 v[150:153], v23 offset:1024
    v_mfma_f32_16x16x32_bf16 v[166:169], v[78:81], a[232:235], v[166:169]
    ds_read_b128 v[154:157], v23 offset:2048
    v_mfma_f32_16x16x32_bf16 v[170:173], v[78:81], a[236:239], v[170:173]
    v_lshlrev_b32 v12, 16, v48
    v_mfma_f32_16x16x32_bf16 v[158:161], v[82:85], a[240:243], v[158:161]
    global_load_dwordx4 v[66:69], v31, s[64:65] offset:-1024 sc1
    v_and_b32 v13, 0xffff0000, v48
    v_mfma_f32_16x16x32_bf16 v[162:165], v[82:85], a[244:247], v[162:165]
    v_mfma_f32_16x16x32_bf16 v[166:169], v[82:85], a[248:251], v[166:169]
    v_lshlrev_b32 v14, 16, v49
    v_mfma_f32_16x16x32_bf16 v[170:173], v[82:85], a[252:255], v[170:173]
    v_and_b32 v15, 0xffff0000, v49
    v_mfma_f32_16x16x32_bf16 v[158:161], v[86:89], a[192:195], v[158:161]
    global_load_dwordx4 v[70:73], v30, s[66:67] offset:-1024 sc1
    s_waitcnt lgkmcnt(2)
    v_add_f32 v142, v142, v146
    v_mfma_f32_16x16x32_bf16 v[162:165], v[86:89], a[196:199], v[162:165]
    v_add_f32 v143, v143, v147
    v_mfma_f32_16x16x32_bf16 v[166:169], v[86:89], a[200:203], v[166:169]
    s_waitcnt vmcnt(13)
    v_and_b32 v28, v97, v101
    v_mfma_f32_16x16x32_bf16 v[170:173], v[86:89], a[204:207], v[170:173]
    s_waitcnt vmcnt(11)
    v_bitop3_b32 v28, v105, v109, v28 bitop3:0x80
    v_add_f32 v144, v144, v148
    v_mfma_f32_16x16x32_bf16 v[158:161], v[90:93], a[208:211], v[158:161]
    v_and_b32 v28, 1, v28
    global_load_dwordx4 v[74:77], v31, s[66:67] offset:-1024 sc1
    v_mfma_f32_16x16x32_bf16 v[162:165], v[90:93], a[212:215], v[162:165]
    v_add_f32 v145, v145, v149
    v_cmp_ne_u32 vcc, 1, v28
    v_mfma_f32_16x16x32_bf16 v[166:169], v[90:93], a[216:219], v[166:169]
    s_waitcnt lgkmcnt(1)
    v_add_f32 v142, v142, v150
    v_add_f32 v143, v143, v151
    v_mfma_f32_16x16x32_bf16 v[170:173], v[90:93], a[220:223], v[170:173]
    s_cbranch_vccnz Lz12_r
Lz12_ok:
    v_mfma_f32_16x16x32_bf16 v[158:161], v[94:97], a[96:99], v[158:161]
    global_load_dwordx4 v[78:81], v30, s[60:61] offset:0 sc1
    v_add_f32 v144, v144, v152
    v_mfma_f32_16x16x32_bf16 v[162:165], v[94:97], a[100:103], v[162:165]
    v_add_f32 v145, v145, v153
    v_mfma_f32_16x16x32_bf16 v[166:169], v[94:97], a[104:107], v[166:169]
    s_waitcnt lgkmcnt(0)
    v_add_f32 v142, v142, v154
    v_mfma_f32_16x16x32_bf16 v[170:173], v[94:97], a[108:111], v[170:173]
    v_mfma_f32_16x16x32_bf16 v[158:161], v[98:101], a[112:115], v[158:161]
    global_load_dwordx4 v[82:85], v31, s[60:61] offset:0 sc1
    v_add_f32 v143, v143, v155
    v_mfma_f32_16x16x32_bf16 v[162:165], v[98:101], a[116:119], v[162:165]
    v_add_f32 v144, v144, v156
    v_mfma_f32_16x16x32_bf16 v[166:169], v[98:101], a[120:123], v[166:169]
    v_add_f32 v145, v145, v157
    v_mfma_f32_16x16x32_bf16 v[170:173], v[98:101], a[124:127], v[170:173]
    v_mfma_f32_16x16x32_bf16 v[158:161], v[102:105], a[128:131], v[158:161]
    global_load_dwordx4 v[86:89], v30, s[62:63] offset:0 sc1
    v_mul_f32 v142, v142, v12
    v_mfma_f32_16x16x32_bf16 v[162:165], v[102:105], a[132:135], v[162:165]
    v_mul_f32 v143, v143, v13
    v_mfma_f32_16x16x32_bf16 v[166:169], v[102:105], a[136:139], v[166:169]
    s_waitcnt vmcnt(13)
    v_and_b32 v28, v113, v117
    v_mul_f32 v144, v144, v14
    v_mfma_f32_16x16x32_bf16 v[170:173], v[102:105], a[140:143], v[170:173]
    s_waitcnt vmcnt(11)
    v_bitop3_b32 v28, v121, v125, v28 bitop3:0x80
    v_mfma_f32_16x16x32_bf16 v[158:161], v[106:109], a[144:147], v[158:161]
    v_and_b32 v28, 1, v28
    global_load_dwordx4 v[90:93], v31, s[62:63] offset:0 sc1
    v_mfma_f32_16x16x32_bf16 v[162:165], v[106:109], a[148:151], v[162:165]
    v_mul_f32 v145, v145, v15
    v_cmp_ne_u32 vcc, 1, v28
    v_mfma_f32_16x16x32_bf16 v[166:169], v[106:109], a[152:155], v[166:169]
    v_cvt_pk_bf16_f32 v48, v142, v143
    v_cvt_pk_bf16_f32 v49, v144, v145
    v_mfma_f32_16x16x32_bf16 v[170:173], v[106:109], a[156:159], v[170:173]
    s_cbranch_vccnz Lz13_r
Lz13_ok:
    v_mfma_f32_16x16x32_bf16 v[174:177], v[110:113], a[32:35], v[174:177]
    global_load_dwordx4 v[94:97], v30, s[52:53] offset:0 sc1
    v_mfma_f32_16x16x32_bf16 v[178:181], v[110:113], a[36:39], v[178:181]
    v_mfma_f32_16x16x32_bf16 v[182:185], v[110:113], a[40:43], v[182:185]
    v_mfma_f32_16x16x32_bf16 v[186:189], v[110:113], a[44:47], v[186:189]
    ds_write_b128 v20, v[162:165] offset:12288
    v_mfma_f32_16x16x32_bf16 v[174:177], v[114:117], a[48:51], v[174:177]
    global_load_dwordx4 v[98:101], v31, s[52:53] offset:0 sc1
    v_mfma_f32_16x16x32_bf16 v[178:181], v[114:117], a[52:55], v[178:181]
    v_mfma_f32_16x16x32_bf16 v[182:185], v[114:117], a[56:59], v[182:185]
    ds_write_b128 v21, v[166:169] offset:12288
    v_mfma_f32_16x16x32_bf16 v[186:189], v[114:117], a[60:63], v[186:189]
    v_mfma_f32_16x16x32_bf16 v[174:177], v[118:121], a[64:67], v[174:177]
    global_load_dwordx4 v[102:105], v30, s[54:55] offset:0 sc1
    v_mfma_f32_16x16x32_bf16 v[178:181], v[118:121], a[68:71], v[178:181]
    ds_write_b128 v22, v[170:173] offset:12288
    v_mfma_f32_16x16x32_bf16 v[182:185], v[118:121], a[72:75], v[182:185]
    s_waitcnt vmcnt(13)
    v_and_b32 v28, v129, v133
    v_mfma_f32_16x16x32_bf16 v[186:189], v[118:121], a[76:79], v[186:189]
    s_waitcnt vmcnt(11)
    v_bitop3_b32 v28, v137, v141, v28 bitop3:0x80
    v_mfma_f32_16x16x32_bf16 v[174:177], v[122:125], a[80:83], v[174:177]
    v_and_b32 v28, 1, v28
    global_load_dwordx4 v[106:109], v31, s[54:55] offset:0 sc1
    v_mfma_f32_16x16x32_bf16 v[178:181], v[122:125], a[84:87], v[178:181]
    s_waitcnt lgkmcnt(0)
    s_barrier
    v_cmp_ne_u32 vcc, 1, v28
    v_mfma_f32_16x16x32_bf16 v[182:185], v[122:125], a[88:91], v[182:185]
    v_mfma_f32_16x16x32_bf16 v[186:189], v[122:125], a[92:95], v[186:189]
    s_cbranch_vccnz Lz14_r
Lz14_ok:
    v_mfma_f32_16x16x32_bf16 v[174:177], v[126:129], a[224:227], v[174:177]
    global_load_dwordx4 v[110:113], v30, s[64:65] offset:0 sc1
    ds_read_b128 v[162:165], v23 offset:12288
    v_mfma_f32_16x16x32_bf16 v[178:181], v[126:129], a[228:231], v[178:181]
    ds_read_b128 v[166:169], v23 offset:13312
    v_mfma_f32_16x16x32_bf16 v[182:185], v[126:129], a[232:235], v[182:185]
    ds_read_b128 v[170:173], v23 offset:14336
    global_load_dwordx4 v[114:117], v31, s[64:65] offset:0 sc1
    v_mfma_f32_16x16x32_bf16 v[186:189], v[126:129], a[236:239], v[186:189]
    v_lshlrev_b32 v12, 16, v50
    v_mfma_f32_16x16x32_bf16 v[174:177], v[130:133], a[240:243], v[174:177]
    v_and_b32 v13, 0xffff0000, v50
    v_mfma_f32_16x16x32_bf16 v[178:181], v[130:133], a[244:247], v[178:181]
    global_load_dwordx4 v[118:121], v30, s[66:67] offset:0 sc1
    v_mfma_f32_16x16x32_bf16 v[182:185], v[130:133], a[248:251], v[182:185]
    v_lshlrev_b32 v14, 16, v51
    v_mfma_f32_16x16x32_bf16 v[186:189], v[130:133], a[252:255], v[186:189]
    v_and_b32 v15, 0xffff0000, v51
    v_mfma_f32_16x16x32_bf16 v[174:177], v[134:137], a[192:195], v[174:177]
    global_load_dwordx4 v[122:125], v31, s[66:67] offset:0 sc1
    s_waitcnt lgkmcnt(2)
    v_add_f32 v158, v158, v162
    v_mfma_f32_16x16x32_bf16 v[178:181], v[134:137], a[196:199], v[178:181]
    v_add_f32 v159, v159, v163
    v_mfma_f32_16x16x32_bf16 v[182:185], v[134:137], a[200:203], v[182:185]
    s_waitcnt vmcnt(14)
    v_and_b32 v28, v65, v69
    global_load_lds_dwordx4 v4, s[92:93] offset:2048 sc1
    v_mfma_f32_16x16x32_bf16 v[186:189], v[134:137], a[204:207], v[186:189]
    s_waitcnt vmcnt(13)
    v_bitop3_b32 v28, v73, v77, v28 bitop3:0x80
    v_add_f32 v160, v160, v164
    v_mfma_f32_16x16x32_bf16 v[174:177], v[138:141], a[208:211], v[174:177]
    v_and_b32 v28, 1, v28
    v_add_f32 v161, v161, v165
    v_mfma_f32_16x16x32_bf16 v[178:181], v[138:141], a[212:215], v[178:181]
    v_cmp_ne_u32 vcc, 1, v28
    global_load_lds_dwordx4 v4, s[92:93] offset:3072 sc1
    v_mfma_f32_16x16x32_bf16 v[182:185], v[138:141], a[216:219], v[182:185]
    s_waitcnt lgkmcnt(1)
    v_add_f32 v158, v158, v166
    v_add_f32 v159, v159, v167
    v_mfma_f32_16x16x32_bf16 v[186:189], v[138:141], a[220:223], v[186:189]
    s_cbranch_vccnz Lz15_r
Lz15_ok:
    v_mfma_f32_16x16x32_bf16 v[174:177], v[62:65], a[96:99], v[174:177]
    global_load_dwordx4 v[126:129], v30, s[60:61] offset:1024 sc1
    v_add_f32 v160, v160, v168
    v_mfma_f32_16x16x32_bf16 v[178:181], v[62:65], a[100:103], v[178:181]
    v_add_f32 v161, v161, v169
    global_load_dwordx4 v[130:133], v31, s[60:61] offset:1024 sc1
    v_mfma_f32_16x16x32_bf16 v[182:185], v[62:65], a[104:107], v[182:185]
    s_waitcnt lgkmcnt(0)
    v_add_f32 v158, v158, v170
    v_mfma_f32_16x16x32_bf16 v[186:189], v[62:65], a[108:111], v[186:189]
    global_load_dwordx4 v[134:137], v30, s[62:63] offset:1024 sc1
    v_add_f32 v159, v159, v171
    v_mfma_f32_16x16x32_bf16 v[174:177], v[66:69], a[112:115], v[174:177]
    v_add_f32 v160, v160, v172
    v_mfma_f32_16x16x32_bf16 v[178:181], v[66:69], a[116:119], v[178:181]
    global_load_dwordx4 v[138:141], v31, s[62:63] offset:1024 sc1
    v_mfma_f32_16x16x32_bf16 v[182:185], v[66:69], a[120:123], v[182:185]
    v_add_f32 v161, v161, v173
    v_mfma_f32_16x16x32_bf16 v[186:189], v[66:69], a[124:127], v[186:189]
    s_add_u32 m0, s95, 8192
    v_mul_f32 v158, v158, v12
    v_mfma_f32_16x16x32_bf16 v[174:177], v[70:73], a[128:131], v[174:177]
    v_mul_f32 v159, v159, v13
    s_add_u32 s92, s92, 4096
    s_addc_u32 s93, s93, 0
    v_mfma_f32_16x16x32_bf16 v[178:181], v[70:73], a[132:135], v[178:181]
    v_mul_f32 v160, v160, v14
    v_mfma_f32_16x16x32_bf16 v[182:185], v[70:73], a[136:139], v[182:185]
    s_waitcnt vmcnt(16)
    v_and_b32 v28, v81, v85
    v_mfma_f32_16x16x32_bf16 v[186:189], v[70:73], a[140:143], v[186:189]
    s_waitcnt vmcnt(14)
    v_bitop3_b32 v28, v89, v93, v28 bitop3:0x80
    v_mul_f32 v161, v161, v15
    v_mfma_f32_16x16x32_bf16 v[174:177], v[74:77], a[144:147], v[174:177]
    v_and_b32 v28, 1, v28
    v_cvt_pk_bf16_f32 v50, v158, v159
    v_mfma_f32_16x16x32_bf16 v[178:181], v[74:77], a[148:151], v[178:181]
    global_load_lds_dwordx4 v4, s[92:93] offset:0 sc1
    v_cmp_ne_u32 vcc, 1, v28
    v_mfma_f32_16x16x32_bf16 v[182:185], v[74:77], a[152:155], v[182:185]
    v_cvt_pk_bf16_f32 v51, v160, v161
    global_load_lds_dwordx4 v4, s[92:93] offset:1024 sc1
    v_mfma_f32_16x16x32_bf16 v[186:189], v[74:77], a[156:159], v[186:189]
    v_and_b32 v51, -2, v51
    s_cbranch_vccnz Lz16_r
Lz16_ok:
    v_mfma_f32_16x16x32_bf16 v[190:193], v[78:81], a[32:35], v[190:193]
    global_load_dwordx4 v[62:65], v30, s[52:53] offset:1024 sc1
    v_mfma_f32_16x16x32_bf16 v[194:197], v[78:81], a[36:39], v[194:197]
    v_mfma_f32_16x16x32_bf16 v[198:201], v[78:81], a[40:43], v[198:201]
    global_load_dwordx4 v[66:69], v31, s[52:53] offset:1024 sc1
    v_mfma_f32_16x16x32_bf16 v[202:205], v[78:81], a[44:47], v[202:205]
    ds_write_b128 v20, v[178:181] offset:0
    v_mfma_f32_16x16x32_bf16 v[190:193], v[82:85], a[48:51], v[190:193]
    v_mfma_f32_16x16x32_bf16 v[194:197], v[82:85], a[52:55], v[194:197]
    global_load_dwordx4 v[70:73], v30, s[54:55] offset:1024 sc1
    v_mfma_f32_16x16x32_bf16 v[198:201], v[82:85], a[56:59], v[198:201]
    ds_write_b128 v21, v[182:185] offset:0
    v_mfma_f32_16x16x32_bf16 v[202:205], v[82:85], a[60:63], v[202:205]
    v_mfma_f32_16x16x32_bf16 v[190:193], v[86:89], a[64:67], v[190:193]
    global_load_dwordx4 v[74:77], v31, s[54:55] offset:1024 sc1
    v_mfma_f32_16x16x32_bf16 v[194:197], v[86:89], a[68:71], v[194:197]
    ds_write_b128 v22, v[186:189] offset:0
    v_mfma_f32_16x16x32_bf16 v[198:201], v[86:89], a[72:75], v[198:201]
    s_waitcnt vmcnt(18)
    v_and_b32 v28, v97, v101
    global_load_lds_dwordx4 v4, s[92:93] offset:2048 sc1
    v_mfma_f32_16x16x32_bf16 v[202:205], v[86:89], a[76:79], v[202:205]
    s_waitcnt vmcnt(17)
    v_bitop3_b32 v28, v105, v109, v28 bitop3:0x80
    v_mfma_f32_16x16x32_bf16 v[190:193], v[90:93], a[80:83], v[190:193]
    v_and_b32 v28, 1, v28
    s_waitcnt lgkmcnt(0)
    s_barrier
    v_mfma_f32_16x16x32_bf16 v[194:197], v[90:93], a[84:87], v[194:197]
    v_cmp_ne_u32 vcc, 1, v28
    global_load_lds_dwordx4 v4, s[92:93] offset:3072 sc1
    v_mfma_f32_16x16x32_bf16 v[198:201], v[90:93], a[88:91], v[198:201]
    v_mfma_f32_16x16x32_bf16 v[202:205], v[90:93], a[92:95], v[202:205]
    s_cbranch_vccnz Lz17_r
Lz17_ok:
    v_mfma_f32_16x16x32_bf16 v[190:193], v[94:97], a[224:227], v[190:193]
    global_load_dwordx4 v[78:81], v30, s[64:65] offset:1024 sc1
    ds_read_b128 v[178:181], v23 offset:0
    v_mfma_f32_16x16x32_bf16 v[194:197], v[94:97], a[228:231], v[194:197]
    ds_read_b128 v[182:185], v23 offset:1024
    global_load_dwordx4 v[82:85], v31, s[64:65] offset:1024 sc1
    v_mfma_f32_16x16x32_bf16 v[198:201], v[94:97], a[232:235], v[198:201]
    ds_read_b128 v[186:189], v23 offset:2048
    v_mfma_f32_16x16x32_bf16 v[202:205], v[94:97], a[236:239], v[202:205]
    global_load_dwordx4 v[86:89], v30, s[66:67] offset:1024 sc1
    v_lshlrev_b32 v12, 16, v52
    v_mfma_f32_16x16x32_bf16 v[190:193], v[98:101], a[240:243], v[190:193]
    v_and_b32 v13, 0xffff0000, v52
    v_mfma_f32_16x16x32_bf16 v[194:197], v[98:101], a[244:247], v[194:197]
    global_load_dwordx4 v[90:93], v31, s[66:67] offset:1024 sc1
    v_mfma_f32_16x16x32_bf16 v[198:201], v[98:101], a[248:251], v[198:201]
    v_lshlrev_b32 v14, 16, v53
    v_mfma_f32_16x16x32_bf16 v[202:205], v[98:101], a[252:255], v[202:205]
    s_add_u32 m0, s95, 12288
    v_and_b32 v15, 0xffff0000, v53
    v_mfma_f32_16x16x32_bf16 v[190:193], v[102:105], a[192:195], v[190:193]
    s_waitcnt lgkmcnt(2)
    v_add_f32 v174, v174, v178
    s_add_u32 s92, s92, 4096
    s_addc_u32 s93, s93, 0
    v_mfma_f32_16x16x32_bf16 v[194:197], v[102:105], a[196:199], v[194:197]
    v_add_f32 v175, v175, v179
    v_mfma_f32_16x16x32_bf16 v[198:201], v[102:105], a[200:203], v[198:201]
    s_waitcnt vmcnt(20)
    v_and_b32 v28, v113, v117
    v_mfma_f32_16x16x32_bf16 v[202:205], v[102:105], a[204:207], v[202:205]
    s_waitcnt vmcnt(18)
    v_bitop3_b32 v28, v121, v125, v28 bitop3:0x80
    v_add_f32 v176, v176, v180
    v_mfma_f32_16x16x32_bf16 v[190:193], v[106:109], a[208:211], v[190:193]
    v_and_b32 v28, 1, v28
    v_add_f32 v177, v177, v181
    v_mfma_f32_16x16x32_bf16 v[194:197], v[106:109], a[212:215], v[194:197]
    global_load_lds_dwordx4 v4, s[92:93] offset:0 sc1
    v_cmp_ne_u32 vcc, 1, v28
    v_mfma_f32_16x16x32_bf16 v[198:201], v[106:109], a[216:219], v[198:201]
    s_waitcnt lgkmcnt(1)
    v_add_f32 v174, v174, v182
    global_load_lds_dwordx4 v4, s[92:93] offset:1024 sc1
    v_mfma_f32_16x16x32_bf16 v[202:205], v[106:109], a[220:223], v[202:205]
    v_add_f32 v175, v175, v183
    s_cbranch_vccnz Lz18_r
Lz18_ok:
    v_mfma_f32_16x16x32_bf16 v[190:193], v[110:113], a[96:99], v[190:193]
    global_load_dwordx4 v[94:97], v30, s[60:61] offset:2048 sc1
    v_add_f32 v176, v176, v184
    v_mfma_f32_16x16x32_bf16 v[194:197], v[110:113], a[100:103], v[194:197]
    v_add_f32 v177, v177, v185
    v_mfma_f32_16x16x32_bf16 v[198:201], v[110:113], a[104:107], v[198:201]
    global_load_dwordx4 v[98:101], v31, s[60:61] offset:2048 sc1
    s_waitcnt lgkmcnt(0)
    v_add_f32 v174, v174, v186
    v_mfma_f32_16x16x32_bf16 v[202:205], v[110:113], a[108:111], v[202:205]
    v_mfma_f32_16x16x32_bf16 v[190:193], v[114:117], a[112:115], v[190:193]
    v_add_f32 v175, v175, v187
    v_mfma_f32_16x16x32_bf16 v[194:197], v[114:117], a[116:119], v[194:197]
    global_load_dwordx4 v[102:105], v30, s[62:63] offset:2048 sc1
    v_add_f32 v176, v176, v188
    v_mfma_f32_16x16x32_bf16 v[198:201], v[114:117], a[120:123], v[198:201]
    v_add_f32 v177, v177, v189
    v_mfma_f32_16x16x32_bf16 v[202:205], v[114:117], a[124:127], v[202:205]
    v_mfma_f32_16x16x32_bf16 v[190:193], v[118:121], a[128:131], v[190:193]
    global_load_dwordx4 v[106:109], v31, s[62:63] offset:2048 sc1
    v_mul_f32 v174, v174, v12
    v_mfma_f32_16x16x32_bf16 v[194:197], v[118:121], a[132:135], v[194:197]
    v_mul_f32 v175, v175, v13
    v_mfma_f32_16x16x32_bf16 v[198:201], v[118:121], a[136:139], v[198:201]
    s_waitcnt vmcnt(20)
    v_and_b32 v28, v129, v133
    global_load_lds_dwordx4 v4, s[92:93] offset:2048 sc1
    v_mfma_f32_16x16x32_bf16 v[202:205], v[118:121], a[140:143], v[202:205]
    s_waitcnt vmcnt(19)
    v_bitop3_b32 v28, v137, v141, v28 bitop3:0x80
    v_mul_f32 v176, v176, v14
    v_mfma_f32_16x16x32_bf16 v[190:193], v[122:125], a[144:147], v[190:193]
    v_and_b32 v28, 1, v28
    v_mul_f32 v177, v177, v15
    v_mfma_f32_16x16x32_bf16 v[194:197], v[122:125], a[148:151], v[194:197]
    v_cmp_ne_u32 vcc, 1, v28
    global_load_lds_dwordx4 v4, s[92:93] offset:3072 sc1
    v_mfma_f32_16x16x32_bf16 v[198:201], v[122:125], a[152:155], v[198:201]
    v_cvt_pk_bf16_f32 v52, v174, v175
    v_cvt_pk_bf16_f32 v53, v176, v177
    v_mfma_f32_16x16x32_bf16 v[202:205], v[122:125], a[156:159], v[202:205]
    s_cbranch_vccnz Lz19_r
Lz19_ok:
    v_mfma_f32_16x16x32_bf16 v[206:209], v[126:129], a[32:35], v[206:209]
    global_load_dwordx4 v[110:113], v30, s[52:53] offset:2048 sc1
    v_mfma_f32_16x16x32_bf16 v[210:213], v[126:129], a[36:39], v[210:213]
    global_load_dwordx4 v[114:117], v31, s[52:53] offset:2048 sc1
    v_mfma_f32_16x16x32_bf16 v[214:217], v[126:129], a[40:43], v[214:217]
    v_mfma_f32_16x16x32_bf16 v[218:221], v[126:129], a[44:47], v[218:221]
    ds_write_b128 v20, v[194:197] offset:12288
    v_mfma_f32_16x16x32_bf16 v[206:209], v[130:133], a[48:51], v[206:209]
    global_load_dwordx4 v[118:121], v30, s[54:55] offset:2048 sc1
    v_mfma_f32_16x16x32_bf16 v[210:213], v[130:133], a[52:55], v[210:213]
    global_load_dwordx4 v[122:125], v31, s[54:55] offset:2048 sc1
    v_mfma_f32_16x16x32_bf16 v[214:217], v[130:133], a[56:59], v[214:217]
    ds_write_b128 v21, v[198:201] offset:12288
    v_mfma_f32_16x16x32_bf16 v[218:221], v[130:133], a[60:63], v[218:221]
    s_add_u32 m0, s95, 16384
    v_mfma_f32_16x16x32_bf16 v[206:209], v[134:137], a[64:67], v[206:209]
    s_add_u32 s92, s92, 4096
    s_addc_u32 s93, s93, 0
    v_mfma_f32_16x16x32_bf16 v[210:213], v[134:137], a[68:71], v[210:213]
    ds_write_b128 v22, v[202:205] offset:12288
    v_mfma_f32_16x16x32_bf16 v[214:217], v[134:137], a[72:75], v[214:217]
    s_waitcnt vmcnt(20)
    v_and_b32 v28, v65, v69
    v_mfma_f32_16x16x32_bf16 v[218:221], v[134:137], a[76:79], v[218:221]
    s_waitcnt vmcnt(18)
    v_bitop3_b32 v28, v73, v77, v28 bitop3:0x80
    v_mfma_f32_16x16x32_bf16 v[206:209], v[138:141], a[80:83], v[206:209]
    v_and_b32 v28, 1, v28
    global_load_lds_dwordx4 v4, s[92:93] offset:0 sc1
    v_mfma_f32_16x16x32_bf16 v[210:213], v[138:141], a[84:87], v[210:213]
    s_waitcnt lgkmcnt(0)
    s_barrier
    v_cmp_ne_u32 vcc, 1, v28
    v_mfma_f32_16x16x32_bf16 v[214:217], v[138:141], a[88:91], v[214:217]
    global_load_lds_dwordx4 v4, s[92:93] offset:1024 sc1
    v_mfma_f32_16x16x32_bf16 v[218:221], v[138:141], a[92:95], v[218:221]
    s_cbranch_vccnz Lz20_r
Lz20_ok:
    v_mfma_f32_16x16x32_bf16 v[206:209], v[62:65], a[224:227], v[206:209]
    global_load_dwordx4 v[126:129], v30, s[64:65] offset:2048 sc1
    ds_read_b128 v[194:197], v23 offset:12288
    v_mfma_f32_16x16x32_bf16 v[210:213], v[62:65], a[228:231], v[210:213]
    ds_read_b128 v[198:201], v23 offset:13312
    v_mfma_f32_16x16x32_bf16 v[214:217], v[62:65], a[232:235], v[214:217]
    ds_read_b128 v[202:205], v23 offset:14336
    global_load_dwordx4 v[130:133], v31, s[64:65] offset:2048 sc1
    v_mfma_f32_16x16x32_bf16 v[218:221], v[62:65], a[236:239], v[218:221]
    v_lshlrev_b32 v12, 16, v54
    v_mfma_f32_16x16x32_bf16 v[206:209], v[66:69], a[240:243], v[206:209]
    v_and_b32 v13, 0xffff0000, v54
    v_mfma_f32_16x16x32_bf16 v[210:213], v[66:69], a[244:247], v[210:213]
    global_load_dwordx4 v[134:137], v30, s[66:67] offset:2048 sc1
    v_mfma_f32_16x16x32_bf16 v[214:217], v[66:69], a[248:251], v[214:217]
    v_lshlrev_b32 v14, 16, v55
    v_mfma_f32_16x16x32_bf16 v[218:221], v[66:69], a[252:255], v[218:221]
    v_and_b32 v15, 0xffff0000, v55
    v_mfma_f32_16x16x32_bf16 v[206:209], v[70:73], a[192:195], v[206:209]
    global_load_dwordx4 v[138:141], v31, s[66:67] offset:2048 sc1
    s_waitcnt lgkmcnt(2)
    v_add_f32 v190, v190, v194
    v_mfma_f32_16x16x32_bf16 v[210:213], v[70:73], a[196:199], v[210:213]
    v_add_f32 v191, v191, v195
    v_mfma_f32_16x16x32_bf16 v[214:217], v[70:73], a[200:203], v[214:217]
    s_waitcnt vmcnt(20)
    v_and_b32 v28, v81, v85
    global_load_lds_dwordx4 v4, s[92:93] offset:2048 sc1
    v_mfma_f32_16x16x32_bf16 v[218:221], v[70:73], a[204:207], v[218:221]
    s_waitcnt vmcnt(19)
    v_bitop3_b32 v28, v89, v93, v28 bitop3:0x80
    v_add_f32 v192, v192, v196
    v_mfma_f32_16x16x32_bf16 v[206:209], v[74:77], a[208:211], v[206:209]
    v_and_b32 v28, 1, v28
    v_add_f32 v193, v193, v197
    v_mfma_f32_16x16x32_bf16 v[210:213], v[74:77], a[212:215], v[210:213]
    v_cmp_ne_u32 vcc, 1, v28
    global_load_lds_dwordx4 v4, s[92:93] offset:3072 sc1
    v_mfma_f32_16x16x32_bf16 v[214:217], v[74:77], a[216:219], v[214:217]
    s_waitcnt lgkmcnt(1)
    v_add_f32 v190, v190, v198
    v_add_f32 v191, v191, v199
    v_mfma_f32_16x16x32_bf16 v[218:221], v[74:77], a[220:223], v[218:221]
    s_cbranch_vccnz Lz21_r
Lz21_ok:
    v_mfma_f32_16x16x32_bf16 v[206:209], v[78:81], a[96:99], v[206:209]
    global_load_dwordx4 v[62:65], v30, s[60:61] offset:3072 sc1
    v_add_f32 v192, v192, v200
    v_mfma_f32_16x16x32_bf16 v[210:213], v[78:81], a[100:103], v[210:213]
    v_add_f32 v193, v193, v201
    global_load_dwordx4 v[66:69], v31, s[60:61] offset:3072 sc1
    v_mfma_f32_16x16x32_bf16 v[214:217], v[78:81], a[104:107], v[214:217]
    s_waitcnt lgkmcnt(0)
    v_add_f32 v190, v190, v202
    v_mfma_f32_16x16x32_bf16 v[218:221], v[78:81], a[108:111], v[218:221]
    global_load_dwordx4 v[70:73], v30, s[62:63] offset:3072 sc1
    v_add_f32 v191, v191, v203
    v_mfma_f32_16x16x32_bf16 v[206:209], v[82:85], a[112:115], v[206:209]
    v_add_f32 v192, v192, v204
    v_mfma_f32_16x16x32_bf16 v[210:213], v[82:85], a[116:119], v[210:213]
    global_load_dwordx4 v[74:77], v31, s[62:63] offset:3072 sc1
    v_mfma_f32_16x16x32_bf16 v[214:217], v[82:85], a[120:123], v[214:217]
    v_add_f32 v193, v193, v205
    v_mfma_f32_16x16x32_bf16 v[218:221], v[82:85], a[124:127], v[218:221]
    s_add_u32 m0, s95, 20480
    v_mul_f32 v190, v190, v12
    v_mfma_f32_16x16x32_bf16 v[206:209], v[86:89], a[128:131], v[206:209]
    v_mul_f32 v191, v191, v13
    s_add_u32 s92, s92, 4096
    s_addc_u32 s93, s93, 0
    v_mfma_f32_16x16x32_bf16 v[210:213], v[86:89], a[132:135], v[210:213]
    v_mul_f32 v192, v192, v14
    v_mfma_f32_16x16x32_bf16 v[214:217], v[86:89], a[136:139], v[214:217]
    s_waitcnt vmcnt(20)
    v_and_b32 v28, v97, v101
    v_mfma_f32_16x16x32_bf16 v[218:221], v[86:89], a[140:143], v[218:221]
    s_waitcnt vmcnt(18)
    v_bitop3_b32 v28, v105, v109, v28 bitop3:0x80
    v_mul_f32 v193, v193, v15
    v_mfma_f32_16x16x32_bf16 v[206:209], v[90:93], a[144:147], v[206:209]
    v_and_b32 v28, 1, v28
    v_cvt_pk_bf16_f32 v54, v190, v191
    v_mfma_f32_16x16x32_bf16 v[210:213], v[90:93], a[148:151], v[210:213]
    global_load_lds_dwordx4 v4, s[92:93] offset:0 sc1
    v_cmp_ne_u32 vcc, 1, v28
    v_mfma_f32_16x16x32_bf16 v[214:217], v[90:93], a[152:155], v[214:217]
    v_cvt_pk_bf16_f32 v55, v192, v193
    global_load_lds_dwordx4 v4, s[92:93] offset:1024 sc1
    v_mfma_f32_16x16x32_bf16 v[218:221], v[90:93], a[156:159], v[218:221]
    v_and_b32 v55, -2, v55
    s_cbranch_vccnz Lz22_r
Lz22_ok:
    v_mfma_f32_16x16x32_bf16 v[222:225], v[94:97], a[32:35], v[222:225]
    global_load_dwordx4 v[78:81], v30, s[52:53] offset:3072 sc1
    v_mfma_f32_16x16x32_bf16 v[226:229], v[94:97], a[36:39], v[226:229]
    v_mfma_f32_16x16x32_bf16 v[230:233], v[94:97], a[40:43], v[230:233]
    global_load_dwordx4 v[82:85], v31, s[52:53] offset:3072 sc1
    v_mfma_f32_16x16x32_bf16 v[234:237], v[94:97], a[44:47], v[234:237]
    ds_write_b128 v20, v[210:213] offset:0
    v_mfma_f32_16x16x32_bf16 v[222:225], v[98:101], a[48:51], v[222:225]
    global_load_dwordx4 v[86:89], v30, s[54:55] offset:3072 sc1
    v_mfma_f32_16x16x32_bf16 v[226:229], v[98:101], a[52:55], v[226:229]
    v_mfma_f32_16x16x32_bf16 v[230:233], v[98:101], a[56:59], v[230:233]
    global_load_dwordx4 v[90:93], v31, s[54:55] offset:3072 sc1
    v_mfma_f32_16x16x32_bf16 v[234:237], v[98:101], a[60:63], v[234:237]
    ds_write_b128 v21, v[214:217] offset:0
    v_mfma_f32_16x16x32_bf16 v[222:225], v[102:105], a[64:67], v[222:225]
    global_store_dwordx4 v6, v[48:51], s[8:9] offset:-4096 sc1
    v_mfma_f32_16x16x32_bf16 v[226:229], v[102:105], a[68:71], v[226:229]
    ds_write_b128 v22, v[218:221] offset:0
    v_mfma_f32_16x16x32_bf16 v[230:233], v[102:105], a[72:75], v[230:233]
    s_waitcnt vmcnt(21)
    v_and_b32 v28, v113, v117
    global_store_dwordx4 v7, v[52:55], s[8:9] offset:-4096 sc1
    v_mfma_f32_16x16x32_bf16 v[234:237], v[102:105], a[76:79], v[234:237]
    s_waitcnt vmcnt(20)
    v_bitop3_b32 v28, v121, v125, v28 bitop3:0x80
    v_mfma_f32_16x16x32_bf16 v[222:225], v[106:109], a[80:83], v[222:225]
    v_and_b32 v28, 1, v28
    global_load_lds_dwordx4 v4, s[92:93] offset:2048 sc1
    v_mfma_f32_16x16x32_bf16 v[226:229], v[106:109], a[84:87], v[226:229]
    s_waitcnt lgkmcnt(0)
    s_barrier
    v_cmp_ne_u32 vcc, 1, v28
    v_mfma_f32_16x16x32_bf16 v[230:233], v[106:109], a[88:91], v[230:233]
    global_load_lds_dwordx4 v4, s[92:93] offset:3072 sc1
    v_mfma_f32_16x16x32_bf16 v[234:237], v[106:109], a[92:95], v[234:237]
    s_cbranch_vccnz Lz23_r
Lz23_ok:
    v_mfma_f32_16x16x32_bf16 v[222:225], v[110:113], a[224:227], v[222:225]
    global_load_dwordx4 v[94:97], v30, s[64:65] offset:3072 sc1
    ds_read_b128 v[210:213], v23 offset:0
    v_mfma_f32_16x16x32_bf16 v[226:229], v[110:113], a[228:231], v[226:229]
    ds_read_b128 v[214:217], v23 offset:1024
    global_load_dwordx4 v[98:101], v31, s[64:65] offset:3072 sc1
    v_mfma_f32_16x16x32_bf16 v[230:233], v[110:113], a[232:235], v[230:233]
    ds_read_b128 v[218:221], v23 offset:2048
    v_mfma_f32_16x16x32_bf16 v[234:237], v[110:113], a[236:239], v[234:237]
    global_load_dwordx4 v[102:105], v30, s[66:67] offset:3072 sc1
    v_lshlrev_b32 v12, 16, v56
    v_mfma_f32_16x16x32_bf16 v[222:225], v[114:117], a[240:243], v[222:225]
    v_and_b32 v13, 0xffff0000, v56
    v_mfma_f32_16x16x32_bf16 v[226:229], v[114:117], a[244:247], v[226:229]
    global_load_dwordx4 v[106:109], v31, s[66:67] offset:3072 sc1
    v_mfma_f32_16x16x32_bf16 v[230:233], v[114:117], a[248:251], v[230:233]
    v_lshlrev_b32 v14, 16, v57
    v_mfma_f32_16x16x32_bf16 v[234:237], v[114:117], a[252:255], v[234:237]
    s_add_u32 m0, s95, 24576
    v_and_b32 v15, 0xffff0000, v57
    v_mfma_f32_16x16x32_bf16 v[222:225], v[118:121], a[192:195], v[222:225]
    s_waitcnt lgkmcnt(2)
    v_add_f32 v206, v206, v210
    s_add_u32 s92, s92, 4096
    s_addc_u32 s93, s93, 0
    v_mfma_f32_16x16x32_bf16 v[226:229], v[118:121], a[196:199], v[226:229]
    v_add_f32 v207, v207, v211
    v_mfma_f32_16x16x32_bf16 v[230:233], v[118:121], a[200:203], v[230:233]
    s_waitcnt vmcnt(22)
    v_and_b32 v28, v129, v133
    v_mfma_f32_16x16x32_bf16 v[234:237], v[118:121], a[204:207], v[234:237]
    s_waitcnt vmcnt(20)
    v_bitop3_b32 v28, v137, v141, v28 bitop3:0x80
    v_add_f32 v208, v208, v212
    v_mfma_f32_16x16x32_bf16 v[222:225], v[122:125], a[208:211], v[222:225]
    v_and_b32 v28, 1, v28
    v_add_f32 v209, v209, v213
    v_mfma_f32_16x16x32_bf16 v[226:229], v[122:125], a[212:215], v[226:229]
    global_load_lds_dwordx4 v4, s[92:93] offset:0 sc1
    v_cmp_ne_u32 vcc, 1, v28
    v_mfma_f32_16x16x32_bf16 v[230:233], v[122:125], a[216:219], v[230:233]
    s_waitcnt lgkmcnt(1)
    v_add_f32 v206, v206, v214
    global_load_lds_dwordx4 v4, s[92:93] offset:1024 sc1
    v_mfma_f32_16x16x32_bf16 v[234:237], v[122:125], a[220:223], v[234:237]
    v_add_f32 v207, v207, v215
    s_cbranch_vccnz Lz24_r
Lz24_ok:
    v_mfma_f32_16x16x32_bf16 v[222:225], v[126:129], a[96:99], v[222:225]
    global_load_lds_dwordx4 v4, s[92:93] offset:2048 sc1
    v_add_f32 v208, v208, v216
    v_mfma_f32_16x16x32_bf16 v[226:229], v[126:129], a[100:103], v[226:229]
    v_add_f32 v209, v209, v217
    v_mfma_f32_16x16x32_bf16 v[230:233], v[126:129], a[104:107], v[230:233]
    s_waitcnt lgkmcnt(0)
    v_add_f32 v206, v206, v218
    v_mfma_f32_16x16x32_bf16 v[234:237], v[126:129], a[108:111], v[234:237]
    v_mfma_f32_16x16x32_bf16 v[222:225], v[130:133], a[112:115], v[222:225]
    v_add_f32 v207, v207, v219
    v_mfma_f32_16x16x32_bf16 v[226:229], v[130:133], a[116:119], v[226:229]
    v_add_f32 v208, v208, v220
    v_mfma_f32_16x16x32_bf16 v[230:233], v[130:133], a[120:123], v[230:233]
    v_add_f32 v209, v209, v221
    v_mfma_f32_16x16x32_bf16 v[234:237], v[130:133], a[124:127], v[234:237]
    v_mfma_f32_16x16x32_bf16 v[222:225], v[134:137], a[128:131], v[222:225]
    global_load_lds_dwordx4 v4, s[92:93] offset:3072 sc1
    v_mul_f32 v206, v206, v12
    v_mfma_f32_16x16x32_bf16 v[226:229], v[134:137], a[132:135], v[226:229]
    v_mul_f32 v207, v207, v13
    v_mfma_f32_16x16x32_bf16 v[230:233], v[134:137], a[136:139], v[230:233]
    s_waitcnt vmcnt(20)
    v_and_b32 v28, v65, v69
    v_mul_f32 v208, v208, v14
    v_mfma_f32_16x16x32_bf16 v[234:237], v[134:137], a[140:143], v[234:237]
    s_waitcnt vmcnt(18)
    v_bitop3_b32 v28, v73, v77, v28 bitop3:0x80
    v_mfma_f32_16x16x32_bf16 v[222:225], v[138:141], a[144:147], v[222:225]
    v_and_b32 v28, 1, v28
    v_mul_f32 v209, v209, v15
    v_mfma_f32_16x16x32_bf16 v[226:229], v[138:141], a[148:151], v[226:229]
    v_cmp_ne_u32 vcc, 1, v28
    v_cvt_pk_bf16_f32 v56, v206, v207
    v_mfma_f32_16x16x32_bf16 v[230:233], v[138:141], a[152:155], v[230:233]
    v_cvt_pk_bf16_f32 v57, v208, v209
    v_mfma_f32_16x16x32_bf16 v[234:237], v[138:141], a[156:159], v[234:237]
    s_cbranch_vccnz Lz25_r
Lz25_ok:
    v_mfma_f32_16x16x32_bf16 v[238:241], v[62:65], a[32:35], v[238:241]
    s_add_u32 m0, s95, 28672
    v_mfma_f32_16x16x32_bf16 v[242:245], v[62:65], a[36:39], v[242:245]
    v_mfma_f32_16x16x32_bf16 v[246:249], v[62:65], a[40:43], v[246:249]
    v_mfma_f32_16x16x32_bf16 v[250:253], v[62:65], a[44:47], v[250:253]
    ds_write_b128 v20, v[226:229] offset:12288
    v_mfma_f32_16x16x32_bf16 v[238:241], v[66:69], a[48:51], v[238:241]
    s_add_u32 s92, s92, 4096
    s_addc_u32 s93, s93, 0
    v_mfma_f32_16x16x32_bf16 v[242:245], v[66:69], a[52:55], v[242:245]
    v_mfma_f32_16x16x32_bf16 v[246:249], v[66:69], a[56:59], v[246:249]
    ds_write_b128 v21, v[230:233] offset:12288
    v_mfma_f32_16x16x32_bf16 v[250:253], v[66:69], a[60:63], v[250:253]
    v_mfma_f32_16x16x32_bf16 v[238:241], v[70:73], a[64:67], v[238:241]
    v_mfma_f32_16x16x32_bf16 v[242:245], v[70:73], a[68:71], v[242:245]
    ds_write_b128 v22, v[234:237] offset:12288
    v_mfma_f32_16x16x32_bf16 v[246:249], v[70:73], a[72:75], v[246:249]
    s_waitcnt vmcnt(14)
    v_and_b32 v28, v81, v85
    global_load_lds_dwordx4 v4, s[92:93] offset:0 sc1
    v_mfma_f32_16x16x32_bf16 v[250:253], v[70:73], a[76:79], v[250:253]
    s_waitcnt vmcnt(13)
    v_bitop3_b32 v28, v89, v93, v28 bitop3:0x80
    v_mfma_f32_16x16x32_bf16 v[238:241], v[74:77], a[80:83], v[238:241]
    v_and_b32 v28, 1, v28
    s_waitcnt lgkmcnt(0)
    s_barrier
    v_mfma_f32_16x16x32_bf16 v[242:245], v[74:77], a[84:87], v[242:245]
    global_load_lds_dwordx4 v4, s[92:93] offset:1024 sc1
    v_cmp_ne_u32 vcc, 1, v28
    v_mfma_f32_16x16x32_bf16 v[246:249], v[74:77], a[88:91], v[246:249]
    v_mfma_f32_16x16x32_bf16 v[250:253], v[74:77], a[92:95], v[250:253]
    s_cbranch_vccnz Lz26_r
Lz26_ok:
    v_mfma_f32_16x16x32_bf16 v[238:241], v[78:81], a[224:227], v[238:241]
    global_load_lds_dwordx4 v4, s[92:93] offset:2048 sc1
    ds_read_b128 v[226:229], v23 offset:12288
    v_mfma_f32_16x16x32_bf16 v[242:245], v[78:81], a[228:231], v[242:245]
    ds_read_b128 v[230:233], v23 offset:13312
    v_mfma_f32_16x16x32_bf16 v[246:249], v[78:81], a[232:235], v[246:249]
    ds_read_b128 v[234:237], v23 offset:14336
    v_mfma_f32_16x16x32_bf16 v[250:253], v[78:81], a[236:239], v[250:253]
    v_lshlrev_b32 v12, 16, v58
    v_mfma_f32_16x16x32_bf16 v[238:241], v[82:85], a[240:243], v[238:241]
    v_and_b32 v13, 0xffff0000, v58
    v_mfma_f32_16x16x32_bf16 v[242:245], v[82:85], a[244:247], v[242:245]
    v_mfma_f32_16x16x32_bf16 v[246:249], v[82:85], a[248:251], v[246:249]
    v_lshlrev_b32 v14, 16, v59
    v_mfma_f32_16x16x32_bf16 v[250:253], v[82:85], a[252:255], v[250:253]
    v_and_b32 v15, 0xffff0000, v59
    v_mfma_f32_16x16x32_bf16 v[238:241], v[86:89], a[192:195], v[238:241]
    global_load_lds_dwordx4 v4, s[92:93] offset:3072 sc1
    s_waitcnt lgkmcnt(2)
    v_add_f32 v222, v222, v226
    v_mfma_f32_16x16x32_bf16 v[242:245], v[86:89], a[196:199], v[242:245]
    v_add_f32 v223, v223, v227
    v_mfma_f32_16x16x32_bf16 v[246:249], v[86:89], a[200:203], v[246:249]
    s_waitcnt vmcnt(10)
    v_and_b32 v28, v97, v101
    v_mfma_f32_16x16x32_bf16 v[250:253], v[86:89], a[204:207], v[250:253]
    s_waitcnt vmcnt(8)
    v_bitop3_b32 v28, v105, v109, v28 bitop3:0x80
    v_add_f32 v224, v224, v228
    v_mfma_f32_16x16x32_bf16 v[238:241], v[90:93], a[208:211], v[238:241]
    v_and_b32 v28, 1, v28
    v_add_f32 v225, v225, v229
    v_mfma_f32_16x16x32_bf16 v[242:245], v[90:93], a[212:215], v[242:245]
    v_cmp_ne_u32 vcc, 1, v28
    s_waitcnt lgkmcnt(1)
    v_add_f32 v222, v222, v230
    v_mfma_f32_16x16x32_bf16 v[246:249], v[90:93], a[216:219], v[246:249]
    v_add_f32 v223, v223, v231
    v_mfma_f32_16x16x32_bf16 v[250:253], v[90:93], a[220:223], v[250:253]
    s_cbranch_vccnz Lz27_r
Lz27_ok:
    v_mfma_f32_16x16x32_bf16 v[238:241], v[94:97], a[96:99], v[238:241]
    s_add_u32 m0, s95, 32768
    v_add_f32 v224, v224, v232
    v_mfma_f32_16x16x32_bf16 v[242:245], v[94:97], a[100:103], v[242:245]
    v_add_f32 v225, v225, v233
    v_mfma_f32_16x16x32_bf16 v[246:249], v[94:97], a[104:107], v[246:249]
    s_waitcnt lgkmcnt(0)
    v_add_f32 v222, v222, v234
    v_mfma_f32_16x16x32_bf16 v[250:253], v[94:97], a[108:111], v[250:253]
    s_add_u32 s92, s92, 4096
    s_addc_u32 s93, s93, 0
    v_add_f32 v223, v223, v235
    v_mfma_f32_16x16x32_bf16 v[238:241], v[98:101], a[112:115], v[238:241]
    v_add_f32 v224, v224, v236
    v_mfma_f32_16x16x32_bf16 v[242:245], v[98:101], a[116:119], v[242:245]
    v_mfma_f32_16x16x32_bf16 v[246:249], v[98:101], a[120:123], v[246:249]
    v_add_f32 v225, v225, v237
    v_mfma_f32_16x16x32_bf16 v[250:253], v[98:101], a[124:127], v[250:253]
    v_mul_f32 v222, v222, v12
    v_mfma_f32_16x16x32_bf16 v[238:241], v[102:105], a[128:131], v[238:241]
    v_mul_f32 v223, v223, v13
    v_mfma_f32_16x16x32_bf16 v[242:245], v[102:105], a[132:135], v[242:245]
    global_load_lds_dwordx4 v4, s[92:93] offset:0 sc1
    v_mul_f32 v224, v224, v14
    v_mfma_f32_16x16x32_bf16 v[246:249], v[102:105], a[136:139], v[246:249]
    v_mfma_f32_16x16x32_bf16 v[250:253], v[102:105], a[140:143], v[250:253]
    v_mul_f32 v225, v225, v15
    v_mfma_f32_16x16x32_bf16 v[238:241], v[106:109], a[144:147], v[238:241]
    v_cvt_pk_bf16_f32 v58, v222, v223
    global_load_lds_dwordx4 v4, s[92:93] offset:1024 sc1
    v_mfma_f32_16x16x32_bf16 v[242:245], v[106:109], a[148:151], v[242:245]
    v_cvt_pk_bf16_f32 v59, v224, v225
    v_mfma_f32_16x16x32_bf16 v[246:249], v[106:109], a[152:155], v[246:249]
    v_and_b32 v59, -2, v59
    v_mfma_f32_16x16x32_bf16 v[250:253], v[106:109], a[156:159], v[250:253]
    global_load_dwordx4 v[142:145], v6, s[38:39] offset:-4096 sc1
    s_nop 2
    ds_write_b128 v20, v[242:245] offset:0
    s_nop 0
    ds_write_b128 v21, v[246:249] offset:0
    global_load_dwordx4 v[146:149], v6, s[38:39] offset:-3072 sc1
    ds_write_b128 v22, v[250:253] offset:0
    s_waitcnt lgkmcnt(0)
    s_barrier
    global_load_dwordx4 v[150:153], v6, s[38:39] offset:-2048 sc1
    ds_read_b128 v[242:245], v23 offset:0
    ds_read_b128 v[246:249], v23 offset:1024
    global_load_dwordx4 v[154:157], v6, s[38:39] offset:-1024 sc1
    ds_read_b128 v[250:253], v23 offset:2048
    v_lshlrev_b32 v12, 16, v60
    v_and_b32 v13, 0xffff0000, v60
    global_load_dwordx4 v[158:161], v6, s[38:39] offset:0 sc1
    v_lshlrev_b32 v14, 16, v61
    v_and_b32 v15, 0xffff0000, v61
    global_load_dwordx4 v[162:165], v6, s[38:39] offset:1024 sc1
    s_waitcnt lgkmcnt(2)
    v_pk_add_f32 v[238:239], v[238:239], v[242:243] op_sel:[0,0] op_sel_hi:[1,1]
    v_pk_add_f32 v[240:241], v[240:241], v[244:245] op_sel:[0,0] op_sel_hi:[1,1]
    s_waitcnt lgkmcnt(1)
    v_pk_add_f32 v[238:239], v[238:239], v[246:247] op_sel:[0,0] op_sel_hi:[1,1]
    global_load_dwordx4 v[166:169], v6, s[38:39] offset:2048 sc1
    v_pk_add_f32 v[240:241], v[240:241], v[248:249] op_sel:[0,0] op_sel_hi:[1,1]
    s_waitcnt lgkmcnt(0)
    v_pk_add_f32 v[238:239], v[238:239], v[250:251] op_sel:[0,0] op_sel_hi:[1,1]
    global_load_dwordx4 v[170:173], v6, s[38:39] offset:3072 sc1
    v_pk_add_f32 v[240:241], v[240:241], v[252:253] op_sel:[0,0] op_sel_hi:[1,1]
    v_pk_mul_f32 v[238:239], v[238:239], v[12:13] op_sel:[0,0] op_sel_hi:[1,1]
    v_pk_mul_f32 v[240:241], v[240:241], v[14:15] op_sel:[0,0] op_sel_hi:[1,1]
    v_cvt_pk_bf16_f32 v60, v238, v239
    v_cvt_pk_bf16_f32 v61, v240, v241
    v_and_b32 v61, -2, v61
    global_store_dwordx4 v26, v[56:59], s[8:9] offset:-4096 sc1
    global_store_dwordx2 v27, v[60:61], s[10:11] offset:-4096 sc1
    v_add_u32 v30, 61440, v4
    v_add_u32 v31, 122880, v4
    global_load_dwordx4 v[174:177], v7, s[38:39] offset:-4096 sc1
    global_load_dwordx4 v[178:181], v7, s[38:39] offset:-3072 sc1
    global_load_dwordx4 v[182:185], v7, s[38:39] offset:-2048 sc1
    global_load_dwordx4 v[186:189], v7, s[38:39] offset:-1024 sc1
    global_load_dwordx4 v[190:193], v7, s[38:39] offset:0 sc1
    global_load_dwordx4 v[194:197], v7, s[38:39] offset:1024 sc1
    global_load_dwordx4 v[198:201], v7, s[38:39] offset:2048 sc1
    global_load_dwordx4 v[202:205], v7, s[38:39] offset:3072 sc1
    s_waitcnt vmcnt(18)
    s_barrier
    ds_read_b128 v[82:85], v4 offset:0
    ds_read_b128 v[86:89], v4 offset:1024
    ds_read_b128 v[90:93], v4 offset:2048
    ds_read_b128 v[94:97], v4 offset:3072
    ds_read_b128 v[98:101], v4 offset:4096
    s_waitcnt vmcnt(16)
    v_or_b32 v28, v145, v149
    s_waitcnt vmcnt(14)
    v_or3_b32 v28, v153, v157, v28
    s_waitcnt vmcnt(12)
    v_or3_b32 v28, v161, v165, v28
    s_waitcnt vmcnt(10)
    v_or3_b32 v28, v169, v173, v28
    v_and_b32 v28, 1, v28
    v_cmp_ne_u32 vcc, 0, v28
    s_nop 0
    s_cbranch_vccnz Lp0_r
Lp0_ok:
    s_waitcnt lgkmcnt(4)
    v_mfma_f32_16x16x32_bf16 v[62:65], v[82:85], v[142:145], 0
    ds_read_b128 v[102:105], v4 offset:20480
    s_waitcnt lgkmcnt(4)
    v_mfma_f32_16x16x32_bf16 v[66:69], v[86:89], v[142:145], 0
    ds_read_b128 v[82:85], v4 offset:21504
    s_waitcnt lgkmcnt(4)
    v_mfma_f32_16x16x32_bf16 v[70:73], v[90:93], v[142:145], 0
    ds_read_b128 v[86:89], v4 offset:22528
    s_waitcnt lgkmcnt(4)
    v_mfma_f32_16x16x32_bf16 v[74:77], v[94:97], v[142:145], 0
    ds_read_b128 v[90:93], v4 offset:23552
    s_waitcnt lgkmcnt(4)
    v_mfma_f32_16x16x32_bf16 v[78:81], v[98:101], v[142:145], 0
    ds_read_b128 v[94:97], v4 offset:24576
    s_waitcnt lgkmcnt(4)
    v_mfma_f32_16x16x32_bf16 v[62:65], v[102:105], v[146:149], v[62:65]
    ds_read_b128 v[98:101], v4 offset:35840
    s_waitcnt lgkmcnt(4)
    v_mfma_f32_16x16x32_bf16 v[66:69], v[82:85], v[146:149], v[66:69]
    ds_read_b128 v[102:105], v4 offset:36864
    s_waitcnt lgkmcnt(4)
    v_mfma_f32_16x16x32_bf16 v[70:73], v[86:89], v[146:149], v[70:73]
    ds_read_b128 v[82:85], v4 offset:37888
    s_waitcnt lgkmcnt(4)
    v_mfma_f32_16x16x32_bf16 v[74:77], v[90:93], v[146:149], v[74:77]
    ds_read_b128 v[86:89], v4 offset:38912
    s_waitcnt lgkmcnt(4)
    v_mfma_f32_16x16x32_bf16 v[78:81], v[94:97], v[146:149], v[78:81]
    ds_read_b128 v[90:93], v4 offset:39936
    s_waitcnt lgkmcnt(4)
    v_mfma_f32_16x16x32_bf16 v[62:65], v[98:101], v[150:153], v[62:65]
    ds_read_b128 v[94:97], v4 offset:56320
    s_waitcnt lgkmcnt(4)
    v_mfma_f32_16x16x32_bf16 v[66:69], v[102:105], v[150:153], v[66:69]
    ds_read_b128 v[98:101], v4 offset:57344
    s_waitcnt lgkmcnt(4)
    v_mfma_f32_16x16x32_bf16 v[70:73], v[82:85], v[150:153], v[70:73]
    ds_read_b128 v[102:105], v4 offset:58368
    s_waitcnt lgkmcnt(4)
    v_mfma_f32_16x16x32_bf16 v[74:77], v[86:89], v[150:153], v[74:77]
    ds_read_b128 v[82:85], v4 offset:59392
    s_waitcnt lgkmcnt(4)
    v_mfma_f32_16x16x32_bf16 v[78:81], v[90:93], v[150:153], v[78:81]
    ds_read_b128 v[86:89], v4 offset:60416
    s_waitcnt lgkmcnt(4)
    v_mfma_f32_16x16x32_bf16 v[62:65], v[94:97], v[154:157], v[62:65]
    ds_read_b128 v[90:93], v30 offset:10240
    s_waitcnt lgkmcnt(4)
    v_mfma_f32_16x16x32_bf16 v[66:69], v[98:101], v[154:157], v[66:69]
    ds_read_b128 v[94:97], v30 offset:11264
    s_waitcnt lgkmcnt(4)
    v_mfma_f32_16x16x32_bf16 v[70:73], v[102:105], v[154:157], v[70:73]
    ds_read_b128 v[98:101], v30 offset:12288
    s_waitcnt lgkmcnt(4)
    v_mfma_f32_16x16x32_bf16 v[74:77], v[82:85], v[154:157], v[74:77]
    ds_read_b128 v[102:105], v30 offset:13312
    s_waitcnt lgkmcnt(4)
    v_mfma_f32_16x16x32_bf16 v[78:81], v[86:89], v[154:157], v[78:81]
    ds_read_b128 v[82:85], v30 offset:14336
    s_waitcnt lgkmcnt(4)
    v_mfma_f32_16x16x32_bf16 v[62:65], v[90:93], v[158:161], v[62:65]
    ds_read_b128 v[86:89], v30 offset:30720
    s_waitcnt lgkmcnt(4)
    v_mfma_f32_16x16x32_bf16 v[66:69], v[94:97], v[158:161], v[66:69]
    ds_read_b128 v[90:93], v30 offset:31744
    s_waitcnt lgkmcnt(4)
    v_mfma_f32_16x16x32_bf16 v[70:73], v[98:101], v[158:161], v[70:73]
    ds_read_b128 v[94:97], v30 offset:32768
    s_waitcnt lgkmcnt(4)
    v_mfma_f32_16x16x32_bf16 v[74:77], v[102:105], v[158:161], v[74:77]
    ds_read_b128 v[98:101], v30 offset:33792
    s_waitcnt lgkmcnt(4)
    v_mfma_f32_16x16x32_bf16 v[78:81], v[82:85], v[158:161], v[78:81]
    ds_read_b128 v[102:105], v30 offset:34816
    s_waitcnt lgkmcnt(4)
    v_mfma_f32_16x16x32_bf16 v[62:65], v[86:89], v[162:165], v[62:65]
    ds_read_b128 v[82:85], v30 offset:46080
    s_waitcnt lgkmcnt(4)
    v_mfma_f32_16x16x32_bf16 v[66:69], v[90:93], v[162:165], v[66:69]
    ds_read_b128 v[86:89], v30 offset:47104
    s_waitcnt lgkmcnt(4)
    v_mfma_f32_16x16x32_bf16 v[70:73], v[94:97], v[162:165], v[70:73]
    ds_read_b128 v[90:93], v30 offset:48128
    s_waitcnt lgkmcnt(4)
    v_mfma_f32_16x16x32_bf16 v[74:77], v[98:101], v[162:165], v[74:77]
    ds_read_b128 v[94:97], v30 offset:49152
    s_waitcnt lgkmcnt(4)
    v_mfma_f32_16x16x32_bf16 v[78:81], v[102:105], v[162:165], v[78:81]
    ds_read_b128 v[98:101], v30 offset:50176
    s_waitcnt lgkmcnt(4)
    v_mfma_f32_16x16x32_bf16 v[62:65], v[82:85], v[166:169], v[62:65]
    ds_read_b128 v[102:105], v31 offset:5120
    s_waitcnt lgkmcnt(4)
    v_mfma_f32_16x16x32_bf16 v[66:69], v[86:89], v[166:169], v[66:69]
    ds_read_b128 v[82:85], v31 offset:6144
    s_waitcnt lgkmcnt(4)
    v_mfma_f32_16x16x32_bf16 v[70:73], v[90:93], v[166:169], v[70:73]
    ds_read_b128 v[86:89], v31 offset:7168
    s_waitcnt lgkmcnt(4)
    v_mfma_f32_16x16x32_bf16 v[74:77], v[94:97], v[166:169], v[74:77]
    ds_read_b128 v[90:93], v31 offset:8192
    s_waitcnt lgkmcnt(4)
    v_mfma_f32_16x16x32_bf16 v[78:81], v[98:101], v[166:169], v[78:81]
    ds_read_b128 v[94:97], v31 offset:9216
    s_waitcnt lgkmcnt(4)
    v_mfma_f32_16x16x32_bf16 v[62:65], v[102:105], v[170:173], v[62:65]
    ds_read_b128 v[98:101], v4 offset:5120
    s_waitcnt lgkmcnt(4)
    v_mfma_f32_16x16x32_bf16 v[66:69], v[82:85], v[170:173], v[66:69]
    ds_read_b128 v[102:105], v4 offset:6144
    s_waitcnt lgkmcnt(4)
    v_mfma_f32_16x16x32_bf16 v[70:73], v[86:89], v[170:173], v[70:73]
    ds_read_b128 v[82:85], v4 offset:7168
    s_waitcnt lgkmcnt(4)
    v_mfma_f32_16x16x32_bf16 v[74:77], v[90:93], v[170:173], v[74:77]
    ds_read_b128 v[86:89], v4 offset:8192
    s_waitcnt lgkmcnt(4)
    v_mfma_f32_16x16x32_bf16 v[78:81], v[94:97], v[170:173], v[78:81]
    ds_read_b128 v[90:93], v4 offset:9216
    s_waitcnt vmcnt(6)
    v_or_b32 v28, v177, v181
    s_waitcnt vmcnt(4)
    v_or3_b32 v28, v185, v189, v28
    s_waitcnt vmcnt(2)
    v_or3_b32 v28, v193, v197, v28
    s_waitcnt vmcnt(0)
    v_or3_b32 v28, v201, v205, v28
    v_and_b32 v28, 1, v28
    v_cmp_ne_u32 vcc, 0, v28
    s_nop 0
    s_cbranch_vccnz Lp1_r
Lp1_ok:
    s_waitcnt lgkmcnt(4)
    v_mfma_f32_16x16x32_bf16 v[62:65], v[98:101], v[174:177], v[62:65]
    ds_read_b128 v[94:97], v4 offset:25600
    s_waitcnt lgkmcnt(4)
    v_mfma_f32_16x16x32_bf16 v[66:69], v[102:105], v[174:177], v[66:69]
    ds_read_b128 v[98:101], v4 offset:26624
    s_waitcnt lgkmcnt(4)
    v_mfma_f32_16x16x32_bf16 v[70:73], v[82:85], v[174:177], v[70:73]
    ds_read_b128 v[102:105], v4 offset:27648
    s_waitcnt lgkmcnt(4)
    v_mfma_f32_16x16x32_bf16 v[74:77], v[86:89], v[174:177], v[74:77]
    ds_read_b128 v[82:85], v4 offset:28672
    s_waitcnt lgkmcnt(4)
    v_mfma_f32_16x16x32_bf16 v[78:81], v[90:93], v[174:177], v[78:81]
    ds_read_b128 v[86:89], v4 offset:29696
    s_waitcnt lgkmcnt(4)
    v_mfma_f32_16x16x32_bf16 v[62:65], v[94:97], v[178:181], v[62:65]
    ds_read_b128 v[90:93], v4 offset:40960
    s_waitcnt lgkmcnt(4)
    v_mfma_f32_16x16x32_bf16 v[66:69], v[98:101], v[178:181], v[66:69]
    ds_read_b128 v[94:97], v4 offset:41984
    s_waitcnt lgkmcnt(4)
    v_mfma_f32_16x16x32_bf16 v[70:73], v[102:105], v[178:181], v[70:73]
    ds_read_b128 v[98:101], v4 offset:43008
    s_waitcnt lgkmcnt(4)
    v_mfma_f32_16x16x32_bf16 v[74:77], v[82:85], v[178:181], v[74:77]
    ds_read_b128 v[102:105], v4 offset:44032
    s_waitcnt lgkmcnt(4)
    v_mfma_f32_16x16x32_bf16 v[78:81], v[86:89], v[178:181], v[78:81]
    ds_read_b128 v[82:85], v4 offset:45056
    s_waitcnt lgkmcnt(4)
    v_mfma_f32_16x16x32_bf16 v[62:65], v[90:93], v[182:185], v[62:65]
    ds_read_b128 v[86:89], v30 offset:0
    global_load_dwordx4 v[206:209], v26, s[38:39] offset:-4096 sc1
    s_waitcnt lgkmcnt(4)
    v_mfma_f32_16x16x32_bf16 v[66:69], v[94:97], v[182:185], v[66:69]
    ds_read_b128 v[90:93], v30 offset:1024
    s_waitcnt lgkmcnt(4)
    v_mfma_f32_16x16x32_bf16 v[70:73], v[98:101], v[182:185], v[70:73]
    ds_read_b128 v[94:97], v30 offset:2048
    global_load_dwordx4 v[210:213], v26, s[38:39] offset:-3072 sc1
    s_waitcnt lgkmcnt(4)
    v_mfma_f32_16x16x32_bf16 v[74:77], v[102:105], v[182:185], v[74:77]
    ds_read_b128 v[98:101], v30 offset:3072
    s_waitcnt lgkmcnt(4)
    v_mfma_f32_16x16x32_bf16 v[78:81], v[82:85], v[182:185], v[78:81]
    ds_read_b128 v[102:105], v30 offset:4096
    s_waitcnt lgkmcnt(4)
    v_mfma_f32_16x16x32_bf16 v[62:65], v[86:89], v[186:189], v[62:65]
    ds_read_b128 v[82:85], v30 offset:15360
    global_load_dwordx4 v[214:217], v26, s[38:39] offset:-2048 sc1
    s_waitcnt lgkmcnt(4)
    v_mfma_f32_16x16x32_bf16 v[66:69], v[90:93], v[186:189], v[66:69]
    ds_read_b128 v[86:89], v30 offset:16384
    s_waitcnt lgkmcnt(4)
    v_mfma_f32_16x16x32_bf16 v[70:73], v[94:97], v[186:189], v[70:73]
    ds_read_b128 v[90:93], v30 offset:17408
    s_waitcnt lgkmcnt(4)
    v_mfma_f32_16x16x32_bf16 v[74:77], v[98:101], v[186:189], v[74:77]
    ds_read_b128 v[94:97], v30 offset:18432
    global_load_dwordx4 v[218:221], v26, s[38:39] offset:-1024 sc1
    s_waitcnt lgkmcnt(4)
    v_mfma_f32_16x16x32_bf16 v[78:81], v[102:105], v[186:189], v[78:81]
    ds_read_b128 v[98:101], v30 offset:19456
    s_waitcnt lgkmcnt(4)
    v_mfma_f32_16x16x32_bf16 v[62:65], v[82:85], v[190:193], v[62:65]
    ds_read_b128 v[102:105], v30 offset:35840
    global_load_dwordx4 v[222:225], v26, s[38:39] offset:0 sc1
    s_waitcnt lgkmcnt(4)
    v_mfma_f32_16x16x32_bf16 v[66:69], v[86:89], v[190:193], v[66:69]
    ds_read_b128 v[82:85], v30 offset:36864
    s_waitcnt lgkmcnt(4)
    v_mfma_f32_16x16x32_bf16 v[70:73], v[90:93], v[190:193], v[70:73]
    ds_read_b128 v[86:89], v30 offset:37888
    s_waitcnt lgkmcnt(4)
    v_mfma_f32_16x16x32_bf16 v[74:77], v[94:97], v[190:193], v[74:77]
    ds_read_b128 v[90:93], v30 offset:38912
    global_load_dwordx4 v[226:229], v26, s[38:39] offset:1024 sc1
    s_waitcnt lgkmcnt(4)
    v_mfma_f32_16x16x32_bf16 v[78:81], v[98:101], v[190:193], v[78:81]
    ds_read_b128 v[94:97], v30 offset:39936
    s_waitcnt lgkmcnt(4)
    v_mfma_f32_16x16x32_bf16 v[62:65], v[102:105], v[194:197], v[62:65]
    ds_read_b128 v[98:101], v30 offset:51200
    s_waitcnt lgkmcnt(4)
    v_mfma_f32_16x16x32_bf16 v[66:69], v[82:85], v[194:197], v[66:69]
    ds_read_b128 v[102:105], v30 offset:52224
    global_load_dwordx4 v[230:233], v26, s[38:39] offset:2048 sc1
    s_waitcnt lgkmcnt(4)
    v_mfma_f32_16x16x32_bf16 v[70:73], v[86:89], v[194:197], v[70:73]
    ds_read_b128 v[82:85], v30 offset:53248
    s_waitcnt lgkmcnt(4)
    v_mfma_f32_16x16x32_bf16 v[74:77], v[90:93], v[194:197], v[74:77]
    ds_read_b128 v[86:89], v30 offset:54272
    s_waitcnt lgkmcnt(4)
    v_mfma_f32_16x16x32_bf16 v[78:81], v[94:97], v[194:197], v[78:81]
    ds_read_b128 v[90:93], v30 offset:55296
    global_load_dwordx4 v[238:241], v27, s[38:39] offset:-4096 sc1
    s_waitcnt lgkmcnt(4)
    v_mfma_f32_16x16x32_bf16 v[62:65], v[98:101], v[198:201], v[62:65]
    ds_read_b128 v[94:97], v31 offset:10240
    s_waitcnt lgkmcnt(4)
    v_mfma_f32_16x16x32_bf16 v[66:69], v[102:105], v[198:201], v[66:69]
    ds_read_b128 v[98:101], v31 offset:11264
    global_load_dwordx4 v[242:245], v27, s[38:39] offset:-3072 sc1
    s_waitcnt lgkmcnt(4)
    v_mfma_f32_16x16x32_bf16 v[70:73], v[82:85], v[198:201], v[70:73]
    ds_read_b128 v[102:105], v31 offset:12288
    s_waitcnt lgkmcnt(4)
    v_mfma_f32_16x16x32_bf16 v[74:77], v[86:89], v[198:201], v[74:77]
    ds_read_b128 v[82:85], v31 offset:13312
    s_waitcnt lgkmcnt(4)
    v_mfma_f32_16x16x32_bf16 v[78:81], v[90:93], v[198:201], v[78:81]
    ds_read_b128 v[86:89], v31 offset:14336
    global_load_dwordx4 v[246:249], v27, s[38:39] offset:-2048 sc1
    s_waitcnt lgkmcnt(4)
    v_mfma_f32_16x16x32_bf16 v[62:65], v[94:97], v[202:205], v[62:65]
    ds_read_b128 v[90:93], v4 offset:10240
    s_waitcnt lgkmcnt(4)
    v_mfma_f32_16x16x32_bf16 v[66:69], v[98:101], v[202:205], v[66:69]
    ds_read_b128 v[94:97], v4 offset:11264
    s_waitcnt lgkmcnt(4)
    v_mfma_f32_16x16x32_bf16 v[70:73], v[102:105], v[202:205], v[70:73]
    ds_read_b128 v[98:101], v4 offset:12288
    global_load_dwordx4 v[250:253], v27, s[38:39] offset:-1024 sc1
    s_waitcnt lgkmcnt(4)
    v_mfma_f32_16x16x32_bf16 v[74:77], v[82:85], v[202:205], v[74:77]
    ds_read_b128 v[102:105], v4 offset:13312
    s_waitcnt lgkmcnt(4)
    v_mfma_f32_16x16x32_bf16 v[78:81], v[86:89], v[202:205], v[78:81]
    ds_read_b128 v[82:85], v4 offset:14336
    v_lshlrev_b32 v29, 5, v3
    v_add_u32 v29, 162816, v29
    ds_read_b128 v[106:109], v29 offset:0
    ds_read_b128 v[110:113], v29 offset:16
    ds_read_b128 v[114:117], v29 offset:128
    ds_read_b128 v[118:121], v29 offset:144
    v_lshlrev_b32 v29, 4, v3
    v_add_u32 v29, 162816, v29
    ds_read_b128 v[122:125], v29 offset:256
    v_lshlrev_b32 v126, 16, v36
    v_and_b32 v127, 0xffff0000, v36
    v_lshlrev_b32 v128, 16, v37
    v_and_b32 v129, 0xffff0000, v37
    v_lshlrev_b32 v130, 16, v38
    v_and_b32 v131, 0xffff0000, v38
    v_lshlrev_b32 v132, 16, v39
    v_and_b32 v133, 0xffff0000, v39
    v_lshlrev_b32 v134, 16, v40
    v_and_b32 v135, 0xffff0000, v40
    v_lshlrev_b32 v136, 16, v41
    v_and_b32 v137, 0xffff0000, v41
    v_lshlrev_b32 v138, 16, v42
    v_and_b32 v139, 0xffff0000, v42
    v_lshlrev_b32 v140, 16, v43
    v_and_b32 v141, 0xffff0000, v43
    v_lshlrev_b32 v12, 16, v44
    v_and_b32 v13, 0xffff0000, v44
    v_lshlrev_b32 v14, 16, v45
    v_and_b32 v15, 0xffff0000, v45
    v_add_u32 v46, s90, v5
    v_mul_u32_u24 v46, 1280, v46
    s_mul_i32 s4, s41, 160
    v_add_u32 v46, s4, v46
    v_lshl_add_u32 v47, v3, 4, v46
    v_lshl_add_u32 v46, v3, 3, v46
    s_waitcnt vmcnt(8)
    v_or3_b32 v28, v209, v213, v217
    s_waitcnt vmcnt(6)
    v_or3_b32 v28, v221, v225, v28
    s_waitcnt vmcnt(4)
    v_or3_b32 v28, v229, v233, v28
    v_and_b32 v28, 1, v28
    v_cmp_ne_u32 vcc, 0, v28
    s_nop 0
    s_cbranch_vccnz Lp2_r
Lp2_ok:
    s_waitcnt lgkmcnt(9)
    v_mfma_f32_16x16x32_bf16 v[62:65], v[90:93], v[206:209], v[62:65]
    ds_read_b128 v[86:89], v4 offset:30720
    s_waitcnt lgkmcnt(9)
    v_mfma_f32_16x16x32_bf16 v[66:69], v[94:97], v[206:209], v[66:69]
    ds_read_b128 v[90:93], v4 offset:31744
    s_waitcnt lgkmcnt(9)
    v_mfma_f32_16x16x32_bf16 v[70:73], v[98:101], v[206:209], v[70:73]
    ds_read_b128 v[94:97], v4 offset:32768
    s_waitcnt lgkmcnt(9)
    v_mfma_f32_16x16x32_bf16 v[74:77], v[102:105], v[206:209], v[74:77]
    ds_read_b128 v[98:101], v4 offset:33792
    s_waitcnt lgkmcnt(9)
    v_mfma_f32_16x16x32_bf16 v[78:81], v[82:85], v[206:209], v[78:81]
    ds_read_b128 v[102:105], v4 offset:34816
    s_waitcnt lgkmcnt(4)
    v_mfma_f32_16x16x32_bf16 v[62:65], v[86:89], v[210:213], v[62:65]
    ds_read_b128 v[82:85], v4 offset:46080
    s_waitcnt lgkmcnt(4)
    v_mfma_f32_16x16x32_bf16 v[66:69], v[90:93], v[210:213], v[66:69]
    ds_read_b128 v[86:89], v4 offset:47104
    s_waitcnt lgkmcnt(4)
    v_mfma_f32_16x16x32_bf16 v[70:73], v[94:97], v[210:213], v[70:73]
    ds_read_b128 v[90:93], v4 offset:48128
    s_waitcnt lgkmcnt(4)
    v_mfma_f32_16x16x32_bf16 v[74:77], v[98:101], v[210:213], v[74:77]
    ds_read_b128 v[94:97], v4 offset:49152
    s_waitcnt lgkmcnt(4)
    v_mfma_f32_16x16x32_bf16 v[78:81], v[102:105], v[210:213], v[78:81]
    ds_read_b128 v[98:101], v4 offset:50176
    s_waitcnt lgkmcnt(4)
    v_mfma_f32_16x16x32_bf16 v[62:65], v[82:85], v[214:217], v[62:65]
    ds_read_b128 v[102:105], v30 offset:5120
    s_waitcnt lgkmcnt(4)
    v_mfma_f32_16x16x32_bf16 v[66:69], v[86:89], v[214:217], v[66:69]
    ds_read_b128 v[82:85], v30 offset:6144
    s_waitcnt lgkmcnt(4)
    v_mfma_f32_16x16x32_bf16 v[70:73], v[90:93], v[214:217], v[70:73]
    ds_read_b128 v[86:89], v30 offset:7168
    s_waitcnt lgkmcnt(4)
    v_mfma_f32_16x16x32_bf16 v[74:77], v[94:97], v[214:217], v[74:77]
    ds_read_b128 v[90:93], v30 offset:8192
    s_waitcnt lgkmcnt(4)
    v_mfma_f32_16x16x32_bf16 v[78:81], v[98:101], v[214:217], v[78:81]
    ds_read_b128 v[94:97], v30 offset:9216
    s_waitcnt lgkmcnt(4)
    v_mfma_f32_16x16x32_bf16 v[62:65], v[102:105], v[218:221], v[62:65]
    ds_read_b128 v[98:101], v30 offset:20480
    s_waitcnt lgkmcnt(4)
    v_mfma_f32_16x16x32_bf16 v[66:69], v[82:85], v[218:221], v[66:69]
    ds_read_b128 v[102:105], v30 offset:21504
    s_waitcnt lgkmcnt(4)
    v_mfma_f32_16x16x32_bf16 v[70:73], v[86:89], v[218:221], v[70:73]
    ds_read_b128 v[82:85], v30 offset:22528
    s_waitcnt lgkmcnt(4)
    v_mfma_f32_16x16x32_bf16 v[74:77], v[90:93], v[218:221], v[74:77]
    ds_read_b128 v[86:89], v30 offset:23552
    s_waitcnt lgkmcnt(4)
    v_mfma_f32_16x16x32_bf16 v[78:81], v[94:97], v[218:221], v[78:81]
    ds_read_b128 v[90:93], v30 offset:24576
    s_waitcnt lgkmcnt(4)
    v_mfma_f32_16x16x32_bf16 v[62:65], v[98:101], v[222:225], v[62:65]
    ds_read_b128 v[94:97], v30 offset:40960
    s_waitcnt lgkmcnt(4)
    v_mfma_f32_16x16x32_bf16 v[66:69], v[102:105], v[222:225], v[66:69]
    ds_read_b128 v[98:101], v30 offset:41984
    s_waitcnt lgkmcnt(4)
    v_mfma_f32_16x16x32_bf16 v[70:73], v[82:85], v[222:225], v[70:73]
    ds_read_b128 v[102:105], v30 offset:43008
    s_waitcnt lgkmcnt(4)
    v_mfma_f32_16x16x32_bf16 v[74:77], v[86:89], v[222:225], v[74:77]
    ds_read_b128 v[82:85], v30 offset:44032
    s_waitcnt lgkmcnt(4)
    v_mfma_f32_16x16x32_bf16 v[78:81], v[90:93], v[222:225], v[78:81]
    ds_read_b128 v[86:89], v30 offset:45056
    s_waitcnt lgkmcnt(4)
    v_mfma_f32_16x16x32_bf16 v[62:65], v[94:97], v[226:229], v[62:65]
    ds_read_b128 v[90:93], v30 offset:56320
    s_waitcnt lgkmcnt(4)
    v_mfma_f32_16x16x32_bf16 v[66:69], v[98:101], v[226:229], v[66:69]
    ds_read_b128 v[94:97], v30 offset:57344
    s_waitcnt lgkmcnt(4)
    v_mfma_f32_16x16x32_bf16 v[70:73], v[102:105], v[226:229], v[70:73]
    ds_read_b128 v[98:101], v30 offset:58368
    s_waitcnt lgkmcnt(4)
    v_mfma_f32_16x16x32_bf16 v[74:77], v[82:85], v[226:229], v[74:77]
    ds_read_b128 v[102:105], v30 offset:59392
    s_waitcnt lgkmcnt(4)
    v_mfma_f32_16x16x32_bf16 v[78:81], v[86:89], v[226:229], v[78:81]
    ds_read_b128 v[82:85], v30 offset:60416
    s_waitcnt lgkmcnt(4)
    v_mfma_f32_16x16x32_bf16 v[62:65], v[90:93], v[230:233], v[62:65]
    ds_read_b128 v[86:89], v4 offset:15360
    s_waitcnt lgkmcnt(4)
    v_mfma_f32_16x16x32_bf16 v[66:69], v[94:97], v[230:233], v[66:69]
    ds_read_b128 v[90:93], v4 offset:16384
    s_waitcnt lgkmcnt(4)
    v_mfma_f32_16x16x32_bf16 v[70:73], v[98:101], v[230:233], v[70:73]
    ds_read_b128 v[94:97], v4 offset:17408
    s_waitcnt lgkmcnt(4)
    v_mfma_f32_16x16x32_bf16 v[74:77], v[102:105], v[230:233], v[74:77]
    ds_read_b128 v[98:101], v4 offset:18432
    s_waitcnt lgkmcnt(4)
    v_mfma_f32_16x16x32_bf16 v[78:81], v[82:85], v[230:233], v[78:81]
    ds_read_b128 v[102:105], v4 offset:19456
    s_waitcnt vmcnt(3)
    v_or_b32 v28, v239, v241
    s_waitcnt vmcnt(2)
    v_or3_b32 v28, v243, v245, v28
    s_waitcnt vmcnt(1)
    v_or3_b32 v28, v247, v249, v28
    s_waitcnt vmcnt(0)
    v_or3_b32 v28, v251, v253, v28
    v_and_b32 v28, 1, v28
    v_cmp_ne_u32 vcc, 0, v28
    s_nop 0
    s_cbranch_vccnz Lp3_r
Lp3_ok:
    s_waitcnt lgkmcnt(4)
    v_mfma_f32_16x16x32_bf16 v[62:65], v[86:89], v[238:241], v[62:65]
    ds_read_b128 v[82:85], v4 offset:51200
    s_waitcnt lgkmcnt(4)
    v_mfma_f32_16x16x32_bf16 v[66:69], v[90:93], v[238:241], v[66:69]
    ds_read_b128 v[86:89], v4 offset:52224
    s_waitcnt lgkmcnt(4)
    v_mfma_f32_16x16x32_bf16 v[70:73], v[94:97], v[238:241], v[70:73]
    ds_read_b128 v[90:93], v4 offset:53248
    s_waitcnt lgkmcnt(4)
    v_mfma_f32_16x16x32_bf16 v[74:77], v[98:101], v[238:241], v[74:77]
    ds_read_b128 v[94:97], v4 offset:54272
    s_waitcnt lgkmcnt(4)
    v_mfma_f32_16x16x32_bf16 v[78:81], v[102:105], v[238:241], v[78:81]
    ds_read_b128 v[98:101], v4 offset:55296
    s_waitcnt lgkmcnt(4)
    v_mfma_f32_16x16x32_bf16 v[62:65], v[82:85], v[242:245], v[62:65]
    ds_read_b128 v[102:105], v30 offset:25600
    s_waitcnt lgkmcnt(4)
    v_mfma_f32_16x16x32_bf16 v[66:69], v[86:89], v[242:245], v[66:69]
    ds_read_b128 v[82:85], v30 offset:26624
    s_waitcnt lgkmcnt(4)
    v_mfma_f32_16x16x32_bf16 v[70:73], v[90:93], v[242:245], v[70:73]
    ds_read_b128 v[86:89], v30 offset:27648
    s_waitcnt lgkmcnt(4)
    v_mfma_f32_16x16x32_bf16 v[74:77], v[94:97], v[242:245], v[74:77]
    ds_read_b128 v[90:93], v30 offset:28672
    s_waitcnt lgkmcnt(4)
    v_mfma_f32_16x16x32_bf16 v[78:81], v[98:101], v[242:245], v[78:81]
    ds_read_b128 v[94:97], v30 offset:29696
    s_waitcnt lgkmcnt(4)
    v_mfma_f32_16x16x32_bf16 v[62:65], v[102:105], v[246:249], v[62:65]
    ds_read_b128 v[98:101], v31 offset:0
    s_waitcnt lgkmcnt(4)
    v_mfma_f32_16x16x32_bf16 v[66:69], v[82:85], v[246:249], v[66:69]
    ds_read_b128 v[102:105], v31 offset:1024
    s_waitcnt lgkmcnt(4)
    v_mfma_f32_16x16x32_bf16 v[70:73], v[86:89], v[246:249], v[70:73]
    ds_read_b128 v[82:85], v31 offset:2048
    s_waitcnt lgkmcnt(4)
    v_mfma_f32_16x16x32_bf16 v[74:77], v[90:93], v[246:249], v[74:77]
    ds_read_b128 v[86:89], v31 offset:3072
    s_waitcnt lgkmcnt(4)
    v_mfma_f32_16x16x32_bf16 v[78:81], v[94:97], v[246:249], v[78:81]
    ds_read_b128 v[90:93], v31 offset:4096
    s_waitcnt lgkmcnt(4)
    v_mfma_f32_16x16x32_bf16 v[62:65], v[98:101], v[250:253], v[62:65]
    s_waitcnt lgkmcnt(3)
    v_mfma_f32_16x16x32_bf16 v[66:69], v[102:105], v[250:253], v[66:69]
    s_waitcnt lgkmcnt(2)
    v_mfma_f32_16x16x32_bf16 v[70:73], v[82:85], v[250:253], v[70:73]
    s_waitcnt lgkmcnt(1)
    v_mfma_f32_16x16x32_bf16 v[74:77], v[86:89], v[250:253], v[74:77]
    s_waitcnt lgkmcnt(0)
    v_mfma_f32_16x16x32_bf16 v[78:81], v[90:93], v[250:253], v[78:81]
    v_fmac_f32 v126, v62, v106
    s_nop 0
    v_fmac_f32 v127, v66, v107
    v_fmac_f32 v128, v63, v108
    v_fmac_f32 v129, v67, v109
    v_fmac_f32 v130, v64, v110
    v_fmac_f32 v131, v68, v111
    v_fmac_f32 v132, v65, v112
    v_fmac_f32 v133, v69, v113
    v_cvt_pk_bf16_f32 v142, v126, v127
    v_cvt_pk_bf16_f32 v143, v128, v129
    v_cvt_pk_bf16_f32 v144, v130, v131
    v_cvt_pk_bf16_f32 v145, v132, v133
    global_store_dwordx4 v47, v[142:145], s[34:35] offset:0
    v_fmac_f32 v134, v70, v114
    v_fmac_f32 v135, v74, v115
    v_fmac_f32 v136, v71, v116
    v_fmac_f32 v137, v75, v117
    v_fmac_f32 v138, v72, v118
    v_fmac_f32 v139, v76, v119
    v_fmac_f32 v140, v73, v120
    v_fmac_f32 v141, v77, v121
    v_cvt_pk_bf16_f32 v146, v134, v135
    v_cvt_pk_bf16_f32 v147, v136, v137
    v_cvt_pk_bf16_f32 v148, v138, v139
    v_cvt_pk_bf16_f32 v149, v140, v141
    global_store_dwordx4 v47, v[146:149], s[34:35] offset:64
    v_fmac_f32 v12, v78, v122
    v_fmac_f32 v13, v79, v123
    v_fmac_f32 v14, v80, v124
    v_fmac_f32 v15, v81, v125
    v_cvt_pk_bf16_f32 v150, v12, v13
    v_cvt_pk_bf16_f32 v151, v14, v15
    global_store_dwordx2 v46, v[150:151], s[34:35] offset:128
Lflush:
Lend:
    s_endpgm
Lspare:
    s_sub_u32 s42, s2, 160
    s_cmp_lt_u32 s42, 54
    s_cbranch_scc0 Lsp_b
    s_cmp_ge_u32 s42, 8
    s_cbranch_scc1 Lsp_a2
    s_mov_b32 s48, s42
    v_mov_b32 v8, -1
    v_mov_b32 v9, -1
    v_mov_b32 v10, -1
    v_mov_b32 v11, -1
    s_mul_i32 s4, s48, 9216
    s_mul_i32 s5, s3, 2304
    s_add_u32 s4, s4, s5
    s_add_u32 s4, s4, 32768
    v_add_u32 v6, s4, v4
    global_store_dwordx4 v6, v[8:11], s[38:39] offset:0 sc1
    global_store_dwordx4 v6, v[8:11], s[38:39] offset:1024 sc1
    global_store_dwordx4 v6, v[8:11], s[38:39] offset:1280 sc1
    s_lshl_b32 s4, s48, 2
    v_mov_b32 v6, s4
    s_waitcnt vmcnt(0)
    s_barrier
    s_cmp_lg_u32 s3, 0
    s_cbranch_scc1 Linit_skip
    global_store_dword v6, v8, s[36:37] sc1
Linit_skip:
    s_branch Lsp_a2
Lsp_b:
    s_sub_u32 s48, s42, 54
    s_add_u32 s49, s48, 42
    s_add_u32 s50, s48, 84
    s_cmp_ge_u32 s50, 120
    s_cselect_b32 s50, s49, s50
    s_cmp_eq_u32 s3, 1
    s_cselect_b32 s51, s49, s48
    s_cmp_eq_u32 s3, 2
    s_cselect_b32 s51, s50, s51
    s_lshr_b32 s4, s51, 1
    s_and_b32 s5, s51, 1
    s_cmp_lt_u32 s4, 50
    s_cselect_b32 s6, -20, 0
    s_cmp_lt_u32 s4, 20
    s_cselect_b32 s6, 30, s6
    s_add_u32 s4, s4, s6
    s_mul_i32 s6, s5, 15360
    s_lshl_b32 s7, s4, 8
    s_add_u32 s51, s6, s7
    v_lshl_add_u32 v164, v1, 2, s51
    v_mov_b32 v165, -1
    global_store_dword v164, v165, s[38:39] offset:0 sc1
    s_lshr_b32 s4, s48, 1
    s_and_b32 s5, s48, 1
    s_cmp_lt_u32 s4, 50
    s_cselect_b32 s6, -20, 0
    s_cmp_lt_u32 s4, 20
    s_cselect_b32 s6, 30, s6
    s_add_u32 s4, s4, s6
    s_mul_i32 s6, s5, 15360
    s_lshl_b32 s7, s4, 8
    s_add_u32 s44, s6, s7
    s_lshl_b32 s5, s5, 2
    s_add_u32 s5, s5, s3
    s_mul_i32 s5, s5, 80
    s_lshl_b32 s4, s4, 7
    s_mul_i32 s6, s5, 7680
    s_add_u32 s4, s4, s6
    v_min_u32 v28, 39, v1
    s_lshl_b32 s5, s5, 1
    v_lshl_add_u32 v28, v28, 2, s5
    global_load_dword v80, v28, s[30:31]
    v_lshrrev_b32 v29, 3, v1
    v_mul_u32_u24 v28, 15232, v29
    v_add3_u32 v28, v28, v4, s4
    global_load_dwordx4 v[40:43], v28, s[32:33] nt
    v_add_u32 v28, 7680, v28
    global_load_dwordx4 v[44:47], v28, s[32:33] nt
    v_add_u32 v28, 115200, v28
    global_load_dwordx4 v[48:51], v28, s[32:33] nt
    v_add_u32 v28, 7680, v28
    global_load_dwordx4 v[52:55], v28, s[32:33] nt
    v_add_u32 v28, 115200, v28
    global_load_dwordx4 v[56:59], v28, s[32:33] nt
    v_add_u32 v28, 7680, v28
    global_load_dwordx4 v[60:63], v28, s[32:33] nt
    v_add_u32 v28, 115200, v28
    global_load_dwordx4 v[64:67], v28, s[32:33] nt
    v_add_u32 v28, 7680, v28
    global_load_dwordx4 v[68:71], v28, s[32:33] nt
    v_add_u32 v28, 115200, v28
    global_load_dwordx4 v[72:75], v28, s[32:33] nt
    v_add_u32 v28, 7680, v28
    global_load_dwordx4 v[76:79], v28, s[32:33] nt
    s_lshl_b32 s4, s48, 2
    s_add_u32 s4, s4, 60
    v_mov_b32 v164, s4
    s_waitcnt vmcnt(10)
    s_barrier
    s_cmp_lg_u32 s3, 0
    s_cbranch_scc1 Lsb_skip
    global_store_dword v164, v165, s[36:37] sc1
    s_branch Lsb_skip2
Lsb_skip:
    global_load_dword v165, v164, s[30:31]
Lsb_skip2:
    s_lshr_b32 s4, s49, 1
    s_and_b32 s5, s49, 1
    s_cmp_lt_u32 s4, 50
    s_cselect_b32 s6, -20, 0
    s_cmp_lt_u32 s4, 20
    s_cselect_b32 s6, 30, s6
    s_add_u32 s4, s4, s6
    s_mul_i32 s6, s5, 15360
    s_lshl_b32 s7, s4, 8
    s_add_u32 s45, s6, s7
    s_lshl_b32 s5, s5, 2
    s_add_u32 s5, s5, s3
    s_mul_i32 s5, s5, 80
    s_lshl_b32 s4, s4, 7
    s_mul_i32 s6, s5, 7680
    s_add_u32 s4, s4, s6
    v_min_u32 v96, 39, v1
    s_lshl_b32 s5, s5, 1
    v_lshl_add_u32 v96, v96, 2, s5
    global_load_dword v148, v96, s[30:31]
    v_lshrrev_b32 v97, 3, v1
    v_mul_u32_u24 v96, 15232, v97
    v_add3_u32 v96, v96, v4, s4
    global_load_dwordx4 v[108:111], v96, s[32:33] nt
    v_add_u32 v96, 7680, v96
    global_load_dwordx4 v[112:115], v96, s[32:33] nt
    v_add_u32 v96, 115200, v96
    global_load_dwordx4 v[116:119], v96, s[32:33] nt
    v_add_u32 v96, 7680, v96
    global_load_dwordx4 v[120:123], v96, s[32:33] nt
    v_add_u32 v96, 115200, v96
    global_load_dwordx4 v[124:127], v96, s[32:33] nt
    v_add_u32 v96, 7680, v96
    global_load_dwordx4 v[128:131], v96, s[32:33] nt
    v_add_u32 v96, 115200, v96
    global_load_dwordx4 v[132:135], v96, s[32:33] nt
    v_add_u32 v96, 7680, v96
    global_load_dwordx4 v[136:139], v96, s[32:33] nt
    v_add_u32 v96, 115200, v96
    global_load_dwordx4 v[140:143], v96, s[32:33] nt
    v_add_u32 v96, 7680, v96
    v_lshlrev_b32 v82, 16, v80
    v_and_b32 v83, 0xffff0000, v80
    v_lshlrev_b32 v29, 2, v29
    v_mul_f32 v84, 0xbfb8aa3b, v82
    v_mul_f32 v85, 0xbfb8aa3b, v83
    v_exp_f32 v84, v84
    v_exp_f32 v85, v85
    v_add_f32 v84, 1.0, v84
    v_add_f32 v85, 1.0, v85
    v_rcp_f32 v84, v84
    v_rcp_f32 v85, v85
    v_mul_f32 v82, v82, v84
    v_mul_f32 v83, v83, v85
    v_cvt_pk_bf16_f32 v80, v82, v83
    ds_bpermute_b32 v88, v29, v80 offset:0
    ds_bpermute_b32 v89, v29, v80 offset:32
    ds_bpermute_b32 v90, v29, v80 offset:64
    ds_bpermute_b32 v91, v29, v80 offset:96
    ds_bpermute_b32 v92, v29, v80 offset:128
    s_waitcnt lgkmcnt(4)
    v_lshlrev_b32 v30, 16, v88
    v_and_b32 v31, 0xffff0000, v88
    s_waitcnt lgkmcnt(3)
    v_lshlrev_b32 v32, 16, v89
    v_and_b32 v33, 0xffff0000, v89
    s_waitcnt lgkmcnt(2)
    v_lshlrev_b32 v34, 16, v90
    v_and_b32 v35, 0xffff0000, v90
    s_waitcnt lgkmcnt(1)
    v_lshlrev_b32 v36, 16, v91
    v_and_b32 v37, 0xffff0000, v91
    s_waitcnt lgkmcnt(0)
    v_lshlrev_b32 v38, 16, v92
    v_and_b32 v39, 0xffff0000, v92
    s_waitcnt vmcnt(20)
    v_lshlrev_b32 v80, 16, v40
    v_and_b32 v81, 0xffff0000, v40
    v_lshlrev_b32 v82, 16, v41
    v_and_b32 v83, 0xffff0000, v41
    v_lshlrev_b32 v84, 16, v42
    v_and_b32 v85, 0xffff0000, v42
    v_lshlrev_b32 v86, 16, v43
    v_and_b32 v87, 0xffff0000, v43
    v_pk_mul_f32 v[88:89], v[30:31], v[80:81] op_sel:[0,0] op_sel_hi:[0,1]
    v_pk_mul_f32 v[90:91], v[30:31], v[82:83] op_sel:[0,0] op_sel_hi:[0,1]
    v_pk_mul_f32 v[92:93], v[30:31], v[84:85] op_sel:[0,0] op_sel_hi:[0,1]
    v_pk_mul_f32 v[94:95], v[30:31], v[86:87] op_sel:[0,0] op_sel_hi:[0,1]
    s_waitcnt vmcnt(19)
    v_lshlrev_b32 v80, 16, v44
    v_and_b32 v81, 0xffff0000, v44
    v_lshlrev_b32 v82, 16, v45
    v_and_b32 v83, 0xffff0000, v45
    v_lshlrev_b32 v84, 16, v46
    v_and_b32 v85, 0xffff0000, v46
    v_lshlrev_b32 v86, 16, v47
    v_and_b32 v87, 0xffff0000, v47
    v_pk_fma_f32 v[88:89], v[30:31], v[80:81], v[88:89] op_sel:[1,0,0] op_sel_hi:[1,1,1]
    v_pk_fma_f32 v[90:91], v[30:31], v[82:83], v[90:91] op_sel:[1,0,0] op_sel_hi:[1,1,1]
    v_pk_fma_f32 v[92:93], v[30:31], v[84:85], v[92:93] op_sel:[1,0,0] op_sel_hi:[1,1,1]
    v_pk_fma_f32 v[94:95], v[30:31], v[86:87], v[94:95] op_sel:[1,0,0] op_sel_hi:[1,1,1]
    s_waitcnt vmcnt(18)
    v_lshlrev_b32 v80, 16, v48
    v_and_b32 v81, 0xffff0000, v48
    v_lshlrev_b32 v82, 16, v49
    v_and_b32 v83, 0xffff0000, v49
    v_lshlrev_b32 v84, 16, v50
    v_and_b32 v85, 0xffff0000, v50
    v_lshlrev_b32 v86, 16, v51
    v_and_b32 v87, 0xffff0000, v51
    v_pk_fma_f32 v[88:89], v[32:33], v[80:81], v[88:89] op_sel:[0,0,0] op_sel_hi:[0,1,1]
    v_pk_fma_f32 v[90:91], v[32:33], v[82:83], v[90:91] op_sel:[0,0,0] op_sel_hi:[0,1,1]
    v_pk_fma_f32 v[92:93], v[32:33], v[84:85], v[92:93] op_sel:[0,0,0] op_sel_hi:[0,1,1]
    v_pk_fma_f32 v[94:95], v[32:33], v[86:87], v[94:95] op_sel:[0,0,0] op_sel_hi:[0,1,1]
    s_waitcnt vmcnt(17)
    v_lshlrev_b32 v80, 16, v52
    v_and_b32 v81, 0xffff0000, v52
    v_lshlrev_b32 v82, 16, v53
    v_and_b32 v83, 0xffff0000, v53
    v_lshlrev_b32 v84, 16, v54
    v_and_b32 v85, 0xffff0000, v54
    v_lshlrev_b32 v86, 16, v55
    v_and_b32 v87, 0xffff0000, v55
    v_pk_fma_f32 v[88:89], v[32:33], v[80:81], v[88:89] op_sel:[1,0,0] op_sel_hi:[1,1,1]
    v_pk_fma_f32 v[90:91], v[32:33], v[82:83], v[90:91] op_sel:[1,0,0] op_sel_hi:[1,1,1]
    v_pk_fma_f32 v[92:93], v[32:33], v[84:85], v[92:93] op_sel:[1,0,0] op_sel_hi:[1,1,1]
    v_pk_fma_f32 v[94:95], v[32:33], v[86:87], v[94:95] op_sel:[1,0,0] op_sel_hi:[1,1,1]
    s_waitcnt vmcnt(16)
    v_lshlrev_b32 v80, 16, v56
    v_and_b32 v81, 0xffff0000, v56
    v_lshlrev_b32 v82, 16, v57
    v_and_b32 v83, 0xffff0000, v57
    v_lshlrev_b32 v84, 16, v58
    v_and_b32 v85, 0xffff0000, v58
    v_lshlrev_b32 v86, 16, v59
    v_and_b32 v87, 0xffff0000, v59
    v_pk_fma_f32 v[88:89], v[34:35], v[80:81], v[88:89] op_sel:[0,0,0] op_sel_hi:[0,1,1]
    v_pk_fma_f32 v[90:91], v[34:35], v[82:83], v[90:91] op_sel:[0,0,0] op_sel_hi:[0,1,1]
    v_pk_fma_f32 v[92:93], v[34:35], v[84:85], v[92:93] op_sel:[0,0,0] op_sel_hi:[0,1,1]
    v_pk_fma_f32 v[94:95], v[34:35], v[86:87], v[94:95] op_sel:[0,0,0] op_sel_hi:[0,1,1]
    s_waitcnt vmcnt(15)
    v_lshlrev_b32 v80, 16, v60
    v_and_b32 v81, 0xffff0000, v60
    v_lshlrev_b32 v82, 16, v61
    v_and_b32 v83, 0xffff0000, v61
    v_lshlrev_b32 v84, 16, v62
    v_and_b32 v85, 0xffff0000, v62
    v_lshlrev_b32 v86, 16, v63
    v_and_b32 v87, 0xffff0000, v63
    v_pk_fma_f32 v[88:89], v[34:35], v[80:81], v[88:89] op_sel:[1,0,0] op_sel_hi:[1,1,1]
    v_pk_fma_f32 v[90:91], v[34:35], v[82:83], v[90:91] op_sel:[1,0,0] op_sel_hi:[1,1,1]
    v_pk_fma_f32 v[92:93], v[34:35], v[84:85], v[92:93] op_sel:[1,0,0] op_sel_hi:[1,1,1]
    v_pk_fma_f32 v[94:95], v[34:35], v[86:87], v[94:95] op_sel:[1,0,0] op_sel_hi:[1,1,1]
    s_waitcnt vmcnt(14)
    v_lshlrev_b32 v80, 16, v64
    v_and_b32 v81, 0xffff0000, v64
    v_lshlrev_b32 v82, 16, v65
    v_and_b32 v83, 0xffff0000, v65
    v_lshlrev_b32 v84, 16, v66
    v_and_b32 v85, 0xffff0000, v66
    v_lshlrev_b32 v86, 16, v67
    v_and_b32 v87, 0xffff0000, v67
    v_pk_fma_f32 v[88:89], v[36:37], v[80:81], v[88:89] op_sel:[0,0,0] op_sel_hi:[0,1,1]
    v_pk_fma_f32 v[90:91], v[36:37], v[82:83], v[90:91] op_sel:[0,0,0] op_sel_hi:[0,1,1]
    v_pk_fma_f32 v[92:93], v[36:37], v[84:85], v[92:93] op_sel:[0,0,0] op_sel_hi:[0,1,1]
    v_pk_fma_f32 v[94:95], v[36:37], v[86:87], v[94:95] op_sel:[0,0,0] op_sel_hi:[0,1,1]
    s_waitcnt vmcnt(13)
    v_lshlrev_b32 v80, 16, v68
    v_and_b32 v81, 0xffff0000, v68
    v_lshlrev_b32 v82, 16, v69
    v_and_b32 v83, 0xffff0000, v69
    v_lshlrev_b32 v84, 16, v70
    v_and_b32 v85, 0xffff0000, v70
    v_lshlrev_b32 v86, 16, v71
    v_and_b32 v87, 0xffff0000, v71
    v_pk_fma_f32 v[88:89], v[36:37], v[80:81], v[88:89] op_sel:[1,0,0] op_sel_hi:[1,1,1]
    v_pk_fma_f32 v[90:91], v[36:37], v[82:83], v[90:91] op_sel:[1,0,0] op_sel_hi:[1,1,1]
    v_pk_fma_f32 v[92:93], v[36:37], v[84:85], v[92:93] op_sel:[1,0,0] op_sel_hi:[1,1,1]
    v_pk_fma_f32 v[94:95], v[36:37], v[86:87], v[94:95] op_sel:[1,0,0] op_sel_hi:[1,1,1]
    s_waitcnt vmcnt(12)
    v_lshlrev_b32 v80, 16, v72
    v_and_b32 v81, 0xffff0000, v72
    v_lshlrev_b32 v82, 16, v73
    v_and_b32 v83, 0xffff0000, v73
    v_lshlrev_b32 v84, 16, v74
    v_and_b32 v85, 0xffff0000, v74
    v_lshlrev_b32 v86, 16, v75
    v_and_b32 v87, 0xffff0000, v75
    v_pk_fma_f32 v[88:89], v[38:39], v[80:81], v[88:89] op_sel:[0,0,0] op_sel_hi:[0,1,1]
    v_pk_fma_f32 v[90:91], v[38:39], v[82:83], v[90:91] op_sel:[0,0,0] op_sel_hi:[0,1,1]
    v_pk_fma_f32 v[92:93], v[38:39], v[84:85], v[92:93] op_sel:[0,0,0] op_sel_hi:[0,1,1]
    v_pk_fma_f32 v[94:95], v[38:39], v[86:87], v[94:95] op_sel:[0,0,0] op_sel_hi:[0,1,1]
    s_waitcnt vmcnt(11)
    v_lshlrev_b32 v80, 16, v76
    v_and_b32 v81, 0xffff0000, v76
    v_lshlrev_b32 v82, 16, v77
    v_and_b32 v83, 0xffff0000, v77
    v_lshlrev_b32 v84, 16, v78
    v_and_b32 v85, 0xffff0000, v78
    v_lshlrev_b32 v86, 16, v79
    v_and_b32 v87, 0xffff0000, v79
    v_pk_fma_f32 v[88:89], v[38:39], v[80:81], v[88:89] op_sel:[1,0,0] op_sel_hi:[1,1,1]
    v_pk_fma_f32 v[90:91], v[38:39], v[82:83], v[90:91] op_sel:[1,0,0] op_sel_hi:[1,1,1]
    v_pk_fma_f32 v[92:93], v[38:39], v[84:85], v[92:93] op_sel:[1,0,0] op_sel_hi:[1,1,1]
    v_pk_fma_f32 v[94:95], v[38:39], v[86:87], v[94:95] op_sel:[1,0,0] op_sel_hi:[1,1,1]
    s_nop 0
    v_permlane32_swap_b32 v88, v92
    v_permlane32_swap_b32 v89, v93
    v_permlane32_swap_b32 v90, v94
    v_permlane32_swap_b32 v91, v95
    v_add_f32 v88, v88, v92
    v_add_f32 v89, v89, v93
    v_add_f32 v90, v90, v94
    v_add_f32 v91, v91, v95
    s_nop 0
    v_permlane16_swap_b32 v88, v90
    v_permlane16_swap_b32 v89, v91
    v_add_f32 v88, v88, v90
    v_add_f32 v89, v89, v91
    v_and_b32 v81, 7, v1
    v_lshrrev_b32 v82, 3, v1
    v_add_f32_dpp v80, v88, v88 row_ror:8 row_mask:0xf bank_mask:0x3
    s_nop 1
    v_add_f32_dpp v80, v89, v89 row_ror:8 row_mask:0xf bank_mask:0xc
    v_lshl_add_u32 v81, v81, 3, v82
    s_lshl_b32 s7, s3, 8
    s_add_u32 s7, s7, 122880
    v_lshl_add_u32 v81, v81, 2, s7
    ds_write_b32 v81, v80
    s_waitcnt lgkmcnt(0)
    s_barrier
    v_lshlrev_b32 v81, 2, v1
    v_add_u32 v82, 122880, v81
    ds_read_b32 v88, v82 offset:0
    ds_read_b32 v89, v82 offset:256
    ds_read_b32 v90, v82 offset:512
    ds_read_b32 v91, v82 offset:768
    v_add_u32 v81, s44, v81
    s_waitcnt lgkmcnt(2)
    v_add_f32 v88, v88, v89
    s_waitcnt lgkmcnt(0)
    v_add_f32 v90, v90, v91
    v_add_f32 v88, v88, v90
    v_min_u32 v88, -2, v88
    s_cmp_lg_u32 s3, 0
    s_cbranch_scc1 Lmod_skip_s1
    global_store_dword v81, v88, s[38:39] offset:0 sc1
Lmod_skip_s1:
    global_load_dwordx4 v[144:147], v96, s[32:33] nt
    s_cmp_ge_u32 s48, 27
    s_cbranch_scc1 Lsb_n3
    s_mul_i32 s4, s48, 40960
    s_mul_i32 s5, s3, 10240
    s_add_u32 s4, s4, s5
    v_lshl_add_u32 v164, v1, 4, s4
    s_add_u32 m0, s5, 0
    s_nop 0
    global_load_lds_dwordx4 v164, s[28:29] offset:0 nt
    global_load_lds_dwordx4 v164, s[28:29] offset:1024 nt
    global_load_lds_dwordx4 v164, s[28:29] offset:2048 nt
    global_load_lds_dwordx4 v164, s[28:29] offset:3072 nt
    s_add_u32 m0, s5, 4096
    v_add_u32 v164, 4096, v164
    global_load_lds_dwordx4 v164, s[28:29] offset:0 nt
    global_load_lds_dwordx4 v164, s[28:29] offset:1024 nt
    global_load_lds_dwordx4 v164, s[28:29] offset:2048 nt
    global_load_lds_dwordx4 v164, s[28:29] offset:3072 nt
    s_add_u32 m0, s5, 8192
    v_add_u32 v164, 4096, v164
    global_load_lds_dwordx4 v164, s[28:29] offset:0 nt
    global_load_lds_dwordx4 v164, s[28:29] offset:1024 nt
    s_waitcnt vmcnt(10)
    s_branch Lsb_n4
Lsb_n3:
    s_add_u32 s50, s48, 78
    s_lshr_b32 s4, s50, 1
    s_and_b32 s5, s50, 1
    s_cmp_lt_u32 s4, 50
    s_cselect_b32 s6, -20, 0
    s_cmp_lt_u32 s4, 20
    s_cselect_b32 s6, 30, s6
    s_add_u32 s4, s4, s6
    s_mul_i32 s6, s5, 15360
    s_lshl_b32 s7, s4, 8
    s_add_u32 s44, s6, s7
    s_lshl_b32 s5, s5, 2
    s_add_u32 s5, s5, s3
    s_mul_i32 s5, s5, 80
    s_lshl_b32 s4, s4, 7
    s_mul_i32 s6, s5, 7680
    s_add_u32 s4, s4, s6
    v_min_u32 v28, 39, v1
    s_lshl_b32 s5, s5, 1
    v_lshl_add_u32 v28, v28, 2, s5
    global_load_dword v80, v28, s[30:31]
    v_lshrrev_b32 v29, 3, v1
    v_mul_u32_u24 v28, 15232, v29
    v_add3_u32 v28, v28, v4, s4
    global_load_dwordx4 v[40:43], v28, s[32:33] nt
    v_add_u32 v28, 7680, v28
    global_load_dwordx4 v[44:47], v28, s[32:33] nt
    v_add_u32 v28, 115200, v28
    global_load_dwordx4 v[48:51], v28, s[32:33] nt
    v_add_u32 v28, 7680, v28
    global_load_dwordx4 v[52:55], v28, s[32:33] nt
    v_add_u32 v28, 115200, v28
    global_load_dwordx4 v[56:59], v28, s[32:33] nt
    v_add_u32 v28, 7680, v28
    global_load_dwordx4 v[60:63], v28, s[32:33] nt
    v_add_u32 v28, 115200, v28
    global_load_dwordx4 v[64:67], v28, s[32:33] nt
    v_add_u32 v28, 7680, v28
    global_load_dwordx4 v[68:71], v28, s[32:33] nt
    v_add_u32 v28, 115200, v28
    global_load_dwordx4 v[72:75], v28, s[32:33] nt
    v_add_u32 v28, 7680, v28
    global_load_dwordx4 v[76:79], v28, s[32:33] nt
    s_waitcnt vmcnt(11)
Lsb_n4:
    v_lshlrev_b32 v150, 16, v148
    v_and_b32 v151, 0xffff0000, v148
    v_lshlrev_b32 v97, 2, v97
    v_mul_f32 v152, 0xbfb8aa3b, v150
    v_mul_f32 v153, 0xbfb8aa3b, v151
    v_exp_f32 v152, v152
    v_exp_f32 v153, v153
    v_add_f32 v152, 1.0, v152
    v_add_f32 v153, 1.0, v153
    v_rcp_f32 v152, v152
    v_rcp_f32 v153, v153
    v_mul_f32 v150, v150, v152
    v_mul_f32 v151, v151, v153
    v_cvt_pk_bf16_f32 v148, v150, v151
    ds_bpermute_b32 v156, v97, v148 offset:0
    ds_bpermute_b32 v157, v97, v148 offset:32
    ds_bpermute_b32 v158, v97, v148 offset:64
    ds_bpermute_b32 v159, v97, v148 offset:96
    ds_bpermute_b32 v160, v97, v148 offset:128
    s_waitcnt lgkmcnt(4)
    v_lshlrev_b32 v98, 16, v156
    v_and_b32 v99, 0xffff0000, v156
    s_waitcnt lgkmcnt(3)
    v_lshlrev_b32 v100, 16, v157
    v_and_b32 v101, 0xffff0000, v157
    s_waitcnt lgkmcnt(2)
    v_lshlrev_b32 v102, 16, v158
    v_and_b32 v103, 0xffff0000, v158
    s_waitcnt lgkmcnt(1)
    v_lshlrev_b32 v104, 16, v159
    v_and_b32 v105, 0xffff0000, v159
    s_waitcnt lgkmcnt(0)
    v_lshlrev_b32 v106, 16, v160
    v_and_b32 v107, 0xffff0000, v160
    v_lshlrev_b32 v148, 16, v108
    v_and_b32 v149, 0xffff0000, v108
    v_lshlrev_b32 v150, 16, v109
    v_and_b32 v151, 0xffff0000, v109
    v_lshlrev_b32 v152, 16, v110
    v_and_b32 v153, 0xffff0000, v110
    v_lshlrev_b32 v154, 16, v111
    v_and_b32 v155, 0xffff0000, v111
    v_pk_mul_f32 v[156:157], v[98:99], v[148:149] op_sel:[0,0] op_sel_hi:[0,1]
    v_pk_mul_f32 v[158:159], v[98:99], v[150:151] op_sel:[0,0] op_sel_hi:[0,1]
    v_pk_mul_f32 v[160:161], v[98:99], v[152:153] op_sel:[0,0] op_sel_hi:[0,1]
    v_pk_mul_f32 v[162:163], v[98:99], v[154:155] op_sel:[0,0] op_sel_hi:[0,1]
    v_lshlrev_b32 v148, 16, v112
    v_and_b32 v149, 0xffff0000, v112
    v_lshlrev_b32 v150, 16, v113
    v_and_b32 v151, 0xffff0000, v113
    v_lshlrev_b32 v152, 16, v114
    v_and_b32 v153, 0xffff0000, v114
    v_lshlrev_b32 v154, 16, v115
    v_and_b32 v155, 0xffff0000, v115
    v_pk_fma_f32 v[156:157], v[98:99], v[148:149], v[156:157] op_sel:[1,0,0] op_sel_hi:[1,1,1]
    v_pk_fma_f32 v[158:159], v[98:99], v[150:151], v[158:159] op_sel:[1,0,0] op_sel_hi:[1,1,1]
    v_pk_fma_f32 v[160:161], v[98:99], v[152:153], v[160:161] op_sel:[1,0,0] op_sel_hi:[1,1,1]
    v_pk_fma_f32 v[162:163], v[98:99], v[154:155], v[162:163] op_sel:[1,0,0] op_sel_hi:[1,1,1]
    v_lshlrev_b32 v148, 16, v116
    v_and_b32 v149, 0xffff0000, v116
    v_lshlrev_b32 v150, 16, v117
    v_and_b32 v151, 0xffff0000, v117
    v_lshlrev_b32 v152, 16, v118
    v_and_b32 v153, 0xffff0000, v118
    v_lshlrev_b32 v154, 16, v119
    v_and_b32 v155, 0xffff0000, v119
    v_pk_fma_f32 v[156:157], v[100:101], v[148:149], v[156:157] op_sel:[0,0,0] op_sel_hi:[0,1,1]
    v_pk_fma_f32 v[158:159], v[100:101], v[150:151], v[158:159] op_sel:[0,0,0] op_sel_hi:[0,1,1]
    v_pk_fma_f32 v[160:161], v[100:101], v[152:153], v[160:161] op_sel:[0,0,0] op_sel_hi:[0,1,1]
    v_pk_fma_f32 v[162:163], v[100:101], v[154:155], v[162:163] op_sel:[0,0,0] op_sel_hi:[0,1,1]
    v_lshlrev_b32 v148, 16, v120
    v_and_b32 v149, 0xffff0000, v120
    v_lshlrev_b32 v150, 16, v121
    v_and_b32 v151, 0xffff0000, v121
    v_lshlrev_b32 v152, 16, v122
    v_and_b32 v153, 0xffff0000, v122
    v_lshlrev_b32 v154, 16, v123
    v_and_b32 v155, 0xffff0000, v123
    v_pk_fma_f32 v[156:157], v[100:101], v[148:149], v[156:157] op_sel:[1,0,0] op_sel_hi:[1,1,1]
    v_pk_fma_f32 v[158:159], v[100:101], v[150:151], v[158:159] op_sel:[1,0,0] op_sel_hi:[1,1,1]
    v_pk_fma_f32 v[160:161], v[100:101], v[152:153], v[160:161] op_sel:[1,0,0] op_sel_hi:[1,1,1]
    v_pk_fma_f32 v[162:163], v[100:101], v[154:155], v[162:163] op_sel:[1,0,0] op_sel_hi:[1,1,1]
    v_lshlrev_b32 v148, 16, v124
    v_and_b32 v149, 0xffff0000, v124
    v_lshlrev_b32 v150, 16, v125
    v_and_b32 v151, 0xffff0000, v125
    v_lshlrev_b32 v152, 16, v126
    v_and_b32 v153, 0xffff0000, v126
    v_lshlrev_b32 v154, 16, v127
    v_and_b32 v155, 0xffff0000, v127
    v_pk_fma_f32 v[156:157], v[102:103], v[148:149], v[156:157] op_sel:[0,0,0] op_sel_hi:[0,1,1]
    v_pk_fma_f32 v[158:159], v[102:103], v[150:151], v[158:159] op_sel:[0,0,0] op_sel_hi:[0,1,1]
    v_pk_fma_f32 v[160:161], v[102:103], v[152:153], v[160:161] op_sel:[0,0,0] op_sel_hi:[0,1,1]
    v_pk_fma_f32 v[162:163], v[102:103], v[154:155], v[162:163] op_sel:[0,0,0] op_sel_hi:[0,1,1]
    v_lshlrev_b32 v148, 16, v128
    v_and_b32 v149, 0xffff0000, v128
    v_lshlrev_b32 v150, 16, v129
    v_and_b32 v151, 0xffff0000, v129
    v_lshlrev_b32 v152, 16, v130
    v_and_b32 v153, 0xffff0000, v130
    v_lshlrev_b32 v154, 16, v131
    v_and_b32 v155, 0xffff0000, v131
    v_pk_fma_f32 v[156:157], v[102:103], v[148:149], v[156:157] op_sel:[1,0,0] op_sel_hi:[1,1,1]
    v_pk_fma_f32 v[158:159], v[102:103], v[150:151], v[158:159] op_sel:[1,0,0] op_sel_hi:[1,1,1]
    v_pk_fma_f32 v[160:161], v[102:103], v[152:153], v[160:161] op_sel:[1,0,0] op_sel_hi:[1,1,1]
    v_pk_fma_f32 v[162:163], v[102:103], v[154:155], v[162:163] op_sel:[1,0,0] op_sel_hi:[1,1,1]
    v_lshlrev_b32 v148, 16, v132
    v_and_b32 v149, 0xffff0000, v132
    v_lshlrev_b32 v150, 16, v133
    v_and_b32 v151, 0xffff0000, v133
    v_lshlrev_b32 v152, 16, v134
    v_and_b32 v153, 0xffff0000, v134
    v_lshlrev_b32 v154, 16, v135
    v_and_b32 v155, 0xffff0000, v135
    v_pk_fma_f32 v[156:157], v[104:105], v[148:149], v[156:157] op_sel:[0,0,0] op_sel_hi:[0,1,1]
    v_pk_fma_f32 v[158:159], v[104:105], v[150:151], v[158:159] op_sel:[0,0,0] op_sel_hi:[0,1,1]
    v_pk_fma_f32 v[160:161], v[104:105], v[152:153], v[160:161] op_sel:[0,0,0] op_sel_hi:[0,1,1]
    v_pk_fma_f32 v[162:163], v[104:105], v[154:155], v[162:163] op_sel:[0,0,0] op_sel_hi:[0,1,1]
    v_lshlrev_b32 v148, 16, v136
    v_and_b32 v149, 0xffff0000, v136
    v_lshlrev_b32 v150, 16, v137
    v_and_b32 v151, 0xffff0000, v137
    v_lshlrev_b32 v152, 16, v138
    v_and_b32 v153, 0xffff0000, v138
    v_lshlrev_b32 v154, 16, v139
    v_and_b32 v155, 0xffff0000, v139
    v_pk_fma_f32 v[156:157], v[104:105], v[148:149], v[156:157] op_sel:[1,0,0] op_sel_hi:[1,1,1]
    v_pk_fma_f32 v[158:159], v[104:105], v[150:151], v[158:159] op_sel:[1,0,0] op_sel_hi:[1,1,1]
    v_pk_fma_f32 v[160:161], v[104:105], v[152:153], v[160:161] op_sel:[1,0,0] op_sel_hi:[1,1,1]
    v_pk_fma_f32 v[162:163], v[104:105], v[154:155], v[162:163] op_sel:[1,0,0] op_sel_hi:[1,1,1]
    v_lshlrev_b32 v148, 16, v140
    v_and_b32 v149, 0xffff0000, v140
    v_lshlrev_b32 v150, 16, v141
    v_and_b32 v151, 0xffff0000, v141
    v_lshlrev_b32 v152, 16, v142
    v_and_b32 v153, 0xffff0000, v142
    v_lshlrev_b32 v154, 16, v143
    v_and_b32 v155, 0xffff0000, v143
    v_pk_fma_f32 v[156:157], v[106:107], v[148:149], v[156:157] op_sel:[0,0,0] op_sel_hi:[0,1,1]
    v_pk_fma_f32 v[158:159], v[106:107], v[150:151], v[158:159] op_sel:[0,0,0] op_sel_hi:[0,1,1]
    v_pk_fma_f32 v[160:161], v[106:107], v[152:153], v[160:161] op_sel:[0,0,0] op_sel_hi:[0,1,1]
    v_pk_fma_f32 v[162:163], v[106:107], v[154:155], v[162:163] op_sel:[0,0,0] op_sel_hi:[0,1,1]
    v_lshlrev_b32 v148, 16, v144
    v_and_b32 v149, 0xffff0000, v144
    v_lshlrev_b32 v150, 16, v145
    v_and_b32 v151, 0xffff0000, v145
    v_lshlrev_b32 v152, 16, v146
    v_and_b32 v153, 0xffff0000, v146
    v_lshlrev_b32 v154, 16, v147
    v_and_b32 v155, 0xffff0000, v147
    v_pk_fma_f32 v[156:157], v[106:107], v[148:149], v[156:157] op_sel:[1,0,0] op_sel_hi:[1,1,1]
    v_pk_fma_f32 v[158:159], v[106:107], v[150:151], v[158:159] op_sel:[1,0,0] op_sel_hi:[1,1,1]
    v_pk_fma_f32 v[160:161], v[106:107], v[152:153], v[160:161] op_sel:[1,0,0] op_sel_hi:[1,1,1]
    v_pk_fma_f32 v[162:163], v[106:107], v[154:155], v[162:163] op_sel:[1,0,0] op_sel_hi:[1,1,1]
    s_nop 0
    v_permlane32_swap_b32 v156, v160
    v_permlane32_swap_b32 v157, v161
    v_permlane32_swap_b32 v158, v162
    v_permlane32_swap_b32 v159, v163
    v_add_f32 v156, v156, v160
    v_add_f32 v157, v157, v161
    v_add_f32 v158, v158, v162
    v_add_f32 v159, v159, v163
    s_nop 0
    v_permlane16_swap_b32 v156, v158
    v_permlane16_swap_b32 v157, v159
    v_add_f32 v156, v156, v158
    v_add_f32 v157, v157, v159
    v_and_b32 v149, 7, v1
    v_lshrrev_b32 v150, 3, v1
    v_add_f32_dpp v148, v156, v156 row_ror:8 row_mask:0xf bank_mask:0x3
    s_nop 1
    v_add_f32_dpp v148, v157, v157 row_ror:8 row_mask:0xf bank_mask:0xc
    v_lshl_add_u32 v149, v149, 3, v150
    s_lshl_b32 s7, s3, 8
    s_add_u32 s7, s7, 123904
    v_lshl_add_u32 v149, v149, 2, s7
    ds_write_b32 v149, v148
    s_waitcnt lgkmcnt(0)
    s_barrier
    v_lshlrev_b32 v149, 2, v1
    v_add_u32 v150, 123904, v149
    ds_read_b32 v156, v150 offset:0
    ds_read_b32 v157, v150 offset:256
    ds_read_b32 v158, v150 offset:512
    ds_read_b32 v159, v150 offset:768
    v_add_u32 v149, s45, v149
    s_waitcnt lgkmcnt(2)
    v_add_f32 v156, v156, v157
    s_waitcnt lgkmcnt(0)
    v_add_f32 v158, v158, v159
    v_add_f32 v156, v156, v158
    v_min_u32 v156, -2, v156
    s_cmp_lg_u32 s3, 0
    s_cbranch_scc1 Lmod_skip_s2
    global_store_dword v149, v156, s[38:39] offset:0 sc1
Lmod_skip_s2:
    s_cmp_lg_u32 s3, 0
    s_cbranch_scc1 Lbic_x
    v_min_u32 v164, 49, v1
    v_cmp_lt_u32 vcc, 7, v164
    s_nop 1
    v_cndmask_b32_e64 v165, 0, 7, vcc
    v_add_lshl_u32 v164, v164, v165, 2
    s_branch Lbic_f
Lbic:
    s_sleep 4
Lbic_f:
    global_load_dword v165, v164, s[36:37] sc1
    s_waitcnt vmcnt(0)
    v_cmp_eq_u32 vcc, 0, v165
    s_add_u32 s100, s100, 1
    s_cmp_ge_u32 s100, 262144
    s_cbranch_scc1 Lbic_x
    s_cbranch_vccnz Lbic
Lbic_x:
    s_waitcnt vmcnt(0)
    s_cmp_ge_u32 s48, 27
    s_cbranch_scc1 Lsp_b3
    s_barrier
    v_and_b32 v33, 15, v1
    v_lshrrev_b32 v34, 4, v1
    v_mul_u32_u24 v34, 10240, v34
    s_mul_i32 s5, s3, 320
    s_add_u32 s5, s5, 0
    v_add_u32 v34, s5, v34
    v_lshl_add_u32 v31, v33, 2, v34
    v_lshl_add_u32 v32, v33, 1, v34
    s_mul_i32 s5, s3, 276480
    s_mul_i32 s6, s48, 5120
    s_add_u32 s5, s5, s6
    s_add_u32 s5, s5, 10487808
    v_lshl_add_u32 v30, v1, 4, s5
    s_mov_b32 s6, 0x5040100
    s_mov_b32 s7, 0x7060302
    ds_read_b32 v36, v31 offset:0
    ds_read_b32 v37, v31 offset:2560
    ds_read_b32 v38, v31 offset:5120
    ds_read_b32 v39, v31 offset:7680
    ds_read_b32 v40, v31 offset:1280
    ds_read_b32 v41, v31 offset:3840
    ds_read_b32 v42, v31 offset:6400
    ds_read_b32 v43, v31 offset:8960
    ds_read_b32 v44, v31 offset:64
    ds_read_b32 v45, v31 offset:2624
    ds_read_b32 v46, v31 offset:5184
    ds_read_b32 v47, v31 offset:7744
    ds_read_b32 v48, v31 offset:1344
    ds_read_b32 v49, v31 offset:3904
    ds_read_b32 v50, v31 offset:6464
    ds_read_b32 v51, v31 offset:9024
    ds_read_u16 v52, v32 offset:128
    ds_read_u16 v53, v32 offset:2688
    ds_read_u16 v54, v32 offset:5248
    ds_read_u16 v55, v32 offset:7808
    ds_read_u16 v56, v32 offset:1408
    ds_read_u16 v57, v32 offset:3968
    ds_read_u16 v58, v32 offset:6528
    ds_read_u16 v59, v32 offset:9088
    s_waitcnt lgkmcnt(15)
    v_perm_b32 v60, v37, v36, s6
    v_perm_b32 v61, v39, v38, s6
    v_perm_b32 v62, v41, v40, s6
    v_perm_b32 v63, v43, v42, s6
    v_perm_b32 v64, v37, v36, s7
    v_perm_b32 v65, v39, v38, s7
    v_perm_b32 v66, v41, v40, s7
    v_perm_b32 v67, v43, v42, s7
    s_waitcnt lgkmcnt(14)
    v_perm_b32 v68, v45, v44, s6
    s_waitcnt lgkmcnt(12)
    v_perm_b32 v69, v47, v46, s6
    s_waitcnt lgkmcnt(10)
    v_perm_b32 v70, v49, v48, s6
    s_waitcnt lgkmcnt(8)
    v_perm_b32 v71, v51, v50, s6
    v_perm_b32 v72, v45, v44, s7
    v_perm_b32 v73, v47, v46, s7
    v_perm_b32 v74, v49, v48, s7
    v_perm_b32 v75, v51, v50, s7
    s_waitcnt lgkmcnt(6)
    v_perm_b32 v76, v53, v52, s6
    s_waitcnt lgkmcnt(4)
    v_perm_b32 v77, v55, v54, s6
    s_waitcnt lgkmcnt(2)
    v_perm_b32 v78, v57, v56, s6
    s_waitcnt lgkmcnt(0)
    v_perm_b32 v79, v59, v58, s6
    global_store_dwordx4 v30, v[60:63], s[38:39] offset:-2048 sc1
    global_store_dwordx4 v30, v[64:67], s[38:39] offset:-1024 sc1
    global_store_dwordx4 v30, v[68:71], s[38:39] offset:0 sc1
    global_store_dwordx4 v30, v[72:75], s[38:39] offset:1024 sc1
    global_store_dwordx4 v30, v[76:79], s[38:39] offset:2048 sc1
    v_add_u32 v30, 138240, v30
    ds_read_b32 v80, v31 offset:160
    ds_read_b32 v81, v31 offset:2720
    ds_read_b32 v82, v31 offset:5280
    ds_read_b32 v83, v31 offset:7840
    ds_read_b32 v84, v31 offset:1440
    ds_read_b32 v85, v31 offset:4000
    ds_read_b32 v86, v31 offset:6560
    ds_read_b32 v87, v31 offset:9120
    ds_read_b32 v88, v31 offset:224
    ds_read_b32 v89, v31 offset:2784
    ds_read_b32 v90, v31 offset:5344
    ds_read_b32 v91, v31 offset:7904
    ds_read_b32 v92, v31 offset:1504
    ds_read_b32 v93, v31 offset:4064
    ds_read_b32 v94, v31 offset:6624
    ds_read_b32 v95, v31 offset:9184
    ds_read_u16 v96, v32 offset:288
    ds_read_u16 v97, v32 offset:2848
    ds_read_u16 v98, v32 offset:5408
    ds_read_u16 v99, v32 offset:7968
    ds_read_u16 v100, v32 offset:1568
    ds_read_u16 v101, v32 offset:4128
    ds_read_u16 v102, v32 offset:6688
    ds_read_u16 v103, v32 offset:9248
    s_waitcnt lgkmcnt(15)
    v_perm_b32 v104, v81, v80, s6
    v_perm_b32 v105, v83, v82, s6
    v_perm_b32 v106, v85, v84, s6
    v_perm_b32 v107, v87, v86, s6
    v_perm_b32 v108, v81, v80, s7
    v_perm_b32 v109, v83, v82, s7
    v_perm_b32 v110, v85, v84, s7
    v_perm_b32 v111, v87, v86, s7
    s_waitcnt lgkmcnt(14)
    v_perm_b32 v112, v89, v88, s6
    s_waitcnt lgkmcnt(12)
    v_perm_b32 v113, v91, v90, s6
    s_waitcnt lgkmcnt(10)
    v_perm_b32 v114, v93, v92, s6
    s_waitcnt lgkmcnt(8)
    v_perm_b32 v115, v95, v94, s6
    v_perm_b32 v116, v89, v88, s7
    v_perm_b32 v117, v91, v90, s7
    v_perm_b32 v118, v93, v92, s7
    v_perm_b32 v119, v95, v94, s7
    s_waitcnt lgkmcnt(6)
    v_perm_b32 v120, v97, v96, s6
    s_waitcnt lgkmcnt(4)
    v_perm_b32 v121, v99, v98, s6
    s_waitcnt lgkmcnt(2)
    v_perm_b32 v122, v101, v100, s6
    s_waitcnt lgkmcnt(0)
    v_perm_b32 v123, v103, v102, s6
    global_store_dwordx4 v30, v[104:107], s[38:39] offset:-2048 sc1
    global_store_dwordx4 v30, v[108:111], s[38:39] offset:-1024 sc1
    global_store_dwordx4 v30, v[112:115], s[38:39] offset:0 sc1
    global_store_dwordx4 v30, v[116:119], s[38:39] offset:1024 sc1
    global_store_dwordx4 v30, v[120:123], s[38:39] offset:2048 sc1
    s_lshl_b32 s4, s48, 7
    s_add_u32 s51, s4, 98304
    s_branch Lsp_d
Lsp_a2:
    s_and_b32 s4, s42, 1
    s_lshl_b32 s4, s4, 1
    s_and_b32 s5, s3, 1
    s_add_u32 s44, s4, s5
    s_and_b32 s4, s42, -2
    s_lshr_b32 s5, s3, 1
    s_add_u32 s45, s4, s5
    s_and_b32 s4, s42, 1
    s_lshl_b32 s4, s4, 2
    s_add_u32 s4, s4, s3
    s_mul_i32 s4, s4, 276480
    s_lshr_b32 s5, s42, 1
    s_lshl_b32 s5, s5, 7
    s_add_u32 s4, s4, s5
    v_lshrrev_b32 v28, 3, v1
    v_mul_u32_u24 v28, 3328, v28
    v_add3_u32 v28, v28, v4, s4
    s_mul_i32 s5, s3, 10240
    s_add_u32 m0, s5, 0
    s_nop 0
    global_load_lds_dwordx4 v28, s[22:23] nt
    v_add_u32 v28, 27648, v28
    s_add_u32 m0, s5, 1024
    s_nop 0
    global_load_lds_dwordx4 v28, s[22:23] nt
    v_add_u32 v28, 27648, v28
    s_add_u32 m0, s5, 2048
    s_nop 0
    global_load_lds_dwordx4 v28, s[22:23] nt
    v_add_u32 v28, 27648, v28
    s_add_u32 m0, s5, 3072
    s_nop 0
    global_load_lds_dwordx4 v28, s[22:23] nt
    v_add_u32 v28, 27648, v28
    s_add_u32 m0, s5, 4096
    s_nop 0
    global_load_lds_dwordx4 v28, s[22:23] nt
    v_add_u32 v28, 27648, v28
    s_add_u32 m0, s5, 5120
    s_nop 0
    global_load_lds_dwordx4 v28, s[22:23] nt
    v_add_u32 v28, 27648, v28
    s_add_u32 m0, s5, 6144
    s_nop 0
    global_load_lds_dwordx4 v28, s[22:23] nt
    v_add_u32 v28, 27648, v28
    s_add_u32 m0, s5, 7168
    s_nop 0
    global_load_lds_dwordx4 v28, s[22:23] nt
    v_add_u32 v28, 27648, v28
    s_add_u32 m0, s5, 8192
    s_nop 0
    global_load_lds_dwordx4 v28, s[22:23] nt
    v_add_u32 v28, 27648, v28
    s_add_u32 m0, s5, 9216
    s_nop 0
    global_load_lds_dwordx4 v28, s[22:23] nt
    v_add_u32 v28, 27648, v28
    v_min_u32 v72, 624, v4
    s_mul_i32 s5, s44, 640
    s_add_u32 s5, s5, 7680
    v_add_u32 v73, s5, v72
    s_mul_i32 s5, s3, 1280
    s_add_u32 s5, s5, 124928
    v_add_u32 v72, s5, v72
    v_lshl_add_u32 v74, v3, 5, s5
    s_cmp_ge_u32 s45, 27
    s_cselect_b32 s6, -54, 56
    s_lshl_b32 s7, s45, 1
    s_add_u32 s46, s6, s7
    s_mul_i32 s4, s46, 20480
    s_mul_i32 s5, s44, 5120
    s_add_u32 s4, s4, s5
    s_add_u32 s4, s4, 7342080
    v_add_u32 v75, s4, v4
    v_add_u32 v76, 20480, v75
    s_and_b32 s4, s3, 1
    s_mul_i32 s4, s4, 20480
    s_lshr_b32 s5, s3, 1
    s_lshl_b32 s5, s5, 6
    s_add_u32 s4, s4, s5
    v_lshl_add_u32 v28, v3, 10, s4
    v_lshl_add_u32 v28, v2, 2, v28
    s_cmp_lt_u32 s42, 8
    s_cselect_b32 s48, 21, 0
    s_add_u32 s48, s48, s42
    s_add_u32 s48, s48, 76
    s_sub_u32 s4, s42, 5
    s_cmp_ge_u32 s4, 21
    s_cbranch_scc1 Lwp_n1
    s_lshr_b32 s4, s48, 1
    s_and_b32 s5, s48, 1
    s_cmp_lt_u32 s4, 50
    s_cselect_b32 s6, -20, 0
    s_cmp_lt_u32 s4, 20
    s_cselect_b32 s6, 30, s6
    s_add_u32 s4, s4, s6
    s_mul_i32 s6, s5, 15360
    s_lshl_b32 s7, s4, 8
    s_add_u32 s47, s6, s7
    s_lshl_b32 s5, s5, 2
    s_add_u32 s5, s5, s3
    s_mul_i32 s5, s5, 80
    s_lshl_b32 s4, s4, 7
    s_mul_i32 s6, s5, 7680
    s_add_u32 s4, s4, s6
    v_min_u32 v78, 39, v1
    s_lshl_b32 s5, s5, 1
    v_lshl_add_u32 v78, v78, 2, s5
    global_load_dword v132, v78, s[30:31]
    v_lshrrev_b32 v79, 3, v1
    v_mul_u32_u24 v78, 15232, v79
    v_add3_u32 v78, v78, v4, s4
    global_load_dwordx4 v[92:95], v78, s[32:33] nt
    v_add_u32 v78, 7680, v78
    global_load_dwordx4 v[96:99], v78, s[32:33] nt
    v_add_u32 v78, 115200, v78
    global_load_dwordx4 v[100:103], v78, s[32:33] nt
    v_add_u32 v78, 7680, v78
    global_load_dwordx4 v[104:107], v78, s[32:33] nt
    v_add_u32 v78, 115200, v78
    global_load_dwordx4 v[108:111], v78, s[32:33] nt
    v_add_u32 v78, 7680, v78
    global_load_dwordx4 v[112:115], v78, s[32:33] nt
    v_add_u32 v78, 115200, v78
    global_load_dwordx4 v[116:119], v78, s[32:33] nt
    v_add_u32 v78, 7680, v78
    global_load_dwordx4 v[120:123], v78, s[32:33] nt
    v_add_u32 v78, 115200, v78
    global_load_dwordx4 v[124:127], v78, s[32:33] nt
    v_add_u32 v78, 7680, v78
    global_load_dwordx4 v[128:131], v78, s[32:33] nt
    s_waitcnt vmcnt(11)
    s_branch Lwp_n2
Lwp_n1:
    s_waitcnt vmcnt(0)
Lwp_n2:
    s_barrier
    ds_read_b32 v32, v28 offset:0
    ds_read_b32 v33, v28 offset:128
    ds_read_b32 v34, v28 offset:256
    ds_read_b32 v35, v28 offset:384
    ds_read_b32 v36, v28 offset:512
    ds_read_b32 v37, v28 offset:640
    ds_read_b32 v38, v28 offset:768
    ds_read_b32 v39, v28 offset:896
    ds_read_b32 v40, v28 offset:4096
    ds_read_b32 v41, v28 offset:4224
    ds_read_b32 v42, v28 offset:4352
    ds_read_b32 v43, v28 offset:4480
    ds_read_b32 v44, v28 offset:4608
    ds_read_b32 v45, v28 offset:4736
    ds_read_b32 v46, v28 offset:4864
    ds_read_b32 v47, v28 offset:4992
    ds_read_b32 v48, v28 offset:8192
    ds_read_b32 v49, v28 offset:8320
    ds_read_b32 v50, v28 offset:8448
    ds_read_b32 v51, v28 offset:8576
    ds_read_b32 v52, v28 offset:8704
    ds_read_b32 v53, v28 offset:8832
    ds_read_b32 v54, v28 offset:8960
    ds_read_b32 v55, v28 offset:9088
    ds_read_b32 v56, v28 offset:12288
    ds_read_b32 v57, v28 offset:12416
    ds_read_b32 v58, v28 offset:12544
    ds_read_b32 v59, v28 offset:12672
    ds_read_b32 v60, v28 offset:12800
    ds_read_b32 v61, v28 offset:12928
    ds_read_b32 v62, v28 offset:13056
    ds_read_b32 v63, v28 offset:13184
    ds_read_b32 v64, v28 offset:16384
    ds_read_b32 v65, v28 offset:16512
    ds_read_b32 v66, v28 offset:16640
    ds_read_b32 v67, v28 offset:16768
    ds_read_b32 v68, v28 offset:16896
    ds_read_b32 v69, v28 offset:17024
    ds_read_b32 v70, v28 offset:17152
    ds_read_b32 v71, v28 offset:17280
    s_waitcnt lgkmcnt(15)
    v_lshlrev_b32 v152, 16, v32
    v_and_b32 v153, 0xffff0000, v32
    v_lshlrev_b32 v154, 16, v33
    v_and_b32 v155, 0xffff0000, v33
    v_lshlrev_b32 v156, 16, v34
    v_and_b32 v157, 0xffff0000, v34
    v_lshlrev_b32 v158, 16, v35
    v_and_b32 v159, 0xffff0000, v35
    v_lshlrev_b32 v160, 16, v36
    v_and_b32 v161, 0xffff0000, v36
    v_lshlrev_b32 v162, 16, v37
    v_and_b32 v163, 0xffff0000, v37
    v_lshlrev_b32 v164, 16, v38
    v_and_b32 v165, 0xffff0000, v38
    v_lshlrev_b32 v166, 16, v39
    v_and_b32 v167, 0xffff0000, v39
    v_lshlrev_b32 v168, 16, v40
    v_and_b32 v169, 0xffff0000, v40
    v_lshlrev_b32 v170, 16, v41
    v_and_b32 v171, 0xffff0000, v41
    v_lshlrev_b32 v172, 16, v42
    v_and_b32 v173, 0xffff0000, v42
    v_lshlrev_b32 v174, 16, v43
    v_and_b32 v175, 0xffff0000, v43
    v_lshlrev_b32 v176, 16, v44
    v_and_b32 v177, 0xffff0000, v44
    v_lshlrev_b32 v178, 16, v45
    v_and_b32 v179, 0xffff0000, v45
    v_lshlrev_b32 v180, 16, v46
    v_and_b32 v181, 0xffff0000, v46
    v_lshlrev_b32 v182, 16, v47
    v_and_b32 v183, 0xffff0000, v47
    v_lshlrev_b32 v184, 16, v48
    v_and_b32 v185, 0xffff0000, v48
    v_lshlrev_b32 v186, 16, v49
    v_and_b32 v187, 0xffff0000, v49
    v_lshlrev_b32 v188, 16, v50
    v_and_b32 v189, 0xffff0000, v50
    v_lshlrev_b32 v190, 16, v51
    v_and_b32 v191, 0xffff0000, v51
    v_lshlrev_b32 v192, 16, v52
    v_and_b32 v193, 0xffff0000, v52
    v_lshlrev_b32 v194, 16, v53
    v_and_b32 v195, 0xffff0000, v53
    v_lshlrev_b32 v196, 16, v54
    v_and_b32 v197, 0xffff0000, v54
    v_lshlrev_b32 v198, 16, v55
    v_and_b32 v199, 0xffff0000, v55
    v_lshlrev_b32 v200, 16, v56
    v_and_b32 v201, 0xffff0000, v56
    s_waitcnt lgkmcnt(14)
    v_lshlrev_b32 v202, 16, v57
    v_and_b32 v203, 0xffff0000, v57
    s_waitcnt lgkmcnt(13)
    v_lshlrev_b32 v204, 16, v58
    v_and_b32 v205, 0xffff0000, v58
    s_waitcnt lgkmcnt(12)
    v_lshlrev_b32 v206, 16, v59
    v_and_b32 v207, 0xffff0000, v59
    s_waitcnt lgkmcnt(11)
    v_lshlrev_b32 v208, 16, v60
    v_and_b32 v209, 0xffff0000, v60
    s_waitcnt lgkmcnt(10)
    v_lshlrev_b32 v210, 16, v61
    v_and_b32 v211, 0xffff0000, v61
    s_waitcnt lgkmcnt(9)
    v_lshlrev_b32 v212, 16, v62
    v_and_b32 v213, 0xffff0000, v62
    s_waitcnt lgkmcnt(8)
    v_lshlrev_b32 v214, 16, v63
    v_and_b32 v215, 0xffff0000, v63
    s_waitcnt lgkmcnt(7)
    v_lshlrev_b32 v216, 16, v64
    v_and_b32 v217, 0xffff0000, v64
    s_waitcnt lgkmcnt(6)
    v_lshlrev_b32 v218, 16, v65
    v_and_b32 v219, 0xffff0000, v65
    s_waitcnt lgkmcnt(5)
    v_lshlrev_b32 v220, 16, v66
    v_and_b32 v221, 0xffff0000, v66
    s_waitcnt lgkmcnt(4)
    v_lshlrev_b32 v222, 16, v67
    v_and_b32 v223, 0xffff0000, v67
    s_waitcnt lgkmcnt(3)
    v_lshlrev_b32 v224, 16, v68
    v_and_b32 v225, 0xffff0000, v68
    s_waitcnt lgkmcnt(2)
    v_lshlrev_b32 v226, 16, v69
    v_and_b32 v227, 0xffff0000, v69
    s_waitcnt lgkmcnt(1)
    v_lshlrev_b32 v228, 16, v70
    v_and_b32 v229, 0xffff0000, v70
    s_waitcnt lgkmcnt(0)
    v_lshlrev_b32 v230, 16, v71
    v_and_b32 v231, 0xffff0000, v71
    s_cmp_lg_u32 s3, 0
    s_cbranch_scc1 Lwic_x
    v_min_u32 v32, 49, v1
    v_cmp_lt_u32 vcc, 7, v32
    s_nop 1
    v_cndmask_b32_e64 v33, 0, 7, vcc
    v_add_lshl_u32 v32, v32, v33, 2
    s_branch Lwic_f
Lwic:
    s_sleep 4
Lwic_f:
    global_load_dword v33, v32, s[36:37] sc1
    s_waitcnt vmcnt(0)
    v_cmp_eq_u32 vcc, 0, v33
    s_add_u32 s100, s100, 1
    s_cmp_ge_u32 s100, 262144
    s_cbranch_scc1 Lwic_x
    s_cbranch_vccnz Lwic
Lwic_x:
    s_waitcnt vmcnt(0)
    s_barrier
    s_sub_u32 s4, s42, 5
    s_cmp_ge_u32 s4, 21
    s_cbranch_scc1 Lwp_n3
    v_lshlrev_b32 v134, 16, v132
    v_and_b32 v135, 0xffff0000, v132
    v_lshlrev_b32 v79, 2, v79
    v_mul_f32 v136, 0xbfb8aa3b, v134
    v_mul_f32 v137, 0xbfb8aa3b, v135
    v_exp_f32 v136, v136
    v_exp_f32 v137, v137
    v_add_f32 v136, 1.0, v136
    v_add_f32 v137, 1.0, v137
    v_rcp_f32 v136, v136
    v_rcp_f32 v137, v137
    v_mul_f32 v134, v134, v136
    v_mul_f32 v135, v135, v137
    v_cvt_pk_bf16_f32 v132, v134, v135
    ds_bpermute_b32 v140, v79, v132 offset:0
    ds_bpermute_b32 v141, v79, v132 offset:32
    ds_bpermute_b32 v142, v79, v132 offset:64
    ds_bpermute_b32 v143, v79, v132 offset:96
    ds_bpermute_b32 v144, v79, v132 offset:128
    s_waitcnt lgkmcnt(4)
    v_lshlrev_b32 v80, 16, v140
    v_and_b32 v81, 0xffff0000, v140
    s_waitcnt lgkmcnt(3)
    v_lshlrev_b32 v82, 16, v141
    v_and_b32 v83, 0xffff0000, v141
    s_waitcnt lgkmcnt(2)
    v_lshlrev_b32 v84, 16, v142
    v_and_b32 v85, 0xffff0000, v142
    s_waitcnt lgkmcnt(1)
    v_lshlrev_b32 v86, 16, v143
    v_and_b32 v87, 0xffff0000, v143
    s_waitcnt lgkmcnt(0)
    v_lshlrev_b32 v88, 16, v144
    v_and_b32 v89, 0xffff0000, v144
    v_lshlrev_b32 v132, 16, v92
    v_and_b32 v133, 0xffff0000, v92
    v_lshlrev_b32 v134, 16, v93
    v_and_b32 v135, 0xffff0000, v93
    v_lshlrev_b32 v136, 16, v94
    v_and_b32 v137, 0xffff0000, v94
    v_lshlrev_b32 v138, 16, v95
    v_and_b32 v139, 0xffff0000, v95
    v_pk_mul_f32 v[140:141], v[80:81], v[132:133] op_sel:[0,0] op_sel_hi:[0,1]
    v_pk_mul_f32 v[142:143], v[80:81], v[134:135] op_sel:[0,0] op_sel_hi:[0,1]
    v_pk_mul_f32 v[144:145], v[80:81], v[136:137] op_sel:[0,0] op_sel_hi:[0,1]
    v_pk_mul_f32 v[146:147], v[80:81], v[138:139] op_sel:[0,0] op_sel_hi:[0,1]
    v_lshlrev_b32 v132, 16, v96
    v_and_b32 v133, 0xffff0000, v96
    v_lshlrev_b32 v134, 16, v97
    v_and_b32 v135, 0xffff0000, v97
    v_lshlrev_b32 v136, 16, v98
    v_and_b32 v137, 0xffff0000, v98
    v_lshlrev_b32 v138, 16, v99
    v_and_b32 v139, 0xffff0000, v99
    v_pk_fma_f32 v[140:141], v[80:81], v[132:133], v[140:141] op_sel:[1,0,0] op_sel_hi:[1,1,1]
    v_pk_fma_f32 v[142:143], v[80:81], v[134:135], v[142:143] op_sel:[1,0,0] op_sel_hi:[1,1,1]
    v_pk_fma_f32 v[144:145], v[80:81], v[136:137], v[144:145] op_sel:[1,0,0] op_sel_hi:[1,1,1]
    v_pk_fma_f32 v[146:147], v[80:81], v[138:139], v[146:147] op_sel:[1,0,0] op_sel_hi:[1,1,1]
    v_lshlrev_b32 v132, 16, v100
    v_and_b32 v133, 0xffff0000, v100
    v_lshlrev_b32 v134, 16, v101
    v_and_b32 v135, 0xffff0000, v101
    v_lshlrev_b32 v136, 16, v102
    v_and_b32 v137, 0xffff0000, v102
    v_lshlrev_b32 v138, 16, v103
    v_and_b32 v139, 0xffff0000, v103
    v_pk_fma_f32 v[140:141], v[82:83], v[132:133], v[140:141] op_sel:[0,0,0] op_sel_hi:[0,1,1]
    v_pk_fma_f32 v[142:143], v[82:83], v[134:135], v[142:143] op_sel:[0,0,0] op_sel_hi:[0,1,1]
    v_pk_fma_f32 v[144:145], v[82:83], v[136:137], v[144:145] op_sel:[0,0,0] op_sel_hi:[0,1,1]
    v_pk_fma_f32 v[146:147], v[82:83], v[138:139], v[146:147] op_sel:[0,0,0] op_sel_hi:[0,1,1]
    v_lshlrev_b32 v132, 16, v104
    v_and_b32 v133, 0xffff0000, v104
    v_lshlrev_b32 v134, 16, v105
    v_and_b32 v135, 0xffff0000, v105
    v_lshlrev_b32 v136, 16, v106
    v_and_b32 v137, 0xffff0000, v106
    v_lshlrev_b32 v138, 16, v107
    v_and_b32 v139, 0xffff0000, v107
    v_pk_fma_f32 v[140:141], v[82:83], v[132:133], v[140:141] op_sel:[1,0,0] op_sel_hi:[1,1,1]
    v_pk_fma_f32 v[142:143], v[82:83], v[134:135], v[142:143] op_sel:[1,0,0] op_sel_hi:[1,1,1]
    v_pk_fma_f32 v[144:145], v[82:83], v[136:137], v[144:145] op_sel:[1,0,0] op_sel_hi:[1,1,1]
    v_pk_fma_f32 v[146:147], v[82:83], v[138:139], v[146:147] op_sel:[1,0,0] op_sel_hi:[1,1,1]
    v_lshlrev_b32 v132, 16, v108
    v_and_b32 v133, 0xffff0000, v108
    v_lshlrev_b32 v134, 16, v109
    v_and_b32 v135, 0xffff0000, v109
    v_lshlrev_b32 v136, 16, v110
    v_and_b32 v137, 0xffff0000, v110
    v_lshlrev_b32 v138, 16, v111
    v_and_b32 v139, 0xffff0000, v111
    v_pk_fma_f32 v[140:141], v[84:85], v[132:133], v[140:141] op_sel:[0,0,0] op_sel_hi:[0,1,1]
    v_pk_fma_f32 v[142:143], v[84:85], v[134:135], v[142:143] op_sel:[0,0,0] op_sel_hi:[0,1,1]
    v_pk_fma_f32 v[144:145], v[84:85], v[136:137], v[144:145] op_sel:[0,0,0] op_sel_hi:[0,1,1]
    v_pk_fma_f32 v[146:147], v[84:85], v[138:139], v[146:147] op_sel:[0,0,0] op_sel_hi:[0,1,1]
    v_lshlrev_b32 v132, 16, v112
    v_and_b32 v133, 0xffff0000, v112
    v_lshlrev_b32 v134, 16, v113
    v_and_b32 v135, 0xffff0000, v113
    v_lshlrev_b32 v136, 16, v114
    v_and_b32 v137, 0xffff0000, v114
    v_lshlrev_b32 v138, 16, v115
    v_and_b32 v139, 0xffff0000, v115
    v_pk_fma_f32 v[140:141], v[84:85], v[132:133], v[140:141] op_sel:[1,0,0] op_sel_hi:[1,1,1]
    v_pk_fma_f32 v[142:143], v[84:85], v[134:135], v[142:143] op_sel:[1,0,0] op_sel_hi:[1,1,1]
    v_pk_fma_f32 v[144:145], v[84:85], v[136:137], v[144:145] op_sel:[1,0,0] op_sel_hi:[1,1,1]
    v_pk_fma_f32 v[146:147], v[84:85], v[138:139], v[146:147] op_sel:[1,0,0] op_sel_hi:[1,1,1]
    v_lshlrev_b32 v132, 16, v116
    v_and_b32 v133, 0xffff0000, v116
    v_lshlrev_b32 v134, 16, v117
    v_and_b32 v135, 0xffff0000, v117
    v_lshlrev_b32 v136, 16, v118
    v_and_b32 v137, 0xffff0000, v118
    v_lshlrev_b32 v138, 16, v119
    v_and_b32 v139, 0xffff0000, v119
    v_pk_fma_f32 v[140:141], v[86:87], v[132:133], v[140:141] op_sel:[0,0,0] op_sel_hi:[0,1,1]
    v_pk_fma_f32 v[142:143], v[86:87], v[134:135], v[142:143] op_sel:[0,0,0] op_sel_hi:[0,1,1]
    v_pk_fma_f32 v[144:145], v[86:87], v[136:137], v[144:145] op_sel:[0,0,0] op_sel_hi:[0,1,1]
    v_pk_fma_f32 v[146:147], v[86:87], v[138:139], v[146:147] op_sel:[0,0,0] op_sel_hi:[0,1,1]
    v_lshlrev_b32 v132, 16, v120
    v_and_b32 v133, 0xffff0000, v120
    v_lshlrev_b32 v134, 16, v121
    v_and_b32 v135, 0xffff0000, v121
    v_lshlrev_b32 v136, 16, v122
    v_and_b32 v137, 0xffff0000, v122
    v_lshlrev_b32 v138, 16, v123
    v_and_b32 v139, 0xffff0000, v123
    v_pk_fma_f32 v[140:141], v[86:87], v[132:133], v[140:141] op_sel:[1,0,0] op_sel_hi:[1,1,1]
    v_pk_fma_f32 v[142:143], v[86:87], v[134:135], v[142:143] op_sel:[1,0,0] op_sel_hi:[1,1,1]
    v_pk_fma_f32 v[144:145], v[86:87], v[136:137], v[144:145] op_sel:[1,0,0] op_sel_hi:[1,1,1]
    v_pk_fma_f32 v[146:147], v[86:87], v[138:139], v[146:147] op_sel:[1,0,0] op_sel_hi:[1,1,1]
    v_lshlrev_b32 v132, 16, v124
    v_and_b32 v133, 0xffff0000, v124
    v_lshlrev_b32 v134, 16, v125
    v_and_b32 v135, 0xffff0000, v125
    v_lshlrev_b32 v136, 16, v126
    v_and_b32 v137, 0xffff0000, v126
    v_lshlrev_b32 v138, 16, v127
    v_and_b32 v139, 0xffff0000, v127
    v_pk_fma_f32 v[140:141], v[88:89], v[132:133], v[140:141] op_sel:[0,0,0] op_sel_hi:[0,1,1]
    v_pk_fma_f32 v[142:143], v[88:89], v[134:135], v[142:143] op_sel:[0,0,0] op_sel_hi:[0,1,1]
    v_pk_fma_f32 v[144:145], v[88:89], v[136:137], v[144:145] op_sel:[0,0,0] op_sel_hi:[0,1,1]
    v_pk_fma_f32 v[146:147], v[88:89], v[138:139], v[146:147] op_sel:[0,0,0] op_sel_hi:[0,1,1]
    v_lshlrev_b32 v132, 16, v128
    v_and_b32 v133, 0xffff0000, v128
    v_lshlrev_b32 v134, 16, v129
    v_and_b32 v135, 0xffff0000, v129
    v_lshlrev_b32 v136, 16, v130
    v_and_b32 v137, 0xffff0000, v130
    v_lshlrev_b32 v138, 16, v131
    v_and_b32 v139, 0xffff0000, v131
    v_pk_fma_f32 v[140:141], v[88:89], v[132:133], v[140:141] op_sel:[1,0,0] op_sel_hi:[1,1,1]
    v_pk_fma_f32 v[142:143], v[88:89], v[134:135], v[142:143] op_sel:[1,0,0] op_sel_hi:[1,1,1]
    v_pk_fma_f32 v[144:145], v[88:89], v[136:137], v[144:145] op_sel:[1,0,0] op_sel_hi:[1,1,1]
    v_pk_fma_f32 v[146:147], v[88:89], v[138:139], v[146:147] op_sel:[1,0,0] op_sel_hi:[1,1,1]
    s_nop 0
    v_permlane32_swap_b32 v140, v144
    v_permlane32_swap_b32 v141, v145
    v_permlane32_swap_b32 v142, v146
    v_permlane32_swap_b32 v143, v147
    v_add_f32 v140, v140, v144
    v_add_f32 v141, v141, v145
    v_add_f32 v142, v142, v146
    v_add_f32 v143, v143, v147
    s_nop 0
    v_permlane16_swap_b32 v140, v142
    v_permlane16_swap_b32 v141, v143
    v_add_f32 v140, v140, v142
    v_add_f32 v141, v141, v143
    v_and_b32 v133, 7, v1
    v_lshrrev_b32 v134, 3, v1
    v_add_f32_dpp v132, v140, v140 row_ror:8 row_mask:0xf bank_mask:0x3
    s_nop 1
    v_add_f32_dpp v132, v141, v141 row_ror:8 row_mask:0xf bank_mask:0xc
    v_lshl_add_u32 v133, v133, 3, v134
    s_lshl_b32 s7, s3, 8
    s_add_u32 s7, s7, 122880
    v_lshl_add_u32 v133, v133, 2, s7
    ds_write_b32 v133, v132
    s_waitcnt lgkmcnt(0)
    s_barrier
    v_lshlrev_b32 v133, 2, v1
    v_add_u32 v134, 122880, v133
    ds_read_b32 v140, v134 offset:0
    ds_read_b32 v141, v134 offset:256
    ds_read_b32 v142, v134 offset:512
    ds_read_b32 v143, v134 offset:768
    v_add_u32 v133, s47, v133
    s_waitcnt lgkmcnt(2)
    v_add_f32 v140, v140, v141
    s_waitcnt lgkmcnt(0)
    v_add_f32 v142, v142, v143
    v_add_f32 v140, v140, v142
    v_min_u32 v140, -2, v140
    s_cmp_lg_u32 s3, 0
    s_cbranch_scc1 Lmod_skip_w
    global_store_dword v133, v140, s[38:39] offset:0 sc1
Lmod_skip_w:
Lwp_n3:
    s_branch Lwm_f
Lwm:
    s_sleep 4
Lwm_f:
    v_add_u32 v77, 0, v73
    global_load_dwordx4 v[80:83], v77, s[38:39] sc1
    global_load_dwordx4 v[84:87], v77, s[38:39] offset:2560 sc1
    v_add_u32 v77, 15360, v73
    global_load_dwordx4 v[88:91], v77, s[38:39] sc1
    global_load_dwordx4 v[92:95], v77, s[38:39] offset:2560 sc1
    s_waitcnt vmcnt(0)
    v_max_u32 v77, v80, v81
    v_max3_u32 v77, v82, v83, v77
    v_max3_u32 v77, v84, v85, v77
    v_max3_u32 v77, v86, v87, v77
    v_max3_u32 v77, v88, v89, v77
    v_max3_u32 v77, v90, v91, v77
    v_max3_u32 v77, v92, v93, v77
    v_max3_u32 v77, v94, v95, v77
    v_cmp_eq_u32 vcc, -1, v77
    s_add_u32 s100, s100, 1
    s_cmp_ge_u32 s100, 262144
    s_cbranch_scc1 Lwm_x
    s_cbranch_vccnz Lwm
Lwm_x:
    v_pk_add_f32 v[80:81], v[80:81], v[88:89] op_sel:[0,0] op_sel_hi:[1,1]
    v_pk_add_f32 v[82:83], v[82:83], v[90:91] op_sel:[0,0] op_sel_hi:[1,1]
    v_pk_add_f32 v[84:85], v[84:85], v[92:93] op_sel:[0,0] op_sel_hi:[1,1]
    v_pk_add_f32 v[86:87], v[86:87], v[94:95] op_sel:[0,0] op_sel_hi:[1,1]
    v_cvt_pk_bf16_f32 v80, v80, v80
    v_lshlrev_b32 v80, 16, v80
    v_cvt_pk_bf16_f32 v81, v81, v81
    v_lshlrev_b32 v81, 16, v81
    v_cvt_pk_bf16_f32 v82, v82, v82
    v_lshlrev_b32 v82, 16, v82
    v_cvt_pk_bf16_f32 v83, v83, v83
    v_lshlrev_b32 v83, 16, v83
    v_cvt_pk_bf16_f32 v84, v84, v84
    v_lshlrev_b32 v84, 16, v84
    v_cvt_pk_bf16_f32 v85, v85, v85
    v_lshlrev_b32 v85, 16, v85
    v_cvt_pk_bf16_f32 v86, v86, v86
    v_lshlrev_b32 v86, 16, v86
    v_cvt_pk_bf16_f32 v87, v87, v87
    v_lshlrev_b32 v87, 16, v87
    v_add_f32 v84, 1.0, v84
    v_add_f32 v85, 1.0, v85
    v_add_f32 v86, 1.0, v86
    v_add_f32 v87, 1.0, v87
    v_cvt_pk_bf16_f32 v84, v84, v84
    v_lshlrev_b32 v84, 16, v84
    v_cvt_pk_bf16_f32 v85, v85, v85
    v_lshlrev_b32 v85, 16, v85
    v_cvt_pk_bf16_f32 v86, v86, v86
    v_lshlrev_b32 v86, 16, v86
    v_cvt_pk_bf16_f32 v87, v87, v87
    v_lshlrev_b32 v87, 16, v87
    ds_write_b128 v72, v[84:87]
    ds_write_b128 v72, v[80:83] offset:640
    ds_read_b128 v[32:35], v74 offset:0
    ds_read_b128 v[36:39], v74 offset:16
    ds_read_b128 v[40:43], v74 offset:128
    ds_read_b128 v[44:47], v74 offset:144
    ds_read_b128 v[48:51], v74 offset:256
    ds_read_b128 v[52:55], v74 offset:272
    ds_read_b128 v[56:59], v74 offset:384
    ds_read_b128 v[60:63], v74 offset:400
    ds_read_b128 v[64:67], v74 offset:512
    ds_read_b128 v[68:71], v74 offset:528
    s_waitcnt lgkmcnt(9)
    v_pk_mul_f32 v[96:97], v[32:33], v[152:153] op_sel:[0,0] op_sel_hi:[0,1]
    v_pk_mul_f32 v[98:99], v[32:33], v[154:155] op_sel:[1,0] op_sel_hi:[1,1]
    v_pk_mul_f32 v[100:101], v[34:35], v[156:157] op_sel:[0,0] op_sel_hi:[0,1]
    v_pk_mul_f32 v[102:103], v[34:35], v[158:159] op_sel:[1,0] op_sel_hi:[1,1]
    s_waitcnt lgkmcnt(8)
    v_pk_mul_f32 v[104:105], v[36:37], v[160:161] op_sel:[0,0] op_sel_hi:[0,1]
    v_pk_mul_f32 v[106:107], v[36:37], v[162:163] op_sel:[1,0] op_sel_hi:[1,1]
    v_pk_mul_f32 v[108:109], v[38:39], v[164:165] op_sel:[0,0] op_sel_hi:[0,1]
    v_pk_mul_f32 v[110:111], v[38:39], v[166:167] op_sel:[1,0] op_sel_hi:[1,1]
    v_cvt_pk_bf16_f32 v112, v96, v98
    v_cvt_pk_bf16_f32 v113, v100, v102
    v_cvt_pk_bf16_f32 v114, v104, v106
    v_cvt_pk_bf16_f32 v115, v108, v110
    v_cvt_pk_bf16_f32 v116, v97, v99
    v_cvt_pk_bf16_f32 v117, v101, v103
    v_cvt_pk_bf16_f32 v118, v105, v107
    v_cvt_pk_bf16_f32 v119, v109, v111
    global_store_dwordx4 v75, v[112:115], s[38:39] offset:-2048 sc1
    global_store_dwordx4 v76, v[116:119], s[38:39] offset:-2048 sc1
    s_waitcnt lgkmcnt(7)
    v_pk_mul_f32 v[96:97], v[40:41], v[168:169] op_sel:[0,0] op_sel_hi:[0,1]
    v_pk_mul_f32 v[98:99], v[40:41], v[170:171] op_sel:[1,0] op_sel_hi:[1,1]
    v_pk_mul_f32 v[100:101], v[42:43], v[172:173] op_sel:[0,0] op_sel_hi:[0,1]
    v_pk_mul_f32 v[102:103], v[42:43], v[174:175] op_sel:[1,0] op_sel_hi:[1,1]
    s_waitcnt lgkmcnt(6)
    v_pk_mul_f32 v[104:105], v[44:45], v[176:177] op_sel:[0,0] op_sel_hi:[0,1]
    v_pk_mul_f32 v[106:107], v[44:45], v[178:179] op_sel:[1,0] op_sel_hi:[1,1]
    v_pk_mul_f32 v[108:109], v[46:47], v[180:181] op_sel:[0,0] op_sel_hi:[0,1]
    v_pk_mul_f32 v[110:111], v[46:47], v[182:183] op_sel:[1,0] op_sel_hi:[1,1]
    v_cvt_pk_bf16_f32 v120, v96, v98
    v_cvt_pk_bf16_f32 v121, v100, v102
    v_cvt_pk_bf16_f32 v122, v104, v106
    v_cvt_pk_bf16_f32 v123, v108, v110
    v_cvt_pk_bf16_f32 v124, v97, v99
    v_cvt_pk_bf16_f32 v125, v101, v103
    v_cvt_pk_bf16_f32 v126, v105, v107
    v_cvt_pk_bf16_f32 v127, v109, v111
    global_store_dwordx4 v75, v[120:123], s[38:39] offset:-1024 sc1
    global_store_dwordx4 v76, v[124:127], s[38:39] offset:-1024 sc1
    s_waitcnt lgkmcnt(5)
    v_pk_mul_f32 v[96:97], v[48:49], v[184:185] op_sel:[0,0] op_sel_hi:[0,1]
    v_pk_mul_f32 v[98:99], v[48:49], v[186:187] op_sel:[1,0] op_sel_hi:[1,1]
    v_pk_mul_f32 v[100:101], v[50:51], v[188:189] op_sel:[0,0] op_sel_hi:[0,1]
    v_pk_mul_f32 v[102:103], v[50:51], v[190:191] op_sel:[1,0] op_sel_hi:[1,1]
    s_waitcnt lgkmcnt(4)
    v_pk_mul_f32 v[104:105], v[52:53], v[192:193] op_sel:[0,0] op_sel_hi:[0,1]
    v_pk_mul_f32 v[106:107], v[52:53], v[194:195] op_sel:[1,0] op_sel_hi:[1,1]
    v_pk_mul_f32 v[108:109], v[54:55], v[196:197] op_sel:[0,0] op_sel_hi:[0,1]
    v_pk_mul_f32 v[110:111], v[54:55], v[198:199] op_sel:[1,0] op_sel_hi:[1,1]
    v_cvt_pk_bf16_f32 v128, v96, v98
    v_cvt_pk_bf16_f32 v129, v100, v102
    v_cvt_pk_bf16_f32 v130, v104, v106
    v_cvt_pk_bf16_f32 v131, v108, v110
    v_cvt_pk_bf16_f32 v132, v97, v99
    v_cvt_pk_bf16_f32 v133, v101, v103
    v_cvt_pk_bf16_f32 v134, v105, v107
    v_cvt_pk_bf16_f32 v135, v109, v111
    global_store_dwordx4 v75, v[128:131], s[38:39] offset:0 sc1
    global_store_dwordx4 v76, v[132:135], s[38:39] offset:0 sc1
    s_waitcnt lgkmcnt(3)
    v_pk_mul_f32 v[96:97], v[56:57], v[200:201] op_sel:[0,0] op_sel_hi:[0,1]
    v_pk_mul_f32 v[98:99], v[56:57], v[202:203] op_sel:[1,0] op_sel_hi:[1,1]
    v_pk_mul_f32 v[100:101], v[58:59], v[204:205] op_sel:[0,0] op_sel_hi:[0,1]
    v_pk_mul_f32 v[102:103], v[58:59], v[206:207] op_sel:[1,0] op_sel_hi:[1,1]
    s_waitcnt lgkmcnt(2)
    v_pk_mul_f32 v[104:105], v[60:61], v[208:209] op_sel:[0,0] op_sel_hi:[0,1]
    v_pk_mul_f32 v[106:107], v[60:61], v[210:211] op_sel:[1,0] op_sel_hi:[1,1]
    v_pk_mul_f32 v[108:109], v[62:63], v[212:213] op_sel:[0,0] op_sel_hi:[0,1]
    v_pk_mul_f32 v[110:111], v[62:63], v[214:215] op_sel:[1,0] op_sel_hi:[1,1]
    v_cvt_pk_bf16_f32 v136, v96, v98
    v_cvt_pk_bf16_f32 v137, v100, v102
    v_cvt_pk_bf16_f32 v138, v104, v106
    v_cvt_pk_bf16_f32 v139, v108, v110
    v_cvt_pk_bf16_f32 v140, v97, v99
    v_cvt_pk_bf16_f32 v141, v101, v103
    v_cvt_pk_bf16_f32 v142, v105, v107
    v_cvt_pk_bf16_f32 v143, v109, v111
    global_store_dwordx4 v75, v[136:139], s[38:39] offset:1024 sc1
    global_store_dwordx4 v76, v[140:143], s[38:39] offset:1024 sc1
    s_waitcnt lgkmcnt(1)
    v_pk_mul_f32 v[96:97], v[64:65], v[216:217] op_sel:[0,0] op_sel_hi:[0,1]
    v_pk_mul_f32 v[98:99], v[64:65], v[218:219] op_sel:[1,0] op_sel_hi:[1,1]
    v_pk_mul_f32 v[100:101], v[66:67], v[220:221] op_sel:[0,0] op_sel_hi:[0,1]
    v_pk_mul_f32 v[102:103], v[66:67], v[222:223] op_sel:[1,0] op_sel_hi:[1,1]
    s_waitcnt lgkmcnt(0)
    v_pk_mul_f32 v[104:105], v[68:69], v[224:225] op_sel:[0,0] op_sel_hi:[0,1]
    v_pk_mul_f32 v[106:107], v[68:69], v[226:227] op_sel:[1,0] op_sel_hi:[1,1]
    v_pk_mul_f32 v[108:109], v[70:71], v[228:229] op_sel:[0,0] op_sel_hi:[0,1]
    v_pk_mul_f32 v[110:111], v[70:71], v[230:231] op_sel:[1,0] op_sel_hi:[1,1]
    v_cvt_pk_bf16_f32 v144, v96, v98
    v_cvt_pk_bf16_f32 v145, v100, v102
    v_cvt_pk_bf16_f32 v146, v104, v106
    v_cvt_pk_bf16_f32 v147, v108, v110
    v_cvt_pk_bf16_f32 v148, v97, v99
    v_cvt_pk_bf16_f32 v149, v101, v103
    v_cvt_pk_bf16_f32 v150, v105, v107
    v_cvt_pk_bf16_f32 v151, v109, v111
    global_store_dwordx4 v75, v[144:147], s[38:39] offset:2048 sc1
    global_store_dwordx4 v76, v[148:151], s[38:39] offset:2048 sc1
    ds_read_b128 v[32:35], v74 offset:640
    ds_read_b128 v[36:39], v74 offset:656
    ds_read_b128 v[40:43], v74 offset:768
    ds_read_b128 v[44:47], v74 offset:784
    ds_read_b128 v[48:51], v74 offset:896
    ds_read_b128 v[52:55], v74 offset:912
    ds_read_b128 v[56:59], v74 offset:1024
    ds_read_b128 v[60:63], v74 offset:1040
    ds_read_b128 v[64:67], v74 offset:1152
    ds_read_b128 v[68:71], v74 offset:1168
    s_mov_b32 s7, 0x3f803f80
    v_mov_b32 v88, 0
    v_mov_b32 v89, 0
    v_mov_b32 v90, 0
    v_mov_b32 v91, 0
    v_mov_b32 v92, 0
    v_mov_b32 v93, 0
    v_mov_b32 v94, 0
    v_mov_b32 v95, 0
    v_dot2_f32_bf16 v88, v112, s7, v88
    v_dot2_f32_bf16 v89, v116, s7, v89
    v_dot2_f32_bf16 v88, v113, s7, v88
    v_dot2_f32_bf16 v89, v117, s7, v89
    v_dot2_f32_bf16 v88, v114, s7, v88
    v_dot2_f32_bf16 v89, v118, s7, v89
    v_dot2_f32_bf16 v88, v115, s7, v88
    v_dot2_f32_bf16 v89, v119, s7, v89
    v_dot2_f32_bf16 v88, v120, s7, v88
    v_dot2_f32_bf16 v89, v124, s7, v89
    v_dot2_f32_bf16 v88, v121, s7, v88
    v_dot2_f32_bf16 v89, v125, s7, v89
    v_dot2_f32_bf16 v88, v122, s7, v88
    v_dot2_f32_bf16 v89, v126, s7, v89
    v_dot2_f32_bf16 v88, v123, s7, v88
    v_dot2_f32_bf16 v89, v127, s7, v89
    v_dot2_f32_bf16 v88, v128, s7, v88
    v_dot2_f32_bf16 v89, v132, s7, v89
    v_dot2_f32_bf16 v88, v129, s7, v88
    v_dot2_f32_bf16 v89, v133, s7, v89
    v_dot2_f32_bf16 v88, v130, s7, v88
    v_dot2_f32_bf16 v89, v134, s7, v89
    v_dot2_f32_bf16 v88, v131, s7, v88
    v_dot2_f32_bf16 v89, v135, s7, v89
    v_dot2_f32_bf16 v88, v136, s7, v88
    v_dot2_f32_bf16 v89, v140, s7, v89
    v_dot2_f32_bf16 v88, v137, s7, v88
    v_dot2_f32_bf16 v89, v141, s7, v89
    v_dot2_f32_bf16 v88, v138, s7, v88
    v_dot2_f32_bf16 v89, v142, s7, v89
    v_dot2_f32_bf16 v88, v139, s7, v88
    v_dot2_f32_bf16 v89, v143, s7, v89
    v_dot2_f32_bf16 v88, v144, s7, v88
    v_dot2_f32_bf16 v89, v148, s7, v89
    v_dot2_f32_bf16 v88, v145, s7, v88
    v_dot2_f32_bf16 v89, v149, s7, v89
    v_dot2_f32_bf16 v88, v146, s7, v88
    v_dot2_f32_bf16 v89, v150, s7, v89
    v_dot2_f32_bf16 v88, v147, s7, v88
    v_dot2_f32_bf16 v89, v151, s7, v89
    s_waitcnt lgkmcnt(9)
    v_pk_fma_f32 v[90:91], v[32:33], v[152:153], v[90:91] op_sel:[0,0,0] op_sel_hi:[0,1,1]
    v_pk_fma_f32 v[92:93], v[32:33], v[154:155], v[92:93] op_sel:[1,0,0] op_sel_hi:[1,1,1]
    v_pk_fma_f32 v[94:95], v[34:35], v[156:157], v[94:95] op_sel:[0,0,0] op_sel_hi:[0,1,1]
    v_pk_fma_f32 v[90:91], v[34:35], v[158:159], v[90:91] op_sel:[1,0,0] op_sel_hi:[1,1,1]
    s_waitcnt lgkmcnt(8)
    v_pk_fma_f32 v[92:93], v[36:37], v[160:161], v[92:93] op_sel:[0,0,0] op_sel_hi:[0,1,1]
    v_pk_fma_f32 v[94:95], v[36:37], v[162:163], v[94:95] op_sel:[1,0,0] op_sel_hi:[1,1,1]
    v_pk_fma_f32 v[90:91], v[38:39], v[164:165], v[90:91] op_sel:[0,0,0] op_sel_hi:[0,1,1]
    v_pk_fma_f32 v[92:93], v[38:39], v[166:167], v[92:93] op_sel:[1,0,0] op_sel_hi:[1,1,1]
    s_waitcnt lgkmcnt(7)
    v_pk_fma_f32 v[94:95], v[40:41], v[168:169], v[94:95] op_sel:[0,0,0] op_sel_hi:[0,1,1]
    v_pk_fma_f32 v[90:91], v[40:41], v[170:171], v[90:91] op_sel:[1,0,0] op_sel_hi:[1,1,1]
    v_pk_fma_f32 v[92:93], v[42:43], v[172:173], v[92:93] op_sel:[0,0,0] op_sel_hi:[0,1,1]
    v_pk_fma_f32 v[94:95], v[42:43], v[174:175], v[94:95] op_sel:[1,0,0] op_sel_hi:[1,1,1]
    s_waitcnt lgkmcnt(6)
    v_pk_fma_f32 v[90:91], v[44:45], v[176:177], v[90:91] op_sel:[0,0,0] op_sel_hi:[0,1,1]
    v_pk_fma_f32 v[92:93], v[44:45], v[178:179], v[92:93] op_sel:[1,0,0] op_sel_hi:[1,1,1]
    v_pk_fma_f32 v[94:95], v[46:47], v[180:181], v[94:95] op_sel:[0,0,0] op_sel_hi:[0,1,1]
    v_pk_fma_f32 v[90:91], v[46:47], v[182:183], v[90:91] op_sel:[1,0,0] op_sel_hi:[1,1,1]
    s_waitcnt lgkmcnt(5)
    v_pk_fma_f32 v[92:93], v[48:49], v[184:185], v[92:93] op_sel:[0,0,0] op_sel_hi:[0,1,1]
    v_pk_fma_f32 v[94:95], v[48:49], v[186:187], v[94:95] op_sel:[1,0,0] op_sel_hi:[1,1,1]
    v_pk_fma_f32 v[90:91], v[50:51], v[188:189], v[90:91] op_sel:[0,0,0] op_sel_hi:[0,1,1]
    v_pk_fma_f32 v[92:93], v[50:51], v[190:191], v[92:93] op_sel:[1,0,0] op_sel_hi:[1,1,1]
    s_waitcnt lgkmcnt(4)
    v_pk_fma_f32 v[94:95], v[52:53], v[192:193], v[94:95] op_sel:[0,0,0] op_sel_hi:[0,1,1]
    v_pk_fma_f32 v[90:91], v[52:53], v[194:195], v[90:91] op_sel:[1,0,0] op_sel_hi:[1,1,1]
    v_pk_fma_f32 v[92:93], v[54:55], v[196:197], v[92:93] op_sel:[0,0,0] op_sel_hi:[0,1,1]
    v_pk_fma_f32 v[94:95], v[54:55], v[198:199], v[94:95] op_sel:[1,0,0] op_sel_hi:[1,1,1]
    s_waitcnt lgkmcnt(3)
    v_pk_fma_f32 v[90:91], v[56:57], v[200:201], v[90:91] op_sel:[0,0,0] op_sel_hi:[0,1,1]
    v_pk_fma_f32 v[92:93], v[56:57], v[202:203], v[92:93] op_sel:[1,0,0] op_sel_hi:[1,1,1]
    v_pk_fma_f32 v[94:95], v[58:59], v[204:205], v[94:95] op_sel:[0,0,0] op_sel_hi:[0,1,1]
    v_pk_fma_f32 v[90:91], v[58:59], v[206:207], v[90:91] op_sel:[1,0,0] op_sel_hi:[1,1,1]
    s_waitcnt lgkmcnt(2)
    v_pk_fma_f32 v[92:93], v[60:61], v[208:209], v[92:93] op_sel:[0,0,0] op_sel_hi:[0,1,1]
    v_pk_fma_f32 v[94:95], v[60:61], v[210:211], v[94:95] op_sel:[1,0,0] op_sel_hi:[1,1,1]
    v_pk_fma_f32 v[90:91], v[62:63], v[212:213], v[90:91] op_sel:[0,0,0] op_sel_hi:[0,1,1]
    v_pk_fma_f32 v[92:93], v[62:63], v[214:215], v[92:93] op_sel:[1,0,0] op_sel_hi:[1,1,1]
    s_waitcnt lgkmcnt(1)
    v_pk_fma_f32 v[94:95], v[64:65], v[216:217], v[94:95] op_sel:[0,0,0] op_sel_hi:[0,1,1]
    v_pk_fma_f32 v[90:91], v[64:65], v[218:219], v[90:91] op_sel:[1,0,0] op_sel_hi:[1,1,1]
    v_pk_fma_f32 v[92:93], v[66:67], v[220:221], v[92:93] op_sel:[0,0,0] op_sel_hi:[0,1,1]
    v_pk_fma_f32 v[94:95], v[66:67], v[222:223], v[94:95] op_sel:[1,0,0] op_sel_hi:[1,1,1]
    s_waitcnt lgkmcnt(0)
    v_pk_fma_f32 v[90:91], v[68:69], v[224:225], v[90:91] op_sel:[0,0,0] op_sel_hi:[0,1,1]
    v_pk_fma_f32 v[92:93], v[68:69], v[226:227], v[92:93] op_sel:[1,0,0] op_sel_hi:[1,1,1]
    v_pk_fma_f32 v[94:95], v[70:71], v[228:229], v[94:95] op_sel:[0,0,0] op_sel_hi:[0,1,1]
    v_pk_fma_f32 v[90:91], v[70:71], v[230:231], v[90:91] op_sel:[1,0,0] op_sel_hi:[1,1,1]
    v_pk_add_f32 v[90:91], v[90:91], v[92:93] op_sel:[0,0] op_sel_hi:[1,1]
    v_pk_add_f32 v[90:91], v[90:91], v[94:95] op_sel:[0,0] op_sel_hi:[1,1]
    v_permlane32_swap_b32 v88, v89
    s_nop 0
    v_permlane32_swap_b32 v90, v91
    v_add_f32 v88, v88, v89
    v_add_f32 v90, v90, v91
    s_nop 1
    v_permlane16_swap_b32 v88, v90
    v_add_f32 v88, v88, v90
    v_lshlrev_b32 v74, 2, v0
    v_add_u32 v74, 131072, v74
    ds_write_b32 v74, v88
    v_xor_b32 v74, 256, v74
    s_waitcnt vmcnt(0) lgkmcnt(0)
    s_barrier
    ds_read_b32 v89, v74
    s_lshl_b32 s6, s46, 7
    s_lshr_b32 s5, s44, 1
    s_mul_i32 s5, s5, 14336
    s_add_u32 s6, s6, s5
    s_add_u32 s6, s6, 49152
    v_lshl_add_u32 v74, v1, 2, s6
    s_waitcnt lgkmcnt(0)
    v_add_f32 v88, v88, v89
    v_min_u32 v88, -2, v88
    s_bitcmp1_b32 s3, 0
    s_cbranch_scc1 Lwp_skip
    global_store_dword v74, v88, s[38:39] sc1
Lwp_skip:
    s_branch Lsp_c
Lsp_b3:
    v_lshlrev_b32 v82, 16, v80
    v_and_b32 v83, 0xffff0000, v80
    v_lshlrev_b32 v29, 2, v29
    v_mul_f32 v84, 0xbfb8aa3b, v82
    v_mul_f32 v85, 0xbfb8aa3b, v83
    v_exp_f32 v84, v84
    v_exp_f32 v85, v85
    v_add_f32 v84, 1.0, v84
    v_add_f32 v85, 1.0, v85
    v_rcp_f32 v84, v84
    v_rcp_f32 v85, v85
    v_mul_f32 v82, v82, v84
    v_mul_f32 v83, v83, v85
    v_cvt_pk_bf16_f32 v80, v82, v83
    ds_bpermute_b32 v88, v29, v80 offset:0
    ds_bpermute_b32 v89, v29, v80 offset:32
    ds_bpermute_b32 v90, v29, v80 offset:64
    ds_bpermute_b32 v91, v29, v80 offset:96
    ds_bpermute_b32 v92, v29, v80 offset:128
    s_waitcnt lgkmcnt(4)
    v_lshlrev_b32 v30, 16, v88
    v_and_b32 v31, 0xffff0000, v88
    s_waitcnt lgkmcnt(3)
    v_lshlrev_b32 v32, 16, v89
    v_and_b32 v33, 0xffff0000, v89
    s_waitcnt lgkmcnt(2)
    v_lshlrev_b32 v34, 16, v90
    v_and_b32 v35, 0xffff0000, v90
    s_waitcnt lgkmcnt(1)
    v_lshlrev_b32 v36, 16, v91
    v_and_b32 v37, 0xffff0000, v91
    s_waitcnt lgkmcnt(0)
    v_lshlrev_b32 v38, 16, v92
    v_and_b32 v39, 0xffff0000, v92
    v_lshlrev_b32 v80, 16, v40
    v_and_b32 v81, 0xffff0000, v40
    v_lshlrev_b32 v82, 16, v41
    v_and_b32 v83, 0xffff0000, v41
    v_lshlrev_b32 v84, 16, v42
    v_and_b32 v85, 0xffff0000, v42
    v_lshlrev_b32 v86, 16, v43
    v_and_b32 v87, 0xffff0000, v43
    v_pk_mul_f32 v[88:89], v[30:31], v[80:81] op_sel:[0,0] op_sel_hi:[0,1]
    v_pk_mul_f32 v[90:91], v[30:31], v[82:83] op_sel:[0,0] op_sel_hi:[0,1]
    v_pk_mul_f32 v[92:93], v[30:31], v[84:85] op_sel:[0,0] op_sel_hi:[0,1]
    v_pk_mul_f32 v[94:95], v[30:31], v[86:87] op_sel:[0,0] op_sel_hi:[0,1]
    v_lshlrev_b32 v80, 16, v44
    v_and_b32 v81, 0xffff0000, v44
    v_lshlrev_b32 v82, 16, v45
    v_and_b32 v83, 0xffff0000, v45
    v_lshlrev_b32 v84, 16, v46
    v_and_b32 v85, 0xffff0000, v46
    v_lshlrev_b32 v86, 16, v47
    v_and_b32 v87, 0xffff0000, v47
    v_pk_fma_f32 v[88:89], v[30:31], v[80:81], v[88:89] op_sel:[1,0,0] op_sel_hi:[1,1,1]
    v_pk_fma_f32 v[90:91], v[30:31], v[82:83], v[90:91] op_sel:[1,0,0] op_sel_hi:[1,1,1]
    v_pk_fma_f32 v[92:93], v[30:31], v[84:85], v[92:93] op_sel:[1,0,0] op_sel_hi:[1,1,1]
    v_pk_fma_f32 v[94:95], v[30:31], v[86:87], v[94:95] op_sel:[1,0,0] op_sel_hi:[1,1,1]
    v_lshlrev_b32 v80, 16, v48
    v_and_b32 v81, 0xffff0000, v48
    v_lshlrev_b32 v82, 16, v49
    v_and_b32 v83, 0xffff0000, v49
    v_lshlrev_b32 v84, 16, v50
    v_and_b32 v85, 0xffff0000, v50
    v_lshlrev_b32 v86, 16, v51
    v_and_b32 v87, 0xffff0000, v51
    v_pk_fma_f32 v[88:89], v[32:33], v[80:81], v[88:89] op_sel:[0,0,0] op_sel_hi:[0,1,1]
    v_pk_fma_f32 v[90:91], v[32:33], v[82:83], v[90:91] op_sel:[0,0,0] op_sel_hi:[0,1,1]
    v_pk_fma_f32 v[92:93], v[32:33], v[84:85], v[92:93] op_sel:[0,0,0] op_sel_hi:[0,1,1]
    v_pk_fma_f32 v[94:95], v[32:33], v[86:87], v[94:95] op_sel:[0,0,0] op_sel_hi:[0,1,1]
    v_lshlrev_b32 v80, 16, v52
    v_and_b32 v81, 0xffff0000, v52
    v_lshlrev_b32 v82, 16, v53
    v_and_b32 v83, 0xffff0000, v53
    v_lshlrev_b32 v84, 16, v54
    v_and_b32 v85, 0xffff0000, v54
    v_lshlrev_b32 v86, 16, v55
    v_and_b32 v87, 0xffff0000, v55
    v_pk_fma_f32 v[88:89], v[32:33], v[80:81], v[88:89] op_sel:[1,0,0] op_sel_hi:[1,1,1]
    v_pk_fma_f32 v[90:91], v[32:33], v[82:83], v[90:91] op_sel:[1,0,0] op_sel_hi:[1,1,1]
    v_pk_fma_f32 v[92:93], v[32:33], v[84:85], v[92:93] op_sel:[1,0,0] op_sel_hi:[1,1,1]
    v_pk_fma_f32 v[94:95], v[32:33], v[86:87], v[94:95] op_sel:[1,0,0] op_sel_hi:[1,1,1]
    v_lshlrev_b32 v80, 16, v56
    v_and_b32 v81, 0xffff0000, v56
    v_lshlrev_b32 v82, 16, v57
    v_and_b32 v83, 0xffff0000, v57
    v_lshlrev_b32 v84, 16, v58
    v_and_b32 v85, 0xffff0000, v58
    v_lshlrev_b32 v86, 16, v59
    v_and_b32 v87, 0xffff0000, v59
    v_pk_fma_f32 v[88:89], v[34:35], v[80:81], v[88:89] op_sel:[0,0,0] op_sel_hi:[0,1,1]
    v_pk_fma_f32 v[90:91], v[34:35], v[82:83], v[90:91] op_sel:[0,0,0] op_sel_hi:[0,1,1]
    v_pk_fma_f32 v[92:93], v[34:35], v[84:85], v[92:93] op_sel:[0,0,0] op_sel_hi:[0,1,1]
    v_pk_fma_f32 v[94:95], v[34:35], v[86:87], v[94:95] op_sel:[0,0,0] op_sel_hi:[0,1,1]
    v_lshlrev_b32 v80, 16, v60
    v_and_b32 v81, 0xffff0000, v60
    v_lshlrev_b32 v82, 16, v61
    v_and_b32 v83, 0xffff0000, v61
    v_lshlrev_b32 v84, 16, v62
    v_and_b32 v85, 0xffff0000, v62
    v_lshlrev_b32 v86, 16, v63
    v_and_b32 v87, 0xffff0000, v63
    v_pk_fma_f32 v[88:89], v[34:35], v[80:81], v[88:89] op_sel:[1,0,0] op_sel_hi:[1,1,1]
    v_pk_fma_f32 v[90:91], v[34:35], v[82:83], v[90:91] op_sel:[1,0,0] op_sel_hi:[1,1,1]
    v_pk_fma_f32 v[92:93], v[34:35], v[84:85], v[92:93] op_sel:[1,0,0] op_sel_hi:[1,1,1]
    v_pk_fma_f32 v[94:95], v[34:35], v[86:87], v[94:95] op_sel:[1,0,0] op_sel_hi:[1,1,1]
    v_lshlrev_b32 v80, 16, v64
    v_and_b32 v81, 0xffff0000, v64
    v_lshlrev_b32 v82, 16, v65
    v_and_b32 v83, 0xffff0000, v65
    v_lshlrev_b32 v84, 16, v66
    v_and_b32 v85, 0xffff0000, v66
    v_lshlrev_b32 v86, 16, v67
    v_and_b32 v87, 0xffff0000, v67
    v_pk_fma_f32 v[88:89], v[36:37], v[80:81], v[88:89] op_sel:[0,0,0] op_sel_hi:[0,1,1]
    v_pk_fma_f32 v[90:91], v[36:37], v[82:83], v[90:91] op_sel:[0,0,0] op_sel_hi:[0,1,1]
    v_pk_fma_f32 v[92:93], v[36:37], v[84:85], v[92:93] op_sel:[0,0,0] op_sel_hi:[0,1,1]
    v_pk_fma_f32 v[94:95], v[36:37], v[86:87], v[94:95] op_sel:[0,0,0] op_sel_hi:[0,1,1]
    v_lshlrev_b32 v80, 16, v68
    v_and_b32 v81, 0xffff0000, v68
    v_lshlrev_b32 v82, 16, v69
    v_and_b32 v83, 0xffff0000, v69
    v_lshlrev_b32 v84, 16, v70
    v_and_b32 v85, 0xffff0000, v70
    v_lshlrev_b32 v86, 16, v71
    v_and_b32 v87, 0xffff0000, v71
    v_pk_fma_f32 v[88:89], v[36:37], v[80:81], v[88:89] op_sel:[1,0,0] op_sel_hi:[1,1,1]
    v_pk_fma_f32 v[90:91], v[36:37], v[82:83], v[90:91] op_sel:[1,0,0] op_sel_hi:[1,1,1]
    v_pk_fma_f32 v[92:93], v[36:37], v[84:85], v[92:93] op_sel:[1,0,0] op_sel_hi:[1,1,1]
    v_pk_fma_f32 v[94:95], v[36:37], v[86:87], v[94:95] op_sel:[1,0,0] op_sel_hi:[1,1,1]
    v_lshlrev_b32 v80, 16, v72
    v_and_b32 v81, 0xffff0000, v72
    v_lshlrev_b32 v82, 16, v73
    v_and_b32 v83, 0xffff0000, v73
    v_lshlrev_b32 v84, 16, v74
    v_and_b32 v85, 0xffff0000, v74
    v_lshlrev_b32 v86, 16, v75
    v_and_b32 v87, 0xffff0000, v75
    v_pk_fma_f32 v[88:89], v[38:39], v[80:81], v[88:89] op_sel:[0,0,0] op_sel_hi:[0,1,1]
    v_pk_fma_f32 v[90:91], v[38:39], v[82:83], v[90:91] op_sel:[0,0,0] op_sel_hi:[0,1,1]
    v_pk_fma_f32 v[92:93], v[38:39], v[84:85], v[92:93] op_sel:[0,0,0] op_sel_hi:[0,1,1]
    v_pk_fma_f32 v[94:95], v[38:39], v[86:87], v[94:95] op_sel:[0,0,0] op_sel_hi:[0,1,1]
    v_lshlrev_b32 v80, 16, v76
    v_and_b32 v81, 0xffff0000, v76
    v_lshlrev_b32 v82, 16, v77
    v_and_b32 v83, 0xffff0000, v77
    v_lshlrev_b32 v84, 16, v78
    v_and_b32 v85, 0xffff0000, v78
    v_lshlrev_b32 v86, 16, v79
    v_and_b32 v87, 0xffff0000, v79
    v_pk_fma_f32 v[88:89], v[38:39], v[80:81], v[88:89] op_sel:[1,0,0] op_sel_hi:[1,1,1]
    v_pk_fma_f32 v[90:91], v[38:39], v[82:83], v[90:91] op_sel:[1,0,0] op_sel_hi:[1,1,1]
    v_pk_fma_f32 v[92:93], v[38:39], v[84:85], v[92:93] op_sel:[1,0,0] op_sel_hi:[1,1,1]
    v_pk_fma_f32 v[94:95], v[38:39], v[86:87], v[94:95] op_sel:[1,0,0] op_sel_hi:[1,1,1]
    s_nop 0
    v_permlane32_swap_b32 v88, v92
    v_permlane32_swap_b32 v89, v93
    v_permlane32_swap_b32 v90, v94
    v_permlane32_swap_b32 v91, v95
    v_add_f32 v88, v88, v92
    v_add_f32 v89, v89, v93
    v_add_f32 v90, v90, v94
    v_add_f32 v91, v91, v95
    s_nop 0
    v_permlane16_swap_b32 v88, v90
    v_permlane16_swap_b32 v89, v91
    v_add_f32 v88, v88, v90
    v_add_f32 v89, v89, v91
    v_and_b32 v81, 7, v1
    v_lshrrev_b32 v82, 3, v1
    v_add_f32_dpp v80, v88, v88 row_ror:8 row_mask:0xf bank_mask:0x3
    s_nop 1
    v_add_f32_dpp v80, v89, v89 row_ror:8 row_mask:0xf bank_mask:0xc
    v_lshl_add_u32 v81, v81, 3, v82
    s_lshl_b32 s7, s3, 8
    s_add_u32 s7, s7, 124928
    v_lshl_add_u32 v81, v81, 2, s7
    ds_write_b32 v81, v80
    s_waitcnt lgkmcnt(0)
    s_barrier
    v_lshlrev_b32 v81, 2, v1
    v_add_u32 v82, 124928, v81
    ds_read_b32 v88, v82 offset:0
    ds_read_b32 v89, v82 offset:256
    ds_read_b32 v90, v82 offset:512
    ds_read_b32 v91, v82 offset:768
    v_add_u32 v81, s44, v81
    s_waitcnt lgkmcnt(2)
    v_add_f32 v88, v88, v89
    s_waitcnt lgkmcnt(0)
    v_add_f32 v90, v90, v91
    v_add_f32 v88, v88, v90
    v_min_u32 v88, -2, v88
    s_cmp_lg_u32 s3, 0
    s_cbranch_scc1 Lmod_skip_s3
    global_store_dword v81, v88, s[38:39] offset:0 sc1
Lmod_skip_s3:
Lsp_c:
    s_mov_b32 s51, 102400
Lsp_d:
    s_mov_b32 s93, s51
    s_waitcnt lgkmcnt(0)
    s_barrier
    s_lshr_b32 s5, s3, 1
    s_lshl_b32 s5, s5, 5
    s_and_b32 s6, s3, 1
    s_lshl_b32 s6, s6, 2
    s_add_u32 s6, s6, s5
    s_lshl_b32 s5, s40, 6
    s_add_u32 s90, s6, s5
    v_add_lshl_u32 v27, v5, s90, 1
    global_load_ushort v27, v27, s[26:27]
    s_and_b32 s4, s41, 3
    s_cmp_eq_u32 s4, 0
    s_cselect_b32 s5, 8, 0
    s_cmp_le_u32 s4, 1
    s_cselect_b32 s6, 16, 8
    s_cmp_eq_u32 s4, 3
    s_cselect_b32 s50, 16, 24
    s_lshl_b32 s44, s4, 3
    s_bitcmp1_b32 s43, 0
    s_cselect_b32 s46, s6, s5
    s_cselect_b32 s48, s5, s6
    s_lshl_b32 s5, s3, 1
    s_add_u32 s44, s44, s5
    s_add_u32 s45, s44, 1
    s_add_u32 s46, s46, s5
    s_add_u32 s47, s46, 1
    s_add_u32 s48, s48, s5
    s_add_u32 s49, s48, 1
    s_add_u32 s50, s50, s5
    s_add_u32 s51, s50, 1
    s_lshl_b32 s5, s40, 18
    s_lshl_b32 s6, s44, 7
    s_add_u32 s6, s6, s5
    s_add_u32 s68, s24, s6
    s_addc_u32 s69, s25, 0
    s_lshl_b32 s6, s45, 7
    s_add_u32 s6, s6, s5
    s_add_u32 s70, s24, s6
    s_addc_u32 s71, s25, 0
    s_lshl_b32 s6, s46, 7
    s_add_u32 s6, s6, s5
    s_add_u32 s72, s24, s6
    s_addc_u32 s73, s25, 0
    s_lshl_b32 s6, s47, 7
    s_add_u32 s6, s6, s5
    s_add_u32 s74, s24, s6
    s_addc_u32 s75, s25, 0
    s_lshl_b32 s6, s48, 7
    s_add_u32 s6, s6, s5
    s_add_u32 s76, s24, s6
    s_addc_u32 s77, s25, 0
    s_lshl_b32 s6, s49, 7
    s_add_u32 s6, s6, s5
    s_add_u32 s78, s24, s6
    s_addc_u32 s79, s25, 0
    s_lshl_b32 s6, s50, 7
    s_add_u32 s6, s6, s5
    s_add_u32 s80, s24, s6
    s_addc_u32 s81, s25, 0
    s_lshl_b32 s6, s51, 7
    s_add_u32 s6, s6, s5
    s_add_u32 s82, s24, s6
    s_addc_u32 s83, s25, 0
    s_lshl_b32 s89, s3, 14
    s_add_u32 s89, s89, 83200
    s_and_b32 s4, s41, 1
    s_lshl_b32 s5, s3, 1
    s_add_u32 s5, s5, s4
    s_cmp_eq_u32 s5, 7
    s_cselect_b32 s5, 0, s5
    s_mul_i32 s96, s41, 7
    s_add_u32 s96, s96, s5
    s_cmp_lt_u32 s96, 54
    s_cselect_b32 s101, 2, 0
    s_min_u32 s96, s96, 53
    s_cmp_eq_u32 s3, 3
    s_cselect_b32 s101, 1, s101
    s_lshr_b32 s97, s101, 1
    s_cselect_b32 s5, -1, 0
    v_and_b32 v7, s5, v4
    s_add_u32 s97, s97, s96
    s_mul_i32 s4, s96, 20480
    s_add_u32 s5, s4, 7344128
    s_add_u32 s8, s38, s5
    s_addc_u32 s9, s39, 0
    s_add_u32 s5, s4, 7352320
    s_add_u32 s10, s38, s5
    s_addc_u32 s11, s39, 0
    s_add_u32 s5, s4, 7360512
    s_add_u32 s12, s38, s5
    s_addc_u32 s13, s39, 0
    s_mul_i32 s4, s97, 20480
    s_add_u32 s5, s4, 7344128
    s_add_u32 s14, s38, s5
    s_addc_u32 s15, s39, 0
    s_add_u32 s5, s4, 7352320
    s_add_u32 s16, s38, s5
    s_addc_u32 s17, s39, 0
    s_add_u32 s5, s4, 7360512
    s_add_u32 s18, s38, s5
    s_addc_u32 s19, s39, 0
    v_bfe_u32 v106, v1, 3, 1
    s_sub_u32 s4, s97, s96
    v_mul_u32_u24 v106, s4, v106
    v_add_lshl_u32 v106, v106, s96, 7
    v_mul_u32_u24 v101, 7168, v3
    v_add_u32 v106, v106, v101
    v_and_b32 v101, 112, v4
    v_add_u32 v106, v106, v101
    v_add_u32 v106, 49152, v106
    v_and_b32 v100, 1, v3
    v_mul_u32_u24 v100, 7168, v100
    v_sub_u32 v100, v106, v100
    s_branch Lsp_f
Lsp:
    s_sleep 16
Lsp_f:
    global_load_dword v112, v100, s[38:39] sc1
    s_waitcnt vmcnt(0)
    v_cmp_eq_u32 vcc, -1, v112
    s_add_u32 s100, s100, 1
    s_cmp_ge_u32 s100, 262144
    s_cbranch_scc1 Lsp_x
    s_cbranch_vccnz Lsp
Lsp_x:
    s_barrier
    s_cmp_eq_u32 s93, 102400
    s_cbranch_scc1 Lsd_none
    v_mov_b32 v103, s93
    s_cmp_lg_u32 s3, 0
    s_cbranch_scc1 Lsd_skip
    global_store_dword v103, v103, s[38:39] sc1
Lsd_skip:
Lsd_none:
    global_load_dwordx4 a[248:251], v4, s[12:13] offset:-1024 sc1
    v_and_b32 v67, 7, v1
    v_lshl_add_u32 v67, v3, 3, v67
    v_bfe_u32 v69, v1, 3, 1
    global_load_dwordx4 a[252:255], v7, s[18:19] offset:-1024 sc1
    v_lshlrev_b32 v66, 9, v69
    v_lshl_add_u32 v66, v67, 4, v66
    s_mul_i32 s4, s3, 20480
    s_mul_i32 s5, s40, 114688
    global_load_dwordx4 a[240:243], v4, s[12:13] offset:-2048 sc1
    s_add_u32 s4, s4, s5
    s_add_u32 s4, s4, 1048576
    v_add_u32 v66, s4, v66
    v_lshl_add_u32 v70, v67, 1, v69
    global_load_dwordx4 a[244:247], v7, s[18:19] offset:-2048 sc1
    v_min_u32 v72, 9, v1
    v_lshl_add_u32 v72, v72, 11, s4
    v_lshrrev_b32 v67, 5, v1
    v_bfe_u32 v68, v1, 1, 1
    global_load_dwordx4 a[232:235], v4, s[12:13] offset:-3072 sc1
    v_lshl_add_u32 v67, v67, 1, v68
    v_mul_u32_u24 v68, 1040, v67
    v_bfe_u32 v67, v1, 3, 1
    v_lshl_add_u32 v68, v67, 3, v68
    global_load_dwordx4 a[236:239], v7, s[18:19] offset:-3072 sc1
    v_bfe_u32 v67, v1, 2, 1
    v_lshl_add_u32 v68, v67, 6, v68
    v_bfe_u32 v67, v1, 4, 1
    v_lshl_add_u32 v68, v67, 7, v68
    global_load_dwordx4 a[224:227], v4, s[12:13] offset:-4096 sc1
    v_bfe_u32 v67, v1, 0, 1
    v_lshl_add_u32 v68, v67, 5, v68
    s_mul_i32 s5, s3, 20800
    v_add_u32 v68, s5, v68
    global_load_dwordx4 a[228:231], v7, s[18:19] offset:-4096 sc1
    v_lshlrev_b32 v30, 3, v1
    s_lshl_b32 s88, s3, 9
    v_lshrrev_b32 v67, 3, v1
    v_lshlrev_b32 v67, 12, v67
    global_load_dwordx4 a[216:219], v4, s[10:11] offset:3072 sc1
    v_bfe_u32 v69, v1, 4, 1
    v_xor_b32 v69, v69, v1
    v_and_b32 v69, 7, v69
    global_load_dwordx4 a[220:223], v7, s[16:17] offset:3072 sc1
    v_xor_b32 v74, 0, v69
    v_lshl_add_u32 v74, v74, 4, v67
    v_add_u32 v78, 131072, v74
    v_xor_b32 v75, 2, v69
    global_load_dwordx4 a[208:211], v4, s[10:11] offset:2048 sc1
    v_lshl_add_u32 v75, v75, 4, v67
    v_add_u32 v75, 31744, v75
    v_add_u32 v79, 131072, v75
    v_xor_b32 v76, 4, v69
    global_load_dwordx4 a[212:215], v7, s[16:17] offset:2048 sc1
    v_lshl_add_u32 v76, v76, 4, v67
    v_add_u32 v76, 63488, v76
    v_add_u32 v80, 131072, v76
    v_xor_b32 v77, 6, v69
    global_load_dwordx4 a[200:203], v4, s[10:11] offset:1024 sc1
    v_lshl_add_u32 v77, v77, 4, v67
    v_add_u32 v77, 95232, v77
    v_add_u32 v81, 131072, v77
    v_lshrrev_b32 v69, 1, v2
    global_load_dwordx4 a[204:207], v7, s[16:17] offset:1024 sc1
    v_xor_b32 v69, v69, v3
    v_lshlrev_b32 v69, 4, v69
    v_lshl_add_u32 v69, v5, 7, v69
    s_xor_b32 s4, s3, 0
    global_load_dwordx4 a[192:195], v4, s[10:11] offset:0 sc1
    s_lshr_b32 s5, s4, 1
    s_lshl_b32 s5, s5, 12
    s_and_b32 s4, s4, 1
    s_lshl_b32 s4, s4, 9
    global_load_dwordx4 a[196:199], v7, s[16:17] offset:0 sc1
    s_add_u32 s4, s4, s5
    s_add_u32 s4, s4, s89
    v_add_u32 v82, s4, v69
    v_xor_b32 v83, 64, v82
    global_load_dwordx4 a[184:187], v4, s[10:11] offset:-1024 sc1
    s_xor_b32 s4, s3, 1
    s_lshr_b32 s5, s4, 1
    s_lshl_b32 s5, s5, 12
    global_load_dwordx4 a[188:191], v7, s[16:17] offset:-1024 sc1
    s_and_b32 s4, s4, 1
    s_lshl_b32 s4, s4, 9
    s_add_u32 s4, s4, s5
    s_add_u32 s4, s4, s89
    global_load_dwordx4 a[176:179], v4, s[10:11] offset:-2048 sc1
    v_add_u32 v84, s4, v69
    v_xor_b32 v85, 64, v84
    s_xor_b32 s4, s3, 2
    s_lshr_b32 s5, s4, 1
    global_load_dwordx4 a[180:183], v7, s[16:17] offset:-2048 sc1
    s_lshl_b32 s5, s5, 12
    s_and_b32 s4, s4, 1
    s_lshl_b32 s4, s4, 9
    s_add_u32 s4, s4, s5
    global_load_dwordx4 a[168:171], v4, s[10:11] offset:-3072 sc1
    s_add_u32 s4, s4, s89
    v_add_u32 v86, s4, v69
    v_xor_b32 v87, 64, v86
    s_xor_b32 s4, s3, 3
    global_load_dwordx4 a[172:175], v7, s[16:17] offset:-3072 sc1
    s_lshr_b32 s5, s4, 1
    s_lshl_b32 s5, s5, 12
    s_and_b32 s4, s4, 1
    s_lshl_b32 s4, s4, 9
    global_load_dwordx4 a[160:163], v4, s[10:11] offset:-4096 sc1
    s_add_u32 s4, s4, s5
    s_add_u32 s4, s4, s89
    v_add_u32 v88, s4, v69
    v_xor_b32 v89, 64, v88
    global_load_dwordx4 a[164:167], v7, s[16:17] offset:-4096 sc1
    s_add_u32 s52, s8, 1146880
    s_addc_u32 s53, s9, 0
    s_add_u32 s54, s10, 1146880
    s_addc_u32 s55, s11, 0
    global_load_dwordx4 a[152:155], v4, s[8:9] offset:3072 sc1
    s_add_u32 s56, s12, 1146880
    s_addc_u32 s57, s13, 0
    s_add_u32 s58, s14, 1146880
    global_load_dwordx4 a[156:159], v7, s[14:15] offset:3072 sc1
    s_addc_u32 s59, s15, 0
    s_add_u32 s60, s16, 1146880
    s_addc_u32 s61, s17, 0
    s_add_u32 s62, s18, 1146880
    global_load_dwordx4 a[144:147], v4, s[8:9] offset:2048 sc1
    s_addc_u32 s63, s19, 0
    s_mov_b32 s84, 0xc0135761
    s_mov_b32 s85, 0xbdd2d3e8
    v_lshlrev_b32 v32, 16, v27
    global_load_dwordx4 a[148:151], v7, s[14:15] offset:2048 sc1
    v_lshlrev_b32 v33, 16, v27
    v_lshlrev_b32 v34, 16, v27
    v_lshlrev_b32 v35, 16, v27
    s_mul_i32 s5, s41, 10
    global_load_dwordx4 a[136:139], v4, s[8:9] offset:1024 sc1
    s_mul_i32 s6, s3, 1040
    v_add_u32 v67, s5, v3
    v_lshrrev_b32 v69, 2, v67
    v_mul_u32_u24 v69, 3136, v69
    global_load_dwordx4 a[140:143], v7, s[14:15] offset:1024 sc1
    v_lshl_add_u32 v69, v67, 8, v69
    v_lshl_add_u32 v69, v2, 4, v69
    v_add_u32 v46, s6, v69
    v_lshrrev_b32 v67, 1, v3
    global_load_dwordx4 a[128:131], v4, s[8:9] offset:0 sc1
    v_add_u32 v67, s5, v67
    v_lshrrev_b32 v69, 2, v67
    v_mul_u32_u24 v69, 3136, v69
    v_lshl_add_u32 v69, v67, 8, v69
    global_load_dwordx4 a[132:135], v7, s[14:15] offset:0 sc1
    v_lshl_add_u32 v69, v2, 4, v69
    v_add_u32 v47, s6, v69
    v_and_b32 v67, 1, v3
    v_lshl_add_u32 v47, v67, 3, v47
    s_add_u32 m0, s89, 0
    s_nop 0
    global_load_lds_dwordx4 v74, s[68:69] offset:0
    global_load_lds_dwordx4 v75, s[68:69] offset:1024
    global_load_lds_dwordx4 v76, s[68:69] offset:2048
    global_load_lds_dwordx4 v77, s[68:69] offset:3072
    s_add_u32 m0, s89, 4096
    s_nop 0
    global_load_lds_dwordx4 v78, s[68:69] offset:0
    global_load_lds_dwordx4 v79, s[68:69] offset:1024
    global_load_lds_dwordx4 v80, s[68:69] offset:2048
    global_load_lds_dwordx4 v81, s[68:69] offset:3072
    s_lshl_b32 s4, s40, 9
    s_add_u32 s4, s4, 32772
    v_lshl_add_u32 v102, v1, 3, s4
    s_branch Lsu_f
Lsu:
    s_sleep 16
Lsu_f:
    global_load_dwordx4 v[112:115], v106, s[38:39] sc1
    global_load_dword v116, v102, s[38:39] sc1
    s_waitcnt vmcnt(0)
    v_max3_u32 v101, v112, v113, v114
    v_max3_u32 v101, v115, v116, v101
    v_cmp_eq_u32 vcc, -1, v101
    s_add_u32 s100, s100, 1
    s_cmp_ge_u32 s100, 262144
    s_cbranch_scc1 Lsu_x
    s_cbranch_vccnz Lsu
Lsu_x:
    v_permlane32_swap_b32 v112, v114
    v_permlane32_swap_b32 v113, v115
    s_lshl_b32 s4, s3, 9
    s_add_u32 s4, s4, 156672
    v_and_b32 v106, 496, v4
    v_add_f32 v112, v112, v114
    v_add_f32 v113, v113, v115
    v_bfe_u32 v114, v1, 3, 1
    v_cmp_gt_u32 vcc, s101, v114
    v_lshrrev_b32 v114, 5, v1
    v_lshl_add_u32 v106, v114, 3, v106
    v_cndmask_b32 v112, 0, v112, vcc
    v_cndmask_b32 v113, 0, v113, vcc
    v_add_u32 v106, s4, v106
    ds_write_b64 v106, v[112:113]
    s_barrier
    s_branch Ljoin
Lic_r:
    s_branch Lic_p_f
Lic_p:
    s_sleep 4
Lic_p_f:
    global_load_dword v221, v220, s[36:37] sc1
    s_waitcnt vmcnt(0)
    v_cmp_eq_u32 vcc, 0, v221
    s_add_u32 s100, s100, 1
    s_cmp_ge_u32 s100, 262144
    s_cbranch_scc1 Lic_p_x
    s_cbranch_vccnz Lic_p
Lic_p_x:
    s_branch Lic_ok
Lic2_r:
    s_branch Lic2_p_f
Lic2_p:
    s_sleep 4
Lic2_p_f:
    global_load_dword v100, v99, s[36:37] sc1
    s_waitcnt vmcnt(0)
    v_cmp_eq_u32 vcc, 0, v100
    s_add_u32 s100, s100, 1
    s_cmp_ge_u32 s100, 262144
    s_cbranch_scc1 Lic2_p_x
    s_cbranch_vccnz Lic2_p
Lic2_p_x:
    s_branch Lic2_ok
Lkf_r:
    s_nop 7
Lkf_p:
    global_load_dword v45, v44, s[38:39] sc1
    s_waitcnt vmcnt(0)
    v_cmp_eq_u32 vcc, -1, v45
    s_add_u32 s100, s100, 1
    s_cmp_ge_u32 s100, 262144
    s_cbranch_scc1 Lkf_p_x
    s_cbranch_vccnz Lkf_p
Lkf_p_x:
    s_nop 1
    s_branch Lkf_ok
Lcu_r:
    s_nop 7
Lcu_p:
    global_load_dword v234, v45, s[38:39] sc1
    s_waitcnt vmcnt(0)
    v_cmp_eq_u32 vcc, -1, v234
    s_add_u32 s100, s100, 1
    s_cmp_ge_u32 s100, 262144
    s_cbranch_scc1 Lcu_p_x
    s_cbranch_vccnz Lcu_p
Lcu_p_x:
    s_nop 1
    s_branch Lcu_ok
Lax_r:
    s_nop 7
Lax_p:
    v_lshlrev_b32 v28, 4, v0
    v_add_u32 v28, 36864, v28
    global_load_dwordx4 v[214:217], v28, s[38:39] offset:-4096 sc1
    global_load_dwordx4 v[218:221], v28, s[38:39] offset:0 sc1
    v_add_u32 v28, 8192, v28
    global_load_dwordx4 v[222:225], v28, s[38:39] offset:-4096 sc1
    global_load_dwordx4 v[226:229], v28, s[38:39] offset:0 sc1
    v_min_u32 v28, 11, v1
    v_lshrrev_b32 v29, 2, v28
    v_mul_u32_u24 v29, 2544, v29
    v_lshl_add_u32 v28, v28, 2, v29
    s_lshl_b32 s4, s42, 4
    s_add_u32 s4, s4, 0
    v_add_u32 v28, s4, v28
    global_load_dword v64, v28, s[38:39] sc1
    v_add_u32 v28, 15360, v28
    global_load_dword v65, v28, s[38:39] sc1
    s_waitcnt vmcnt(0)
    v_max_u32 v236, v215, v217
    v_max3_u32 v236, v219, v221, v236
    v_max3_u32 v236, v223, v225, v236
    v_max3_u32 v236, v227, v229, v236
    v_max3_u32 v236, v64, v65, v236
    v_cmp_eq_u32 vcc, -1, v236
    s_add_u32 s100, s100, 1
    s_cmp_ge_u32 s100, 262144
    s_cbranch_scc1 Lax_p_x
    s_cbranch_vccnz Lax_p
Lax_p_x:
    s_nop 1
    s_branch Lax_ok
Lcv_r:
    s_nop 7
Lcv_p:
    global_load_dwordx4 v[230:233], v235, s[38:39] sc1
    s_waitcnt vmcnt(0)
    v_max_u32 v236, v230, v231
    v_max3_u32 v236, v232, v233, v236
    v_cmp_eq_u32 vcc, -1, v236
    s_add_u32 s100, s100, 1
    s_cmp_ge_u32 s100, 262144
    s_cbranch_scc1 Lcv_p_x
    s_cbranch_vccnz Lcv_p
Lcv_p_x:
    s_nop 1
    s_branch Lcv_ok
Lgb_r:
    s_nop 7
Lgb_p:
    v_min_u32 v175, 26, v1
    v_lshlrev_b32 v175, 7, v175
    v_add_u32 v175, 98304, v175
    global_load_dword v250, v175, s[38:39] sc1
    s_mul_i32 s7, s41, 320
    s_add_u32 s7, s7, 12800
    v_min_u32 v175, 304, v4
    v_add_u32 v175, s7, v175
    global_load_dwordx4 v[242:245], v175, s[38:39] sc1
    v_add_u32 v175, 15360, v175
    global_load_dwordx4 v[246:249], v175, s[38:39] sc1
    s_waitcnt vmcnt(0)
    v_max3_u32 v28, v242, v243, v244
    v_max3_u32 v28, v245, v246, v28
    v_max3_u32 v28, v247, v248, v28
    v_max3_u32 v28, v249, v250, v28
    v_cmp_eq_u32 vcc, -1, v28
    s_add_u32 s100, s100, 1
    s_cmp_ge_u32 s100, 262144
    s_cbranch_scc1 Lgb_p_x
    s_cbranch_vccnz Lgb_p
Lgb_p_x:
    s_nop 1
    s_branch Lgb_ok
Ls3_r:
    s_nop 7
Ls3_p:
    global_load_dwordx2 v[130:131], v174, s[38:39] offset:0 sc1
    global_load_dwordx2 v[132:133], v174, s[38:39] offset:512 sc1
    global_load_dwordx2 v[134:135], v174, s[38:39] offset:1024 sc1
    global_load_dwordx2 v[136:137], v174, s[38:39] offset:1536 sc1
    global_load_dwordx2 v[138:139], v174, s[38:39] offset:2048 sc1
    global_load_dwordx2 v[140:141], v174, s[38:39] offset:2560 sc1
    global_load_dwordx2 v[142:143], v174, s[38:39] offset:3072 sc1
    global_load_dwordx2 v[144:145], v174, s[38:39] offset:3584 sc1
    s_waitcnt vmcnt(0)
    v_max_u32 v28, v131, v133
    v_max3_u32 v28, v135, v137, v28
    v_max3_u32 v28, v139, v141, v28
    v_max3_u32 v28, v143, v145, v28
    v_cmp_eq_u32 vcc, -1, v28
    s_add_u32 s100, s100, 1
    s_cmp_ge_u32 s100, 262144
    s_cbranch_scc1 Ls3_p_x
    s_cbranch_vccnz Ls3_p
Ls3_p_x:
    s_nop 1
    s_branch Ls3_ok
Lz0_r:
    s_nop 7
Lz0_p:
    global_load_dwordx4 v[62:65], v30, s[56:57] offset:-3072 sc1
    global_load_dwordx4 v[66:69], v30, s[56:57] offset:-2048 sc1
    global_load_dwordx4 v[70:73], v30, s[56:57] offset:-1024 sc1
    global_load_dwordx4 v[74:77], v30, s[56:57] offset:0 sc1
    global_load_dwordx4 v[78:81], v30, s[56:57] offset:1024 sc1
    global_load_dwordx4 v[82:85], v30, s[56:57] offset:2048 sc1
    global_load_dwordx4 v[86:89], v30, s[56:57] offset:3072 sc1
    global_load_dwordx4 v[90:93], v31, s[56:57] offset:-3072 sc1
    global_load_dwordx4 v[94:97], v31, s[56:57] offset:-2048 sc1
    global_load_dwordx4 v[98:101], v31, s[56:57] offset:-1024 sc1
    global_load_dwordx4 v[102:105], v31, s[56:57] offset:0 sc1
    global_load_dwordx4 v[106:109], v31, s[56:57] offset:1024 sc1
    global_load_dwordx4 v[110:113], v31, s[56:57] offset:2048 sc1
    global_load_dwordx4 v[114:117], v31, s[56:57] offset:3072 sc1
    global_load_dwordx4 v[118:121], v30, s[58:59] offset:-3072 sc1
    global_load_dwordx4 v[122:125], v30, s[58:59] offset:-2048 sc1
    s_waitcnt vmcnt(0)
    v_and_b32 v28, v65, v69
    v_bitop3_b32 v28, v73, v77, v28 bitop3:0x80
    v_and_b32 v28, 1, v28
    v_cmp_ne_u32 vcc, 1, v28
    s_add_u32 s100, s100, 1
    s_cmp_ge_u32 s100, 262144
    s_cbranch_scc1 Lz0_p_x
    s_cbranch_vccnz Lz0_p
Lz0_p_x:
    s_nop 1
    s_branch Lz0_ok
Lz1_r:
    s_nop 7
Lz1_p:
    global_load_dwordx4 v[78:81], v30, s[56:57] offset:1024 sc1
    global_load_dwordx4 v[82:85], v30, s[56:57] offset:2048 sc1
    global_load_dwordx4 v[86:89], v30, s[56:57] offset:3072 sc1
    global_load_dwordx4 v[90:93], v31, s[56:57] offset:-3072 sc1
    s_waitcnt vmcnt(0)
    v_and_b32 v28, v81, v85
    v_bitop3_b32 v28, v89, v93, v28 bitop3:0x80
    v_and_b32 v28, 1, v28
    v_cmp_ne_u32 vcc, 1, v28
    s_add_u32 s100, s100, 1
    s_cmp_ge_u32 s100, 262144
    s_cbranch_scc1 Lz1_p_x
    s_cbranch_vccnz Lz1_p
Lz1_p_x:
    s_nop 1
    s_branch Lz1_ok
Lz2_r:
    s_nop 7
Lz2_p:
    global_load_dwordx4 v[94:97], v31, s[56:57] offset:-2048 sc1
    global_load_dwordx4 v[98:101], v31, s[56:57] offset:-1024 sc1
    global_load_dwordx4 v[102:105], v31, s[56:57] offset:0 sc1
    global_load_dwordx4 v[106:109], v31, s[56:57] offset:1024 sc1
    s_waitcnt vmcnt(0)
    v_and_b32 v28, v97, v101
    v_bitop3_b32 v28, v105, v109, v28 bitop3:0x80
    v_and_b32 v28, 1, v28
    v_cmp_ne_u32 vcc, 1, v28
    s_add_u32 s100, s100, 1
    s_cmp_ge_u32 s100, 262144
    s_cbranch_scc1 Lz2_p_x
    s_cbranch_vccnz Lz2_p
Lz2_p_x:
    s_nop 1
    s_branch Lz2_ok
Lz3_r:
    s_nop 7
Lz3_p:
    global_load_dwordx4 v[110:113], v31, s[56:57] offset:2048 sc1
    global_load_dwordx4 v[114:117], v31, s[56:57] offset:3072 sc1
    global_load_dwordx4 v[118:121], v30, s[58:59] offset:-3072 sc1
    global_load_dwordx4 v[122:125], v30, s[58:59] offset:-2048 sc1
    s_waitcnt vmcnt(0)
    v_and_b32 v28, v113, v117
    v_bitop3_b32 v28, v121, v125, v28 bitop3:0x80
    v_and_b32 v28, 1, v28
    v_cmp_ne_u32 vcc, 1, v28
    s_add_u32 s100, s100, 1
    s_cmp_ge_u32 s100, 262144
    s_cbranch_scc1 Lz3_p_x
    s_cbranch_vccnz Lz3_p
Lz3_p_x:
    s_nop 1
    s_branch Lz3_ok
Lz4_r:
    s_nop 7
Lz4_p:
    global_load_dwordx4 v[126:129], v30, s[58:59] offset:-1024 sc1
    global_load_dwordx4 v[130:133], v30, s[58:59] offset:0 sc1
    global_load_dwordx4 v[134:137], v30, s[58:59] offset:1024 sc1
    global_load_dwordx4 v[138:141], v30, s[58:59] offset:2048 sc1
    s_waitcnt vmcnt(0)
    v_and_b32 v28, v129, v133
    v_bitop3_b32 v28, v137, v141, v28 bitop3:0x80
    v_and_b32 v28, 1, v28
    v_cmp_ne_u32 vcc, 1, v28
    s_add_u32 s100, s100, 1
    s_cmp_ge_u32 s100, 262144
    s_cbranch_scc1 Lz4_p_x
    s_cbranch_vccnz Lz4_p
Lz4_p_x:
    s_nop 1
    s_branch Lz4_ok
Lz5_r:
    s_nop 7
Lz5_p:
    global_load_dwordx4 v[62:65], v30, s[58:59] offset:3072 sc1
    global_load_dwordx4 v[66:69], v31, s[58:59] offset:-3072 sc1
    global_load_dwordx4 v[70:73], v31, s[58:59] offset:-2048 sc1
    global_load_dwordx4 v[74:77], v31, s[58:59] offset:-1024 sc1
    s_waitcnt vmcnt(0)
    v_and_b32 v28, v65, v69
    v_bitop3_b32 v28, v73, v77, v28 bitop3:0x80
    v_and_b32 v28, 1, v28
    v_cmp_ne_u32 vcc, 1, v28
    s_add_u32 s100, s100, 1
    s_cmp_ge_u32 s100, 262144
    s_cbranch_scc1 Lz5_p_x
    s_cbranch_vccnz Lz5_p
Lz5_p_x:
    s_nop 1
    s_branch Lz5_ok
Lz6_r:
    s_nop 7
Lz6_p:
    global_load_dwordx4 v[78:81], v31, s[58:59] offset:0 sc1
    global_load_dwordx4 v[82:85], v31, s[58:59] offset:1024 sc1
    global_load_dwordx4 v[86:89], v31, s[58:59] offset:2048 sc1
    global_load_dwordx4 v[90:93], v31, s[58:59] offset:3072 sc1
    s_waitcnt vmcnt(0)
    v_and_b32 v28, v81, v85
    v_bitop3_b32 v28, v89, v93, v28 bitop3:0x80
    v_and_b32 v28, 1, v28
    v_cmp_ne_u32 vcc, 1, v28
    s_add_u32 s100, s100, 1
    s_cmp_ge_u32 s100, 262144
    s_cbranch_scc1 Lz6_p_x
    s_cbranch_vccnz Lz6_p
Lz6_p_x:
    s_nop 1
    s_branch Lz6_ok
Lz7_r:
    s_nop 7
Lz7_p:
    global_load_dwordx4 v[94:97], v30, s[60:61] offset:-3072 sc1
    global_load_dwordx4 v[98:101], v31, s[60:61] offset:-3072 sc1
    global_load_dwordx4 v[102:105], v30, s[62:63] offset:-3072 sc1
    global_load_dwordx4 v[106:109], v31, s[62:63] offset:-3072 sc1
    s_waitcnt vmcnt(0)
    v_and_b32 v28, v97, v101
    v_bitop3_b32 v28, v105, v109, v28 bitop3:0x80
    v_and_b32 v28, 1, v28
    v_cmp_ne_u32 vcc, 1, v28
    s_add_u32 s100, s100, 1
    s_cmp_ge_u32 s100, 262144
    s_cbranch_scc1 Lz7_p_x
    s_cbranch_vccnz Lz7_p
Lz7_p_x:
    s_nop 1
    s_branch Lz7_ok
Lz8_r:
    s_nop 7
Lz8_p:
    global_load_dwordx4 v[110:113], v30, s[52:53] offset:-3072 sc1
    global_load_dwordx4 v[114:117], v31, s[52:53] offset:-3072 sc1
    global_load_dwordx4 v[118:121], v30, s[54:55] offset:-3072 sc1
    global_load_dwordx4 v[122:125], v31, s[54:55] offset:-3072 sc1
    s_waitcnt vmcnt(0)
    v_and_b32 v28, v113, v117
    v_bitop3_b32 v28, v121, v125, v28 bitop3:0x80
    v_and_b32 v28, 1, v28
    v_cmp_ne_u32 vcc, 1, v28
    s_add_u32 s100, s100, 1
    s_cmp_ge_u32 s100, 262144
    s_cbranch_scc1 Lz8_p_x
    s_cbranch_vccnz Lz8_p
Lz8_p_x:
    s_nop 1
    s_branch Lz8_ok
Lz9_r:
    s_nop 7
Lz9_p:
    global_load_dwordx4 v[126:129], v30, s[64:65] offset:-3072 sc1
    global_load_dwordx4 v[130:133], v31, s[64:65] offset:-3072 sc1
    global_load_dwordx4 v[134:137], v30, s[66:67] offset:-3072 sc1
    global_load_dwordx4 v[138:141], v31, s[66:67] offset:-3072 sc1
    s_waitcnt vmcnt(0)
    v_and_b32 v28, v129, v133
    v_bitop3_b32 v28, v137, v141, v28 bitop3:0x80
    v_and_b32 v28, 1, v28
    v_cmp_ne_u32 vcc, 1, v28
    s_add_u32 s100, s100, 1
    s_cmp_ge_u32 s100, 262144
    s_cbranch_scc1 Lz9_p_x
    s_cbranch_vccnz Lz9_p
Lz9_p_x:
    s_nop 1
    s_branch Lz9_ok
Lz10_r:
    s_nop 7
Lz10_p:
    global_load_dwordx4 v[62:65], v30, s[60:61] offset:-2048 sc1
    global_load_dwordx4 v[66:69], v31, s[60:61] offset:-2048 sc1
    global_load_dwordx4 v[70:73], v30, s[62:63] offset:-2048 sc1
    global_load_dwordx4 v[74:77], v31, s[62:63] offset:-2048 sc1
    s_waitcnt vmcnt(0)
    v_and_b32 v28, v65, v69
    v_bitop3_b32 v28, v73, v77, v28 bitop3:0x80
    v_and_b32 v28, 1, v28
    v_cmp_ne_u32 vcc, 1, v28
    s_add_u32 s100, s100, 1
    s_cmp_ge_u32 s100, 262144
    s_cbranch_scc1 Lz10_p_x
    s_cbranch_vccnz Lz10_p
Lz10_p_x:
    s_nop 1
    s_branch Lz10_ok
Lz11_r:
    s_nop 7
Lz11_p:
    global_load_dwordx4 v[78:81], v30, s[52:53] offset:-2048 sc1
    global_load_dwordx4 v[82:85], v31, s[52:53] offset:-2048 sc1
    global_load_dwordx4 v[86:89], v30, s[54:55] offset:-2048 sc1
    global_load_dwordx4 v[90:93], v31, s[54:55] offset:-2048 sc1
    s_waitcnt vmcnt(0)
    v_and_b32 v28, v81, v85
    v_bitop3_b32 v28, v89, v93, v28 bitop3:0x80
    v_and_b32 v28, 1, v28
    v_cmp_ne_u32 vcc, 1, v28
    s_add_u32 s100, s100, 1
    s_cmp_ge_u32 s100, 262144
    s_cbranch_scc1 Lz11_p_x
    s_cbranch_vccnz Lz11_p
Lz11_p_x:
    s_nop 1
    s_branch Lz11_ok
Lz12_r:
    s_nop 7
Lz12_p:
    global_load_dwordx4 v[94:97], v30, s[64:65] offset:-2048 sc1
    global_load_dwordx4 v[98:101], v31, s[64:65] offset:-2048 sc1
    global_load_dwordx4 v[102:105], v30, s[66:67] offset:-2048 sc1
    global_load_dwordx4 v[106:109], v31, s[66:67] offset:-2048 sc1
    s_waitcnt vmcnt(0)
    v_and_b32 v28, v97, v101
    v_bitop3_b32 v28, v105, v109, v28 bitop3:0x80
    v_and_b32 v28, 1, v28
    v_cmp_ne_u32 vcc, 1, v28
    s_add_u32 s100, s100, 1
    s_cmp_ge_u32 s100, 262144
    s_cbranch_scc1 Lz12_p_x
    s_cbranch_vccnz Lz12_p
Lz12_p_x:
    s_nop 1
    s_branch Lz12_ok
Lz13_r:
    s_nop 7
Lz13_p:
    global_load_dwordx4 v[110:113], v30, s[60:61] offset:-1024 sc1
    global_load_dwordx4 v[114:117], v31, s[60:61] offset:-1024 sc1
    global_load_dwordx4 v[118:121], v30, s[62:63] offset:-1024 sc1
    global_load_dwordx4 v[122:125], v31, s[62:63] offset:-1024 sc1
    s_waitcnt vmcnt(0)
    v_and_b32 v28, v113, v117
    v_bitop3_b32 v28, v121, v125, v28 bitop3:0x80
    v_and_b32 v28, 1, v28
    v_cmp_ne_u32 vcc, 1, v28
    s_add_u32 s100, s100, 1
    s_cmp_ge_u32 s100, 262144
    s_cbranch_scc1 Lz13_p_x
    s_cbranch_vccnz Lz13_p
Lz13_p_x:
    s_nop 1
    s_branch Lz13_ok
Lz14_r:
    s_nop 7
Lz14_p:
    global_load_dwordx4 v[126:129], v30, s[52:53] offset:-1024 sc1
    global_load_dwordx4 v[130:133], v31, s[52:53] offset:-1024 sc1
    global_load_dwordx4 v[134:137], v30, s[54:55] offset:-1024 sc1
    global_load_dwordx4 v[138:141], v31, s[54:55] offset:-1024 sc1
    s_waitcnt vmcnt(0)
    v_and_b32 v28, v129, v133
    v_bitop3_b32 v28, v137, v141, v28 bitop3:0x80
    v_and_b32 v28, 1, v28
    v_cmp_ne_u32 vcc, 1, v28
    s_add_u32 s100, s100, 1
    s_cmp_ge_u32 s100, 262144
    s_cbranch_scc1 Lz14_p_x
    s_cbranch_vccnz Lz14_p
Lz14_p_x:
    s_nop 1
    s_branch Lz14_ok
Lz15_r:
    s_nop 7
Lz15_p:
    global_load_dwordx4 v[62:65], v30, s[64:65] offset:-1024 sc1
    global_load_dwordx4 v[66:69], v31, s[64:65] offset:-1024 sc1
    global_load_dwordx4 v[70:73], v30, s[66:67] offset:-1024 sc1
    global_load_dwordx4 v[74:77], v31, s[66:67] offset:-1024 sc1
    s_waitcnt vmcnt(0)
    v_and_b32 v28, v65, v69
    v_bitop3_b32 v28, v73, v77, v28 bitop3:0x80
    v_and_b32 v28, 1, v28
    v_cmp_ne_u32 vcc, 1, v28
    s_add_u32 s100, s100, 1
    s_cmp_ge_u32 s100, 262144
    s_cbranch_scc1 Lz15_p_x
    s_cbranch_vccnz Lz15_p
Lz15_p_x:
    s_nop 1
    s_branch Lz15_ok
Lz16_r:
    s_nop 7
Lz16_p:
    global_load_dwordx4 v[78:81], v30, s[60:61] offset:0 sc1
    global_load_dwordx4 v[82:85], v31, s[60:61] offset:0 sc1
    global_load_dwordx4 v[86:89], v30, s[62:63] offset:0 sc1
    global_load_dwordx4 v[90:93], v31, s[62:63] offset:0 sc1
    s_waitcnt vmcnt(0)
    v_and_b32 v28, v81, v85
    v_bitop3_b32 v28, v89, v93, v28 bitop3:0x80
    v_and_b32 v28, 1, v28
    v_cmp_ne_u32 vcc, 1, v28
    s_add_u32 s100, s100, 1
    s_cmp_ge_u32 s100, 262144
    s_cbranch_scc1 Lz16_p_x
    s_cbranch_vccnz Lz16_p
Lz16_p_x:
    s_nop 1
    s_branch Lz16_ok
Lz17_r:
    s_nop 7
Lz17_p:
    global_load_dwordx4 v[94:97], v30, s[52:53] offset:0 sc1
    global_load_dwordx4 v[98:101], v31, s[52:53] offset:0 sc1
    global_load_dwordx4 v[102:105], v30, s[54:55] offset:0 sc1
    global_load_dwordx4 v[106:109], v31, s[54:55] offset:0 sc1
    s_waitcnt vmcnt(0)
    v_and_b32 v28, v97, v101
    v_bitop3_b32 v28, v105, v109, v28 bitop3:0x80
    v_and_b32 v28, 1, v28
    v_cmp_ne_u32 vcc, 1, v28
    s_add_u32 s100, s100, 1
    s_cmp_ge_u32 s100, 262144
    s_cbranch_scc1 Lz17_p_x
    s_cbranch_vccnz Lz17_p
Lz17_p_x:
    s_nop 1
    s_branch Lz17_ok
Lz18_r:
    s_nop 7
Lz18_p:
    global_load_dwordx4 v[110:113], v30, s[64:65] offset:0 sc1
    global_load_dwordx4 v[114:117], v31, s[64:65] offset:0 sc1
    global_load_dwordx4 v[118:121], v30, s[66:67] offset:0 sc1
    global_load_dwordx4 v[122:125], v31, s[66:67] offset:0 sc1
    s_waitcnt vmcnt(0)
    v_and_b32 v28, v113, v117
    v_bitop3_b32 v28, v121, v125, v28 bitop3:0x80
    v_and_b32 v28, 1, v28
    v_cmp_ne_u32 vcc, 1, v28
    s_add_u32 s100, s100, 1
    s_cmp_ge_u32 s100, 262144
    s_cbranch_scc1 Lz18_p_x
    s_cbranch_vccnz Lz18_p
Lz18_p_x:
    s_nop 1
    s_branch Lz18_ok
Lz19_r:
    s_nop 7
Lz19_p:
    global_load_dwordx4 v[126:129], v30, s[60:61] offset:1024 sc1
    global_load_dwordx4 v[130:133], v31, s[60:61] offset:1024 sc1
    global_load_dwordx4 v[134:137], v30, s[62:63] offset:1024 sc1
    global_load_dwordx4 v[138:141], v31, s[62:63] offset:1024 sc1
    s_waitcnt vmcnt(0)
    v_and_b32 v28, v129, v133
    v_bitop3_b32 v28, v137, v141, v28 bitop3:0x80
    v_and_b32 v28, 1, v28
    v_cmp_ne_u32 vcc, 1, v28
    s_add_u32 s100, s100, 1
    s_cmp_ge_u32 s100, 262144
    s_cbranch_scc1 Lz19_p_x
    s_cbranch_vccnz Lz19_p
Lz19_p_x:
    s_nop 1
    s_branch Lz19_ok
Lz20_r:
    s_nop 7
Lz20_p:
    global_load_dwordx4 v[62:65], v30, s[52:53] offset:1024 sc1
    global_load_dwordx4 v[66:69], v31, s[52:53] offset:1024 sc1
    global_load_dwordx4 v[70:73], v30, s[54:55] offset:1024 sc1
    global_load_dwordx4 v[74:77], v31, s[54:55] offset:1024 sc1
    s_waitcnt vmcnt(0)
    v_and_b32 v28, v65, v69
    v_bitop3_b32 v28, v73, v77, v28 bitop3:0x80
    v_and_b32 v28, 1, v28
    v_cmp_ne_u32 vcc, 1, v28
    s_add_u32 s100, s100, 1
    s_cmp_ge_u32 s100, 262144
    s_cbranch_scc1 Lz20_p_x
    s_cbranch_vccnz Lz20_p
Lz20_p_x:
    s_nop 1
    s_branch Lz20_ok
Lz21_r:
    s_nop 7
Lz21_p:
    global_load_dwordx4 v[78:81], v30, s[64:65] offset:1024 sc1
    global_load_dwordx4 v[82:85], v31, s[64:65] offset:1024 sc1
    global_load_dwordx4 v[86:89], v30, s[66:67] offset:1024 sc1
    global_load_dwordx4 v[90:93], v31, s[66:67] offset:1024 sc1
    s_waitcnt vmcnt(0)
    v_and_b32 v28, v81, v85
    v_bitop3_b32 v28, v89, v93, v28 bitop3:0x80
    v_and_b32 v28, 1, v28
    v_cmp_ne_u32 vcc, 1, v28
    s_add_u32 s100, s100, 1
    s_cmp_ge_u32 s100, 262144
    s_cbranch_scc1 Lz21_p_x
    s_cbranch_vccnz Lz21_p
Lz21_p_x:
    s_nop 1
    s_branch Lz21_ok
Lz22_r:
    s_nop 7
Lz22_p:
    global_load_dwordx4 v[94:97], v30, s[60:61] offset:2048 sc1
    global_load_dwordx4 v[98:101], v31, s[60:61] offset:2048 sc1
    global_load_dwordx4 v[102:105], v30, s[62:63] offset:2048 sc1
    global_load_dwordx4 v[106:109], v31, s[62:63] offset:2048 sc1
    s_waitcnt vmcnt(0)
    v_and_b32 v28, v97, v101
    v_bitop3_b32 v28, v105, v109, v28 bitop3:0x80
    v_and_b32 v28, 1, v28
    v_cmp_ne_u32 vcc, 1, v28
    s_add_u32 s100, s100, 1
    s_cmp_ge_u32 s100, 262144
    s_cbranch_scc1 Lz22_p_x
    s_cbranch_vccnz Lz22_p
Lz22_p_x:
    s_nop 1
    s_branch Lz22_ok
Lz23_r:
    s_nop 7
Lz23_p:
    global_load_dwordx4 v[110:113], v30, s[52:53] offset:2048 sc1
    global_load_dwordx4 v[114:117], v31, s[52:53] offset:2048 sc1
    global_load_dwordx4 v[118:121], v30, s[54:55] offset:2048 sc1
    global_load_dwordx4 v[122:125], v31, s[54:55] offset:2048 sc1
    s_waitcnt vmcnt(0)
    v_and_b32 v28, v113, v117
    v_bitop3_b32 v28, v121, v125, v28 bitop3:0x80
    v_and_b32 v28, 1, v28
    v_cmp_ne_u32 vcc, 1, v28
    s_add_u32 s100, s100, 1
    s_cmp_ge_u32 s100, 262144
    s_cbranch_scc1 Lz23_p_x
    s_cbranch_vccnz Lz23_p
Lz23_p_x:
    s_nop 1
    s_branch Lz23_ok
Lz24_r:
    s_nop 7
Lz24_p:
    global_load_dwordx4 v[126:129], v30, s[64:65] offset:2048 sc1
    global_load_dwordx4 v[130:133], v31, s[64:65] offset:2048 sc1
    global_load_dwordx4 v[134:137], v30, s[66:67] offset:2048 sc1
    global_load_dwordx4 v[138:141], v31, s[66:67] offset:2048 sc1
    s_waitcnt vmcnt(0)
    v_and_b32 v28, v129, v133
    v_bitop3_b32 v28, v137, v141, v28 bitop3:0x80
    v_and_b32 v28, 1, v28
    v_cmp_ne_u32 vcc, 1, v28
    s_add_u32 s100, s100, 1
    s_cmp_ge_u32 s100, 262144
    s_cbranch_scc1 Lz24_p_x
    s_cbranch_vccnz Lz24_p
Lz24_p_x:
    s_nop 1
    s_branch Lz24_ok
Lz25_r:
    s_nop 7
Lz25_p:
    global_load_dwordx4 v[62:65], v30, s[60:61] offset:3072 sc1
    global_load_dwordx4 v[66:69], v31, s[60:61] offset:3072 sc1
    global_load_dwordx4 v[70:73], v30, s[62:63] offset:3072 sc1
    global_load_dwordx4 v[74:77], v31, s[62:63] offset:3072 sc1
    s_waitcnt vmcnt(0)
    v_and_b32 v28, v65, v69
    v_bitop3_b32 v28, v73, v77, v28 bitop3:0x80
    v_and_b32 v28, 1, v28
    v_cmp_ne_u32 vcc, 1, v28
    s_add_u32 s100, s100, 1
    s_cmp_ge_u32 s100, 262144
    s_cbranch_scc1 Lz25_p_x
    s_cbranch_vccnz Lz25_p
Lz25_p_x:
    s_nop 1
    s_branch Lz25_ok
Lz26_r:
    s_nop 7
Lz26_p:
    global_load_dwordx4 v[78:81], v30, s[52:53] offset:3072 sc1
    global_load_dwordx4 v[82:85], v31, s[52:53] offset:3072 sc1
    global_load_dwordx4 v[86:89], v30, s[54:55] offset:3072 sc1
    global_load_dwordx4 v[90:93], v31, s[54:55] offset:3072 sc1
    s_waitcnt vmcnt(0)
    v_and_b32 v28, v81, v85
    v_bitop3_b32 v28, v89, v93, v28 bitop3:0x80
    v_and_b32 v28, 1, v28
    v_cmp_ne_u32 vcc, 1, v28
    s_add_u32 s100, s100, 1
    s_cmp_ge_u32 s100, 262144
    s_cbranch_scc1 Lz26_p_x
    s_cbranch_vccnz Lz26_p
Lz26_p_x:
    s_nop 1
    s_branch Lz26_ok
Lz27_r:
    s_nop 7
Lz27_p:
    global_load_dwordx4 v[94:97], v30, s[64:65] offset:3072 sc1
    global_load_dwordx4 v[98:101], v31, s[64:65] offset:3072 sc1
    global_load_dwordx4 v[102:105], v30, s[66:67] offset:3072 sc1
    global_load_dwordx4 v[106:109], v31, s[66:67] offset:3072 sc1
    s_waitcnt vmcnt(0)
    v_and_b32 v28, v97, v101
    v_bitop3_b32 v28, v105, v109, v28 bitop3:0x80
    v_and_b32 v28, 1, v28
    v_cmp_ne_u32 vcc, 1, v28
    s_add_u32 s100, s100, 1
    s_cmp_ge_u32 s100, 262144
    s_cbranch_scc1 Lz27_p_x
    s_cbranch_vccnz Lz27_p
Lz27_p_x:
    s_nop 1
    s_branch Lz27_ok
Lp0_r:
    s_nop 7
Lp0_p:
    global_load_dwordx4 v[142:145], v6, s[38:39] offset:-4096 sc1
    global_load_dwordx4 v[146:149], v6, s[38:39] offset:-3072 sc1
    global_load_dwordx4 v[150:153], v6, s[38:39] offset:-2048 sc1
    global_load_dwordx4 v[154:157], v6, s[38:39] offset:-1024 sc1
    global_load_dwordx4 v[158:161], v6, s[38:39] offset:0 sc1
    global_load_dwordx4 v[162:165], v6, s[38:39] offset:1024 sc1
    global_load_dwordx4 v[166:169], v6, s[38:39] offset:2048 sc1
    global_load_dwordx4 v[170:173], v6, s[38:39] offset:3072 sc1
    s_waitcnt vmcnt(0)
    v_or_b32 v28, v145, v149
    v_or3_b32 v28, v153, v157, v28
    v_or3_b32 v28, v161, v165, v28
    v_or3_b32 v28, v169, v173, v28
    v_and_b32 v28, 1, v28
    v_cmp_ne_u32 vcc, 0, v28
    s_add_u32 s100, s100, 1
    s_cmp_ge_u32 s100, 262144
    s_cbranch_scc1 Lp0_p_x
    s_cbranch_vccnz Lp0_p
Lp0_p_x:
    s_nop 1
    s_branch Lp0_ok
Lp1_r:
    s_nop 7
Lp1_p:
    global_load_dwordx4 v[174:177], v7, s[38:39] offset:-4096 sc1
    global_load_dwordx4 v[178:181], v7, s[38:39] offset:-3072 sc1
    global_load_dwordx4 v[182:185], v7, s[38:39] offset:-2048 sc1
    global_load_dwordx4 v[186:189], v7, s[38:39] offset:-1024 sc1
    global_load_dwordx4 v[190:193], v7, s[38:39] offset:0 sc1
    global_load_dwordx4 v[194:197], v7, s[38:39] offset:1024 sc1
    global_load_dwordx4 v[198:201], v7, s[38:39] offset:2048 sc1
    global_load_dwordx4 v[202:205], v7, s[38:39] offset:3072 sc1
    s_waitcnt vmcnt(0)
    v_or_b32 v28, v177, v181
    v_or3_b32 v28, v185, v189, v28
    v_or3_b32 v28, v193, v197, v28
    v_or3_b32 v28, v201, v205, v28
    v_and_b32 v28, 1, v28
    v_cmp_ne_u32 vcc, 0, v28
    s_add_u32 s100, s100, 1
    s_cmp_ge_u32 s100, 262144
    s_cbranch_scc1 Lp1_p_x
    s_cbranch_vccnz Lp1_p
Lp1_p_x:
    s_nop 1
    s_branch Lp1_ok
Lp2_r:
    s_nop 7
Lp2_p:
    global_load_dwordx4 v[206:209], v26, s[38:39] offset:-4096 sc1
    global_load_dwordx4 v[210:213], v26, s[38:39] offset:-3072 sc1
    global_load_dwordx4 v[214:217], v26, s[38:39] offset:-2048 sc1
    global_load_dwordx4 v[218:221], v26, s[38:39] offset:-1024 sc1
    global_load_dwordx4 v[222:225], v26, s[38:39] offset:0 sc1
    global_load_dwordx4 v[226:229], v26, s[38:39] offset:1024 sc1
    global_load_dwordx4 v[230:233], v26, s[38:39] offset:2048 sc1
    s_waitcnt vmcnt(0)
    v_or3_b32 v28, v209, v213, v217
    v_or3_b32 v28, v221, v225, v28
    v_or3_b32 v28, v229, v233, v28
    v_and_b32 v28, 1, v28
    v_cmp_ne_u32 vcc, 0, v28
    s_add_u32 s100, s100, 1
    s_cmp_ge_u32 s100, 262144
    s_cbranch_scc1 Lp2_p_x
    s_cbranch_vccnz Lp2_p
Lp2_p_x:
    s_nop 1
    s_branch Lp2_ok
Lp3_r:
    s_nop 7
Lp3_p:
    global_load_dwordx4 v[238:241], v27, s[38:39] offset:-4096 sc1
    global_load_dwordx4 v[242:245], v27, s[38:39] offset:-3072 sc1
    global_load_dwordx4 v[246:249], v27, s[38:39] offset:-2048 sc1
    global_load_dwordx4 v[250:253], v27, s[38:39] offset:-1024 sc1
    s_waitcnt vmcnt(0)
    v_or_b32 v28, v239, v241
    v_or3_b32 v28, v243, v245, v28
    v_or3_b32 v28, v247, v249, v28
    v_or3_b32 v28, v251, v253, v28
    v_and_b32 v28, 1, v28
    v_cmp_ne_u32 vcc, 0, v28
    s_add_u32 s100, s100, 1
    s_cmp_ge_u32 s100, 262144
    s_cbranch_scc1 Lp3_p_x
    s_cbranch_vccnz Lp3_p
Lp3_p_x:
    s_nop 1
    s_branch Lp3_ok
Lcode_end:
    s_endpgm
.section .rodata,"a"
.p2align 6
.amdhsa_kernel adaLN_cond__ssm_conv_h3__mixer_gmlp__prompt_kernel
  .amdhsa_next_free_vgpr 512
  .amdhsa_next_free_sgpr 102
  .amdhsa_accum_offset 256
  .amdhsa_group_segment_fixed_size 0
  .amdhsa_kernarg_size 128
  .amdhsa_user_sgpr_count 2
  .amdhsa_user_sgpr_kernarg_segment_ptr 1
  .amdhsa_system_sgpr_workgroup_id_x 1
  .amdhsa_float_denorm_mode_32 3
.end_amdhsa_kernel
```

```asm
; @launch grid=(256,1,1) block=(256,1,1) lds=163840
.amdgcn_target "amdgcn-amd-amdhsa--gfx950"
.text
.p2align 8
.globl adaLN_cond__ssm_conv_h3__mixer_gmlp__prompt_kernel
.type adaLN_cond__ssm_conv_h3__mixer_gmlp__prompt_kernel,@function
adaLN_cond__ssm_conv_h3__mixer_gmlp__prompt_kernel:
    s_cmp_ge_u32 s2, 256
    s_cbranch_scc1 Lend
    s_load_dwordx16 s[8:23], s[0:1], 0
    s_load_dwordx16 s[24:39], s[0:1], 64
    v_lshrrev_b32 v2, 6, v0
    v_and_b32 v1, 63, v0
    v_readfirstlane_b32 s3, v2
    s_getpc_b64 s[4:5]
Lpf_adaLN_cond__ssm_conv_h3__mixer_gmlp__prompt_kernel_9:
    s_add_u32 s4, s4, adaLN_cond__ssm_conv_h3__mixer_gmlp__prompt_kernel-Lpf_adaLN_cond__ssm_conv_h3__mixer_gmlp__prompt_kernel_9
    s_addc_u32 s5, s5, -1
    s_lshr_b32 s6, s2, 3
    s_and_b32 s6, s6, 31
    v_mul_u32_u24 v254, 32, v0
    v_add_lshl_u32 v254, v254, s6, 7
    v_min_u32 v254, (Lcode_end-adaLN_cond__ssm_conv_h3__mixer_gmlp__prompt_kernel-4), v254
    global_load_dword v254, v254, s[4:5]
    s_mov_b64 s[58:59], s[4:5]
    v_and_b32 v2, 15, v1
    v_lshrrev_b32 v3, 4, v1
    v_lshlrev_b32 v4, 4, v1
    v_lshrrev_b32 v6, 2, v2
    v_and_b32 v5, 3, v2
    v_lshl_add_u32 v5, v6, 3, v5
    s_mov_b32 s100, 0
    s_and_b32 s4, s2, 7
    s_lshr_b32 s5, s2, 3
    s_lshr_b32 s43, s5, 2
    s_lshr_b32 s6, s43, 1
    s_lshl_b32 s6, s6, 3
    s_and_b32 s7, s4, 6
    s_add_u32 s6, s6, s7
    s_and_b32 s7, s43, 1
    s_add_u32 s40, s6, s7
    s_and_b32 s6, s4, 1
    s_lshl_b32 s6, s6, 2
    s_and_b32 s7, s5, 3
    s_add_u32 s41, s6, s7
    s_mul_i32 s4, s4, 20
    s_add_u32 s42, s4, s5
    s_waitcnt lgkmcnt(0)
    s_mov_b64 s[0:1], s[58:59]
    s_cmp_ge_u32 s2, 160
    s_cbranch_scc1 Lspare
Lconv:
    s_and_b32 s4, s42, 15
    s_lshl_b32 s4, s4, 2
    s_add_u32 s4, s4, s3
    s_mul_i32 s4, s4, 40960
    s_lshr_b32 s5, s42, 4
    s_lshl_b32 s6, s5, 7
    s_add_u32 s4, s4, s6
    v_mul_u32_u24 v46, 10240, v3
    v_lshl_add_u32 v46, v2, 3, v46
    v_add_u32 v46, s4, v46
    v_add_u32 v47, 5120, v46
    global_load_dwordx2 v[56:57], v46, s[10:11] offset:0
    global_load_dwordx2 v[58:59], v46, s[10:11] offset:1280
    global_load_dwordx2 v[60:61], v46, s[10:11] offset:2560
    global_load_dwordx2 v[62:63], v46, s[10:11] offset:3840
    global_load_dwordx2 v[64:65], v47, s[10:11] offset:0
    global_load_dwordx2 v[66:67], v47, s[10:11] offset:1280
    global_load_dwordx2 v[68:69], v47, s[10:11] offset:2560
    global_load_dwordx2 v[70:71], v47, s[10:11] offset:3840
    v_max_u32 v48, 3840, v46
    global_load_dwordx2 v[50:51], v48, s[10:11] offset:-3840
    global_load_dwordx2 v[52:53], v48, s[10:11] offset:-2560
    global_load_dwordx2 v[54:55], v48, s[10:11] offset:-1280
    s_lshl_b32 s5, s5, 9
    v_lshl_add_u32 v48, v2, 5, s5
    global_load_dwordx4 v[88:91], v48, s[14:15] offset:0
    global_load_dwordx4 v[92:95], v48, s[14:15] offset:16
    global_load_dwordx2 v[72:73], v46, s[12:13] offset:0 nt
    global_load_dwordx2 v[74:75], v46, s[12:13] offset:1280 nt
    global_load_dwordx2 v[76:77], v46, s[12:13] offset:2560 nt
    global_load_dwordx2 v[78:79], v46, s[12:13] offset:3840 nt
    global_load_dwordx2 v[80:81], v47, s[12:13] offset:0 nt
    global_load_dwordx2 v[82:83], v47, s[12:13] offset:1280 nt
    global_load_dwordx2 v[84:85], v47, s[12:13] offset:2560 nt
    global_load_dwordx2 v[86:87], v47, s[12:13] offset:3840 nt
    s_lshl_b32 s7, s42, 3
    s_load_dwordx2 s[92:93], s[18:19], s7
    v_mov_b32 v156, 0
    v_mov_b32 v157, 0
    v_mov_b32 v158, 0
    v_mov_b32 v159, 0
    s_mul_i32 s5, s3, 8448
    v_and_b32 v28, 48, v4
    v_add_u32 v28, s5, v28
    ds_write_b128 v28, v[156:159] offset:0
    ds_write_b128 v28, v[156:159] offset:4224
    v_min_u32 v28, 448, v4
    s_mul_i32 s4, s3, 9280
    v_add_u32 v28, s4, v28
    ds_write_b128 v28, v[156:159] offset:37888
    ds_write_b128 v28, v[156:159] offset:42528
    v_add_u32 v37, s5, v4
    v_and_b32 v28, 1, v2
    v_lshrrev_b32 v29, 1, v2
    v_mul_u32_u24 v36, 4224, v28
    v_lshl_add_u32 v36, v29, 3, v36
    v_lshl_add_u32 v36, v3, 4, v36
    v_add_u32 v36, s5, v36
    v_mul_u32_u24 v38, 4640, v28
    v_lshlrev_b32 v29, 6, v29
    v_sub_u32 v38, v38, v29
    v_lshl_add_u32 v38, v3, 4, v38
    s_add_u32 s4, s4, 34256
    v_add_u32 v38, s4, v38
    v_lshl_add_u32 v40, v28, 2, v29
    v_lshl_add_u32 v40, v3, 4, v40
    s_mul_i32 s4, s3, 1056
    s_add_u32 s4, s4, 0
    v_add_u32 v40, s4, v40
    v_lshlrev_b32 v28, 2, v0
    v_sub_u32 v39, 34824, v28
    v_add_u32 v41, 0, v28
    v_lshrrev_b32 v28, 5, v0
    v_mul_u32_u24 v43, 114688, v28
    v_and_b32 v28, 31, v0
    v_lshl_add_u32 v43, v28, 4, v43
    s_lshl_b32 s4, s42, 9
    s_add_u32 s4, s4, 1048576
    v_add_u32 v43, s4, v43
    s_waitcnt lgkmcnt(0)
    s_lshl_b32 s20, s92, 16
    s_lshr_b32 s28, s20, 16
    s_and_b32 s21, s92, 0xffff0000
    s_lshr_b32 s29, s21, 16
    s_lshl_b32 s22, s93, 16
    s_lshr_b32 s30, s22, 16
    s_and_b32 s23, s93, 0xffff0000
    s_lshr_b32 s31, s23, 16
    v_and_b32 v211, 7, v1
    v_lshrrev_b32 v212, 3, v1
    s_lshl_b32 s4, s42, 2
    s_add_u32 s4, s4, s3
    s_lshl_b32 s94, s4, 12
    v_add_u32 v28, s94, v4
    s_mul_i32 s5, s3, 8448
    s_add_u32 m0, s5, 4288
    s_nop 0
    global_load_lds_dwordx4 v28, s[16:17] offset:0 nt
    global_load_lds_dwordx4 v28, s[16:17] offset:1024 nt
    global_load_lds_dwordx4 v28, s[16:17] offset:2048 nt
    global_load_lds_dwordx4 v28, s[16:17] offset:3072 nt
    s_lshr_b32 s5, s3, 1
    s_lshl_b32 s5, s5, 5
    s_and_b32 s6, s3, 1
    s_lshl_b32 s6, s6, 2
    s_add_u32 s6, s6, s5
    s_lshl_b32 s5, s40, 6
    s_add_u32 s90, s6, s5
    v_add_lshl_u32 v27, v5, s90, 1
    global_load_ushort v27, v27, s[26:27]
    s_waitcnt vmcnt(25)
    v_lshlrev_b32 v124, 16, v56
    v_and_b32 v125, 0xffff0000, v56
    v_lshlrev_b32 v126, 16, v57
    v_and_b32 v127, 0xffff0000, v57
    s_waitcnt vmcnt(24)
    v_lshlrev_b32 v128, 16, v58
    v_and_b32 v129, 0xffff0000, v58
    v_lshlrev_b32 v130, 16, v59
    v_and_b32 v131, 0xffff0000, v59
    s_waitcnt vmcnt(23)
    v_lshlrev_b32 v132, 16, v60
    v_and_b32 v133, 0xffff0000, v60
    v_lshlrev_b32 v134, 16, v61
    v_and_b32 v135, 0xffff0000, v61
    s_waitcnt vmcnt(22)
    v_lshlrev_b32 v136, 16, v62
    v_and_b32 v137, 0xffff0000, v62
    v_lshlrev_b32 v138, 16, v63
    v_and_b32 v139, 0xffff0000, v63
    s_waitcnt vmcnt(21)
    v_lshlrev_b32 v140, 16, v64
    v_and_b32 v141, 0xffff0000, v64
    v_lshlrev_b32 v142, 16, v65
    v_and_b32 v143, 0xffff0000, v65
    s_waitcnt vmcnt(20)
    v_lshlrev_b32 v144, 16, v66
    v_and_b32 v145, 0xffff0000, v66
    v_lshlrev_b32 v146, 16, v67
    v_and_b32 v147, 0xffff0000, v67
    s_waitcnt vmcnt(19)
    v_lshlrev_b32 v148, 16, v68
    v_and_b32 v149, 0xffff0000, v68
    v_lshlrev_b32 v150, 16, v69
    v_and_b32 v151, 0xffff0000, v69
    s_waitcnt vmcnt(18)
    v_lshlrev_b32 v152, 16, v70
    v_and_b32 v153, 0xffff0000, v70
    v_lshlrev_b32 v154, 16, v71
    v_and_b32 v155, 0xffff0000, v71
    s_lshl_b32 s4, s42, 2
    s_add_u32 s4, s4, s3
    s_mul_i32 s4, s4, 5120
    s_cmp_lt_u32 s42, 128
    s_cselect_b32 s5, -1, 0
    v_add_u32 v209, s4, v4
    v_and_b32 v209, s5, v209
    v_add_u32 v209, 2048, v209
    global_load_dwordx4 v[188:191], v209, s[8:9] offset:-2048 nt
    global_load_dwordx4 v[192:195], v209, s[8:9] offset:-1024 nt
    global_load_dwordx4 v[196:199], v209, s[8:9] offset:0 nt
    global_load_dwordx4 v[200:203], v209, s[8:9] offset:1024 nt
    global_load_dwordx4 v[204:207], v209, s[8:9] offset:2048 nt
    v_cmp_le_u32 vcc, 1280, v46
    s_waitcnt vmcnt(22)
    s_nop 0
    v_cndmask_b32 v50, 0, v50, vcc
    v_cndmask_b32 v51, 0, v51, vcc
    s_waitcnt vmcnt(21)
    v_cndmask_b32 v52, 0, v52, vcc
    v_cndmask_b32 v53, 0, v53, vcc
    s_waitcnt vmcnt(20)
    v_cndmask_b32 v54, 0, v54, vcc
    v_cndmask_b32 v55, 0, v55, vcc
    v_lshlrev_b32 v112, 16, v50
    v_and_b32 v113, 0xffff0000, v50
    v_lshlrev_b32 v114, 16, v51
    v_and_b32 v115, 0xffff0000, v51
    v_lshlrev_b32 v116, 16, v52
    v_and_b32 v117, 0xffff0000, v52
    v_lshlrev_b32 v118, 16, v53
    v_and_b32 v119, 0xffff0000, v53
    v_lshlrev_b32 v120, 16, v54
    v_and_b32 v121, 0xffff0000, v54
    v_lshlrev_b32 v122, 16, v55
    v_and_b32 v123, 0xffff0000, v55
    s_waitcnt vmcnt(19)
    v_lshlrev_b32 v96, 16, v88
    v_and_b32 v100, 0xffff0000, v88
    v_lshlrev_b32 v104, 16, v89
    v_and_b32 v108, 0xffff0000, v89
    v_lshlrev_b32 v97, 16, v90
    v_and_b32 v101, 0xffff0000, v90
    v_lshlrev_b32 v105, 16, v91
    v_and_b32 v109, 0xffff0000, v91
    s_waitcnt vmcnt(18)
    v_lshlrev_b32 v98, 16, v92
    v_and_b32 v102, 0xffff0000, v92
    v_lshlrev_b32 v106, 16, v93
    v_and_b32 v110, 0xffff0000, v93
    v_lshlrev_b32 v99, 16, v94
    v_and_b32 v103, 0xffff0000, v94
    v_lshlrev_b32 v107, 16, v95
    v_and_b32 v111, 0xffff0000, v95
    v_pk_mul_f32 v[156:157], v[124:125], v[96:97] op_sel:[0,0] op_sel_hi:[1,1]
    v_pk_mul_f32 v[158:159], v[126:127], v[98:99] op_sel:[0,0] op_sel_hi:[1,1]
    v_pk_mul_f32 v[160:161], v[128:129], v[96:97] op_sel:[0,0] op_sel_hi:[1,1]
    v_pk_mul_f32 v[162:163], v[130:131], v[98:99] op_sel:[0,0] op_sel_hi:[1,1]
    v_pk_mul_f32 v[164:165], v[132:133], v[96:97] op_sel:[0,0] op_sel_hi:[1,1]
    v_pk_mul_f32 v[166:167], v[134:135], v[98:99] op_sel:[0,0] op_sel_hi:[1,1]
    v_pk_mul_f32 v[168:169], v[136:137], v[96:97] op_sel:[0,0] op_sel_hi:[1,1]
    v_pk_mul_f32 v[170:171], v[138:139], v[98:99] op_sel:[0,0] op_sel_hi:[1,1]
    v_pk_mul_f32 v[172:173], v[140:141], v[96:97] op_sel:[0,0] op_sel_hi:[1,1]
    v_pk_mul_f32 v[174:175], v[142:143], v[98:99] op_sel:[0,0] op_sel_hi:[1,1]
    v_pk_mul_f32 v[176:177], v[144:145], v[96:97] op_sel:[0,0] op_sel_hi:[1,1]
    v_pk_mul_f32 v[178:179], v[146:147], v[98:99] op_sel:[0,0] op_sel_hi:[1,1]
    v_pk_mul_f32 v[180:181], v[148:149], v[96:97] op_sel:[0,0] op_sel_hi:[1,1]
    v_pk_mul_f32 v[182:183], v[150:151], v[98:99] op_sel:[0,0] op_sel_hi:[1,1]
    v_pk_mul_f32 v[184:185], v[152:153], v[96:97] op_sel:[0,0] op_sel_hi:[1,1]
    v_pk_mul_f32 v[186:187], v[154:155], v[98:99] op_sel:[0,0] op_sel_hi:[1,1]
    v_pk_fma_f32 v[156:157], v[120:121], v[100:101], v[156:157] op_sel:[0,0,0] op_sel_hi:[1,1,1]
    v_pk_fma_f32 v[158:159], v[122:123], v[102:103], v[158:159] op_sel:[0,0,0] op_sel_hi:[1,1,1]
    v_pk_fma_f32 v[160:161], v[124:125], v[100:101], v[160:161] op_sel:[0,0,0] op_sel_hi:[1,1,1]
    v_pk_fma_f32 v[162:163], v[126:127], v[102:103], v[162:163] op_sel:[0,0,0] op_sel_hi:[1,1,1]
    v_pk_fma_f32 v[164:165], v[128:129], v[100:101], v[164:165] op_sel:[0,0,0] op_sel_hi:[1,1,1]
    v_pk_fma_f32 v[166:167], v[130:131], v[102:103], v[166:167] op_sel:[0,0,0] op_sel_hi:[1,1,1]
    v_pk_fma_f32 v[168:169], v[132:133], v[100:101], v[168:169] op_sel:[0,0,0] op_sel_hi:[1,1,1]
    v_pk_fma_f32 v[170:171], v[134:135], v[102:103], v[170:171] op_sel:[0,0,0] op_sel_hi:[1,1,1]
    v_pk_fma_f32 v[172:173], v[136:137], v[100:101], v[172:173] op_sel:[0,0,0] op_sel_hi:[1,1,1]
    v_pk_fma_f32 v[174:175], v[138:139], v[102:103], v[174:175] op_sel:[0,0,0] op_sel_hi:[1,1,1]
    v_pk_fma_f32 v[176:177], v[140:141], v[100:101], v[176:177] op_sel:[0,0,0] op_sel_hi:[1,1,1]
    v_pk_fma_f32 v[178:179], v[142:143], v[102:103], v[178:179] op_sel:[0,0,0] op_sel_hi:[1,1,1]
    v_pk_fma_f32 v[180:181], v[144:145], v[100:101], v[180:181] op_sel:[0,0,0] op_sel_hi:[1,1,1]
    v_pk_fma_f32 v[182:183], v[146:147], v[102:103], v[182:183] op_sel:[0,0,0] op_sel_hi:[1,1,1]
    v_pk_fma_f32 v[184:185], v[148:149], v[100:101], v[184:185] op_sel:[0,0,0] op_sel_hi:[1,1,1]
    v_pk_fma_f32 v[186:187], v[150:151], v[102:103], v[186:187] op_sel:[0,0,0] op_sel_hi:[1,1,1]
    v_pk_fma_f32 v[156:157], v[116:117], v[104:105], v[156:157] op_sel:[0,0,0] op_sel_hi:[1,1,1]
    v_pk_fma_f32 v[158:159], v[118:119], v[106:107], v[158:159] op_sel:[0,0,0] op_sel_hi:[1,1,1]
    v_pk_fma_f32 v[160:161], v[120:121], v[104:105], v[160:161] op_sel:[0,0,0] op_sel_hi:[1,1,1]
    v_pk_fma_f32 v[162:163], v[122:123], v[106:107], v[162:163] op_sel:[0,0,0] op_sel_hi:[1,1,1]
    v_pk_fma_f32 v[164:165], v[124:125], v[104:105], v[164:165] op_sel:[0,0,0] op_sel_hi:[1,1,1]
    v_pk_fma_f32 v[166:167], v[126:127], v[106:107], v[166:167] op_sel:[0,0,0] op_sel_hi:[1,1,1]
    v_pk_fma_f32 v[168:169], v[128:129], v[104:105], v[168:169] op_sel:[0,0,0] op_sel_hi:[1,1,1]
    v_pk_fma_f32 v[170:171], v[130:131], v[106:107], v[170:171] op_sel:[0,0,0] op_sel_hi:[1,1,1]
    v_pk_fma_f32 v[172:173], v[132:133], v[104:105], v[172:173] op_sel:[0,0,0] op_sel_hi:[1,1,1]
    v_pk_fma_f32 v[174:175], v[134:135], v[106:107], v[174:175] op_sel:[0,0,0] op_sel_hi:[1,1,1]
    v_pk_fma_f32 v[176:177], v[136:137], v[104:105], v[176:177] op_sel:[0,0,0] op_sel_hi:[1,1,1]
    v_pk_fma_f32 v[178:179], v[138:139], v[106:107], v[178:179] op_sel:[0,0,0] op_sel_hi:[1,1,1]
    v_pk_fma_f32 v[180:181], v[140:141], v[104:105], v[180:181] op_sel:[0,0,0] op_sel_hi:[1,1,1]
    v_pk_fma_f32 v[182:183], v[142:143], v[106:107], v[182:183] op_sel:[0,0,0] op_sel_hi:[1,1,1]
    v_pk_fma_f32 v[184:185], v[144:145], v[104:105], v[184:185] op_sel:[0,0,0] op_sel_hi:[1,1,1]
    v_pk_fma_f32 v[186:187], v[146:147], v[106:107], v[186:187] op_sel:[0,0,0] op_sel_hi:[1,1,1]
    v_pk_fma_f32 v[156:157], v[112:113], v[108:109], v[156:157] op_sel:[0,0,0] op_sel_hi:[1,1,1]
    v_pk_fma_f32 v[158:159], v[114:115], v[110:111], v[158:159] op_sel:[0,0,0] op_sel_hi:[1,1,1]
    v_pk_fma_f32 v[160:161], v[116:117], v[108:109], v[160:161] op_sel:[0,0,0] op_sel_hi:[1,1,1]
    v_pk_fma_f32 v[162:163], v[118:119], v[110:111], v[162:163] op_sel:[0,0,0] op_sel_hi:[1,1,1]
    v_pk_fma_f32 v[164:165], v[120:121], v[108:109], v[164:165] op_sel:[0,0,0] op_sel_hi:[1,1,1]
    v_pk_fma_f32 v[166:167], v[122:123], v[110:111], v[166:167] op_sel:[0,0,0] op_sel_hi:[1,1,1]
    v_pk_fma_f32 v[168:169], v[124:125], v[108:109], v[168:169] op_sel:[0,0,0] op_sel_hi:[1,1,1]
    v_pk_fma_f32 v[170:171], v[126:127], v[110:111], v[170:171] op_sel:[0,0,0] op_sel_hi:[1,1,1]
    v_pk_fma_f32 v[172:173], v[128:129], v[108:109], v[172:173] op_sel:[0,0,0] op_sel_hi:[1,1,1]
    v_pk_fma_f32 v[174:175], v[130:131], v[110:111], v[174:175] op_sel:[0,0,0] op_sel_hi:[1,1,1]
    v_pk_fma_f32 v[176:177], v[132:133], v[108:109], v[176:177] op_sel:[0,0,0] op_sel_hi:[1,1,1]
    v_pk_fma_f32 v[178:179], v[134:135], v[110:111], v[178:179] op_sel:[0,0,0] op_sel_hi:[1,1,1]
    v_pk_fma_f32 v[180:181], v[136:137], v[108:109], v[180:181] op_sel:[0,0,0] op_sel_hi:[1,1,1]
    v_pk_fma_f32 v[182:183], v[138:139], v[110:111], v[182:183] op_sel:[0,0,0] op_sel_hi:[1,1,1]
    v_pk_fma_f32 v[184:185], v[140:141], v[108:109], v[184:185] op_sel:[0,0,0] op_sel_hi:[1,1,1]
    v_pk_fma_f32 v[186:187], v[142:143], v[110:111], v[186:187] op_sel:[0,0,0] op_sel_hi:[1,1,1]
    s_lshl_b32 s4, s3, 6
    s_sub_u32 s4, 104688, s4
    v_mul_u32_u24 v48, 272, v2
    v_add_u32 v48, s4, v48
    v_lshlrev_b32 v47, 4, v3
    v_sub_u32 v48, v48, v47
    s_waitcnt vmcnt(17)
    v_lshlrev_b32 v112, 16, v72
    v_and_b32 v113, 0xffff0000, v72
    v_lshlrev_b32 v114, 16, v73
    v_and_b32 v115, 0xffff0000, v73
    v_pk_mul_f32 v[156:157], v[156:157], v[112:113] op_sel:[0,0] op_sel_hi:[1,1]
    v_pk_mul_f32 v[158:159], v[158:159], v[114:115] op_sel:[0,0] op_sel_hi:[1,1]
    s_waitcnt vmcnt(16)
    v_lshlrev_b32 v116, 16, v74
    v_and_b32 v117, 0xffff0000, v74
    v_lshlrev_b32 v118, 16, v75
    v_and_b32 v119, 0xffff0000, v75
    v_pk_mul_f32 v[160:161], v[160:161], v[116:117] op_sel:[0,0] op_sel_hi:[1,1]
    v_pk_mul_f32 v[162:163], v[162:163], v[118:119] op_sel:[0,0] op_sel_hi:[1,1]
    s_waitcnt vmcnt(15)
    v_lshlrev_b32 v120, 16, v76
    v_and_b32 v121, 0xffff0000, v76
    v_lshlrev_b32 v122, 16, v77
    v_and_b32 v123, 0xffff0000, v77
    v_pk_mul_f32 v[164:165], v[164:165], v[120:121] op_sel:[0,0] op_sel_hi:[1,1]
    v_pk_mul_f32 v[166:167], v[166:167], v[122:123] op_sel:[0,0] op_sel_hi:[1,1]
    s_waitcnt vmcnt(14)
    v_lshlrev_b32 v124, 16, v78
    v_and_b32 v125, 0xffff0000, v78
    v_lshlrev_b32 v126, 16, v79
    v_and_b32 v127, 0xffff0000, v79
    v_pk_mul_f32 v[168:169], v[168:169], v[124:125] op_sel:[0,0] op_sel_hi:[1,1]
    v_pk_mul_f32 v[170:171], v[170:171], v[126:127] op_sel:[0,0] op_sel_hi:[1,1]
    s_waitcnt vmcnt(13)
    v_lshlrev_b32 v128, 16, v80
    v_and_b32 v129, 0xffff0000, v80
    v_lshlrev_b32 v130, 16, v81
    v_and_b32 v131, 0xffff0000, v81
    v_pk_mul_f32 v[172:173], v[172:173], v[128:129] op_sel:[0,0] op_sel_hi:[1,1]
    v_pk_mul_f32 v[174:175], v[174:175], v[130:131] op_sel:[0,0] op_sel_hi:[1,1]
    s_waitcnt vmcnt(12)
    v_lshlrev_b32 v132, 16, v82
    v_and_b32 v133, 0xffff0000, v82
    v_lshlrev_b32 v134, 16, v83
    v_and_b32 v135, 0xffff0000, v83
    v_pk_mul_f32 v[176:177], v[176:177], v[132:133] op_sel:[0,0] op_sel_hi:[1,1]
    v_pk_mul_f32 v[178:179], v[178:179], v[134:135] op_sel:[0,0] op_sel_hi:[1,1]
    s_waitcnt vmcnt(11)
    v_lshlrev_b32 v136, 16, v84
    v_and_b32 v137, 0xffff0000, v84
    v_lshlrev_b32 v138, 16, v85
    v_and_b32 v139, 0xffff0000, v85
    v_pk_mul_f32 v[180:181], v[180:181], v[136:137] op_sel:[0,0] op_sel_hi:[1,1]
    v_pk_mul_f32 v[182:183], v[182:183], v[138:139] op_sel:[0,0] op_sel_hi:[1,1]
    s_waitcnt vmcnt(10)
    v_lshlrev_b32 v140, 16, v86
    v_and_b32 v141, 0xffff0000, v86
    v_lshlrev_b32 v142, 16, v87
    v_and_b32 v143, 0xffff0000, v87
    v_pk_mul_f32 v[184:185], v[184:185], v[140:141] op_sel:[0,0] op_sel_hi:[1,1]
    v_pk_mul_f32 v[186:187], v[186:187], v[142:143] op_sel:[0,0] op_sel_hi:[1,1]
    v_cvt_pk_bf16_f32 v96, v184, v180
    v_cvt_pk_bf16_f32 v97, v176, v172
    v_cvt_pk_bf16_f32 v98, v168, v164
    v_cvt_pk_bf16_f32 v99, v160, v156
    v_and_b32 v99, -2, v99
    ds_write_b128 v48, v[96:99] offset:0
    v_cvt_pk_bf16_f32 v100, v185, v181
    v_cvt_pk_bf16_f32 v101, v177, v173
    v_cvt_pk_bf16_f32 v102, v169, v165
    v_cvt_pk_bf16_f32 v103, v161, v157
    v_and_b32 v103, -2, v103
    ds_write_b128 v48, v[100:103] offset:4352
    v_cvt_pk_bf16_f32 v104, v186, v182
    v_cvt_pk_bf16_f32 v105, v178, v174
    v_cvt_pk_bf16_f32 v106, v170, v166
    v_cvt_pk_bf16_f32 v107, v162, v158
    v_and_b32 v107, -2, v107
    ds_write_b128 v48, v[104:107] offset:8704
    v_cvt_pk_bf16_f32 v108, v187, v183
    v_cvt_pk_bf16_f32 v109, v179, v175
    v_cvt_pk_bf16_f32 v110, v171, v167
    v_cvt_pk_bf16_f32 v111, v163, v159
    v_and_b32 v111, -2, v111
    ds_write_b128 v48, v[108:111] offset:13056
    s_waitcnt lgkmcnt(0)
    s_barrier
    s_mul_i32 s4, s3, 4352
    s_add_u32 s4, s4, 104448
    v_mul_u32_u24 v48, 272, v3
    v_lshl_add_u32 v48, v2, 4, v48
    v_add_u32 v48, s4, v48
    ds_read_b128 v[156:159], v48 offset:0
    ds_read_b128 v[160:163], v48 offset:1088
    ds_read_b128 v[164:167], v48 offset:2176
    ds_read_b128 v[168:171], v48 offset:3264
    s_lshr_b32 s4, s42, 4
    s_lshl_b32 s4, s4, 6
    s_add_u32 s4, s4, s3
    s_lshl_b32 s4, s4, 12
    s_and_b32 s5, s42, 15
    s_lshl_b32 s5, s5, 8
    s_sub_u32 s4, s4, s5
    s_add_u32 s4, s4, 12586752
    v_lshl_add_u32 v46, v3, 14, s4
    v_lshl_add_u32 v46, v2, 4, v46
    s_waitcnt lgkmcnt(3)
    global_store_dwordx4 v46, v[156:159], s[38:39] sc1
    v_add_u32 v46, 65536, v46
    s_waitcnt lgkmcnt(2)
    global_store_dwordx4 v46, v[160:163], s[38:39] sc1
    v_add_u32 v46, 65536, v46
    s_waitcnt lgkmcnt(1)
    global_store_dwordx4 v46, v[164:167], s[38:39] sc1
    v_add_u32 v46, 65536, v46
    s_waitcnt lgkmcnt(0)
    global_store_dwordx4 v46, v[168:171], s[38:39] sc1
    v_and_b32 v220, 7, v1
    v_lshlrev_b32 v220, 2, v220
    v_mov_b32 v221, 1
    s_cmp_lg_u32 s3, 0
    s_cbranch_scc1 Ldb1
    global_load_dword v221, v220, s[36:37] sc1
Ldb1:
    s_waitcnt vmcnt(10)
    ds_read_b128 v[50:53], v37 offset:4288
    ds_read_b32 v49, v37 offset:4284
    ds_read_b128 v[58:61], v37 offset:5312
    ds_read_b32 v57, v37 offset:5308
    ds_read_b128 v[66:69], v37 offset:6336
    ds_read_b32 v65, v37 offset:6332
    ds_read_b128 v[74:77], v37 offset:7360
    ds_read_b32 v73, v37 offset:7356
    s_waitcnt lgkmcnt(6)
    v_alignbit_b32 v80, v50, v49, 16
    v_alignbit_b32 v81, v51, v50, 16
    v_alignbit_b32 v82, v52, v51, 16
    v_alignbit_b32 v83, v53, v52, 16
    ds_write_b128 v37, v[80:83] offset:64
    s_waitcnt lgkmcnt(5)
    v_alignbit_b32 v84, v58, v57, 16
    v_alignbit_b32 v85, v59, v58, 16
    v_alignbit_b32 v86, v60, v59, 16
    v_alignbit_b32 v87, v61, v60, 16
    ds_write_b128 v37, v[84:87] offset:1088
    s_waitcnt lgkmcnt(4)
    v_alignbit_b32 v88, v66, v65, 16
    v_alignbit_b32 v89, v67, v66, 16
    v_alignbit_b32 v90, v68, v67, 16
    v_alignbit_b32 v91, v69, v68, 16
    ds_write_b128 v37, v[88:91] offset:2112
    s_waitcnt lgkmcnt(3)
    v_alignbit_b32 v92, v74, v73, 16
    v_alignbit_b32 v93, v75, v74, 16
    v_alignbit_b32 v94, v76, v75, 16
    v_alignbit_b32 v95, v77, v76, 16
    ds_write_b128 v37, v[92:95] offset:3136
    ds_read_b64 a[0:1], v36 offset:8
    ds_read_b64 a[2:3], v36 offset:16
    ds_read_b64 a[4:5], v36 offset:72
    ds_read_b64 a[6:7], v36 offset:80
    ds_read_b64 a[8:9], v36 offset:136
    ds_read_b64 a[10:11], v36 offset:144
    ds_read_b64 a[12:13], v36 offset:200
    ds_read_b64 a[14:15], v36 offset:208
    ds_read_b64 a[16:17], v36 offset:264
    ds_read_b64 a[18:19], v36 offset:272
    ds_read_b64 a[20:21], v36 offset:328
    ds_read_b64 a[22:23], v36 offset:336
    ds_read_b64 a[24:25], v36 offset:392
    ds_read_b64 a[26:27], v36 offset:400
    ds_read_b64 a[28:29], v36 offset:456
    ds_read_b64 a[30:31], v36 offset:464
    ds_read_b64 a[32:33], v36 offset:520
    ds_read_b64 a[34:35], v36 offset:528
    ds_read_b64 a[36:37], v36 offset:584
    ds_read_b64 a[38:39], v36 offset:592
    ds_read_b64 a[40:41], v36 offset:648
    ds_read_b64 a[42:43], v36 offset:656
    ds_read_b64 a[44:45], v36 offset:712
    ds_read_b64 a[46:47], v36 offset:720
    ds_read_b64 a[48:49], v36 offset:776
    ds_read_b64 a[50:51], v36 offset:784
    ds_read_b64 a[52:53], v36 offset:840
    ds_read_b64 a[54:55], v36 offset:848
    ds_read_b64 a[56:57], v36 offset:904
    ds_read_b64 a[58:59], v36 offset:912
    ds_read_b64 a[60:61], v36 offset:968
    ds_read_b64 a[62:63], v36 offset:976
    ds_read_b64 a[64:65], v36 offset:1032
    ds_read_b64 a[66:67], v36 offset:1040
    ds_read_b64 a[68:69], v36 offset:1096
    ds_read_b64 a[70:71], v36 offset:1104
    ds_read_b64 a[72:73], v36 offset:1160
    ds_read_b64 a[74:75], v36 offset:1168
    ds_read_b64 a[76:77], v36 offset:1224
    ds_read_b64 a[78:79], v36 offset:1232
    ds_read_b64 a[80:81], v36 offset:1288
    ds_read_b64 a[82:83], v36 offset:1296
    ds_read_b64 a[84:85], v36 offset:1352
    ds_read_b64 a[86:87], v36 offset:1360
    ds_read_b64 a[88:89], v36 offset:1416
    ds_read_b64 a[90:91], v36 offset:1424
    ds_read_b64 a[92:93], v36 offset:1480
    ds_read_b64 a[94:95], v36 offset:1488
    s_mul_i32 s5, s3, 5152
    s_add_u32 s5, s5, 122880
    v_add_u32 v209, s5, v4
    v_lshrrev_b32 v210, 5, v1
    v_lshl_add_u32 v210, v210, 4, v209
    s_waitcnt vmcnt(8)
    ds_write_b128 v209, v[188:191] offset:0
    s_waitcnt vmcnt(7)
    ds_write_b128 v209, v[192:195] offset:1024
    s_waitcnt vmcnt(6)
    ds_write_b128 v210, v[196:199] offset:2048
    s_waitcnt vmcnt(5)
    ds_write_b128 v209, v[200:203] offset:3088
    s_waitcnt vmcnt(4)
    ds_write_b128 v209, v[204:207] offset:4112
    s_lshl_b32 s95, s42, 7
    s_add_u32 s95, s95, 77824
    v_max_u32 v44, 1, v2
    v_lshlrev_b32 v44, 7, v44
    v_xor_b32 v44, s95, v44
    s_add_u32 s4, s94, 12582912
    v_add_u32 v28, s4, v4
    s_mul_i32 s93, s3, 9280
    s_waitcnt vmcnt(0)
    v_cmp_eq_u32 vcc, 0, v221
    s_nop 0
    s_cbranch_vccnz Lic_r
Lic_ok:
    s_waitcnt lgkmcnt(0)
    s_barrier
    v_mov_b32 v29, s95
    s_cmp_lg_u32 s3, 0
    s_cbranch_scc1 Lkf_skip
    global_store_dword v29, v29, s[38:39] sc1
Lkf_skip:
    s_cmp_ge_u32 s42, 128
    s_cbranch_scc1 Lc_j2
    v_mul_u32_u24 v209, 2576, v211
    v_lshl_add_u32 v209, v212, 3, v209
    s_mul_i32 s5, s3, 320
    s_add_u32 s5, s5, 122880
    v_add_u32 v209, s5, v209
    ds_read2_b64 v[188:191], v209 offset0:0 offset1:160
    ds_read2_b64 v[192:195], v209 offset0:8 offset1:168
    ds_read2_b64 v[196:199], v209 offset0:16 offset1:176
    ds_read2_b64 v[200:203], v209 offset0:24 offset1:184
    ds_read2_b64 v[204:207], v209 offset0:32 offset1:192
    s_lshr_b32 s4, s42, 2
    s_mul_i32 s4, s4, 114688
    s_and_b32 s5, s42, 3
    s_lshl_b32 s5, s5, 7
    s_add_u32 s4, s4, s5
    s_mul_i32 s5, s3, 20480
    s_add_u32 s4, s4, s5
    s_add_u32 s4, s4, 1052672
    v_lshl_add_u32 v208, v212, 9, s4
    v_lshl_add_u32 v208, v211, 4, v208
    s_mov_b32 s7, 0x3f803f80
    v_mov_b32 v216, 0
    v_mov_b32 v217, 0
    v_mov_b32 v218, 0
    v_mov_b32 v219, 0
    s_waitcnt lgkmcnt(4)
    v_and_b32 v191, -2, v191
    global_store_dwordx4 v208, v[188:191], s[38:39] offset:-4096 sc1
    s_waitcnt lgkmcnt(2)
    v_and_b32 v195, -2, v195
    global_store_dwordx4 v208, v[192:195], s[38:39] offset:0 sc1
    v_add_u32 v208, 8192, v208
    v_and_b32 v199, -2, v199
    global_store_dwordx4 v208, v[196:199], s[38:39] offset:-4096 sc1
    s_waitcnt lgkmcnt(0)
    v_and_b32 v203, -2, v203
    global_store_dwordx4 v208, v[200:203], s[38:39] offset:0 sc1
    v_add_u32 v208, 8192, v208
    v_and_b32 v207, -2, v207
    global_store_dwordx4 v208, v[204:207], s[38:39] offset:-4096 sc1
    v_dot2_f32_bf16 v216, v188, s7, v216
    v_dot2_f32_bf16 v217, v188, v188, v217
    v_dot2_f32_bf16 v218, v190, s7, v218
    v_dot2_f32_bf16 v219, v190, v190, v219
    v_dot2_f32_bf16 v216, v189, s7, v216
    v_dot2_f32_bf16 v217, v189, v189, v217
    v_dot2_f32_bf16 v218, v191, s7, v218
    v_dot2_f32_bf16 v219, v191, v191, v219
    v_dot2_f32_bf16 v216, v192, s7, v216
    v_dot2_f32_bf16 v217, v192, v192, v217
    v_dot2_f32_bf16 v218, v194, s7, v218
    v_dot2_f32_bf16 v219, v194, v194, v219
    v_dot2_f32_bf16 v216, v193, s7, v216
    v_dot2_f32_bf16 v217, v193, v193, v217
    v_dot2_f32_bf16 v218, v195, s7, v218
    v_dot2_f32_bf16 v219, v195, v195, v219
    v_dot2_f32_bf16 v216, v196, s7, v216
    v_dot2_f32_bf16 v217, v196, v196, v217
    v_dot2_f32_bf16 v218, v198, s7, v218
    v_dot2_f32_bf16 v219, v198, v198, v219
    v_dot2_f32_bf16 v216, v197, s7, v216
    v_dot2_f32_bf16 v217, v197, v197, v217
    v_dot2_f32_bf16 v218, v199, s7, v218
    v_dot2_f32_bf16 v219, v199, v199, v219
    v_dot2_f32_bf16 v216, v200, s7, v216
    v_dot2_f32_bf16 v217, v200, v200, v217
    v_dot2_f32_bf16 v218, v202, s7, v218
    v_dot2_f32_bf16 v219, v202, v202, v219
    v_dot2_f32_bf16 v216, v201, s7, v216
    v_dot2_f32_bf16 v217, v201, v201, v217
    v_dot2_f32_bf16 v218, v203, s7, v218
    v_dot2_f32_bf16 v219, v203, v203, v219
    v_dot2_f32_bf16 v216, v204, s7, v216
    v_dot2_f32_bf16 v217, v204, v204, v217
    v_dot2_f32_bf16 v218, v206, s7, v218
    v_dot2_f32_bf16 v219, v206, v206, v219
    v_dot2_f32_bf16 v216, v205, s7, v216
    v_dot2_f32_bf16 v217, v205, v205, v217
    v_dot2_f32_bf16 v218, v207, s7, v218
    v_dot2_f32_bf16 v219, v207, v207, v219
    s_nop 1
    v_permlane32_swap_b32 v216, v218
    v_permlane32_swap_b32 v217, v219
    v_add_f32 v216, v216, v218
    v_add_f32 v217, v217, v219
    s_nop 1
    v_permlane16_swap_b32 v216, v217
    v_add_f32 v216, v216, v217
    v_lshlrev_b32 v209, 4, v211
    v_lshl_add_u32 v209, v3, 2, v209
    v_add_f32_dpp v216, v216, v216 row_ror:8 row_mask:0xf bank_mask:0xf
    s_lshl_b32 s5, s3, 7
    s_add_u32 s5, s5, 143616
    v_add_u32 v209, s5, v209
    ds_write_b32 v209, v216
    s_waitcnt vmcnt(5)
    s_branch Lc_j3
Lc_j2:
    s_waitcnt vmcnt(0)
Lc_j3:
    s_mov_b32 s95, 0
    ds_read_b64 a[96:97], v36 offset:1544
    ds_read_b64 a[98:99], v36 offset:1552
    ds_read_b64 a[100:101], v36 offset:1608
    ds_read_b64 a[102:103], v36 offset:1616
    ds_read_b64 a[104:105], v36 offset:1672
    ds_read_b64 a[106:107], v36 offset:1680
    ds_read_b64 a[108:109], v36 offset:1736
    ds_read_b64 a[110:111], v36 offset:1744
    ds_read_b64 a[112:113], v36 offset:1800
    ds_read_b64 a[114:115], v36 offset:1808
    ds_read_b64 a[116:117], v36 offset:1864
    ds_read_b64 a[118:119], v36 offset:1872
    ds_read_b64 a[120:121], v36 offset:1928
    ds_read_b64 a[122:123], v36 offset:1936
    ds_read_b64 a[124:125], v36 offset:1992
    ds_read_b64 a[126:127], v36 offset:2000
    ds_read_b64 a[128:129], v36 offset:2056
    ds_read_b64 a[130:131], v36 offset:2064
    ds_read_b64 a[132:133], v36 offset:2120
    ds_read_b64 a[134:135], v36 offset:2128
    ds_read_b64 a[136:137], v36 offset:2184
    ds_read_b64 a[138:139], v36 offset:2192
    ds_read_b64 a[140:141], v36 offset:2248
    ds_read_b64 a[142:143], v36 offset:2256
    ds_read_b64 a[144:145], v36 offset:2312
    ds_read_b64 a[146:147], v36 offset:2320
    ds_read_b64 a[148:149], v36 offset:2376
    ds_read_b64 a[150:151], v36 offset:2384
    ds_read_b64 a[152:153], v36 offset:2440
    ds_read_b64 a[154:155], v36 offset:2448
    ds_read_b64 a[156:157], v36 offset:2504
    ds_read_b64 a[158:159], v36 offset:2512
    ds_read_b64 a[160:161], v36 offset:2568
    ds_read_b64 a[162:163], v36 offset:2576
    ds_read_b64 a[164:165], v36 offset:2632
    ds_read_b64 a[166:167], v36 offset:2640
    ds_read_b64 a[168:169], v36 offset:2696
    ds_read_b64 a[170:171], v36 offset:2704
    ds_read_b64 a[172:173], v36 offset:2760
    ds_read_b64 a[174:175], v36 offset:2768
    ds_read_b64 a[176:177], v36 offset:2824
    ds_read_b64 a[178:179], v36 offset:2832
    ds_read_b64 a[180:181], v36 offset:2888
    ds_read_b64 a[182:183], v36 offset:2896
    ds_read_b64 a[184:185], v36 offset:2952
    ds_read_b64 a[186:187], v36 offset:2960
    ds_read_b64 a[188:189], v36 offset:3016
    ds_read_b64 a[190:191], v36 offset:3024
    ds_read_b64 a[192:193], v36 offset:3080
    ds_read_b64 a[194:195], v36 offset:3088
    ds_read_b64 a[196:197], v36 offset:3144
    ds_read_b64 a[198:199], v36 offset:3152
    ds_read_b64 a[200:201], v36 offset:3208
    ds_read_b64 a[202:203], v36 offset:3216
    ds_read_b64 a[204:205], v36 offset:3272
    ds_read_b64 a[206:207], v36 offset:3280
    ds_read_b64 a[208:209], v36 offset:3336
    ds_read_b64 a[210:211], v36 offset:3344
    ds_read_b64 a[212:213], v36 offset:3400
    ds_read_b64 a[214:215], v36 offset:3408
    ds_read_b64 a[216:217], v36 offset:3464
    ds_read_b64 a[218:219], v36 offset:3472
    ds_read_b64 a[220:221], v36 offset:3528
    ds_read_b64 a[222:223], v36 offset:3536
    ds_read_b64 a[224:225], v36 offset:3592
    ds_read_b64 a[226:227], v36 offset:3600
    ds_read_b64 a[228:229], v36 offset:3656
    ds_read_b64 a[230:231], v36 offset:3664
    ds_read_b64 a[232:233], v36 offset:3720
    ds_read_b64 a[234:235], v36 offset:3728
    ds_read_b64 a[236:237], v36 offset:3784
    ds_read_b64 a[238:239], v36 offset:3792
    global_load_dword v45, v44, s[38:39] sc1
    v_min_u32 v99, 49, v1
    v_cmp_lt_u32 vcc, 7, v99
    s_nop 1
    v_cndmask_b32_e64 v100, 0, 7, vcc
    v_add_lshl_u32 v99, v99, v100, 2
    v_mov_b32 v100, 1
    s_cmp_lg_u32 s3, 0
    s_cbranch_scc1 Ldb2
    global_load_dword v100, v99, s[36:37] sc1
Ldb2:
    ds_read_b64 a[240:241], v36 offset:3848
    ds_read_b64 a[242:243], v36 offset:3856
    ds_read_b64 a[244:245], v36 offset:3912
    ds_read_b64 a[246:247], v36 offset:3920
    ds_read_b64 a[248:249], v36 offset:3976
    ds_read_b64 a[250:251], v36 offset:3984
    ds_read_b64 a[252:253], v36 offset:4040
    ds_read_b64 a[254:255], v36 offset:4048
    s_and_b32 s4, s41, 1
    s_lshl_b32 s5, s3, 1
    s_add_u32 s5, s5, s4
    s_cmp_eq_u32 s5, 7
    s_cselect_b32 s5, 0, s5
    s_mul_i32 s96, s41, 7
    s_add_u32 s96, s96, s5
    s_cmp_lt_u32 s96, 54
    s_cselect_b32 s101, 2, 0
    s_min_u32 s96, s96, 53
    s_cmp_eq_u32 s3, 3
    s_cselect_b32 s101, 1, s101
    s_lshr_b32 s97, s101, 1
    s_cselect_b32 s5, -1, 0
    v_and_b32 v7, s5, v4
    s_add_u32 s97, s97, s96
    s_mul_i32 s4, s96, 20480
    s_add_u32 s5, s4, 7344128
    s_add_u32 s8, s38, s5
    s_addc_u32 s9, s39, 0
    s_add_u32 s5, s4, 7352320
    s_add_u32 s10, s38, s5
    s_addc_u32 s11, s39, 0
    s_add_u32 s5, s4, 7360512
    s_add_u32 s12, s38, s5
    s_addc_u32 s13, s39, 0
    s_mul_i32 s4, s97, 20480
    s_add_u32 s5, s4, 7344128
    s_add_u32 s14, s38, s5
    s_addc_u32 s15, s39, 0
    s_add_u32 s5, s4, 7352320
    s_add_u32 s16, s38, s5
    s_addc_u32 s17, s39, 0
    s_add_u32 s5, s4, 7360512
    s_add_u32 s18, s38, s5
    s_addc_u32 s19, s39, 0
    s_and_b32 s4, s41, 3
    s_cmp_eq_u32 s4, 0
    s_cselect_b32 s5, 8, 0
    s_cmp_le_u32 s4, 1
    s_cselect_b32 s6, 16, 8
    s_cmp_eq_u32 s4, 3
    s_cselect_b32 s50, 16, 24
    s_lshl_b32 s44, s4, 3
    s_bitcmp1_b32 s43, 0
    s_cselect_b32 s46, s6, s5
    s_cselect_b32 s48, s5, s6
    s_lshl_b32 s5, s3, 1
    s_add_u32 s44, s44, s5
    s_add_u32 s45, s44, 1
    s_add_u32 s46, s46, s5
    s_add_u32 s47, s46, 1
    s_add_u32 s48, s48, s5
    s_add_u32 s49, s48, 1
    s_add_u32 s50, s50, s5
    s_add_u32 s51, s50, 1
    s_lshl_b32 s5, s40, 18
    s_lshl_b32 s6, s44, 7
    s_add_u32 s6, s6, s5
    s_add_u32 s68, s24, s6
    s_addc_u32 s69, s25, 0
    s_lshl_b32 s6, s45, 7
    s_add_u32 s6, s6, s5
    s_add_u32 s70, s24, s6
    s_addc_u32 s71, s25, 0
    s_lshl_b32 s6, s46, 7
    s_add_u32 s6, s6, s5
    s_add_u32 s72, s24, s6
    s_addc_u32 s73, s25, 0
    s_lshl_b32 s6, s47, 7
    s_add_u32 s6, s6, s5
    s_add_u32 s74, s24, s6
    s_addc_u32 s75, s25, 0
    s_lshl_b32 s6, s48, 7
    s_add_u32 s6, s6, s5
    s_add_u32 s76, s24, s6
    s_addc_u32 s77, s25, 0
    s_lshl_b32 s6, s49, 7
    s_add_u32 s6, s6, s5
    s_add_u32 s78, s24, s6
    s_addc_u32 s79, s25, 0
    s_lshl_b32 s6, s50, 7
    s_add_u32 s6, s6, s5
    s_add_u32 s80, s24, s6
    s_addc_u32 s81, s25, 0
    s_lshl_b32 s6, s51, 7
    s_add_u32 s6, s6, s5
    s_add_u32 s82, s24, s6
    s_addc_u32 s83, s25, 0
    s_lshl_b32 s89, s3, 14
    s_add_u32 s89, s89, 83200
    s_waitcnt vmcnt(0) lgkmcnt(0)
    v_cmp_eq_u32 vcc, 0, v100
    s_nop 0
    s_cbranch_vccnz Lic2_r
Lic2_ok:
    s_barrier
    s_cmp_ge_u32 s42, 128
    s_cbranch_scc1 Lc_j5
    s_cmp_lg_u32 s3, 0
    s_cbranch_scc1 Lc_j5
    v_lshlrev_b32 v209, 3, v2
    v_add_u32 v210, 143616, v209
    ds_read_b64 v[220:221], v210 offset:0
    ds_read_b64 v[222:223], v210 offset:128
    ds_read_b64 v[224:225], v210 offset:256
    ds_read_b64 v[226:227], v210 offset:384
    s_waitcnt lgkmcnt(2)
    v_pk_add_f32 v[220:221], v[220:221], v[222:223] op_sel:[0,0] op_sel_hi:[1,1]
    s_waitcnt lgkmcnt(0)
    v_pk_add_f32 v[224:225], v[224:225], v[226:227] op_sel:[0,0] op_sel_hi:[1,1]
    v_pk_add_f32 v[220:221], v[220:221], v[224:225] op_sel:[0,0] op_sel_hi:[1,1]
    v_mul_f32 v220, 0x3acccccd, v220
    v_mul_f32 v221, 0x3acccccd, v221
    v_fma_f32 v221, -v220, v220, v221
    v_max_f32 v221, 0, v221
    v_add_f32 v221, 0x3727c5ac, v221
    v_rsq_f32 v222, v221
    s_nop 0
    v_mul_f32_e64 v221, -v220, v222
    v_mov_b32 v220, v222
    v_min_u32 v220, -2, v220
    v_min_u32 v221, -2, v221
    s_lshl_b32 s5, s42, 7
    s_add_u32 s5, s5, 32768
    v_add_u32 v209, s5, v209
    global_store_dwordx2 v209, v[220:221], s[38:39] sc1
Lc_j5:
    s_cmp_eq_u32 s95, 1
    s_cbranch_scc1 Lc_k2
    v_cmp_eq_u32 vcc, -1, v45
    s_nop 0
    s_cbranch_vccnz Lkf_r
Lkf_ok:
    s_add_u32 m0, s93, 33804
    s_nop 0
    global_load_lds_dwordx4 v28, s[38:39] offset:0 sc1
    global_load_lds_dwordx4 v28, s[38:39] offset:1024 sc1
    global_load_lds_dwordx4 v28, s[38:39] offset:2048 sc1
    global_load_lds_dwordx4 v28, s[38:39] offset:3072 sc1
    s_add_u32 m0, s93, 38448
    s_nop 0
    global_load_lds_dwordx4 v28, s[38:39] offset:0 sc1
    global_load_lds_dwordx4 v28, s[38:39] offset:1024 sc1
    global_load_lds_dwordx4 v28, s[38:39] offset:2048 sc1
    global_load_lds_dwordx4 v28, s[38:39] offset:3072 sc1
Lc_k2:
    v_bfe_u32 v235, v1, 3, 1
    s_sub_u32 s4, s97, s96
    v_mul_u32_u24 v235, s4, v235
    v_add_lshl_u32 v235, v235, s96, 7
    v_mul_u32_u24 v174, 7168, v3
    v_add_u32 v235, v235, v174
    v_and_b32 v174, 112, v4
    v_add_u32 v235, v235, v174
    v_add_u32 v235, 49152, v235
    v_and_b32 v45, 1, v3
    v_mul_u32_u24 v45, 7168, v45
    v_sub_u32 v45, v235, v45
    v_and_b32 v67, 7, v1
    v_lshl_add_u32 v67, v3, 3, v67
    v_bfe_u32 v69, v1, 3, 1
    v_lshlrev_b32 v66, 9, v69
    v_lshl_add_u32 v66, v67, 4, v66
    s_mul_i32 s4, s3, 20480
    s_mul_i32 s5, s40, 114688
    s_add_u32 s4, s4, s5
    s_add_u32 s4, s4, 1048576
    v_add_u32 v66, s4, v66
    v_lshl_add_u32 v70, v67, 1, v69
    v_min_u32 v72, 9, v1
    v_lshl_add_u32 v72, v72, 11, s4
    v_lshrrev_b32 v67, 5, v1
    v_bfe_u32 v68, v1, 1, 1
    v_lshl_add_u32 v67, v67, 1, v68
    v_mul_u32_u24 v68, 1040, v67
    v_bfe_u32 v67, v1, 3, 1
    v_lshl_add_u32 v68, v67, 3, v68
    v_bfe_u32 v67, v1, 2, 1
    v_lshl_add_u32 v68, v67, 6, v68
    v_bfe_u32 v67, v1, 4, 1
    v_lshl_add_u32 v68, v67, 7, v68
    v_bfe_u32 v67, v1, 0, 1
    v_lshl_add_u32 v68, v67, 5, v68
    s_mul_i32 s5, s3, 20800
    v_add_u32 v68, s5, v68
    v_lshlrev_b32 v30, 3, v1
    s_lshl_b32 s88, s3, 9
    v_lshrrev_b32 v67, 3, v1
    v_lshlrev_b32 v67, 12, v67
    v_bfe_u32 v69, v1, 4, 1
    v_xor_b32 v69, v69, v1
    v_and_b32 v69, 7, v69
    v_xor_b32 v74, 0, v69
    v_lshl_add_u32 v74, v74, 4, v67
    v_add_u32 v78, 131072, v74
    v_xor_b32 v75, 2, v69
    v_lshl_add_u32 v75, v75, 4, v67
    v_add_u32 v75, 31744, v75
    v_add_u32 v79, 131072, v75
    v_xor_b32 v76, 4, v69
    v_lshl_add_u32 v76, v76, 4, v67
    v_add_u32 v76, 63488, v76
    v_add_u32 v80, 131072, v76
    v_xor_b32 v77, 6, v69
    v_lshl_add_u32 v77, v77, 4, v67
    v_add_u32 v77, 95232, v77
    v_add_u32 v81, 131072, v77
    v_lshrrev_b32 v69, 1, v2
    v_xor_b32 v69, v69, v3
    v_lshlrev_b32 v69, 4, v69
    v_lshl_add_u32 v69, v5, 7, v69
    s_xor_b32 s4, s3, 0
    s_lshr_b32 s5, s4, 1
    s_lshl_b32 s5, s5, 12
    s_and_b32 s4, s4, 1
    s_lshl_b32 s4, s4, 9
    s_add_u32 s4, s4, s5
    s_add_u32 s4, s4, s89
    v_add_u32 v82, s4, v69
    v_xor_b32 v83, 64, v82
    s_xor_b32 s4, s3, 1
    s_lshr_b32 s5, s4, 1
    s_lshl_b32 s5, s5, 12
    s_and_b32 s4, s4, 1
    s_lshl_b32 s4, s4, 9
    s_add_u32 s4, s4, s5
    s_add_u32 s4, s4, s89
    v_add_u32 v84, s4, v69
    v_xor_b32 v85, 64, v84
    s_xor_b32 s4, s3, 2
    s_lshr_b32 s5, s4, 1
    s_lshl_b32 s5, s5, 12
    s_and_b32 s4, s4, 1
    s_lshl_b32 s4, s4, 9
    s_add_u32 s4, s4, s5
    s_add_u32 s4, s4, s89
    v_add_u32 v86, s4, v69
    v_xor_b32 v87, 64, v86
    s_xor_b32 s4, s3, 3
    s_lshr_b32 s5, s4, 1
    s_lshl_b32 s5, s5, 12
    s_and_b32 s4, s4, 1
    s_lshl_b32 s4, s4, 9
    s_add_u32 s4, s4, s5
    s_add_u32 s4, s4, s89
    v_add_u32 v88, s4, v69
    s_cmp_eq_u32 s95, 1
    s_cbranch_scc1 Lc_k3
    s_waitcnt vmcnt(0)
Lc_k3:
    ds_read_b128 v[122:125], v38 offset:3584
    ds_read_b128 v[126:129], v38 offset:3648
    s_waitcnt lgkmcnt(1)
    v_mfma_f32_16x16x32_bf16 v[90:93], a[0:3], v[122:125], 0
    ds_read_b128 v[130:133], v38 offset:3712
    v_xor_b32 v89, 64, v88
    v_mfma_f32_16x16x32_bf16 v[94:97], a[32:35], v[122:125], 0
    ds_read_b128 v[134:137], v38 offset:3776
    s_add_u32 s52, s8, 1146880
    s_addc_u32 s53, s9, 0
    v_mfma_f32_16x16x32_bf16 v[98:101], a[64:67], v[122:125], 0
    ds_read_b128 v[138:141], v38 offset:3840
    v_mfma_f32_16x16x32_bf16 v[102:105], a[96:99], v[122:125], 0
    s_add_u32 s54, s10, 1146880
    s_addc_u32 s55, s11, 0
    v_mfma_f32_16x16x32_bf16 v[106:109], a[128:131], v[122:125], 0
    v_mfma_f32_16x16x32_bf16 v[110:113], a[160:163], v[122:125], 0
    s_add_u32 s56, s12, 1146880
    s_addc_u32 s57, s13, 0
    s_waitcnt lgkmcnt(2)
    v_mfma_f32_16x16x32_bf16 v[90:93], a[4:7], v[126:129], v[90:93]
    ds_read_b128 v[142:145], v38 offset:3904
    v_mfma_f32_16x16x32_bf16 v[94:97], a[36:39], v[126:129], v[94:97]
    s_add_u32 s58, s14, 1146880
    s_addc_u32 s59, s15, 0
    v_mfma_f32_16x16x32_bf16 v[98:101], a[68:71], v[126:129], v[98:101]
    v_mfma_f32_16x16x32_bf16 v[102:105], a[100:103], v[126:129], v[102:105]
    s_add_u32 s60, s16, 1146880
    s_addc_u32 s61, s17, 0
    v_mfma_f32_16x16x32_bf16 v[106:109], a[132:135], v[126:129], v[106:109]
    v_mfma_f32_16x16x32_bf16 v[110:113], a[164:167], v[126:129], v[110:113]
    s_add_u32 s62, s18, 1146880
    s_addc_u32 s63, s19, 0
    v_mfma_f32_16x16x32_bf16 v[90:93], a[8:11], v[130:133], v[90:93]
    ds_read_b128 v[146:149], v38 offset:3968
    v_mfma_f32_16x16x32_bf16 v[94:97], a[40:43], v[130:133], v[94:97]
    s_mov_b32 s84, 0xc0135761
    v_mfma_f32_16x16x32_bf16 v[98:101], a[72:75], v[130:133], v[98:101]
    s_mov_b32 s85, 0xbdd2d3e8
    v_mfma_f32_16x16x32_bf16 v[102:105], a[104:107], v[130:133], v[102:105]
    v_lshlrev_b32 v32, 16, v27
    v_mfma_f32_16x16x32_bf16 v[106:109], a[136:139], v[130:133], v[106:109]
    v_lshlrev_b32 v33, 16, v27
    v_mfma_f32_16x16x32_bf16 v[110:113], a[168:171], v[130:133], v[110:113]
    v_lshlrev_b32 v34, 16, v27
    s_waitcnt lgkmcnt(0)
    v_mfma_f32_16x16x32_bf16 v[90:93], a[12:15], v[134:137], v[90:93]
    ds_read_b128 v[150:153], v38 offset:4032
    v_lshlrev_b32 v35, 16, v27
    v_mfma_f32_16x16x32_bf16 v[94:97], a[44:47], v[134:137], v[94:97]
    s_mul_i32 s5, s41, 10
    v_mfma_f32_16x16x32_bf16 v[98:101], a[76:79], v[134:137], v[98:101]
    s_mul_i32 s6, s3, 1040
    v_mfma_f32_16x16x32_bf16 v[102:105], a[108:111], v[134:137], v[102:105]
    v_add_u32 v67, s5, v3
    v_mfma_f32_16x16x32_bf16 v[106:109], a[140:143], v[134:137], v[106:109]
    v_lshrrev_b32 v69, 2, v67
    v_mfma_f32_16x16x32_bf16 v[110:113], a[172:175], v[134:137], v[110:113]
    v_mul_u32_u24 v69, 3136, v69
    v_mfma_f32_16x16x32_bf16 v[90:93], a[16:19], v[138:141], v[90:93]
    ds_read_b128 v[154:157], v38 offset:3072
    v_lshl_add_u32 v69, v67, 8, v69
    v_mfma_f32_16x16x32_bf16 v[94:97], a[48:51], v[138:141], v[94:97]
    v_lshl_add_u32 v69, v2, 4, v69
    v_mfma_f32_16x16x32_bf16 v[98:101], a[80:83], v[138:141], v[98:101]
    v_add_u32 v46, s6, v69
    v_mfma_f32_16x16x32_bf16 v[102:105], a[112:115], v[138:141], v[102:105]
    v_lshrrev_b32 v67, 1, v3
    v_mfma_f32_16x16x32_bf16 v[106:109], a[144:147], v[138:141], v[106:109]
    v_add_u32 v67, s5, v67
    v_mfma_f32_16x16x32_bf16 v[110:113], a[176:179], v[138:141], v[110:113]
    ds_read_b128 v[158:161], v38 offset:3136
    v_lshrrev_b32 v69, 2, v67
    v_mfma_f32_16x16x32_bf16 v[90:93], a[20:23], v[142:145], v[90:93]
    v_mul_u32_u24 v69, 3136, v69
    v_mfma_f32_16x16x32_bf16 v[94:97], a[52:55], v[142:145], v[94:97]
    v_lshl_add_u32 v69, v67, 8, v69
    v_mfma_f32_16x16x32_bf16 v[98:101], a[84:87], v[142:145], v[98:101]
    v_lshl_add_u32 v69, v2, 4, v69
    v_mfma_f32_16x16x32_bf16 v[102:105], a[116:119], v[142:145], v[102:105]
    v_add_u32 v47, s6, v69
    v_mfma_f32_16x16x32_bf16 v[106:109], a[148:151], v[142:145], v[106:109]
    ds_read_b128 v[122:125], v38 offset:3200
    v_and_b32 v67, 1, v3
    v_mfma_f32_16x16x32_bf16 v[110:113], a[180:183], v[142:145], v[110:113]
    v_lshl_add_u32 v47, v67, 3, v47
    v_mfma_f32_16x16x32_bf16 v[90:93], a[24:27], v[146:149], v[90:93]
    v_mov_b32 v166, 0
    v_mfma_f32_16x16x32_bf16 v[94:97], a[56:59], v[146:149], v[94:97]
    v_mov_b32 v167, 0
    v_mfma_f32_16x16x32_bf16 v[98:101], a[88:91], v[146:149], v[98:101]
    v_mov_b32 v168, 0
    v_mfma_f32_16x16x32_bf16 v[102:105], a[120:123], v[146:149], v[102:105]
    ds_read_b128 v[126:129], v38 offset:3264
    v_mov_b32 v169, 0
    v_mfma_f32_16x16x32_bf16 v[106:109], a[152:155], v[146:149], v[106:109]
    v_mfma_f32_16x16x32_bf16 v[110:113], a[184:187], v[146:149], v[110:113]
    s_min_u32 s5, s42, 127
    s_waitcnt lgkmcnt(1)
    v_mfma_f32_16x16x32_bf16 v[90:93], a[28:31], v[150:153], v[90:93]
    s_lshl_b32 s4, s5, 13
    v_mfma_f32_16x16x32_bf16 v[94:97], a[60:63], v[150:153], v[94:97]
    s_add_u32 s4, s4, 15208448
    v_mfma_f32_16x16x32_bf16 v[98:101], a[92:95], v[150:153], v[98:101]
    ds_read_b128 v[130:133], v38 offset:3328
    v_lshl_add_u32 v236, v0, 4, s4
    v_mfma_f32_16x16x32_bf16 v[102:105], a[124:127], v[150:153], v[102:105]
    v_mfma_f32_16x16x32_bf16 v[106:109], a[156:159], v[150:153], v[106:109]
    global_store_dwordx4 v236, v[166:169], s[38:39] offset:-4096 sc1
    v_mfma_f32_16x16x32_bf16 v[110:113], a[188:191], v[150:153], v[110:113]
    global_store_dwordx4 v236, v[166:169], s[38:39] offset:0 sc1
    v_mfma_f32_16x16x32_bf16 v[94:97], a[0:3], v[154:157], v[94:97]
    v_mov_b32 v162, -1
    v_mfma_f32_16x16x32_bf16 v[98:101], a[32:35], v[154:157], v[98:101]
    ds_read_b128 v[134:137], v38 offset:3392
    v_mov_b32 v163, -1
    v_mfma_f32_16x16x32_bf16 v[102:105], a[64:67], v[154:157], v[102:105]
    v_mfma_f32_16x16x32_bf16 v[106:109], a[96:99], v[154:157], v[106:109]
    v_mov_b32 v164, -1
    v_mfma_f32_16x16x32_bf16 v[110:113], a[128:131], v[154:157], v[110:113]
    v_mov_b32 v165, -1
    v_mfma_f32_16x16x32_bf16 v[94:97], a[4:7], v[158:161], v[94:97]
    s_lshr_b32 s4, s5, 2
    v_mfma_f32_16x16x32_bf16 v[98:101], a[36:39], v[158:161], v[98:101]
    ds_read_b128 v[138:141], v38 offset:3456
    s_mul_i32 s4, s4, 114688
    v_mfma_f32_16x16x32_bf16 v[102:105], a[68:71], v[158:161], v[102:105]
    v_mfma_f32_16x16x32_bf16 v[106:109], a[100:103], v[158:161], v[106:109]
    s_and_b32 s5, s5, 3
    v_mfma_f32_16x16x32_bf16 v[110:113], a[132:135], v[158:161], v[110:113]
    s_lshl_b32 s5, s5, 13
    v_mfma_f32_16x16x32_bf16 v[94:97], a[8:11], v[122:125], v[94:97]
    s_add_u32 s4, s4, s5
    v_mfma_f32_16x16x32_bf16 v[98:101], a[40:43], v[122:125], v[98:101]
    ds_read_b128 v[142:145], v38 offset:3520
    s_add_u32 s4, s4, 1134592
    v_mfma_f32_16x16x32_bf16 v[102:105], a[72:75], v[122:125], v[102:105]
    v_mfma_f32_16x16x32_bf16 v[106:109], a[104:107], v[122:125], v[106:109]
    v_lshl_add_u32 v236, v0, 4, s4
    v_mfma_f32_16x16x32_bf16 v[110:113], a[136:139], v[122:125], v[110:113]
    global_store_dwordx4 v236, v[162:165], s[38:39] offset:-4096 sc1
    s_waitcnt lgkmcnt(1)
    v_mfma_f32_16x16x32_bf16 v[94:97], a[12:15], v[126:129], v[94:97]
    global_store_dwordx4 v236, v[162:165], s[38:39] offset:0 sc1
    v_mfma_f32_16x16x32_bf16 v[98:101], a[44:47], v[126:129], v[98:101]
    ds_read_b128 v[146:149], v38 offset:2560
    s_min_u32 s4, s42, 127
    v_mfma_f32_16x16x32_bf16 v[102:105], a[76:79], v[126:129], v[102:105]
    v_mfma_f32_16x16x32_bf16 v[106:109], a[108:111], v[126:129], v[106:109]
    s_lshl_b32 s4, s4, 10
    v_mfma_f32_16x16x32_bf16 v[110:113], a[140:143], v[126:129], v[110:113]
    s_add_u32 s4, s4, 12451840
    v_mfma_f32_16x16x32_bf16 v[94:97], a[16:19], v[130:133], v[94:97]
    ds_read_b128 v[150:153], v38 offset:2624
    v_lshl_add_u32 v236, v0, 2, s4
    v_mfma_f32_16x16x32_bf16 v[98:101], a[48:51], v[130:133], v[98:101]
    global_store_dword v236, v162, s[38:39] sc1
    v_mfma_f32_16x16x32_bf16 v[102:105], a[80:83], v[130:133], v[102:105]
    v_mfma_f32_16x16x32_bf16 v[106:109], a[112:115], v[130:133], v[106:109]
    v_mfma_f32_16x16x32_bf16 v[110:113], a[144:147], v[130:133], v[110:113]
    ds_read_b128 v[154:157], v38 offset:2688
    v_mfma_f32_16x16x32_bf16 v[94:97], a[20:23], v[134:137], v[94:97]
    v_mfma_f32_16x16x32_bf16 v[98:101], a[52:55], v[134:137], v[98:101]
    v_mfma_f32_16x16x32_bf16 v[102:105], a[84:87], v[134:137], v[102:105]
    v_mfma_f32_16x16x32_bf16 v[106:109], a[116:119], v[134:137], v[106:109]
    ds_read_b128 v[158:161], v38 offset:2752
    v_mfma_f32_16x16x32_bf16 v[110:113], a[148:151], v[134:137], v[110:113]
    v_mfma_f32_16x16x32_bf16 v[94:97], a[24:27], v[138:141], v[94:97]
    v_mfma_f32_16x16x32_bf16 v[98:101], a[56:59], v[138:141], v[98:101]
    v_mfma_f32_16x16x32_bf16 v[102:105], a[88:91], v[138:141], v[102:105]
    ds_read_b128 v[122:125], v38 offset:2816
    v_mfma_f32_16x16x32_bf16 v[106:109], a[120:123], v[138:141], v[106:109]
    v_mfma_f32_16x16x32_bf16 v[110:113], a[152:155], v[138:141], v[110:113]
    s_waitcnt lgkmcnt(1)
    v_mfma_f32_16x16x32_bf16 v[94:97], a[28:31], v[142:145], v[94:97]
    v_mfma_f32_16x16x32_bf16 v[98:101], a[60:63], v[142:145], v[98:101]
    ds_read_b128 v[126:129], v38 offset:2880
    v_mfma_f32_16x16x32_bf16 v[102:105], a[92:95], v[142:145], v[102:105]
    v_mfma_f32_16x16x32_bf16 v[106:109], a[124:127], v[142:145], v[106:109]
    v_mfma_f32_16x16x32_bf16 v[110:113], a[156:159], v[142:145], v[110:113]
    v_mfma_f32_16x16x32_bf16 v[98:101], a[0:3], v[146:149], v[98:101]
    ds_read_b128 v[130:133], v38 offset:2944
    v_mfma_f32_16x16x32_bf16 v[102:105], a[32:35], v[146:149], v[102:105]
    v_mfma_f32_16x16x32_bf16 v[106:109], a[64:67], v[146:149], v[106:109]
    v_mfma_f32_16x16x32_bf16 v[110:113], a[96:99], v[146:149], v[110:113]
    v_mfma_f32_16x16x32_bf16 v[98:101], a[4:7], v[150:153], v[98:101]
    ds_read_b128 v[134:137], v38 offset:3008
    v_cvt_pk_bf16_f32 v48, v90, v91
    v_mfma_f32_16x16x32_bf16 v[102:105], a[36:39], v[150:153], v[102:105]
    v_cvt_pk_bf16_f32 v49, v92, v93
    v_mfma_f32_16x16x32_bf16 v[106:109], a[68:71], v[150:153], v[106:109]
    ds_write2_b32 v40, v48, v49 offset0:0 offset1:2
    v_mfma_f32_16x16x32_bf16 v[110:113], a[100:103], v[150:153], v[110:113]
    v_cvt_pk_bf16_f32 v50, v94, v95
    v_mfma_f32_16x16x32_bf16 v[98:101], a[8:11], v[154:157], v[98:101]
    ds_read_b128 v[138:141], v38 offset:2048
    v_cvt_pk_bf16_f32 v51, v96, v97
    v_mfma_f32_16x16x32_bf16 v[102:105], a[40:43], v[154:157], v[102:105]
    ds_write2_b32 v40, v50, v51 offset0:128 offset1:130
    v_mfma_f32_16x16x32_bf16 v[106:109], a[72:75], v[154:157], v[106:109]
    v_add_u32 v40, 4224, v40
    v_mfma_f32_16x16x32_bf16 v[110:113], a[104:107], v[154:157], v[110:113]
    ds_read_b128 v[142:145], v38 offset:2112
    v_mfma_f32_16x16x32_bf16 v[98:101], a[12:15], v[158:161], v[98:101]
    v_lshlrev_b32 v28, 4, v0
    s_waitcnt lgkmcnt(1)
    s_barrier
    v_mfma_f32_16x16x32_bf16 v[102:105], a[44:47], v[158:161], v[102:105]
    v_add_u32 v28, 36864, v28
    global_load_dwordx4 v[214:217], v28, s[38:39] offset:-4096 sc1
    v_mfma_f32_16x16x32_bf16 v[106:109], a[76:79], v[158:161], v[106:109]
    ds_read_b128 v[146:149], v38 offset:2176
    global_load_dwordx4 v[218:221], v28, s[38:39] offset:0 sc1
    v_mfma_f32_16x16x32_bf16 v[110:113], a[108:111], v[158:161], v[110:113]
    v_add_u32 v28, 8192, v28
    ds_read_b32 v52, v41 offset:0
    v_mfma_f32_16x16x32_bf16 v[98:101], a[16:19], v[122:125], v[98:101]
    global_load_dwordx4 v[222:225], v28, s[38:39] offset:-4096 sc1
    ds_read_b32 v53, v41 offset:1056
    v_mfma_f32_16x16x32_bf16 v[102:105], a[48:51], v[122:125], v[102:105]
    ds_read_b128 v[150:153], v38 offset:2240
    global_load_dwordx4 v[226:229], v28, s[38:39] offset:0 sc1
    v_mfma_f32_16x16x32_bf16 v[106:109], a[80:83], v[122:125], v[106:109]
    v_min_u32 v28, 11, v1
    v_lshrrev_b32 v29, 2, v28
    v_mfma_f32_16x16x32_bf16 v[110:113], a[112:115], v[122:125], v[110:113]
    v_mul_u32_u24 v29, 2544, v29
    ds_read_b32 v54, v41 offset:2112
    v_mfma_f32_16x16x32_bf16 v[98:101], a[20:23], v[126:129], v[98:101]
    ds_read_b128 v[154:157], v38 offset:2304
    v_lshl_add_u32 v28, v28, 2, v29
    s_lshl_b32 s4, s42, 4
    v_mfma_f32_16x16x32_bf16 v[102:105], a[52:55], v[126:129], v[102:105]
    ds_read_b32 v55, v41 offset:3168
    ds_read_b32 v56, v39 offset:3072
    s_add_u32 s4, s4, 0
    v_mfma_f32_16x16x32_bf16 v[106:109], a[84:87], v[126:129], v[106:109]
    v_add_u32 v28, s4, v28
    ds_read_b32 v57, v39 offset:12352
    v_mfma_f32_16x16x32_bf16 v[110:113], a[116:119], v[126:129], v[110:113]
    ds_read_b128 v[158:161], v38 offset:2368
    global_load_dword v64, v28, s[38:39] sc1
    v_mfma_f32_16x16x32_bf16 v[98:101], a[24:27], v[130:133], v[98:101]
    v_add_u32 v28, 15360, v28
    global_load_dword v65, v28, s[38:39] sc1
    v_mfma_f32_16x16x32_bf16 v[102:105], a[56:59], v[130:133], v[102:105]
    ds_read_b32 v58, v39 offset:21632
    ds_read_b32 v59, v39 offset:30912
    v_mfma_f32_16x16x32_bf16 v[106:109], a[88:91], v[130:133], v[106:109]
    ds_read_b128 v[122:125], v38 offset:2432
    s_waitcnt lgkmcnt(5)
    v_lshlrev_b32 v90, 16, v52
    v_mfma_f32_16x16x32_bf16 v[110:113], a[120:123], v[130:133], v[110:113]
    v_and_b32 v94, 0xffff0000, v52
    v_lshlrev_b32 v91, 16, v53
    v_mfma_f32_16x16x32_bf16 v[98:101], a[28:31], v[134:137], v[98:101]
    v_and_b32 v95, 0xffff0000, v53
    v_lshlrev_b32 v92, 16, v54
    v_mfma_f32_16x16x32_bf16 v[102:105], a[60:63], v[134:137], v[102:105]
    ds_read_b128 v[126:129], v38 offset:2496
    v_and_b32 v96, 0xffff0000, v54
    v_mfma_f32_16x16x32_bf16 v[106:109], a[92:95], v[134:137], v[106:109]
    v_lshlrev_b32 v93, 16, v55
    v_mfma_f32_16x16x32_bf16 v[110:113], a[124:127], v[134:137], v[110:113]
    v_and_b32 v97, 0xffff0000, v55
    v_mfma_f32_16x16x32_bf16 v[102:105], a[0:3], v[138:141], v[102:105]
    ds_read_b128 v[130:133], v38 offset:1536
    global_load_dword v234, v45, s[38:39] sc1
    v_mfma_f32_16x16x32_bf16 v[106:109], a[32:35], v[138:141], v[106:109]
    v_and_b32 v194, 0xffff0000, v56
    s_waitcnt lgkmcnt(2)
    v_and_b32 v195, 0xffff0000, v57
    v_mfma_f32_16x16x32_bf16 v[110:113], a[64:67], v[138:141], v[110:113]
    ds_read_b128 v[134:137], v38 offset:1600
    v_and_b32 v196, 0xffff0000, v58
    v_mfma_f32_16x16x32_bf16 v[102:105], a[4:7], v[142:145], v[102:105]
    v_mfma_f32_16x16x32_bf16 v[106:109], a[36:39], v[142:145], v[106:109]
    ds_read_b128 v[138:141], v38 offset:1664
    v_and_b32 v197, 0xffff0000, v59
    v_mfma_f32_16x16x32_bf16 v[110:113], a[68:71], v[142:145], v[110:113]
    v_fmac_f32 v90, s20, v194
    v_mfma_f32_16x16x32_bf16 v[102:105], a[8:11], v[146:149], v[102:105]
    ds_read_b128 v[142:145], v38 offset:1728
    v_fmac_f32 v91, s21, v195
    v_mfma_f32_16x16x32_bf16 v[106:109], a[40:43], v[146:149], v[106:109]
    v_fmac_f32 v92, s22, v196
    v_mfma_f32_16x16x32_bf16 v[110:113], a[72:75], v[146:149], v[110:113]
    ds_read_b128 v[146:149], v38 offset:1792
    v_fmac_f32 v93, s23, v197
    v_mfma_f32_16x16x32_bf16 v[102:105], a[12:15], v[150:153], v[102:105]
    v_lshlrev_b32 v194, 16, v56
    v_mfma_f32_16x16x32_bf16 v[106:109], a[44:47], v[150:153], v[106:109]
    v_lshlrev_b32 v195, 16, v57
    v_mfma_f32_16x16x32_bf16 v[110:113], a[76:79], v[150:153], v[110:113]
    ds_read_b128 v[150:153], v38 offset:1856
    v_mfma_f32_16x16x32_bf16 v[102:105], a[16:19], v[154:157], v[102:105]
    v_lshlrev_b32 v196, 16, v58
    v_mfma_f32_16x16x32_bf16 v[106:109], a[48:51], v[154:157], v[106:109]
    v_lshlrev_b32 v197, 16, v59
    v_mfma_f32_16x16x32_bf16 v[110:113], a[80:83], v[154:157], v[110:113]
    ds_read_b128 v[154:157], v38 offset:1920
    v_fmac_f32 v94, s20, v194
    v_mfma_f32_16x16x32_bf16 v[102:105], a[20:23], v[158:161], v[102:105]
    v_fmac_f32 v95, s21, v195
    v_mfma_f32_16x16x32_bf16 v[106:109], a[52:55], v[158:161], v[106:109]
    v_fmac_f32 v96, s22, v196
    v_mfma_f32_16x16x32_bf16 v[110:113], a[84:87], v[158:161], v[110:113]
    ds_read_b128 v[158:161], v38 offset:1984
    v_fmac_f32 v97, s23, v197
    v_mfma_f32_16x16x32_bf16 v[102:105], a[24:27], v[122:125], v[102:105]
    v_mfma_f32_16x16x32_bf16 v[106:109], a[56:59], v[122:125], v[106:109]
    v_mfma_f32_16x16x32_bf16 v[110:113], a[88:91], v[122:125], v[110:113]
    ds_read_b128 v[122:125], v38 offset:1024
    s_waitcnt lgkmcnt(2)
    v_mfma_f32_16x16x32_bf16 v[102:105], a[28:31], v[126:129], v[102:105]
    v_mfma_f32_16x16x32_bf16 v[106:109], a[60:63], v[126:129], v[106:109]
    v_mfma_f32_16x16x32_bf16 v[110:113], a[92:95], v[126:129], v[110:113]
    ds_read_b128 v[126:129], v38 offset:1088
    v_mfma_f32_16x16x32_bf16 v[106:109], a[0:3], v[130:133], v[106:109]
    s_waitcnt vmcnt(6)
    v_max_u32 v236, v215, v217
    s_waitcnt vmcnt(5)
    v_max3_u32 v236, v219, v221, v236
    v_mfma_f32_16x16x32_bf16 v[110:113], a[32:35], v[130:133], v[110:113]
    ds_read_b128 v[130:133], v38 offset:1152
    s_waitcnt vmcnt(4)
    v_max3_u32 v236, v223, v225, v236
    v_mfma_f32_16x16x32_bf16 v[106:109], a[4:7], v[134:137], v[106:109]
    s_waitcnt vmcnt(3)
    v_max3_u32 v236, v227, v229, v236
    s_waitcnt vmcnt(1)
    v_max3_u32 v236, v64, v65, v236
    v_mfma_f32_16x16x32_bf16 v[110:113], a[36:39], v[134:137], v[110:113]
    ds_read_b128 v[134:137], v38 offset:1216
    v_cmp_eq_u32 vcc, -1, v236
    v_mfma_f32_16x16x32_bf16 v[106:109], a[8:11], v[138:141], v[106:109]
    v_cvt_pk_bf16_f32 v48, v98, v99
    s_cbranch_vccnz Lax_r
Lax_ok:
    v_cvt_pk_bf16_f32 v49, v100, v101
    v_mfma_f32_16x16x32_bf16 v[110:113], a[40:43], v[138:141], v[110:113]
    ds_read_b128 v[138:141], v38 offset:1280
    v_add_u32 v42, 0, v43
    v_mfma_f32_16x16x32_bf16 v[106:109], a[12:15], v[142:145], v[106:109]
    ds_write2_b32 v40, v48, v49 offset0:0 offset1:2
    global_load_dwordx4 v[198:201], v42, s[38:39] sc1
    v_mfma_f32_16x16x32_bf16 v[110:113], a[44:47], v[142:145], v[110:113]
    ds_read_b128 v[142:145], v38 offset:1344
    v_cvt_pk_bf16_f32 v50, v102, v103
    v_mfma_f32_16x16x32_bf16 v[106:109], a[16:19], v[146:149], v[106:109]
    v_add_u32 v42, 917504, v43
    v_cvt_pk_bf16_f32 v51, v104, v105
    v_mfma_f32_16x16x32_bf16 v[110:113], a[48:51], v[146:149], v[110:113]
    ds_read_b128 v[146:149], v38 offset:1408
    global_load_dwordx4 v[202:205], v42, s[38:39] sc1
    v_mfma_f32_16x16x32_bf16 v[106:109], a[20:23], v[150:153], v[106:109]
    ds_write2_b32 v40, v50, v51 offset0:128 offset1:130
    v_add_u32 v42, 1835008, v43
    v_mfma_f32_16x16x32_bf16 v[110:113], a[52:55], v[150:153], v[110:113]
    ds_read_b128 v[150:153], v38 offset:1472
    v_add_u32 v40, 4224, v40
    v_mfma_f32_16x16x32_bf16 v[106:109], a[24:27], v[154:157], v[106:109]
    global_load_dwordx4 v[206:209], v42, s[38:39] sc1
    ds_read_b32 v56, v39 offset:2048
    v_mfma_f32_16x16x32_bf16 v[110:113], a[56:59], v[154:157], v[110:113]
    ds_read_b128 v[154:157], v38 offset:3584
    v_add_u32 v42, 2752512, v43
    s_waitcnt lgkmcnt(5)
    v_mfma_f32_16x16x32_bf16 v[106:109], a[28:31], v[158:161], v[106:109]
    ds_read_b32 v57, v39 offset:11328
    global_load_dwordx4 v[210:213], v42, s[38:39] sc1
    v_mfma_f32_16x16x32_bf16 v[110:113], a[60:63], v[158:161], v[110:113]
    ds_read_b128 v[158:161], v38 offset:3648
    ds_read_b32 v58, v39 offset:20608
    v_mfma_f32_16x16x32_bf16 v[110:113], a[0:3], v[122:125], v[110:113]
    ds_read_b128 v[122:125], v38 offset:3712
    v_add_f32 v64, v64, v65
    v_mfma_f32_16x16x32_bf16 v[110:113], a[4:7], v[126:129], v[110:113]
    ds_read_b128 v[126:129], v38 offset:3776
    ds_read_b32 v59, v39 offset:29888
    v_mfma_f32_16x16x32_bf16 v[110:113], a[8:11], v[130:133], v[110:113]
    ds_read_b128 v[130:133], v38 offset:3840
    v_cvt_pk_bf16_f32 v64, v64, v64
    v_lshlrev_b32 v64, 16, v64
    v_mfma_f32_16x16x32_bf16 v[110:113], a[12:15], v[134:137], v[110:113]
    ds_read_b128 v[134:137], v38 offset:3904
    v_mov_b32 v29, 1.0
    s_nop 1
    v_add_f32_dpp v64, v64, v29 quad_perm:[0,1,2,3] row_mask:0xf bank_mask:0x2
    v_cvt_pk_bf16_f32 v64, v64, v64
    v_mfma_f32_16x16x32_bf16 v[110:113], a[16:19], v[138:141], v[110:113]
    ds_read_b128 v[138:141], v38 offset:3968
    s_waitcnt lgkmcnt(6)
    s_barrier
    v_lshlrev_b32 v64, 16, v64
    s_nop 1
    v_mul_f32_dpp v65, v64, v64 row_shl:8 row_mask:0xf bank_mask:0x1
    s_nop 1
    v_mul_f32_dpp v65, v64, v64 row_shl:4 row_mask:0xf bank_mask:0x2
    v_mfma_f32_16x16x32_bf16 v[110:113], a[20:23], v[142:145], v[110:113]
    ds_read_b128 v[142:145], v38 offset:4032
    ds_read_b32 v52, v41 offset:4224
    v_readlane_b32 s32, v65, 0
    v_readlane_b32 s33, v65, 1
    v_readlane_b32 s86, v65, 2
    v_mfma_f32_16x16x32_bf16 v[110:113], a[24:27], v[146:149], v[110:113]
    ds_read_b128 v[146:149], v38 offset:3072
    ds_read_b32 v53, v41 offset:5280
    ds_read_b32 v54, v41 offset:6336
    ds_read_b32 v55, v41 offset:7392
    v_readlane_b32 s87, v65, 3
    v_readlane_b32 s64, v65, 4
    v_readlane_b32 s65, v65, 5
    v_mfma_f32_16x16x32_bf16 v[110:113], a[28:31], v[150:153], v[110:113]
    ds_read_b128 v[150:153], v38 offset:3136
    s_waitcnt lgkmcnt(5)
    v_lshlrev_b32 v98, 16, v52
    v_and_b32 v102, 0xffff0000, v52
    s_waitcnt lgkmcnt(3)
    v_lshlrev_b32 v99, 16, v53
    v_readlane_b32 s66, v65, 6
    v_readlane_b32 s67, v65, 7
    v_mov_b32 v60, s32
    v_mfma_f32_16x16x32_bf16 v[118:121], a[224:227], v[154:157], 0
    v_mov_b32 v61, s33
    v_mov_b32 v62, s86
    v_mov_b32 v63, s87
    v_and_b32 v103, 0xffff0000, v53
    s_waitcnt lgkmcnt(2)
    v_lshlrev_b32 v100, 16, v54
    v_and_b32 v104, 0xffff0000, v54
    v_mfma_f32_16x16x32_bf16 v[114:117], a[192:195], v[154:157], 0
    ds_read_b128 v[154:157], v38 offset:3200
    s_waitcnt lgkmcnt(2)
    v_lshlrev_b32 v101, 16, v55
    v_and_b32 v105, 0xffff0000, v55
    v_and_b32 v194, 0xffff0000, v56
    v_mfma_f32_16x16x32_bf16 v[118:121], a[228:231], v[158:161], v[118:121]
    v_and_b32 v195, 0xffff0000, v57
    v_and_b32 v196, 0xffff0000, v58
    v_and_b32 v197, 0xffff0000, v59
    v_mfma_f32_16x16x32_bf16 v[114:117], a[196:199], v[158:161], v[114:117]
    ds_read_b128 v[158:161], v38 offset:3264
    v_fmac_f32 v98, s20, v194
    v_fmac_f32 v99, s21, v195
    v_fmac_f32 v100, s22, v196
    v_mfma_f32_16x16x32_bf16 v[118:121], a[232:235], v[122:125], v[118:121]
    s_waitcnt vmcnt(4)
    v_cmp_eq_u32 vcc, -1, v234
    v_fmac_f32 v101, s23, v197
    v_lshlrev_b32 v194, 16, v56
    v_lshlrev_b32 v195, 16, v57
    v_mfma_f32_16x16x32_bf16 v[114:117], a[200:203], v[122:125], v[114:117]
    ds_read_b128 v[122:125], v38 offset:3328
    s_barrier
    v_lshlrev_b32 v196, 16, v58
    v_lshlrev_b32 v197, 16, v59
    v_fmac_f32 v102, s20, v194
    v_mfma_f32_16x16x32_bf16 v[118:121], a[236:239], v[126:129], v[118:121]
    v_fmac_f32 v103, s21, v195
    v_fmac_f32 v104, s22, v196
    v_fmac_f32 v105, s23, v197
    v_mfma_f32_16x16x32_bf16 v[114:117], a[204:207], v[126:129], v[114:117]
    ds_read_b128 v[126:129], v38 offset:3392
    s_cbranch_vccnz Lcu_r
Lcu_ok:
    s_add_u32 m0, s89, 0
    v_mfma_f32_16x16x32_bf16 v[118:121], a[240:243], v[130:133], v[118:121]
    v_cvt_pk_bf16_f32 v48, v106, v107
    v_cvt_pk_bf16_f32 v49, v108, v109
    v_mfma_f32_16x16x32_bf16 v[114:117], a[208:211], v[130:133], v[114:117]
    ds_read_b128 v[130:133], v38 offset:3456
    ds_write2_b32 v40, v48, v49 offset0:0 offset1:2
    v_mfma_f32_16x16x32_bf16 v[118:121], a[244:247], v[134:137], v[118:121]
    global_load_lds_dwordx4 v74, s[68:69] offset:0
    v_cvt_pk_bf16_f32 v50, v110, v111
    v_mfma_f32_16x16x32_bf16 v[114:117], a[212:215], v[134:137], v[114:117]
    ds_read_b128 v[134:137], v38 offset:3520
    v_cvt_pk_bf16_f32 v51, v112, v113
    v_mfma_f32_16x16x32_bf16 v[118:121], a[248:251], v[138:141], v[118:121]
    ds_write2_b32 v40, v50, v51 offset0:128 offset1:130
    v_add_u32 v40, 4224, v40
    v_mfma_f32_16x16x32_bf16 v[114:117], a[216:219], v[138:141], v[114:117]
    ds_read_b128 v[138:141], v38 offset:2560
    global_load_lds_dwordx4 v75, s[68:69] offset:1024
    v_mfma_f32_16x16x32_bf16 v[118:121], a[252:255], v[142:145], v[118:121]
    ds_read_b32 v56, v39 offset:1024
    ds_read_b32 v57, v39 offset:10304
    v_mfma_f32_16x16x32_bf16 v[114:117], a[220:223], v[142:145], v[114:117]
    ds_read_b128 v[142:145], v38 offset:2624
    ds_read_b32 v58, v39 offset:19584
    v_mfma_f32_16x16x32_bf16 v[118:121], a[192:195], v[146:149], v[118:121]
    ds_read_b32 v59, v39 offset:28864
    global_load_lds_dwordx4 v76, s[68:69] offset:2048
    v_mfma_f32_16x16x32_bf16 v[114:117], a[160:163], v[146:149], v[114:117]
    ds_read_b128 v[146:149], v38 offset:2688
    s_waitcnt lgkmcnt(7)
    s_barrier
    v_mfma_f32_16x16x32_bf16 v[118:121], a[196:199], v[150:153], v[118:121]
    ds_read_b32 v52, v41 offset:8448
    ds_read_b32 v53, v41 offset:9504
    v_mfma_f32_16x16x32_bf16 v[114:117], a[164:167], v[150:153], v[114:117]
    ds_read_b128 v[150:153], v38 offset:2752
    ds_read_b32 v54, v41 offset:10560
    v_mfma_f32_16x16x32_bf16 v[118:121], a[200:203], v[154:157], v[118:121]
    global_load_lds_dwordx4 v77, s[68:69] offset:3072
    ds_read_b32 v55, v41 offset:11616
    s_add_u32 m0, s89, 4096
    v_mfma_f32_16x16x32_bf16 v[114:117], a[168:171], v[154:157], v[114:117]
    ds_read_b128 v[154:157], v38 offset:2816
    s_waitcnt lgkmcnt(5)
    v_lshlrev_b32 v106, 16, v52
    v_mfma_f32_16x16x32_bf16 v[118:121], a[204:207], v[158:161], v[118:121]
    v_and_b32 v110, 0xffff0000, v52
    s_waitcnt lgkmcnt(4)
    v_lshlrev_b32 v107, 16, v53
    v_mfma_f32_16x16x32_bf16 v[114:117], a[172:175], v[158:161], v[114:117]
    ds_read_b128 v[158:161], v38 offset:2880
    v_and_b32 v111, 0xffff0000, v53
    v_mfma_f32_16x16x32_bf16 v[118:121], a[208:211], v[122:125], v[118:121]
    s_waitcnt lgkmcnt(3)
    v_lshlrev_b32 v108, 16, v54
    v_and_b32 v112, 0xffff0000, v54
    v_mfma_f32_16x16x32_bf16 v[114:117], a[176:179], v[122:125], v[114:117]
    ds_read_b128 v[122:125], v38 offset:2944
    s_waitcnt lgkmcnt(3)
    v_lshlrev_b32 v109, 16, v55
    v_mfma_f32_16x16x32_bf16 v[118:121], a[212:215], v[126:129], v[118:121]
    v_and_b32 v113, 0xffff0000, v55
    global_load_lds_dwordx4 v78, s[68:69] offset:0
    v_mfma_f32_16x16x32_bf16 v[114:117], a[180:183], v[126:129], v[114:117]
    ds_read_b128 v[126:129], v38 offset:3008
    v_and_b32 v194, 0xffff0000, v56
    v_mfma_f32_16x16x32_bf16 v[118:121], a[216:219], v[130:133], v[118:121]
    v_and_b32 v195, 0xffff0000, v57
    v_and_b32 v196, 0xffff0000, v58
    v_mfma_f32_16x16x32_bf16 v[114:117], a[184:187], v[130:133], v[114:117]
    ds_read_b128 v[130:133], v38 offset:2048
    v_and_b32 v197, 0xffff0000, v59
    v_mfma_f32_16x16x32_bf16 v[118:121], a[220:223], v[134:137], v[118:121]
    global_load_lds_dwordx4 v79, s[68:69] offset:1024
    v_fmac_f32 v106, s20, v194
    v_mfma_f32_16x16x32_bf16 v[114:117], a[188:191], v[134:137], v[114:117]
    ds_read_b128 v[134:137], v38 offset:2112
    v_fmac_f32 v107, s21, v195
    v_mfma_f32_16x16x32_bf16 v[118:121], a[160:163], v[138:141], v[118:121]
    v_fmac_f32 v108, s22, v196
    v_fmac_f32 v109, s23, v197
    v_mfma_f32_16x16x32_bf16 v[114:117], a[128:131], v[138:141], v[114:117]
    ds_read_b128 v[138:141], v38 offset:2176
    v_lshlrev_b32 v194, 16, v56
    v_lshlrev_b32 v195, 16, v57
    v_mfma_f32_16x16x32_bf16 v[118:121], a[164:167], v[142:145], v[118:121]
    global_load_lds_dwordx4 v80, s[68:69] offset:2048
    v_lshlrev_b32 v196, 16, v58
    v_lshlrev_b32 v197, 16, v59
    v_fmac_f32 v110, s20, v194
    v_mfma_f32_16x16x32_bf16 v[114:117], a[132:135], v[142:145], v[114:117]
    ds_read_b128 v[142:145], v38 offset:2240
    global_load_lds_dwordx4 v81, s[68:69] offset:3072
    v_fmac_f32 v111, s21, v195
    v_fmac_f32 v112, s22, v196
    v_fmac_f32 v113, s23, v197
    v_mfma_f32_16x16x32_bf16 v[118:121], a[168:171], v[146:149], v[118:121]
    s_waitcnt vmcnt(11)
    v_lshlrev_b32 v162, 16, v198
    global_load_dwordx4 a[248:251], v4, s[12:13] offset:-1024 sc1
    v_mfma_f32_16x16x32_bf16 v[114:117], a[136:139], v[146:149], v[114:117]
    ds_read_b128 v[146:149], v38 offset:2304
    v_and_b32 v163, 0xffff0000, v198
    v_mfma_f32_16x16x32_bf16 v[118:121], a[172:175], v[150:153], v[118:121]
    v_lshlrev_b32 v164, 16, v199
    v_and_b32 v165, 0xffff0000, v199
    v_mfma_f32_16x16x32_bf16 v[114:117], a[140:143], v[150:153], v[114:117]
    ds_read_b128 v[150:153], v38 offset:2368
    v_lshlrev_b32 v166, 16, v200
    s_waitcnt lgkmcnt(2)
    v_mfma_f32_16x16x32_bf16 v[118:121], a[176:179], v[154:157], v[118:121]
    v_and_b32 v167, 0xffff0000, v200
    v_lshlrev_b32 v168, 16, v201
    v_mfma_f32_16x16x32_bf16 v[114:117], a[144:147], v[154:157], v[114:117]
    ds_read_b128 v[154:157], v38 offset:2432
    v_and_b32 v169, 0xffff0000, v201
    v_mfma_f32_16x16x32_bf16 v[118:121], a[180:183], v[158:161], v[118:121]
    v_fma_f32 v170, v162, v214, v215
    v_fma_f32 v171, v163, v214, v215
    v_mfma_f32_16x16x32_bf16 v[114:117], a[148:151], v[158:161], v[114:117]
    ds_read_b128 v[158:161], v38 offset:2496
    v_fma_f32 v172, v164, v214, v215
    v_mfma_f32_16x16x32_bf16 v[118:121], a[184:187], v[122:125], v[118:121]
    v_fma_f32 v173, v165, v214, v215
    v_fma_f32 v174, v166, v216, v217
    v_mfma_f32_16x16x32_bf16 v[114:117], a[152:155], v[122:125], v[114:117]
    ds_read_b128 v[122:125], v38 offset:1536
    v_fma_f32 v175, v167, v216, v217
    v_mfma_f32_16x16x32_bf16 v[118:121], a[188:191], v[126:129], v[118:121]
    v_fma_f32 v176, v168, v216, v217
    global_load_dwordx4 a[252:255], v7, s[18:19] offset:-1024 sc1
    v_mfma_f32_16x16x32_bf16 v[114:117], a[156:159], v[126:129], v[114:117]
    ds_read_b128 v[126:129], v38 offset:1600
    v_fma_f32 v177, v169, v216, v217
    v_mfma_f32_16x16x32_bf16 v[118:121], a[128:131], v[130:133], v[118:121]
    v_fma_f32 v170, v170, s64, v60
    v_fma_f32 v171, v171, s65, v61
    v_mfma_f32_16x16x32_bf16 v[114:117], a[96:99], v[130:133], v[114:117]
    ds_read_b128 v[130:133], v38 offset:1664
    v_fma_f32 v172, v172, s66, v62
    v_mfma_f32_16x16x32_bf16 v[118:121], a[132:135], v[134:137], v[118:121]
    v_fma_f32 v173, v173, s67, v63
    v_fma_f32 v174, v174, s64, v60
    v_mfma_f32_16x16x32_bf16 v[114:117], a[100:103], v[134:137], v[114:117]
    ds_read_b128 v[134:137], v38 offset:1728
    v_fma_f32 v175, v175, s65, v61
    v_mfma_f32_16x16x32_bf16 v[118:121], a[136:139], v[138:141], v[118:121]
    v_fma_f32 v176, v176, s66, v62
    v_fma_f32 v177, v177, s67, v63
    v_mfma_f32_16x16x32_bf16 v[114:117], a[104:107], v[138:141], v[114:117]
    ds_read_b128 v[138:141], v38 offset:1792
    v_fma_f32 v162, v170, v90, v162
    v_mfma_f32_16x16x32_bf16 v[118:121], a[140:143], v[142:145], v[118:121]
    v_fma_f32 v163, v171, v91, v163
    v_fma_f32 v164, v172, v92, v164
    v_mfma_f32_16x16x32_bf16 v[114:117], a[108:111], v[142:145], v[114:117]
    ds_read_b128 v[142:145], v38 offset:1856
    v_fma_f32 v165, v173, v93, v165
    s_waitcnt lgkmcnt(3)
    v_mfma_f32_16x16x32_bf16 v[118:121], a[144:147], v[146:149], v[118:121]
    v_fma_f32 v166, v174, v94, v166
    global_load_dwordx4 a[240:243], v4, s[12:13] offset:-2048 sc1
    v_mfma_f32_16x16x32_bf16 v[114:117], a[112:115], v[146:149], v[114:117]
    ds_read_b128 v[146:149], v38 offset:1920
    v_fma_f32 v167, v175, v95, v167
    v_mfma_f32_16x16x32_bf16 v[118:121], a[148:151], v[150:153], v[118:121]
    v_fma_f32 v168, v176, v96, v168
    v_fma_f32 v169, v177, v97, v169
    v_mfma_f32_16x16x32_bf16 v[114:117], a[116:119], v[150:153], v[114:117]
    ds_read_b128 v[150:153], v38 offset:1984
    v_cvt_pk_bf16_f32 v198, v162, v163
    v_mfma_f32_16x16x32_bf16 v[118:121], a[152:155], v[154:157], v[118:121]
    v_cvt_pk_bf16_f32 v199, v164, v165
    v_cvt_pk_bf16_f32 v200, v166, v167
    v_mfma_f32_16x16x32_bf16 v[114:117], a[120:123], v[154:157], v[114:117]
    ds_read_b128 v[154:157], v38 offset:1024
    v_cvt_pk_bf16_f32 v201, v168, v169
    v_mfma_f32_16x16x32_bf16 v[118:121], a[156:159], v[158:161], v[118:121]
    v_or_b32 v201, 1, v201
    v_add_u32 v44, 0, v43
    v_mfma_f32_16x16x32_bf16 v[114:117], a[124:127], v[158:161], v[114:117]
    ds_read_b128 v[158:161], v38 offset:1088
    global_store_dwordx4 v44, v[198:201], s[38:39] sc1
    v_mfma_f32_16x16x32_bf16 v[118:121], a[96:99], v[122:125], v[118:121]
    s_waitcnt vmcnt(14)
    v_lshlrev_b32 v162, 16, v202
    v_and_b32 v163, 0xffff0000, v202
    v_mfma_f32_16x16x32_bf16 v[114:117], a[64:67], v[122:125], v[114:117]
    ds_read_b128 v[122:125], v38 offset:1152
    v_lshlrev_b32 v164, 16, v203
    v_mfma_f32_16x16x32_bf16 v[118:121], a[100:103], v[126:129], v[118:121]
    v_and_b32 v165, 0xffff0000, v203
    v_lshlrev_b32 v166, 16, v204
    v_mfma_f32_16x16x32_bf16 v[114:117], a[68:71], v[126:129], v[114:117]
    ds_read_b128 v[126:129], v38 offset:1216
    global_load_dwordx4 a[244:247], v7, s[18:19] offset:-2048 sc1
    v_mfma_f32_16x16x32_bf16 v[118:121], a[104:107], v[130:133], v[118:121]
    v_and_b32 v167, 0xffff0000, v204
    v_lshlrev_b32 v168, 16, v205
    v_mfma_f32_16x16x32_bf16 v[114:117], a[72:75], v[130:133], v[114:117]
    ds_read_b128 v[130:133], v38 offset:1280
    v_and_b32 v169, 0xffff0000, v205
    s_waitcnt lgkmcnt(3)
    v_mfma_f32_16x16x32_bf16 v[118:121], a[108:111], v[134:137], v[118:121]
    v_fma_f32 v170, v162, v218, v219
    v_fma_f32 v171, v163, v218, v219
    v_mfma_f32_16x16x32_bf16 v[114:117], a[76:79], v[134:137], v[114:117]
    ds_read_b128 v[134:137], v38 offset:1344
    v_fma_f32 v172, v164, v218, v219
    v_mfma_f32_16x16x32_bf16 v[118:121], a[112:115], v[138:141], v[118:121]
    v_fma_f32 v173, v165, v218, v219
    v_fma_f32 v174, v166, v220, v221
    v_mfma_f32_16x16x32_bf16 v[114:117], a[80:83], v[138:141], v[114:117]
    ds_read_b128 v[138:141], v38 offset:1408
    v_fma_f32 v175, v167, v220, v221
    v_mfma_f32_16x16x32_bf16 v[118:121], a[116:119], v[142:145], v[118:121]
    v_fma_f32 v176, v168, v220, v221
    v_fma_f32 v177, v169, v220, v221
    v_mfma_f32_16x16x32_bf16 v[114:117], a[84:87], v[142:145], v[114:117]
    ds_read_b128 v[142:145], v38 offset:1472
    v_fma_f32 v170, v170, s64, v60
    v_mfma_f32_16x16x32_bf16 v[118:121], a[120:123], v[146:149], v[118:121]
    v_fma_f32 v171, v171, s65, v61
    v_fma_f32 v172, v172, s66, v62
    v_mfma_f32_16x16x32_bf16 v[114:117], a[88:91], v[146:149], v[114:117]
    ds_read_b128 v[146:149], v38 offset:512
    global_load_dwordx4 a[232:235], v4, s[12:13] offset:-3072 sc1
    v_mfma_f32_16x16x32_bf16 v[118:121], a[124:127], v[150:153], v[118:121]
    v_fma_f32 v173, v173, s67, v63
    v_fma_f32 v174, v174, s64, v60
    v_mfma_f32_16x16x32_bf16 v[114:117], a[92:95], v[150:153], v[114:117]
    ds_read_b128 v[150:153], v38 offset:576
    v_fma_f32 v175, v175, s65, v61
    v_mfma_f32_16x16x32_bf16 v[118:121], a[64:67], v[154:157], v[118:121]
    v_fma_f32 v176, v176, s66, v62
    v_fma_f32 v177, v177, s67, v63
    v_mfma_f32_16x16x32_bf16 v[114:117], a[32:35], v[154:157], v[114:117]
    ds_read_b128 v[154:157], v38 offset:640
    v_fma_f32 v162, v170, v98, v162
    v_mfma_f32_16x16x32_bf16 v[118:121], a[68:71], v[158:161], v[118:121]
    v_fma_f32 v163, v171, v99, v163
    v_fma_f32 v164, v172, v100, v164
    v_mfma_f32_16x16x32_bf16 v[114:117], a[36:39], v[158:161], v[114:117]
    ds_read_b128 v[158:161], v38 offset:704
    v_fma_f32 v165, v173, v101, v165
    s_waitcnt lgkmcnt(3)
    v_mfma_f32_16x16x32_bf16 v[118:121], a[72:75], v[122:125], v[118:121]
    v_fma_f32 v166, v174, v102, v166
    v_fma_f32 v167, v175, v103, v167
    v_mfma_f32_16x16x32_bf16 v[114:117], a[40:43], v[122:125], v[114:117]
    ds_read_b128 v[122:125], v38 offset:768
    v_fma_f32 v168, v176, v104, v168
    v_mfma_f32_16x16x32_bf16 v[118:121], a[76:79], v[126:129], v[118:121]
    v_fma_f32 v169, v177, v105, v169
    v_cvt_pk_bf16_f32 v202, v162, v163
    v_mfma_f32_16x16x32_bf16 v[114:117], a[44:47], v[126:129], v[114:117]
    ds_read_b128 v[126:129], v38 offset:832
    v_cvt_pk_bf16_f32 v203, v164, v165
    v_mfma_f32_16x16x32_bf16 v[118:121], a[80:83], v[130:133], v[118:121]
    global_load_dwordx4 a[236:239], v7, s[18:19] offset:-3072 sc1
    v_cvt_pk_bf16_f32 v204, v166, v167
    v_mfma_f32_16x16x32_bf16 v[114:117], a[48:51], v[130:133], v[114:117]
    ds_read_b128 v[130:133], v38 offset:896
    v_cvt_pk_bf16_f32 v205, v168, v169
    v_mfma_f32_16x16x32_bf16 v[118:121], a[84:87], v[134:137], v[118:121]
    v_or_b32 v205, 1, v205
    v_add_u32 v44, 917504, v43
    v_mfma_f32_16x16x32_bf16 v[114:117], a[52:55], v[134:137], v[114:117]
    ds_read_b128 v[134:137], v38 offset:960
    global_store_dwordx4 v44, v[202:205], s[38:39] sc1
    v_mfma_f32_16x16x32_bf16 v[118:121], a[88:91], v[138:141], v[118:121]
    s_waitcnt vmcnt(17)
    v_lshlrev_b32 v162, 16, v206
    v_and_b32 v163, 0xffff0000, v206
    v_mfma_f32_16x16x32_bf16 v[114:117], a[56:59], v[138:141], v[114:117]
    ds_read_b128 v[138:141], v38 offset:0
    v_lshlrev_b32 v164, 16, v207
    v_mfma_f32_16x16x32_bf16 v[118:121], a[92:95], v[142:145], v[118:121]
    v_and_b32 v165, 0xffff0000, v207
    v_lshlrev_b32 v166, 16, v208
    v_mfma_f32_16x16x32_bf16 v[114:117], a[60:63], v[142:145], v[114:117]
    ds_read_b128 v[142:145], v38 offset:64
    v_and_b32 v167, 0xffff0000, v208
    v_mfma_f32_16x16x32_bf16 v[118:121], a[32:35], v[146:149], v[118:121]
    v_lshlrev_b32 v168, 16, v209
    v_and_b32 v169, 0xffff0000, v209
    v_mfma_f32_16x16x32_bf16 v[114:117], a[0:3], v[146:149], v[114:117]
    ds_read_b128 v[146:149], v38 offset:128
    v_fma_f32 v170, v162, v222, v223
    s_waitcnt lgkmcnt(3)
    v_mfma_f32_16x16x32_bf16 v[118:121], a[36:39], v[150:153], v[118:121]
    global_load_dwordx4 a[224:227], v4, s[12:13] offset:-4096 sc1
    v_fma_f32 v171, v163, v222, v223
    v_mfma_f32_16x16x32_bf16 v[114:117], a[4:7], v[150:153], v[114:117]
    ds_read_b128 v[150:153], v38 offset:192
    v_fma_f32 v172, v164, v222, v223
    v_mfma_f32_16x16x32_bf16 v[118:121], a[40:43], v[154:157], v[118:121]
    v_fma_f32 v173, v165, v222, v223
    v_fma_f32 v174, v166, v224, v225
    v_mfma_f32_16x16x32_bf16 v[114:117], a[8:11], v[154:157], v[114:117]
    ds_read_b128 v[154:157], v38 offset:256
    v_fma_f32 v175, v167, v224, v225
    v_mfma_f32_16x16x32_bf16 v[118:121], a[44:47], v[158:161], v[118:121]
    v_fma_f32 v176, v168, v224, v225
    v_fma_f32 v177, v169, v224, v225
    v_mfma_f32_16x16x32_bf16 v[114:117], a[12:15], v[158:161], v[114:117]
    ds_read_b128 v[158:161], v38 offset:320
    v_fma_f32 v170, v170, s64, v60
    v_fma_f32 v171, v171, s65, v61
    v_fma_f32 v172, v172, s66, v62
    v_mfma_f32_16x16x32_bf16 v[118:121], a[48:51], v[122:125], v[118:121]
    v_fma_f32 v173, v173, s67, v63
    v_fma_f32 v174, v174, s64, v60
    v_fma_f32 v175, v175, s65, v61
    v_mfma_f32_16x16x32_bf16 v[114:117], a[16:19], v[122:125], v[114:117]
    ds_read_b128 v[122:125], v38 offset:384
    v_fma_f32 v176, v176, s66, v62
    v_fma_f32 v177, v177, s67, v63
    v_fma_f32 v162, v170, v106, v162
    v_mfma_f32_16x16x32_bf16 v[118:121], a[52:55], v[126:129], v[118:121]
    global_load_dwordx4 a[228:231], v7, s[18:19] offset:-4096 sc1
    v_fma_f32 v163, v171, v107, v163
    v_fma_f32 v164, v172, v108, v164
    v_fma_f32 v165, v173, v109, v165
    v_mfma_f32_16x16x32_bf16 v[114:117], a[20:23], v[126:129], v[114:117]
    ds_read_b128 v[126:129], v38 offset:448
    v_fma_f32 v166, v174, v110, v166
    v_fma_f32 v167, v175, v111, v167
    v_fma_f32 v168, v176, v112, v168
    v_mfma_f32_16x16x32_bf16 v[118:121], a[56:59], v[130:133], v[118:121]
    v_fma_f32 v169, v177, v113, v169
    v_cvt_pk_bf16_f32 v206, v162, v163
    v_cvt_pk_bf16_f32 v207, v164, v165
    v_mfma_f32_16x16x32_bf16 v[114:117], a[24:27], v[130:133], v[114:117]
    v_cvt_pk_bf16_f32 v208, v166, v167
    v_cvt_pk_bf16_f32 v209, v168, v169
    v_or_b32 v209, 1, v209
    v_mfma_f32_16x16x32_bf16 v[118:121], a[60:63], v[134:137], v[118:121]
    v_add_u32 v44, 1835008, v43
    global_store_dwordx4 v44, v[206:209], s[38:39] sc1
    s_waitcnt vmcnt(19)
    v_lshlrev_b32 v178, 16, v210
    v_mfma_f32_16x16x32_bf16 v[114:117], a[28:31], v[134:137], v[114:117]
    global_load_dwordx4 a[216:219], v4, s[10:11] offset:3072 sc1
    v_and_b32 v179, 0xffff0000, v210
    v_lshlrev_b32 v180, 16, v211
    v_and_b32 v181, 0xffff0000, v211
    s_waitcnt lgkmcnt(0)
    v_mfma_f32_16x16x32_bf16 v[118:121], a[0:3], v[138:141], v[118:121]
    v_lshlrev_b32 v182, 16, v212
    v_and_b32 v183, 0xffff0000, v212
    v_lshlrev_b32 v184, 16, v213
    v_mfma_f32_16x16x32_bf16 v[118:121], a[4:7], v[142:145], v[118:121]
    v_and_b32 v185, 0xffff0000, v213
    v_fma_f32 v186, v178, v226, v227
    v_fma_f32 v187, v179, v226, v227
    v_mfma_f32_16x16x32_bf16 v[118:121], a[8:11], v[146:149], v[118:121]
    v_fma_f32 v188, v180, v226, v227
    v_fma_f32 v189, v181, v226, v227
    v_fma_f32 v190, v182, v228, v229
    v_mfma_f32_16x16x32_bf16 v[118:121], a[12:15], v[150:153], v[118:121]
    v_fma_f32 v191, v183, v228, v229
    global_load_dwordx4 a[220:223], v7, s[16:17] offset:3072 sc1
    v_fma_f32 v192, v184, v228, v229
    v_fma_f32 v193, v185, v228, v229
    v_mfma_f32_16x16x32_bf16 v[118:121], a[16:19], v[154:157], v[118:121]
    v_fma_f32 v186, v186, s64, v60
    v_fma_f32 v187, v187, s65, v61
    v_fma_f32 v188, v188, s66, v62
    v_mfma_f32_16x16x32_bf16 v[118:121], a[20:23], v[158:161], v[118:121]
    v_fma_f32 v189, v189, s67, v63
    v_fma_f32 v190, v190, s64, v60
    v_fma_f32 v191, v191, s65, v61
    v_mfma_f32_16x16x32_bf16 v[118:121], a[24:27], v[122:125], v[118:121]
    v_fma_f32 v192, v192, s66, v62
    v_fma_f32 v193, v193, s67, v63
    ds_read_b32 v56, v39 offset:0
    v_mfma_f32_16x16x32_bf16 v[118:121], a[28:31], v[126:129], v[118:121]
    ds_read_b32 v57, v39 offset:9280
    ds_read_b32 v58, v39 offset:18560
    ds_read_b32 v59, v39 offset:27840
    global_load_dwordx4 v[230:233], v235, s[38:39] sc1
    global_load_dwordx4 a[208:211], v4, s[10:11] offset:2048 sc1
    v_cvt_pk_bf16_f32 v48, v114, v115
    v_cvt_pk_bf16_f32 v49, v116, v117
    ds_write2_b32 v40, v48, v49 offset0:0 offset1:2
    v_cvt_pk_bf16_f32 v50, v118, v119
    v_cvt_pk_bf16_f32 v51, v120, v121
    global_load_dwordx4 a[212:215], v7, s[16:17] offset:2048 sc1
    ds_write2_b32 v40, v50, v51 offset0:128 offset1:130
    s_waitcnt lgkmcnt(0)
    s_barrier
    ds_read_b32 v52, v41 offset:12672
    ds_read_b32 v53, v41 offset:13728
    ds_read_b32 v54, v41 offset:14784
    global_load_dwordx4 a[200:203], v4, s[10:11] offset:1024 sc1
    ds_read_b32 v55, v41 offset:15840
    s_waitcnt lgkmcnt(3)
    v_lshlrev_b32 v114, 16, v52
    v_and_b32 v118, 0xffff0000, v52
    s_waitcnt lgkmcnt(2)
    v_lshlrev_b32 v115, 16, v53
    v_and_b32 v119, 0xffff0000, v53
    s_waitcnt lgkmcnt(1)
    v_lshlrev_b32 v116, 16, v54
    global_load_dwordx4 a[204:207], v7, s[16:17] offset:1024 sc1
    v_and_b32 v120, 0xffff0000, v54
    s_waitcnt lgkmcnt(0)
    v_lshlrev_b32 v117, 16, v55
    v_and_b32 v121, 0xffff0000, v55
    v_dot2_f32_bf16 v114, v56, s20, v114
    v_dot2_f32_bf16 v115, v57, s21, v115
    v_dot2_f32_bf16 v116, v58, s22, v116
    v_dot2_f32_bf16 v117, v59, s23, v117
    v_dot2_f32_bf16 v118, v56, s28, v118
    v_dot2_f32_bf16 v119, v57, s29, v119
    v_dot2_f32_bf16 v120, v58, s30, v120
    v_dot2_f32_bf16 v121, v59, s31, v121
    v_pk_fma_f32 v[178:179], v[186:187], v[114:115], v[178:179] op_sel:[0,0,0] op_sel_hi:[1,1,1]
    v_pk_fma_f32 v[180:181], v[188:189], v[116:117], v[180:181] op_sel:[0,0,0] op_sel_hi:[1,1,1]
    v_pk_fma_f32 v[182:183], v[190:191], v[118:119], v[182:183] op_sel:[0,0,0] op_sel_hi:[1,1,1]
    v_pk_fma_f32 v[184:185], v[192:193], v[120:121], v[184:185] op_sel:[0,0,0] op_sel_hi:[1,1,1]
    v_cvt_pk_bf16_f32 v210, v178, v179
    v_cvt_pk_bf16_f32 v211, v180, v181
    v_cvt_pk_bf16_f32 v212, v182, v183
    v_cvt_pk_bf16_f32 v213, v184, v185
    v_or_b32 v213, 1, v213
    v_add_u32 v44, 2752512, v43
    global_store_dwordx4 v44, v[210:213], s[38:39] sc1
    s_waitcnt lgkmcnt(0)
    s_barrier
    s_waitcnt vmcnt(5)
    v_max_u32 v236, v230, v231
    v_max3_u32 v236, v232, v233, v236
    v_cmp_eq_u32 vcc, -1, v236
    s_nop 0
    s_cbranch_vccnz Lcv_r
Lcv_ok:
    v_permlane32_swap_b32 v230, v232
    v_permlane32_swap_b32 v231, v233
    s_lshl_b32 s4, s3, 9
    s_add_u32 s4, s4, 156672
    v_and_b32 v235, 496, v4
    v_add_f32 v230, v230, v232
    v_add_f32 v231, v231, v233
    v_bfe_u32 v232, v1, 3, 1
    v_cmp_gt_u32 vcc, s101, v232
    v_lshrrev_b32 v232, 5, v1
    v_lshl_add_u32 v235, v232, 3, v235
    v_cndmask_b32 v230, 0, v230, vcc
    v_cndmask_b32 v231, 0, v231, vcc
    v_add_u32 v235, s4, v235
    ds_write_b64 v235, v[230:231]
    global_load_dwordx4 a[192:195], v4, s[10:11] offset:0 sc1
    global_load_dwordx4 a[196:199], v7, s[16:17] offset:0 sc1
    global_load_dwordx4 a[184:187], v4, s[10:11] offset:-1024 sc1
    global_load_dwordx4 a[188:191], v7, s[16:17] offset:-1024 sc1
    global_load_dwordx4 a[176:179], v4, s[10:11] offset:-2048 sc1
    global_load_dwordx4 a[180:183], v7, s[16:17] offset:-2048 sc1
    global_load_dwordx4 a[168:171], v4, s[10:11] offset:-3072 sc1
    global_load_dwordx4 a[172:175], v7, s[16:17] offset:-3072 sc1
    global_load_dwordx4 a[160:163], v4, s[10:11] offset:-4096 sc1
    global_load_dwordx4 a[164:167], v7, s[16:17] offset:-4096 sc1
    global_load_dwordx4 a[152:155], v4, s[8:9] offset:3072 sc1
    global_load_dwordx4 a[156:159], v7, s[14:15] offset:3072 sc1
    global_load_dwordx4 a[144:147], v4, s[8:9] offset:2048 sc1
    global_load_dwordx4 a[148:151], v7, s[14:15] offset:2048 sc1
    global_load_dwordx4 a[136:139], v4, s[8:9] offset:1024 sc1
    global_load_dwordx4 a[140:143], v7, s[14:15] offset:1024 sc1
    global_load_dwordx4 a[128:131], v4, s[8:9] offset:0 sc1
    global_load_dwordx4 a[132:135], v7, s[14:15] offset:0 sc1
Ljoin:
    s_bfe_u32 s6, s2, 0x30003
    v_mul_u32_u24 v254, 8, v0
    v_add_lshl_u32 v254, v254, s6, 7
    v_min_u32 v254, (Lmid-Lx_go-4), v254
    v_add_u32 v254, (Lx_go-adaLN_cond__ssm_conv_h3__mixer_gmlp__prompt_kernel), v254
    global_load_dword v254, v254, s[0:1]
    s_cmp_lt_u32 s43, 5
    s_cbranch_scc1 Lx_first
Lx_redo:
    s_branch Lxp_f
Lxp:
    s_sleep 1
Lxp_f:
    global_load_dword v71, v72, s[38:39] offset:508 sc1
    s_waitcnt vmcnt(0)
    v_and_b32 v71, 1, v71
    v_cmp_ne_u32 vcc, 1, v71
    s_add_u32 s100, s100, 1
    s_cmp_ge_u32 s100, 262144
    s_cbranch_scc1 Lxp_x
    s_cbranch_vccnz Lxp
Lxp_x:
Lx_first:
    s_mov_b32 s7, 0x3f803f80
    v_add_u32 v67, 4096, v66
    global_load_dwordx4 v[98:101], v67, s[38:39] offset:-4096 sc1
    global_load_dwordx4 v[102:105], v67, s[38:39] offset:-3072 sc1
    global_load_dwordx4 v[106:109], v67, s[38:39] offset:-2048 sc1
    global_load_dwordx4 v[110:113], v67, s[38:39] offset:-1024 sc1
    global_load_dwordx4 v[114:117], v67, s[38:39] offset:0 sc1
    global_load_dwordx4 v[118:121], v67, s[38:39] offset:1024 sc1
    global_load_dwordx4 v[122:125], v67, s[38:39] offset:2048 sc1
    global_load_dwordx4 v[126:129], v67, s[38:39] offset:3072 sc1
    v_add_u32 v67, 8192, v67
    global_load_dwordx4 v[130:133], v67, s[38:39] offset:-4096 sc1
    global_load_dwordx4 v[134:137], v67, s[38:39] offset:-3072 sc1
    v_mov_b32 v62, 0
    v_mov_b32 v63, 0
    v_mov_b32 v64, 0
    v_mov_b32 v65, 0
    v_mov_b32 v71, -1
    global_load_dwordx4 v[138:141], v67, s[38:39] offset:-2048 sc1
    v_add_u32 v69, 0, v68
    s_waitcnt vmcnt(10)
    ds_write2_b64 v69, v[98:99], v[100:101] offset0:0 offset1:2
    v_dot2_f32_bf16 v62, v98, s7, v62
    v_dot2_f32_bf16 v63, v98, v98, v63
    v_dot2_f32_bf16 v64, v100, s7, v64
    v_dot2_f32_bf16 v65, v100, v100, v65
    v_dot2_f32_bf16 v62, v99, s7, v62
    v_dot2_f32_bf16 v63, v99, v99, v63
    v_dot2_f32_bf16 v64, v101, s7, v64
    v_dot2_f32_bf16 v65, v101, v101, v65
    global_load_dwordx4 v[142:145], v67, s[38:39] offset:-1024 sc1
    s_waitcnt vmcnt(10)
    ds_write2_b64 v69, v[102:103], v[104:105] offset0:32 offset1:34
    v_bitop3_b32 v71, v101, v105, v71 bitop3:0x80
    v_dot2_f32_bf16 v62, v102, s7, v62
    v_dot2_f32_bf16 v63, v102, v102, v63
    v_dot2_f32_bf16 v64, v104, s7, v64
    v_dot2_f32_bf16 v65, v104, v104, v65
    v_dot2_f32_bf16 v62, v103, s7, v62
    v_dot2_f32_bf16 v63, v103, v103, v63
    v_dot2_f32_bf16 v64, v105, s7, v64
    v_dot2_f32_bf16 v65, v105, v105, v65
    global_load_dwordx4 v[146:149], v67, s[38:39] offset:0 sc1
    s_waitcnt vmcnt(10)
    ds_write2_b64 v69, v[106:107], v[108:109] offset0:64 offset1:66
    v_dot2_f32_bf16 v62, v106, s7, v62
    v_dot2_f32_bf16 v63, v106, v106, v63
    v_dot2_f32_bf16 v64, v108, s7, v64
    v_dot2_f32_bf16 v65, v108, v108, v65
    v_dot2_f32_bf16 v62, v107, s7, v62
    v_dot2_f32_bf16 v63, v107, v107, v63
    v_dot2_f32_bf16 v64, v109, s7, v64
    v_dot2_f32_bf16 v65, v109, v109, v65
    global_load_dwordx4 v[150:153], v67, s[38:39] offset:1024 sc1
    s_waitcnt vmcnt(10)
    ds_write2_b64 v69, v[110:111], v[112:113] offset0:96 offset1:98
    v_bitop3_b32 v71, v109, v113, v71 bitop3:0x80
    v_dot2_f32_bf16 v62, v110, s7, v62
    v_dot2_f32_bf16 v63, v110, v110, v63
    v_dot2_f32_bf16 v64, v112, s7, v64
    v_dot2_f32_bf16 v65, v112, v112, v65
    v_dot2_f32_bf16 v62, v111, s7, v62
    v_dot2_f32_bf16 v63, v111, v111, v63
    v_dot2_f32_bf16 v64, v113, s7, v64
    v_dot2_f32_bf16 v65, v113, v113, v65
    global_load_dwordx4 v[154:157], v67, s[38:39] offset:2048 sc1
    v_add_u32 v69, 4160, v68
    s_waitcnt vmcnt(10)
    ds_write2_b64 v69, v[114:115], v[116:117] offset0:0 offset1:2
    v_dot2_f32_bf16 v62, v114, s7, v62
    v_dot2_f32_bf16 v63, v114, v114, v63
    v_dot2_f32_bf16 v64, v116, s7, v64
    v_dot2_f32_bf16 v65, v116, v116, v65
    v_dot2_f32_bf16 v62, v115, s7, v62
    v_dot2_f32_bf16 v63, v115, v115, v63
    v_dot2_f32_bf16 v64, v117, s7, v64
    v_dot2_f32_bf16 v65, v117, v117, v65
    global_load_dwordx4 v[158:161], v67, s[38:39] offset:3072 sc1
    v_add_u32 v67, 8192, v67
    s_waitcnt vmcnt(10)
    ds_write2_b64 v69, v[118:119], v[120:121] offset0:32 offset1:34
    v_bitop3_b32 v71, v117, v121, v71 bitop3:0x80
    v_dot2_f32_bf16 v62, v118, s7, v62
    v_dot2_f32_bf16 v63, v118, v118, v63
    v_dot2_f32_bf16 v64, v120, s7, v64
    v_dot2_f32_bf16 v65, v120, v120, v65
    v_dot2_f32_bf16 v62, v119, s7, v62
    v_dot2_f32_bf16 v63, v119, v119, v63
    v_dot2_f32_bf16 v64, v121, s7, v64
    v_dot2_f32_bf16 v65, v121, v121, v65
    global_load_dwordx4 v[162:165], v67, s[38:39] offset:-4096 sc1
    s_waitcnt vmcnt(10)
    ds_write2_b64 v69, v[122:123], v[124:125] offset0:64 offset1:66
    v_dot2_f32_bf16 v62, v122, s7, v62
    v_dot2_f32_bf16 v63, v122, v122, v63
    v_dot2_f32_bf16 v64, v124, s7, v64
    v_dot2_f32_bf16 v65, v124, v124, v65
    v_dot2_f32_bf16 v62, v123, s7, v62
    v_dot2_f32_bf16 v63, v123, v123, v63
    v_dot2_f32_bf16 v64, v125, s7, v64
    v_dot2_f32_bf16 v65, v125, v125, v65
    global_load_dwordx4 v[166:169], v67, s[38:39] offset:-3072 sc1
    s_waitcnt vmcnt(10)
    ds_write2_b64 v69, v[126:127], v[128:129] offset0:96 offset1:98
    v_bitop3_b32 v71, v125, v129, v71 bitop3:0x80
    v_dot2_f32_bf16 v62, v126, s7, v62
    v_dot2_f32_bf16 v63, v126, v126, v63
    v_dot2_f32_bf16 v64, v128, s7, v64
    v_dot2_f32_bf16 v65, v128, v128, v65
    v_dot2_f32_bf16 v62, v127, s7, v62
    v_dot2_f32_bf16 v63, v127, v127, v63
    v_dot2_f32_bf16 v64, v129, s7, v64
    v_dot2_f32_bf16 v65, v129, v129, v65
    global_load_dwordx4 v[170:173], v67, s[38:39] offset:-2048 sc1
    v_add_u32 v69, 8320, v68
    s_waitcnt vmcnt(10)
    ds_write2_b64 v69, v[130:131], v[132:133] offset0:0 offset1:2
    v_dot2_f32_bf16 v62, v130, s7, v62
    v_dot2_f32_bf16 v63, v130, v130, v63
    v_dot2_f32_bf16 v64, v132, s7, v64
    v_dot2_f32_bf16 v65, v132, v132, v65
    v_dot2_f32_bf16 v62, v131, s7, v62
    v_dot2_f32_bf16 v63, v131, v131, v63
    v_dot2_f32_bf16 v64, v133, s7, v64
    v_dot2_f32_bf16 v65, v133, v133, v65
    global_load_dwordx4 v[174:177], v67, s[38:39] offset:-1024 sc1
    s_waitcnt vmcnt(10)
    ds_write2_b64 v69, v[134:135], v[136:137] offset0:32 offset1:34
    v_bitop3_b32 v71, v133, v137, v71 bitop3:0x80
    v_dot2_f32_bf16 v62, v134, s7, v62
    v_dot2_f32_bf16 v63, v134, v134, v63
    v_dot2_f32_bf16 v64, v136, s7, v64
    v_dot2_f32_bf16 v65, v136, v136, v65
    v_dot2_f32_bf16 v62, v135, s7, v62
    v_dot2_f32_bf16 v63, v135, v135, v63
    v_dot2_f32_bf16 v64, v137, s7, v64
    v_dot2_f32_bf16 v65, v137, v137, v65
    global_load_dwordx4 a[96:99], v4, s[8:9] offset:-4096 sc1
    s_waitcnt vmcnt(10)
    ds_write2_b64 v69, v[138:139], v[140:141] offset0:64 offset1:66
    v_dot2_f32_bf16 v62, v138, s7, v62
    v_dot2_f32_bf16 v63, v138, v138, v63
    v_dot2_f32_bf16 v64, v140, s7, v64
    v_dot2_f32_bf16 v65, v140, v140, v65
    v_dot2_f32_bf16 v62, v139, s7, v62
    v_dot2_f32_bf16 v63, v139, v139, v63
    v_dot2_f32_bf16 v64, v141, s7, v64
    v_dot2_f32_bf16 v65, v141, v141, v65
    global_load_dwordx4 a[100:103], v7, s[14:15] offset:-4096 sc1
    s_waitcnt vmcnt(10)
    ds_write2_b64 v69, v[142:143], v[144:145] offset0:96 offset1:98
    v_bitop3_b32 v71, v141, v145, v71 bitop3:0x80
    v_dot2_f32_bf16 v62, v142, s7, v62
    v_dot2_f32_bf16 v63, v142, v142, v63
    v_dot2_f32_bf16 v64, v144, s7, v64
    v_dot2_f32_bf16 v65, v144, v144, v65
    v_dot2_f32_bf16 v62, v143, s7, v62
    v_dot2_f32_bf16 v63, v143, v143, v63
    v_dot2_f32_bf16 v64, v145, s7, v64
    v_dot2_f32_bf16 v65, v145, v145, v65
    global_load_dwordx4 a[104:107], v4, s[8:9] offset:-3072 sc1
    v_add_u32 v69, 12480, v68
    s_waitcnt vmcnt(10)
    ds_write2_b64 v69, v[146:147], v[148:149] offset0:0 offset1:2
    v_dot2_f32_bf16 v62, v146, s7, v62
    v_dot2_f32_bf16 v63, v146, v146, v63
    v_dot2_f32_bf16 v64, v148, s7, v64
    v_dot2_f32_bf16 v65, v148, v148, v65
    v_dot2_f32_bf16 v62, v147, s7, v62
    v_dot2_f32_bf16 v63, v147, v147, v63
    v_dot2_f32_bf16 v64, v149, s7, v64
    v_dot2_f32_bf16 v65, v149, v149, v65
    global_load_dwordx4 a[108:111], v7, s[14:15] offset:-3072 sc1
    s_waitcnt vmcnt(10)
    ds_write2_b64 v69, v[150:151], v[152:153] offset0:32 offset1:34
    v_bitop3_b32 v71, v149, v153, v71 bitop3:0x80
    v_dot2_f32_bf16 v62, v150, s7, v62
    v_dot2_f32_bf16 v63, v150, v150, v63
    v_dot2_f32_bf16 v64, v152, s7, v64
    v_dot2_f32_bf16 v65, v152, v152, v65
    v_dot2_f32_bf16 v62, v151, s7, v62
    v_dot2_f32_bf16 v63, v151, v151, v63
    v_dot2_f32_bf16 v64, v153, s7, v64
    v_dot2_f32_bf16 v65, v153, v153, v65
    global_load_dwordx4 a[112:115], v4, s[8:9] offset:-2048 sc1
    s_waitcnt vmcnt(10)
    ds_write2_b64 v69, v[154:155], v[156:157] offset0:64 offset1:66
    v_dot2_f32_bf16 v62, v154, s7, v62
    v_dot2_f32_bf16 v63, v154, v154, v63
    v_dot2_f32_bf16 v64, v156, s7, v64
    v_dot2_f32_bf16 v65, v156, v156, v65
    v_dot2_f32_bf16 v62, v155, s7, v62
    v_dot2_f32_bf16 v63, v155, v155, v63
    v_dot2_f32_bf16 v64, v157, s7, v64
    v_dot2_f32_bf16 v65, v157, v157, v65
    global_load_dwordx4 a[116:119], v7, s[14:15] offset:-2048 sc1
    s_waitcnt vmcnt(10)
    ds_write2_b64 v69, v[158:159], v[160:161] offset0:96 offset1:98
    v_bitop3_b32 v71, v157, v161, v71 bitop3:0x80
    v_dot2_f32_bf16 v62, v158, s7, v62
    v_dot2_f32_bf16 v63, v158, v158, v63
    v_dot2_f32_bf16 v64, v160, s7, v64
    v_dot2_f32_bf16 v65, v160, v160, v65
    v_dot2_f32_bf16 v62, v159, s7, v62
    v_dot2_f32_bf16 v63, v159, v159, v63
    v_dot2_f32_bf16 v64, v161, s7, v64
    v_dot2_f32_bf16 v65, v161, v161, v65
    global_load_dwordx4 a[120:123], v4, s[8:9] offset:-1024 sc1
    v_add_u32 v69, 16640, v68
    s_waitcnt vmcnt(10)
    ds_write2_b64 v69, v[162:163], v[164:165] offset0:0 offset1:2
    v_dot2_f32_bf16 v62, v162, s7, v62
    v_dot2_f32_bf16 v63, v162, v162, v63
    v_dot2_f32_bf16 v64, v164, s7, v64
    v_dot2_f32_bf16 v65, v164, v164, v65
    v_dot2_f32_bf16 v62, v163, s7, v62
    v_dot2_f32_bf16 v63, v163, v163, v63
    v_dot2_f32_bf16 v64, v165, s7, v64
    v_dot2_f32_bf16 v65, v165, v165, v65
    global_load_dwordx4 a[124:127], v7, s[14:15] offset:-1024 sc1
    s_waitcnt vmcnt(10)
    ds_write2_b64 v69, v[166:167], v[168:169] offset0:32 offset1:34
    v_bitop3_b32 v71, v165, v169, v71 bitop3:0x80
    v_dot2_f32_bf16 v62, v166, s7, v62
    v_dot2_f32_bf16 v63, v166, v166, v63
    v_dot2_f32_bf16 v64, v168, s7, v64
    v_dot2_f32_bf16 v65, v168, v168, v65
    v_dot2_f32_bf16 v62, v167, s7, v62
    v_dot2_f32_bf16 v63, v167, v167, v63
    v_dot2_f32_bf16 v64, v169, s7, v64
    v_dot2_f32_bf16 v65, v169, v169, v65
    s_waitcnt vmcnt(9)
    ds_write2_b64 v69, v[170:171], v[172:173] offset0:64 offset1:66
    v_dot2_f32_bf16 v62, v170, s7, v62
    v_dot2_f32_bf16 v63, v170, v170, v63
    v_dot2_f32_bf16 v64, v172, s7, v64
    v_dot2_f32_bf16 v65, v172, v172, v65
    v_dot2_f32_bf16 v62, v171, s7, v62
    v_dot2_f32_bf16 v63, v171, v171, v63
    v_dot2_f32_bf16 v64, v173, s7, v64
    v_dot2_f32_bf16 v65, v173, v173, v65
    s_waitcnt vmcnt(8)
    ds_write2_b64 v69, v[174:175], v[176:177] offset0:96 offset1:98
    v_bitop3_b32 v71, v173, v177, v71 bitop3:0x80
    v_dot2_f32_bf16 v62, v174, s7, v62
    v_dot2_f32_bf16 v63, v174, v174, v63
    v_dot2_f32_bf16 v64, v176, s7, v64
    v_dot2_f32_bf16 v65, v176, v176, v65
    v_dot2_f32_bf16 v62, v175, s7, v62
    v_dot2_f32_bf16 v63, v175, v175, v63
    v_dot2_f32_bf16 v64, v177, s7, v64
    v_dot2_f32_bf16 v65, v177, v177, v65
    v_and_b32 v71, 1, v71
    v_cmp_ne_u32 vcc, 1, v71
    s_cmp_ge_u32 s100, 262144
    s_cbranch_scc1 Lx_go
    s_cbranch_vccnz Lx_redo
Lx_go:
    v_add_f32_dpp v90, v62, v62 row_ror:8 row_mask:0xf bank_mask:0x3
    s_nop 1
    v_add_f32_dpp v90, v64, v64 row_ror:8 row_mask:0xf bank_mask:0xc
    v_add_f32_dpp v91, v63, v63 row_ror:8 row_mask:0xf bank_mask:0x3
    s_nop 1
    v_add_f32_dpp v91, v65, v65 row_ror:8 row_mask:0xf bank_mask:0xc
    s_add_u32 s4, s88, 148736
    v_lshl_add_u32 v28, v70, 3, s4
    ds_write_b64 v28, v[90:91]
    s_waitcnt lgkmcnt(0)
    s_barrier
    v_add_u32 v173, 41600, v4
    ds_read_b128 v[48:51], v173 offset:37440
    ds_read_b128 v[52:55], v173 offset:38480
    ds_read_b128 v[56:59], v173 offset:39520
    ds_read_b128 v[60:63], v173 offset:40560
    ds_read_b128 v[64:67], v173 offset:33280
    s_waitcnt lgkmcnt(3)
    v_mfma_f32_16x16x32_bf16 v[178:181], v[48:51], a[248:251], 0
    ds_read_b128 v[68:71], v173 offset:34320
    s_add_u32 m0, s89, 8192
    v_mfma_f32_16x16x32_bf16 v[194:197], v[48:51], a[252:255], 0
    v_mfma_f32_16x16x32_bf16 v[182:185], v[52:55], a[248:251], 0
    ds_read_b128 v[48:51], v173 offset:35360
    v_mfma_f32_16x16x32_bf16 v[198:201], v[52:55], a[252:255], 0
    s_waitcnt lgkmcnt(3)
    v_mfma_f32_16x16x32_bf16 v[186:189], v[56:59], a[248:251], 0
    ds_read_b128 v[52:55], v173 offset:36400
    v_add_u32 v28, 148736, v30
    v_mfma_f32_16x16x32_bf16 v[202:205], v[56:59], a[252:255], 0
    global_load_lds_dwordx4 v74, s[70:71] offset:0
    ds_read_b64 v[90:91], v28 offset:0
    v_mfma_f32_16x16x32_bf16 v[190:193], v[60:63], a[248:251], 0
    ds_read_b128 v[56:59], v173 offset:29120
    v_mfma_f32_16x16x32_bf16 v[206:209], v[60:63], a[252:255], 0
    ds_read_b64 v[92:93], v28 offset:512
    s_waitcnt lgkmcnt(4)
    v_mfma_f32_16x16x32_bf16 v[178:181], v[64:67], a[240:243], v[178:181]
    ds_read_b128 v[60:63], v173 offset:30160
    v_mfma_f32_16x16x32_bf16 v[194:197], v[64:67], a[244:247], v[194:197]
    ds_read_b64 v[94:95], v28 offset:1024
    v_mfma_f32_16x16x32_bf16 v[182:185], v[68:71], a[240:243], v[182:185]
    ds_read_b128 v[64:67], v173 offset:31200
    global_load_lds_dwordx4 v75, s[70:71] offset:1024
    v_mfma_f32_16x16x32_bf16 v[198:201], v[68:71], a[244:247], v[198:201]
    ds_read_b64 v[96:97], v28 offset:1536
    s_waitcnt lgkmcnt(5)
    v_mfma_f32_16x16x32_bf16 v[186:189], v[48:51], a[240:243], v[186:189]
    ds_read_b128 v[68:71], v173 offset:32240
    v_mfma_f32_16x16x32_bf16 v[202:205], v[48:51], a[244:247], v[202:205]
    s_add_u32 s4, s88, 150784
    v_mfma_f32_16x16x32_bf16 v[190:193], v[52:55], a[240:243], v[190:193]
    ds_read_b128 v[48:51], v173 offset:24960
    v_mfma_f32_16x16x32_bf16 v[206:209], v[52:55], a[244:247], v[206:209]
    v_lshl_add_u32 v170, v1, 2, s4
    s_waitcnt lgkmcnt(3)
    v_mfma_f32_16x16x32_bf16 v[178:181], v[56:59], a[232:235], v[178:181]
    ds_read_b128 v[52:55], v173 offset:26000
    global_load_lds_dwordx4 v76, s[70:71] offset:2048
    v_mfma_f32_16x16x32_bf16 v[194:197], v[56:59], a[236:239], v[194:197]
    v_lshl_add_u32 v171, v3, 5, s4
    v_mfma_f32_16x16x32_bf16 v[182:185], v[60:63], a[232:235], v[182:185]
    ds_read_b128 v[56:59], v173 offset:27040
    v_lshl_add_u32 v172, v5, 2, s4
    v_mfma_f32_16x16x32_bf16 v[198:201], v[60:63], a[236:239], v[198:201]
    s_waitcnt lgkmcnt(3)
    v_mfma_f32_16x16x32_bf16 v[186:189], v[64:67], a[232:235], v[186:189]
    ds_read_b128 v[60:63], v173 offset:28080
    v_add_f32 v90, v90, v92
    v_mfma_f32_16x16x32_bf16 v[202:205], v[64:67], a[236:239], v[202:205]
    global_load_lds_dwordx4 v77, s[70:71] offset:3072
    v_mfma_f32_16x16x32_bf16 v[190:193], v[68:71], a[232:235], v[190:193]
    ds_read_b128 v[64:67], v173 offset:20800
    v_add_f32 v91, v91, v93
    v_mfma_f32_16x16x32_bf16 v[206:209], v[68:71], a[236:239], v[206:209]
    s_waitcnt lgkmcnt(3)
    v_mfma_f32_16x16x32_bf16 v[178:181], v[48:51], a[224:227], v[178:181]
    ds_read_b128 v[68:71], v173 offset:21840
    v_add_f32 v94, v94, v96
    v_mfma_f32_16x16x32_bf16 v[194:197], v[48:51], a[228:231], v[194:197]
    v_mfma_f32_16x16x32_bf16 v[182:185], v[52:55], a[224:227], v[182:185]
    ds_read_b128 v[48:51], v173 offset:22880
    v_add_f32 v95, v95, v97
    s_add_u32 m0, s89, 12288
    v_mfma_f32_16x16x32_bf16 v[198:201], v[52:55], a[228:231], v[198:201]
    s_waitcnt lgkmcnt(3)
    v_mfma_f32_16x16x32_bf16 v[186:189], v[56:59], a[224:227], v[186:189]
    ds_read_b128 v[52:55], v173 offset:23920
    v_add_f32 v90, v90, v94
    v_mfma_f32_16x16x32_bf16 v[202:205], v[56:59], a[228:231], v[202:205]
    v_add_f32 v91, v91, v95
    v_mfma_f32_16x16x32_bf16 v[190:193], v[60:63], a[224:227], v[190:193]
    ds_read_b128 v[56:59], v173 offset:16640
    v_mfma_f32_16x16x32_bf16 v[206:209], v[60:63], a[228:231], v[206:209]
    v_mul_f32 v90, 0x3acccccd, v90
    s_waitcnt lgkmcnt(2)
    v_mfma_f32_16x16x32_bf16 v[178:181], v[64:67], a[216:219], v[178:181]
    ds_read_b128 v[60:63], v173 offset:17680
    global_load_lds_dwordx4 v78, s[70:71] offset:0
    v_mfma_f32_16x16x32_bf16 v[194:197], v[64:67], a[220:223], v[194:197]
    v_mul_f32 v91, 0x3acccccd, v91
    v_mfma_f32_16x16x32_bf16 v[182:185], v[68:71], a[216:219], v[182:185]
    ds_read_b128 v[64:67], v173 offset:18720
    v_mfma_f32_16x16x32_bf16 v[198:201], v[68:71], a[220:223], v[198:201]
    v_fma_f32 v91, -v90, v90, v91
    s_waitcnt lgkmcnt(2)
    v_mfma_f32_16x16x32_bf16 v[186:189], v[48:51], a[216:219], v[186:189]
    ds_read_b128 v[68:71], v173 offset:19760
    v_mfma_f32_16x16x32_bf16 v[202:205], v[48:51], a[220:223], v[202:205]
    v_max_f32 v91, 0, v91
    global_load_lds_dwordx4 v79, s[70:71] offset:1024
    v_mfma_f32_16x16x32_bf16 v[190:193], v[52:55], a[216:219], v[190:193]
    ds_read_b128 v[48:51], v173 offset:12480
    v_mfma_f32_16x16x32_bf16 v[206:209], v[52:55], a[220:223], v[206:209]
    v_add_f32 v91, 0x3727c5ac, v91
    s_waitcnt lgkmcnt(2)
    v_mfma_f32_16x16x32_bf16 v[178:181], v[56:59], a[208:211], v[178:181]
    ds_read_b128 v[52:55], v173 offset:13520
    v_mfma_f32_16x16x32_bf16 v[194:197], v[56:59], a[212:215], v[194:197]
    v_rsq_f32 v92, v91
    v_mfma_f32_16x16x32_bf16 v[182:185], v[60:63], a[208:211], v[182:185]
    ds_read_b128 v[56:59], v173 offset:14560
    global_load_lds_dwordx4 v80, s[70:71] offset:2048
    v_mfma_f32_16x16x32_bf16 v[198:201], v[60:63], a[212:215], v[198:201]
    s_waitcnt lgkmcnt(3)
    v_mfma_f32_16x16x32_bf16 v[186:189], v[64:67], a[208:211], v[186:189]
    ds_read_b128 v[60:63], v173 offset:15600
    v_mul_f32_e64 v91, -v90, v92
    v_mfma_f32_16x16x32_bf16 v[202:205], v[64:67], a[212:215], v[202:205]
    v_mfma_f32_16x16x32_bf16 v[190:193], v[68:71], a[208:211], v[190:193]
    ds_read_b128 v[64:67], v173 offset:8320
    v_mov_b32 v90, v92
    v_mfma_f32_16x16x32_bf16 v[206:209], v[68:71], a[212:215], v[206:209]
    s_waitcnt lgkmcnt(3)
    v_mfma_f32_16x16x32_bf16 v[178:181], v[48:51], a[200:203], v[178:181]
    ds_read_b128 v[68:71], v173 offset:9360
    global_load_lds_dwordx4 v81, s[70:71] offset:3072
    v_mfma_f32_16x16x32_bf16 v[194:197], v[48:51], a[204:207], v[194:197]
    ds_write2st64_b32 v170, v90, v91 offset0:0 offset1:1
    v_mfma_f32_16x16x32_bf16 v[182:185], v[52:55], a[200:203], v[182:185]
    ds_read_b128 v[48:51], v173 offset:10400
    ds_read_b128 v[98:101], v171 offset:0
    v_mfma_f32_16x16x32_bf16 v[198:201], v[52:55], a[204:207], v[198:201]
    s_waitcnt lgkmcnt(5)
    v_mfma_f32_16x16x32_bf16 v[186:189], v[56:59], a[200:203], v[186:189]
    ds_read_b128 v[52:55], v173 offset:11440
    ds_read_b128 v[102:105], v171 offset:16
    v_mfma_f32_16x16x32_bf16 v[202:205], v[56:59], a[204:207], v[202:205]
    global_load_dwordx4 a[0:3], v4, s[52:53] offset:-4096 sc1
    v_mfma_f32_16x16x32_bf16 v[190:193], v[60:63], a[200:203], v[190:193]
    ds_read_b128 v[56:59], v173 offset:4160
    ds_read_b128 v[106:109], v171 offset:128
    v_mfma_f32_16x16x32_bf16 v[206:209], v[60:63], a[204:207], v[206:209]
    ds_read_b128 v[110:113], v171 offset:144
    s_waitcnt lgkmcnt(6)
    v_mfma_f32_16x16x32_bf16 v[178:181], v[64:67], a[192:195], v[178:181]
    ds_read_b128 v[60:63], v173 offset:5200
    v_mfma_f32_16x16x32_bf16 v[194:197], v[64:67], a[196:199], v[194:197]
    ds_read_b128 v[114:117], v171 offset:256
    v_mfma_f32_16x16x32_bf16 v[182:185], v[68:71], a[192:195], v[182:185]
    ds_read_b128 v[64:67], v173 offset:6240
    global_load_dwordx4 a[4:7], v7, s[58:59] offset:-4096 sc1
    v_mfma_f32_16x16x32_bf16 v[198:201], v[68:71], a[196:199], v[198:201]
    ds_read_b128 v[118:121], v171 offset:272
    s_waitcnt lgkmcnt(6)
    v_mfma_f32_16x16x32_bf16 v[186:189], v[48:51], a[192:195], v[186:189]
    ds_read_b128 v[68:71], v173 offset:7280
    v_mfma_f32_16x16x32_bf16 v[202:205], v[48:51], a[196:199], v[202:205]
    ds_read_b128 v[122:125], v171 offset:384
    v_mfma_f32_16x16x32_bf16 v[190:193], v[52:55], a[192:195], v[190:193]
    ds_read_b128 v[48:51], v173 offset:0
    v_mfma_f32_16x16x32_bf16 v[206:209], v[52:55], a[196:199], v[206:209]
    ds_read_b128 v[126:129], v171 offset:400
    s_waitcnt lgkmcnt(5)
    v_mfma_f32_16x16x32_bf16 v[178:181], v[56:59], a[184:187], v[178:181]
    ds_read_b128 v[52:55], v173 offset:1040
    global_load_dwordx4 a[8:11], v4, s[52:53] offset:-3072 sc1
    v_mfma_f32_16x16x32_bf16 v[194:197], v[56:59], a[188:191], v[194:197]
    ds_read_b32 v162, v172 offset:0
    v_mfma_f32_16x16x32_bf16 v[182:185], v[60:63], a[184:187], v[182:185]
    ds_read_b128 v[56:59], v173 offset:2080
    v_mfma_f32_16x16x32_bf16 v[198:201], v[60:63], a[188:191], v[198:201]
    ds_read_b32 v163, v172 offset:256
    s_waitcnt lgkmcnt(5)
    v_mfma_f32_16x16x32_bf16 v[186:189], v[64:67], a[184:187], v[186:189]
    ds_read_b128 v[60:63], v173 offset:3120
    ds_read_b32 v164, v172 offset:16
    v_mfma_f32_16x16x32_bf16 v[202:205], v[64:67], a[188:191], v[202:205]
    global_load_dwordx4 a[12:15], v7, s[58:59] offset:-3072 sc1
    v_mfma_f32_16x16x32_bf16 v[190:193], v[68:71], a[184:187], v[190:193]
    ds_read_b128 v[64:67], v4 offset:37440
    ds_read_b32 v165, v172 offset:272
    v_mfma_f32_16x16x32_bf16 v[206:209], v[68:71], a[188:191], v[206:209]
    s_waitcnt lgkmcnt(6)
    v_mfma_f32_16x16x32_bf16 v[178:181], v[48:51], a[176:179], v[178:181]
    ds_read_b128 v[68:71], v4 offset:38480
    ds_read_b32 v166, v172 offset:128
    v_mfma_f32_16x16x32_bf16 v[194:197], v[48:51], a[180:183], v[194:197]
    v_mfma_f32_16x16x32_bf16 v[182:185], v[52:55], a[176:179], v[182:185]
    ds_read_b128 v[48:51], v4 offset:39520
    ds_read_b32 v167, v172 offset:384
    v_mfma_f32_16x16x32_bf16 v[198:201], v[52:55], a[180:183], v[198:201]
    global_load_dwordx4 a[16:19], v4, s[52:53] offset:-2048 sc1
    s_waitcnt lgkmcnt(5)
    v_mfma_f32_16x16x32_bf16 v[186:189], v[56:59], a[176:179], v[186:189]
    ds_read_b128 v[52:55], v4 offset:40560
    ds_read_b32 v168, v172 offset:144
    v_mfma_f32_16x16x32_bf16 v[202:205], v[56:59], a[180:183], v[202:205]
    v_mfma_f32_16x16x32_bf16 v[190:193], v[60:63], a[176:179], v[190:193]
    ds_read_b128 v[56:59], v4 offset:33280
    ds_read_b32 v169, v172 offset:400
    v_mfma_f32_16x16x32_bf16 v[206:209], v[60:63], a[180:183], v[206:209]
    s_waitcnt lgkmcnt(6)
    v_mfma_f32_16x16x32_bf16 v[178:181], v[64:67], a[168:171], v[178:181]
    ds_read_b128 v[60:63], v4 offset:34320
    s_add_u32 s4, s88, 156672
    global_load_dwordx4 a[20:23], v7, s[58:59] offset:-2048 sc1
    v_mfma_f32_16x16x32_bf16 v[194:197], v[64:67], a[172:175], v[194:197]
    v_lshl_add_u32 v28, v2, 2, s4
    v_mfma_f32_16x16x32_bf16 v[182:185], v[68:71], a[168:171], v[182:185]
    ds_read_b128 v[64:67], v4 offset:35360
    v_mfma_f32_16x16x32_bf16 v[198:201], v[68:71], a[172:175], v[198:201]
    ds_read2_b32 v[8:9], v28 offset0:0 offset1:16
    s_waitcnt lgkmcnt(4)
    v_mfma_f32_16x16x32_bf16 v[186:189], v[48:51], a[168:171], v[186:189]
    ds_read_b128 v[68:71], v4 offset:36400
    v_mfma_f32_16x16x32_bf16 v[202:205], v[48:51], a[172:175], v[202:205]
    global_load_dwordx4 a[24:27], v4, s[52:53] offset:-1024 sc1
    ds_read2_b32 v[10:11], v28 offset0:32 offset1:48
    v_mfma_f32_16x16x32_bf16 v[190:193], v[52:55], a[168:171], v[190:193]
    ds_read_b128 v[48:51], v4 offset:29120
    v_mfma_f32_16x16x32_bf16 v[206:209], v[52:55], a[172:175], v[206:209]
    v_lshl_add_u32 v28, v3, 4, s4
    s_waitcnt lgkmcnt(4)
    v_mfma_f32_16x16x32_bf16 v[178:181], v[56:59], a[160:163], v[178:181]
    ds_read_b128 v[52:55], v4 offset:30160
    v_mfma_f32_16x16x32_bf16 v[194:197], v[56:59], a[164:167], v[194:197]
    ds_read_b128 v[12:15], v28 offset:256
    v_mfma_f32_16x16x32_bf16 v[182:185], v[60:63], a[160:163], v[182:185]
    ds_read_b128 v[56:59], v4 offset:31200
    global_load_dwordx4 a[28:31], v7, s[58:59] offset:-1024 sc1
    v_mfma_f32_16x16x32_bf16 v[198:201], v[60:63], a[164:167], v[198:201]
    ds_read_b128 v[16:19], v28 offset:320
    s_waitcnt lgkmcnt(4)
    v_mfma_f32_16x16x32_bf16 v[186:189], v[64:67], a[160:163], v[186:189]
    ds_read_b128 v[60:63], v4 offset:32240
    ds_read_b128 v[20:23], v28 offset:384
    v_mfma_f32_16x16x32_bf16 v[202:205], v[64:67], a[164:167], v[202:205]
    v_mfma_f32_16x16x32_bf16 v[190:193], v[68:71], a[160:163], v[190:193]
    ds_read_b128 v[64:67], v4 offset:24960
    ds_read_b128 v[24:27], v28 offset:448
    v_mfma_f32_16x16x32_bf16 v[206:209], v[68:71], a[164:167], v[206:209]
    s_waitcnt lgkmcnt(6)
    v_mfma_f32_16x16x32_bf16 v[178:181], v[48:51], a[152:155], v[178:181]
    ds_read_b128 v[68:71], v4 offset:26000
    global_load_dwordx4 a[32:35], v4, s[52:53] offset:0 sc1
    v_mfma_f32_16x16x32_bf16 v[194:197], v[48:51], a[156:159], v[194:197]
    v_fma_f32 v130, v114, v8, v9
    v_mfma_f32_16x16x32_bf16 v[182:185], v[52:55], a[152:155], v[182:185]
    ds_read_b128 v[48:51], v4 offset:27040
    v_fma_f32 v131, v115, v8, v9
    v_mfma_f32_16x16x32_bf16 v[198:201], v[52:55], a[156:159], v[198:201]
    s_waitcnt lgkmcnt(4)
    v_mfma_f32_16x16x32_bf16 v[186:189], v[56:59], a[152:155], v[186:189]
    ds_read_b128 v[52:55], v4 offset:28080
    v_fma_f32 v132, v116, v8, v9
    v_mfma_f32_16x16x32_bf16 v[202:205], v[56:59], a[156:159], v[202:205]
    global_load_dwordx4 a[36:39], v7, s[58:59] offset:0 sc1
    v_mfma_f32_16x16x32_bf16 v[190:193], v[60:63], a[152:155], v[190:193]
    ds_read_b128 v[56:59], v4 offset:20800
    v_fma_f32 v133, v117, v8, v9
    v_mfma_f32_16x16x32_bf16 v[206:209], v[60:63], a[156:159], v[206:209]
    s_waitcnt lgkmcnt(3)
    v_mfma_f32_16x16x32_bf16 v[178:181], v[64:67], a[144:147], v[178:181]
    ds_read_b128 v[60:63], v4 offset:21840
    v_fma_f32 v134, v118, v8, v9
    v_mfma_f32_16x16x32_bf16 v[194:197], v[64:67], a[148:151], v[194:197]
    v_fma_f32 v135, v119, v8, v9
    v_mfma_f32_16x16x32_bf16 v[182:185], v[68:71], a[144:147], v[182:185]
    ds_read_b128 v[64:67], v4 offset:22880
    global_load_dwordx4 a[40:43], v4, s[52:53] offset:1024 sc1
    v_mfma_f32_16x16x32_bf16 v[198:201], v[68:71], a[148:151], v[198:201]
    v_fma_f32 v136, v120, v8, v9
    s_waitcnt lgkmcnt(2)
    v_mfma_f32_16x16x32_bf16 v[186:189], v[48:51], a[144:147], v[186:189]
    ds_read_b128 v[68:71], v4 offset:23920
    v_mfma_f32_16x16x32_bf16 v[202:205], v[48:51], a[148:151], v[202:205]
    v_fma_f32 v137, v121, v8, v9
    v_mfma_f32_16x16x32_bf16 v[190:193], v[52:55], a[144:147], v[190:193]
    ds_read_b128 v[48:51], v4 offset:16640
    v_mfma_f32_16x16x32_bf16 v[206:209], v[52:55], a[148:151], v[206:209]
    v_fma_f32 v138, v122, v8, v9
    s_waitcnt lgkmcnt(2)
    v_mfma_f32_16x16x32_bf16 v[178:181], v[56:59], a[136:139], v[178:181]
    ds_read_b128 v[52:55], v4 offset:17680
    global_load_dwordx4 a[44:47], v7, s[58:59] offset:1024 sc1
    v_mfma_f32_16x16x32_bf16 v[194:197], v[56:59], a[140:143], v[194:197]
    v_fma_f32 v139, v123, v8, v9
    v_mfma_f32_16x16x32_bf16 v[182:185], v[60:63], a[136:139], v[182:185]
    ds_read_b128 v[56:59], v4 offset:18720
    v_mfma_f32_16x16x32_bf16 v[198:201], v[60:63], a[140:143], v[198:201]
    v_fma_f32 v140, v124, v8, v9
    s_waitcnt lgkmcnt(2)
    v_mfma_f32_16x16x32_bf16 v[186:189], v[64:67], a[136:139], v[186:189]
    ds_read_b128 v[60:63], v4 offset:19760
    v_mfma_f32_16x16x32_bf16 v[202:205], v[64:67], a[140:143], v[202:205]
    v_fma_f32 v141, v125, v8, v9
    global_load_dwordx4 a[48:51], v4, s[52:53] offset:2048 sc1
    v_mfma_f32_16x16x32_bf16 v[190:193], v[68:71], a[136:139], v[190:193]
    ds_read_b128 v[64:67], v4 offset:0
    v_fma_f32 v142, v126, v8, v9
    v_mfma_f32_16x16x32_bf16 v[206:209], v[68:71], a[140:143], v[206:209]
    s_waitcnt lgkmcnt(3)
    v_mfma_f32_16x16x32_bf16 v[178:181], v[48:51], a[128:131], v[178:181]
    ds_read_b128 v[68:71], v4 offset:1040
    v_fma_f32 v143, v127, v8, v9
    v_mfma_f32_16x16x32_bf16 v[194:197], v[48:51], a[132:135], v[194:197]
    v_mfma_f32_16x16x32_bf16 v[182:185], v[52:55], a[128:131], v[182:185]
    ds_read_b128 v[48:51], v4 offset:2080
    v_fma_f32 v144, v128, v8, v9
    v_mfma_f32_16x16x32_bf16 v[198:201], v[52:55], a[132:135], v[198:201]
    global_load_dwordx4 a[52:55], v7, s[58:59] offset:2048 sc1
    s_waitcnt lgkmcnt(2)
    v_mfma_f32_16x16x32_bf16 v[186:189], v[56:59], a[128:131], v[186:189]
    ds_read_b128 v[52:55], v4 offset:3120
    v_fma_f32 v145, v129, v8, v9
    v_mfma_f32_16x16x32_bf16 v[202:205], v[56:59], a[132:135], v[202:205]
    v_mfma_f32_16x16x32_bf16 v[190:193], v[60:63], a[128:131], v[190:193]
    ds_read_b128 v[56:59], v4 offset:4160
    v_fma_f32 v146, v114, v10, v11
    v_mfma_f32_16x16x32_bf16 v[206:209], v[60:63], a[132:135], v[206:209]
    s_waitcnt lgkmcnt(3)
    s_waitcnt vmcnt(29)
    v_mfma_f32_16x16x32_bf16 v[178:181], v[64:67], a[96:99], v[178:181]
    ds_read_b128 v[60:63], v4 offset:5200
    global_load_dwordx4 a[56:59], v4, s[52:53] offset:3072 sc1
    s_waitcnt vmcnt(29)
    v_mfma_f32_16x16x32_bf16 v[194:197], v[64:67], a[100:103], v[194:197]
    v_fma_f32 v147, v115, v10, v11
    v_mfma_f32_16x16x32_bf16 v[182:185], v[68:71], a[96:99], v[182:185]
    ds_read_b128 v[64:67], v4 offset:6240
    v_fma_f32 v148, v116, v10, v11
    v_mfma_f32_16x16x32_bf16 v[198:201], v[68:71], a[100:103], v[198:201]
    v_fma_f32 v149, v117, v10, v11
    s_waitcnt lgkmcnt(2)
    v_mfma_f32_16x16x32_bf16 v[186:189], v[48:51], a[96:99], v[186:189]
    ds_read_b128 v[68:71], v4 offset:7280
    v_mfma_f32_16x16x32_bf16 v[202:205], v[48:51], a[100:103], v[202:205]
    global_load_dwordx4 a[60:63], v7, s[58:59] offset:3072 sc1
    v_fma_f32 v150, v118, v10, v11
    v_mfma_f32_16x16x32_bf16 v[190:193], v[52:55], a[96:99], v[190:193]
    ds_read_b128 v[48:51], v4 offset:8320
    v_mfma_f32_16x16x32_bf16 v[206:209], v[52:55], a[100:103], v[206:209]
    v_fma_f32 v151, v119, v10, v11
    s_waitcnt lgkmcnt(2)
    s_waitcnt vmcnt(29)
    v_mfma_f32_16x16x32_bf16 v[178:181], v[56:59], a[104:107], v[178:181]
    ds_read_b128 v[52:55], v4 offset:9360
    s_waitcnt vmcnt(28)
    v_mfma_f32_16x16x32_bf16 v[194:197], v[56:59], a[108:111], v[194:197]
    v_fma_f32 v152, v120, v10, v11
    v_mfma_f32_16x16x32_bf16 v[182:185], v[60:63], a[104:107], v[182:185]
    ds_read_b128 v[56:59], v4 offset:10400
    global_load_dwordx4 a[64:67], v4, s[54:55] offset:-4096 sc1
    v_mfma_f32_16x16x32_bf16 v[198:201], v[60:63], a[108:111], v[198:201]
    v_fma_f32 v153, v121, v10, v11
    s_waitcnt lgkmcnt(2)
    v_mfma_f32_16x16x32_bf16 v[186:189], v[64:67], a[104:107], v[186:189]
    ds_read_b128 v[60:63], v4 offset:11440
    v_mfma_f32_16x16x32_bf16 v[202:205], v[64:67], a[108:111], v[202:205]
    v_fma_f32 v154, v122, v10, v11
    v_mfma_f32_16x16x32_bf16 v[190:193], v[68:71], a[104:107], v[190:193]
    ds_read_b128 v[64:67], v4 offset:12480
    v_mfma_f32_16x16x32_bf16 v[206:209], v[68:71], a[108:111], v[206:209]
    v_fma_f32 v155, v123, v10, v11
    s_waitcnt lgkmcnt(2)
    s_waitcnt vmcnt(28)
    v_mfma_f32_16x16x32_bf16 v[178:181], v[48:51], a[112:115], v[178:181]
    ds_read_b128 v[68:71], v4 offset:13520
    global_load_dwordx4 a[68:71], v7, s[60:61] offset:-4096 sc1
    s_waitcnt vmcnt(28)
    v_mfma_f32_16x16x32_bf16 v[194:197], v[48:51], a[116:119], v[194:197]
    v_fma_f32 v156, v124, v10, v11
    v_mfma_f32_16x16x32_bf16 v[182:185], v[52:55], a[112:115], v[182:185]
    ds_read_b128 v[48:51], v4 offset:14560
    v_fma_f32 v157, v125, v10, v11
    v_mfma_f32_16x16x32_bf16 v[198:201], v[52:55], a[116:119], v[198:201]
    s_waitcnt lgkmcnt(3)
    v_mfma_f32_16x16x32_bf16 v[186:189], v[56:59], a[112:115], v[186:189]
    ds_read_b128 v[52:55], v4 offset:15600
    v_fma_f32 v158, v126, v10, v11
    v_mfma_f32_16x16x32_bf16 v[202:205], v[56:59], a[116:119], v[202:205]
    global_load_dwordx4 a[72:75], v4, s[54:55] offset:-3072 sc1
    v_mfma_f32_16x16x32_bf16 v[190:193], v[60:63], a[112:115], v[190:193]
    v_fma_f32 v159, v127, v10, v11
    v_mfma_f32_16x16x32_bf16 v[206:209], v[60:63], a[116:119], v[206:209]
    s_waitcnt lgkmcnt(2)
    s_waitcnt vmcnt(28)
    v_mfma_f32_16x16x32_bf16 v[178:181], v[64:67], a[120:123], v[178:181]
    v_fma_f32 v160, v128, v10, v11
    s_waitcnt vmcnt(27)
    v_mfma_f32_16x16x32_bf16 v[194:197], v[64:67], a[124:127], v[194:197]
    v_mfma_f32_16x16x32_bf16 v[182:185], v[68:71], a[120:123], v[182:185]
    v_fma_f32 v161, v129, v10, v11
    global_load_dwordx4 a[76:79], v7, s[60:61] offset:-3072 sc1
    v_mfma_f32_16x16x32_bf16 v[198:201], v[68:71], a[124:127], v[198:201]
    s_waitcnt lgkmcnt(0)
    v_mfma_f32_16x16x32_bf16 v[186:189], v[48:51], a[120:123], v[186:189]
    v_mfma_f32_16x16x32_bf16 v[202:205], v[48:51], a[124:127], v[202:205]
    v_mfma_f32_16x16x32_bf16 v[190:193], v[52:55], a[120:123], v[190:193]
    v_mfma_f32_16x16x32_bf16 v[206:209], v[52:55], a[124:127], v[206:209]
    s_nop 7
    s_cmp_eq_u32 s101, 2
    s_cbranch_scc1 Lz_keep
    v_mov_b32 v194, 0
    v_mov_b32 v195, 0
    v_mov_b32 v196, 0
    v_mov_b32 v197, 0
    v_mov_b32 v198, 0
    v_mov_b32 v199, 0
    v_mov_b32 v200, 0
    v_mov_b32 v201, 0
    v_mov_b32 v202, 0
    v_mov_b32 v203, 0
    v_mov_b32 v204, 0
    v_mov_b32 v205, 0
    v_mov_b32 v206, 0
    v_mov_b32 v207, 0
    v_mov_b32 v208, 0
    v_mov_b32 v209, 0
    s_cmp_eq_u32 s101, 1
    s_cbranch_scc1 Lz_keep
    v_mov_b32 v178, 0
    v_mov_b32 v179, 0
    v_mov_b32 v180, 0
    v_mov_b32 v181, 0
    v_mov_b32 v182, 0
    v_mov_b32 v183, 0
    v_mov_b32 v184, 0
    v_mov_b32 v185, 0
    v_mov_b32 v186, 0
    v_mov_b32 v187, 0
    v_mov_b32 v188, 0
    v_mov_b32 v189, 0
    v_mov_b32 v190, 0
    v_mov_b32 v191, 0
    v_mov_b32 v192, 0
    v_mov_b32 v193, 0
Lz_keep:
    global_load_dwordx4 a[80:83], v4, s[54:55] offset:-2048 sc1
    v_pk_fma_f32 v[178:179], v[178:179], v[98:99], v[130:131] op_sel:[0,0,0] op_sel_hi:[1,1,1]
    v_pk_fma_f32 v[180:181], v[180:181], v[100:101], v[132:133] op_sel:[0,0,0] op_sel_hi:[1,1,1]
    v_pk_fma_f32 v[182:183], v[182:183], v[102:103], v[134:135] op_sel:[0,0,0] op_sel_hi:[1,1,1]
    v_pk_fma_f32 v[184:185], v[184:185], v[104:105], v[136:137] op_sel:[0,0,0] op_sel_hi:[1,1,1]
    global_load_dwordx4 a[84:87], v7, s[60:61] offset:-2048 sc1
    v_pk_fma_f32 v[186:187], v[186:187], v[106:107], v[138:139] op_sel:[0,0,0] op_sel_hi:[1,1,1]
    v_pk_fma_f32 v[188:189], v[188:189], v[108:109], v[140:141] op_sel:[0,0,0] op_sel_hi:[1,1,1]
    v_pk_fma_f32 v[190:191], v[190:191], v[110:111], v[142:143] op_sel:[0,0,0] op_sel_hi:[1,1,1]
    v_pk_fma_f32 v[192:193], v[192:193], v[112:113], v[144:145] op_sel:[0,0,0] op_sel_hi:[1,1,1]
    global_load_dwordx4 a[88:91], v4, s[54:55] offset:-1024 sc1
    v_pk_fma_f32 v[194:195], v[194:195], v[98:99], v[146:147] op_sel:[0,0,0] op_sel_hi:[1,1,1]
    v_pk_fma_f32 v[196:197], v[196:197], v[100:101], v[148:149] op_sel:[0,0,0] op_sel_hi:[1,1,1]
    v_pk_fma_f32 v[198:199], v[198:199], v[102:103], v[150:151] op_sel:[0,0,0] op_sel_hi:[1,1,1]
    v_pk_fma_f32 v[200:201], v[200:201], v[104:105], v[152:153] op_sel:[0,0,0] op_sel_hi:[1,1,1]
    v_pk_fma_f32 v[202:203], v[202:203], v[106:107], v[154:155] op_sel:[0,0,0] op_sel_hi:[1,1,1]
    global_load_dwordx4 a[92:95], v7, s[60:61] offset:-1024 sc1
    v_pk_fma_f32 v[204:205], v[204:205], v[108:109], v[156:157] op_sel:[0,0,0] op_sel_hi:[1,1,1]
    v_pk_fma_f32 v[206:207], v[206:207], v[110:111], v[158:159] op_sel:[0,0,0] op_sel_hi:[1,1,1]
    v_pk_fma_f32 v[208:209], v[208:209], v[112:113], v[160:161] op_sel:[0,0,0] op_sel_hi:[1,1,1]
    v_pk_mul_f32 v[130:131], v[178:179], v[178:179] op_sel:[0,0] op_sel_hi:[1,1]
    global_load_dwordx4 a[96:99], v4, s[54:55] offset:0 sc1
    v_pk_mul_f32 v[132:133], v[180:181], v[180:181] op_sel:[0,0] op_sel_hi:[1,1]
    v_pk_mul_f32 v[134:135], v[182:183], v[182:183] op_sel:[0,0] op_sel_hi:[1,1]
    v_pk_mul_f32 v[136:137], v[184:185], v[184:185] op_sel:[0,0] op_sel_hi:[1,1]
    v_pk_mul_f32 v[138:139], v[186:187], v[186:187] op_sel:[0,0] op_sel_hi:[1,1]
    global_load_dwordx4 a[100:103], v7, s[60:61] offset:0 sc1
    v_pk_mul_f32 v[140:141], v[188:189], v[188:189] op_sel:[0,0] op_sel_hi:[1,1]
    v_pk_mul_f32 v[142:143], v[190:191], v[190:191] op_sel:[0,0] op_sel_hi:[1,1]
    v_pk_mul_f32 v[144:145], v[192:193], v[192:193] op_sel:[0,0] op_sel_hi:[1,1]
    v_pk_mul_f32 v[146:147], v[194:195], v[194:195] op_sel:[0,0] op_sel_hi:[1,1]
    v_pk_mul_f32 v[148:149], v[196:197], v[196:197] op_sel:[0,0] op_sel_hi:[1,1]
    global_load_dwordx4 a[104:107], v4, s[54:55] offset:1024 sc1
    v_pk_mul_f32 v[150:151], v[198:199], v[198:199] op_sel:[0,0] op_sel_hi:[1,1]
    v_pk_mul_f32 v[152:153], v[200:201], v[200:201] op_sel:[0,0] op_sel_hi:[1,1]
    v_pk_mul_f32 v[154:155], v[202:203], v[202:203] op_sel:[0,0] op_sel_hi:[1,1]
    v_pk_mul_f32 v[156:157], v[204:205], v[204:205] op_sel:[0,0] op_sel_hi:[1,1]
    global_load_dwordx4 a[108:111], v7, s[60:61] offset:1024 sc1
    v_pk_mul_f32 v[158:159], v[206:207], v[206:207] op_sel:[0,0] op_sel_hi:[1,1]
    v_pk_mul_f32 v[160:161], v[208:209], v[208:209] op_sel:[0,0] op_sel_hi:[1,1]
    v_pk_fma_f32 v[130:131], v[130:131], s[84:85], s[84:85] op_sel:[0,1,0] op_sel_hi:[1,1,0]
    v_pk_fma_f32 v[132:133], v[132:133], s[84:85], s[84:85] op_sel:[0,1,0] op_sel_hi:[1,1,0]
    global_load_dwordx4 a[112:115], v4, s[54:55] offset:2048 sc1
    v_pk_fma_f32 v[134:135], v[134:135], s[84:85], s[84:85] op_sel:[0,1,0] op_sel_hi:[1,1,0]
    v_pk_fma_f32 v[136:137], v[136:137], s[84:85], s[84:85] op_sel:[0,1,0] op_sel_hi:[1,1,0]
    v_pk_fma_f32 v[138:139], v[138:139], s[84:85], s[84:85] op_sel:[0,1,0] op_sel_hi:[1,1,0]
    v_pk_fma_f32 v[140:141], v[140:141], s[84:85], s[84:85] op_sel:[0,1,0] op_sel_hi:[1,1,0]
    v_pk_fma_f32 v[142:143], v[142:143], s[84:85], s[84:85] op_sel:[0,1,0] op_sel_hi:[1,1,0]
    global_load_dwordx4 a[116:119], v7, s[60:61] offset:2048 sc1
    v_pk_fma_f32 v[144:145], v[144:145], s[84:85], s[84:85] op_sel:[0,1,0] op_sel_hi:[1,1,0]
    v_pk_fma_f32 v[146:147], v[146:147], s[84:85], s[84:85] op_sel:[0,1,0] op_sel_hi:[1,1,0]
    v_pk_fma_f32 v[148:149], v[148:149], s[84:85], s[84:85] op_sel:[0,1,0] op_sel_hi:[1,1,0]
    v_pk_fma_f32 v[150:151], v[150:151], s[84:85], s[84:85] op_sel:[0,1,0] op_sel_hi:[1,1,0]
    global_load_dwordx4 a[120:123], v4, s[54:55] offset:3072 sc1
    v_pk_fma_f32 v[152:153], v[152:153], s[84:85], s[84:85] op_sel:[0,1,0] op_sel_hi:[1,1,0]
    v_pk_fma_f32 v[154:155], v[154:155], s[84:85], s[84:85] op_sel:[0,1,0] op_sel_hi:[1,1,0]
    v_pk_fma_f32 v[156:157], v[156:157], s[84:85], s[84:85] op_sel:[0,1,0] op_sel_hi:[1,1,0]
    v_pk_fma_f32 v[158:159], v[158:159], s[84:85], s[84:85] op_sel:[0,1,0] op_sel_hi:[1,1,0]
    global_load_dwordx4 a[124:127], v7, s[60:61] offset:3072 sc1
    v_pk_fma_f32 v[160:161], v[160:161], s[84:85], s[84:85] op_sel:[0,1,0] op_sel_hi:[1,1,0]
    v_pk_mul_f32 v[130:131], v[130:131], v[178:179] op_sel:[0,0] op_sel_hi:[1,1]
    v_pk_mul_f32 v[132:133], v[132:133], v[180:181] op_sel:[0,0] op_sel_hi:[1,1]
    v_pk_mul_f32 v[134:135], v[134:135], v[182:183] op_sel:[0,0] op_sel_hi:[1,1]
    v_pk_mul_f32 v[136:137], v[136:137], v[184:185] op_sel:[0,0] op_sel_hi:[1,1]
    global_load_dwordx4 a[128:131], v4, s[56:57] offset:-4096 sc1
    v_pk_mul_f32 v[138:139], v[138:139], v[186:187] op_sel:[0,0] op_sel_hi:[1,1]
    v_pk_mul_f32 v[140:141], v[140:141], v[188:189] op_sel:[0,0] op_sel_hi:[1,1]
    v_pk_mul_f32 v[142:143], v[142:143], v[190:191] op_sel:[0,0] op_sel_hi:[1,1]
    v_pk_mul_f32 v[144:145], v[144:145], v[192:193] op_sel:[0,0] op_sel_hi:[1,1]
    global_load_dwordx4 a[132:135], v7, s[62:63] offset:-4096 sc1
    v_pk_mul_f32 v[146:147], v[146:147], v[194:195] op_sel:[0,0] op_sel_hi:[1,1]
    v_pk_mul_f32 v[148:149], v[148:149], v[196:197] op_sel:[0,0] op_sel_hi:[1,1]
    v_pk_mul_f32 v[150:151], v[150:151], v[198:199] op_sel:[0,0] op_sel_hi:[1,1]
    v_pk_mul_f32 v[152:153], v[152:153], v[200:201] op_sel:[0,0] op_sel_hi:[1,1]
    global_load_dwordx4 a[136:139], v4, s[56:57] offset:-3072 sc1
    v_pk_mul_f32 v[154:155], v[154:155], v[202:203] op_sel:[0,0] op_sel_hi:[1,1]
    v_pk_mul_f32 v[156:157], v[156:157], v[204:205] op_sel:[0,0] op_sel_hi:[1,1]
    v_pk_mul_f32 v[158:159], v[158:159], v[206:207] op_sel:[0,0] op_sel_hi:[1,1]
    v_pk_mul_f32 v[160:161], v[160:161], v[208:209] op_sel:[0,0] op_sel_hi:[1,1]
    v_exp_f32 v130, v130
    global_load_dwordx4 a[140:143], v7, s[62:63] offset:-3072 sc1
    v_exp_f32 v131, v131
    v_exp_f32 v132, v132
    v_exp_f32 v133, v133
    v_exp_f32 v134, v134
    global_load_dwordx4 a[144:147], v4, s[56:57] offset:-2048 sc1
    v_exp_f32 v135, v135
    v_exp_f32 v136, v136
    v_exp_f32 v137, v137
    v_exp_f32 v138, v138
    global_load_dwordx4 a[148:151], v7, s[62:63] offset:-2048 sc1
    v_exp_f32 v139, v139
    v_exp_f32 v140, v140
    v_exp_f32 v141, v141
    v_exp_f32 v142, v142
    v_exp_f32 v143, v143
    global_load_dwordx4 a[152:155], v4, s[56:57] offset:-1024 sc1
    v_exp_f32 v144, v144
    v_exp_f32 v145, v145
    v_exp_f32 v146, v146
    v_exp_f32 v147, v147
    global_load_dwordx4 a[156:159], v7, s[62:63] offset:-1024 sc1
    v_exp_f32 v148, v148
    v_exp_f32 v149, v149
    v_exp_f32 v150, v150
    v_exp_f32 v151, v151
    ds_read_b128 a[224:227], v82 offset:0
    v_exp_f32 v152, v152
    v_exp_f32 v153, v153
    v_exp_f32 v154, v154
    v_exp_f32 v155, v155
    v_exp_f32 v156, v156
    ds_read_b128 a[228:231], v84 offset:0
    v_exp_f32 v157, v157
    v_exp_f32 v158, v158
    v_exp_f32 v159, v159
    v_exp_f32 v160, v160
    ds_read_b128 a[232:235], v86 offset:0
    v_exp_f32 v161, v161
    v_pk_add_f32 v[130:131], v[130:131], 1.0 op_sel:[0,0] op_sel_hi:[1,0]
    v_pk_add_f32 v[132:133], v[132:133], 1.0 op_sel:[0,0] op_sel_hi:[1,0]
    v_pk_add_f32 v[134:135], v[134:135], 1.0 op_sel:[0,0] op_sel_hi:[1,0]
    ds_read_b128 a[236:239], v88 offset:0
    v_pk_add_f32 v[136:137], v[136:137], 1.0 op_sel:[0,0] op_sel_hi:[1,0]
    v_pk_add_f32 v[138:139], v[138:139], 1.0 op_sel:[0,0] op_sel_hi:[1,0]
    v_pk_add_f32 v[140:141], v[140:141], 1.0 op_sel:[0,0] op_sel_hi:[1,0]
    v_pk_add_f32 v[142:143], v[142:143], 1.0 op_sel:[0,0] op_sel_hi:[1,0]
    v_pk_add_f32 v[144:145], v[144:145], 1.0 op_sel:[0,0] op_sel_hi:[1,0]
    ds_read_b128 a[240:243], v83 offset:0
    v_pk_add_f32 v[146:147], v[146:147], 1.0 op_sel:[0,0] op_sel_hi:[1,0]
    v_pk_add_f32 v[148:149], v[148:149], 1.0 op_sel:[0,0] op_sel_hi:[1,0]
    v_pk_add_f32 v[150:151], v[150:151], 1.0 op_sel:[0,0] op_sel_hi:[1,0]
    v_pk_add_f32 v[152:153], v[152:153], 1.0 op_sel:[0,0] op_sel_hi:[1,0]
    ds_read_b128 a[244:247], v85 offset:0
    v_pk_add_f32 v[154:155], v[154:155], 1.0 op_sel:[0,0] op_sel_hi:[1,0]
    v_pk_add_f32 v[156:157], v[156:157], 1.0 op_sel:[0,0] op_sel_hi:[1,0]
    v_pk_add_f32 v[158:159], v[158:159], 1.0 op_sel:[0,0] op_sel_hi:[1,0]
    v_pk_add_f32 v[160:161], v[160:161], 1.0 op_sel:[0,0] op_sel_hi:[1,0]
    v_rcp_f32 v130, v130
    ds_read_b128 a[248:251], v87 offset:0
    v_rcp_f32 v131, v131
    v_rcp_f32 v132, v132
    v_rcp_f32 v133, v133
    v_rcp_f32 v134, v134
    ds_read_b128 a[252:255], v89 offset:0
    v_rcp_f32 v135, v135
    v_rcp_f32 v136, v136
    v_rcp_f32 v137, v137
    v_rcp_f32 v138, v138
    s_waitcnt lgkmcnt(0)
    s_add_u32 m0, s89, 0
    s_nop 0
    global_load_lds_dwordx4 v74, s[72:73] offset:0
    v_rcp_f32 v139, v139
    v_rcp_f32 v140, v140
    v_rcp_f32 v141, v141
    v_rcp_f32 v142, v142
    v_rcp_f32 v143, v143
    global_load_lds_dwordx4 v75, s[72:73] offset:1024
    v_rcp_f32 v144, v144
    v_rcp_f32 v145, v145
    v_rcp_f32 v146, v146
    v_rcp_f32 v147, v147
    global_load_lds_dwordx4 v76, s[72:73] offset:2048
    v_rcp_f32 v148, v148
    v_rcp_f32 v149, v149
    v_rcp_f32 v150, v150
    v_rcp_f32 v151, v151
    global_load_lds_dwordx4 v77, s[72:73] offset:3072
    v_rcp_f32 v152, v152
    v_rcp_f32 v153, v153
    v_rcp_f32 v154, v154
    v_rcp_f32 v155, v155
    v_rcp_f32 v156, v156
    s_add_u32 m0, s89, 4096
    s_nop 0
    global_load_lds_dwordx4 v78, s[72:73] offset:0
    v_rcp_f32 v157, v157
    v_rcp_f32 v158, v158
    v_rcp_f32 v159, v159
    v_rcp_f32 v160, v160
    global_load_lds_dwordx4 v79, s[72:73] offset:1024
    v_rcp_f32 v161, v161
    v_pk_mul_f32 v[178:179], v[178:179], v[130:131] op_sel:[0,0] op_sel_hi:[1,1]
    v_pk_mul_f32 v[180:181], v[180:181], v[132:133] op_sel:[0,0] op_sel_hi:[1,1]
    v_pk_mul_f32 v[182:183], v[182:183], v[134:135] op_sel:[0,0] op_sel_hi:[1,1]
    global_load_lds_dwordx4 v80, s[72:73] offset:2048
    v_pk_mul_f32 v[184:185], v[184:185], v[136:137] op_sel:[0,0] op_sel_hi:[1,1]
    v_pk_mul_f32 v[186:187], v[186:187], v[138:139] op_sel:[0,0] op_sel_hi:[1,1]
    v_pk_mul_f32 v[188:189], v[188:189], v[140:141] op_sel:[0,0] op_sel_hi:[1,1]
    v_pk_mul_f32 v[190:191], v[190:191], v[142:143] op_sel:[0,0] op_sel_hi:[1,1]
    v_pk_mul_f32 v[192:193], v[192:193], v[144:145] op_sel:[0,0] op_sel_hi:[1,1]
    global_load_lds_dwordx4 v81, s[72:73] offset:3072
    v_pk_mul_f32 v[194:195], v[194:195], v[146:147] op_sel:[0,0] op_sel_hi:[1,1]
    v_pk_mul_f32 v[196:197], v[196:197], v[148:149] op_sel:[0,0] op_sel_hi:[1,1]
    v_pk_mul_f32 v[198:199], v[198:199], v[150:151] op_sel:[0,0] op_sel_hi:[1,1]
    v_pk_mul_f32 v[200:201], v[200:201], v[152:153] op_sel:[0,0] op_sel_hi:[1,1]
    s_waitcnt vmcnt(48)
    ds_read_b128 a[192:195], v82 offset:8192
    v_pk_mul_f32 v[202:203], v[202:203], v[154:155] op_sel:[0,0] op_sel_hi:[1,1]
    v_pk_mul_f32 v[204:205], v[204:205], v[156:157] op_sel:[0,0] op_sel_hi:[1,1]
    v_pk_mul_f32 v[206:207], v[206:207], v[158:159] op_sel:[0,0] op_sel_hi:[1,1]
    v_pk_mul_f32 v[208:209], v[208:209], v[160:161] op_sel:[0,0] op_sel_hi:[1,1]
    ds_read_b128 a[196:199], v84 offset:8192
    v_pk_add_f32 v[130:131], v[178:179], v[194:195] op_sel:[0,0] op_sel_hi:[1,1]
    v_pk_mul_f32 v[146:147], v[178:179], v[178:179] op_sel:[0,0] op_sel_hi:[1,1]
    v_pk_add_f32 v[132:133], v[180:181], v[196:197] op_sel:[0,0] op_sel_hi:[1,1]
    v_pk_mul_f32 v[148:149], v[180:181], v[180:181] op_sel:[0,0] op_sel_hi:[1,1]
    v_pk_add_f32 v[134:135], v[182:183], v[198:199] op_sel:[0,0] op_sel_hi:[1,1]
    ds_read_b128 a[200:203], v86 offset:8192
    v_pk_mul_f32 v[150:151], v[182:183], v[182:183] op_sel:[0,0] op_sel_hi:[1,1]
    v_pk_add_f32 v[136:137], v[184:185], v[200:201] op_sel:[0,0] op_sel_hi:[1,1]
    v_pk_mul_f32 v[152:153], v[184:185], v[184:185] op_sel:[0,0] op_sel_hi:[1,1]
    v_pk_add_f32 v[138:139], v[186:187], v[202:203] op_sel:[0,0] op_sel_hi:[1,1]
    ds_read_b128 a[204:207], v88 offset:8192
    v_pk_mul_f32 v[154:155], v[186:187], v[186:187] op_sel:[0,0] op_sel_hi:[1,1]
    v_pk_add_f32 v[140:141], v[188:189], v[204:205] op_sel:[0,0] op_sel_hi:[1,1]
    v_pk_mul_f32 v[156:157], v[188:189], v[188:189] op_sel:[0,0] op_sel_hi:[1,1]
    v_pk_add_f32 v[142:143], v[190:191], v[206:207] op_sel:[0,0] op_sel_hi:[1,1]
    ds_read_b128 a[208:211], v83 offset:8192
    v_pk_mul_f32 v[158:159], v[190:191], v[190:191] op_sel:[0,0] op_sel_hi:[1,1]
    v_pk_add_f32 v[144:145], v[192:193], v[208:209] op_sel:[0,0] op_sel_hi:[1,1]
    v_pk_mul_f32 v[160:161], v[192:193], v[192:193] op_sel:[0,0] op_sel_hi:[1,1]
    v_pk_fma_f32 v[146:147], v[194:195], v[194:195], v[146:147] op_sel:[0,0,0] op_sel_hi:[1,1,1]
    v_pk_fma_f32 v[148:149], v[196:197], v[196:197], v[148:149] op_sel:[0,0,0] op_sel_hi:[1,1,1]
    ds_read_b128 a[212:215], v85 offset:8192
    v_pk_fma_f32 v[150:151], v[198:199], v[198:199], v[150:151] op_sel:[0,0,0] op_sel_hi:[1,1,1]
    v_pk_fma_f32 v[152:153], v[200:201], v[200:201], v[152:153] op_sel:[0,0,0] op_sel_hi:[1,1,1]
    v_pk_fma_f32 v[154:155], v[202:203], v[202:203], v[154:155] op_sel:[0,0,0] op_sel_hi:[1,1,1]
    v_pk_fma_f32 v[156:157], v[204:205], v[204:205], v[156:157] op_sel:[0,0,0] op_sel_hi:[1,1,1]
    ds_read_b128 a[216:219], v87 offset:8192
    v_pk_fma_f32 v[158:159], v[206:207], v[206:207], v[158:159] op_sel:[0,0,0] op_sel_hi:[1,1,1]
    v_pk_fma_f32 v[160:161], v[208:209], v[208:209], v[160:161] op_sel:[0,0,0] op_sel_hi:[1,1,1]
    v_add_f32_dpp v98, v130, v130 row_ror:8 row_mask:0xf bank_mask:0x3
    v_add_f32_dpp v99, v131, v131 row_ror:8 row_mask:0xf bank_mask:0x3
    ds_read_b128 a[220:223], v89 offset:8192
    v_add_f32_dpp v100, v132, v132 row_ror:8 row_mask:0xf bank_mask:0x3
    v_add_f32_dpp v101, v133, v133 row_ror:8 row_mask:0xf bank_mask:0x3
    v_add_f32_dpp v102, v134, v134 row_ror:8 row_mask:0xf bank_mask:0x3
    v_add_f32_dpp v103, v135, v135 row_ror:8 row_mask:0xf bank_mask:0x3
    v_add_f32_dpp v104, v136, v136 row_ror:8 row_mask:0xf bank_mask:0x3
    s_waitcnt lgkmcnt(0)
    s_add_u32 m0, s89, 8192
    s_nop 0
    global_load_lds_dwordx4 v74, s[74:75] offset:0
    v_add_f32_dpp v105, v137, v137 row_ror:8 row_mask:0xf bank_mask:0x3
    v_add_f32_dpp v106, v138, v138 row_ror:8 row_mask:0xf bank_mask:0x3
    v_add_f32_dpp v107, v139, v139 row_ror:8 row_mask:0xf bank_mask:0x3
    v_add_f32_dpp v108, v140, v140 row_ror:8 row_mask:0xf bank_mask:0x3
    global_load_lds_dwordx4 v75, s[74:75] offset:1024
    v_add_f32_dpp v109, v141, v141 row_ror:8 row_mask:0xf bank_mask:0x3
    v_add_f32_dpp v110, v142, v142 row_ror:8 row_mask:0xf bank_mask:0x3
    v_add_f32_dpp v111, v143, v143 row_ror:8 row_mask:0xf bank_mask:0x3
    v_add_f32_dpp v112, v144, v144 row_ror:8 row_mask:0xf bank_mask:0x3
    global_load_lds_dwordx4 v76, s[74:75] offset:2048
    v_add_f32_dpp v113, v145, v145 row_ror:8 row_mask:0xf bank_mask:0x3
    v_add_f32_dpp v98, v146, v146 row_ror:8 row_mask:0xf bank_mask:0xc
    v_add_f32_dpp v99, v147, v147 row_ror:8 row_mask:0xf bank_mask:0xc
    v_add_f32_dpp v100, v148, v148 row_ror:8 row_mask:0xf bank_mask:0xc
    v_add_f32_dpp v101, v149, v149 row_ror:8 row_mask:0xf bank_mask:0xc
    global_load_lds_dwordx4 v77, s[74:75] offset:3072
    v_add_f32_dpp v102, v150, v150 row_ror:8 row_mask:0xf bank_mask:0xc
    v_add_f32_dpp v103, v151, v151 row_ror:8 row_mask:0xf bank_mask:0xc
    v_add_f32_dpp v104, v152, v152 row_ror:8 row_mask:0xf bank_mask:0xc
    v_add_f32_dpp v105, v153, v153 row_ror:8 row_mask:0xf bank_mask:0xc
    s_add_u32 m0, s89, 12288
    s_nop 0
    global_load_lds_dwordx4 v78, s[74:75] offset:0
    v_add_f32_dpp v106, v154, v154 row_ror:8 row_mask:0xf bank_mask:0xc
    v_add_f32_dpp v107, v155, v155 row_ror:8 row_mask:0xf bank_mask:0xc
    v_add_f32_dpp v108, v156, v156 row_ror:8 row_mask:0xf bank_mask:0xc
    v_add_f32_dpp v109, v157, v157 row_ror:8 row_mask:0xf bank_mask:0xc
    global_load_lds_dwordx4 v79, s[74:75] offset:1024
    v_add_f32_dpp v110, v158, v158 row_ror:8 row_mask:0xf bank_mask:0xc
    v_add_f32_dpp v111, v159, v159 row_ror:8 row_mask:0xf bank_mask:0xc
    v_add_f32_dpp v112, v160, v160 row_ror:8 row_mask:0xf bank_mask:0xc
    v_add_f32_dpp v113, v161, v161 row_ror:8 row_mask:0xf bank_mask:0xc
    v_add_f32_dpp v130, v98, v98 row_half_mirror row_mask:0xf bank_mask:0x5
    global_load_lds_dwordx4 v80, s[74:75] offset:2048
    v_add_f32_dpp v131, v99, v99 row_half_mirror row_mask:0xf bank_mask:0x5
    v_add_f32_dpp v132, v100, v100 row_half_mirror row_mask:0xf bank_mask:0x5
    v_add_f32_dpp v133, v101, v101 row_half_mirror row_mask:0xf bank_mask:0x5
    v_add_f32_dpp v134, v102, v102 row_half_mirror row_mask:0xf bank_mask:0x5
    global_load_lds_dwordx4 v81, s[74:75] offset:3072
    v_add_f32_dpp v135, v103, v103 row_half_mirror row_mask:0xf bank_mask:0x5
    v_add_f32_dpp v136, v104, v104 row_half_mirror row_mask:0xf bank_mask:0x5
    v_add_f32_dpp v137, v105, v105 row_half_mirror row_mask:0xf bank_mask:0x5
    v_add_f32_dpp v130, v106, v106 row_half_mirror row_mask:0xf bank_mask:0xa
    v_add_f32_dpp v131, v107, v107 row_half_mirror row_mask:0xf bank_mask:0xa
    v_add_f32_dpp v132, v108, v108 row_half_mirror row_mask:0xf bank_mask:0xa
    v_add_f32_dpp v133, v109, v109 row_half_mirror row_mask:0xf bank_mask:0xa
    v_add_f32_dpp v134, v110, v110 row_half_mirror row_mask:0xf bank_mask:0xa
    v_add_f32_dpp v135, v111, v111 row_half_mirror row_mask:0xf bank_mask:0xa
    v_add_f32_dpp v136, v112, v112 row_half_mirror row_mask:0xf bank_mask:0xa
    v_add_f32_dpp v137, v113, v113 row_half_mirror row_mask:0xf bank_mask:0xa
    v_add_f32_dpp v130, v130, v130 quad_perm:[1,0,3,2] row_mask:0xf bank_mask:0xf
    v_add_f32_dpp v131, v131, v131 quad_perm:[1,0,3,2] row_mask:0xf bank_mask:0xf
    v_add_f32_dpp v132, v132, v132 quad_perm:[1,0,3,2] row_mask:0xf bank_mask:0xf
    v_add_f32_dpp v133, v133, v133 quad_perm:[1,0,3,2] row_mask:0xf bank_mask:0xf
    v_add_f32_dpp v134, v134, v134 quad_perm:[1,0,3,2] row_mask:0xf bank_mask:0xf
    v_add_f32_dpp v135, v135, v135 quad_perm:[1,0,3,2] row_mask:0xf bank_mask:0xf
    v_add_f32_dpp v136, v136, v136 quad_perm:[1,0,3,2] row_mask:0xf bank_mask:0xf
    v_add_f32_dpp v137, v137, v137 quad_perm:[1,0,3,2] row_mask:0xf bank_mask:0xf
    v_add_f32_dpp v130, v130, v130 quad_perm:[2,3,0,1] row_mask:0xf bank_mask:0xf
    v_add_f32_dpp v131, v131, v131 quad_perm:[2,3,0,1] row_mask:0xf bank_mask:0xf
    v_add_f32_dpp v132, v132, v132 quad_perm:[2,3,0,1] row_mask:0xf bank_mask:0xf
    v_add_f32_dpp v133, v133, v133 quad_perm:[2,3,0,1] row_mask:0xf bank_mask:0xf
    v_add_f32_dpp v134, v134, v134 quad_perm:[2,3,0,1] row_mask:0xf bank_mask:0xf
    v_add_f32_dpp v135, v135, v135 quad_perm:[2,3,0,1] row_mask:0xf bank_mask:0xf
    v_add_f32_dpp v136, v136, v136 quad_perm:[2,3,0,1] row_mask:0xf bank_mask:0xf
    v_add_f32_dpp v137, v137, v137 quad_perm:[2,3,0,1] row_mask:0xf bank_mask:0xf
    v_lshrrev_b32 v28, 2, v2
    v_lshl_add_u32 v28, v28, 7, v171
    ds_write_b128 v28, v[130:133]
    ds_write_b128 v28, v[134:137] offset:16
    s_waitcnt lgkmcnt(0)
    s_barrier
    v_lshlrev_b32 v28, 2, v1
    v_add_u32 v28, 150784, v28
    ds_read2st64_b32 v[90:91], v28 offset0:0 offset1:1
    ds_read2st64_b32 v[92:93], v28 offset0:2 offset1:3
    ds_read2st64_b32 v[94:95], v28 offset0:4 offset1:5
    ds_read2st64_b32 v[96:97], v28 offset0:6 offset1:7
    s_lshl_b32 s4, s40, 12
    s_add_u32 s4, s4, 12451840
    v_add_u32 v174, s4, v30
    s_lshl_b32 s4, s41, 9
    v_add_u32 v28, s4, v174
    v_subrev_u32 v170, 2048, v170
    v_subrev_u32 v171, 2048, v171
    s_waitcnt lgkmcnt(2)
    v_pk_add_f32 v[90:91], v[90:91], v[92:93] op_sel:[0,0] op_sel_hi:[1,1]
    s_waitcnt lgkmcnt(0)
    v_pk_add_f32 v[94:95], v[94:95], v[96:97] op_sel:[0,0] op_sel_hi:[1,1]
    v_pk_add_f32 v[90:91], v[90:91], v[94:95] op_sel:[0,0] op_sel_hi:[1,1]
    v_min_u32 v90, -2, v90
    v_min_u32 v91, -2, v91
    s_lshl_b32 s4, s3, 4
    s_lshl_b64 exec, 0xffff, s4
    global_store_dwordx2 v28, v[90:91], s[38:39] sc1
    s_mov_b64 exec, -1
    ds_read_b128 v[48:51], v4 offset:0
    ds_read_b128 v[52:55], v4 offset:1040
    ds_read_b128 v[56:59], v4 offset:2080
    ds_read_b128 v[60:63], v4 offset:3120
    ds_read_b128 v[64:67], v4 offset:4160
    s_waitcnt lgkmcnt(3)
    s_waitcnt vmcnt(56)
    v_mfma_f32_16x16x32_bf16 v[210:213], a[0:3], v[48:51], 0
    ds_read_b128 v[68:71], v4 offset:5200
    s_waitcnt vmcnt(55)
    v_mfma_f32_16x16x32_bf16 v[226:229], a[4:7], v[48:51], 0
    v_mfma_f32_16x16x32_bf16 v[214:217], a[0:3], v[52:55], 0
    ds_read_b128 v[48:51], v4 offset:6240
    s_waitcnt vmcnt(9)
    ds_read_b128 a[160:163], v82 offset:0
    v_mfma_f32_16x16x32_bf16 v[230:233], a[4:7], v[52:55], 0
    v_min_u32 v175, 26, v1
    s_waitcnt lgkmcnt(4)
    v_mfma_f32_16x16x32_bf16 v[218:221], a[0:3], v[56:59], 0
    ds_read_b128 v[52:55], v4 offset:7280
    v_lshlrev_b32 v175, 7, v175
    v_mfma_f32_16x16x32_bf16 v[234:237], a[4:7], v[56:59], 0
    ds_read_b128 a[164:167], v84 offset:0
    v_mfma_f32_16x16x32_bf16 v[222:225], a[0:3], v[60:63], 0
    ds_read_b128 v[56:59], v4 offset:8320
    v_add_u32 v175, 98304, v175
    v_mfma_f32_16x16x32_bf16 v[238:241], a[4:7], v[60:63], 0
    ds_read_b128 a[168:171], v86 offset:0
    s_waitcnt lgkmcnt(5)
    v_mfma_f32_16x16x32_bf16 v[210:213], a[8:11], v[64:67], v[210:213]
    ds_read_b128 v[60:63], v4 offset:9360
    ds_read_b128 a[172:175], v88 offset:0
    v_mfma_f32_16x16x32_bf16 v[226:229], a[12:15], v[64:67], v[226:229]
    global_load_dword v250, v175, s[38:39] sc1
    v_mfma_f32_16x16x32_bf16 v[214:217], a[8:11], v[68:71], v[214:217]
    ds_read_b128 v[64:67], v4 offset:10400
    ds_read_b128 a[176:179], v83 offset:0
    s_mul_i32 s7, s41, 320
    v_mfma_f32_16x16x32_bf16 v[230:233], a[12:15], v[68:71], v[230:233]
    ds_read_b128 a[180:183], v85 offset:0
    s_waitcnt lgkmcnt(6)
    v_mfma_f32_16x16x32_bf16 v[218:221], a[8:11], v[48:51], v[218:221]
    ds_read_b128 v[68:71], v4 offset:11440
    s_add_u32 s7, s7, 12800
    v_mfma_f32_16x16x32_bf16 v[234:237], a[12:15], v[48:51], v[234:237]
    ds_read_b128 a[184:187], v87 offset:0
    v_mfma_f32_16x16x32_bf16 v[222:225], a[8:11], v[52:55], v[222:225]
    ds_read_b128 v[48:51], v4 offset:12480
    v_min_u32 v175, 304, v4
    v_mfma_f32_16x16x32_bf16 v[238:241], a[12:15], v[52:55], v[238:241]
    ds_read_b128 a[188:191], v89 offset:0
    s_waitcnt lgkmcnt(6)
    v_mfma_f32_16x16x32_bf16 v[210:213], a[16:19], v[56:59], v[210:213]
    ds_read_b128 v[52:55], v4 offset:13520
    s_waitcnt lgkmcnt(1)
    s_add_u32 m0, s89, 0
    v_mfma_f32_16x16x32_bf16 v[226:229], a[20:23], v[56:59], v[226:229]
    v_add_u32 v175, s7, v175
    v_mfma_f32_16x16x32_bf16 v[214:217], a[16:19], v[60:63], v[214:217]
    ds_read_b128 v[56:59], v4 offset:14560
    global_load_dwordx4 v[242:245], v175, s[38:39] sc1
    v_mfma_f32_16x16x32_bf16 v[230:233], a[20:23], v[60:63], v[230:233]
    global_load_lds_dwordx4 v74, s[76:77] offset:0
    v_mfma_f32_16x16x32_bf16 v[218:221], a[16:19], v[64:67], v[218:221]
    ds_read_b128 v[60:63], v4 offset:15600
    v_add_u32 v175, 15360, v175
    v_mfma_f32_16x16x32_bf16 v[234:237], a[20:23], v[64:67], v[234:237]
    global_load_lds_dwordx4 v75, s[76:77] offset:1024
    v_mfma_f32_16x16x32_bf16 v[222:225], a[16:19], v[68:71], v[222:225]
    ds_read_b128 v[64:67], v4 offset:16640
    global_load_lds_dwordx4 v76, s[76:77] offset:2048
    v_mfma_f32_16x16x32_bf16 v[238:241], a[20:23], v[68:71], v[238:241]
    global_load_dwordx4 v[246:249], v175, s[38:39] sc1
    s_waitcnt lgkmcnt(2)
    v_mfma_f32_16x16x32_bf16 v[210:213], a[24:27], v[48:51], v[210:213]
    ds_read_b128 v[68:71], v4 offset:17680
    global_load_lds_dwordx4 v77, s[76:77] offset:3072
    v_mfma_f32_16x16x32_bf16 v[226:229], a[28:31], v[48:51], v[226:229]
    ds_read_b128 v[36:39], v46 offset:0
    v_mfma_f32_16x16x32_bf16 v[214:217], a[24:27], v[52:55], v[214:217]
    ds_read_b128 v[48:51], v4 offset:18720
    s_add_u32 m0, s89, 4096
    ds_read_b128 v[40:43], v46 offset:4160
    v_mfma_f32_16x16x32_bf16 v[230:233], a[28:31], v[52:55], v[230:233]
    global_load_lds_dwordx4 v78, s[76:77] offset:0
    s_waitcnt lgkmcnt(4)
    v_mfma_f32_16x16x32_bf16 v[218:221], a[24:27], v[56:59], v[218:221]
    ds_read_b128 v[52:55], v4 offset:19760
    ds_read_b64 v[44:45], v47 offset:8320
    v_mfma_f32_16x16x32_bf16 v[234:237], a[28:31], v[56:59], v[234:237]
    global_load_lds_dwordx4 v79, s[76:77] offset:1024
    v_mfma_f32_16x16x32_bf16 v[222:225], a[24:27], v[60:63], v[222:225]
    ds_read_b128 v[56:59], v4 offset:20800
    global_load_lds_dwordx4 v80, s[76:77] offset:2048
    v_mfma_f32_16x16x32_bf16 v[238:241], a[28:31], v[60:63], v[238:241]
    s_waitcnt vmcnt(8)
    v_max3_u32 v28, v242, v243, v244
    s_waitcnt lgkmcnt(4)
    v_mfma_f32_16x16x32_bf16 v[210:213], a[32:35], v[64:67], v[210:213]
    ds_read_b128 v[60:63], v4 offset:21840
    global_load_lds_dwordx4 v81, s[76:77] offset:3072
    v_mfma_f32_16x16x32_bf16 v[226:229], a[36:39], v[64:67], v[226:229]
    s_waitcnt vmcnt(5)
    v_max3_u32 v28, v245, v246, v28
    v_mfma_f32_16x16x32_bf16 v[214:217], a[32:35], v[68:71], v[214:217]
    ds_read_b128 v[64:67], v4 offset:22880
    ds_read_b128 a[0:3], v82 offset:8192
    v_mfma_f32_16x16x32_bf16 v[230:233], a[36:39], v[68:71], v[230:233]
    v_max3_u32 v28, v247, v248, v28
    s_waitcnt lgkmcnt(3)
    v_mfma_f32_16x16x32_bf16 v[218:221], a[32:35], v[48:51], v[218:221]
    ds_read_b128 v[68:71], v4 offset:23920
    v_max3_u32 v28, v249, v250, v28
    v_mfma_f32_16x16x32_bf16 v[234:237], a[36:39], v[48:51], v[234:237]
    ds_read_b128 a[4:7], v84 offset:8192
    v_mfma_f32_16x16x32_bf16 v[222:225], a[32:35], v[52:55], v[222:225]
    ds_read_b128 v[48:51], v4 offset:24960
    ds_read_b128 a[8:11], v86 offset:8192
    v_mfma_f32_16x16x32_bf16 v[238:241], a[36:39], v[52:55], v[238:241]
    v_cmp_eq_u32 vcc, -1, v28
    s_waitcnt lgkmcnt(5)
    v_mfma_f32_16x16x32_bf16 v[210:213], a[40:43], v[56:59], v[210:213]
    ds_read_b128 v[52:55], v4 offset:26000
    ds_read_b128 a[12:15], v88 offset:8192
    v_mfma_f32_16x16x32_bf16 v[226:229], a[44:47], v[56:59], v[226:229]
    s_cbranch_vccnz Lgb_r
Lgb_ok:
    v_mfma_f32_16x16x32_bf16 v[214:217], a[40:43], v[60:63], v[214:217]
    ds_read_b128 v[56:59], v4 offset:27040
    ds_read_b128 a[16:19], v83 offset:8192
    v_mfma_f32_16x16x32_bf16 v[230:233], a[44:47], v[60:63], v[230:233]
    ds_read_b128 a[20:23], v85 offset:8192
    v_add_f32 v242, v242, v246
    s_waitcnt lgkmcnt(5)
    v_mfma_f32_16x16x32_bf16 v[218:221], a[40:43], v[64:67], v[218:221]
    ds_read_b128 v[60:63], v4 offset:28080
    v_mfma_f32_16x16x32_bf16 v[234:237], a[44:47], v[64:67], v[234:237]
    ds_read_b128 a[24:27], v87 offset:8192
    v_add_f32 v243, v243, v247
    v_mfma_f32_16x16x32_bf16 v[222:225], a[40:43], v[68:71], v[222:225]
    ds_read_b128 v[64:67], v4 offset:29120
    ds_read_b128 a[28:31], v89 offset:8192
    v_mfma_f32_16x16x32_bf16 v[238:241], a[44:47], v[68:71], v[238:241]
    v_add_f32 v244, v244, v248
    s_waitcnt lgkmcnt(6)
    v_mfma_f32_16x16x32_bf16 v[210:213], a[48:51], v[48:51], v[210:213]
    ds_read_b128 v[68:71], v4 offset:30160
    s_waitcnt lgkmcnt(1)
    s_add_u32 m0, s89, 8192
    v_mfma_f32_16x16x32_bf16 v[226:229], a[52:55], v[48:51], v[226:229]
    v_add_f32 v245, v245, v249
    v_mfma_f32_16x16x32_bf16 v[214:217], a[48:51], v[52:55], v[214:217]
    ds_read_b128 v[48:51], v4 offset:31200
    v_mfma_f32_16x16x32_bf16 v[230:233], a[52:55], v[52:55], v[230:233]
    global_load_lds_dwordx4 v74, s[78:79] offset:0
    v_cvt_pk_bf16_f32 v242, v242, v242
    v_mfma_f32_16x16x32_bf16 v[218:221], a[48:51], v[56:59], v[218:221]
    ds_read_b128 v[52:55], v4 offset:32240
    v_mfma_f32_16x16x32_bf16 v[234:237], a[52:55], v[56:59], v[234:237]
    global_load_lds_dwordx4 v75, s[78:79] offset:1024
    v_lshlrev_b32 v242, 16, v242
    v_mfma_f32_16x16x32_bf16 v[222:225], a[48:51], v[60:63], v[222:225]
    ds_read_b128 v[56:59], v4 offset:33280
    global_load_lds_dwordx4 v76, s[78:79] offset:2048
    v_mfma_f32_16x16x32_bf16 v[238:241], a[52:55], v[60:63], v[238:241]
    v_cvt_pk_bf16_f32 v243, v243, v243
    s_waitcnt lgkmcnt(2)
    v_mfma_f32_16x16x32_bf16 v[210:213], a[56:59], v[64:67], v[210:213]
    ds_read_b128 v[60:63], v4 offset:34320
    global_load_lds_dwordx4 v77, s[78:79] offset:3072
    v_mfma_f32_16x16x32_bf16 v[226:229], a[60:63], v[64:67], v[226:229]
    v_lshlrev_b32 v243, 16, v243
    v_mfma_f32_16x16x32_bf16 v[214:217], a[56:59], v[68:71], v[214:217]
    ds_read_b128 v[64:67], v4 offset:35360
    s_add_u32 m0, s89, 12288
    v_mfma_f32_16x16x32_bf16 v[230:233], a[60:63], v[68:71], v[230:233]
    global_load_lds_dwordx4 v78, s[78:79] offset:0
    v_cvt_pk_bf16_f32 v244, v244, v244
    s_waitcnt lgkmcnt(2)
    v_mfma_f32_16x16x32_bf16 v[218:221], a[56:59], v[48:51], v[218:221]
    ds_read_b128 v[68:71], v4 offset:36400
    v_mfma_f32_16x16x32_bf16 v[234:237], a[60:63], v[48:51], v[234:237]
    global_load_lds_dwordx4 v79, s[78:79] offset:1024
    v_lshlrev_b32 v244, 16, v244
    v_mfma_f32_16x16x32_bf16 v[222:225], a[56:59], v[52:55], v[222:225]
    ds_read_b128 v[48:51], v4 offset:37440
    global_load_lds_dwordx4 v80, s[78:79] offset:2048
    v_mfma_f32_16x16x32_bf16 v[238:241], a[60:63], v[52:55], v[238:241]
    v_cvt_pk_bf16_f32 v245, v245, v245
    s_waitcnt lgkmcnt(2)
    v_mfma_f32_16x16x32_bf16 v[210:213], a[64:67], v[56:59], v[210:213]
    ds_read_b128 v[52:55], v4 offset:38480
    global_load_lds_dwordx4 v81, s[78:79] offset:3072
    v_mfma_f32_16x16x32_bf16 v[226:229], a[68:71], v[56:59], v[226:229]
    v_lshlrev_b32 v245, 16, v245
    v_mfma_f32_16x16x32_bf16 v[214:217], a[64:67], v[60:63], v[214:217]
    ds_read_b128 v[56:59], v4 offset:39520
    s_waitcnt vmcnt(8)
    ds_read_b128 a[32:35], v82 offset:0
    v_mfma_f32_16x16x32_bf16 v[230:233], a[68:71], v[60:63], v[230:233]
    v_min_u32 v175, 304, v4
    s_waitcnt lgkmcnt(3)
    v_mfma_f32_16x16x32_bf16 v[218:221], a[64:67], v[64:67], v[218:221]
    ds_read_b128 v[60:63], v4 offset:40560
    v_mfma_f32_16x16x32_bf16 v[234:237], a[68:71], v[64:67], v[234:237]
    ds_read_b128 a[36:39], v84 offset:0
    v_add_u32 v175, 162816, v175
    v_mfma_f32_16x16x32_bf16 v[222:225], a[64:67], v[68:71], v[222:225]
    ds_read_b128 v[64:67], v173 offset:0
    ds_read_b128 a[40:43], v86 offset:0
    v_mfma_f32_16x16x32_bf16 v[238:241], a[68:71], v[68:71], v[238:241]
    s_waitcnt lgkmcnt(6)
    v_mfma_f32_16x16x32_bf16 v[210:213], a[72:75], v[48:51], v[210:213]
    ds_read_b128 v[68:71], v173 offset:1040
    ds_read_b128 a[44:47], v88 offset:0
    v_mfma_f32_16x16x32_bf16 v[226:229], a[76:79], v[48:51], v[226:229]
    ds_write_b128 v175, v[242:245]
    v_mfma_f32_16x16x32_bf16 v[214:217], a[72:75], v[52:55], v[214:217]
    ds_read_b128 v[48:51], v173 offset:2080
    ds_read_b128 a[48:51], v83 offset:0
    v_mfma_f32_16x16x32_bf16 v[230:233], a[76:79], v[52:55], v[230:233]
    ds_read_b128 a[52:55], v85 offset:0
    s_waitcnt lgkmcnt(7)
    v_mfma_f32_16x16x32_bf16 v[218:221], a[72:75], v[56:59], v[218:221]
    ds_read_b128 v[52:55], v173 offset:3120
    v_mfma_f32_16x16x32_bf16 v[234:237], a[76:79], v[56:59], v[234:237]
    ds_read_b128 a[56:59], v87 offset:0
    v_mfma_f32_16x16x32_bf16 v[222:225], a[72:75], v[60:63], v[222:225]
    ds_read_b128 v[56:59], v173 offset:4160
    global_load_dwordx2 v[130:131], v174, s[38:39] offset:0 sc1
    v_mfma_f32_16x16x32_bf16 v[238:241], a[76:79], v[60:63], v[238:241]
    global_load_dwordx2 v[132:133], v174, s[38:39] offset:512 sc1
    ds_read_b128 a[60:63], v89 offset:0
    s_waitcnt lgkmcnt(5)
    v_mfma_f32_16x16x32_bf16 v[210:213], a[80:83], v[64:67], v[210:213]
    ds_read_b128 v[60:63], v173 offset:5200
    global_load_dwordx2 v[134:135], v174, s[38:39] offset:1024 sc1
    v_mfma_f32_16x16x32_bf16 v[226:229], a[84:87], v[64:67], v[226:229]
    global_load_dwordx2 v[136:137], v174, s[38:39] offset:1536 sc1
    s_waitcnt lgkmcnt(1)
    s_add_u32 m0, s89, 0
    v_mfma_f32_16x16x32_bf16 v[214:217], a[80:83], v[68:71], v[214:217]
    ds_read_b128 v[64:67], v173 offset:6240
    global_load_dwordx2 v[138:139], v174, s[38:39] offset:2048 sc1
    v_mfma_f32_16x16x32_bf16 v[230:233], a[84:87], v[68:71], v[230:233]
    global_load_dwordx2 v[140:141], v174, s[38:39] offset:2560 sc1
    global_load_dwordx2 v[142:143], v174, s[38:39] offset:3072 sc1
    v_mfma_f32_16x16x32_bf16 v[218:221], a[80:83], v[48:51], v[218:221]
    ds_read_b128 v[68:71], v173 offset:7280
    global_load_lds_dwordx4 v74, s[80:81] offset:0
    v_mfma_f32_16x16x32_bf16 v[234:237], a[84:87], v[48:51], v[234:237]
    global_load_dwordx2 v[144:145], v174, s[38:39] offset:3584 sc1
    s_bfe_u32 s6, s2, 0x30003
    global_load_lds_dwordx4 v75, s[80:81] offset:1024
    v_mfma_f32_16x16x32_bf16 v[222:225], a[80:83], v[52:55], v[222:225]
    ds_read_b128 v[48:51], v173 offset:8320
    v_mul_u32_u24 v254, 8, v0
    v_mfma_f32_16x16x32_bf16 v[238:241], a[84:87], v[52:55], v[238:241]
    v_add_lshl_u32 v254, v254, s6, 7
    global_load_lds_dwordx4 v76, s[80:81] offset:2048
    s_waitcnt lgkmcnt(2)
    v_mfma_f32_16x16x32_bf16 v[210:213], a[88:91], v[56:59], v[210:213]
    ds_read_b128 v[52:55], v173 offset:9360
    v_min_u32 v254, (Lend-Lmid-4), v254
    v_mfma_f32_16x16x32_bf16 v[226:229], a[92:95], v[56:59], v[226:229]
    v_add_u32 v254, (Lmid-adaLN_cond__ssm_conv_h3__mixer_gmlp__prompt_kernel), v254
    global_load_lds_dwordx4 v77, s[80:81] offset:3072
    v_mfma_f32_16x16x32_bf16 v[214:217], a[88:91], v[60:63], v[214:217]
    ds_read_b128 v[56:59], v173 offset:10400
    global_load_dword v254, v254, s[0:1]
    s_add_u32 m0, s89, 4096
    v_mfma_f32_16x16x32_bf16 v[230:233], a[92:95], v[60:63], v[230:233]
    global_load_lds_dwordx4 v78, s[80:81] offset:0
    s_waitcnt lgkmcnt(2)
    v_mfma_f32_16x16x32_bf16 v[218:221], a[88:91], v[64:67], v[218:221]
    ds_read_b128 v[60:63], v173 offset:11440
    v_mfma_f32_16x16x32_bf16 v[234:237], a[92:95], v[64:67], v[234:237]
    global_load_lds_dwordx4 v79, s[80:81] offset:1024
    v_mfma_f32_16x16x32_bf16 v[222:225], a[88:91], v[68:71], v[222:225]
    ds_read_b128 v[64:67], v173 offset:12480
    global_load_lds_dwordx4 v80, s[80:81] offset:2048
    v_mfma_f32_16x16x32_bf16 v[238:241], a[92:95], v[68:71], v[238:241]
    s_waitcnt lgkmcnt(3)
    v_mfma_f32_16x16x32_bf16 v[210:213], a[96:99], v[48:51], v[210:213]
    ds_read_b128 v[68:71], v173 offset:13520
    global_load_lds_dwordx4 v81, s[80:81] offset:3072
    v_mfma_f32_16x16x32_bf16 v[226:229], a[100:103], v[48:51], v[226:229]
    v_mfma_f32_16x16x32_bf16 v[214:217], a[96:99], v[52:55], v[214:217]
    ds_read_b128 v[48:51], v173 offset:14560
    s_waitcnt vmcnt(17)
    ds_read_b128 a[64:67], v82 offset:8192
    v_mfma_f32_16x16x32_bf16 v[230:233], a[100:103], v[52:55], v[230:233]
    s_waitcnt lgkmcnt(4)
    v_mfma_f32_16x16x32_bf16 v[218:221], a[96:99], v[56:59], v[218:221]
    ds_read_b128 v[52:55], v173 offset:15600
    v_mfma_f32_16x16x32_bf16 v[234:237], a[100:103], v[56:59], v[234:237]
    ds_read_b128 a[68:71], v84 offset:8192
    v_mfma_f32_16x16x32_bf16 v[222:225], a[96:99], v[60:63], v[222:225]
    ds_read_b128 v[56:59], v173 offset:16640
    ds_read_b128 a[72:75], v86 offset:8192
    v_mfma_f32_16x16x32_bf16 v[238:241], a[100:103], v[60:63], v[238:241]
    s_waitcnt lgkmcnt(6)
    v_mfma_f32_16x16x32_bf16 v[210:213], a[104:107], v[64:67], v[210:213]
    ds_read_b128 v[60:63], v173 offset:17680
    ds_read_b128 a[76:79], v88 offset:8192
    v_mfma_f32_16x16x32_bf16 v[226:229], a[108:111], v[64:67], v[226:229]
    v_mfma_f32_16x16x32_bf16 v[214:217], a[104:107], v[68:71], v[214:217]
    ds_read_b128 v[64:67], v173 offset:18720
    ds_read_b128 a[80:83], v83 offset:8192
    v_mfma_f32_16x16x32_bf16 v[230:233], a[108:111], v[68:71], v[230:233]
    ds_read_b128 a[84:87], v85 offset:8192
    s_waitcnt lgkmcnt(6)
    s_waitcnt vmcnt(15)
    v_max_u32 v28, v131, v133
    s_waitcnt vmcnt(13)
    v_max3_u32 v28, v135, v137, v28
    s_waitcnt vmcnt(11)
    v_max3_u32 v28, v139, v141, v28
    s_waitcnt vmcnt(8)
    v_max3_u32 v28, v143, v145, v28
    v_cmp_eq_u32 vcc, -1, v28
    s_nop 0
    s_cbranch_vccnz Ls3_r
Ls3_ok:
    v_pk_add_f32 v[130:131], v[130:131], v[132:133] op_sel:[0,0] op_sel_hi:[1,1]
    v_pk_add_f32 v[134:135], v[134:135], v[136:137] op_sel:[0,0] op_sel_hi:[1,1]
    v_pk_add_f32 v[138:139], v[138:139], v[140:141] op_sel:[0,0] op_sel_hi:[1,1]
    v_pk_add_f32 v[142:143], v[142:143], v[144:145] op_sel:[0,0] op_sel_hi:[1,1]
    v_pk_add_f32 v[130:131], v[130:131], v[134:135] op_sel:[0,0] op_sel_hi:[1,1]
    v_pk_add_f32 v[138:139], v[138:139], v[142:143] op_sel:[0,0] op_sel_hi:[1,1]
    v_pk_add_f32 v[130:131], v[130:131], v[138:139] op_sel:[0,0] op_sel_hi:[1,1]
    v_mul_f32 v130, 0x3a97b426, v130
    v_mul_f32 v131, 0x3a97b426, v131
    v_fma_f32 v131, -v130, v130, v131
    v_max_f32 v131, 0, v131
    v_add_f32 v131, 0x3727c5ac, v131
    v_rsq_f32 v132, v131
    s_nop 0
    v_mul_f32_e64 v131, -v130, v132
    v_mov_b32 v130, v132
    ds_write2st64_b32 v170, v130, v131 offset0:0 offset1:1
    ds_read_b128 v[98:101], v171 offset:0
    ds_read_b128 v[102:105], v171 offset:16
    ds_read_b128 v[106:109], v171 offset:128
    ds_read_b128 v[110:113], v171 offset:144
    ds_read_b128 v[114:117], v171 offset:256
    ds_read_b128 v[118:121], v171 offset:272
    ds_read_b128 v[122:125], v171 offset:384
    ds_read_b128 v[126:129], v171 offset:400
    s_lshl_b32 s4, s41, 6
    s_lshl_b32 s5, s40, 1
    s_add_u32 s4, s4, s5
    s_mul_i32 s4, s4, 7168
    s_lshl_b32 s5, s3, 11
    s_add_u32 s4, s4, s5
    s_add_u32 s4, s4, 12582912
    v_add_u32 v28, s4, v4
    v_add_u32 v29, 7168, v28
    s_waitcnt lgkmcnt(3)
    v_pk_fma_f32 v[178:179], v[178:179], v[98:99], v[114:115] op_sel:[0,0,0] op_sel_hi:[1,1,1]
    v_pk_fma_f32 v[180:181], v[180:181], v[100:101], v[116:117] op_sel:[0,0,0] op_sel_hi:[1,1,1]
    s_waitcnt lgkmcnt(2)
    v_pk_fma_f32 v[182:183], v[182:183], v[102:103], v[118:119] op_sel:[0,0,0] op_sel_hi:[1,1,1]
    v_pk_fma_f32 v[184:185], v[184:185], v[104:105], v[120:121] op_sel:[0,0,0] op_sel_hi:[1,1,1]
    v_cvt_pk_bf16_f32 v130, v178, v179
    v_cvt_pk_bf16_f32 v131, v180, v181
    v_cvt_pk_bf16_f32 v132, v182, v183
    v_cvt_pk_bf16_f32 v133, v184, v185
    v_or_b32 v133, 1, v133
    global_store_dwordx4 v28, v[130:133], s[38:39] offset:0 sc1
    s_waitcnt lgkmcnt(0)
    v_pk_fma_f32 v[186:187], v[186:187], v[106:107], v[122:123] op_sel:[0,0,0] op_sel_hi:[1,1,1]
    v_pk_fma_f32 v[188:189], v[188:189], v[108:109], v[124:125] op_sel:[0,0,0] op_sel_hi:[1,1,1]
    v_pk_fma_f32 v[190:191], v[190:191], v[110:111], v[126:127] op_sel:[0,0,0] op_sel_hi:[1,1,1]
    v_pk_fma_f32 v[192:193], v[192:193], v[112:113], v[128:129] op_sel:[0,0,0] op_sel_hi:[1,1,1]
    v_cvt_pk_bf16_f32 v134, v186, v187
    v_cvt_pk_bf16_f32 v135, v188, v189
    v_cvt_pk_bf16_f32 v136, v190, v191
    v_cvt_pk_bf16_f32 v137, v192, v193
    v_or_b32 v137, 1, v137
    global_store_dwordx4 v29, v[134:137], s[38:39] offset:0 sc1
    v_pk_fma_f32 v[194:195], v[194:195], v[98:99], v[114:115] op_sel:[0,0,0] op_sel_hi:[1,1,1]
    v_pk_fma_f32 v[196:197], v[196:197], v[100:101], v[116:117] op_sel:[0,0,0] op_sel_hi:[1,1,1]
    v_pk_fma_f32 v[198:199], v[198:199], v[102:103], v[118:119] op_sel:[0,0,0] op_sel_hi:[1,1,1]
    v_pk_fma_f32 v[200:201], v[200:201], v[104:105], v[120:121] op_sel:[0,0,0] op_sel_hi:[1,1,1]
    v_cvt_pk_bf16_f32 v138, v194, v195
    v_cvt_pk_bf16_f32 v139, v196, v197
    v_cvt_pk_bf16_f32 v140, v198, v199
    v_cvt_pk_bf16_f32 v141, v200, v201
    v_or_b32 v141, 1, v141
    s_cmp_eq_u32 s3, 3
    s_cbranch_scc1 Lzs_0
    global_store_dwordx4 v28, v[138:141], s[38:39] offset:1024 sc1
Lzs_0:
    v_pk_fma_f32 v[202:203], v[202:203], v[106:107], v[122:123] op_sel:[0,0,0] op_sel_hi:[1,1,1]
    v_pk_fma_f32 v[204:205], v[204:205], v[108:109], v[124:125] op_sel:[0,0,0] op_sel_hi:[1,1,1]
    v_pk_fma_f32 v[206:207], v[206:207], v[110:111], v[126:127] op_sel:[0,0,0] op_sel_hi:[1,1,1]
    v_pk_fma_f32 v[208:209], v[208:209], v[112:113], v[128:129] op_sel:[0,0,0] op_sel_hi:[1,1,1]
    v_cvt_pk_bf16_f32 v142, v202, v203
    v_cvt_pk_bf16_f32 v143, v204, v205
    v_cvt_pk_bf16_f32 v144, v206, v207
    v_cvt_pk_bf16_f32 v145, v208, v209
    v_or_b32 v145, 1, v145
    s_cmp_eq_u32 s3, 3
    s_cbranch_scc1 Lzs_1
    global_store_dwordx4 v29, v[142:145], s[38:39] offset:1024 sc1
Lzs_1:
    v_mfma_f32_16x16x32_bf16 v[218:221], a[104:107], v[48:51], v[218:221]
    ds_read_b128 v[68:71], v173 offset:19760
    v_mfma_f32_16x16x32_bf16 v[234:237], a[108:111], v[48:51], v[234:237]
    ds_read_b128 a[88:91], v87 offset:8192
    s_mul_i32 s91, s41, 458752
    v_mfma_f32_16x16x32_bf16 v[222:225], a[104:107], v[52:55], v[222:225]
    ds_read_b128 v[48:51], v173 offset:20800
    ds_read_b128 a[92:95], v89 offset:8192
    s_add_u32 s91, s91, 12582912
    v_mfma_f32_16x16x32_bf16 v[238:241], a[108:111], v[52:55], v[238:241]
    v_mfma_f32_16x16x32_bf16 v[210:213], a[112:115], v[56:59], v[210:213]
    ds_read_b128 v[52:55], v173 offset:21840
    s_waitcnt lgkmcnt(1)
    s_add_u32 m0, s89, 8192
    v_mfma_f32_16x16x32_bf16 v[226:229], a[116:119], v[56:59], v[226:229]
    s_mul_i32 s6, s44, 14336
    v_mfma_f32_16x16x32_bf16 v[214:217], a[112:115], v[60:63], v[214:217]
    ds_read_b128 v[56:59], v173 offset:22880
    s_add_u32 s6, s6, s91
    v_mfma_f32_16x16x32_bf16 v[230:233], a[116:119], v[60:63], v[230:233]
    global_load_lds_dwordx4 v74, s[82:83] offset:0
    v_mfma_f32_16x16x32_bf16 v[218:221], a[112:115], v[64:67], v[218:221]
    ds_read_b128 v[60:63], v173 offset:23920
    s_add_u32 s52, s38, s6
    s_addc_u32 s53, s39, 0
    v_mfma_f32_16x16x32_bf16 v[234:237], a[116:119], v[64:67], v[234:237]
    global_load_lds_dwordx4 v75, s[82:83] offset:1024
    v_mfma_f32_16x16x32_bf16 v[222:225], a[112:115], v[68:71], v[222:225]
    ds_read_b128 v[64:67], v173 offset:24960
    global_load_lds_dwordx4 v76, s[82:83] offset:2048
    v_mfma_f32_16x16x32_bf16 v[238:241], a[116:119], v[68:71], v[238:241]
    s_waitcnt lgkmcnt(3)
    v_mfma_f32_16x16x32_bf16 v[210:213], a[120:123], v[48:51], v[210:213]
    ds_read_b128 v[68:71], v173 offset:26000
    global_load_lds_dwordx4 v77, s[82:83] offset:3072
    v_mfma_f32_16x16x32_bf16 v[226:229], a[124:127], v[48:51], v[226:229]
    s_add_u32 s54, s52, 14336
    s_addc_u32 s55, s53, 0
    v_mfma_f32_16x16x32_bf16 v[214:217], a[120:123], v[52:55], v[214:217]
    ds_read_b128 v[48:51], v173 offset:27040
    s_add_u32 m0, s89, 12288
    v_mfma_f32_16x16x32_bf16 v[230:233], a[124:127], v[52:55], v[230:233]
    global_load_lds_dwordx4 v78, s[82:83] offset:0
    s_waitcnt lgkmcnt(2)
    v_mfma_f32_16x16x32_bf16 v[218:221], a[120:123], v[56:59], v[218:221]
    ds_read_b128 v[52:55], v173 offset:28080
    s_mul_i32 s6, s46, 14336
    v_mfma_f32_16x16x32_bf16 v[234:237], a[124:127], v[56:59], v[234:237]
    global_load_lds_dwordx4 v79, s[82:83] offset:1024
    v_mfma_f32_16x16x32_bf16 v[222:225], a[120:123], v[60:63], v[222:225]
    ds_read_b128 v[56:59], v173 offset:29120
    s_add_u32 s6, s6, s91
    global_load_lds_dwordx4 v80, s[82:83] offset:2048
    v_mfma_f32_16x16x32_bf16 v[238:241], a[124:127], v[60:63], v[238:241]
    s_waitcnt lgkmcnt(3)
    v_mfma_f32_16x16x32_bf16 v[210:213], a[128:131], v[64:67], v[210:213]
    ds_read_b128 v[60:63], v173 offset:30160
    global_load_lds_dwordx4 v81, s[82:83] offset:3072
    v_mfma_f32_16x16x32_bf16 v[226:229], a[132:135], v[64:67], v[226:229]
    s_add_u32 s56, s38, s6
    s_addc_u32 s57, s39, 0
    v_mfma_f32_16x16x32_bf16 v[214:217], a[128:131], v[68:71], v[214:217]
    ds_read_b128 v[64:67], v173 offset:31200
    s_waitcnt vmcnt(10)
    ds_read_b128 a[96:99], v82 offset:0
    v_mfma_f32_16x16x32_bf16 v[230:233], a[132:135], v[68:71], v[230:233]
    s_waitcnt lgkmcnt(4)
    v_mfma_f32_16x16x32_bf16 v[218:221], a[128:131], v[48:51], v[218:221]
    ds_read_b128 v[68:71], v173 offset:32240
    s_add_u32 s58, s56, 14336
    s_addc_u32 s59, s57, 0
    v_mfma_f32_16x16x32_bf16 v[234:237], a[132:135], v[48:51], v[234:237]
    v_mfma_f32_16x16x32_bf16 v[222:225], a[128:131], v[52:55], v[222:225]
    ds_read_b128 v[48:51], v173 offset:33280
    ds_read_b128 a[100:103], v84 offset:0
    v_mfma_f32_16x16x32_bf16 v[238:241], a[132:135], v[52:55], v[238:241]
    s_mul_i32 s6, s48, 14336
    s_waitcnt lgkmcnt(4)
    v_mfma_f32_16x16x32_bf16 v[210:213], a[136:139], v[56:59], v[210:213]
    ds_read_b128 v[52:55], v173 offset:34320
    v_mfma_f32_16x16x32_bf16 v[226:229], a[140:143], v[56:59], v[226:229]
    ds_read_b128 a[104:107], v86 offset:0
    s_add_u32 s6, s6, s91
    v_mfma_f32_16x16x32_bf16 v[214:217], a[136:139], v[60:63], v[214:217]
    ds_read_b128 v[56:59], v173 offset:35360
    v_mfma_f32_16x16x32_bf16 v[230:233], a[140:143], v[60:63], v[230:233]
    ds_read_b128 a[108:111], v88 offset:0
    s_waitcnt lgkmcnt(5)
    v_mfma_f32_16x16x32_bf16 v[218:221], a[136:139], v[64:67], v[218:221]
    ds_read_b128 v[60:63], v173 offset:36400
    s_add_u32 s60, s38, s6
    s_addc_u32 s61, s39, 0
    v_mfma_f32_16x16x32_bf16 v[234:237], a[140:143], v[64:67], v[234:237]
    ds_read_b128 a[112:115], v83 offset:0
    v_mfma_f32_16x16x32_bf16 v[222:225], a[136:139], v[68:71], v[222:225]
    ds_read_b128 v[64:67], v173 offset:37440
    v_mfma_f32_16x16x32_bf16 v[238:241], a[140:143], v[68:71], v[238:241]
    s_add_u32 s62, s60, 14336
    s_addc_u32 s63, s61, 0
    s_waitcnt lgkmcnt(4)
    v_mfma_f32_16x16x32_bf16 v[210:213], a[144:147], v[48:51], v[210:213]
    ds_read_b128 v[68:71], v173 offset:38480
    ds_read_b128 a[116:119], v85 offset:0
    v_mfma_f32_16x16x32_bf16 v[226:229], a[148:151], v[48:51], v[226:229]
    v_mfma_f32_16x16x32_bf16 v[214:217], a[144:147], v[52:55], v[214:217]
    ds_read_b128 v[48:51], v173 offset:39520
    ds_read_b128 a[120:123], v87 offset:0
    v_mfma_f32_16x16x32_bf16 v[230:233], a[148:151], v[52:55], v[230:233]
    s_mul_i32 s6, s50, 14336
    s_waitcnt lgkmcnt(4)
    v_mfma_f32_16x16x32_bf16 v[218:221], a[144:147], v[56:59], v[218:221]
    ds_read_b128 v[52:55], v173 offset:40560
    ds_read_b128 a[124:127], v89 offset:0
    v_mfma_f32_16x16x32_bf16 v[234:237], a[148:151], v[56:59], v[234:237]
    s_add_u32 s6, s6, s91
    v_mfma_f32_16x16x32_bf16 v[222:225], a[144:147], v[60:63], v[222:225]
    v_mfma_f32_16x16x32_bf16 v[238:241], a[148:151], v[60:63], v[238:241]
    s_add_u32 s64, s38, s6
    s_addc_u32 s65, s39, 0
    s_waitcnt lgkmcnt(2)
    v_mfma_f32_16x16x32_bf16 v[210:213], a[152:155], v[64:67], v[210:213]
    v_mfma_f32_16x16x32_bf16 v[226:229], a[156:159], v[64:67], v[226:229]
    v_mfma_f32_16x16x32_bf16 v[214:217], a[152:155], v[68:71], v[214:217]
    v_mfma_f32_16x16x32_bf16 v[230:233], a[156:159], v[68:71], v[230:233]
    s_add_u32 s66, s64, 14336
    s_addc_u32 s67, s65, 0
    s_waitcnt lgkmcnt(0)
    v_mfma_f32_16x16x32_bf16 v[218:221], a[152:155], v[48:51], v[218:221]
    v_mfma_f32_16x16x32_bf16 v[234:237], a[156:159], v[48:51], v[234:237]
    v_mfma_f32_16x16x32_bf16 v[222:225], a[152:155], v[52:55], v[222:225]
    v_mfma_f32_16x16x32_bf16 v[238:241], a[156:159], v[52:55], v[238:241]
    s_waitcnt vmcnt(0)
    ds_read_b128 a[128:131], v82 offset:8192
    ds_read_b128 a[132:135], v84 offset:8192
    ds_read_b128 a[136:139], v86 offset:8192
    ds_read_b128 a[140:143], v88 offset:8192
    ds_read_b128 a[144:147], v83 offset:8192
    ds_read_b128 a[148:151], v85 offset:8192
    ds_read_b128 a[152:155], v87 offset:8192
    ds_read_b128 a[156:159], v89 offset:8192
    s_waitcnt lgkmcnt(0)
    s_barrier
    s_mul_i32 s5, s41, 138240
    s_add_u32 s5, s5, 10485760
    s_add_u32 s92, s38, s5
    s_addc_u32 s93, s39, 0
    s_mul_i32 s95, s3, 34816
    s_min_u32 s95, s95, 103424
    s_add_u32 s92, s92, s95
    s_addc_u32 s93, s93, 0
    s_add_u32 m0, s95, 0
    s_nop 0
    global_load_lds_dwordx4 v4, s[92:93] offset:0 sc1
    s_lshl_b32 s4, s3, 10
    s_add_u32 s4, s4, 138240
    v_add_u32 v170, s4, v30
    s_lshl_b32 s4, s3, 12
    s_add_u32 s4, s4, 138240
    v_add_u32 v171, s4, v30
    v_add_u32 v30, 3072, v4
    v_add_u32 v31, 10240, v4
    v_min_u32 v29, 27, v1
    v_lshlrev_b32 v29, 10, v29
    v_pk_fma_f32 v[178:179], v[162:163], v[12:13], v[16:17] op_sel:[1,0,0] op_sel_hi:[1,1,1]
    v_pk_fma_f32 v[180:181], v[162:163], v[14:15], v[18:19] op_sel:[1,0,0] op_sel_hi:[1,1,1]
    v_pk_fma_f32 v[182:183], v[164:165], v[12:13], v[16:17] op_sel:[1,0,0] op_sel_hi:[1,1,1]
    v_pk_fma_f32 v[184:185], v[164:165], v[14:15], v[18:19] op_sel:[1,0,0] op_sel_hi:[1,1,1]
    v_pk_fma_f32 v[186:187], v[166:167], v[12:13], v[16:17] op_sel:[1,0,0] op_sel_hi:[1,1,1]
    v_pk_fma_f32 v[188:189], v[166:167], v[14:15], v[18:19] op_sel:[1,0,0] op_sel_hi:[1,1,1]
    v_pk_fma_f32 v[190:191], v[168:169], v[12:13], v[16:17] op_sel:[1,0,0] op_sel_hi:[1,1,1]
    v_pk_fma_f32 v[192:193], v[168:169], v[14:15], v[18:19] op_sel:[1,0,0] op_sel_hi:[1,1,1]
    v_pk_fma_f32 v[210:211], v[162:163], v[210:211], v[178:179] op_sel:[0,0,0] op_sel_hi:[0,1,1]
    global_load_lds_dwordx4 v4, s[92:93] offset:1024 sc1
    v_pk_fma_f32 v[212:213], v[162:163], v[212:213], v[180:181] op_sel:[0,0,0] op_sel_hi:[0,1,1]
    v_pk_fma_f32 v[214:215], v[164:165], v[214:215], v[182:183] op_sel:[0,0,0] op_sel_hi:[0,1,1]
    v_pk_fma_f32 v[216:217], v[164:165], v[216:217], v[184:185] op_sel:[0,0,0] op_sel_hi:[0,1,1]
    v_pk_fma_f32 v[218:219], v[166:167], v[218:219], v[186:187] op_sel:[0,0,0] op_sel_hi:[0,1,1]
    v_pk_fma_f32 v[220:221], v[166:167], v[220:221], v[188:189] op_sel:[0,0,0] op_sel_hi:[0,1,1]
    v_pk_fma_f32 v[222:223], v[168:169], v[222:223], v[190:191] op_sel:[0,0,0] op_sel_hi:[0,1,1]
    v_pk_fma_f32 v[224:225], v[168:169], v[224:225], v[192:193] op_sel:[0,0,0] op_sel_hi:[0,1,1]
    v_pk_fma_f32 v[178:179], v[162:163], v[20:21], v[24:25] op_sel:[1,0,0] op_sel_hi:[1,1,1]
    v_pk_fma_f32 v[180:181], v[162:163], v[22:23], v[26:27] op_sel:[1,0,0] op_sel_hi:[1,1,1]
    v_pk_fma_f32 v[182:183], v[164:165], v[20:21], v[24:25] op_sel:[1,0,0] op_sel_hi:[1,1,1]
    v_pk_fma_f32 v[184:185], v[164:165], v[22:23], v[26:27] op_sel:[1,0,0] op_sel_hi:[1,1,1]
    v_pk_fma_f32 v[186:187], v[166:167], v[20:21], v[24:25] op_sel:[1,0,0] op_sel_hi:[1,1,1]
    v_pk_fma_f32 v[188:189], v[166:167], v[22:23], v[26:27] op_sel:[1,0,0] op_sel_hi:[1,1,1]
    v_pk_fma_f32 v[190:191], v[168:169], v[20:21], v[24:25] op_sel:[1,0,0] op_sel_hi:[1,1,1]
    v_pk_fma_f32 v[192:193], v[168:169], v[22:23], v[26:27] op_sel:[1,0,0] op_sel_hi:[1,1,1]
    v_pk_fma_f32 v[226:227], v[162:163], v[226:227], v[178:179] op_sel:[0,0,0] op_sel_hi:[0,1,1]
    v_pk_fma_f32 v[228:229], v[162:163], v[228:229], v[180:181] op_sel:[0,0,0] op_sel_hi:[0,1,1]
    v_pk_fma_f32 v[230:231], v[164:165], v[230:231], v[182:183] op_sel:[0,0,0] op_sel_hi:[0,1,1]
    v_pk_fma_f32 v[232:233], v[164:165], v[232:233], v[184:185] op_sel:[0,0,0] op_sel_hi:[0,1,1]
    global_load_lds_dwordx4 v4, s[92:93] offset:2048 sc1
    v_pk_fma_f32 v[234:235], v[166:167], v[234:235], v[186:187] op_sel:[0,0,0] op_sel_hi:[0,1,1]
    v_pk_fma_f32 v[236:237], v[166:167], v[236:237], v[188:189] op_sel:[0,0,0] op_sel_hi:[0,1,1]
    v_pk_fma_f32 v[238:239], v[168:169], v[238:239], v[190:191] op_sel:[0,0,0] op_sel_hi:[0,1,1]
    v_pk_fma_f32 v[240:241], v[168:169], v[240:241], v[192:193] op_sel:[0,0,0] op_sel_hi:[0,1,1]
    v_pk_mul_f32 v[178:179], v[210:211], v[210:211] op_sel:[0,0] op_sel_hi:[1,1]
    v_pk_mul_f32 v[180:181], v[212:213], v[212:213] op_sel:[0,0] op_sel_hi:[1,1]
    v_pk_mul_f32 v[182:183], v[214:215], v[214:215] op_sel:[0,0] op_sel_hi:[1,1]
    v_pk_mul_f32 v[184:185], v[216:217], v[216:217] op_sel:[0,0] op_sel_hi:[1,1]
    v_pk_mul_f32 v[186:187], v[218:219], v[218:219] op_sel:[0,0] op_sel_hi:[1,1]
    v_pk_mul_f32 v[188:189], v[220:221], v[220:221] op_sel:[0,0] op_sel_hi:[1,1]
    v_pk_mul_f32 v[190:191], v[222:223], v[222:223] op_sel:[0,0] op_sel_hi:[1,1]
    v_pk_mul_f32 v[192:193], v[224:225], v[224:225] op_sel:[0,0] op_sel_hi:[1,1]
    v_pk_mul_f32 v[194:195], v[226:227], v[226:227] op_sel:[0,0] op_sel_hi:[1,1]
    v_pk_mul_f32 v[196:197], v[228:229], v[228:229] op_sel:[0,0] op_sel_hi:[1,1]
    v_pk_mul_f32 v[198:199], v[230:231], v[230:231] op_sel:[0,0] op_sel_hi:[1,1]
    v_pk_mul_f32 v[200:201], v[232:233], v[232:233] op_sel:[0,0] op_sel_hi:[1,1]
    v_pk_mul_f32 v[202:203], v[234:235], v[234:235] op_sel:[0,0] op_sel_hi:[1,1]
    v_pk_mul_f32 v[204:205], v[236:237], v[236:237] op_sel:[0,0] op_sel_hi:[1,1]
    v_pk_mul_f32 v[206:207], v[238:239], v[238:239] op_sel:[0,0] op_sel_hi:[1,1]
    global_load_lds_dwordx4 v4, s[92:93] offset:3072 sc1
    v_pk_mul_f32 v[208:209], v[240:241], v[240:241] op_sel:[0,0] op_sel_hi:[1,1]
    v_pk_fma_f32 v[178:179], v[178:179], s[84:85], s[84:85] op_sel:[0,1,0] op_sel_hi:[1,1,0]
    v_pk_fma_f32 v[180:181], v[180:181], s[84:85], s[84:85] op_sel:[0,1,0] op_sel_hi:[1,1,0]
    v_pk_fma_f32 v[182:183], v[182:183], s[84:85], s[84:85] op_sel:[0,1,0] op_sel_hi:[1,1,0]
    v_pk_fma_f32 v[184:185], v[184:185], s[84:85], s[84:85] op_sel:[0,1,0] op_sel_hi:[1,1,0]
    v_pk_fma_f32 v[186:187], v[186:187], s[84:85], s[84:85] op_sel:[0,1,0] op_sel_hi:[1,1,0]
    v_pk_fma_f32 v[188:189], v[188:189], s[84:85], s[84:85] op_sel:[0,1,0] op_sel_hi:[1,1,0]
    v_pk_fma_f32 v[190:191], v[190:191], s[84:85], s[84:85] op_sel:[0,1,0] op_sel_hi:[1,1,0]
    v_pk_fma_f32 v[192:193], v[192:193], s[84:85], s[84:85] op_sel:[0,1,0] op_sel_hi:[1,1,0]
    v_pk_fma_f32 v[194:195], v[194:195], s[84:85], s[84:85] op_sel:[0,1,0] op_sel_hi:[1,1,0]
    v_pk_fma_f32 v[196:197], v[196:197], s[84:85], s[84:85] op_sel:[0,1,0] op_sel_hi:[1,1,0]
    v_pk_fma_f32 v[198:199], v[198:199], s[84:85], s[84:85] op_sel:[0,1,0] op_sel_hi:[1,1,0]
    v_pk_fma_f32 v[200:201], v[200:201], s[84:85], s[84:85] op_sel:[0,1,0] op_sel_hi:[1,1,0]
    v_pk_fma_f32 v[202:203], v[202:203], s[84:85], s[84:85] op_sel:[0,1,0] op_sel_hi:[1,1,0]
    v_pk_fma_f32 v[204:205], v[204:205], s[84:85], s[84:85] op_sel:[0,1,0] op_sel_hi:[1,1,0]
    v_pk_fma_f32 v[206:207], v[206:207], s[84:85], s[84:85] op_sel:[0,1,0] op_sel_hi:[1,1,0]
    v_pk_fma_f32 v[208:209], v[208:209], s[84:85], s[84:85] op_sel:[0,1,0] op_sel_hi:[1,1,0]
    v_pk_mul_f32 v[178:179], v[178:179], v[210:211] op_sel:[0,0] op_sel_hi:[1,1]
    v_pk_mul_f32 v[180:181], v[180:181], v[212:213] op_sel:[0,0] op_sel_hi:[1,1]
    s_add_u32 m0, s95, 4096
    s_add_u32 s92, s92, 4096
    s_addc_u32 s93, s93, 0
    global_load_lds_dwordx4 v4, s[92:93] offset:0 sc1
    v_pk_mul_f32 v[182:183], v[182:183], v[214:215] op_sel:[0,0] op_sel_hi:[1,1]
    v_pk_mul_f32 v[184:185], v[184:185], v[216:217] op_sel:[0,0] op_sel_hi:[1,1]
    v_pk_mul_f32 v[186:187], v[186:187], v[218:219] op_sel:[0,0] op_sel_hi:[1,1]
    v_pk_mul_f32 v[188:189], v[188:189], v[220:221] op_sel:[0,0] op_sel_hi:[1,1]
    v_pk_mul_f32 v[190:191], v[190:191], v[222:223] op_sel:[0,0] op_sel_hi:[1,1]
    v_pk_mul_f32 v[192:193], v[192:193], v[224:225] op_sel:[0,0] op_sel_hi:[1,1]
    v_pk_mul_f32 v[194:195], v[194:195], v[226:227] op_sel:[0,0] op_sel_hi:[1,1]
    v_pk_mul_f32 v[196:197], v[196:197], v[228:229] op_sel:[0,0] op_sel_hi:[1,1]
    v_pk_mul_f32 v[198:199], v[198:199], v[230:231] op_sel:[0,0] op_sel_hi:[1,1]
    v_pk_mul_f32 v[200:201], v[200:201], v[232:233] op_sel:[0,0] op_sel_hi:[1,1]
    v_pk_mul_f32 v[202:203], v[202:203], v[234:235] op_sel:[0,0] op_sel_hi:[1,1]
    v_pk_mul_f32 v[204:205], v[204:205], v[236:237] op_sel:[0,0] op_sel_hi:[1,1]
    v_pk_mul_f32 v[206:207], v[206:207], v[238:239] op_sel:[0,0] op_sel_hi:[1,1]
    v_pk_mul_f32 v[208:209], v[208:209], v[240:241] op_sel:[0,0] op_sel_hi:[1,1]
    v_exp_f32 v178, v178
    v_exp_f32 v179, v179
    v_exp_f32 v180, v180
    v_exp_f32 v181, v181
    v_exp_f32 v182, v182
    global_load_lds_dwordx4 v4, s[92:93] offset:1024 sc1
    v_exp_f32 v183, v183
    v_exp_f32 v184, v184
    v_exp_f32 v185, v185
    v_exp_f32 v186, v186
    v_exp_f32 v187, v187
    v_exp_f32 v188, v188
    v_exp_f32 v189, v189
    v_exp_f32 v190, v190
    v_exp_f32 v191, v191
    v_exp_f32 v192, v192
    v_exp_f32 v193, v193
    v_exp_f32 v194, v194
    global_load_dwordx4 v[62:65], v30, s[56:57] offset:-3072 sc1
    v_exp_f32 v195, v195
    v_exp_f32 v196, v196
    v_exp_f32 v197, v197
    v_exp_f32 v198, v198
    v_exp_f32 v199, v199
    v_exp_f32 v200, v200
    global_load_dwordx4 v[66:69], v30, s[56:57] offset:-2048 sc1
    v_exp_f32 v201, v201
    v_exp_f32 v202, v202
    v_exp_f32 v203, v203
    v_exp_f32 v204, v204
    v_exp_f32 v205, v205
    v_exp_f32 v206, v206
    global_load_dwordx4 v[70:73], v30, s[56:57] offset:-1024 sc1
    v_exp_f32 v207, v207
    v_exp_f32 v208, v208
    v_exp_f32 v209, v209
    v_pk_add_f32 v[178:179], v[178:179], 1.0 op_sel:[0,0] op_sel_hi:[1,0]
    v_pk_add_f32 v[180:181], v[180:181], 1.0 op_sel:[0,0] op_sel_hi:[1,0]
    v_pk_add_f32 v[182:183], v[182:183], 1.0 op_sel:[0,0] op_sel_hi:[1,0]
    v_pk_add_f32 v[184:185], v[184:185], 1.0 op_sel:[0,0] op_sel_hi:[1,0]
    global_load_dwordx4 v[74:77], v30, s[56:57] offset:0 sc1
    v_pk_add_f32 v[186:187], v[186:187], 1.0 op_sel:[0,0] op_sel_hi:[1,0]
    v_pk_add_f32 v[188:189], v[188:189], 1.0 op_sel:[0,0] op_sel_hi:[1,0]
    v_pk_add_f32 v[190:191], v[190:191], 1.0 op_sel:[0,0] op_sel_hi:[1,0]
    v_pk_add_f32 v[192:193], v[192:193], 1.0 op_sel:[0,0] op_sel_hi:[1,0]
    v_pk_add_f32 v[194:195], v[194:195], 1.0 op_sel:[0,0] op_sel_hi:[1,0]
    v_pk_add_f32 v[196:197], v[196:197], 1.0 op_sel:[0,0] op_sel_hi:[1,0]
    global_load_dwordx4 v[78:81], v30, s[56:57] offset:1024 sc1
    v_pk_add_f32 v[198:199], v[198:199], 1.0 op_sel:[0,0] op_sel_hi:[1,0]
    v_pk_add_f32 v[200:201], v[200:201], 1.0 op_sel:[0,0] op_sel_hi:[1,0]
    v_pk_add_f32 v[202:203], v[202:203], 1.0 op_sel:[0,0] op_sel_hi:[1,0]
    v_pk_add_f32 v[204:205], v[204:205], 1.0 op_sel:[0,0] op_sel_hi:[1,0]
    v_pk_add_f32 v[206:207], v[206:207], 1.0 op_sel:[0,0] op_sel_hi:[1,0]
    v_pk_add_f32 v[208:209], v[208:209], 1.0 op_sel:[0,0] op_sel_hi:[1,0]
    v_rcp_f32 v178, v178
    global_load_dwordx4 v[82:85], v30, s[56:57] offset:2048 sc1
    v_rcp_f32 v179, v179
    v_rcp_f32 v180, v180
    v_rcp_f32 v181, v181
    v_rcp_f32 v182, v182
    v_rcp_f32 v183, v183
    v_rcp_f32 v184, v184
    global_load_dwordx4 v[86:89], v30, s[56:57] offset:3072 sc1
    v_rcp_f32 v185, v185
    v_rcp_f32 v186, v186
    v_rcp_f32 v187, v187
    v_rcp_f32 v188, v188
    v_rcp_f32 v189, v189
    v_rcp_f32 v190, v190
    v_rcp_f32 v191, v191
    global_load_dwordx4 v[90:93], v31, s[56:57] offset:-3072 sc1
    v_rcp_f32 v192, v192
    v_rcp_f32 v193, v193
    v_rcp_f32 v194, v194
    v_rcp_f32 v195, v195
    v_rcp_f32 v196, v196
    v_rcp_f32 v197, v197
    global_load_dwordx4 v[94:97], v31, s[56:57] offset:-2048 sc1
    v_rcp_f32 v198, v198
    v_rcp_f32 v199, v199
    v_rcp_f32 v200, v200
    v_rcp_f32 v201, v201
    v_rcp_f32 v202, v202
    v_rcp_f32 v203, v203
    global_load_dwordx4 v[98:101], v31, s[56:57] offset:-1024 sc1
    v_rcp_f32 v204, v204
    v_rcp_f32 v205, v205
    v_rcp_f32 v206, v206
    v_rcp_f32 v207, v207
    v_rcp_f32 v208, v208
    v_rcp_f32 v209, v209
    v_pk_mul_f32 v[210:211], v[210:211], v[178:179] op_sel:[0,0] op_sel_hi:[1,1]
    global_load_dwordx4 v[102:105], v31, s[56:57] offset:0 sc1
    v_pk_mul_f32 v[212:213], v[212:213], v[180:181] op_sel:[0,0] op_sel_hi:[1,1]
    v_pk_mul_f32 v[214:215], v[214:215], v[182:183] op_sel:[0,0] op_sel_hi:[1,1]
    v_pk_mul_f32 v[216:217], v[216:217], v[184:185] op_sel:[0,0] op_sel_hi:[1,1]
    v_pk_mul_f32 v[218:219], v[218:219], v[186:187] op_sel:[0,0] op_sel_hi:[1,1]
    v_pk_mul_f32 v[220:221], v[220:221], v[188:189] op_sel:[0,0] op_sel_hi:[1,1]
    v_pk_mul_f32 v[222:223], v[222:223], v[190:191] op_sel:[0,0] op_sel_hi:[1,1]
    global_load_dwordx4 v[106:109], v31, s[56:57] offset:1024 sc1
    v_pk_mul_f32 v[224:225], v[224:225], v[192:193] op_sel:[0,0] op_sel_hi:[1,1]
    v_pk_mul_f32 v[226:227], v[226:227], v[194:195] op_sel:[0,0] op_sel_hi:[1,1]
    v_pk_mul_f32 v[228:229], v[228:229], v[196:197] op_sel:[0,0] op_sel_hi:[1,1]
    v_pk_mul_f32 v[230:231], v[230:231], v[198:199] op_sel:[0,0] op_sel_hi:[1,1]
    v_pk_mul_f32 v[232:233], v[232:233], v[200:201] op_sel:[0,0] op_sel_hi:[1,1]
    v_pk_mul_f32 v[234:235], v[234:235], v[202:203] op_sel:[0,0] op_sel_hi:[1,1]
    v_pk_mul_f32 v[236:237], v[236:237], v[204:205] op_sel:[0,0] op_sel_hi:[1,1]
    global_load_dwordx4 v[110:113], v31, s[56:57] offset:2048 sc1
    v_pk_mul_f32 v[238:239], v[238:239], v[206:207] op_sel:[0,0] op_sel_hi:[1,1]
    v_pk_mul_f32 v[240:241], v[240:241], v[208:209] op_sel:[0,0] op_sel_hi:[1,1]
    v_cvt_pk_bf16_f32 v178, v210, v211
    v_cvt_pk_bf16_f32 v179, v212, v213
    v_cvt_pk_bf16_f32 v180, v214, v215
    v_cvt_pk_bf16_f32 v181, v216, v217
    global_load_dwordx4 v[114:117], v31, s[56:57] offset:3072 sc1
    v_cvt_pk_bf16_f32 v182, v218, v219
    v_cvt_pk_bf16_f32 v183, v220, v221
    v_cvt_pk_bf16_f32 v184, v222, v223
    v_cvt_pk_bf16_f32 v185, v224, v225
    v_cvt_pk_bf16_f32 v186, v226, v227
    v_cvt_pk_bf16_f32 v187, v228, v229
    v_cvt_pk_bf16_f32 v188, v230, v231
    global_load_dwordx4 v[118:121], v30, s[58:59] offset:-3072 sc1
    v_cvt_pk_bf16_f32 v189, v232, v233
    v_cvt_pk_bf16_f32 v190, v234, v235
    v_cvt_pk_bf16_f32 v191, v236, v237
    v_cvt_pk_bf16_f32 v192, v238, v239
    v_cvt_pk_bf16_f32 v193, v240, v241
    ds_write_b64 v170, v[178:179] offset:0
    global_load_dwordx4 v[122:125], v30, s[58:59] offset:-2048 sc1
    ds_write_b64 v170, v[180:181] offset:4096
    ds_write_b64 v170, v[182:183] offset:8192
    ds_write_b64 v170, v[184:185] offset:12288
    ds_write_b64 v170, v[186:187] offset:512
    ds_write_b64 v170, v[188:189] offset:4608
    ds_write_b64 v170, v[190:191] offset:8704
    ds_write_b64 v170, v[192:193] offset:12800
    s_waitcnt lgkmcnt(0)
    s_barrier
    ds_read_b64 v[48:49], v171 offset:0
    ds_read_b64 v[50:51], v171 offset:512
    ds_read_b64 v[52:53], v171 offset:1024
    ds_read_b64 v[54:55], v171 offset:1536
    ds_read_b64 v[56:57], v171 offset:2048
    ds_read_b64 v[58:59], v171 offset:2560
    ds_read_b64 v[60:61], v171 offset:3072
Lmid:
    s_waitcnt vmcnt(14)
    v_and_b32 v28, v65, v69
    s_waitcnt vmcnt(12)
    v_bitop3_b32 v28, v73, v77, v28 bitop3:0x80
    v_and_b32 v28, 1, v28
    v_cmp_ne_u32 vcc, 1, v28
    s_nop 0
    s_cbranch_vccnz Lz0_r
Lz0_ok:
    v_mfma_f32_16x16x32_bf16 v[142:145], v[62:65], a[160:163], v[32:35]
    global_load_dwordx4 v[126:129], v30, s[58:59] offset:-1024 sc1
    v_mfma_f32_16x16x32_bf16 v[146:149], v[62:65], a[164:167], 0
    v_mfma_f32_16x16x32_bf16 v[150:153], v[62:65], a[168:171], 0
    v_mfma_f32_16x16x32_bf16 v[154:157], v[62:65], a[172:175], 0
    v_mfma_f32_16x16x32_bf16 v[158:161], v[66:69], a[160:163], v[32:35]
    global_load_dwordx4 v[130:133], v30, s[58:59] offset:0 sc1
    v_mfma_f32_16x16x32_bf16 v[162:165], v[66:69], a[164:167], 0
    v_mfma_f32_16x16x32_bf16 v[166:169], v[66:69], a[168:171], 0
    v_mfma_f32_16x16x32_bf16 v[170:173], v[66:69], a[172:175], 0
    v_mfma_f32_16x16x32_bf16 v[174:177], v[70:73], a[160:163], v[32:35]
    global_load_dwordx4 v[134:137], v30, s[58:59] offset:1024 sc1
    v_mfma_f32_16x16x32_bf16 v[178:181], v[70:73], a[164:167], 0
    v_mfma_f32_16x16x32_bf16 v[182:185], v[70:73], a[168:171], 0
    s_waitcnt vmcnt(13)
    v_and_b32 v28, v81, v85
    v_mfma_f32_16x16x32_bf16 v[186:189], v[70:73], a[172:175], 0
    s_waitcnt vmcnt(11)
    v_bitop3_b32 v28, v89, v93, v28 bitop3:0x80
    v_mfma_f32_16x16x32_bf16 v[190:193], v[74:77], a[160:163], v[32:35]
    v_and_b32 v28, 1, v28
    global_load_dwordx4 v[138:141], v30, s[58:59] offset:2048 sc1
    v_mfma_f32_16x16x32_bf16 v[194:197], v[74:77], a[164:167], 0
    v_cmp_ne_u32 vcc, 1, v28
    v_mfma_f32_16x16x32_bf16 v[198:201], v[74:77], a[168:171], 0
    v_mfma_f32_16x16x32_bf16 v[202:205], v[74:77], a[172:175], 0
    s_cbranch_vccnz Lz1_r
Lz1_ok:
    v_mfma_f32_16x16x32_bf16 v[206:209], v[78:81], a[160:163], v[32:35]
    global_load_dwordx4 v[62:65], v30, s[58:59] offset:3072 sc1
    s_xor_b32 s4, s3, 1
    s_mul_i32 s4, s4, 3072
    v_mfma_f32_16x16x32_bf16 v[210:213], v[78:81], a[164:167], 0
    s_add_u32 s4, s4, 138240
    v_add_u32 v20, s4, v4
    s_xor_b32 s4, s3, 2
    v_mfma_f32_16x16x32_bf16 v[214:217], v[78:81], a[168:171], 0
    s_mul_i32 s4, s4, 3072
    s_add_u32 s4, s4, 139264
    v_add_u32 v21, s4, v4
    v_mfma_f32_16x16x32_bf16 v[218:221], v[78:81], a[172:175], 0
    s_xor_b32 s4, s3, 3
    s_mul_i32 s4, s4, 3072
    v_mfma_f32_16x16x32_bf16 v[222:225], v[82:85], a[160:163], v[32:35]
    global_load_dwordx4 v[66:69], v31, s[58:59] offset:-3072 sc1
    s_add_u32 s4, s4, 140288
    v_add_u32 v22, s4, v4
    v_mfma_f32_16x16x32_bf16 v[226:229], v[82:85], a[164:167], 0
    s_mul_i32 s4, s3, 3072
    s_add_u32 s4, s4, 138240
    v_add_u32 v23, s4, v4
    v_mfma_f32_16x16x32_bf16 v[230:233], v[82:85], a[168:171], 0
    s_mul_i32 s4, s40, 114688
    s_add_u32 s4, s4, 1052672
    v_mfma_f32_16x16x32_bf16 v[234:237], v[82:85], a[172:175], 0
    s_lshl_b32 s5, s3, 13
    s_add_u32 s5, s5, s4
    v_mfma_f32_16x16x32_bf16 v[238:241], v[86:89], a[160:163], v[32:35]
    global_load_dwordx4 v[70:73], v31, s[58:59] offset:-2048 sc1
    v_add_u32 v6, s5, v4
    v_mfma_f32_16x16x32_bf16 v[242:245], v[86:89], a[164:167], 0
    v_add_u32 v7, 32768, v6
    v_add_u32 v26, 65536, v6
    s_lshl_b32 s5, s3, 12
    v_mfma_f32_16x16x32_bf16 v[246:249], v[86:89], a[168:171], 0
    s_waitcnt vmcnt(13)
    v_and_b32 v28, v97, v101
    s_add_u32 s5, s5, s4
    s_add_u32 s5, s5, 98304
    v_mfma_f32_16x16x32_bf16 v[250:253], v[86:89], a[172:175], 0
    s_waitcnt vmcnt(11)
    v_bitop3_b32 v28, v105, v109, v28 bitop3:0x80
    v_add_u32 v27, s5, v4
    s_lshl_b32 s4, s41, 10
    v_mfma_f32_16x16x32_bf16 v[142:145], v[90:93], a[176:179], v[142:145]
    s_add_u32 s8, s38, s4
    s_addc_u32 s9, s39, 0
    v_and_b32 v28, 1, v28
    v_mfma_f32_16x16x32_bf16 v[146:149], v[90:93], a[180:183], v[146:149]
    global_load_dwordx4 v[74:77], v31, s[58:59] offset:-1024 sc1
    s_lshr_b32 s4, s41, 1
    s_lshl_b32 s4, s4, 10
    s_and_b32 s5, s41, 1
    v_mfma_f32_16x16x32_bf16 v[150:153], v[90:93], a[184:187], v[150:153]
    v_cmp_ne_u32 vcc, 1, v28
    s_lshl_b32 s5, s5, 3
    s_add_u32 s4, s4, s5
    s_add_u32 s10, s38, s4
    s_addc_u32 s11, s39, 0
    v_mfma_f32_16x16x32_bf16 v[154:157], v[90:93], a[188:191], v[154:157]
    s_waitcnt lgkmcnt(0)
    s_barrier
    s_cbranch_vccnz Lz2_r
Lz2_ok:
    v_mfma_f32_16x16x32_bf16 v[158:161], v[94:97], a[176:179], v[158:161]
    global_load_dwordx4 v[78:81], v31, s[58:59] offset:0 sc1
    v_mfma_f32_16x16x32_bf16 v[162:165], v[94:97], a[180:183], v[162:165]
    v_mfma_f32_16x16x32_bf16 v[166:169], v[94:97], a[184:187], v[166:169]
    v_mfma_f32_16x16x32_bf16 v[170:173], v[94:97], a[188:191], v[170:173]
    v_mfma_f32_16x16x32_bf16 v[174:177], v[98:101], a[176:179], v[174:177]
    global_load_dwordx4 v[82:85], v31, s[58:59] offset:1024 sc1
    v_mfma_f32_16x16x32_bf16 v[178:181], v[98:101], a[180:183], v[178:181]
    v_mfma_f32_16x16x32_bf16 v[182:185], v[98:101], a[184:187], v[182:185]
    v_mfma_f32_16x16x32_bf16 v[186:189], v[98:101], a[188:191], v[186:189]
    v_mfma_f32_16x16x32_bf16 v[190:193], v[102:105], a[176:179], v[190:193]
    global_load_dwordx4 v[86:89], v31, s[58:59] offset:2048 sc1
    v_mfma_f32_16x16x32_bf16 v[194:197], v[102:105], a[180:183], v[194:197]
    v_mfma_f32_16x16x32_bf16 v[198:201], v[102:105], a[184:187], v[198:201]
    s_waitcnt vmcnt(13)
    v_and_b32 v28, v113, v117
    v_mfma_f32_16x16x32_bf16 v[202:205], v[102:105], a[188:191], v[202:205]
    s_waitcnt vmcnt(11)
    v_bitop3_b32 v28, v121, v125, v28 bitop3:0x80
    v_mfma_f32_16x16x32_bf16 v[206:209], v[106:109], a[176:179], v[206:209]
    v_and_b32 v28, 1, v28
    global_load_dwordx4 v[90:93], v31, s[58:59] offset:3072 sc1
    v_mfma_f32_16x16x32_bf16 v[210:213], v[106:109], a[180:183], v[210:213]
    v_cmp_ne_u32 vcc, 1, v28
    v_mfma_f32_16x16x32_bf16 v[214:217], v[106:109], a[184:187], v[214:217]
    v_mfma_f32_16x16x32_bf16 v[218:221], v[106:109], a[188:191], v[218:221]
    s_cbranch_vccnz Lz3_r
Lz3_ok:
    v_mfma_f32_16x16x32_bf16 v[222:225], v[110:113], a[176:179], v[222:225]
    global_load_dwordx4 v[94:97], v30, s[60:61] offset:-3072 sc1
    v_mfma_f32_16x16x32_bf16 v[226:229], v[110:113], a[180:183], v[226:229]
    v_mfma_f32_16x16x32_bf16 v[230:233], v[110:113], a[184:187], v[230:233]
    v_mfma_f32_16x16x32_bf16 v[234:237], v[110:113], a[188:191], v[234:237]
    v_mfma_f32_16x16x32_bf16 v[238:241], v[114:117], a[176:179], v[238:241]
    global_load_dwordx4 v[98:101], v31, s[60:61] offset:-3072 sc1
    v_mfma_f32_16x16x32_bf16 v[242:245], v[114:117], a[180:183], v[242:245]
    v_mfma_f32_16x16x32_bf16 v[246:249], v[114:117], a[184:187], v[246:249]
    v_mfma_f32_16x16x32_bf16 v[250:253], v[114:117], a[188:191], v[250:253]
    v_mfma_f32_16x16x32_bf16 v[142:145], v[118:121], a[0:3], v[142:145]
    global_load_dwordx4 v[102:105], v30, s[62:63] offset:-3072 sc1
    v_mfma_f32_16x16x32_bf16 v[146:149], v[118:121], a[4:7], v[146:149]
    v_mfma_f32_16x16x32_bf16 v[150:153], v[118:121], a[8:11], v[150:153]
    s_waitcnt vmcnt(13)
    v_and_b32 v28, v129, v133
    v_mfma_f32_16x16x32_bf16 v[154:157], v[118:121], a[12:15], v[154:157]
    s_waitcnt vmcnt(11)
    v_bitop3_b32 v28, v137, v141, v28 bitop3:0x80
    v_mfma_f32_16x16x32_bf16 v[158:161], v[122:125], a[0:3], v[158:161]
    v_and_b32 v28, 1, v28
    global_load_dwordx4 v[106:109], v31, s[62:63] offset:-3072 sc1
    v_mfma_f32_16x16x32_bf16 v[162:165], v[122:125], a[4:7], v[162:165]
    v_cmp_ne_u32 vcc, 1, v28
    v_mfma_f32_16x16x32_bf16 v[166:169], v[122:125], a[8:11], v[166:169]
    v_mfma_f32_16x16x32_bf16 v[170:173], v[122:125], a[12:15], v[170:173]
    s_cbranch_vccnz Lz4_r
Lz4_ok:
    v_mfma_f32_16x16x32_bf16 v[174:177], v[126:129], a[0:3], v[174:177]
    global_load_dwordx4 v[110:113], v30, s[52:53] offset:-3072 sc1
    v_mfma_f32_16x16x32_bf16 v[178:181], v[126:129], a[4:7], v[178:181]
    v_mfma_f32_16x16x32_bf16 v[182:185], v[126:129], a[8:11], v[182:185]
    v_mfma_f32_16x16x32_bf16 v[186:189], v[126:129], a[12:15], v[186:189]
    v_mfma_f32_16x16x32_bf16 v[190:193], v[130:133], a[0:3], v[190:193]
    global_load_dwordx4 v[114:117], v31, s[52:53] offset:-3072 sc1
    v_mfma_f32_16x16x32_bf16 v[194:197], v[130:133], a[4:7], v[194:197]
    v_mfma_f32_16x16x32_bf16 v[198:201], v[130:133], a[8:11], v[198:201]
    v_mfma_f32_16x16x32_bf16 v[202:205], v[130:133], a[12:15], v[202:205]
    v_mfma_f32_16x16x32_bf16 v[206:209], v[134:137], a[0:3], v[206:209]
    global_load_dwordx4 v[118:121], v30, s[54:55] offset:-3072 sc1
    v_mfma_f32_16x16x32_bf16 v[210:213], v[134:137], a[4:7], v[210:213]
    v_mfma_f32_16x16x32_bf16 v[214:217], v[134:137], a[8:11], v[214:217]
    s_waitcnt vmcnt(13)
    v_and_b32 v28, v65, v69
    v_mfma_f32_16x16x32_bf16 v[218:221], v[134:137], a[12:15], v[218:221]
    s_waitcnt vmcnt(11)
    v_bitop3_b32 v28, v73, v77, v28 bitop3:0x80
    v_mfma_f32_16x16x32_bf16 v[222:225], v[138:141], a[0:3], v[222:225]
    v_and_b32 v28, 1, v28
    global_load_dwordx4 v[122:125], v31, s[54:55] offset:-3072 sc1
    v_mfma_f32_16x16x32_bf16 v[226:229], v[138:141], a[4:7], v[226:229]
    v_cmp_ne_u32 vcc, 1, v28
    v_mfma_f32_16x16x32_bf16 v[230:233], v[138:141], a[8:11], v[230:233]
    v_mfma_f32_16x16x32_bf16 v[234:237], v[138:141], a[12:15], v[234:237]
    s_cbranch_vccnz Lz5_r
Lz5_ok:
    v_mfma_f32_16x16x32_bf16 v[238:241], v[62:65], a[0:3], v[238:241]
    global_load_dwordx4 v[126:129], v30, s[64:65] offset:-3072 sc1
    v_mfma_f32_16x16x32_bf16 v[242:245], v[62:65], a[4:7], v[242:245]
    v_mfma_f32_16x16x32_bf16 v[246:249], v[62:65], a[8:11], v[246:249]
    v_mfma_f32_16x16x32_bf16 v[250:253], v[62:65], a[12:15], v[250:253]
    v_mfma_f32_16x16x32_bf16 v[142:145], v[66:69], a[16:19], v[142:145]
    global_load_dwordx4 v[130:133], v31, s[64:65] offset:-3072 sc1
    v_mfma_f32_16x16x32_bf16 v[146:149], v[66:69], a[20:23], v[146:149]
    v_mfma_f32_16x16x32_bf16 v[150:153], v[66:69], a[24:27], v[150:153]
    v_mfma_f32_16x16x32_bf16 v[154:157], v[66:69], a[28:31], v[154:157]
    v_mfma_f32_16x16x32_bf16 v[158:161], v[70:73], a[16:19], v[158:161]
    global_load_dwordx4 v[134:137], v30, s[66:67] offset:-3072 sc1
    v_mfma_f32_16x16x32_bf16 v[162:165], v[70:73], a[20:23], v[162:165]
    v_mfma_f32_16x16x32_bf16 v[166:169], v[70:73], a[24:27], v[166:169]
    s_waitcnt vmcnt(13)
    v_and_b32 v28, v81, v85
    v_mfma_f32_16x16x32_bf16 v[170:173], v[70:73], a[28:31], v[170:173]
    s_waitcnt vmcnt(11)
    v_bitop3_b32 v28, v89, v93, v28 bitop3:0x80
    v_mfma_f32_16x16x32_bf16 v[174:177], v[74:77], a[16:19], v[174:177]
    v_and_b32 v28, 1, v28
    global_load_dwordx4 v[138:141], v31, s[66:67] offset:-3072 sc1
    v_mfma_f32_16x16x32_bf16 v[178:181], v[74:77], a[20:23], v[178:181]
    v_cmp_ne_u32 vcc, 1, v28
    v_mfma_f32_16x16x32_bf16 v[182:185], v[74:77], a[24:27], v[182:185]
    v_mfma_f32_16x16x32_bf16 v[186:189], v[74:77], a[28:31], v[186:189]
    s_cbranch_vccnz Lz6_r
Lz6_ok:
    v_mfma_f32_16x16x32_bf16 v[190:193], v[78:81], a[16:19], v[190:193]
    global_load_dwordx4 v[62:65], v30, s[60:61] offset:-2048 sc1
    v_mfma_f32_16x16x32_bf16 v[194:197], v[78:81], a[20:23], v[194:197]
    v_mfma_f32_16x16x32_bf16 v[198:201], v[78:81], a[24:27], v[198:201]
    v_mfma_f32_16x16x32_bf16 v[202:205], v[78:81], a[28:31], v[202:205]
    v_mfma_f32_16x16x32_bf16 v[206:209], v[82:85], a[16:19], v[206:209]
    global_load_dwordx4 v[66:69], v31, s[60:61] offset:-2048 sc1
    v_mfma_f32_16x16x32_bf16 v[210:213], v[82:85], a[20:23], v[210:213]
    v_mfma_f32_16x16x32_bf16 v[214:217], v[82:85], a[24:27], v[214:217]
    v_mfma_f32_16x16x32_bf16 v[218:221], v[82:85], a[28:31], v[218:221]
    v_mfma_f32_16x16x32_bf16 v[222:225], v[86:89], a[16:19], v[222:225]
    global_load_dwordx4 v[70:73], v30, s[62:63] offset:-2048 sc1
    v_mfma_f32_16x16x32_bf16 v[226:229], v[86:89], a[20:23], v[226:229]
    v_mfma_f32_16x16x32_bf16 v[230:233], v[86:89], a[24:27], v[230:233]
    s_waitcnt vmcnt(13)
    v_and_b32 v28, v97, v101
    v_mfma_f32_16x16x32_bf16 v[234:237], v[86:89], a[28:31], v[234:237]
    s_waitcnt vmcnt(11)
    v_bitop3_b32 v28, v105, v109, v28 bitop3:0x80
    v_mfma_f32_16x16x32_bf16 v[238:241], v[90:93], a[16:19], v[238:241]
    v_and_b32 v28, 1, v28
    global_load_dwordx4 v[74:77], v31, s[62:63] offset:-2048 sc1
    v_mfma_f32_16x16x32_bf16 v[242:245], v[90:93], a[20:23], v[242:245]
    v_cmp_ne_u32 vcc, 1, v28
    v_mfma_f32_16x16x32_bf16 v[246:249], v[90:93], a[24:27], v[246:249]
    v_mfma_f32_16x16x32_bf16 v[250:253], v[90:93], a[28:31], v[250:253]
    s_cbranch_vccnz Lz7_r
Lz7_ok:
    v_mfma_f32_16x16x32_bf16 v[142:145], v[94:97], a[32:35], v[142:145]
    global_load_dwordx4 v[78:81], v30, s[52:53] offset:-2048 sc1
    v_mfma_f32_16x16x32_bf16 v[146:149], v[94:97], a[36:39], v[146:149]
    v_mfma_f32_16x16x32_bf16 v[150:153], v[94:97], a[40:43], v[150:153]
    v_mfma_f32_16x16x32_bf16 v[154:157], v[94:97], a[44:47], v[154:157]
    v_mfma_f32_16x16x32_bf16 v[142:145], v[98:101], a[48:51], v[142:145]
    global_load_dwordx4 v[82:85], v31, s[52:53] offset:-2048 sc1
    v_mfma_f32_16x16x32_bf16 v[146:149], v[98:101], a[52:55], v[146:149]
    v_mfma_f32_16x16x32_bf16 v[150:153], v[98:101], a[56:59], v[150:153]
    v_mfma_f32_16x16x32_bf16 v[154:157], v[98:101], a[60:63], v[154:157]
    v_mfma_f32_16x16x32_bf16 v[142:145], v[102:105], a[64:67], v[142:145]
    global_load_dwordx4 v[86:89], v30, s[54:55] offset:-2048 sc1
    v_mfma_f32_16x16x32_bf16 v[146:149], v[102:105], a[68:71], v[146:149]
    v_mfma_f32_16x16x32_bf16 v[150:153], v[102:105], a[72:75], v[150:153]
    s_waitcnt vmcnt(13)
    v_and_b32 v28, v113, v117
    v_mfma_f32_16x16x32_bf16 v[154:157], v[102:105], a[76:79], v[154:157]
    s_waitcnt vmcnt(11)
    v_bitop3_b32 v28, v121, v125, v28 bitop3:0x80
    v_mfma_f32_16x16x32_bf16 v[142:145], v[106:109], a[80:83], v[142:145]
    v_and_b32 v28, 1, v28
    global_load_dwordx4 v[90:93], v31, s[54:55] offset:-2048 sc1
    v_mfma_f32_16x16x32_bf16 v[146:149], v[106:109], a[84:87], v[146:149]
    v_cmp_ne_u32 vcc, 1, v28
    v_mfma_f32_16x16x32_bf16 v[150:153], v[106:109], a[88:91], v[150:153]
    v_mfma_f32_16x16x32_bf16 v[154:157], v[106:109], a[92:95], v[154:157]
    s_cbranch_vccnz Lz8_r
Lz8_ok:
    v_mfma_f32_16x16x32_bf16 v[142:145], v[110:113], a[224:227], v[142:145]
    global_load_dwordx4 v[94:97], v30, s[64:65] offset:-2048 sc1
    v_mfma_f32_16x16x32_bf16 v[146:149], v[110:113], a[228:231], v[146:149]
    v_mfma_f32_16x16x32_bf16 v[150:153], v[110:113], a[232:235], v[150:153]
    v_mfma_f32_16x16x32_bf16 v[154:157], v[110:113], a[236:239], v[154:157]
    v_mfma_f32_16x16x32_bf16 v[142:145], v[114:117], a[240:243], v[142:145]
    global_load_dwordx4 v[98:101], v31, s[64:65] offset:-2048 sc1
    v_mfma_f32_16x16x32_bf16 v[146:149], v[114:117], a[244:247], v[146:149]
    v_mfma_f32_16x16x32_bf16 v[150:153], v[114:117], a[248:251], v[150:153]
    v_mfma_f32_16x16x32_bf16 v[154:157], v[114:117], a[252:255], v[154:157]
    v_mfma_f32_16x16x32_bf16 v[142:145], v[118:121], a[192:195], v[142:145]
    global_load_dwordx4 v[102:105], v30, s[66:67] offset:-2048 sc1
    v_mfma_f32_16x16x32_bf16 v[146:149], v[118:121], a[196:199], v[146:149]
    v_mfma_f32_16x16x32_bf16 v[150:153], v[118:121], a[200:203], v[150:153]
    s_waitcnt vmcnt(13)
    v_and_b32 v28, v129, v133
    v_mfma_f32_16x16x32_bf16 v[154:157], v[118:121], a[204:207], v[154:157]
    s_waitcnt vmcnt(11)
    v_bitop3_b32 v28, v137, v141, v28 bitop3:0x80
    v_mfma_f32_16x16x32_bf16 v[142:145], v[122:125], a[208:211], v[142:145]
    v_and_b32 v28, 1, v28
    global_load_dwordx4 v[106:109], v31, s[66:67] offset:-2048 sc1
    v_mfma_f32_16x16x32_bf16 v[146:149], v[122:125], a[212:215], v[146:149]
    v_cmp_ne_u32 vcc, 1, v28
    v_mfma_f32_16x16x32_bf16 v[150:153], v[122:125], a[216:219], v[150:153]
    v_mfma_f32_16x16x32_bf16 v[154:157], v[122:125], a[220:223], v[154:157]
    s_cbranch_vccnz Lz9_r
Lz9_ok:
    v_mfma_f32_16x16x32_bf16 v[142:145], v[126:129], a[96:99], v[142:145]
    global_load_dwordx4 v[110:113], v30, s[60:61] offset:-1024 sc1
    v_mfma_f32_16x16x32_bf16 v[146:149], v[126:129], a[100:103], v[146:149]
    v_mfma_f32_16x16x32_bf16 v[150:153], v[126:129], a[104:107], v[150:153]
    v_mfma_f32_16x16x32_bf16 v[154:157], v[126:129], a[108:111], v[154:157]
    v_mfma_f32_16x16x32_bf16 v[142:145], v[130:133], a[112:115], v[142:145]
    global_load_dwordx4 v[114:117], v31, s[60:61] offset:-1024 sc1
    v_mfma_f32_16x16x32_bf16 v[146:149], v[130:133], a[116:119], v[146:149]
    v_mfma_f32_16x16x32_bf16 v[150:153], v[130:133], a[120:123], v[150:153]
    v_mfma_f32_16x16x32_bf16 v[154:157], v[130:133], a[124:127], v[154:157]
    v_mfma_f32_16x16x32_bf16 v[142:145], v[134:137], a[128:131], v[142:145]
    global_load_dwordx4 v[118:121], v30, s[62:63] offset:-1024 sc1
    v_mfma_f32_16x16x32_bf16 v[146:149], v[134:137], a[132:135], v[146:149]
    v_mfma_f32_16x16x32_bf16 v[150:153], v[134:137], a[136:139], v[150:153]
    s_waitcnt vmcnt(13)
    v_and_b32 v28, v65, v69
    v_mfma_f32_16x16x32_bf16 v[154:157], v[134:137], a[140:143], v[154:157]
    s_waitcnt vmcnt(11)
    v_bitop3_b32 v28, v73, v77, v28 bitop3:0x80
    v_mfma_f32_16x16x32_bf16 v[142:145], v[138:141], a[144:147], v[142:145]
    v_and_b32 v28, 1, v28
    global_load_dwordx4 v[122:125], v31, s[62:63] offset:-1024 sc1
    v_mfma_f32_16x16x32_bf16 v[146:149], v[138:141], a[148:151], v[146:149]
    v_cmp_ne_u32 vcc, 1, v28
    v_mfma_f32_16x16x32_bf16 v[150:153], v[138:141], a[152:155], v[150:153]
    v_mfma_f32_16x16x32_bf16 v[154:157], v[138:141], a[156:159], v[154:157]
    s_cbranch_vccnz Lz10_r
Lz10_ok:
    v_mfma_f32_16x16x32_bf16 v[158:161], v[62:65], a[32:35], v[158:161]
    global_load_dwordx4 v[126:129], v30, s[52:53] offset:-1024 sc1
    v_mfma_f32_16x16x32_bf16 v[162:165], v[62:65], a[36:39], v[162:165]
    v_mfma_f32_16x16x32_bf16 v[166:169], v[62:65], a[40:43], v[166:169]
    v_mfma_f32_16x16x32_bf16 v[170:173], v[62:65], a[44:47], v[170:173]
    ds_write_b128 v20, v[146:149] offset:0
    v_mfma_f32_16x16x32_bf16 v[158:161], v[66:69], a[48:51], v[158:161]
    global_load_dwordx4 v[130:133], v31, s[52:53] offset:-1024 sc1
    v_mfma_f32_16x16x32_bf16 v[162:165], v[66:69], a[52:55], v[162:165]
    v_mfma_f32_16x16x32_bf16 v[166:169], v[66:69], a[56:59], v[166:169]
    ds_write_b128 v21, v[150:153] offset:0
    v_mfma_f32_16x16x32_bf16 v[170:173], v[66:69], a[60:63], v[170:173]
    v_mfma_f32_16x16x32_bf16 v[158:161], v[70:73], a[64:67], v[158:161]
    global_load_dwordx4 v[134:137], v30, s[54:55] offset:-1024 sc1
    v_mfma_f32_16x16x32_bf16 v[162:165], v[70:73], a[68:71], v[162:165]
    ds_write_b128 v22, v[154:157] offset:0
    v_mfma_f32_16x16x32_bf16 v[166:169], v[70:73], a[72:75], v[166:169]
    s_waitcnt vmcnt(13)
    v_and_b32 v28, v81, v85
    v_mfma_f32_16x16x32_bf16 v[170:173], v[70:73], a[76:79], v[170:173]
    s_waitcnt vmcnt(11)
    v_bitop3_b32 v28, v89, v93, v28 bitop3:0x80
    v_mfma_f32_16x16x32_bf16 v[158:161], v[74:77], a[80:83], v[158:161]
    v_and_b32 v28, 1, v28
    global_load_dwordx4 v[138:141], v31, s[54:55] offset:-1024 sc1
    v_mfma_f32_16x16x32_bf16 v[162:165], v[74:77], a[84:87], v[162:165]
    s_waitcnt lgkmcnt(0)
    s_barrier
    v_cmp_ne_u32 vcc, 1, v28
    v_mfma_f32_16x16x32_bf16 v[166:169], v[74:77], a[88:91], v[166:169]
    v_mfma_f32_16x16x32_bf16 v[170:173], v[74:77], a[92:95], v[170:173]
    s_cbranch_vccnz Lz11_r
Lz11_ok:
    v_mfma_f32_16x16x32_bf16 v[158:161], v[78:81], a[224:227], v[158:161]
    global_load_dwordx4 v[62:65], v30, s[64:65] offset:-1024 sc1
    ds_read_b128 v[146:149], v23 offset:0
    v_mfma_f32_16x16x32_bf16 v[162:165], v[78:81], a[228:231], v[162:165]
    ds_read_b128 v[150:153], v23 offset:1024
    v_mfma_f32_16x16x32_bf16 v[166:169], v[78:81], a[232:235], v[166:169]
    ds_read_b128 v[154:157], v23 offset:2048
    v_mfma_f32_16x16x32_bf16 v[170:173], v[78:81], a[236:239], v[170:173]
    v_lshlrev_b32 v12, 16, v48
    v_mfma_f32_16x16x32_bf16 v[158:161], v[82:85], a[240:243], v[158:161]
    global_load_dwordx4 v[66:69], v31, s[64:65] offset:-1024 sc1
    v_and_b32 v13, 0xffff0000, v48
    v_mfma_f32_16x16x32_bf16 v[162:165], v[82:85], a[244:247], v[162:165]
    v_mfma_f32_16x16x32_bf16 v[166:169], v[82:85], a[248:251], v[166:169]
    v_lshlrev_b32 v14, 16, v49
    v_mfma_f32_16x16x32_bf16 v[170:173], v[82:85], a[252:255], v[170:173]
    v_and_b32 v15, 0xffff0000, v49
    v_mfma_f32_16x16x32_bf16 v[158:161], v[86:89], a[192:195], v[158:161]
    global_load_dwordx4 v[70:73], v30, s[66:67] offset:-1024 sc1
    s_waitcnt lgkmcnt(0)
    v_add_f32 v142, v142, v146
    v_mfma_f32_16x16x32_bf16 v[162:165], v[86:89], a[196:199], v[162:165]
    v_add_f32 v143, v143, v147
    v_mfma_f32_16x16x32_bf16 v[166:169], v[86:89], a[200:203], v[166:169]
    s_waitcnt vmcnt(13)
    v_and_b32 v28, v97, v101
    v_mfma_f32_16x16x32_bf16 v[170:173], v[86:89], a[204:207], v[170:173]
    s_waitcnt vmcnt(11)
    v_bitop3_b32 v28, v105, v109, v28 bitop3:0x80
    v_add_f32 v144, v144, v148
    v_mfma_f32_16x16x32_bf16 v[158:161], v[90:93], a[208:211], v[158:161]
    v_and_b32 v28, 1, v28
    global_load_dwordx4 v[74:77], v31, s[66:67] offset:-1024 sc1
    v_mfma_f32_16x16x32_bf16 v[162:165], v[90:93], a[212:215], v[162:165]
    v_add_f32 v145, v145, v149
    v_cmp_ne_u32 vcc, 1, v28
    v_mfma_f32_16x16x32_bf16 v[166:169], v[90:93], a[216:219], v[166:169]
    v_add_f32 v142, v142, v150
    v_add_f32 v143, v143, v151
    v_mfma_f32_16x16x32_bf16 v[170:173], v[90:93], a[220:223], v[170:173]
    s_cbranch_vccnz Lz12_r
Lz12_ok:
    v_mfma_f32_16x16x32_bf16 v[158:161], v[94:97], a[96:99], v[158:161]
    global_load_dwordx4 v[78:81], v30, s[60:61] offset:0 sc1
    v_add_f32 v144, v144, v152
    v_mfma_f32_16x16x32_bf16 v[162:165], v[94:97], a[100:103], v[162:165]
    v_add_f32 v145, v145, v153
    v_mfma_f32_16x16x32_bf16 v[166:169], v[94:97], a[104:107], v[166:169]
    v_add_f32 v142, v142, v154
    v_mfma_f32_16x16x32_bf16 v[170:173], v[94:97], a[108:111], v[170:173]
    v_mfma_f32_16x16x32_bf16 v[158:161], v[98:101], a[112:115], v[158:161]
    global_load_dwordx4 v[82:85], v31, s[60:61] offset:0 sc1
    v_add_f32 v143, v143, v155
    v_mfma_f32_16x16x32_bf16 v[162:165], v[98:101], a[116:119], v[162:165]
    v_add_f32 v144, v144, v156
    v_mfma_f32_16x16x32_bf16 v[166:169], v[98:101], a[120:123], v[166:169]
    v_add_f32 v145, v145, v157
    v_mfma_f32_16x16x32_bf16 v[170:173], v[98:101], a[124:127], v[170:173]
    v_mfma_f32_16x16x32_bf16 v[158:161], v[102:105], a[128:131], v[158:161]
    global_load_dwordx4 v[86:89], v30, s[62:63] offset:0 sc1
    v_mul_f32 v142, v142, v12
    v_mfma_f32_16x16x32_bf16 v[162:165], v[102:105], a[132:135], v[162:165]
    v_mul_f32 v143, v143, v13
    v_mfma_f32_16x16x32_bf16 v[166:169], v[102:105], a[136:139], v[166:169]
    s_waitcnt vmcnt(13)
    v_and_b32 v28, v113, v117
    v_mul_f32 v144, v144, v14
    v_mfma_f32_16x16x32_bf16 v[170:173], v[102:105], a[140:143], v[170:173]
    s_waitcnt vmcnt(11)
    v_bitop3_b32 v28, v121, v125, v28 bitop3:0x80
    v_mfma_f32_16x16x32_bf16 v[158:161], v[106:109], a[144:147], v[158:161]
    v_and_b32 v28, 1, v28
    global_load_dwordx4 v[90:93], v31, s[62:63] offset:0 sc1
    v_mfma_f32_16x16x32_bf16 v[162:165], v[106:109], a[148:151], v[162:165]
    v_mul_f32 v145, v145, v15
    v_cmp_ne_u32 vcc, 1, v28
    v_mfma_f32_16x16x32_bf16 v[166:169], v[106:109], a[152:155], v[166:169]
    v_cvt_pk_bf16_f32 v48, v142, v143
    v_cvt_pk_bf16_f32 v49, v144, v145
    v_mfma_f32_16x16x32_bf16 v[170:173], v[106:109], a[156:159], v[170:173]
    s_cbranch_vccnz Lz13_r
Lz13_ok:
    v_mfma_f32_16x16x32_bf16 v[174:177], v[110:113], a[32:35], v[174:177]
    global_load_dwordx4 v[94:97], v30, s[52:53] offset:0 sc1
    v_mfma_f32_16x16x32_bf16 v[178:181], v[110:113], a[36:39], v[178:181]
    v_mfma_f32_16x16x32_bf16 v[182:185], v[110:113], a[40:43], v[182:185]
    v_mfma_f32_16x16x32_bf16 v[186:189], v[110:113], a[44:47], v[186:189]
    ds_write_b128 v20, v[162:165] offset:12288
    v_mfma_f32_16x16x32_bf16 v[174:177], v[114:117], a[48:51], v[174:177]
    global_load_dwordx4 v[98:101], v31, s[52:53] offset:0 sc1
    v_mfma_f32_16x16x32_bf16 v[178:181], v[114:117], a[52:55], v[178:181]
    v_mfma_f32_16x16x32_bf16 v[182:185], v[114:117], a[56:59], v[182:185]
    ds_write_b128 v21, v[166:169] offset:12288
    v_mfma_f32_16x16x32_bf16 v[186:189], v[114:117], a[60:63], v[186:189]
    v_mfma_f32_16x16x32_bf16 v[174:177], v[118:121], a[64:67], v[174:177]
    global_load_dwordx4 v[102:105], v30, s[54:55] offset:0 sc1
    v_mfma_f32_16x16x32_bf16 v[178:181], v[118:121], a[68:71], v[178:181]
    ds_write_b128 v22, v[170:173] offset:12288
    v_mfma_f32_16x16x32_bf16 v[182:185], v[118:121], a[72:75], v[182:185]
    s_waitcnt vmcnt(13)
    v_and_b32 v28, v129, v133
    v_mfma_f32_16x16x32_bf16 v[186:189], v[118:121], a[76:79], v[186:189]
    s_waitcnt vmcnt(11)
    v_bitop3_b32 v28, v137, v141, v28 bitop3:0x80
    v_mfma_f32_16x16x32_bf16 v[174:177], v[122:125], a[80:83], v[174:177]
    v_and_b32 v28, 1, v28
    global_load_dwordx4 v[106:109], v31, s[54:55] offset:0 sc1
    v_mfma_f32_16x16x32_bf16 v[178:181], v[122:125], a[84:87], v[178:181]
    s_waitcnt lgkmcnt(0)
    s_barrier
    v_cmp_ne_u32 vcc, 1, v28
    v_mfma_f32_16x16x32_bf16 v[182:185], v[122:125], a[88:91], v[182:185]
    v_mfma_f32_16x16x32_bf16 v[186:189], v[122:125], a[92:95], v[186:189]
    s_cbranch_vccnz Lz14_r
Lz14_ok:
    v_mfma_f32_16x16x32_bf16 v[174:177], v[126:129], a[224:227], v[174:177]
    global_load_dwordx4 v[110:113], v30, s[64:65] offset:0 sc1
    ds_read_b128 v[162:165], v23 offset:12288
    v_mfma_f32_16x16x32_bf16 v[178:181], v[126:129], a[228:231], v[178:181]
    ds_read_b128 v[166:169], v23 offset:13312
    v_mfma_f32_16x16x32_bf16 v[182:185], v[126:129], a[232:235], v[182:185]
    ds_read_b128 v[170:173], v23 offset:14336
    global_load_dwordx4 v[114:117], v31, s[64:65] offset:0 sc1
    v_mfma_f32_16x16x32_bf16 v[186:189], v[126:129], a[236:239], v[186:189]
    v_lshlrev_b32 v12, 16, v50
    v_mfma_f32_16x16x32_bf16 v[174:177], v[130:133], a[240:243], v[174:177]
    v_and_b32 v13, 0xffff0000, v50
    v_mfma_f32_16x16x32_bf16 v[178:181], v[130:133], a[244:247], v[178:181]
    global_load_dwordx4 v[118:121], v30, s[66:67] offset:0 sc1
    v_mfma_f32_16x16x32_bf16 v[182:185], v[130:133], a[248:251], v[182:185]
    v_lshlrev_b32 v14, 16, v51
    v_mfma_f32_16x16x32_bf16 v[186:189], v[130:133], a[252:255], v[186:189]
    v_and_b32 v15, 0xffff0000, v51
    v_mfma_f32_16x16x32_bf16 v[174:177], v[134:137], a[192:195], v[174:177]
    global_load_dwordx4 v[122:125], v31, s[66:67] offset:0 sc1
    s_waitcnt lgkmcnt(0)
    v_add_f32 v158, v158, v162
    v_mfma_f32_16x16x32_bf16 v[178:181], v[134:137], a[196:199], v[178:181]
    v_add_f32 v159, v159, v163
    v_mfma_f32_16x16x32_bf16 v[182:185], v[134:137], a[200:203], v[182:185]
    s_waitcnt vmcnt(14)
    v_and_b32 v28, v65, v69
    global_load_lds_dwordx4 v4, s[92:93] offset:2048 sc1
    v_mfma_f32_16x16x32_bf16 v[186:189], v[134:137], a[204:207], v[186:189]
    s_waitcnt vmcnt(13)
    v_bitop3_b32 v28, v73, v77, v28 bitop3:0x80
    v_add_f32 v160, v160, v164
    v_mfma_f32_16x16x32_bf16 v[174:177], v[138:141], a[208:211], v[174:177]
    v_and_b32 v28, 1, v28
    v_add_f32 v161, v161, v165
    v_mfma_f32_16x16x32_bf16 v[178:181], v[138:141], a[212:215], v[178:181]
    v_cmp_ne_u32 vcc, 1, v28
    global_load_lds_dwordx4 v4, s[92:93] offset:3072 sc1
    v_mfma_f32_16x16x32_bf16 v[182:185], v[138:141], a[216:219], v[182:185]
    v_add_f32 v158, v158, v166
    v_add_f32 v159, v159, v167
    v_mfma_f32_16x16x32_bf16 v[186:189], v[138:141], a[220:223], v[186:189]
    s_cbranch_vccnz Lz15_r
Lz15_ok:
    v_mfma_f32_16x16x32_bf16 v[174:177], v[62:65], a[96:99], v[174:177]
    global_load_dwordx4 v[126:129], v30, s[60:61] offset:1024 sc1
    v_add_f32 v160, v160, v168
    v_mfma_f32_16x16x32_bf16 v[178:181], v[62:65], a[100:103], v[178:181]
    v_add_f32 v161, v161, v169
    global_load_dwordx4 v[130:133], v31, s[60:61] offset:1024 sc1
    v_mfma_f32_16x16x32_bf16 v[182:185], v[62:65], a[104:107], v[182:185]
    v_add_f32 v158, v158, v170
    v_mfma_f32_16x16x32_bf16 v[186:189], v[62:65], a[108:111], v[186:189]
    global_load_dwordx4 v[134:137], v30, s[62:63] offset:1024 sc1
    v_add_f32 v159, v159, v171
    v_mfma_f32_16x16x32_bf16 v[174:177], v[66:69], a[112:115], v[174:177]
    v_add_f32 v160, v160, v172
    v_mfma_f32_16x16x32_bf16 v[178:181], v[66:69], a[116:119], v[178:181]
    global_load_dwordx4 v[138:141], v31, s[62:63] offset:1024 sc1
    v_mfma_f32_16x16x32_bf16 v[182:185], v[66:69], a[120:123], v[182:185]
    v_add_f32 v161, v161, v173
    v_mfma_f32_16x16x32_bf16 v[186:189], v[66:69], a[124:127], v[186:189]
    s_add_u32 m0, s95, 8192
    v_mul_f32 v158, v158, v12
    v_mfma_f32_16x16x32_bf16 v[174:177], v[70:73], a[128:131], v[174:177]
    v_mul_f32 v159, v159, v13
    s_add_u32 s92, s92, 4096
    s_addc_u32 s93, s93, 0
    v_mfma_f32_16x16x32_bf16 v[178:181], v[70:73], a[132:135], v[178:181]
    v_mul_f32 v160, v160, v14
    v_mfma_f32_16x16x32_bf16 v[182:185], v[70:73], a[136:139], v[182:185]
    s_waitcnt vmcnt(16)
    v_and_b32 v28, v81, v85
    v_mfma_f32_16x16x32_bf16 v[186:189], v[70:73], a[140:143], v[186:189]
    s_waitcnt vmcnt(14)
    v_bitop3_b32 v28, v89, v93, v28 bitop3:0x80
    v_mul_f32 v161, v161, v15
    v_mfma_f32_16x16x32_bf16 v[174:177], v[74:77], a[144:147], v[174:177]
    v_and_b32 v28, 1, v28
    v_cvt_pk_bf16_f32 v50, v158, v159
    v_mfma_f32_16x16x32_bf16 v[178:181], v[74:77], a[148:151], v[178:181]
    global_load_lds_dwordx4 v4, s[92:93] offset:0 sc1
    v_cmp_ne_u32 vcc, 1, v28
    v_mfma_f32_16x16x32_bf16 v[182:185], v[74:77], a[152:155], v[182:185]
    v_cvt_pk_bf16_f32 v51, v160, v161
    global_load_lds_dwordx4 v4, s[92:93] offset:1024 sc1
    v_mfma_f32_16x16x32_bf16 v[186:189], v[74:77], a[156:159], v[186:189]
    v_and_b32 v51, -2, v51
    s_cbranch_vccnz Lz16_r
Lz16_ok:
    v_mfma_f32_16x16x32_bf16 v[190:193], v[78:81], a[32:35], v[190:193]
    global_load_dwordx4 v[62:65], v30, s[52:53] offset:1024 sc1
    v_mfma_f32_16x16x32_bf16 v[194:197], v[78:81], a[36:39], v[194:197]
    v_mfma_f32_16x16x32_bf16 v[198:201], v[78:81], a[40:43], v[198:201]
    global_load_dwordx4 v[66:69], v31, s[52:53] offset:1024 sc1
    v_mfma_f32_16x16x32_bf16 v[202:205], v[78:81], a[44:47], v[202:205]
    ds_write_b128 v20, v[178:181] offset:0
    v_mfma_f32_16x16x32_bf16 v[190:193], v[82:85], a[48:51], v[190:193]
    v_mfma_f32_16x16x32_bf16 v[194:197], v[82:85], a[52:55], v[194:197]
    global_load_dwordx4 v[70:73], v30, s[54:55] offset:1024 sc1
    v_mfma_f32_16x16x32_bf16 v[198:201], v[82:85], a[56:59], v[198:201]
    ds_write_b128 v21, v[182:185] offset:0
    v_mfma_f32_16x16x32_bf16 v[202:205], v[82:85], a[60:63], v[202:205]
    v_mfma_f32_16x16x32_bf16 v[190:193], v[86:89], a[64:67], v[190:193]
    global_load_dwordx4 v[74:77], v31, s[54:55] offset:1024 sc1
    v_mfma_f32_16x16x32_bf16 v[194:197], v[86:89], a[68:71], v[194:197]
    ds_write_b128 v22, v[186:189] offset:0
    v_mfma_f32_16x16x32_bf16 v[198:201], v[86:89], a[72:75], v[198:201]
    s_waitcnt vmcnt(18)
    v_and_b32 v28, v97, v101
    global_load_lds_dwordx4 v4, s[92:93] offset:2048 sc1
    v_mfma_f32_16x16x32_bf16 v[202:205], v[86:89], a[76:79], v[202:205]
    s_waitcnt vmcnt(17)
    v_bitop3_b32 v28, v105, v109, v28 bitop3:0x80
    v_mfma_f32_16x16x32_bf16 v[190:193], v[90:93], a[80:83], v[190:193]
    v_and_b32 v28, 1, v28
    s_waitcnt lgkmcnt(0)
    s_barrier
    v_mfma_f32_16x16x32_bf16 v[194:197], v[90:93], a[84:87], v[194:197]
    v_cmp_ne_u32 vcc, 1, v28
    global_load_lds_dwordx4 v4, s[92:93] offset:3072 sc1
    v_mfma_f32_16x16x32_bf16 v[198:201], v[90:93], a[88:91], v[198:201]
    v_mfma_f32_16x16x32_bf16 v[202:205], v[90:93], a[92:95], v[202:205]
    s_cbranch_vccnz Lz17_r
Lz17_ok:
    v_mfma_f32_16x16x32_bf16 v[190:193], v[94:97], a[224:227], v[190:193]
    global_load_dwordx4 v[78:81], v30, s[64:65] offset:1024 sc1
    ds_read_b128 v[178:181], v23 offset:0
    v_mfma_f32_16x16x32_bf16 v[194:197], v[94:97], a[228:231], v[194:197]
    ds_read_b128 v[182:185], v23 offset:1024
    global_load_dwordx4 v[82:85], v31, s[64:65] offset:1024 sc1
    v_mfma_f32_16x16x32_bf16 v[198:201], v[94:97], a[232:235], v[198:201]
    ds_read_b128 v[186:189], v23 offset:2048
    v_mfma_f32_16x16x32_bf16 v[202:205], v[94:97], a[236:239], v[202:205]
    global_load_dwordx4 v[86:89], v30, s[66:67] offset:1024 sc1
    v_lshlrev_b32 v12, 16, v52
    v_mfma_f32_16x16x32_bf16 v[190:193], v[98:101], a[240:243], v[190:193]
    v_and_b32 v13, 0xffff0000, v52
    v_mfma_f32_16x16x32_bf16 v[194:197], v[98:101], a[244:247], v[194:197]
    global_load_dwordx4 v[90:93], v31, s[66:67] offset:1024 sc1
    v_mfma_f32_16x16x32_bf16 v[198:201], v[98:101], a[248:251], v[198:201]
    v_lshlrev_b32 v14, 16, v53
    v_mfma_f32_16x16x32_bf16 v[202:205], v[98:101], a[252:255], v[202:205]
    s_add_u32 m0, s95, 12288
    v_and_b32 v15, 0xffff0000, v53
    v_mfma_f32_16x16x32_bf16 v[190:193], v[102:105], a[192:195], v[190:193]
    s_waitcnt lgkmcnt(0)
    v_add_f32 v174, v174, v178
    s_add_u32 s92, s92, 4096
    s_addc_u32 s93, s93, 0
    v_mfma_f32_16x16x32_bf16 v[194:197], v[102:105], a[196:199], v[194:197]
    v_add_f32 v175, v175, v179
    v_mfma_f32_16x16x32_bf16 v[198:201], v[102:105], a[200:203], v[198:201]
    s_waitcnt vmcnt(20)
    v_and_b32 v28, v113, v117
    v_mfma_f32_16x16x32_bf16 v[202:205], v[102:105], a[204:207], v[202:205]
    s_waitcnt vmcnt(18)
    v_bitop3_b32 v28, v121, v125, v28 bitop3:0x80
    v_add_f32 v176, v176, v180
    v_mfma_f32_16x16x32_bf16 v[190:193], v[106:109], a[208:211], v[190:193]
    v_and_b32 v28, 1, v28
    v_add_f32 v177, v177, v181
    v_mfma_f32_16x16x32_bf16 v[194:197], v[106:109], a[212:215], v[194:197]
    global_load_lds_dwordx4 v4, s[92:93] offset:0 sc1
    v_cmp_ne_u32 vcc, 1, v28
    v_mfma_f32_16x16x32_bf16 v[198:201], v[106:109], a[216:219], v[198:201]
    v_add_f32 v174, v174, v182
    global_load_lds_dwordx4 v4, s[92:93] offset:1024 sc1
    v_mfma_f32_16x16x32_bf16 v[202:205], v[106:109], a[220:223], v[202:205]
    v_add_f32 v175, v175, v183
    s_cbranch_vccnz Lz18_r
Lz18_ok:
    v_mfma_f32_16x16x32_bf16 v[190:193], v[110:113], a[96:99], v[190:193]
    global_load_dwordx4 v[94:97], v30, s[60:61] offset:2048 sc1
    v_add_f32 v176, v176, v184
    v_mfma_f32_16x16x32_bf16 v[194:197], v[110:113], a[100:103], v[194:197]
    v_add_f32 v177, v177, v185
    v_mfma_f32_16x16x32_bf16 v[198:201], v[110:113], a[104:107], v[198:201]
    global_load_dwordx4 v[98:101], v31, s[60:61] offset:2048 sc1
    v_add_f32 v174, v174, v186
    v_mfma_f32_16x16x32_bf16 v[202:205], v[110:113], a[108:111], v[202:205]
    v_mfma_f32_16x16x32_bf16 v[190:193], v[114:117], a[112:115], v[190:193]
    v_add_f32 v175, v175, v187
    v_mfma_f32_16x16x32_bf16 v[194:197], v[114:117], a[116:119], v[194:197]
    global_load_dwordx4 v[102:105], v30, s[62:63] offset:2048 sc1
    v_add_f32 v176, v176, v188
    v_mfma_f32_16x16x32_bf16 v[198:201], v[114:117], a[120:123], v[198:201]
    v_add_f32 v177, v177, v189
    v_mfma_f32_16x16x32_bf16 v[202:205], v[114:117], a[124:127], v[202:205]
    v_mfma_f32_16x16x32_bf16 v[190:193], v[118:121], a[128:131], v[190:193]
    global_load_dwordx4 v[106:109], v31, s[62:63] offset:2048 sc1
    v_mul_f32 v174, v174, v12
    v_mfma_f32_16x16x32_bf16 v[194:197], v[118:121], a[132:135], v[194:197]
    v_mul_f32 v175, v175, v13
    v_mfma_f32_16x16x32_bf16 v[198:201], v[118:121], a[136:139], v[198:201]
    s_waitcnt vmcnt(20)
    v_and_b32 v28, v129, v133
    global_load_lds_dwordx4 v4, s[92:93] offset:2048 sc1
    v_mfma_f32_16x16x32_bf16 v[202:205], v[118:121], a[140:143], v[202:205]
    s_waitcnt vmcnt(19)
    v_bitop3_b32 v28, v137, v141, v28 bitop3:0x80
    v_mul_f32 v176, v176, v14
    v_mfma_f32_16x16x32_bf16 v[190:193], v[122:125], a[144:147], v[190:193]
    v_and_b32 v28, 1, v28
    v_mul_f32 v177, v177, v15
    v_mfma_f32_16x16x32_bf16 v[194:197], v[122:125], a[148:151], v[194:197]
    v_cmp_ne_u32 vcc, 1, v28
    global_load_lds_dwordx4 v4, s[92:93] offset:3072 sc1
    v_mfma_f32_16x16x32_bf16 v[198:201], v[122:125], a[152:155], v[198:201]
    v_cvt_pk_bf16_f32 v52, v174, v175
    v_cvt_pk_bf16_f32 v53, v176, v177
    v_mfma_f32_16x16x32_bf16 v[202:205], v[122:125], a[156:159], v[202:205]
    s_cbranch_vccnz Lz19_r
Lz19_ok:
    v_mfma_f32_16x16x32_bf16 v[206:209], v[126:129], a[32:35], v[206:209]
    global_load_dwordx4 v[110:113], v30, s[52:53] offset:2048 sc1
    v_mfma_f32_16x16x32_bf16 v[210:213], v[126:129], a[36:39], v[210:213]
    global_load_dwordx4 v[114:117], v31, s[52:53] offset:2048 sc1
    v_mfma_f32_16x16x32_bf16 v[214:217], v[126:129], a[40:43], v[214:217]
    v_mfma_f32_16x16x32_bf16 v[218:221], v[126:129], a[44:47], v[218:221]
    ds_write_b128 v20, v[194:197] offset:12288
    v_mfma_f32_16x16x32_bf16 v[206:209], v[130:133], a[48:51], v[206:209]
    global_load_dwordx4 v[118:121], v30, s[54:55] offset:2048 sc1
    v_mfma_f32_16x16x32_bf16 v[210:213], v[130:133], a[52:55], v[210:213]
    global_load_dwordx4 v[122:125], v31, s[54:55] offset:2048 sc1
    v_mfma_f32_16x16x32_bf16 v[214:217], v[130:133], a[56:59], v[214:217]
    ds_write_b128 v21, v[198:201] offset:12288
    v_mfma_f32_16x16x32_bf16 v[218:221], v[130:133], a[60:63], v[218:221]
    s_add_u32 m0, s95, 16384
    v_mfma_f32_16x16x32_bf16 v[206:209], v[134:137], a[64:67], v[206:209]
    s_add_u32 s92, s92, 4096
    s_addc_u32 s93, s93, 0
    v_mfma_f32_16x16x32_bf16 v[210:213], v[134:137], a[68:71], v[210:213]
    ds_write_b128 v22, v[202:205] offset:12288
    v_mfma_f32_16x16x32_bf16 v[214:217], v[134:137], a[72:75], v[214:217]
    s_waitcnt vmcnt(20)
    v_and_b32 v28, v65, v69
    v_mfma_f32_16x16x32_bf16 v[218:221], v[134:137], a[76:79], v[218:221]
    s_waitcnt vmcnt(18)
    v_bitop3_b32 v28, v73, v77, v28 bitop3:0x80
    v_mfma_f32_16x16x32_bf16 v[206:209], v[138:141], a[80:83], v[206:209]
    v_and_b32 v28, 1, v28
    global_load_lds_dwordx4 v4, s[92:93] offset:0 sc1
    v_mfma_f32_16x16x32_bf16 v[210:213], v[138:141], a[84:87], v[210:213]
    s_waitcnt lgkmcnt(0)
    s_barrier
    v_cmp_ne_u32 vcc, 1, v28
    v_mfma_f32_16x16x32_bf16 v[214:217], v[138:141], a[88:91], v[214:217]
    global_load_lds_dwordx4 v4, s[92:93] offset:1024 sc1
    v_mfma_f32_16x16x32_bf16 v[218:221], v[138:141], a[92:95], v[218:221]
    s_cbranch_vccnz Lz20_r
Lz20_ok:
    v_mfma_f32_16x16x32_bf16 v[206:209], v[62:65], a[224:227], v[206:209]
    global_load_dwordx4 v[126:129], v30, s[64:65] offset:2048 sc1
    ds_read_b128 v[194:197], v23 offset:12288
    v_mfma_f32_16x16x32_bf16 v[210:213], v[62:65], a[228:231], v[210:213]
    ds_read_b128 v[198:201], v23 offset:13312
    v_mfma_f32_16x16x32_bf16 v[214:217], v[62:65], a[232:235], v[214:217]
    ds_read_b128 v[202:205], v23 offset:14336
    global_load_dwordx4 v[130:133], v31, s[64:65] offset:2048 sc1
    v_mfma_f32_16x16x32_bf16 v[218:221], v[62:65], a[236:239], v[218:221]
    v_lshlrev_b32 v12, 16, v54
    v_mfma_f32_16x16x32_bf16 v[206:209], v[66:69], a[240:243], v[206:209]
    v_and_b32 v13, 0xffff0000, v54
    v_mfma_f32_16x16x32_bf16 v[210:213], v[66:69], a[244:247], v[210:213]
    global_load_dwordx4 v[134:137], v30, s[66:67] offset:2048 sc1
    v_mfma_f32_16x16x32_bf16 v[214:217], v[66:69], a[248:251], v[214:217]
    v_lshlrev_b32 v14, 16, v55
    v_mfma_f32_16x16x32_bf16 v[218:221], v[66:69], a[252:255], v[218:221]
    v_and_b32 v15, 0xffff0000, v55
    v_mfma_f32_16x16x32_bf16 v[206:209], v[70:73], a[192:195], v[206:209]
    global_load_dwordx4 v[138:141], v31, s[66:67] offset:2048 sc1
    s_waitcnt lgkmcnt(0)
    v_add_f32 v190, v190, v194
    v_mfma_f32_16x16x32_bf16 v[210:213], v[70:73], a[196:199], v[210:213]
    v_add_f32 v191, v191, v195
    v_mfma_f32_16x16x32_bf16 v[214:217], v[70:73], a[200:203], v[214:217]
    s_waitcnt vmcnt(20)
    v_and_b32 v28, v81, v85
    global_load_lds_dwordx4 v4, s[92:93] offset:2048 sc1
    v_mfma_f32_16x16x32_bf16 v[218:221], v[70:73], a[204:207], v[218:221]
    s_waitcnt vmcnt(19)
    v_bitop3_b32 v28, v89, v93, v28 bitop3:0x80
    v_add_f32 v192, v192, v196
    v_mfma_f32_16x16x32_bf16 v[206:209], v[74:77], a[208:211], v[206:209]
    v_and_b32 v28, 1, v28
    v_add_f32 v193, v193, v197
    v_mfma_f32_16x16x32_bf16 v[210:213], v[74:77], a[212:215], v[210:213]
    v_cmp_ne_u32 vcc, 1, v28
    global_load_lds_dwordx4 v4, s[92:93] offset:3072 sc1
    v_mfma_f32_16x16x32_bf16 v[214:217], v[74:77], a[216:219], v[214:217]
    v_add_f32 v190, v190, v198
    v_add_f32 v191, v191, v199
    v_mfma_f32_16x16x32_bf16 v[218:221], v[74:77], a[220:223], v[218:221]
    s_cbranch_vccnz Lz21_r
Lz21_ok:
    v_mfma_f32_16x16x32_bf16 v[206:209], v[78:81], a[96:99], v[206:209]
    global_load_dwordx4 v[62:65], v30, s[60:61] offset:3072 sc1
    v_add_f32 v192, v192, v200
    v_mfma_f32_16x16x32_bf16 v[210:213], v[78:81], a[100:103], v[210:213]
    v_add_f32 v193, v193, v201
    global_load_dwordx4 v[66:69], v31, s[60:61] offset:3072 sc1
    v_mfma_f32_16x16x32_bf16 v[214:217], v[78:81], a[104:107], v[214:217]
    v_add_f32 v190, v190, v202
    v_mfma_f32_16x16x32_bf16 v[218:221], v[78:81], a[108:111], v[218:221]
    global_load_dwordx4 v[70:73], v30, s[62:63] offset:3072 sc1
    v_add_f32 v191, v191, v203
    v_mfma_f32_16x16x32_bf16 v[206:209], v[82:85], a[112:115], v[206:209]
    v_add_f32 v192, v192, v204
    v_mfma_f32_16x16x32_bf16 v[210:213], v[82:85], a[116:119], v[210:213]
    global_load_dwordx4 v[74:77], v31, s[62:63] offset:3072 sc1
    v_mfma_f32_16x16x32_bf16 v[214:217], v[82:85], a[120:123], v[214:217]
    v_add_f32 v193, v193, v205
    v_mfma_f32_16x16x32_bf16 v[218:221], v[82:85], a[124:127], v[218:221]
    s_add_u32 m0, s95, 20480
    v_mul_f32 v190, v190, v12
    v_mfma_f32_16x16x32_bf16 v[206:209], v[86:89], a[128:131], v[206:209]
    v_mul_f32 v191, v191, v13
    s_add_u32 s92, s92, 4096
    s_addc_u32 s93, s93, 0
    v_mfma_f32_16x16x32_bf16 v[210:213], v[86:89], a[132:135], v[210:213]
    v_mul_f32 v192, v192, v14
    v_mfma_f32_16x16x32_bf16 v[214:217], v[86:89], a[136:139], v[214:217]
    s_waitcnt vmcnt(20)
    v_and_b32 v28, v97, v101
    v_mfma_f32_16x16x32_bf16 v[218:221], v[86:89], a[140:143], v[218:221]
    s_waitcnt vmcnt(18)
    v_bitop3_b32 v28, v105, v109, v28 bitop3:0x80
    v_mul_f32 v193, v193, v15
    v_mfma_f32_16x16x32_bf16 v[206:209], v[90:93], a[144:147], v[206:209]
    v_and_b32 v28, 1, v28
    v_cvt_pk_bf16_f32 v54, v190, v191
    v_mfma_f32_16x16x32_bf16 v[210:213], v[90:93], a[148:151], v[210:213]
    global_load_lds_dwordx4 v4, s[92:93] offset:0 sc1
    v_cmp_ne_u32 vcc, 1, v28
    v_mfma_f32_16x16x32_bf16 v[214:217], v[90:93], a[152:155], v[214:217]
    v_cvt_pk_bf16_f32 v55, v192, v193
    global_load_lds_dwordx4 v4, s[92:93] offset:1024 sc1
    v_mfma_f32_16x16x32_bf16 v[218:221], v[90:93], a[156:159], v[218:221]
    v_and_b32 v55, -2, v55
    s_cbranch_vccnz Lz22_r
Lz22_ok:
    v_mfma_f32_16x16x32_bf16 v[222:225], v[94:97], a[32:35], v[222:225]
    global_load_dwordx4 v[78:81], v30, s[52:53] offset:3072 sc1
    v_mfma_f32_16x16x32_bf16 v[226:229], v[94:97], a[36:39], v[226:229]
    v_mfma_f32_16x16x32_bf16 v[230:233], v[94:97], a[40:43], v[230:233]
    global_load_dwordx4 v[82:85], v31, s[52:53] offset:3072 sc1
    v_mfma_f32_16x16x32_bf16 v[234:237], v[94:97], a[44:47], v[234:237]
    ds_write_b128 v20, v[210:213] offset:0
    v_mfma_f32_16x16x32_bf16 v[222:225], v[98:101], a[48:51], v[222:225]
    global_load_dwordx4 v[86:89], v30, s[54:55] offset:3072 sc1
    v_mfma_f32_16x16x32_bf16 v[226:229], v[98:101], a[52:55], v[226:229]
    v_mfma_f32_16x16x32_bf16 v[230:233], v[98:101], a[56:59], v[230:233]
    global_load_dwordx4 v[90:93], v31, s[54:55] offset:3072 sc1
    v_mfma_f32_16x16x32_bf16 v[234:237], v[98:101], a[60:63], v[234:237]
    ds_write_b128 v21, v[214:217] offset:0
    v_mfma_f32_16x16x32_bf16 v[222:225], v[102:105], a[64:67], v[222:225]
    global_store_dwordx4 v6, v[48:51], s[8:9] offset:-4096 sc1
    v_mfma_f32_16x16x32_bf16 v[226:229], v[102:105], a[68:71], v[226:229]
    ds_write_b128 v22, v[218:221] offset:0
    v_mfma_f32_16x16x32_bf16 v[230:233], v[102:105], a[72:75], v[230:233]
    s_waitcnt vmcnt(21)
    v_and_b32 v28, v113, v117
    global_store_dwordx4 v7, v[52:55], s[8:9] offset:-4096 sc1
    v_mfma_f32_16x16x32_bf16 v[234:237], v[102:105], a[76:79], v[234:237]
    s_waitcnt vmcnt(20)
    v_bitop3_b32 v28, v121, v125, v28 bitop3:0x80
    v_mfma_f32_16x16x32_bf16 v[222:225], v[106:109], a[80:83], v[222:225]
    v_and_b32 v28, 1, v28
    global_load_lds_dwordx4 v4, s[92:93] offset:2048 sc1
    v_mfma_f32_16x16x32_bf16 v[226:229], v[106:109], a[84:87], v[226:229]
    s_waitcnt lgkmcnt(0)
    s_barrier
    v_cmp_ne_u32 vcc, 1, v28
    v_mfma_f32_16x16x32_bf16 v[230:233], v[106:109], a[88:91], v[230:233]
    global_load_lds_dwordx4 v4, s[92:93] offset:3072 sc1
    v_mfma_f32_16x16x32_bf16 v[234:237], v[106:109], a[92:95], v[234:237]
    s_cbranch_vccnz Lz23_r
Lz23_ok:
    v_mfma_f32_16x16x32_bf16 v[222:225], v[110:113], a[224:227], v[222:225]
    global_load_dwordx4 v[94:97], v30, s[64:65] offset:3072 sc1
    ds_read_b128 v[210:213], v23 offset:0
    v_mfma_f32_16x16x32_bf16 v[226:229], v[110:113], a[228:231], v[226:229]
    ds_read_b128 v[214:217], v23 offset:1024
    global_load_dwordx4 v[98:101], v31, s[64:65] offset:3072 sc1
    v_mfma_f32_16x16x32_bf16 v[230:233], v[110:113], a[232:235], v[230:233]
    ds_read_b128 v[218:221], v23 offset:2048
    v_mfma_f32_16x16x32_bf16 v[234:237], v[110:113], a[236:239], v[234:237]
    global_load_dwordx4 v[102:105], v30, s[66:67] offset:3072 sc1
    v_lshlrev_b32 v12, 16, v56
    v_mfma_f32_16x16x32_bf16 v[222:225], v[114:117], a[240:243], v[222:225]
    v_and_b32 v13, 0xffff0000, v56
    v_mfma_f32_16x16x32_bf16 v[226:229], v[114:117], a[244:247], v[226:229]
    global_load_dwordx4 v[106:109], v31, s[66:67] offset:3072 sc1
    v_mfma_f32_16x16x32_bf16 v[230:233], v[114:117], a[248:251], v[230:233]
    v_lshlrev_b32 v14, 16, v57
    v_mfma_f32_16x16x32_bf16 v[234:237], v[114:117], a[252:255], v[234:237]
    s_add_u32 m0, s95, 24576
    v_and_b32 v15, 0xffff0000, v57
    v_mfma_f32_16x16x32_bf16 v[222:225], v[118:121], a[192:195], v[222:225]
    s_waitcnt lgkmcnt(0)
    v_add_f32 v206, v206, v210
    s_add_u32 s92, s92, 4096
    s_addc_u32 s93, s93, 0
    v_mfma_f32_16x16x32_bf16 v[226:229], v[118:121], a[196:199], v[226:229]
    v_add_f32 v207, v207, v211
    v_mfma_f32_16x16x32_bf16 v[230:233], v[118:121], a[200:203], v[230:233]
    s_waitcnt vmcnt(22)
    v_and_b32 v28, v129, v133
    v_mfma_f32_16x16x32_bf16 v[234:237], v[118:121], a[204:207], v[234:237]
    s_waitcnt vmcnt(20)
    v_bitop3_b32 v28, v137, v141, v28 bitop3:0x80
    v_add_f32 v208, v208, v212
    v_mfma_f32_16x16x32_bf16 v[222:225], v[122:125], a[208:211], v[222:225]
    v_and_b32 v28, 1, v28
    v_add_f32 v209, v209, v213
    v_mfma_f32_16x16x32_bf16 v[226:229], v[122:125], a[212:215], v[226:229]
    global_load_lds_dwordx4 v4, s[92:93] offset:0 sc1
    v_cmp_ne_u32 vcc, 1, v28
    v_mfma_f32_16x16x32_bf16 v[230:233], v[122:125], a[216:219], v[230:233]
    v_add_f32 v206, v206, v214
    global_load_lds_dwordx4 v4, s[92:93] offset:1024 sc1
    v_mfma_f32_16x16x32_bf16 v[234:237], v[122:125], a[220:223], v[234:237]
    v_add_f32 v207, v207, v215
    s_cbranch_vccnz Lz24_r
Lz24_ok:
    v_mfma_f32_16x16x32_bf16 v[222:225], v[126:129], a[96:99], v[222:225]
    global_load_lds_dwordx4 v4, s[92:93] offset:2048 sc1
    v_add_f32 v208, v208, v216
    v_mfma_f32_16x16x32_bf16 v[226:229], v[126:129], a[100:103], v[226:229]
    v_add_f32 v209, v209, v217
    v_mfma_f32_16x16x32_bf16 v[230:233], v[126:129], a[104:107], v[230:233]
    v_add_f32 v206, v206, v218
    v_mfma_f32_16x16x32_bf16 v[234:237], v[126:129], a[108:111], v[234:237]
    v_mfma_f32_16x16x32_bf16 v[222:225], v[130:133], a[112:115], v[222:225]
    v_add_f32 v207, v207, v219
    v_mfma_f32_16x16x32_bf16 v[226:229], v[130:133], a[116:119], v[226:229]
    v_add_f32 v208, v208, v220
    v_mfma_f32_16x16x32_bf16 v[230:233], v[130:133], a[120:123], v[230:233]
    v_add_f32 v209, v209, v221
    v_mfma_f32_16x16x32_bf16 v[234:237], v[130:133], a[124:127], v[234:237]
    v_mfma_f32_16x16x32_bf16 v[222:225], v[134:137], a[128:131], v[222:225]
    global_load_lds_dwordx4 v4, s[92:93] offset:3072 sc1
    v_mul_f32 v206, v206, v12
    v_mfma_f32_16x16x32_bf16 v[226:229], v[134:137], a[132:135], v[226:229]
    v_mul_f32 v207, v207, v13
    v_mfma_f32_16x16x32_bf16 v[230:233], v[134:137], a[136:139], v[230:233]
    s_waitcnt vmcnt(20)
    v_and_b32 v28, v65, v69
    v_mul_f32 v208, v208, v14
    v_mfma_f32_16x16x32_bf16 v[234:237], v[134:137], a[140:143], v[234:237]
    s_waitcnt vmcnt(18)
    v_bitop3_b32 v28, v73, v77, v28 bitop3:0x80
    v_mfma_f32_16x16x32_bf16 v[222:225], v[138:141], a[144:147], v[222:225]
    v_and_b32 v28, 1, v28
    v_mul_f32 v209, v209, v15
    v_mfma_f32_16x16x32_bf16 v[226:229], v[138:141], a[148:151], v[226:229]
    v_cmp_ne_u32 vcc, 1, v28
    v_cvt_pk_bf16_f32 v56, v206, v207
    v_mfma_f32_16x16x32_bf16 v[230:233], v[138:141], a[152:155], v[230:233]
    v_cvt_pk_bf16_f32 v57, v208, v209
    v_mfma_f32_16x16x32_bf16 v[234:237], v[138:141], a[156:159], v[234:237]
    s_cbranch_vccnz Lz25_r
Lz25_ok:
    v_mfma_f32_16x16x32_bf16 v[238:241], v[62:65], a[32:35], v[238:241]
    s_add_u32 m0, s95, 28672
    v_mfma_f32_16x16x32_bf16 v[242:245], v[62:65], a[36:39], v[242:245]
    v_mfma_f32_16x16x32_bf16 v[246:249], v[62:65], a[40:43], v[246:249]
    v_mfma_f32_16x16x32_bf16 v[250:253], v[62:65], a[44:47], v[250:253]
    ds_write_b128 v20, v[226:229] offset:12288
    v_mfma_f32_16x16x32_bf16 v[238:241], v[66:69], a[48:51], v[238:241]
    s_add_u32 s92, s92, 4096
    s_addc_u32 s93, s93, 0
    v_mfma_f32_16x16x32_bf16 v[242:245], v[66:69], a[52:55], v[242:245]
    v_mfma_f32_16x16x32_bf16 v[246:249], v[66:69], a[56:59], v[246:249]
    ds_write_b128 v21, v[230:233] offset:12288
    v_mfma_f32_16x16x32_bf16 v[250:253], v[66:69], a[60:63], v[250:253]
    v_mfma_f32_16x16x32_bf16 v[238:241], v[70:73], a[64:67], v[238:241]
    v_mfma_f32_16x16x32_bf16 v[242:245], v[70:73], a[68:71], v[242:245]
    ds_write_b128 v22, v[234:237] offset:12288
    v_mfma_f32_16x16x32_bf16 v[246:249], v[70:73], a[72:75], v[246:249]
    s_waitcnt vmcnt(14)
    v_and_b32 v28, v81, v85
    global_load_lds_dwordx4 v4, s[92:93] offset:0 sc1
    v_mfma_f32_16x16x32_bf16 v[250:253], v[70:73], a[76:79], v[250:253]
    s_waitcnt vmcnt(13)
    v_bitop3_b32 v28, v89, v93, v28 bitop3:0x80
    v_mfma_f32_16x16x32_bf16 v[238:241], v[74:77], a[80:83], v[238:241]
    v_and_b32 v28, 1, v28
    s_waitcnt lgkmcnt(0)
    s_barrier
    v_mfma_f32_16x16x32_bf16 v[242:245], v[74:77], a[84:87], v[242:245]
    global_load_lds_dwordx4 v4, s[92:93] offset:1024 sc1
    v_cmp_ne_u32 vcc, 1, v28
    v_mfma_f32_16x16x32_bf16 v[246:249], v[74:77], a[88:91], v[246:249]
    v_mfma_f32_16x16x32_bf16 v[250:253], v[74:77], a[92:95], v[250:253]
    s_cbranch_vccnz Lz26_r
Lz26_ok:
    v_mfma_f32_16x16x32_bf16 v[238:241], v[78:81], a[224:227], v[238:241]
    global_load_lds_dwordx4 v4, s[92:93] offset:2048 sc1
    ds_read_b128 v[226:229], v23 offset:12288
    v_mfma_f32_16x16x32_bf16 v[242:245], v[78:81], a[228:231], v[242:245]
    ds_read_b128 v[230:233], v23 offset:13312
    v_mfma_f32_16x16x32_bf16 v[246:249], v[78:81], a[232:235], v[246:249]
    ds_read_b128 v[234:237], v23 offset:14336
    v_mfma_f32_16x16x32_bf16 v[250:253], v[78:81], a[236:239], v[250:253]
    v_lshlrev_b32 v12, 16, v58
    v_mfma_f32_16x16x32_bf16 v[238:241], v[82:85], a[240:243], v[238:241]
    v_and_b32 v13, 0xffff0000, v58
    v_mfma_f32_16x16x32_bf16 v[242:245], v[82:85], a[244:247], v[242:245]
    v_mfma_f32_16x16x32_bf16 v[246:249], v[82:85], a[248:251], v[246:249]
    v_lshlrev_b32 v14, 16, v59
    v_mfma_f32_16x16x32_bf16 v[250:253], v[82:85], a[252:255], v[250:253]
    v_and_b32 v15, 0xffff0000, v59
    v_mfma_f32_16x16x32_bf16 v[238:241], v[86:89], a[192:195], v[238:241]
    global_load_lds_dwordx4 v4, s[92:93] offset:3072 sc1
    s_waitcnt lgkmcnt(0)
    v_add_f32 v222, v222, v226
    v_mfma_f32_16x16x32_bf16 v[242:245], v[86:89], a[196:199], v[242:245]
    v_add_f32 v223, v223, v227
    v_mfma_f32_16x16x32_bf16 v[246:249], v[86:89], a[200:203], v[246:249]
    s_waitcnt vmcnt(10)
    v_and_b32 v28, v97, v101
    v_mfma_f32_16x16x32_bf16 v[250:253], v[86:89], a[204:207], v[250:253]
    s_waitcnt vmcnt(8)
    v_bitop3_b32 v28, v105, v109, v28 bitop3:0x80
    v_add_f32 v224, v224, v228
    v_mfma_f32_16x16x32_bf16 v[238:241], v[90:93], a[208:211], v[238:241]
    v_and_b32 v28, 1, v28
    v_add_f32 v225, v225, v229
    v_mfma_f32_16x16x32_bf16 v[242:245], v[90:93], a[212:215], v[242:245]
    v_cmp_ne_u32 vcc, 1, v28
    v_add_f32 v222, v222, v230
    v_mfma_f32_16x16x32_bf16 v[246:249], v[90:93], a[216:219], v[246:249]
    v_add_f32 v223, v223, v231
    v_mfma_f32_16x16x32_bf16 v[250:253], v[90:93], a[220:223], v[250:253]
    s_cbranch_vccnz Lz27_r
Lz27_ok:
    v_mfma_f32_16x16x32_bf16 v[238:241], v[94:97], a[96:99], v[238:241]
    s_add_u32 m0, s95, 32768
    v_add_f32 v224, v224, v232
    v_mfma_f32_16x16x32_bf16 v[242:245], v[94:97], a[100:103], v[242:245]
    v_add_f32 v225, v225, v233
    v_mfma_f32_16x16x32_bf16 v[246:249], v[94:97], a[104:107], v[246:249]
    v_add_f32 v222, v222, v234
    v_mfma_f32_16x16x32_bf16 v[250:253], v[94:97], a[108:111], v[250:253]
    s_add_u32 s92, s92, 4096
    s_addc_u32 s93, s93, 0
    v_add_f32 v223, v223, v235
    v_mfma_f32_16x16x32_bf16 v[238:241], v[98:101], a[112:115], v[238:241]
    v_add_f32 v224, v224, v236
    v_mfma_f32_16x16x32_bf16 v[242:245], v[98:101], a[116:119], v[242:245]
    v_mfma_f32_16x16x32_bf16 v[246:249], v[98:101], a[120:123], v[246:249]
    v_add_f32 v225, v225, v237
    v_mfma_f32_16x16x32_bf16 v[250:253], v[98:101], a[124:127], v[250:253]
    v_mul_f32 v222, v222, v12
    v_mfma_f32_16x16x32_bf16 v[238:241], v[102:105], a[128:131], v[238:241]
    v_mul_f32 v223, v223, v13
    v_mfma_f32_16x16x32_bf16 v[242:245], v[102:105], a[132:135], v[242:245]
    global_load_lds_dwordx4 v4, s[92:93] offset:0 sc1
    v_mul_f32 v224, v224, v14
    v_mfma_f32_16x16x32_bf16 v[246:249], v[102:105], a[136:139], v[246:249]
    v_mfma_f32_16x16x32_bf16 v[250:253], v[102:105], a[140:143], v[250:253]
    v_mul_f32 v225, v225, v15
    v_mfma_f32_16x16x32_bf16 v[238:241], v[106:109], a[144:147], v[238:241]
    v_cvt_pk_bf16_f32 v58, v222, v223
    global_load_lds_dwordx4 v4, s[92:93] offset:1024 sc1
    v_mfma_f32_16x16x32_bf16 v[242:245], v[106:109], a[148:151], v[242:245]
    v_cvt_pk_bf16_f32 v59, v224, v225
    v_mfma_f32_16x16x32_bf16 v[246:249], v[106:109], a[152:155], v[246:249]
    v_and_b32 v59, -2, v59
    v_mfma_f32_16x16x32_bf16 v[250:253], v[106:109], a[156:159], v[250:253]
    global_load_dwordx4 v[142:145], v6, s[38:39] offset:-4096 sc1
    s_nop 2
    ds_write_b128 v20, v[242:245] offset:0
    s_nop 0
    ds_write_b128 v21, v[246:249] offset:0
    global_load_dwordx4 v[146:149], v6, s[38:39] offset:-3072 sc1
    ds_write_b128 v22, v[250:253] offset:0
    s_waitcnt lgkmcnt(0)
    s_barrier
    global_load_dwordx4 v[150:153], v6, s[38:39] offset:-2048 sc1
    ds_read_b128 v[242:245], v23 offset:0
    ds_read_b128 v[246:249], v23 offset:1024
    global_load_dwordx4 v[154:157], v6, s[38:39] offset:-1024 sc1
    ds_read_b128 v[250:253], v23 offset:2048
    v_lshlrev_b32 v12, 16, v60
    v_and_b32 v13, 0xffff0000, v60
    global_load_dwordx4 v[158:161], v6, s[38:39] offset:0 sc1
    v_lshlrev_b32 v14, 16, v61
    v_and_b32 v15, 0xffff0000, v61
    global_load_dwordx4 v[162:165], v6, s[38:39] offset:1024 sc1
    s_waitcnt lgkmcnt(2)
    v_pk_add_f32 v[238:239], v[238:239], v[242:243] op_sel:[0,0] op_sel_hi:[1,1]
    v_pk_add_f32 v[240:241], v[240:241], v[244:245] op_sel:[0,0] op_sel_hi:[1,1]
    s_waitcnt lgkmcnt(1)
    v_pk_add_f32 v[238:239], v[238:239], v[246:247] op_sel:[0,0] op_sel_hi:[1,1]
    global_load_dwordx4 v[166:169], v6, s[38:39] offset:2048 sc1
    v_pk_add_f32 v[240:241], v[240:241], v[248:249] op_sel:[0,0] op_sel_hi:[1,1]
    s_waitcnt lgkmcnt(0)
    v_pk_add_f32 v[238:239], v[238:239], v[250:251] op_sel:[0,0] op_sel_hi:[1,1]
    global_load_dwordx4 v[170:173], v6, s[38:39] offset:3072 sc1
    v_pk_add_f32 v[240:241], v[240:241], v[252:253] op_sel:[0,0] op_sel_hi:[1,1]
    v_pk_mul_f32 v[238:239], v[238:239], v[12:13] op_sel:[0,0] op_sel_hi:[1,1]
    v_pk_mul_f32 v[240:241], v[240:241], v[14:15] op_sel:[0,0] op_sel_hi:[1,1]
    v_cvt_pk_bf16_f32 v60, v238, v239
    v_cvt_pk_bf16_f32 v61, v240, v241
    v_and_b32 v61, -2, v61
    global_store_dwordx4 v26, v[56:59], s[8:9] offset:-4096 sc1
    global_store_dwordx2 v27, v[60:61], s[10:11] offset:-4096 sc1
    v_add_u32 v30, 61440, v4
    v_add_u32 v31, 122880, v4
    global_load_dwordx4 v[174:177], v7, s[38:39] offset:-4096 sc1
    global_load_dwordx4 v[178:181], v7, s[38:39] offset:-3072 sc1
    global_load_dwordx4 v[182:185], v7, s[38:39] offset:-2048 sc1
    global_load_dwordx4 v[186:189], v7, s[38:39] offset:-1024 sc1
    global_load_dwordx4 v[190:193], v7, s[38:39] offset:0 sc1
    global_load_dwordx4 v[194:197], v7, s[38:39] offset:1024 sc1
    global_load_dwordx4 v[198:201], v7, s[38:39] offset:2048 sc1
    global_load_dwordx4 v[202:205], v7, s[38:39] offset:3072 sc1
    s_waitcnt vmcnt(18)
    s_barrier
    ds_read_b128 a[0:3], v4 offset:0
    ds_read_b128 a[4:7], v4 offset:1024
    ds_read_b128 a[8:11], v4 offset:2048
    ds_read_b128 a[12:15], v4 offset:3072
    ds_read_b128 a[16:19], v4 offset:4096
    ds_read_b128 a[20:23], v4 offset:20480
    ds_read_b128 a[24:27], v4 offset:21504
    ds_read_b128 a[28:31], v4 offset:22528
    ds_read_b128 a[32:35], v4 offset:23552
    ds_read_b128 a[36:39], v4 offset:24576
    s_waitcnt vmcnt(16)
    v_or_b32 v28, v145, v149
    s_waitcnt vmcnt(14)
    v_or3_b32 v28, v153, v157, v28
    s_waitcnt vmcnt(12)
    v_or3_b32 v28, v161, v165, v28
    s_waitcnt vmcnt(10)
    v_or3_b32 v28, v169, v173, v28
    v_and_b32 v28, 1, v28
    v_cmp_ne_u32 vcc, 0, v28
    s_nop 0
    s_cbranch_vccnz Lp0_r
Lp0_ok:
    s_waitcnt lgkmcnt(9)
    v_mfma_f32_16x16x32_bf16 v[62:65], a[0:3], v[142:145], 0
    ds_read_b128 a[40:43], v4 offset:35840
    s_waitcnt lgkmcnt(9)
    v_mfma_f32_16x16x32_bf16 v[66:69], a[4:7], v[142:145], 0
    ds_read_b128 a[0:3], v4 offset:36864
    s_waitcnt lgkmcnt(6)
    v_mfma_f32_16x16x32_bf16 v[70:73], a[8:11], v[142:145], 0
    ds_read_b128 a[4:7], v4 offset:37888
    v_mfma_f32_16x16x32_bf16 v[74:77], a[12:15], v[142:145], 0
    ds_read_b128 a[8:11], v4 offset:38912
    v_mfma_f32_16x16x32_bf16 v[78:81], a[16:19], v[142:145], 0
    ds_read_b128 a[12:15], v4 offset:39936
    v_mfma_f32_16x16x32_bf16 v[62:65], a[20:23], v[146:149], v[62:65]
    ds_read_b128 a[16:19], v4 offset:56320
    s_waitcnt lgkmcnt(5)
    v_mfma_f32_16x16x32_bf16 v[66:69], a[24:27], v[146:149], v[66:69]
    ds_read_b128 a[20:23], v4 offset:57344
    v_mfma_f32_16x16x32_bf16 v[70:73], a[28:31], v[146:149], v[70:73]
    ds_read_b128 a[24:27], v4 offset:58368
    v_mfma_f32_16x16x32_bf16 v[74:77], a[32:35], v[146:149], v[74:77]
    ds_read_b128 a[28:31], v4 offset:59392
    v_mfma_f32_16x16x32_bf16 v[78:81], a[36:39], v[146:149], v[78:81]
    ds_read_b128 a[32:35], v4 offset:60416
    v_mfma_f32_16x16x32_bf16 v[62:65], a[40:43], v[150:153], v[62:65]
    ds_read_b128 a[36:39], v30 offset:10240
    s_waitcnt lgkmcnt(5)
    v_mfma_f32_16x16x32_bf16 v[66:69], a[0:3], v[150:153], v[66:69]
    ds_read_b128 a[40:43], v30 offset:11264
    v_mfma_f32_16x16x32_bf16 v[70:73], a[4:7], v[150:153], v[70:73]
    ds_read_b128 a[0:3], v30 offset:12288
    v_mfma_f32_16x16x32_bf16 v[74:77], a[8:11], v[150:153], v[74:77]
    ds_read_b128 a[4:7], v30 offset:13312
    v_mfma_f32_16x16x32_bf16 v[78:81], a[12:15], v[150:153], v[78:81]
    ds_read_b128 a[8:11], v30 offset:14336
    v_mfma_f32_16x16x32_bf16 v[62:65], a[16:19], v[154:157], v[62:65]
    ds_read_b128 a[12:15], v30 offset:30720
    s_waitcnt lgkmcnt(5)
    v_mfma_f32_16x16x32_bf16 v[66:69], a[20:23], v[154:157], v[66:69]
    ds_read_b128 a[16:19], v30 offset:31744
    v_mfma_f32_16x16x32_bf16 v[70:73], a[24:27], v[154:157], v[70:73]
    ds_read_b128 a[20:23], v30 offset:32768
    v_mfma_f32_16x16x32_bf16 v[74:77], a[28:31], v[154:157], v[74:77]
    ds_read_b128 a[24:27], v30 offset:33792
    v_mfma_f32_16x16x32_bf16 v[78:81], a[32:35], v[154:157], v[78:81]
    ds_read_b128 a[28:31], v30 offset:34816
    v_mfma_f32_16x16x32_bf16 v[62:65], a[36:39], v[158:161], v[62:65]
    ds_read_b128 a[32:35], v30 offset:46080
    s_waitcnt lgkmcnt(5)
    v_mfma_f32_16x16x32_bf16 v[66:69], a[40:43], v[158:161], v[66:69]
    ds_read_b128 a[36:39], v30 offset:47104
    v_mfma_f32_16x16x32_bf16 v[70:73], a[0:3], v[158:161], v[70:73]
    ds_read_b128 a[40:43], v30 offset:48128
    v_mfma_f32_16x16x32_bf16 v[74:77], a[4:7], v[158:161], v[74:77]
    ds_read_b128 a[0:3], v30 offset:49152
    v_mfma_f32_16x16x32_bf16 v[78:81], a[8:11], v[158:161], v[78:81]
    ds_read_b128 a[4:7], v30 offset:50176
    v_mfma_f32_16x16x32_bf16 v[62:65], a[12:15], v[162:165], v[62:65]
    ds_read_b128 a[8:11], v31 offset:5120
    s_waitcnt lgkmcnt(5)
    v_mfma_f32_16x16x32_bf16 v[66:69], a[16:19], v[162:165], v[66:69]
    ds_read_b128 a[12:15], v31 offset:6144
    v_mfma_f32_16x16x32_bf16 v[70:73], a[20:23], v[162:165], v[70:73]
    ds_read_b128 a[16:19], v31 offset:7168
    v_mfma_f32_16x16x32_bf16 v[74:77], a[24:27], v[162:165], v[74:77]
    ds_read_b128 a[20:23], v31 offset:8192
    v_mfma_f32_16x16x32_bf16 v[78:81], a[28:31], v[162:165], v[78:81]
    ds_read_b128 a[24:27], v31 offset:9216
    v_mfma_f32_16x16x32_bf16 v[62:65], a[32:35], v[166:169], v[62:65]
    ds_read_b128 a[28:31], v4 offset:5120
    s_waitcnt lgkmcnt(5)
    v_mfma_f32_16x16x32_bf16 v[66:69], a[36:39], v[166:169], v[66:69]
    ds_read_b128 a[32:35], v4 offset:6144
    v_mfma_f32_16x16x32_bf16 v[70:73], a[40:43], v[166:169], v[70:73]
    ds_read_b128 a[36:39], v4 offset:7168
    v_mfma_f32_16x16x32_bf16 v[74:77], a[0:3], v[166:169], v[74:77]
    ds_read_b128 a[40:43], v4 offset:8192
    v_mfma_f32_16x16x32_bf16 v[78:81], a[4:7], v[166:169], v[78:81]
    ds_read_b128 a[0:3], v4 offset:9216
    v_mfma_f32_16x16x32_bf16 v[62:65], a[8:11], v[170:173], v[62:65]
    ds_read_b128 a[4:7], v4 offset:25600
    s_waitcnt lgkmcnt(5)
    v_mfma_f32_16x16x32_bf16 v[66:69], a[12:15], v[170:173], v[66:69]
    ds_read_b128 a[8:11], v4 offset:26624
    v_mfma_f32_16x16x32_bf16 v[70:73], a[16:19], v[170:173], v[70:73]
    ds_read_b128 a[12:15], v4 offset:27648
    v_mfma_f32_16x16x32_bf16 v[74:77], a[20:23], v[170:173], v[74:77]
    ds_read_b128 a[16:19], v4 offset:28672
    v_mfma_f32_16x16x32_bf16 v[78:81], a[24:27], v[170:173], v[78:81]
    ds_read_b128 a[20:23], v4 offset:29696
    s_waitcnt vmcnt(6)
    v_or_b32 v28, v177, v181
    s_waitcnt vmcnt(4)
    v_or3_b32 v28, v185, v189, v28
    s_waitcnt vmcnt(2)
    v_or3_b32 v28, v193, v197, v28
    s_waitcnt vmcnt(0)
    v_or3_b32 v28, v201, v205, v28
    v_and_b32 v28, 1, v28
    v_cmp_ne_u32 vcc, 0, v28
    s_nop 0
    s_cbranch_vccnz Lp1_r
Lp1_ok:
    v_mfma_f32_16x16x32_bf16 v[62:65], a[28:31], v[174:177], v[62:65]
    ds_read_b128 a[24:27], v4 offset:40960
    s_waitcnt lgkmcnt(3)
    v_mfma_f32_16x16x32_bf16 v[66:69], a[32:35], v[174:177], v[66:69]
    ds_read_b128 a[28:31], v4 offset:41984
    v_mfma_f32_16x16x32_bf16 v[70:73], a[36:39], v[174:177], v[70:73]
    ds_read_b128 a[32:35], v4 offset:43008
    v_mfma_f32_16x16x32_bf16 v[74:77], a[40:43], v[174:177], v[74:77]
    ds_read_b128 a[36:39], v4 offset:44032
    v_mfma_f32_16x16x32_bf16 v[78:81], a[0:3], v[174:177], v[78:81]
    ds_read_b128 a[40:43], v4 offset:45056
    v_mfma_f32_16x16x32_bf16 v[62:65], a[4:7], v[178:181], v[62:65]
    ds_read_b128 a[0:3], v30 offset:0
    v_mfma_f32_16x16x32_bf16 v[66:69], a[8:11], v[178:181], v[66:69]
    ds_read_b128 a[4:7], v30 offset:1024
    v_mfma_f32_16x16x32_bf16 v[70:73], a[12:15], v[178:181], v[70:73]
    ds_read_b128 a[8:11], v30 offset:2048
    s_waitcnt lgkmcnt(5)
    v_mfma_f32_16x16x32_bf16 v[74:77], a[16:19], v[178:181], v[74:77]
    ds_read_b128 a[12:15], v30 offset:3072
    v_mfma_f32_16x16x32_bf16 v[78:81], a[20:23], v[178:181], v[78:81]
    ds_read_b128 a[16:19], v30 offset:4096
    v_mfma_f32_16x16x32_bf16 v[62:65], a[24:27], v[182:185], v[62:65]
    ds_read_b128 a[20:23], v30 offset:15360
    global_load_dwordx4 v[206:209], v26, s[38:39] offset:-4096 sc1
    v_mfma_f32_16x16x32_bf16 v[66:69], a[28:31], v[182:185], v[66:69]
    ds_read_b128 a[24:27], v30 offset:16384
    v_mfma_f32_16x16x32_bf16 v[70:73], a[32:35], v[182:185], v[70:73]
    ds_read_b128 a[28:31], v30 offset:17408
    global_load_dwordx4 v[210:213], v26, s[38:39] offset:-3072 sc1
    s_waitcnt lgkmcnt(5)
    v_mfma_f32_16x16x32_bf16 v[74:77], a[36:39], v[182:185], v[74:77]
    ds_read_b128 a[32:35], v30 offset:18432
    v_mfma_f32_16x16x32_bf16 v[78:81], a[40:43], v[182:185], v[78:81]
    ds_read_b128 a[36:39], v30 offset:19456
    v_mfma_f32_16x16x32_bf16 v[62:65], a[0:3], v[186:189], v[62:65]
    ds_read_b128 a[40:43], v30 offset:35840
    global_load_dwordx4 v[214:217], v26, s[38:39] offset:-2048 sc1
    v_mfma_f32_16x16x32_bf16 v[66:69], a[4:7], v[186:189], v[66:69]
    ds_read_b128 a[0:3], v30 offset:36864
    v_mfma_f32_16x16x32_bf16 v[70:73], a[8:11], v[186:189], v[70:73]
    ds_read_b128 a[4:7], v30 offset:37888
    s_waitcnt lgkmcnt(5)
    v_mfma_f32_16x16x32_bf16 v[74:77], a[12:15], v[186:189], v[74:77]
    ds_read_b128 a[8:11], v30 offset:38912
    global_load_dwordx4 v[218:221], v26, s[38:39] offset:-1024 sc1
    v_mfma_f32_16x16x32_bf16 v[78:81], a[16:19], v[186:189], v[78:81]
    ds_read_b128 a[12:15], v30 offset:39936
    v_mfma_f32_16x16x32_bf16 v[62:65], a[20:23], v[190:193], v[62:65]
    ds_read_b128 a[16:19], v30 offset:51200
    global_load_dwordx4 v[222:225], v26, s[38:39] offset:0 sc1
    v_mfma_f32_16x16x32_bf16 v[66:69], a[24:27], v[190:193], v[66:69]
    ds_read_b128 a[20:23], v30 offset:52224
    v_mfma_f32_16x16x32_bf16 v[70:73], a[28:31], v[190:193], v[70:73]
    ds_read_b128 a[24:27], v30 offset:53248
    s_waitcnt lgkmcnt(5)
    v_mfma_f32_16x16x32_bf16 v[74:77], a[32:35], v[190:193], v[74:77]
    ds_read_b128 a[28:31], v30 offset:54272
    global_load_dwordx4 v[226:229], v26, s[38:39] offset:1024 sc1
    v_mfma_f32_16x16x32_bf16 v[78:81], a[36:39], v[190:193], v[78:81]
    ds_read_b128 a[32:35], v30 offset:55296
    v_mfma_f32_16x16x32_bf16 v[62:65], a[40:43], v[194:197], v[62:65]
    ds_read_b128 a[36:39], v31 offset:10240
    v_mfma_f32_16x16x32_bf16 v[66:69], a[0:3], v[194:197], v[66:69]
    ds_read_b128 a[40:43], v31 offset:11264
    global_load_dwordx4 v[230:233], v26, s[38:39] offset:2048 sc1
    v_mfma_f32_16x16x32_bf16 v[70:73], a[4:7], v[194:197], v[70:73]
    ds_read_b128 a[0:3], v31 offset:12288
    s_waitcnt lgkmcnt(5)
    v_mfma_f32_16x16x32_bf16 v[74:77], a[8:11], v[194:197], v[74:77]
    ds_read_b128 a[4:7], v31 offset:13312
    v_mfma_f32_16x16x32_bf16 v[78:81], a[12:15], v[194:197], v[78:81]
    ds_read_b128 a[8:11], v31 offset:14336
    global_load_dwordx4 v[238:241], v27, s[38:39] offset:-4096 sc1
    v_mfma_f32_16x16x32_bf16 v[62:65], a[16:19], v[198:201], v[62:65]
    ds_read_b128 a[12:15], v4 offset:10240
    v_mfma_f32_16x16x32_bf16 v[66:69], a[20:23], v[198:201], v[66:69]
    ds_read_b128 a[16:19], v4 offset:11264
    global_load_dwordx4 v[242:245], v27, s[38:39] offset:-3072 sc1
    v_mfma_f32_16x16x32_bf16 v[70:73], a[24:27], v[198:201], v[70:73]
    ds_read_b128 a[20:23], v4 offset:12288
    s_waitcnt lgkmcnt(5)
    v_mfma_f32_16x16x32_bf16 v[74:77], a[28:31], v[198:201], v[74:77]
    ds_read_b128 a[24:27], v4 offset:13312
    v_mfma_f32_16x16x32_bf16 v[78:81], a[32:35], v[198:201], v[78:81]
    ds_read_b128 a[28:31], v4 offset:14336
    global_load_dwordx4 v[246:249], v27, s[38:39] offset:-2048 sc1
    v_mfma_f32_16x16x32_bf16 v[62:65], a[36:39], v[202:205], v[62:65]
    ds_read_b128 a[32:35], v4 offset:30720
    v_mfma_f32_16x16x32_bf16 v[66:69], a[40:43], v[202:205], v[66:69]
    ds_read_b128 a[36:39], v4 offset:31744
    v_mfma_f32_16x16x32_bf16 v[70:73], a[0:3], v[202:205], v[70:73]
    ds_read_b128 a[40:43], v4 offset:32768
    global_load_dwordx4 v[250:253], v27, s[38:39] offset:-1024 sc1
    s_waitcnt lgkmcnt(5)
    v_mfma_f32_16x16x32_bf16 v[74:77], a[4:7], v[202:205], v[74:77]
    ds_read_b128 a[0:3], v4 offset:33792
    v_mfma_f32_16x16x32_bf16 v[78:81], a[8:11], v[202:205], v[78:81]
    ds_read_b128 a[4:7], v4 offset:34816
    v_lshlrev_b32 v29, 5, v3
    v_add_u32 v29, 162816, v29
    ds_read_b128 v[106:109], v29 offset:0
    ds_read_b128 v[110:113], v29 offset:16
    ds_read_b128 v[114:117], v29 offset:128
    ds_read_b128 v[118:121], v29 offset:144
    v_lshlrev_b32 v29, 4, v3
    v_add_u32 v29, 162816, v29
    ds_read_b128 v[122:125], v29 offset:256
    v_lshlrev_b32 v126, 16, v36
    v_and_b32 v127, 0xffff0000, v36
    v_lshlrev_b32 v128, 16, v37
    v_and_b32 v129, 0xffff0000, v37
    v_lshlrev_b32 v130, 16, v38
    v_and_b32 v131, 0xffff0000, v38
    v_lshlrev_b32 v132, 16, v39
    v_and_b32 v133, 0xffff0000, v39
    v_lshlrev_b32 v134, 16, v40
    v_and_b32 v135, 0xffff0000, v40
    v_lshlrev_b32 v136, 16, v41
    v_and_b32 v137, 0xffff0000, v41
    v_lshlrev_b32 v138, 16, v42
    v_and_b32 v139, 0xffff0000, v42
    v_lshlrev_b32 v140, 16, v43
    v_and_b32 v141, 0xffff0000, v43
    v_lshlrev_b32 v12, 16, v44
    v_and_b32 v13, 0xffff0000, v44
    v_lshlrev_b32 v14, 16, v45
    v_and_b32 v15, 0xffff0000, v45
    v_add_u32 v46, s90, v5
    v_mul_u32_u24 v46, 1280, v46
    s_mul_i32 s4, s41, 160
    v_add_u32 v46, s4, v46
    v_lshl_add_u32 v47, v3, 4, v46
    v_lshl_add_u32 v46, v3, 3, v46
    s_waitcnt vmcnt(8)
    v_or3_b32 v28, v209, v213, v217
    s_waitcnt vmcnt(6)
    v_or3_b32 v28, v221, v225, v28
    s_waitcnt vmcnt(4)
    v_or3_b32 v28, v229, v233, v28
    v_and_b32 v28, 1, v28
    v_cmp_ne_u32 vcc, 0, v28
    s_nop 0
    s_cbranch_vccnz Lp2_r
Lp2_ok:
    v_mfma_f32_16x16x32_bf16 v[62:65], a[12:15], v[206:209], v[62:65]
    ds_read_b128 a[8:11], v4 offset:46080
    v_mfma_f32_16x16x32_bf16 v[66:69], a[16:19], v[206:209], v[66:69]
    ds_read_b128 a[12:15], v4 offset:47104
    v_mfma_f32_16x16x32_bf16 v[70:73], a[20:23], v[206:209], v[70:73]
    ds_read_b128 a[16:19], v4 offset:48128
    s_waitcnt lgkmcnt(3)
    v_mfma_f32_16x16x32_bf16 v[74:77], a[24:27], v[206:209], v[74:77]
    ds_read_b128 a[20:23], v4 offset:49152
    v_mfma_f32_16x16x32_bf16 v[78:81], a[28:31], v[206:209], v[78:81]
    ds_read_b128 a[24:27], v4 offset:50176
    v_mfma_f32_16x16x32_bf16 v[62:65], a[32:35], v[210:213], v[62:65]
    ds_read_b128 a[28:31], v30 offset:5120
    v_mfma_f32_16x16x32_bf16 v[66:69], a[36:39], v[210:213], v[66:69]
    ds_read_b128 a[32:35], v30 offset:6144
    v_mfma_f32_16x16x32_bf16 v[70:73], a[40:43], v[210:213], v[70:73]
    ds_read_b128 a[36:39], v30 offset:7168
    v_mfma_f32_16x16x32_bf16 v[74:77], a[0:3], v[210:213], v[74:77]
    ds_read_b128 a[40:43], v30 offset:8192
    v_mfma_f32_16x16x32_bf16 v[78:81], a[4:7], v[210:213], v[78:81]
    ds_read_b128 a[0:3], v30 offset:9216
    s_waitcnt lgkmcnt(5)
    v_mfma_f32_16x16x32_bf16 v[62:65], a[8:11], v[214:217], v[62:65]
    ds_read_b128 a[4:7], v30 offset:20480
    v_mfma_f32_16x16x32_bf16 v[66:69], a[12:15], v[214:217], v[66:69]
    ds_read_b128 a[8:11], v30 offset:21504
    v_mfma_f32_16x16x32_bf16 v[70:73], a[16:19], v[214:217], v[70:73]
    ds_read_b128 a[12:15], v30 offset:22528
    v_mfma_f32_16x16x32_bf16 v[74:77], a[20:23], v[214:217], v[74:77]
    ds_read_b128 a[16:19], v30 offset:23552
    v_mfma_f32_16x16x32_bf16 v[78:81], a[24:27], v[214:217], v[78:81]
    ds_read_b128 a[20:23], v30 offset:24576
    s_waitcnt lgkmcnt(5)
    v_mfma_f32_16x16x32_bf16 v[62:65], a[28:31], v[218:221], v[62:65]
    ds_read_b128 a[24:27], v30 offset:40960
    v_mfma_f32_16x16x32_bf16 v[66:69], a[32:35], v[218:221], v[66:69]
    ds_read_b128 a[28:31], v30 offset:41984
    v_mfma_f32_16x16x32_bf16 v[70:73], a[36:39], v[218:221], v[70:73]
    ds_read_b128 a[32:35], v30 offset:43008
    v_mfma_f32_16x16x32_bf16 v[74:77], a[40:43], v[218:221], v[74:77]
    ds_read_b128 a[36:39], v30 offset:44032
    v_mfma_f32_16x16x32_bf16 v[78:81], a[0:3], v[218:221], v[78:81]
    ds_read_b128 a[40:43], v30 offset:45056
    s_waitcnt lgkmcnt(5)
    v_mfma_f32_16x16x32_bf16 v[62:65], a[4:7], v[222:225], v[62:65]
    ds_read_b128 a[0:3], v30 offset:56320
    v_mfma_f32_16x16x32_bf16 v[66:69], a[8:11], v[222:225], v[66:69]
    ds_read_b128 a[4:7], v30 offset:57344
    v_mfma_f32_16x16x32_bf16 v[70:73], a[12:15], v[222:225], v[70:73]
    ds_read_b128 a[8:11], v30 offset:58368
    v_mfma_f32_16x16x32_bf16 v[74:77], a[16:19], v[222:225], v[74:77]
    ds_read_b128 a[12:15], v30 offset:59392
    v_mfma_f32_16x16x32_bf16 v[78:81], a[20:23], v[222:225], v[78:81]
    ds_read_b128 a[16:19], v30 offset:60416
    s_waitcnt lgkmcnt(5)
    v_mfma_f32_16x16x32_bf16 v[62:65], a[24:27], v[226:229], v[62:65]
    ds_read_b128 a[20:23], v4 offset:15360
    v_mfma_f32_16x16x32_bf16 v[66:69], a[28:31], v[226:229], v[66:69]
    ds_read_b128 a[24:27], v4 offset:16384
    v_mfma_f32_16x16x32_bf16 v[70:73], a[32:35], v[226:229], v[70:73]
    ds_read_b128 a[28:31], v4 offset:17408
    v_mfma_f32_16x16x32_bf16 v[74:77], a[36:39], v[226:229], v[74:77]
    ds_read_b128 a[32:35], v4 offset:18432
    v_mfma_f32_16x16x32_bf16 v[78:81], a[40:43], v[226:229], v[78:81]
    ds_read_b128 a[36:39], v4 offset:19456
    s_waitcnt lgkmcnt(5)
    v_mfma_f32_16x16x32_bf16 v[62:65], a[0:3], v[230:233], v[62:65]
    ds_read_b128 a[40:43], v4 offset:51200
    v_mfma_f32_16x16x32_bf16 v[66:69], a[4:7], v[230:233], v[66:69]
    ds_read_b128 a[0:3], v4 offset:52224
    v_mfma_f32_16x16x32_bf16 v[70:73], a[8:11], v[230:233], v[70:73]
    ds_read_b128 a[4:7], v4 offset:53248
    v_mfma_f32_16x16x32_bf16 v[74:77], a[12:15], v[230:233], v[74:77]
    ds_read_b128 a[8:11], v4 offset:54272
    v_mfma_f32_16x16x32_bf16 v[78:81], a[16:19], v[230:233], v[78:81]
    ds_read_b128 a[12:15], v4 offset:55296
    s_waitcnt vmcnt(3)
    v_or_b32 v28, v239, v241
    s_waitcnt vmcnt(2)
    v_or3_b32 v28, v243, v245, v28
    s_waitcnt vmcnt(1)
    v_or3_b32 v28, v247, v249, v28
    s_waitcnt vmcnt(0)
    v_or3_b32 v28, v251, v253, v28
    v_and_b32 v28, 1, v28
    v_cmp_ne_u32 vcc, 0, v28
    s_nop 0
    s_cbranch_vccnz Lp3_r
Lp3_ok:
    s_waitcnt lgkmcnt(3)
    v_mfma_f32_16x16x32_bf16 v[62:65], a[20:23], v[238:241], v[62:65]
    ds_read_b128 a[16:19], v30 offset:25600
    v_mfma_f32_16x16x32_bf16 v[66:69], a[24:27], v[238:241], v[66:69]
    ds_read_b128 a[20:23], v30 offset:26624
    v_mfma_f32_16x16x32_bf16 v[70:73], a[28:31], v[238:241], v[70:73]
    ds_read_b128 a[24:27], v30 offset:27648
    v_mfma_f32_16x16x32_bf16 v[74:77], a[32:35], v[238:241], v[74:77]
    ds_read_b128 a[28:31], v30 offset:28672
    v_mfma_f32_16x16x32_bf16 v[78:81], a[36:39], v[238:241], v[78:81]
    ds_read_b128 a[32:35], v30 offset:29696
    v_mfma_f32_16x16x32_bf16 v[62:65], a[40:43], v[242:245], v[62:65]
    ds_read_b128 a[36:39], v31 offset:0
    v_mfma_f32_16x16x32_bf16 v[66:69], a[0:3], v[242:245], v[66:69]
    ds_read_b128 a[40:43], v31 offset:1024
    s_waitcnt lgkmcnt(5)
    v_mfma_f32_16x16x32_bf16 v[70:73], a[4:7], v[242:245], v[70:73]
    ds_read_b128 a[0:3], v31 offset:2048
    v_mfma_f32_16x16x32_bf16 v[74:77], a[8:11], v[242:245], v[74:77]
    ds_read_b128 a[4:7], v31 offset:3072
    v_mfma_f32_16x16x32_bf16 v[78:81], a[12:15], v[242:245], v[78:81]
    ds_read_b128 a[8:11], v31 offset:4096
    v_mfma_f32_16x16x32_bf16 v[62:65], a[16:19], v[246:249], v[62:65]
    v_mfma_f32_16x16x32_bf16 v[66:69], a[20:23], v[246:249], v[66:69]
    s_waitcnt lgkmcnt(3)
    v_mfma_f32_16x16x32_bf16 v[70:73], a[24:27], v[246:249], v[70:73]
    v_mfma_f32_16x16x32_bf16 v[74:77], a[28:31], v[246:249], v[74:77]
    v_mfma_f32_16x16x32_bf16 v[78:81], a[32:35], v[246:249], v[78:81]
    v_mfma_f32_16x16x32_bf16 v[62:65], a[36:39], v[250:253], v[62:65]
    v_mfma_f32_16x16x32_bf16 v[66:69], a[40:43], v[250:253], v[66:69]
    s_waitcnt lgkmcnt(0)
    v_mfma_f32_16x16x32_bf16 v[70:73], a[0:3], v[250:253], v[70:73]
    v_mfma_f32_16x16x32_bf16 v[74:77], a[4:7], v[250:253], v[74:77]
    v_mfma_f32_16x16x32_bf16 v[78:81], a[8:11], v[250:253], v[78:81]
    s_nop 2
    v_fmac_f32 v126, v62, v106
    v_fmac_f32 v127, v66, v107
    v_fmac_f32 v128, v63, v108
    v_fmac_f32 v129, v67, v109
    v_fmac_f32 v130, v64, v110
    v_fmac_f32 v131, v68, v111
    v_fmac_f32 v132, v65, v112
    v_fmac_f32 v133, v69, v113
    v_cvt_pk_bf16_f32 v142, v126, v127
    v_cvt_pk_bf16_f32 v143, v128, v129
    v_cvt_pk_bf16_f32 v144, v130, v131
    v_cvt_pk_bf16_f32 v145, v132, v133
    global_store_dwordx4 v47, v[142:145], s[34:35] offset:0
    v_fmac_f32 v134, v70, v114
    v_fmac_f32 v135, v74, v115
    v_fmac_f32 v136, v71, v116
    v_fmac_f32 v137, v75, v117
    v_fmac_f32 v138, v72, v118
    v_fmac_f32 v139, v76, v119
    v_fmac_f32 v140, v73, v120
    v_fmac_f32 v141, v77, v121
    v_cvt_pk_bf16_f32 v146, v134, v135
    v_cvt_pk_bf16_f32 v147, v136, v137
    v_cvt_pk_bf16_f32 v148, v138, v139
    v_cvt_pk_bf16_f32 v149, v140, v141
    global_store_dwordx4 v47, v[146:149], s[34:35] offset:64
    v_fmac_f32 v12, v78, v122
    v_fmac_f32 v13, v79, v123
    v_fmac_f32 v14, v80, v124
    v_fmac_f32 v15, v81, v125
    v_cvt_pk_bf16_f32 v150, v12, v13
    v_cvt_pk_bf16_f32 v151, v14, v15
    global_store_dwordx2 v46, v[150:151], s[34:35] offset:128
Lflush:
Lend:
    s_endpgm
Lspare:
    s_sub_u32 s42, s2, 160
    s_cmp_lt_u32 s42, 54
    s_cbranch_scc0 Lsp_b
    s_cmp_ge_u32 s42, 8
    s_cbranch_scc1 Lsp_a2
    s_mov_b32 s48, s42
    v_mov_b32 v8, -1
    v_mov_b32 v9, -1
    v_mov_b32 v10, -1
    v_mov_b32 v11, -1
    s_mul_i32 s4, s48, 9216
    s_mul_i32 s5, s3, 2304
    s_add_u32 s4, s4, s5
    s_add_u32 s4, s4, 32768
    v_add_u32 v6, s4, v4
    global_store_dwordx4 v6, v[8:11], s[38:39] offset:0 sc1
    global_store_dwordx4 v6, v[8:11], s[38:39] offset:1024 sc1
    global_store_dwordx4 v6, v[8:11], s[38:39] offset:1280 sc1
    s_lshl_b32 s4, s48, 2
    v_mov_b32 v6, s4
    s_waitcnt vmcnt(0)
    s_barrier
    s_cmp_lg_u32 s3, 0
    s_cbranch_scc1 Linit_skip
    global_store_dword v6, v8, s[36:37] sc1
Linit_skip:
    s_branch Lsp_a2
Lsp_b:
    s_sub_u32 s48, s42, 54
    s_add_u32 s49, s48, 42
    s_add_u32 s50, s48, 84
    s_cmp_ge_u32 s50, 120
    s_cselect_b32 s50, s49, s50
    s_cmp_eq_u32 s3, 1
    s_cselect_b32 s51, s49, s48
    s_cmp_eq_u32 s3, 2
    s_cselect_b32 s51, s50, s51
    s_lshr_b32 s4, s51, 1
    s_and_b32 s5, s51, 1
    s_cmp_lt_u32 s4, 50
    s_cselect_b32 s6, -20, 0
    s_cmp_lt_u32 s4, 20
    s_cselect_b32 s6, 30, s6
    s_add_u32 s4, s4, s6
    s_mul_i32 s6, s5, 15360
    s_lshl_b32 s7, s4, 8
    s_add_u32 s51, s6, s7
    v_lshl_add_u32 v164, v1, 2, s51
    v_mov_b32 v165, -1
    global_store_dword v164, v165, s[38:39] offset:0 sc1
    s_lshr_b32 s4, s48, 1
    s_and_b32 s5, s48, 1
    s_cmp_lt_u32 s4, 50
    s_cselect_b32 s6, -20, 0
    s_cmp_lt_u32 s4, 20
    s_cselect_b32 s6, 30, s6
    s_add_u32 s4, s4, s6
    s_mul_i32 s6, s5, 15360
    s_lshl_b32 s7, s4, 8
    s_add_u32 s44, s6, s7
    s_lshl_b32 s5, s5, 2
    s_add_u32 s5, s5, s3
    s_mul_i32 s5, s5, 80
    s_lshl_b32 s4, s4, 7
    s_mul_i32 s6, s5, 7680
    s_add_u32 s4, s4, s6
    v_min_u32 v28, 39, v1
    s_lshl_b32 s5, s5, 1
    v_lshl_add_u32 v28, v28, 2, s5
    global_load_dword v80, v28, s[30:31]
    v_lshrrev_b32 v29, 3, v1
    v_mul_u32_u24 v28, 15232, v29
    v_add3_u32 v28, v28, v4, s4
    global_load_dwordx4 v[40:43], v28, s[32:33] nt
    v_add_u32 v28, 7680, v28
    global_load_dwordx4 v[44:47], v28, s[32:33] nt
    v_add_u32 v28, 115200, v28
    global_load_dwordx4 v[48:51], v28, s[32:33] nt
    v_add_u32 v28, 7680, v28
    global_load_dwordx4 v[52:55], v28, s[32:33] nt
    v_add_u32 v28, 115200, v28
    global_load_dwordx4 v[56:59], v28, s[32:33] nt
    v_add_u32 v28, 7680, v28
    global_load_dwordx4 v[60:63], v28, s[32:33] nt
    v_add_u32 v28, 115200, v28
    global_load_dwordx4 v[64:67], v28, s[32:33] nt
    v_add_u32 v28, 7680, v28
    global_load_dwordx4 v[68:71], v28, s[32:33] nt
    v_add_u32 v28, 115200, v28
    global_load_dwordx4 v[72:75], v28, s[32:33] nt
    v_add_u32 v28, 7680, v28
    global_load_dwordx4 v[76:79], v28, s[32:33] nt
    s_lshl_b32 s4, s48, 2
    s_add_u32 s4, s4, 60
    v_mov_b32 v164, s4
    s_waitcnt vmcnt(10)
    s_barrier
    s_cmp_lg_u32 s3, 0
    s_cbranch_scc1 Lsb_skip
    global_store_dword v164, v165, s[36:37] sc1
    s_branch Lsb_skip2
Lsb_skip:
    global_load_dword v165, v164, s[30:31]
Lsb_skip2:
    s_lshr_b32 s4, s49, 1
    s_and_b32 s5, s49, 1
    s_cmp_lt_u32 s4, 50
    s_cselect_b32 s6, -20, 0
    s_cmp_lt_u32 s4, 20
    s_cselect_b32 s6, 30, s6
    s_add_u32 s4, s4, s6
    s_mul_i32 s6, s5, 15360
    s_lshl_b32 s7, s4, 8
    s_add_u32 s45, s6, s7
    s_lshl_b32 s5, s5, 2
    s_add_u32 s5, s5, s3
    s_mul_i32 s5, s5, 80
    s_lshl_b32 s4, s4, 7
    s_mul_i32 s6, s5, 7680
    s_add_u32 s4, s4, s6
    v_min_u32 v96, 39, v1
    s_lshl_b32 s5, s5, 1
    v_lshl_add_u32 v96, v96, 2, s5
    global_load_dword v148, v96, s[30:31]
    v_lshrrev_b32 v97, 3, v1
    v_mul_u32_u24 v96, 15232, v97
    v_add3_u32 v96, v96, v4, s4
    global_load_dwordx4 v[108:111], v96, s[32:33] nt
    v_add_u32 v96, 7680, v96
    global_load_dwordx4 v[112:115], v96, s[32:33] nt
    v_add_u32 v96, 115200, v96
    global_load_dwordx4 v[116:119], v96, s[32:33] nt
    v_add_u32 v96, 7680, v96
    global_load_dwordx4 v[120:123], v96, s[32:33] nt
    v_add_u32 v96, 115200, v96
    global_load_dwordx4 v[124:127], v96, s[32:33] nt
    v_add_u32 v96, 7680, v96
    global_load_dwordx4 v[128:131], v96, s[32:33] nt
    v_add_u32 v96, 115200, v96
    global_load_dwordx4 v[132:135], v96, s[32:33] nt
    v_add_u32 v96, 7680, v96
    global_load_dwordx4 v[136:139], v96, s[32:33] nt
    v_add_u32 v96, 115200, v96
    global_load_dwordx4 v[140:143], v96, s[32:33] nt
    v_add_u32 v96, 7680, v96
    v_lshlrev_b32 v82, 16, v80
    v_and_b32 v83, 0xffff0000, v80
    v_lshlrev_b32 v29, 2, v29
    v_mul_f32 v84, 0xbfb8aa3b, v82
    v_mul_f32 v85, 0xbfb8aa3b, v83
    v_exp_f32 v84, v84
    v_exp_f32 v85, v85
    v_add_f32 v84, 1.0, v84
    v_add_f32 v85, 1.0, v85
    v_rcp_f32 v84, v84
    v_rcp_f32 v85, v85
    v_mul_f32 v82, v82, v84
    v_mul_f32 v83, v83, v85
    v_cvt_pk_bf16_f32 v80, v82, v83
    ds_bpermute_b32 v88, v29, v80 offset:0
    ds_bpermute_b32 v89, v29, v80 offset:32
    ds_bpermute_b32 v90, v29, v80 offset:64
    ds_bpermute_b32 v91, v29, v80 offset:96
    ds_bpermute_b32 v92, v29, v80 offset:128
    s_waitcnt lgkmcnt(4)
    v_lshlrev_b32 v30, 16, v88
    v_and_b32 v31, 0xffff0000, v88
    s_waitcnt lgkmcnt(3)
    v_lshlrev_b32 v32, 16, v89
    v_and_b32 v33, 0xffff0000, v89
    s_waitcnt lgkmcnt(2)
    v_lshlrev_b32 v34, 16, v90
    v_and_b32 v35, 0xffff0000, v90
    s_waitcnt lgkmcnt(1)
    v_lshlrev_b32 v36, 16, v91
    v_and_b32 v37, 0xffff0000, v91
    s_waitcnt lgkmcnt(0)
    v_lshlrev_b32 v38, 16, v92
    v_and_b32 v39, 0xffff0000, v92
    s_waitcnt vmcnt(20)
    v_lshlrev_b32 v80, 16, v40
    v_and_b32 v81, 0xffff0000, v40
    v_lshlrev_b32 v82, 16, v41
    v_and_b32 v83, 0xffff0000, v41
    v_lshlrev_b32 v84, 16, v42
    v_and_b32 v85, 0xffff0000, v42
    v_lshlrev_b32 v86, 16, v43
    v_and_b32 v87, 0xffff0000, v43
    v_pk_mul_f32 v[88:89], v[30:31], v[80:81] op_sel:[0,0] op_sel_hi:[0,1]
    v_pk_mul_f32 v[90:91], v[30:31], v[82:83] op_sel:[0,0] op_sel_hi:[0,1]
    v_pk_mul_f32 v[92:93], v[30:31], v[84:85] op_sel:[0,0] op_sel_hi:[0,1]
    v_pk_mul_f32 v[94:95], v[30:31], v[86:87] op_sel:[0,0] op_sel_hi:[0,1]
    s_waitcnt vmcnt(19)
    v_lshlrev_b32 v80, 16, v44
    v_and_b32 v81, 0xffff0000, v44
    v_lshlrev_b32 v82, 16, v45
    v_and_b32 v83, 0xffff0000, v45
    v_lshlrev_b32 v84, 16, v46
    v_and_b32 v85, 0xffff0000, v46
    v_lshlrev_b32 v86, 16, v47
    v_and_b32 v87, 0xffff0000, v47
    v_pk_fma_f32 v[88:89], v[30:31], v[80:81], v[88:89] op_sel:[1,0,0] op_sel_hi:[1,1,1]
    v_pk_fma_f32 v[90:91], v[30:31], v[82:83], v[90:91] op_sel:[1,0,0] op_sel_hi:[1,1,1]
    v_pk_fma_f32 v[92:93], v[30:31], v[84:85], v[92:93] op_sel:[1,0,0] op_sel_hi:[1,1,1]
    v_pk_fma_f32 v[94:95], v[30:31], v[86:87], v[94:95] op_sel:[1,0,0] op_sel_hi:[1,1,1]
    s_waitcnt vmcnt(18)
    v_lshlrev_b32 v80, 16, v48
    v_and_b32 v81, 0xffff0000, v48
    v_lshlrev_b32 v82, 16, v49
    v_and_b32 v83, 0xffff0000, v49
    v_lshlrev_b32 v84, 16, v50
    v_and_b32 v85, 0xffff0000, v50
    v_lshlrev_b32 v86, 16, v51
    v_and_b32 v87, 0xffff0000, v51
    v_pk_fma_f32 v[88:89], v[32:33], v[80:81], v[88:89] op_sel:[0,0,0] op_sel_hi:[0,1,1]
    v_pk_fma_f32 v[90:91], v[32:33], v[82:83], v[90:91] op_sel:[0,0,0] op_sel_hi:[0,1,1]
    v_pk_fma_f32 v[92:93], v[32:33], v[84:85], v[92:93] op_sel:[0,0,0] op_sel_hi:[0,1,1]
    v_pk_fma_f32 v[94:95], v[32:33], v[86:87], v[94:95] op_sel:[0,0,0] op_sel_hi:[0,1,1]
    s_waitcnt vmcnt(17)
    v_lshlrev_b32 v80, 16, v52
    v_and_b32 v81, 0xffff0000, v52
    v_lshlrev_b32 v82, 16, v53
    v_and_b32 v83, 0xffff0000, v53
    v_lshlrev_b32 v84, 16, v54
    v_and_b32 v85, 0xffff0000, v54
    v_lshlrev_b32 v86, 16, v55
    v_and_b32 v87, 0xffff0000, v55
    v_pk_fma_f32 v[88:89], v[32:33], v[80:81], v[88:89] op_sel:[1,0,0] op_sel_hi:[1,1,1]
    v_pk_fma_f32 v[90:91], v[32:33], v[82:83], v[90:91] op_sel:[1,0,0] op_sel_hi:[1,1,1]
    v_pk_fma_f32 v[92:93], v[32:33], v[84:85], v[92:93] op_sel:[1,0,0] op_sel_hi:[1,1,1]
    v_pk_fma_f32 v[94:95], v[32:33], v[86:87], v[94:95] op_sel:[1,0,0] op_sel_hi:[1,1,1]
    s_waitcnt vmcnt(16)
    v_lshlrev_b32 v80, 16, v56
    v_and_b32 v81, 0xffff0000, v56
    v_lshlrev_b32 v82, 16, v57
    v_and_b32 v83, 0xffff0000, v57
    v_lshlrev_b32 v84, 16, v58
    v_and_b32 v85, 0xffff0000, v58
    v_lshlrev_b32 v86, 16, v59
    v_and_b32 v87, 0xffff0000, v59
    v_pk_fma_f32 v[88:89], v[34:35], v[80:81], v[88:89] op_sel:[0,0,0] op_sel_hi:[0,1,1]
    v_pk_fma_f32 v[90:91], v[34:35], v[82:83], v[90:91] op_sel:[0,0,0] op_sel_hi:[0,1,1]
    v_pk_fma_f32 v[92:93], v[34:35], v[84:85], v[92:93] op_sel:[0,0,0] op_sel_hi:[0,1,1]
    v_pk_fma_f32 v[94:95], v[34:35], v[86:87], v[94:95] op_sel:[0,0,0] op_sel_hi:[0,1,1]
    s_waitcnt vmcnt(15)
    v_lshlrev_b32 v80, 16, v60
    v_and_b32 v81, 0xffff0000, v60
    v_lshlrev_b32 v82, 16, v61
    v_and_b32 v83, 0xffff0000, v61
    v_lshlrev_b32 v84, 16, v62
    v_and_b32 v85, 0xffff0000, v62
    v_lshlrev_b32 v86, 16, v63
    v_and_b32 v87, 0xffff0000, v63
    v_pk_fma_f32 v[88:89], v[34:35], v[80:81], v[88:89] op_sel:[1,0,0] op_sel_hi:[1,1,1]
    v_pk_fma_f32 v[90:91], v[34:35], v[82:83], v[90:91] op_sel:[1,0,0] op_sel_hi:[1,1,1]
    v_pk_fma_f32 v[92:93], v[34:35], v[84:85], v[92:93] op_sel:[1,0,0] op_sel_hi:[1,1,1]
    v_pk_fma_f32 v[94:95], v[34:35], v[86:87], v[94:95] op_sel:[1,0,0] op_sel_hi:[1,1,1]
    s_waitcnt vmcnt(14)
    v_lshlrev_b32 v80, 16, v64
    v_and_b32 v81, 0xffff0000, v64
    v_lshlrev_b32 v82, 16, v65
    v_and_b32 v83, 0xffff0000, v65
    v_lshlrev_b32 v84, 16, v66
    v_and_b32 v85, 0xffff0000, v66
    v_lshlrev_b32 v86, 16, v67
    v_and_b32 v87, 0xffff0000, v67
    v_pk_fma_f32 v[88:89], v[36:37], v[80:81], v[88:89] op_sel:[0,0,0] op_sel_hi:[0,1,1]
    v_pk_fma_f32 v[90:91], v[36:37], v[82:83], v[90:91] op_sel:[0,0,0] op_sel_hi:[0,1,1]
    v_pk_fma_f32 v[92:93], v[36:37], v[84:85], v[92:93] op_sel:[0,0,0] op_sel_hi:[0,1,1]
    v_pk_fma_f32 v[94:95], v[36:37], v[86:87], v[94:95] op_sel:[0,0,0] op_sel_hi:[0,1,1]
    s_waitcnt vmcnt(13)
    v_lshlrev_b32 v80, 16, v68
    v_and_b32 v81, 0xffff0000, v68
    v_lshlrev_b32 v82, 16, v69
    v_and_b32 v83, 0xffff0000, v69
    v_lshlrev_b32 v84, 16, v70
    v_and_b32 v85, 0xffff0000, v70
    v_lshlrev_b32 v86, 16, v71
    v_and_b32 v87, 0xffff0000, v71
    v_pk_fma_f32 v[88:89], v[36:37], v[80:81], v[88:89] op_sel:[1,0,0] op_sel_hi:[1,1,1]
    v_pk_fma_f32 v[90:91], v[36:37], v[82:83], v[90:91] op_sel:[1,0,0] op_sel_hi:[1,1,1]
    v_pk_fma_f32 v[92:93], v[36:37], v[84:85], v[92:93] op_sel:[1,0,0] op_sel_hi:[1,1,1]
    v_pk_fma_f32 v[94:95], v[36:37], v[86:87], v[94:95] op_sel:[1,0,0] op_sel_hi:[1,1,1]
    s_waitcnt vmcnt(12)
    v_lshlrev_b32 v80, 16, v72
    v_and_b32 v81, 0xffff0000, v72
    v_lshlrev_b32 v82, 16, v73
    v_and_b32 v83, 0xffff0000, v73
    v_lshlrev_b32 v84, 16, v74
    v_and_b32 v85, 0xffff0000, v74
    v_lshlrev_b32 v86, 16, v75
    v_and_b32 v87, 0xffff0000, v75
    v_pk_fma_f32 v[88:89], v[38:39], v[80:81], v[88:89] op_sel:[0,0,0] op_sel_hi:[0,1,1]
    v_pk_fma_f32 v[90:91], v[38:39], v[82:83], v[90:91] op_sel:[0,0,0] op_sel_hi:[0,1,1]
    v_pk_fma_f32 v[92:93], v[38:39], v[84:85], v[92:93] op_sel:[0,0,0] op_sel_hi:[0,1,1]
    v_pk_fma_f32 v[94:95], v[38:39], v[86:87], v[94:95] op_sel:[0,0,0] op_sel_hi:[0,1,1]
    s_waitcnt vmcnt(11)
    v_lshlrev_b32 v80, 16, v76
    v_and_b32 v81, 0xffff0000, v76
    v_lshlrev_b32 v82, 16, v77
    v_and_b32 v83, 0xffff0000, v77
    v_lshlrev_b32 v84, 16, v78
    v_and_b32 v85, 0xffff0000, v78
    v_lshlrev_b32 v86, 16, v79
    v_and_b32 v87, 0xffff0000, v79
    v_pk_fma_f32 v[88:89], v[38:39], v[80:81], v[88:89] op_sel:[1,0,0] op_sel_hi:[1,1,1]
    v_pk_fma_f32 v[90:91], v[38:39], v[82:83], v[90:91] op_sel:[1,0,0] op_sel_hi:[1,1,1]
    v_pk_fma_f32 v[92:93], v[38:39], v[84:85], v[92:93] op_sel:[1,0,0] op_sel_hi:[1,1,1]
    v_pk_fma_f32 v[94:95], v[38:39], v[86:87], v[94:95] op_sel:[1,0,0] op_sel_hi:[1,1,1]
    s_nop 0
    v_permlane32_swap_b32 v88, v92
    v_permlane32_swap_b32 v89, v93
    v_permlane32_swap_b32 v90, v94
    v_permlane32_swap_b32 v91, v95
    v_add_f32 v88, v88, v92
    v_add_f32 v89, v89, v93
    v_add_f32 v90, v90, v94
    v_add_f32 v91, v91, v95
    s_nop 0
    v_permlane16_swap_b32 v88, v90
    v_permlane16_swap_b32 v89, v91
    v_add_f32 v88, v88, v90
    v_add_f32 v89, v89, v91
    v_and_b32 v81, 7, v1
    v_lshrrev_b32 v82, 3, v1
    v_add_f32_dpp v80, v88, v88 row_ror:8 row_mask:0xf bank_mask:0x3
    s_nop 1
    v_add_f32_dpp v80, v89, v89 row_ror:8 row_mask:0xf bank_mask:0xc
    v_lshl_add_u32 v81, v81, 3, v82
    s_lshl_b32 s7, s3, 8
    s_add_u32 s7, s7, 122880
    v_lshl_add_u32 v81, v81, 2, s7
    ds_write_b32 v81, v80
    s_waitcnt lgkmcnt(0)
    s_barrier
    v_lshlrev_b32 v81, 2, v1
    v_add_u32 v82, 122880, v81
    ds_read_b32 v88, v82 offset:0
    ds_read_b32 v89, v82 offset:256
    ds_read_b32 v90, v82 offset:512
    ds_read_b32 v91, v82 offset:768
    v_add_u32 v81, s44, v81
    s_waitcnt lgkmcnt(2)
    v_add_f32 v88, v88, v89
    s_waitcnt lgkmcnt(0)
    v_add_f32 v90, v90, v91
    v_add_f32 v88, v88, v90
    v_min_u32 v88, -2, v88
    s_cmp_lg_u32 s3, 0
    s_cbranch_scc1 Lmod_skip_s1
    global_store_dword v81, v88, s[38:39] offset:0 sc1
Lmod_skip_s1:
    global_load_dwordx4 v[144:147], v96, s[32:33] nt
    s_cmp_ge_u32 s48, 27
    s_cbranch_scc1 Lsb_n3
    s_mul_i32 s4, s48, 40960
    s_mul_i32 s5, s3, 10240
    s_add_u32 s4, s4, s5
    v_lshl_add_u32 v164, v1, 4, s4
    s_add_u32 m0, s5, 0
    s_nop 0
    global_load_lds_dwordx4 v164, s[28:29] offset:0 nt
    global_load_lds_dwordx4 v164, s[28:29] offset:1024 nt
    global_load_lds_dwordx4 v164, s[28:29] offset:2048 nt
    global_load_lds_dwordx4 v164, s[28:29] offset:3072 nt
    s_add_u32 m0, s5, 4096
    v_add_u32 v164, 4096, v164
    global_load_lds_dwordx4 v164, s[28:29] offset:0 nt
    global_load_lds_dwordx4 v164, s[28:29] offset:1024 nt
    global_load_lds_dwordx4 v164, s[28:29] offset:2048 nt
    global_load_lds_dwordx4 v164, s[28:29] offset:3072 nt
    s_add_u32 m0, s5, 8192
    v_add_u32 v164, 4096, v164
    global_load_lds_dwordx4 v164, s[28:29] offset:0 nt
    global_load_lds_dwordx4 v164, s[28:29] offset:1024 nt
    s_waitcnt vmcnt(10)
    s_branch Lsb_n4
Lsb_n3:
    s_add_u32 s50, s48, 78
    s_lshr_b32 s4, s50, 1
    s_and_b32 s5, s50, 1
    s_cmp_lt_u32 s4, 50
    s_cselect_b32 s6, -20, 0
    s_cmp_lt_u32 s4, 20
    s_cselect_b32 s6, 30, s6
    s_add_u32 s4, s4, s6
    s_mul_i32 s6, s5, 15360
    s_lshl_b32 s7, s4, 8
    s_add_u32 s44, s6, s7
    s_lshl_b32 s5, s5, 2
    s_add_u32 s5, s5, s3
    s_mul_i32 s5, s5, 80
    s_lshl_b32 s4, s4, 7
    s_mul_i32 s6, s5, 7680
    s_add_u32 s4, s4, s6
    v_min_u32 v28, 39, v1
    s_lshl_b32 s5, s5, 1
    v_lshl_add_u32 v28, v28, 2, s5
    global_load_dword v80, v28, s[30:31]
    v_lshrrev_b32 v29, 3, v1
    v_mul_u32_u24 v28, 15232, v29
    v_add3_u32 v28, v28, v4, s4
    global_load_dwordx4 v[40:43], v28, s[32:33] nt
    v_add_u32 v28, 7680, v28
    global_load_dwordx4 v[44:47], v28, s[32:33] nt
    v_add_u32 v28, 115200, v28
    global_load_dwordx4 v[48:51], v28, s[32:33] nt
    v_add_u32 v28, 7680, v28
    global_load_dwordx4 v[52:55], v28, s[32:33] nt
    v_add_u32 v28, 115200, v28
    global_load_dwordx4 v[56:59], v28, s[32:33] nt
    v_add_u32 v28, 7680, v28
    global_load_dwordx4 v[60:63], v28, s[32:33] nt
    v_add_u32 v28, 115200, v28
    global_load_dwordx4 v[64:67], v28, s[32:33] nt
    v_add_u32 v28, 7680, v28
    global_load_dwordx4 v[68:71], v28, s[32:33] nt
    v_add_u32 v28, 115200, v28
    global_load_dwordx4 v[72:75], v28, s[32:33] nt
    v_add_u32 v28, 7680, v28
    global_load_dwordx4 v[76:79], v28, s[32:33] nt
    s_waitcnt vmcnt(11)
Lsb_n4:
    v_lshlrev_b32 v150, 16, v148
    v_and_b32 v151, 0xffff0000, v148
    v_lshlrev_b32 v97, 2, v97
    v_mul_f32 v152, 0xbfb8aa3b, v150
    v_mul_f32 v153, 0xbfb8aa3b, v151
    v_exp_f32 v152, v152
    v_exp_f32 v153, v153
    v_add_f32 v152, 1.0, v152
    v_add_f32 v153, 1.0, v153
    v_rcp_f32 v152, v152
    v_rcp_f32 v153, v153
    v_mul_f32 v150, v150, v152
    v_mul_f32 v151, v151, v153
    v_cvt_pk_bf16_f32 v148, v150, v151
    ds_bpermute_b32 v156, v97, v148 offset:0
    ds_bpermute_b32 v157, v97, v148 offset:32
    ds_bpermute_b32 v158, v97, v148 offset:64
    ds_bpermute_b32 v159, v97, v148 offset:96
    ds_bpermute_b32 v160, v97, v148 offset:128
    s_waitcnt lgkmcnt(4)
    v_lshlrev_b32 v98, 16, v156
    v_and_b32 v99, 0xffff0000, v156
    s_waitcnt lgkmcnt(3)
    v_lshlrev_b32 v100, 16, v157
    v_and_b32 v101, 0xffff0000, v157
    s_waitcnt lgkmcnt(2)
    v_lshlrev_b32 v102, 16, v158
    v_and_b32 v103, 0xffff0000, v158
    s_waitcnt lgkmcnt(1)
    v_lshlrev_b32 v104, 16, v159
    v_and_b32 v105, 0xffff0000, v159
    s_waitcnt lgkmcnt(0)
    v_lshlrev_b32 v106, 16, v160
    v_and_b32 v107, 0xffff0000, v160
    v_lshlrev_b32 v148, 16, v108
    v_and_b32 v149, 0xffff0000, v108
    v_lshlrev_b32 v150, 16, v109
    v_and_b32 v151, 0xffff0000, v109
    v_lshlrev_b32 v152, 16, v110
    v_and_b32 v153, 0xffff0000, v110
    v_lshlrev_b32 v154, 16, v111
    v_and_b32 v155, 0xffff0000, v111
    v_pk_mul_f32 v[156:157], v[98:99], v[148:149] op_sel:[0,0] op_sel_hi:[0,1]
    v_pk_mul_f32 v[158:159], v[98:99], v[150:151] op_sel:[0,0] op_sel_hi:[0,1]
    v_pk_mul_f32 v[160:161], v[98:99], v[152:153] op_sel:[0,0] op_sel_hi:[0,1]
    v_pk_mul_f32 v[162:163], v[98:99], v[154:155] op_sel:[0,0] op_sel_hi:[0,1]
    v_lshlrev_b32 v148, 16, v112
    v_and_b32 v149, 0xffff0000, v112
    v_lshlrev_b32 v150, 16, v113
    v_and_b32 v151, 0xffff0000, v113
    v_lshlrev_b32 v152, 16, v114
    v_and_b32 v153, 0xffff0000, v114
    v_lshlrev_b32 v154, 16, v115
    v_and_b32 v155, 0xffff0000, v115
    v_pk_fma_f32 v[156:157], v[98:99], v[148:149], v[156:157] op_sel:[1,0,0] op_sel_hi:[1,1,1]
    v_pk_fma_f32 v[158:159], v[98:99], v[150:151], v[158:159] op_sel:[1,0,0] op_sel_hi:[1,1,1]
    v_pk_fma_f32 v[160:161], v[98:99], v[152:153], v[160:161] op_sel:[1,0,0] op_sel_hi:[1,1,1]
    v_pk_fma_f32 v[162:163], v[98:99], v[154:155], v[162:163] op_sel:[1,0,0] op_sel_hi:[1,1,1]
    v_lshlrev_b32 v148, 16, v116
    v_and_b32 v149, 0xffff0000, v116
    v_lshlrev_b32 v150, 16, v117
    v_and_b32 v151, 0xffff0000, v117
    v_lshlrev_b32 v152, 16, v118
    v_and_b32 v153, 0xffff0000, v118
    v_lshlrev_b32 v154, 16, v119
    v_and_b32 v155, 0xffff0000, v119
    v_pk_fma_f32 v[156:157], v[100:101], v[148:149], v[156:157] op_sel:[0,0,0] op_sel_hi:[0,1,1]
    v_pk_fma_f32 v[158:159], v[100:101], v[150:151], v[158:159] op_sel:[0,0,0] op_sel_hi:[0,1,1]
    v_pk_fma_f32 v[160:161], v[100:101], v[152:153], v[160:161] op_sel:[0,0,0] op_sel_hi:[0,1,1]
    v_pk_fma_f32 v[162:163], v[100:101], v[154:155], v[162:163] op_sel:[0,0,0] op_sel_hi:[0,1,1]
    v_lshlrev_b32 v148, 16, v120
    v_and_b32 v149, 0xffff0000, v120
    v_lshlrev_b32 v150, 16, v121
    v_and_b32 v151, 0xffff0000, v121
    v_lshlrev_b32 v152, 16, v122
    v_and_b32 v153, 0xffff0000, v122
    v_lshlrev_b32 v154, 16, v123
    v_and_b32 v155, 0xffff0000, v123
    v_pk_fma_f32 v[156:157], v[100:101], v[148:149], v[156:157] op_sel:[1,0,0] op_sel_hi:[1,1,1]
    v_pk_fma_f32 v[158:159], v[100:101], v[150:151], v[158:159] op_sel:[1,0,0] op_sel_hi:[1,1,1]
    v_pk_fma_f32 v[160:161], v[100:101], v[152:153], v[160:161] op_sel:[1,0,0] op_sel_hi:[1,1,1]
    v_pk_fma_f32 v[162:163], v[100:101], v[154:155], v[162:163] op_sel:[1,0,0] op_sel_hi:[1,1,1]
    v_lshlrev_b32 v148, 16, v124
    v_and_b32 v149, 0xffff0000, v124
    v_lshlrev_b32 v150, 16, v125
    v_and_b32 v151, 0xffff0000, v125
    v_lshlrev_b32 v152, 16, v126
    v_and_b32 v153, 0xffff0000, v126
    v_lshlrev_b32 v154, 16, v127
    v_and_b32 v155, 0xffff0000, v127
    v_pk_fma_f32 v[156:157], v[102:103], v[148:149], v[156:157] op_sel:[0,0,0] op_sel_hi:[0,1,1]
    v_pk_fma_f32 v[158:159], v[102:103], v[150:151], v[158:159] op_sel:[0,0,0] op_sel_hi:[0,1,1]
    v_pk_fma_f32 v[160:161], v[102:103], v[152:153], v[160:161] op_sel:[0,0,0] op_sel_hi:[0,1,1]
    v_pk_fma_f32 v[162:163], v[102:103], v[154:155], v[162:163] op_sel:[0,0,0] op_sel_hi:[0,1,1]
    v_lshlrev_b32 v148, 16, v128
    v_and_b32 v149, 0xffff0000, v128
    v_lshlrev_b32 v150, 16, v129
    v_and_b32 v151, 0xffff0000, v129
    v_lshlrev_b32 v152, 16, v130
    v_and_b32 v153, 0xffff0000, v130
    v_lshlrev_b32 v154, 16, v131
    v_and_b32 v155, 0xffff0000, v131
    v_pk_fma_f32 v[156:157], v[102:103], v[148:149], v[156:157] op_sel:[1,0,0] op_sel_hi:[1,1,1]
    v_pk_fma_f32 v[158:159], v[102:103], v[150:151], v[158:159] op_sel:[1,0,0] op_sel_hi:[1,1,1]
    v_pk_fma_f32 v[160:161], v[102:103], v[152:153], v[160:161] op_sel:[1,0,0] op_sel_hi:[1,1,1]
    v_pk_fma_f32 v[162:163], v[102:103], v[154:155], v[162:163] op_sel:[1,0,0] op_sel_hi:[1,1,1]
    v_lshlrev_b32 v148, 16, v132
    v_and_b32 v149, 0xffff0000, v132
    v_lshlrev_b32 v150, 16, v133
    v_and_b32 v151, 0xffff0000, v133
    v_lshlrev_b32 v152, 16, v134
    v_and_b32 v153, 0xffff0000, v134
    v_lshlrev_b32 v154, 16, v135
    v_and_b32 v155, 0xffff0000, v135
    v_pk_fma_f32 v[156:157], v[104:105], v[148:149], v[156:157] op_sel:[0,0,0] op_sel_hi:[0,1,1]
    v_pk_fma_f32 v[158:159], v[104:105], v[150:151], v[158:159] op_sel:[0,0,0] op_sel_hi:[0,1,1]
    v_pk_fma_f32 v[160:161], v[104:105], v[152:153], v[160:161] op_sel:[0,0,0] op_sel_hi:[0,1,1]
    v_pk_fma_f32 v[162:163], v[104:105], v[154:155], v[162:163] op_sel:[0,0,0] op_sel_hi:[0,1,1]
    v_lshlrev_b32 v148, 16, v136
    v_and_b32 v149, 0xffff0000, v136
    v_lshlrev_b32 v150, 16, v137
    v_and_b32 v151, 0xffff0000, v137
    v_lshlrev_b32 v152, 16, v138
    v_and_b32 v153, 0xffff0000, v138
    v_lshlrev_b32 v154, 16, v139
    v_and_b32 v155, 0xffff0000, v139
    v_pk_fma_f32 v[156:157], v[104:105], v[148:149], v[156:157] op_sel:[1,0,0] op_sel_hi:[1,1,1]
    v_pk_fma_f32 v[158:159], v[104:105], v[150:151], v[158:159] op_sel:[1,0,0] op_sel_hi:[1,1,1]
    v_pk_fma_f32 v[160:161], v[104:105], v[152:153], v[160:161] op_sel:[1,0,0] op_sel_hi:[1,1,1]
    v_pk_fma_f32 v[162:163], v[104:105], v[154:155], v[162:163] op_sel:[1,0,0] op_sel_hi:[1,1,1]
    v_lshlrev_b32 v148, 16, v140
    v_and_b32 v149, 0xffff0000, v140
    v_lshlrev_b32 v150, 16, v141
    v_and_b32 v151, 0xffff0000, v141
    v_lshlrev_b32 v152, 16, v142
    v_and_b32 v153, 0xffff0000, v142
    v_lshlrev_b32 v154, 16, v143
    v_and_b32 v155, 0xffff0000, v143
    v_pk_fma_f32 v[156:157], v[106:107], v[148:149], v[156:157] op_sel:[0,0,0] op_sel_hi:[0,1,1]
    v_pk_fma_f32 v[158:159], v[106:107], v[150:151], v[158:159] op_sel:[0,0,0] op_sel_hi:[0,1,1]
    v_pk_fma_f32 v[160:161], v[106:107], v[152:153], v[160:161] op_sel:[0,0,0] op_sel_hi:[0,1,1]
    v_pk_fma_f32 v[162:163], v[106:107], v[154:155], v[162:163] op_sel:[0,0,0] op_sel_hi:[0,1,1]
    v_lshlrev_b32 v148, 16, v144
    v_and_b32 v149, 0xffff0000, v144
    v_lshlrev_b32 v150, 16, v145
    v_and_b32 v151, 0xffff0000, v145
    v_lshlrev_b32 v152, 16, v146
    v_and_b32 v153, 0xffff0000, v146
    v_lshlrev_b32 v154, 16, v147
    v_and_b32 v155, 0xffff0000, v147
    v_pk_fma_f32 v[156:157], v[106:107], v[148:149], v[156:157] op_sel:[1,0,0] op_sel_hi:[1,1,1]
    v_pk_fma_f32 v[158:159], v[106:107], v[150:151], v[158:159] op_sel:[1,0,0] op_sel_hi:[1,1,1]
    v_pk_fma_f32 v[160:161], v[106:107], v[152:153], v[160:161] op_sel:[1,0,0] op_sel_hi:[1,1,1]
    v_pk_fma_f32 v[162:163], v[106:107], v[154:155], v[162:163] op_sel:[1,0,0] op_sel_hi:[1,1,1]
    s_nop 0
    v_permlane32_swap_b32 v156, v160
    v_permlane32_swap_b32 v157, v161
    v_permlane32_swap_b32 v158, v162
    v_permlane32_swap_b32 v159, v163
    v_add_f32 v156, v156, v160
    v_add_f32 v157, v157, v161
    v_add_f32 v158, v158, v162
    v_add_f32 v159, v159, v163
    s_nop 0
    v_permlane16_swap_b32 v156, v158
    v_permlane16_swap_b32 v157, v159
    v_add_f32 v156, v156, v158
    v_add_f32 v157, v157, v159
    v_and_b32 v149, 7, v1
    v_lshrrev_b32 v150, 3, v1
    v_add_f32_dpp v148, v156, v156 row_ror:8 row_mask:0xf bank_mask:0x3
    s_nop 1
    v_add_f32_dpp v148, v157, v157 row_ror:8 row_mask:0xf bank_mask:0xc
    v_lshl_add_u32 v149, v149, 3, v150
    s_lshl_b32 s7, s3, 8
    s_add_u32 s7, s7, 123904
    v_lshl_add_u32 v149, v149, 2, s7
    ds_write_b32 v149, v148
    s_waitcnt lgkmcnt(0)
    s_barrier
    v_lshlrev_b32 v149, 2, v1
    v_add_u32 v150, 123904, v149
    ds_read_b32 v156, v150 offset:0
    ds_read_b32 v157, v150 offset:256
    ds_read_b32 v158, v150 offset:512
    ds_read_b32 v159, v150 offset:768
    v_add_u32 v149, s45, v149
    s_waitcnt lgkmcnt(2)
    v_add_f32 v156, v156, v157
    s_waitcnt lgkmcnt(0)
    v_add_f32 v158, v158, v159
    v_add_f32 v156, v156, v158
    v_min_u32 v156, -2, v156
    s_cmp_lg_u32 s3, 0
    s_cbranch_scc1 Lmod_skip_s2
    global_store_dword v149, v156, s[38:39] offset:0 sc1
Lmod_skip_s2:
    s_cmp_lg_u32 s3, 0
    s_cbranch_scc1 Lbic_x
    v_min_u32 v164, 49, v1
    v_cmp_lt_u32 vcc, 7, v164
    s_nop 1
    v_cndmask_b32_e64 v165, 0, 7, vcc
    v_add_lshl_u32 v164, v164, v165, 2
    s_branch Lbic_f
Lbic:
    s_sleep 4
Lbic_f:
    global_load_dword v165, v164, s[36:37] sc1
    s_waitcnt vmcnt(0)
    v_cmp_eq_u32 vcc, 0, v165
    s_add_u32 s100, s100, 1
    s_cmp_ge_u32 s100, 262144
    s_cbranch_scc1 Lbic_x
    s_cbranch_vccnz Lbic
Lbic_x:
    s_waitcnt vmcnt(0)
    s_cmp_ge_u32 s48, 27
    s_cbranch_scc1 Lsp_b3
    s_barrier
    v_and_b32 v33, 15, v1
    v_lshrrev_b32 v34, 4, v1
    v_mul_u32_u24 v34, 10240, v34
    s_mul_i32 s5, s3, 320
    s_add_u32 s5, s5, 0
    v_add_u32 v34, s5, v34
    v_lshl_add_u32 v31, v33, 2, v34
    v_lshl_add_u32 v32, v33, 1, v34
    s_mul_i32 s5, s3, 276480
    s_mul_i32 s6, s48, 5120
    s_add_u32 s5, s5, s6
    s_add_u32 s5, s5, 10487808
    v_lshl_add_u32 v30, v1, 4, s5
    s_mov_b32 s6, 0x5040100
    s_mov_b32 s7, 0x7060302
    ds_read_b32 v36, v31 offset:0
    ds_read_b32 v37, v31 offset:2560
    ds_read_b32 v38, v31 offset:5120
    ds_read_b32 v39, v31 offset:7680
    ds_read_b32 v40, v31 offset:1280
    ds_read_b32 v41, v31 offset:3840
    ds_read_b32 v42, v31 offset:6400
    ds_read_b32 v43, v31 offset:8960
    ds_read_b32 v44, v31 offset:64
    ds_read_b32 v45, v31 offset:2624
    ds_read_b32 v46, v31 offset:5184
    ds_read_b32 v47, v31 offset:7744
    ds_read_b32 v48, v31 offset:1344
    ds_read_b32 v49, v31 offset:3904
    ds_read_b32 v50, v31 offset:6464
    ds_read_b32 v51, v31 offset:9024
    ds_read_u16 v52, v32 offset:128
    ds_read_u16 v53, v32 offset:2688
    ds_read_u16 v54, v32 offset:5248
    ds_read_u16 v55, v32 offset:7808
    ds_read_u16 v56, v32 offset:1408
    ds_read_u16 v57, v32 offset:3968
    ds_read_u16 v58, v32 offset:6528
    ds_read_u16 v59, v32 offset:9088
    s_waitcnt lgkmcnt(15)
    v_perm_b32 v60, v37, v36, s6
    v_perm_b32 v61, v39, v38, s6
    v_perm_b32 v62, v41, v40, s6
    v_perm_b32 v63, v43, v42, s6
    v_perm_b32 v64, v37, v36, s7
    v_perm_b32 v65, v39, v38, s7
    v_perm_b32 v66, v41, v40, s7
    v_perm_b32 v67, v43, v42, s7
    s_waitcnt lgkmcnt(11)
    v_perm_b32 v68, v45, v44, s6
    v_perm_b32 v69, v47, v46, s6
    s_waitcnt lgkmcnt(9)
    v_perm_b32 v70, v49, v48, s6
    s_waitcnt lgkmcnt(8)
    v_perm_b32 v71, v51, v50, s6
    v_perm_b32 v72, v45, v44, s7
    v_perm_b32 v73, v47, v46, s7
    v_perm_b32 v74, v49, v48, s7
    v_perm_b32 v75, v51, v50, s7
    s_waitcnt lgkmcnt(3)
    v_perm_b32 v76, v53, v52, s6
    v_perm_b32 v77, v55, v54, s6
    s_waitcnt lgkmcnt(1)
    v_perm_b32 v78, v57, v56, s6
    s_waitcnt lgkmcnt(0)
    v_perm_b32 v79, v59, v58, s6
    global_store_dwordx4 v30, v[60:63], s[38:39] offset:-2048 sc1
    global_store_dwordx4 v30, v[64:67], s[38:39] offset:-1024 sc1
    global_store_dwordx4 v30, v[68:71], s[38:39] offset:0 sc1
    global_store_dwordx4 v30, v[72:75], s[38:39] offset:1024 sc1
    global_store_dwordx4 v30, v[76:79], s[38:39] offset:2048 sc1
    v_add_u32 v30, 138240, v30
    ds_read_b32 v80, v31 offset:160
    ds_read_b32 v81, v31 offset:2720
    ds_read_b32 v82, v31 offset:5280
    ds_read_b32 v83, v31 offset:7840
    ds_read_b32 v84, v31 offset:1440
    ds_read_b32 v85, v31 offset:4000
    ds_read_b32 v86, v31 offset:6560
    ds_read_b32 v87, v31 offset:9120
    ds_read_b32 v88, v31 offset:224
    ds_read_b32 v89, v31 offset:2784
    ds_read_b32 v90, v31 offset:5344
    ds_read_b32 v91, v31 offset:7904
    ds_read_b32 v92, v31 offset:1504
    ds_read_b32 v93, v31 offset:4064
    ds_read_b32 v94, v31 offset:6624
    ds_read_b32 v95, v31 offset:9184
    ds_read_u16 v96, v32 offset:288
    ds_read_u16 v97, v32 offset:2848
    ds_read_u16 v98, v32 offset:5408
    ds_read_u16 v99, v32 offset:7968
    ds_read_u16 v100, v32 offset:1568
    ds_read_u16 v101, v32 offset:4128
    ds_read_u16 v102, v32 offset:6688
    ds_read_u16 v103, v32 offset:9248
    s_waitcnt lgkmcnt(15)
    v_perm_b32 v104, v81, v80, s6
    v_perm_b32 v105, v83, v82, s6
    v_perm_b32 v106, v85, v84, s6
    v_perm_b32 v107, v87, v86, s6
    v_perm_b32 v108, v81, v80, s7
    v_perm_b32 v109, v83, v82, s7
    v_perm_b32 v110, v85, v84, s7
    v_perm_b32 v111, v87, v86, s7
    s_waitcnt lgkmcnt(11)
    v_perm_b32 v112, v89, v88, s6
    v_perm_b32 v113, v91, v90, s6
    s_waitcnt lgkmcnt(9)
    v_perm_b32 v114, v93, v92, s6
    s_waitcnt lgkmcnt(8)
    v_perm_b32 v115, v95, v94, s6
    v_perm_b32 v116, v89, v88, s7
    v_perm_b32 v117, v91, v90, s7
    v_perm_b32 v118, v93, v92, s7
    v_perm_b32 v119, v95, v94, s7
    s_waitcnt lgkmcnt(3)
    v_perm_b32 v120, v97, v96, s6
    v_perm_b32 v121, v99, v98, s6
    s_waitcnt lgkmcnt(1)
    v_perm_b32 v122, v101, v100, s6
    s_waitcnt lgkmcnt(0)
    v_perm_b32 v123, v103, v102, s6
    global_store_dwordx4 v30, v[104:107], s[38:39] offset:-2048 sc1
    global_store_dwordx4 v30, v[108:111], s[38:39] offset:-1024 sc1
    global_store_dwordx4 v30, v[112:115], s[38:39] offset:0 sc1
    global_store_dwordx4 v30, v[116:119], s[38:39] offset:1024 sc1
    global_store_dwordx4 v30, v[120:123], s[38:39] offset:2048 sc1
    s_lshl_b32 s4, s48, 7
    s_add_u32 s51, s4, 98304
    s_branch Lsp_d
Lsp_a2:
    s_and_b32 s4, s42, 1
    s_lshl_b32 s4, s4, 1
    s_and_b32 s5, s3, 1
    s_add_u32 s44, s4, s5
    s_and_b32 s4, s42, -2
    s_lshr_b32 s5, s3, 1
    s_add_u32 s45, s4, s5
    s_and_b32 s4, s42, 1
    s_lshl_b32 s4, s4, 2
    s_add_u32 s4, s4, s3
    s_mul_i32 s4, s4, 276480
    s_lshr_b32 s5, s42, 1
    s_lshl_b32 s5, s5, 7
    s_add_u32 s4, s4, s5
    v_lshrrev_b32 v28, 3, v1
    v_mul_u32_u24 v28, 3328, v28
    v_add3_u32 v28, v28, v4, s4
    s_mul_i32 s5, s3, 10240
    s_add_u32 m0, s5, 0
    s_nop 0
    global_load_lds_dwordx4 v28, s[22:23] nt
    v_add_u32 v28, 27648, v28
    s_add_u32 m0, s5, 1024
    s_nop 0
    global_load_lds_dwordx4 v28, s[22:23] nt
    v_add_u32 v28, 27648, v28
    s_add_u32 m0, s5, 2048
    s_nop 0
    global_load_lds_dwordx4 v28, s[22:23] nt
    v_add_u32 v28, 27648, v28
    s_add_u32 m0, s5, 3072
    s_nop 0
    global_load_lds_dwordx4 v28, s[22:23] nt
    v_add_u32 v28, 27648, v28
    s_add_u32 m0, s5, 4096
    s_nop 0
    global_load_lds_dwordx4 v28, s[22:23] nt
    v_add_u32 v28, 27648, v28
    s_add_u32 m0, s5, 5120
    s_nop 0
    global_load_lds_dwordx4 v28, s[22:23] nt
    v_add_u32 v28, 27648, v28
    s_add_u32 m0, s5, 6144
    s_nop 0
    global_load_lds_dwordx4 v28, s[22:23] nt
    v_add_u32 v28, 27648, v28
    s_add_u32 m0, s5, 7168
    s_nop 0
    global_load_lds_dwordx4 v28, s[22:23] nt
    v_add_u32 v28, 27648, v28
    s_add_u32 m0, s5, 8192
    s_nop 0
    global_load_lds_dwordx4 v28, s[22:23] nt
    v_add_u32 v28, 27648, v28
    s_add_u32 m0, s5, 9216
    s_nop 0
    global_load_lds_dwordx4 v28, s[22:23] nt
    v_add_u32 v28, 27648, v28
    v_min_u32 v72, 624, v4
    s_mul_i32 s5, s44, 640
    s_add_u32 s5, s5, 7680
    v_add_u32 v73, s5, v72
    s_mul_i32 s5, s3, 1280
    s_add_u32 s5, s5, 124928
    v_add_u32 v72, s5, v72
    v_lshl_add_u32 v74, v3, 5, s5
    s_cmp_ge_u32 s45, 27
    s_cselect_b32 s6, -54, 56
    s_lshl_b32 s7, s45, 1
    s_add_u32 s46, s6, s7
    s_mul_i32 s4, s46, 20480
    s_mul_i32 s5, s44, 5120
    s_add_u32 s4, s4, s5
    s_add_u32 s4, s4, 7342080
    v_add_u32 v75, s4, v4
    v_add_u32 v76, 20480, v75
    s_and_b32 s4, s3, 1
    s_mul_i32 s4, s4, 20480
    s_lshr_b32 s5, s3, 1
    s_lshl_b32 s5, s5, 6
    s_add_u32 s4, s4, s5
    v_lshl_add_u32 v28, v3, 10, s4
    v_lshl_add_u32 v28, v2, 2, v28
    s_cmp_lt_u32 s42, 8
    s_cselect_b32 s48, 21, 0
    s_add_u32 s48, s48, s42
    s_add_u32 s48, s48, 76
    s_sub_u32 s4, s42, 5
    s_cmp_ge_u32 s4, 21
    s_cbranch_scc1 Lwp_n1
    s_lshr_b32 s4, s48, 1
    s_and_b32 s5, s48, 1
    s_cmp_lt_u32 s4, 50
    s_cselect_b32 s6, -20, 0
    s_cmp_lt_u32 s4, 20
    s_cselect_b32 s6, 30, s6
    s_add_u32 s4, s4, s6
    s_mul_i32 s6, s5, 15360
    s_lshl_b32 s7, s4, 8
    s_add_u32 s47, s6, s7
    s_lshl_b32 s5, s5, 2
    s_add_u32 s5, s5, s3
    s_mul_i32 s5, s5, 80
    s_lshl_b32 s4, s4, 7
    s_mul_i32 s6, s5, 7680
    s_add_u32 s4, s4, s6
    v_min_u32 v78, 39, v1
    s_lshl_b32 s5, s5, 1
    v_lshl_add_u32 v78, v78, 2, s5
    global_load_dword v132, v78, s[30:31]
    v_lshrrev_b32 v79, 3, v1
    v_mul_u32_u24 v78, 15232, v79
    v_add3_u32 v78, v78, v4, s4
    global_load_dwordx4 v[92:95], v78, s[32:33] nt
    v_add_u32 v78, 7680, v78
    global_load_dwordx4 v[96:99], v78, s[32:33] nt
    v_add_u32 v78, 115200, v78
    global_load_dwordx4 v[100:103], v78, s[32:33] nt
    v_add_u32 v78, 7680, v78
    global_load_dwordx4 v[104:107], v78, s[32:33] nt
    v_add_u32 v78, 115200, v78
    global_load_dwordx4 v[108:111], v78, s[32:33] nt
    v_add_u32 v78, 7680, v78
    global_load_dwordx4 v[112:115], v78, s[32:33] nt
    v_add_u32 v78, 115200, v78
    global_load_dwordx4 v[116:119], v78, s[32:33] nt
    v_add_u32 v78, 7680, v78
    global_load_dwordx4 v[120:123], v78, s[32:33] nt
    v_add_u32 v78, 115200, v78
    global_load_dwordx4 v[124:127], v78, s[32:33] nt
    v_add_u32 v78, 7680, v78
    global_load_dwordx4 v[128:131], v78, s[32:33] nt
    s_waitcnt vmcnt(11)
    s_branch Lwp_n2
Lwp_n1:
    s_waitcnt vmcnt(0)
Lwp_n2:
    s_barrier
    ds_read_b32 v32, v28 offset:0
    ds_read_b32 v33, v28 offset:128
    ds_read_b32 v34, v28 offset:256
    ds_read_b32 v35, v28 offset:384
    ds_read_b32 v36, v28 offset:512
    ds_read_b32 v37, v28 offset:640
    ds_read_b32 v38, v28 offset:768
    ds_read_b32 v39, v28 offset:896
    ds_read_b32 v40, v28 offset:4096
    ds_read_b32 v41, v28 offset:4224
    ds_read_b32 v42, v28 offset:4352
    ds_read_b32 v43, v28 offset:4480
    ds_read_b32 v44, v28 offset:4608
    ds_read_b32 v45, v28 offset:4736
    ds_read_b32 v46, v28 offset:4864
    ds_read_b32 v47, v28 offset:4992
    ds_read_b32 v48, v28 offset:8192
    ds_read_b32 v49, v28 offset:8320
    ds_read_b32 v50, v28 offset:8448
    ds_read_b32 v51, v28 offset:8576
    ds_read_b32 v52, v28 offset:8704
    ds_read_b32 v53, v28 offset:8832
    ds_read_b32 v54, v28 offset:8960
    ds_read_b32 v55, v28 offset:9088
    ds_read_b32 v56, v28 offset:12288
    ds_read_b32 v57, v28 offset:12416
    ds_read_b32 v58, v28 offset:12544
    ds_read_b32 v59, v28 offset:12672
    ds_read_b32 v60, v28 offset:12800
    ds_read_b32 v61, v28 offset:12928
    ds_read_b32 v62, v28 offset:13056
    ds_read_b32 v63, v28 offset:13184
    ds_read_b32 v64, v28 offset:16384
    ds_read_b32 v65, v28 offset:16512
    ds_read_b32 v66, v28 offset:16640
    ds_read_b32 v67, v28 offset:16768
    ds_read_b32 v68, v28 offset:16896
    ds_read_b32 v69, v28 offset:17024
    ds_read_b32 v70, v28 offset:17152
    ds_read_b32 v71, v28 offset:17280
    s_waitcnt lgkmcnt(15)
    v_lshlrev_b32 v152, 16, v32
    v_and_b32 v153, 0xffff0000, v32
    v_lshlrev_b32 v154, 16, v33
    v_and_b32 v155, 0xffff0000, v33
    v_lshlrev_b32 v156, 16, v34
    v_and_b32 v157, 0xffff0000, v34
    v_lshlrev_b32 v158, 16, v35
    v_and_b32 v159, 0xffff0000, v35
    v_lshlrev_b32 v160, 16, v36
    v_and_b32 v161, 0xffff0000, v36
    v_lshlrev_b32 v162, 16, v37
    v_and_b32 v163, 0xffff0000, v37
    v_lshlrev_b32 v164, 16, v38
    v_and_b32 v165, 0xffff0000, v38
    v_lshlrev_b32 v166, 16, v39
    v_and_b32 v167, 0xffff0000, v39
    v_lshlrev_b32 v168, 16, v40
    v_and_b32 v169, 0xffff0000, v40
    v_lshlrev_b32 v170, 16, v41
    v_and_b32 v171, 0xffff0000, v41
    v_lshlrev_b32 v172, 16, v42
    v_and_b32 v173, 0xffff0000, v42
    v_lshlrev_b32 v174, 16, v43
    v_and_b32 v175, 0xffff0000, v43
    v_lshlrev_b32 v176, 16, v44
    v_and_b32 v177, 0xffff0000, v44
    v_lshlrev_b32 v178, 16, v45
    v_and_b32 v179, 0xffff0000, v45
    v_lshlrev_b32 v180, 16, v46
    v_and_b32 v181, 0xffff0000, v46
    v_lshlrev_b32 v182, 16, v47
    v_and_b32 v183, 0xffff0000, v47
    v_lshlrev_b32 v184, 16, v48
    v_and_b32 v185, 0xffff0000, v48
    v_lshlrev_b32 v186, 16, v49
    v_and_b32 v187, 0xffff0000, v49
    v_lshlrev_b32 v188, 16, v50
    v_and_b32 v189, 0xffff0000, v50
    v_lshlrev_b32 v190, 16, v51
    v_and_b32 v191, 0xffff0000, v51
    v_lshlrev_b32 v192, 16, v52
    v_and_b32 v193, 0xffff0000, v52
    v_lshlrev_b32 v194, 16, v53
    v_and_b32 v195, 0xffff0000, v53
    v_lshlrev_b32 v196, 16, v54
    v_and_b32 v197, 0xffff0000, v54
    v_lshlrev_b32 v198, 16, v55
    v_and_b32 v199, 0xffff0000, v55
    v_lshlrev_b32 v200, 16, v56
    v_and_b32 v201, 0xffff0000, v56
    s_waitcnt lgkmcnt(0)
    v_lshlrev_b32 v202, 16, v57
    v_and_b32 v203, 0xffff0000, v57
    v_lshlrev_b32 v204, 16, v58
    v_and_b32 v205, 0xffff0000, v58
    v_lshlrev_b32 v206, 16, v59
    v_and_b32 v207, 0xffff0000, v59
    v_lshlrev_b32 v208, 16, v60
    v_and_b32 v209, 0xffff0000, v60
    v_lshlrev_b32 v210, 16, v61
    v_and_b32 v211, 0xffff0000, v61
    v_lshlrev_b32 v212, 16, v62
    v_and_b32 v213, 0xffff0000, v62
    v_lshlrev_b32 v214, 16, v63
    v_and_b32 v215, 0xffff0000, v63
    v_lshlrev_b32 v216, 16, v64
    v_and_b32 v217, 0xffff0000, v64
    v_lshlrev_b32 v218, 16, v65
    v_and_b32 v219, 0xffff0000, v65
    v_lshlrev_b32 v220, 16, v66
    v_and_b32 v221, 0xffff0000, v66
    v_lshlrev_b32 v222, 16, v67
    v_and_b32 v223, 0xffff0000, v67
    v_lshlrev_b32 v224, 16, v68
    v_and_b32 v225, 0xffff0000, v68
    v_lshlrev_b32 v226, 16, v69
    v_and_b32 v227, 0xffff0000, v69
    v_lshlrev_b32 v228, 16, v70
    v_and_b32 v229, 0xffff0000, v70
    v_lshlrev_b32 v230, 16, v71
    v_and_b32 v231, 0xffff0000, v71
    s_cmp_lg_u32 s3, 0
    s_cbranch_scc1 Lwic_x
    v_min_u32 v32, 49, v1
    v_cmp_lt_u32 vcc, 7, v32
    s_nop 1
    v_cndmask_b32_e64 v33, 0, 7, vcc
    v_add_lshl_u32 v32, v32, v33, 2
    s_branch Lwic_f
Lwic:
    s_sleep 4
Lwic_f:
    global_load_dword v33, v32, s[36:37] sc1
    s_waitcnt vmcnt(0)
    v_cmp_eq_u32 vcc, 0, v33
    s_add_u32 s100, s100, 1
    s_cmp_ge_u32 s100, 262144
    s_cbranch_scc1 Lwic_x
    s_cbranch_vccnz Lwic
Lwic_x:
    s_waitcnt vmcnt(0)
    s_barrier
    s_sub_u32 s4, s42, 5
    s_cmp_ge_u32 s4, 21
    s_cbranch_scc1 Lwp_n3
    v_lshlrev_b32 v134, 16, v132
    v_and_b32 v135, 0xffff0000, v132
    v_lshlrev_b32 v79, 2, v79
    v_mul_f32 v136, 0xbfb8aa3b, v134
    v_mul_f32 v137, 0xbfb8aa3b, v135
    v_exp_f32 v136, v136
    v_exp_f32 v137, v137
    v_add_f32 v136, 1.0, v136
    v_add_f32 v137, 1.0, v137
    v_rcp_f32 v136, v136
    v_rcp_f32 v137, v137
    v_mul_f32 v134, v134, v136
    v_mul_f32 v135, v135, v137
    v_cvt_pk_bf16_f32 v132, v134, v135
    ds_bpermute_b32 v140, v79, v132 offset:0
    ds_bpermute_b32 v141, v79, v132 offset:32
    ds_bpermute_b32 v142, v79, v132 offset:64
    ds_bpermute_b32 v143, v79, v132 offset:96
    ds_bpermute_b32 v144, v79, v132 offset:128
    s_waitcnt lgkmcnt(4)
    v_lshlrev_b32 v80, 16, v140
    v_and_b32 v81, 0xffff0000, v140
    s_waitcnt lgkmcnt(3)
    v_lshlrev_b32 v82, 16, v141
    v_and_b32 v83, 0xffff0000, v141
    s_waitcnt lgkmcnt(2)
    v_lshlrev_b32 v84, 16, v142
    v_and_b32 v85, 0xffff0000, v142
    s_waitcnt lgkmcnt(1)
    v_lshlrev_b32 v86, 16, v143
    v_and_b32 v87, 0xffff0000, v143
    s_waitcnt lgkmcnt(0)
    v_lshlrev_b32 v88, 16, v144
    v_and_b32 v89, 0xffff0000, v144
    v_lshlrev_b32 v132, 16, v92
    v_and_b32 v133, 0xffff0000, v92
    v_lshlrev_b32 v134, 16, v93
    v_and_b32 v135, 0xffff0000, v93
    v_lshlrev_b32 v136, 16, v94
    v_and_b32 v137, 0xffff0000, v94
    v_lshlrev_b32 v138, 16, v95
    v_and_b32 v139, 0xffff0000, v95
    v_pk_mul_f32 v[140:141], v[80:81], v[132:133] op_sel:[0,0] op_sel_hi:[0,1]
    v_pk_mul_f32 v[142:143], v[80:81], v[134:135] op_sel:[0,0] op_sel_hi:[0,1]
    v_pk_mul_f32 v[144:145], v[80:81], v[136:137] op_sel:[0,0] op_sel_hi:[0,1]
    v_pk_mul_f32 v[146:147], v[80:81], v[138:139] op_sel:[0,0] op_sel_hi:[0,1]
    v_lshlrev_b32 v132, 16, v96
    v_and_b32 v133, 0xffff0000, v96
    v_lshlrev_b32 v134, 16, v97
    v_and_b32 v135, 0xffff0000, v97
    v_lshlrev_b32 v136, 16, v98
    v_and_b32 v137, 0xffff0000, v98
    v_lshlrev_b32 v138, 16, v99
    v_and_b32 v139, 0xffff0000, v99
    v_pk_fma_f32 v[140:141], v[80:81], v[132:133], v[140:141] op_sel:[1,0,0] op_sel_hi:[1,1,1]
    v_pk_fma_f32 v[142:143], v[80:81], v[134:135], v[142:143] op_sel:[1,0,0] op_sel_hi:[1,1,1]
    v_pk_fma_f32 v[144:145], v[80:81], v[136:137], v[144:145] op_sel:[1,0,0] op_sel_hi:[1,1,1]
    v_pk_fma_f32 v[146:147], v[80:81], v[138:139], v[146:147] op_sel:[1,0,0] op_sel_hi:[1,1,1]
    v_lshlrev_b32 v132, 16, v100
    v_and_b32 v133, 0xffff0000, v100
    v_lshlrev_b32 v134, 16, v101
    v_and_b32 v135, 0xffff0000, v101
    v_lshlrev_b32 v136, 16, v102
    v_and_b32 v137, 0xffff0000, v102
    v_lshlrev_b32 v138, 16, v103
    v_and_b32 v139, 0xffff0000, v103
    v_pk_fma_f32 v[140:141], v[82:83], v[132:133], v[140:141] op_sel:[0,0,0] op_sel_hi:[0,1,1]
    v_pk_fma_f32 v[142:143], v[82:83], v[134:135], v[142:143] op_sel:[0,0,0] op_sel_hi:[0,1,1]
    v_pk_fma_f32 v[144:145], v[82:83], v[136:137], v[144:145] op_sel:[0,0,0] op_sel_hi:[0,1,1]
    v_pk_fma_f32 v[146:147], v[82:83], v[138:139], v[146:147] op_sel:[0,0,0] op_sel_hi:[0,1,1]
    v_lshlrev_b32 v132, 16, v104
    v_and_b32 v133, 0xffff0000, v104
    v_lshlrev_b32 v134, 16, v105
    v_and_b32 v135, 0xffff0000, v105
    v_lshlrev_b32 v136, 16, v106
    v_and_b32 v137, 0xffff0000, v106
    v_lshlrev_b32 v138, 16, v107
    v_and_b32 v139, 0xffff0000, v107
    v_pk_fma_f32 v[140:141], v[82:83], v[132:133], v[140:141] op_sel:[1,0,0] op_sel_hi:[1,1,1]
    v_pk_fma_f32 v[142:143], v[82:83], v[134:135], v[142:143] op_sel:[1,0,0] op_sel_hi:[1,1,1]
    v_pk_fma_f32 v[144:145], v[82:83], v[136:137], v[144:145] op_sel:[1,0,0] op_sel_hi:[1,1,1]
    v_pk_fma_f32 v[146:147], v[82:83], v[138:139], v[146:147] op_sel:[1,0,0] op_sel_hi:[1,1,1]
    v_lshlrev_b32 v132, 16, v108
    v_and_b32 v133, 0xffff0000, v108
    v_lshlrev_b32 v134, 16, v109
    v_and_b32 v135, 0xffff0000, v109
    v_lshlrev_b32 v136, 16, v110
    v_and_b32 v137, 0xffff0000, v110
    v_lshlrev_b32 v138, 16, v111
    v_and_b32 v139, 0xffff0000, v111
    v_pk_fma_f32 v[140:141], v[84:85], v[132:133], v[140:141] op_sel:[0,0,0] op_sel_hi:[0,1,1]
    v_pk_fma_f32 v[142:143], v[84:85], v[134:135], v[142:143] op_sel:[0,0,0] op_sel_hi:[0,1,1]
    v_pk_fma_f32 v[144:145], v[84:85], v[136:137], v[144:145] op_sel:[0,0,0] op_sel_hi:[0,1,1]
    v_pk_fma_f32 v[146:147], v[84:85], v[138:139], v[146:147] op_sel:[0,0,0] op_sel_hi:[0,1,1]
    v_lshlrev_b32 v132, 16, v112
    v_and_b32 v133, 0xffff0000, v112
    v_lshlrev_b32 v134, 16, v113
    v_and_b32 v135, 0xffff0000, v113
    v_lshlrev_b32 v136, 16, v114
    v_and_b32 v137, 0xffff0000, v114
    v_lshlrev_b32 v138, 16, v115
    v_and_b32 v139, 0xffff0000, v115
    v_pk_fma_f32 v[140:141], v[84:85], v[132:133], v[140:141] op_sel:[1,0,0] op_sel_hi:[1,1,1]
    v_pk_fma_f32 v[142:143], v[84:85], v[134:135], v[142:143] op_sel:[1,0,0] op_sel_hi:[1,1,1]
    v_pk_fma_f32 v[144:145], v[84:85], v[136:137], v[144:145] op_sel:[1,0,0] op_sel_hi:[1,1,1]
    v_pk_fma_f32 v[146:147], v[84:85], v[138:139], v[146:147] op_sel:[1,0,0] op_sel_hi:[1,1,1]
    v_lshlrev_b32 v132, 16, v116
    v_and_b32 v133, 0xffff0000, v116
    v_lshlrev_b32 v134, 16, v117
    v_and_b32 v135, 0xffff0000, v117
    v_lshlrev_b32 v136, 16, v118
    v_and_b32 v137, 0xffff0000, v118
    v_lshlrev_b32 v138, 16, v119
    v_and_b32 v139, 0xffff0000, v119
    v_pk_fma_f32 v[140:141], v[86:87], v[132:133], v[140:141] op_sel:[0,0,0] op_sel_hi:[0,1,1]
    v_pk_fma_f32 v[142:143], v[86:87], v[134:135], v[142:143] op_sel:[0,0,0] op_sel_hi:[0,1,1]
    v_pk_fma_f32 v[144:145], v[86:87], v[136:137], v[144:145] op_sel:[0,0,0] op_sel_hi:[0,1,1]
    v_pk_fma_f32 v[146:147], v[86:87], v[138:139], v[146:147] op_sel:[0,0,0] op_sel_hi:[0,1,1]
    v_lshlrev_b32 v132, 16, v120
    v_and_b32 v133, 0xffff0000, v120
    v_lshlrev_b32 v134, 16, v121
    v_and_b32 v135, 0xffff0000, v121
    v_lshlrev_b32 v136, 16, v122
    v_and_b32 v137, 0xffff0000, v122
    v_lshlrev_b32 v138, 16, v123
    v_and_b32 v139, 0xffff0000, v123
    v_pk_fma_f32 v[140:141], v[86:87], v[132:133], v[140:141] op_sel:[1,0,0] op_sel_hi:[1,1,1]
    v_pk_fma_f32 v[142:143], v[86:87], v[134:135], v[142:143] op_sel:[1,0,0] op_sel_hi:[1,1,1]
    v_pk_fma_f32 v[144:145], v[86:87], v[136:137], v[144:145] op_sel:[1,0,0] op_sel_hi:[1,1,1]
    v_pk_fma_f32 v[146:147], v[86:87], v[138:139], v[146:147] op_sel:[1,0,0] op_sel_hi:[1,1,1]
    v_lshlrev_b32 v132, 16, v124
    v_and_b32 v133, 0xffff0000, v124
    v_lshlrev_b32 v134, 16, v125
    v_and_b32 v135, 0xffff0000, v125
    v_lshlrev_b32 v136, 16, v126
    v_and_b32 v137, 0xffff0000, v126
    v_lshlrev_b32 v138, 16, v127
    v_and_b32 v139, 0xffff0000, v127
    v_pk_fma_f32 v[140:141], v[88:89], v[132:133], v[140:141] op_sel:[0,0,0] op_sel_hi:[0,1,1]
    v_pk_fma_f32 v[142:143], v[88:89], v[134:135], v[142:143] op_sel:[0,0,0] op_sel_hi:[0,1,1]
    v_pk_fma_f32 v[144:145], v[88:89], v[136:137], v[144:145] op_sel:[0,0,0] op_sel_hi:[0,1,1]
    v_pk_fma_f32 v[146:147], v[88:89], v[138:139], v[146:147] op_sel:[0,0,0] op_sel_hi:[0,1,1]
    v_lshlrev_b32 v132, 16, v128
    v_and_b32 v133, 0xffff0000, v128
    v_lshlrev_b32 v134, 16, v129
    v_and_b32 v135, 0xffff0000, v129
    v_lshlrev_b32 v136, 16, v130
    v_and_b32 v137, 0xffff0000, v130
    v_lshlrev_b32 v138, 16, v131
    v_and_b32 v139, 0xffff0000, v131
    v_pk_fma_f32 v[140:141], v[88:89], v[132:133], v[140:141] op_sel:[1,0,0] op_sel_hi:[1,1,1]
    v_pk_fma_f32 v[142:143], v[88:89], v[134:135], v[142:143] op_sel:[1,0,0] op_sel_hi:[1,1,1]
    v_pk_fma_f32 v[144:145], v[88:89], v[136:137], v[144:145] op_sel:[1,0,0] op_sel_hi:[1,1,1]
    v_pk_fma_f32 v[146:147], v[88:89], v[138:139], v[146:147] op_sel:[1,0,0] op_sel_hi:[1,1,1]
    s_nop 0
    v_permlane32_swap_b32 v140, v144
    v_permlane32_swap_b32 v141, v145
    v_permlane32_swap_b32 v142, v146
    v_permlane32_swap_b32 v143, v147
    v_add_f32 v140, v140, v144
    v_add_f32 v141, v141, v145
    v_add_f32 v142, v142, v146
    v_add_f32 v143, v143, v147
    s_nop 0
    v_permlane16_swap_b32 v140, v142
    v_permlane16_swap_b32 v141, v143
    v_add_f32 v140, v140, v142
    v_add_f32 v141, v141, v143
    v_and_b32 v133, 7, v1
    v_lshrrev_b32 v134, 3, v1
    v_add_f32_dpp v132, v140, v140 row_ror:8 row_mask:0xf bank_mask:0x3
    s_nop 1
    v_add_f32_dpp v132, v141, v141 row_ror:8 row_mask:0xf bank_mask:0xc
    v_lshl_add_u32 v133, v133, 3, v134
    s_lshl_b32 s7, s3, 8
    s_add_u32 s7, s7, 122880
    v_lshl_add_u32 v133, v133, 2, s7
    ds_write_b32 v133, v132
    s_waitcnt lgkmcnt(0)
    s_barrier
    v_lshlrev_b32 v133, 2, v1
    v_add_u32 v134, 122880, v133
    ds_read_b32 v140, v134 offset:0
    ds_read_b32 v141, v134 offset:256
    ds_read_b32 v142, v134 offset:512
    ds_read_b32 v143, v134 offset:768
    v_add_u32 v133, s47, v133
    s_waitcnt lgkmcnt(2)
    v_add_f32 v140, v140, v141
    s_waitcnt lgkmcnt(0)
    v_add_f32 v142, v142, v143
    v_add_f32 v140, v140, v142
    v_min_u32 v140, -2, v140
    s_cmp_lg_u32 s3, 0
    s_cbranch_scc1 Lmod_skip_w
    global_store_dword v133, v140, s[38:39] offset:0 sc1
Lmod_skip_w:
Lwp_n3:
    s_branch Lwm_f
Lwm:
    s_sleep 4
Lwm_f:
    v_add_u32 v77, 0, v73
    global_load_dwordx4 v[80:83], v77, s[38:39] sc1
    global_load_dwordx4 v[84:87], v77, s[38:39] offset:2560 sc1
    v_add_u32 v77, 15360, v73
    global_load_dwordx4 v[88:91], v77, s[38:39] sc1
    global_load_dwordx4 v[92:95], v77, s[38:39] offset:2560 sc1
    s_waitcnt vmcnt(0)
    v_max_u32 v77, v80, v81
    v_max3_u32 v77, v82, v83, v77
    v_max3_u32 v77, v84, v85, v77
    v_max3_u32 v77, v86, v87, v77
    v_max3_u32 v77, v88, v89, v77
    v_max3_u32 v77, v90, v91, v77
    v_max3_u32 v77, v92, v93, v77
    v_max3_u32 v77, v94, v95, v77
    v_cmp_eq_u32 vcc, -1, v77
    s_add_u32 s100, s100, 1
    s_cmp_ge_u32 s100, 262144
    s_cbranch_scc1 Lwm_x
    s_cbranch_vccnz Lwm
Lwm_x:
    v_pk_add_f32 v[80:81], v[80:81], v[88:89] op_sel:[0,0] op_sel_hi:[1,1]
    v_pk_add_f32 v[82:83], v[82:83], v[90:91] op_sel:[0,0] op_sel_hi:[1,1]
    v_pk_add_f32 v[84:85], v[84:85], v[92:93] op_sel:[0,0] op_sel_hi:[1,1]
    v_pk_add_f32 v[86:87], v[86:87], v[94:95] op_sel:[0,0] op_sel_hi:[1,1]
    v_cvt_pk_bf16_f32 v80, v80, v80
    v_lshlrev_b32 v80, 16, v80
    v_cvt_pk_bf16_f32 v81, v81, v81
    v_lshlrev_b32 v81, 16, v81
    v_cvt_pk_bf16_f32 v82, v82, v82
    v_lshlrev_b32 v82, 16, v82
    v_cvt_pk_bf16_f32 v83, v83, v83
    v_lshlrev_b32 v83, 16, v83
    v_cvt_pk_bf16_f32 v84, v84, v84
    v_lshlrev_b32 v84, 16, v84
    v_cvt_pk_bf16_f32 v85, v85, v85
    v_lshlrev_b32 v85, 16, v85
    v_cvt_pk_bf16_f32 v86, v86, v86
    v_lshlrev_b32 v86, 16, v86
    v_cvt_pk_bf16_f32 v87, v87, v87
    v_lshlrev_b32 v87, 16, v87
    v_add_f32 v84, 1.0, v84
    v_add_f32 v85, 1.0, v85
    v_add_f32 v86, 1.0, v86
    v_add_f32 v87, 1.0, v87
    v_cvt_pk_bf16_f32 v84, v84, v84
    v_lshlrev_b32 v84, 16, v84
    v_cvt_pk_bf16_f32 v85, v85, v85
    v_lshlrev_b32 v85, 16, v85
    v_cvt_pk_bf16_f32 v86, v86, v86
    v_lshlrev_b32 v86, 16, v86
    v_cvt_pk_bf16_f32 v87, v87, v87
    v_lshlrev_b32 v87, 16, v87
    ds_write_b128 v72, v[84:87]
    ds_write_b128 v72, v[80:83] offset:640
    ds_read_b128 v[32:35], v74 offset:0
    ds_read_b128 v[36:39], v74 offset:16
    ds_read_b128 v[40:43], v74 offset:128
    ds_read_b128 v[44:47], v74 offset:144
    ds_read_b128 v[48:51], v74 offset:256
    ds_read_b128 v[52:55], v74 offset:272
    ds_read_b128 v[56:59], v74 offset:384
    ds_read_b128 v[60:63], v74 offset:400
    ds_read_b128 v[64:67], v74 offset:512
    ds_read_b128 v[68:71], v74 offset:528
    s_waitcnt lgkmcnt(9)
    v_pk_mul_f32 v[96:97], v[32:33], v[152:153] op_sel:[0,0] op_sel_hi:[0,1]
    v_pk_mul_f32 v[98:99], v[32:33], v[154:155] op_sel:[1,0] op_sel_hi:[1,1]
    v_pk_mul_f32 v[100:101], v[34:35], v[156:157] op_sel:[0,0] op_sel_hi:[0,1]
    v_pk_mul_f32 v[102:103], v[34:35], v[158:159] op_sel:[1,0] op_sel_hi:[1,1]
    s_waitcnt lgkmcnt(8)
    v_pk_mul_f32 v[104:105], v[36:37], v[160:161] op_sel:[0,0] op_sel_hi:[0,1]
    v_pk_mul_f32 v[106:107], v[36:37], v[162:163] op_sel:[1,0] op_sel_hi:[1,1]
    v_pk_mul_f32 v[108:109], v[38:39], v[164:165] op_sel:[0,0] op_sel_hi:[0,1]
    v_pk_mul_f32 v[110:111], v[38:39], v[166:167] op_sel:[1,0] op_sel_hi:[1,1]
    v_cvt_pk_bf16_f32 v112, v96, v98
    v_cvt_pk_bf16_f32 v113, v100, v102
    v_cvt_pk_bf16_f32 v114, v104, v106
    v_cvt_pk_bf16_f32 v115, v108, v110
    v_cvt_pk_bf16_f32 v116, v97, v99
    v_cvt_pk_bf16_f32 v117, v101, v103
    v_cvt_pk_bf16_f32 v118, v105, v107
    v_cvt_pk_bf16_f32 v119, v109, v111
    global_store_dwordx4 v75, v[112:115], s[38:39] offset:-2048 sc1
    global_store_dwordx4 v76, v[116:119], s[38:39] offset:-2048 sc1
    s_waitcnt lgkmcnt(1)
    v_pk_mul_f32 v[96:97], v[40:41], v[168:169] op_sel:[0,0] op_sel_hi:[0,1]
    v_pk_mul_f32 v[98:99], v[40:41], v[170:171] op_sel:[1,0] op_sel_hi:[1,1]
    v_pk_mul_f32 v[100:101], v[42:43], v[172:173] op_sel:[0,0] op_sel_hi:[0,1]
    v_pk_mul_f32 v[102:103], v[42:43], v[174:175] op_sel:[1,0] op_sel_hi:[1,1]
    v_pk_mul_f32 v[104:105], v[44:45], v[176:177] op_sel:[0,0] op_sel_hi:[0,1]
    v_pk_mul_f32 v[106:107], v[44:45], v[178:179] op_sel:[1,0] op_sel_hi:[1,1]
    v_pk_mul_f32 v[108:109], v[46:47], v[180:181] op_sel:[0,0] op_sel_hi:[0,1]
    v_pk_mul_f32 v[110:111], v[46:47], v[182:183] op_sel:[1,0] op_sel_hi:[1,1]
    v_cvt_pk_bf16_f32 v120, v96, v98
    v_cvt_pk_bf16_f32 v121, v100, v102
    v_cvt_pk_bf16_f32 v122, v104, v106
    v_cvt_pk_bf16_f32 v123, v108, v110
    v_cvt_pk_bf16_f32 v124, v97, v99
    v_cvt_pk_bf16_f32 v125, v101, v103
    v_cvt_pk_bf16_f32 v126, v105, v107
    v_cvt_pk_bf16_f32 v127, v109, v111
    global_store_dwordx4 v75, v[120:123], s[38:39] offset:-1024 sc1
    global_store_dwordx4 v76, v[124:127], s[38:39] offset:-1024 sc1
    v_pk_mul_f32 v[96:97], v[48:49], v[184:185] op_sel:[0,0] op_sel_hi:[0,1]
    v_pk_mul_f32 v[98:99], v[48:49], v[186:187] op_sel:[1,0] op_sel_hi:[1,1]
    v_pk_mul_f32 v[100:101], v[50:51], v[188:189] op_sel:[0,0] op_sel_hi:[0,1]
    v_pk_mul_f32 v[102:103], v[50:51], v[190:191] op_sel:[1,0] op_sel_hi:[1,1]
    v_pk_mul_f32 v[104:105], v[52:53], v[192:193] op_sel:[0,0] op_sel_hi:[0,1]
    v_pk_mul_f32 v[106:107], v[52:53], v[194:195] op_sel:[1,0] op_sel_hi:[1,1]
    v_pk_mul_f32 v[108:109], v[54:55], v[196:197] op_sel:[0,0] op_sel_hi:[0,1]
    v_pk_mul_f32 v[110:111], v[54:55], v[198:199] op_sel:[1,0] op_sel_hi:[1,1]
    v_cvt_pk_bf16_f32 v128, v96, v98
    v_cvt_pk_bf16_f32 v129, v100, v102
    v_cvt_pk_bf16_f32 v130, v104, v106
    v_cvt_pk_bf16_f32 v131, v108, v110
    v_cvt_pk_bf16_f32 v132, v97, v99
    v_cvt_pk_bf16_f32 v133, v101, v103
    v_cvt_pk_bf16_f32 v134, v105, v107
    v_cvt_pk_bf16_f32 v135, v109, v111
    global_store_dwordx4 v75, v[128:131], s[38:39] offset:0 sc1
    global_store_dwordx4 v76, v[132:135], s[38:39] offset:0 sc1
    v_pk_mul_f32 v[96:97], v[56:57], v[200:201] op_sel:[0,0] op_sel_hi:[0,1]
    v_pk_mul_f32 v[98:99], v[56:57], v[202:203] op_sel:[1,0] op_sel_hi:[1,1]
    v_pk_mul_f32 v[100:101], v[58:59], v[204:205] op_sel:[0,0] op_sel_hi:[0,1]
    v_pk_mul_f32 v[102:103], v[58:59], v[206:207] op_sel:[1,0] op_sel_hi:[1,1]
    v_pk_mul_f32 v[104:105], v[60:61], v[208:209] op_sel:[0,0] op_sel_hi:[0,1]
    v_pk_mul_f32 v[106:107], v[60:61], v[210:211] op_sel:[1,0] op_sel_hi:[1,1]
    v_pk_mul_f32 v[108:109], v[62:63], v[212:213] op_sel:[0,0] op_sel_hi:[0,1]
    v_pk_mul_f32 v[110:111], v[62:63], v[214:215] op_sel:[1,0] op_sel_hi:[1,1]
    v_cvt_pk_bf16_f32 v136, v96, v98
    v_cvt_pk_bf16_f32 v137, v100, v102
    v_cvt_pk_bf16_f32 v138, v104, v106
    v_cvt_pk_bf16_f32 v139, v108, v110
    v_cvt_pk_bf16_f32 v140, v97, v99
    v_cvt_pk_bf16_f32 v141, v101, v103
    v_cvt_pk_bf16_f32 v142, v105, v107
    v_cvt_pk_bf16_f32 v143, v109, v111
    global_store_dwordx4 v75, v[136:139], s[38:39] offset:1024 sc1
    global_store_dwordx4 v76, v[140:143], s[38:39] offset:1024 sc1
    v_pk_mul_f32 v[96:97], v[64:65], v[216:217] op_sel:[0,0] op_sel_hi:[0,1]
    v_pk_mul_f32 v[98:99], v[64:65], v[218:219] op_sel:[1,0] op_sel_hi:[1,1]
    v_pk_mul_f32 v[100:101], v[66:67], v[220:221] op_sel:[0,0] op_sel_hi:[0,1]
    v_pk_mul_f32 v[102:103], v[66:67], v[222:223] op_sel:[1,0] op_sel_hi:[1,1]
    s_waitcnt lgkmcnt(0)
    v_pk_mul_f32 v[104:105], v[68:69], v[224:225] op_sel:[0,0] op_sel_hi:[0,1]
    v_pk_mul_f32 v[106:107], v[68:69], v[226:227] op_sel:[1,0] op_sel_hi:[1,1]
    v_pk_mul_f32 v[108:109], v[70:71], v[228:229] op_sel:[0,0] op_sel_hi:[0,1]
    v_pk_mul_f32 v[110:111], v[70:71], v[230:231] op_sel:[1,0] op_sel_hi:[1,1]
    v_cvt_pk_bf16_f32 v144, v96, v98
    v_cvt_pk_bf16_f32 v145, v100, v102
    v_cvt_pk_bf16_f32 v146, v104, v106
    v_cvt_pk_bf16_f32 v147, v108, v110
    v_cvt_pk_bf16_f32 v148, v97, v99
    v_cvt_pk_bf16_f32 v149, v101, v103
    v_cvt_pk_bf16_f32 v150, v105, v107
    v_cvt_pk_bf16_f32 v151, v109, v111
    global_store_dwordx4 v75, v[144:147], s[38:39] offset:2048 sc1
    global_store_dwordx4 v76, v[148:151], s[38:39] offset:2048 sc1
    ds_read_b128 v[32:35], v74 offset:640
    ds_read_b128 v[36:39], v74 offset:656
    ds_read_b128 v[40:43], v74 offset:768
    ds_read_b128 v[44:47], v74 offset:784
    ds_read_b128 v[48:51], v74 offset:896
    ds_read_b128 v[52:55], v74 offset:912
    ds_read_b128 v[56:59], v74 offset:1024
    ds_read_b128 v[60:63], v74 offset:1040
    ds_read_b128 v[64:67], v74 offset:1152
    ds_read_b128 v[68:71], v74 offset:1168
    s_mov_b32 s7, 0x3f803f80
    v_mov_b32 v88, 0
    v_mov_b32 v89, 0
    v_mov_b32 v90, 0
    v_mov_b32 v91, 0
    v_mov_b32 v92, 0
    v_mov_b32 v93, 0
    v_mov_b32 v94, 0
    v_mov_b32 v95, 0
    v_dot2_f32_bf16 v88, v112, s7, v88
    v_dot2_f32_bf16 v89, v116, s7, v89
    v_dot2_f32_bf16 v88, v113, s7, v88
    v_dot2_f32_bf16 v89, v117, s7, v89
    v_dot2_f32_bf16 v88, v114, s7, v88
    v_dot2_f32_bf16 v89, v118, s7, v89
    v_dot2_f32_bf16 v88, v115, s7, v88
    v_dot2_f32_bf16 v89, v119, s7, v89
    v_dot2_f32_bf16 v88, v120, s7, v88
    v_dot2_f32_bf16 v89, v124, s7, v89
    v_dot2_f32_bf16 v88, v121, s7, v88
    v_dot2_f32_bf16 v89, v125, s7, v89
    v_dot2_f32_bf16 v88, v122, s7, v88
    v_dot2_f32_bf16 v89, v126, s7, v89
    v_dot2_f32_bf16 v88, v123, s7, v88
    v_dot2_f32_bf16 v89, v127, s7, v89
    v_dot2_f32_bf16 v88, v128, s7, v88
    v_dot2_f32_bf16 v89, v132, s7, v89
    v_dot2_f32_bf16 v88, v129, s7, v88
    v_dot2_f32_bf16 v89, v133, s7, v89
    v_dot2_f32_bf16 v88, v130, s7, v88
    v_dot2_f32_bf16 v89, v134, s7, v89
    v_dot2_f32_bf16 v88, v131, s7, v88
    v_dot2_f32_bf16 v89, v135, s7, v89
    v_dot2_f32_bf16 v88, v136, s7, v88
    v_dot2_f32_bf16 v89, v140, s7, v89
    v_dot2_f32_bf16 v88, v137, s7, v88
    v_dot2_f32_bf16 v89, v141, s7, v89
    v_dot2_f32_bf16 v88, v138, s7, v88
    v_dot2_f32_bf16 v89, v142, s7, v89
    v_dot2_f32_bf16 v88, v139, s7, v88
    v_dot2_f32_bf16 v89, v143, s7, v89
    v_dot2_f32_bf16 v88, v144, s7, v88
    v_dot2_f32_bf16 v89, v148, s7, v89
    v_dot2_f32_bf16 v88, v145, s7, v88
    v_dot2_f32_bf16 v89, v149, s7, v89
    v_dot2_f32_bf16 v88, v146, s7, v88
    v_dot2_f32_bf16 v89, v150, s7, v89
    v_dot2_f32_bf16 v88, v147, s7, v88
    v_dot2_f32_bf16 v89, v151, s7, v89
    s_waitcnt lgkmcnt(0)
    v_pk_fma_f32 v[90:91], v[32:33], v[152:153], v[90:91] op_sel:[0,0,0] op_sel_hi:[0,1,1]
    v_pk_fma_f32 v[92:93], v[32:33], v[154:155], v[92:93] op_sel:[1,0,0] op_sel_hi:[1,1,1]
    v_pk_fma_f32 v[94:95], v[34:35], v[156:157], v[94:95] op_sel:[0,0,0] op_sel_hi:[0,1,1]
    v_pk_fma_f32 v[90:91], v[34:35], v[158:159], v[90:91] op_sel:[1,0,0] op_sel_hi:[1,1,1]
    v_pk_fma_f32 v[92:93], v[36:37], v[160:161], v[92:93] op_sel:[0,0,0] op_sel_hi:[0,1,1]
    v_pk_fma_f32 v[94:95], v[36:37], v[162:163], v[94:95] op_sel:[1,0,0] op_sel_hi:[1,1,1]
    v_pk_fma_f32 v[90:91], v[38:39], v[164:165], v[90:91] op_sel:[0,0,0] op_sel_hi:[0,1,1]
    v_pk_fma_f32 v[92:93], v[38:39], v[166:167], v[92:93] op_sel:[1,0,0] op_sel_hi:[1,1,1]
    v_pk_fma_f32 v[94:95], v[40:41], v[168:169], v[94:95] op_sel:[0,0,0] op_sel_hi:[0,1,1]
    v_pk_fma_f32 v[90:91], v[40:41], v[170:171], v[90:91] op_sel:[1,0,0] op_sel_hi:[1,1,1]
    v_pk_fma_f32 v[92:93], v[42:43], v[172:173], v[92:93] op_sel:[0,0,0] op_sel_hi:[0,1,1]
    v_pk_fma_f32 v[94:95], v[42:43], v[174:175], v[94:95] op_sel:[1,0,0] op_sel_hi:[1,1,1]
    v_pk_fma_f32 v[90:91], v[44:45], v[176:177], v[90:91] op_sel:[0,0,0] op_sel_hi:[0,1,1]
    v_pk_fma_f32 v[92:93], v[44:45], v[178:179], v[92:93] op_sel:[1,0,0] op_sel_hi:[1,1,1]
    v_pk_fma_f32 v[94:95], v[46:47], v[180:181], v[94:95] op_sel:[0,0,0] op_sel_hi:[0,1,1]
    v_pk_fma_f32 v[90:91], v[46:47], v[182:183], v[90:91] op_sel:[1,0,0] op_sel_hi:[1,1,1]
    v_pk_fma_f32 v[92:93], v[48:49], v[184:185], v[92:93] op_sel:[0,0,0] op_sel_hi:[0,1,1]
    v_pk_fma_f32 v[94:95], v[48:49], v[186:187], v[94:95] op_sel:[1,0,0] op_sel_hi:[1,1,1]
    v_pk_fma_f32 v[90:91], v[50:51], v[188:189], v[90:91] op_sel:[0,0,0] op_sel_hi:[0,1,1]
    v_pk_fma_f32 v[92:93], v[50:51], v[190:191], v[92:93] op_sel:[1,0,0] op_sel_hi:[1,1,1]
    v_pk_fma_f32 v[94:95], v[52:53], v[192:193], v[94:95] op_sel:[0,0,0] op_sel_hi:[0,1,1]
    v_pk_fma_f32 v[90:91], v[52:53], v[194:195], v[90:91] op_sel:[1,0,0] op_sel_hi:[1,1,1]
    v_pk_fma_f32 v[92:93], v[54:55], v[196:197], v[92:93] op_sel:[0,0,0] op_sel_hi:[0,1,1]
    v_pk_fma_f32 v[94:95], v[54:55], v[198:199], v[94:95] op_sel:[1,0,0] op_sel_hi:[1,1,1]
    v_pk_fma_f32 v[90:91], v[56:57], v[200:201], v[90:91] op_sel:[0,0,0] op_sel_hi:[0,1,1]
    v_pk_fma_f32 v[92:93], v[56:57], v[202:203], v[92:93] op_sel:[1,0,0] op_sel_hi:[1,1,1]
    v_pk_fma_f32 v[94:95], v[58:59], v[204:205], v[94:95] op_sel:[0,0,0] op_sel_hi:[0,1,1]
    v_pk_fma_f32 v[90:91], v[58:59], v[206:207], v[90:91] op_sel:[1,0,0] op_sel_hi:[1,1,1]
    v_pk_fma_f32 v[92:93], v[60:61], v[208:209], v[92:93] op_sel:[0,0,0] op_sel_hi:[0,1,1]
    v_pk_fma_f32 v[94:95], v[60:61], v[210:211], v[94:95] op_sel:[1,0,0] op_sel_hi:[1,1,1]
    v_pk_fma_f32 v[90:91], v[62:63], v[212:213], v[90:91] op_sel:[0,0,0] op_sel_hi:[0,1,1]
    v_pk_fma_f32 v[92:93], v[62:63], v[214:215], v[92:93] op_sel:[1,0,0] op_sel_hi:[1,1,1]
    v_pk_fma_f32 v[94:95], v[64:65], v[216:217], v[94:95] op_sel:[0,0,0] op_sel_hi:[0,1,1]
    v_pk_fma_f32 v[90:91], v[64:65], v[218:219], v[90:91] op_sel:[1,0,0] op_sel_hi:[1,1,1]
    v_pk_fma_f32 v[92:93], v[66:67], v[220:221], v[92:93] op_sel:[0,0,0] op_sel_hi:[0,1,1]
    v_pk_fma_f32 v[94:95], v[66:67], v[222:223], v[94:95] op_sel:[1,0,0] op_sel_hi:[1,1,1]
    v_pk_fma_f32 v[90:91], v[68:69], v[224:225], v[90:91] op_sel:[0,0,0] op_sel_hi:[0,1,1]
    v_pk_fma_f32 v[92:93], v[68:69], v[226:227], v[92:93] op_sel:[1,0,0] op_sel_hi:[1,1,1]
    v_pk_fma_f32 v[94:95], v[70:71], v[228:229], v[94:95] op_sel:[0,0,0] op_sel_hi:[0,1,1]
    v_pk_fma_f32 v[90:91], v[70:71], v[230:231], v[90:91] op_sel:[1,0,0] op_sel_hi:[1,1,1]
    v_pk_add_f32 v[90:91], v[90:91], v[92:93] op_sel:[0,0] op_sel_hi:[1,1]
    v_pk_add_f32 v[90:91], v[90:91], v[94:95] op_sel:[0,0] op_sel_hi:[1,1]
    v_permlane32_swap_b32 v88, v89
    s_nop 0
    v_permlane32_swap_b32 v90, v91
    v_add_f32 v88, v88, v89
    v_add_f32 v90, v90, v91
    s_nop 1
    v_permlane16_swap_b32 v88, v90
    v_add_f32 v88, v88, v90
    v_lshlrev_b32 v74, 2, v0
    v_add_u32 v74, 131072, v74
    ds_write_b32 v74, v88
    v_xor_b32 v74, 256, v74
    s_waitcnt vmcnt(0) lgkmcnt(0)
    s_barrier
    ds_read_b32 v89, v74
    s_lshl_b32 s6, s46, 7
    s_lshr_b32 s5, s44, 1
    s_mul_i32 s5, s5, 14336
    s_add_u32 s6, s6, s5
    s_add_u32 s6, s6, 49152
    v_lshl_add_u32 v74, v1, 2, s6
    s_waitcnt lgkmcnt(0)
    v_add_f32 v88, v88, v89
    v_min_u32 v88, -2, v88
    s_bitcmp1_b32 s3, 0
    s_cbranch_scc1 Lwp_skip
    global_store_dword v74, v88, s[38:39] sc1
Lwp_skip:
    s_branch Lsp_c
Lsp_b3:
    v_lshlrev_b32 v82, 16, v80
    v_and_b32 v83, 0xffff0000, v80
    v_lshlrev_b32 v29, 2, v29
    v_mul_f32 v84, 0xbfb8aa3b, v82
    v_mul_f32 v85, 0xbfb8aa3b, v83
    v_exp_f32 v84, v84
    v_exp_f32 v85, v85
    v_add_f32 v84, 1.0, v84
    v_add_f32 v85, 1.0, v85
    v_rcp_f32 v84, v84
    v_rcp_f32 v85, v85
    v_mul_f32 v82, v82, v84
    v_mul_f32 v83, v83, v85
    v_cvt_pk_bf16_f32 v80, v82, v83
    ds_bpermute_b32 v88, v29, v80 offset:0
    ds_bpermute_b32 v89, v29, v80 offset:32
    ds_bpermute_b32 v90, v29, v80 offset:64
    ds_bpermute_b32 v91, v29, v80 offset:96
    ds_bpermute_b32 v92, v29, v80 offset:128
    s_waitcnt lgkmcnt(4)
    v_lshlrev_b32 v30, 16, v88
    v_and_b32 v31, 0xffff0000, v88
    s_waitcnt lgkmcnt(3)
    v_lshlrev_b32 v32, 16, v89
    v_and_b32 v33, 0xffff0000, v89
    s_waitcnt lgkmcnt(2)
    v_lshlrev_b32 v34, 16, v90
    v_and_b32 v35, 0xffff0000, v90
    s_waitcnt lgkmcnt(1)
    v_lshlrev_b32 v36, 16, v91
    v_and_b32 v37, 0xffff0000, v91
    s_waitcnt lgkmcnt(0)
    v_lshlrev_b32 v38, 16, v92
    v_and_b32 v39, 0xffff0000, v92
    v_lshlrev_b32 v80, 16, v40
    v_and_b32 v81, 0xffff0000, v40
    v_lshlrev_b32 v82, 16, v41
    v_and_b32 v83, 0xffff0000, v41
    v_lshlrev_b32 v84, 16, v42
    v_and_b32 v85, 0xffff0000, v42
    v_lshlrev_b32 v86, 16, v43
    v_and_b32 v87, 0xffff0000, v43
    v_pk_mul_f32 v[88:89], v[30:31], v[80:81] op_sel:[0,0] op_sel_hi:[0,1]
    v_pk_mul_f32 v[90:91], v[30:31], v[82:83] op_sel:[0,0] op_sel_hi:[0,1]
    v_pk_mul_f32 v[92:93], v[30:31], v[84:85] op_sel:[0,0] op_sel_hi:[0,1]
    v_pk_mul_f32 v[94:95], v[30:31], v[86:87] op_sel:[0,0] op_sel_hi:[0,1]
    v_lshlrev_b32 v80, 16, v44
    v_and_b32 v81, 0xffff0000, v44
    v_lshlrev_b32 v82, 16, v45
    v_and_b32 v83, 0xffff0000, v45
    v_lshlrev_b32 v84, 16, v46
    v_and_b32 v85, 0xffff0000, v46
    v_lshlrev_b32 v86, 16, v47
    v_and_b32 v87, 0xffff0000, v47
    v_pk_fma_f32 v[88:89], v[30:31], v[80:81], v[88:89] op_sel:[1,0,0] op_sel_hi:[1,1,1]
    v_pk_fma_f32 v[90:91], v[30:31], v[82:83], v[90:91] op_sel:[1,0,0] op_sel_hi:[1,1,1]
    v_pk_fma_f32 v[92:93], v[30:31], v[84:85], v[92:93] op_sel:[1,0,0] op_sel_hi:[1,1,1]
    v_pk_fma_f32 v[94:95], v[30:31], v[86:87], v[94:95] op_sel:[1,0,0] op_sel_hi:[1,1,1]
    v_lshlrev_b32 v80, 16, v48
    v_and_b32 v81, 0xffff0000, v48
    v_lshlrev_b32 v82, 16, v49
    v_and_b32 v83, 0xffff0000, v49
    v_lshlrev_b32 v84, 16, v50
    v_and_b32 v85, 0xffff0000, v50
    v_lshlrev_b32 v86, 16, v51
    v_and_b32 v87, 0xffff0000, v51
    v_pk_fma_f32 v[88:89], v[32:33], v[80:81], v[88:89] op_sel:[0,0,0] op_sel_hi:[0,1,1]
    v_pk_fma_f32 v[90:91], v[32:33], v[82:83], v[90:91] op_sel:[0,0,0] op_sel_hi:[0,1,1]
    v_pk_fma_f32 v[92:93], v[32:33], v[84:85], v[92:93] op_sel:[0,0,0] op_sel_hi:[0,1,1]
    v_pk_fma_f32 v[94:95], v[32:33], v[86:87], v[94:95] op_sel:[0,0,0] op_sel_hi:[0,1,1]
    v_lshlrev_b32 v80, 16, v52
    v_and_b32 v81, 0xffff0000, v52
    v_lshlrev_b32 v82, 16, v53
    v_and_b32 v83, 0xffff0000, v53
    v_lshlrev_b32 v84, 16, v54
    v_and_b32 v85, 0xffff0000, v54
    v_lshlrev_b32 v86, 16, v55
    v_and_b32 v87, 0xffff0000, v55
    v_pk_fma_f32 v[88:89], v[32:33], v[80:81], v[88:89] op_sel:[1,0,0] op_sel_hi:[1,1,1]
    v_pk_fma_f32 v[90:91], v[32:33], v[82:83], v[90:91] op_sel:[1,0,0] op_sel_hi:[1,1,1]
    v_pk_fma_f32 v[92:93], v[32:33], v[84:85], v[92:93] op_sel:[1,0,0] op_sel_hi:[1,1,1]
    v_pk_fma_f32 v[94:95], v[32:33], v[86:87], v[94:95] op_sel:[1,0,0] op_sel_hi:[1,1,1]
    v_lshlrev_b32 v80, 16, v56
    v_and_b32 v81, 0xffff0000, v56
    v_lshlrev_b32 v82, 16, v57
    v_and_b32 v83, 0xffff0000, v57
    v_lshlrev_b32 v84, 16, v58
    v_and_b32 v85, 0xffff0000, v58
    v_lshlrev_b32 v86, 16, v59
    v_and_b32 v87, 0xffff0000, v59
    v_pk_fma_f32 v[88:89], v[34:35], v[80:81], v[88:89] op_sel:[0,0,0] op_sel_hi:[0,1,1]
    v_pk_fma_f32 v[90:91], v[34:35], v[82:83], v[90:91] op_sel:[0,0,0] op_sel_hi:[0,1,1]
    v_pk_fma_f32 v[92:93], v[34:35], v[84:85], v[92:93] op_sel:[0,0,0] op_sel_hi:[0,1,1]
    v_pk_fma_f32 v[94:95], v[34:35], v[86:87], v[94:95] op_sel:[0,0,0] op_sel_hi:[0,1,1]
    v_lshlrev_b32 v80, 16, v60
    v_and_b32 v81, 0xffff0000, v60
    v_lshlrev_b32 v82, 16, v61
    v_and_b32 v83, 0xffff0000, v61
    v_lshlrev_b32 v84, 16, v62
    v_and_b32 v85, 0xffff0000, v62
    v_lshlrev_b32 v86, 16, v63
    v_and_b32 v87, 0xffff0000, v63
    v_pk_fma_f32 v[88:89], v[34:35], v[80:81], v[88:89] op_sel:[1,0,0] op_sel_hi:[1,1,1]
    v_pk_fma_f32 v[90:91], v[34:35], v[82:83], v[90:91] op_sel:[1,0,0] op_sel_hi:[1,1,1]
    v_pk_fma_f32 v[92:93], v[34:35], v[84:85], v[92:93] op_sel:[1,0,0] op_sel_hi:[1,1,1]
    v_pk_fma_f32 v[94:95], v[34:35], v[86:87], v[94:95] op_sel:[1,0,0] op_sel_hi:[1,1,1]
    v_lshlrev_b32 v80, 16, v64
    v_and_b32 v81, 0xffff0000, v64
    v_lshlrev_b32 v82, 16, v65
    v_and_b32 v83, 0xffff0000, v65
    v_lshlrev_b32 v84, 16, v66
    v_and_b32 v85, 0xffff0000, v66
    v_lshlrev_b32 v86, 16, v67
    v_and_b32 v87, 0xffff0000, v67
    v_pk_fma_f32 v[88:89], v[36:37], v[80:81], v[88:89] op_sel:[0,0,0] op_sel_hi:[0,1,1]
    v_pk_fma_f32 v[90:91], v[36:37], v[82:83], v[90:91] op_sel:[0,0,0] op_sel_hi:[0,1,1]
    v_pk_fma_f32 v[92:93], v[36:37], v[84:85], v[92:93] op_sel:[0,0,0] op_sel_hi:[0,1,1]
    v_pk_fma_f32 v[94:95], v[36:37], v[86:87], v[94:95] op_sel:[0,0,0] op_sel_hi:[0,1,1]
    v_lshlrev_b32 v80, 16, v68
    v_and_b32 v81, 0xffff0000, v68
    v_lshlrev_b32 v82, 16, v69
    v_and_b32 v83, 0xffff0000, v69
    v_lshlrev_b32 v84, 16, v70
    v_and_b32 v85, 0xffff0000, v70
    v_lshlrev_b32 v86, 16, v71
    v_and_b32 v87, 0xffff0000, v71
    v_pk_fma_f32 v[88:89], v[36:37], v[80:81], v[88:89] op_sel:[1,0,0] op_sel_hi:[1,1,1]
    v_pk_fma_f32 v[90:91], v[36:37], v[82:83], v[90:91] op_sel:[1,0,0] op_sel_hi:[1,1,1]
    v_pk_fma_f32 v[92:93], v[36:37], v[84:85], v[92:93] op_sel:[1,0,0] op_sel_hi:[1,1,1]
    v_pk_fma_f32 v[94:95], v[36:37], v[86:87], v[94:95] op_sel:[1,0,0] op_sel_hi:[1,1,1]
    v_lshlrev_b32 v80, 16, v72
    v_and_b32 v81, 0xffff0000, v72
    v_lshlrev_b32 v82, 16, v73
    v_and_b32 v83, 0xffff0000, v73
    v_lshlrev_b32 v84, 16, v74
    v_and_b32 v85, 0xffff0000, v74
    v_lshlrev_b32 v86, 16, v75
    v_and_b32 v87, 0xffff0000, v75
    v_pk_fma_f32 v[88:89], v[38:39], v[80:81], v[88:89] op_sel:[0,0,0] op_sel_hi:[0,1,1]
    v_pk_fma_f32 v[90:91], v[38:39], v[82:83], v[90:91] op_sel:[0,0,0] op_sel_hi:[0,1,1]
    v_pk_fma_f32 v[92:93], v[38:39], v[84:85], v[92:93] op_sel:[0,0,0] op_sel_hi:[0,1,1]
    v_pk_fma_f32 v[94:95], v[38:39], v[86:87], v[94:95] op_sel:[0,0,0] op_sel_hi:[0,1,1]
    v_lshlrev_b32 v80, 16, v76
    v_and_b32 v81, 0xffff0000, v76
    v_lshlrev_b32 v82, 16, v77
    v_and_b32 v83, 0xffff0000, v77
    v_lshlrev_b32 v84, 16, v78
    v_and_b32 v85, 0xffff0000, v78
    v_lshlrev_b32 v86, 16, v79
    v_and_b32 v87, 0xffff0000, v79
    v_pk_fma_f32 v[88:89], v[38:39], v[80:81], v[88:89] op_sel:[1,0,0] op_sel_hi:[1,1,1]
    v_pk_fma_f32 v[90:91], v[38:39], v[82:83], v[90:91] op_sel:[1,0,0] op_sel_hi:[1,1,1]
    v_pk_fma_f32 v[92:93], v[38:39], v[84:85], v[92:93] op_sel:[1,0,0] op_sel_hi:[1,1,1]
    v_pk_fma_f32 v[94:95], v[38:39], v[86:87], v[94:95] op_sel:[1,0,0] op_sel_hi:[1,1,1]
    s_nop 0
    v_permlane32_swap_b32 v88, v92
    v_permlane32_swap_b32 v89, v93
    v_permlane32_swap_b32 v90, v94
    v_permlane32_swap_b32 v91, v95
    v_add_f32 v88, v88, v92
    v_add_f32 v89, v89, v93
    v_add_f32 v90, v90, v94
    v_add_f32 v91, v91, v95
    s_nop 0
    v_permlane16_swap_b32 v88, v90
    v_permlane16_swap_b32 v89, v91
    v_add_f32 v88, v88, v90
    v_add_f32 v89, v89, v91
    v_and_b32 v81, 7, v1
    v_lshrrev_b32 v82, 3, v1
    v_add_f32_dpp v80, v88, v88 row_ror:8 row_mask:0xf bank_mask:0x3
    s_nop 1
    v_add_f32_dpp v80, v89, v89 row_ror:8 row_mask:0xf bank_mask:0xc
    v_lshl_add_u32 v81, v81, 3, v82
    s_lshl_b32 s7, s3, 8
    s_add_u32 s7, s7, 124928
    v_lshl_add_u32 v81, v81, 2, s7
    ds_write_b32 v81, v80
    s_waitcnt lgkmcnt(0)
    s_barrier
    v_lshlrev_b32 v81, 2, v1
    v_add_u32 v82, 124928, v81
    ds_read_b32 v88, v82 offset:0
    ds_read_b32 v89, v82 offset:256
    ds_read_b32 v90, v82 offset:512
    ds_read_b32 v91, v82 offset:768
    v_add_u32 v81, s44, v81
    s_waitcnt lgkmcnt(2)
    v_add_f32 v88, v88, v89
    s_waitcnt lgkmcnt(0)
    v_add_f32 v90, v90, v91
    v_add_f32 v88, v88, v90
    v_min_u32 v88, -2, v88
    s_cmp_lg_u32 s3, 0
    s_cbranch_scc1 Lmod_skip_s3
    global_store_dword v81, v88, s[38:39] offset:0 sc1
Lmod_skip_s3:
Lsp_c:
    s_mov_b32 s51, 102400
Lsp_d:
    s_mov_b32 s93, s51
    s_waitcnt lgkmcnt(0)
    s_barrier
    s_lshr_b32 s5, s3, 1
    s_lshl_b32 s5, s5, 5
    s_and_b32 s6, s3, 1
    s_lshl_b32 s6, s6, 2
    s_add_u32 s6, s6, s5
    s_lshl_b32 s5, s40, 6
    s_add_u32 s90, s6, s5
    v_add_lshl_u32 v27, v5, s90, 1
    global_load_ushort v27, v27, s[26:27]
    s_and_b32 s4, s41, 3
    s_cmp_eq_u32 s4, 0
    s_cselect_b32 s5, 8, 0
    s_cmp_le_u32 s4, 1
    s_cselect_b32 s6, 16, 8
    s_cmp_eq_u32 s4, 3
    s_cselect_b32 s50, 16, 24
    s_lshl_b32 s44, s4, 3
    s_bitcmp1_b32 s43, 0
    s_cselect_b32 s46, s6, s5
    s_cselect_b32 s48, s5, s6
    s_lshl_b32 s5, s3, 1
    s_add_u32 s44, s44, s5
    s_add_u32 s45, s44, 1
    s_add_u32 s46, s46, s5
    s_add_u32 s47, s46, 1
    s_add_u32 s48, s48, s5
    s_add_u32 s49, s48, 1
    s_add_u32 s50, s50, s5
    s_add_u32 s51, s50, 1
    s_lshl_b32 s5, s40, 18
    s_lshl_b32 s6, s44, 7
    s_add_u32 s6, s6, s5
    s_add_u32 s68, s24, s6
    s_addc_u32 s69, s25, 0
    s_lshl_b32 s6, s45, 7
    s_add_u32 s6, s6, s5
    s_add_u32 s70, s24, s6
    s_addc_u32 s71, s25, 0
    s_lshl_b32 s6, s46, 7
    s_add_u32 s6, s6, s5
    s_add_u32 s72, s24, s6
    s_addc_u32 s73, s25, 0
    s_lshl_b32 s6, s47, 7
    s_add_u32 s6, s6, s5
    s_add_u32 s74, s24, s6
    s_addc_u32 s75, s25, 0
    s_lshl_b32 s6, s48, 7
    s_add_u32 s6, s6, s5
    s_add_u32 s76, s24, s6
    s_addc_u32 s77, s25, 0
    s_lshl_b32 s6, s49, 7
    s_add_u32 s6, s6, s5
    s_add_u32 s78, s24, s6
    s_addc_u32 s79, s25, 0
    s_lshl_b32 s6, s50, 7
    s_add_u32 s6, s6, s5
    s_add_u32 s80, s24, s6
    s_addc_u32 s81, s25, 0
    s_lshl_b32 s6, s51, 7
    s_add_u32 s6, s6, s5
    s_add_u32 s82, s24, s6
    s_addc_u32 s83, s25, 0
    s_lshl_b32 s89, s3, 14
    s_add_u32 s89, s89, 83200
    s_and_b32 s4, s41, 1
    s_lshl_b32 s5, s3, 1
    s_add_u32 s5, s5, s4
    s_cmp_eq_u32 s5, 7
    s_cselect_b32 s5, 0, s5
    s_mul_i32 s96, s41, 7
    s_add_u32 s96, s96, s5
    s_cmp_lt_u32 s96, 54
    s_cselect_b32 s101, 2, 0
    s_min_u32 s96, s96, 53
    s_cmp_eq_u32 s3, 3
    s_cselect_b32 s101, 1, s101
    s_lshr_b32 s97, s101, 1
    s_cselect_b32 s5, -1, 0
    v_and_b32 v7, s5, v4
    s_add_u32 s97, s97, s96
    s_mul_i32 s4, s96, 20480
    s_add_u32 s5, s4, 7344128
    s_add_u32 s8, s38, s5
    s_addc_u32 s9, s39, 0
    s_add_u32 s5, s4, 7352320
    s_add_u32 s10, s38, s5
    s_addc_u32 s11, s39, 0
    s_add_u32 s5, s4, 7360512
    s_add_u32 s12, s38, s5
    s_addc_u32 s13, s39, 0
    s_mul_i32 s4, s97, 20480
    s_add_u32 s5, s4, 7344128
    s_add_u32 s14, s38, s5
    s_addc_u32 s15, s39, 0
    s_add_u32 s5, s4, 7352320
    s_add_u32 s16, s38, s5
    s_addc_u32 s17, s39, 0
    s_add_u32 s5, s4, 7360512
    s_add_u32 s18, s38, s5
    s_addc_u32 s19, s39, 0
    v_bfe_u32 v106, v1, 3, 1
    s_sub_u32 s4, s97, s96
    v_mul_u32_u24 v106, s4, v106
    v_add_lshl_u32 v106, v106, s96, 7
    v_mul_u32_u24 v101, 7168, v3
    v_add_u32 v106, v106, v101
    v_and_b32 v101, 112, v4
    v_add_u32 v106, v106, v101
    v_add_u32 v106, 49152, v106
    v_and_b32 v100, 1, v3
    v_mul_u32_u24 v100, 7168, v100
    v_sub_u32 v100, v106, v100
    s_branch Lsp_f
Lsp:
    s_sleep 16
Lsp_f:
    global_load_dword v112, v100, s[38:39] sc1
    s_waitcnt vmcnt(0)
    v_cmp_eq_u32 vcc, -1, v112
    s_add_u32 s100, s100, 1
    s_cmp_ge_u32 s100, 262144
    s_cbranch_scc1 Lsp_x
    s_cbranch_vccnz Lsp
Lsp_x:
    s_barrier
    s_cmp_eq_u32 s93, 102400
    s_cbranch_scc1 Lsd_none
    v_mov_b32 v103, s93
    s_cmp_lg_u32 s3, 0
    s_cbranch_scc1 Lsd_skip
    global_store_dword v103, v103, s[38:39] sc1
Lsd_skip:
Lsd_none:
    global_load_dwordx4 a[248:251], v4, s[12:13] offset:-1024 sc1
    v_and_b32 v67, 7, v1
    v_lshl_add_u32 v67, v3, 3, v67
    v_bfe_u32 v69, v1, 3, 1
    global_load_dwordx4 a[252:255], v7, s[18:19] offset:-1024 sc1
    v_lshlrev_b32 v66, 9, v69
    v_lshl_add_u32 v66, v67, 4, v66
    s_mul_i32 s4, s3, 20480
    s_mul_i32 s5, s40, 114688
    global_load_dwordx4 a[240:243], v4, s[12:13] offset:-2048 sc1
    s_add_u32 s4, s4, s5
    s_add_u32 s4, s4, 1048576
    v_add_u32 v66, s4, v66
    v_lshl_add_u32 v70, v67, 1, v69
    global_load_dwordx4 a[244:247], v7, s[18:19] offset:-2048 sc1
    v_min_u32 v72, 9, v1
    v_lshl_add_u32 v72, v72, 11, s4
    v_lshrrev_b32 v67, 5, v1
    v_bfe_u32 v68, v1, 1, 1
    global_load_dwordx4 a[232:235], v4, s[12:13] offset:-3072 sc1
    v_lshl_add_u32 v67, v67, 1, v68
    v_mul_u32_u24 v68, 1040, v67
    v_bfe_u32 v67, v1, 3, 1
    v_lshl_add_u32 v68, v67, 3, v68
    global_load_dwordx4 a[236:239], v7, s[18:19] offset:-3072 sc1
    v_bfe_u32 v67, v1, 2, 1
    v_lshl_add_u32 v68, v67, 6, v68
    v_bfe_u32 v67, v1, 4, 1
    v_lshl_add_u32 v68, v67, 7, v68
    global_load_dwordx4 a[224:227], v4, s[12:13] offset:-4096 sc1
    v_bfe_u32 v67, v1, 0, 1
    v_lshl_add_u32 v68, v67, 5, v68
    s_mul_i32 s5, s3, 20800
    v_add_u32 v68, s5, v68
    global_load_dwordx4 a[228:231], v7, s[18:19] offset:-4096 sc1
    v_lshlrev_b32 v30, 3, v1
    s_lshl_b32 s88, s3, 9
    v_lshrrev_b32 v67, 3, v1
    v_lshlrev_b32 v67, 12, v67
    global_load_dwordx4 a[216:219], v4, s[10:11] offset:3072 sc1
    v_bfe_u32 v69, v1, 4, 1
    v_xor_b32 v69, v69, v1
    v_and_b32 v69, 7, v69
    global_load_dwordx4 a[220:223], v7, s[16:17] offset:3072 sc1
    v_xor_b32 v74, 0, v69
    v_lshl_add_u32 v74, v74, 4, v67
    v_add_u32 v78, 131072, v74
    v_xor_b32 v75, 2, v69
    global_load_dwordx4 a[208:211], v4, s[10:11] offset:2048 sc1
    v_lshl_add_u32 v75, v75, 4, v67
    v_add_u32 v75, 31744, v75
    v_add_u32 v79, 131072, v75
    v_xor_b32 v76, 4, v69
    global_load_dwordx4 a[212:215], v7, s[16:17] offset:2048 sc1
    v_lshl_add_u32 v76, v76, 4, v67
    v_add_u32 v76, 63488, v76
    v_add_u32 v80, 131072, v76
    v_xor_b32 v77, 6, v69
    global_load_dwordx4 a[200:203], v4, s[10:11] offset:1024 sc1
    v_lshl_add_u32 v77, v77, 4, v67
    v_add_u32 v77, 95232, v77
    v_add_u32 v81, 131072, v77
    v_lshrrev_b32 v69, 1, v2
    global_load_dwordx4 a[204:207], v7, s[16:17] offset:1024 sc1
    v_xor_b32 v69, v69, v3
    v_lshlrev_b32 v69, 4, v69
    v_lshl_add_u32 v69, v5, 7, v69
    s_xor_b32 s4, s3, 0
    global_load_dwordx4 a[192:195], v4, s[10:11] offset:0 sc1
    s_lshr_b32 s5, s4, 1
    s_lshl_b32 s5, s5, 12
    s_and_b32 s4, s4, 1
    s_lshl_b32 s4, s4, 9
    global_load_dwordx4 a[196:199], v7, s[16:17] offset:0 sc1
    s_add_u32 s4, s4, s5
    s_add_u32 s4, s4, s89
    v_add_u32 v82, s4, v69
    v_xor_b32 v83, 64, v82
    global_load_dwordx4 a[184:187], v4, s[10:11] offset:-1024 sc1
    s_xor_b32 s4, s3, 1
    s_lshr_b32 s5, s4, 1
    s_lshl_b32 s5, s5, 12
    global_load_dwordx4 a[188:191], v7, s[16:17] offset:-1024 sc1
    s_and_b32 s4, s4, 1
    s_lshl_b32 s4, s4, 9
    s_add_u32 s4, s4, s5
    s_add_u32 s4, s4, s89
    global_load_dwordx4 a[176:179], v4, s[10:11] offset:-2048 sc1
    v_add_u32 v84, s4, v69
    v_xor_b32 v85, 64, v84
    s_xor_b32 s4, s3, 2
    s_lshr_b32 s5, s4, 1
    global_load_dwordx4 a[180:183], v7, s[16:17] offset:-2048 sc1
    s_lshl_b32 s5, s5, 12
    s_and_b32 s4, s4, 1
    s_lshl_b32 s4, s4, 9
    s_add_u32 s4, s4, s5
    global_load_dwordx4 a[168:171], v4, s[10:11] offset:-3072 sc1
    s_add_u32 s4, s4, s89
    v_add_u32 v86, s4, v69
    v_xor_b32 v87, 64, v86
    s_xor_b32 s4, s3, 3
    global_load_dwordx4 a[172:175], v7, s[16:17] offset:-3072 sc1
    s_lshr_b32 s5, s4, 1
    s_lshl_b32 s5, s5, 12
    s_and_b32 s4, s4, 1
    s_lshl_b32 s4, s4, 9
    global_load_dwordx4 a[160:163], v4, s[10:11] offset:-4096 sc1
    s_add_u32 s4, s4, s5
    s_add_u32 s4, s4, s89
    v_add_u32 v88, s4, v69
    v_xor_b32 v89, 64, v88
    global_load_dwordx4 a[164:167], v7, s[16:17] offset:-4096 sc1
    s_add_u32 s52, s8, 1146880
    s_addc_u32 s53, s9, 0
    s_add_u32 s54, s10, 1146880
    s_addc_u32 s55, s11, 0
    global_load_dwordx4 a[152:155], v4, s[8:9] offset:3072 sc1
    s_add_u32 s56, s12, 1146880
    s_addc_u32 s57, s13, 0
    s_add_u32 s58, s14, 1146880
    global_load_dwordx4 a[156:159], v7, s[14:15] offset:3072 sc1
    s_addc_u32 s59, s15, 0
    s_add_u32 s60, s16, 1146880
    s_addc_u32 s61, s17, 0
    s_add_u32 s62, s18, 1146880
    global_load_dwordx4 a[144:147], v4, s[8:9] offset:2048 sc1
    s_addc_u32 s63, s19, 0
    s_mov_b32 s84, 0xc0135761
    s_mov_b32 s85, 0xbdd2d3e8
    v_lshlrev_b32 v32, 16, v27
    global_load_dwordx4 a[148:151], v7, s[14:15] offset:2048 sc1
    v_lshlrev_b32 v33, 16, v27
    v_lshlrev_b32 v34, 16, v27
    v_lshlrev_b32 v35, 16, v27
    s_mul_i32 s5, s41, 10
    global_load_dwordx4 a[136:139], v4, s[8:9] offset:1024 sc1
    s_mul_i32 s6, s3, 1040
    v_add_u32 v67, s5, v3
    v_lshrrev_b32 v69, 2, v67
    v_mul_u32_u24 v69, 3136, v69
    global_load_dwordx4 a[140:143], v7, s[14:15] offset:1024 sc1
    v_lshl_add_u32 v69, v67, 8, v69
    v_lshl_add_u32 v69, v2, 4, v69
    v_add_u32 v46, s6, v69
    v_lshrrev_b32 v67, 1, v3
    global_load_dwordx4 a[128:131], v4, s[8:9] offset:0 sc1
    v_add_u32 v67, s5, v67
    v_lshrrev_b32 v69, 2, v67
    v_mul_u32_u24 v69, 3136, v69
    v_lshl_add_u32 v69, v67, 8, v69
    global_load_dwordx4 a[132:135], v7, s[14:15] offset:0 sc1
    v_lshl_add_u32 v69, v2, 4, v69
    v_add_u32 v47, s6, v69
    v_and_b32 v67, 1, v3
    v_lshl_add_u32 v47, v67, 3, v47
    s_add_u32 m0, s89, 0
    s_nop 0
    global_load_lds_dwordx4 v74, s[68:69] offset:0
    global_load_lds_dwordx4 v75, s[68:69] offset:1024
    global_load_lds_dwordx4 v76, s[68:69] offset:2048
    global_load_lds_dwordx4 v77, s[68:69] offset:3072
    s_add_u32 m0, s89, 4096
    s_nop 0
    global_load_lds_dwordx4 v78, s[68:69] offset:0
    global_load_lds_dwordx4 v79, s[68:69] offset:1024
    global_load_lds_dwordx4 v80, s[68:69] offset:2048
    global_load_lds_dwordx4 v81, s[68:69] offset:3072
    s_lshl_b32 s4, s40, 9
    s_add_u32 s4, s4, 32772
    v_lshl_add_u32 v102, v1, 3, s4
    s_branch Lsu_f
Lsu:
    s_sleep 16
Lsu_f:
    global_load_dwordx4 v[112:115], v106, s[38:39] sc1
    global_load_dword v116, v102, s[38:39] sc1
    s_waitcnt vmcnt(0)
    v_max3_u32 v101, v112, v113, v114
    v_max3_u32 v101, v115, v116, v101
    v_cmp_eq_u32 vcc, -1, v101
    s_add_u32 s100, s100, 1
    s_cmp_ge_u32 s100, 262144
    s_cbranch_scc1 Lsu_x
    s_cbranch_vccnz Lsu
Lsu_x:
    v_permlane32_swap_b32 v112, v114
    v_permlane32_swap_b32 v113, v115
    s_lshl_b32 s4, s3, 9
    s_add_u32 s4, s4, 156672
    v_and_b32 v106, 496, v4
    v_add_f32 v112, v112, v114
    v_add_f32 v113, v113, v115
    v_bfe_u32 v114, v1, 3, 1
    v_cmp_gt_u32 vcc, s101, v114
    v_lshrrev_b32 v114, 5, v1
    v_lshl_add_u32 v106, v114, 3, v106
    v_cndmask_b32 v112, 0, v112, vcc
    v_cndmask_b32 v113, 0, v113, vcc
    v_add_u32 v106, s4, v106
    ds_write_b64 v106, v[112:113]
    s_barrier
    s_branch Ljoin
Lic_r:
    s_branch Lic_p_f
Lic_p:
    s_sleep 4
Lic_p_f:
    global_load_dword v221, v220, s[36:37] sc1
    s_waitcnt vmcnt(0)
    v_cmp_eq_u32 vcc, 0, v221
    s_add_u32 s100, s100, 1
    s_cmp_ge_u32 s100, 262144
    s_cbranch_scc1 Lic_p_x
    s_cbranch_vccnz Lic_p
Lic_p_x:
    s_branch Lic_ok
Lic2_r:
    s_branch Lic2_p_f
Lic2_p:
    s_sleep 4
Lic2_p_f:
    global_load_dword v100, v99, s[36:37] sc1
    s_waitcnt vmcnt(0)
    v_cmp_eq_u32 vcc, 0, v100
    s_add_u32 s100, s100, 1
    s_cmp_ge_u32 s100, 262144
    s_cbranch_scc1 Lic2_p_x
    s_cbranch_vccnz Lic2_p
Lic2_p_x:
    s_branch Lic2_ok
Lkf_r:
    s_nop 7
Lkf_p:
    global_load_dword v45, v44, s[38:39] sc1
    s_waitcnt vmcnt(0)
    v_cmp_eq_u32 vcc, -1, v45
    s_add_u32 s100, s100, 1
    s_cmp_ge_u32 s100, 262144
    s_cbranch_scc1 Lkf_p_x
    s_cbranch_vccnz Lkf_p
Lkf_p_x:
    s_nop 1
    s_branch Lkf_ok
Lcu_r:
    s_nop 7
Lcu_p:
    global_load_dword v234, v45, s[38:39] sc1
    s_waitcnt vmcnt(0)
    v_cmp_eq_u32 vcc, -1, v234
    s_add_u32 s100, s100, 1
    s_cmp_ge_u32 s100, 262144
    s_cbranch_scc1 Lcu_p_x
    s_cbranch_vccnz Lcu_p
Lcu_p_x:
    s_nop 1
    s_branch Lcu_ok
Lax_r:
    s_nop 7
Lax_p:
    v_lshlrev_b32 v28, 4, v0
    v_add_u32 v28, 36864, v28
    global_load_dwordx4 v[214:217], v28, s[38:39] offset:-4096 sc1
    global_load_dwordx4 v[218:221], v28, s[38:39] offset:0 sc1
    v_add_u32 v28, 8192, v28
    global_load_dwordx4 v[222:225], v28, s[38:39] offset:-4096 sc1
    global_load_dwordx4 v[226:229], v28, s[38:39] offset:0 sc1
    v_min_u32 v28, 11, v1
    v_lshrrev_b32 v29, 2, v28
    v_mul_u32_u24 v29, 2544, v29
    v_lshl_add_u32 v28, v28, 2, v29
    s_lshl_b32 s4, s42, 4
    s_add_u32 s4, s4, 0
    v_add_u32 v28, s4, v28
    global_load_dword v64, v28, s[38:39] sc1
    v_add_u32 v28, 15360, v28
    global_load_dword v65, v28, s[38:39] sc1
    s_waitcnt vmcnt(0)
    v_max_u32 v236, v215, v217
    v_max3_u32 v236, v219, v221, v236
    v_max3_u32 v236, v223, v225, v236
    v_max3_u32 v236, v227, v229, v236
    v_max3_u32 v236, v64, v65, v236
    v_cmp_eq_u32 vcc, -1, v236
    s_add_u32 s100, s100, 1
    s_cmp_ge_u32 s100, 262144
    s_cbranch_scc1 Lax_p_x
    s_cbranch_vccnz Lax_p
Lax_p_x:
    s_nop 1
    s_branch Lax_ok
Lcv_r:
    s_nop 7
Lcv_p:
    global_load_dwordx4 v[230:233], v235, s[38:39] sc1
    s_waitcnt vmcnt(0)
    v_max_u32 v236, v230, v231
    v_max3_u32 v236, v232, v233, v236
    v_cmp_eq_u32 vcc, -1, v236
    s_add_u32 s100, s100, 1
    s_cmp_ge_u32 s100, 262144
    s_cbranch_scc1 Lcv_p_x
    s_cbranch_vccnz Lcv_p
Lcv_p_x:
    s_nop 1
    s_branch Lcv_ok
Lgb_r:
    s_nop 7
Lgb_p:
    v_min_u32 v175, 26, v1
    v_lshlrev_b32 v175, 7, v175
    v_add_u32 v175, 98304, v175
    global_load_dword v250, v175, s[38:39] sc1
    s_mul_i32 s7, s41, 320
    s_add_u32 s7, s7, 12800
    v_min_u32 v175, 304, v4
    v_add_u32 v175, s7, v175
    global_load_dwordx4 v[242:245], v175, s[38:39] sc1
    v_add_u32 v175, 15360, v175
    global_load_dwordx4 v[246:249], v175, s[38:39] sc1
    s_waitcnt vmcnt(0)
    v_max3_u32 v28, v242, v243, v244
    v_max3_u32 v28, v245, v246, v28
    v_max3_u32 v28, v247, v248, v28
    v_max3_u32 v28, v249, v250, v28
    v_cmp_eq_u32 vcc, -1, v28
    s_add_u32 s100, s100, 1
    s_cmp_ge_u32 s100, 262144
    s_cbranch_scc1 Lgb_p_x
    s_cbranch_vccnz Lgb_p
Lgb_p_x:
    s_nop 1
    s_branch Lgb_ok
Ls3_r:
    s_nop 7
Ls3_p:
    global_load_dwordx2 v[130:131], v174, s[38:39] offset:0 sc1
    global_load_dwordx2 v[132:133], v174, s[38:39] offset:512 sc1
    global_load_dwordx2 v[134:135], v174, s[38:39] offset:1024 sc1
    global_load_dwordx2 v[136:137], v174, s[38:39] offset:1536 sc1
    global_load_dwordx2 v[138:139], v174, s[38:39] offset:2048 sc1
    global_load_dwordx2 v[140:141], v174, s[38:39] offset:2560 sc1
    global_load_dwordx2 v[142:143], v174, s[38:39] offset:3072 sc1
    global_load_dwordx2 v[144:145], v174, s[38:39] offset:3584 sc1
    s_waitcnt vmcnt(0)
    v_max_u32 v28, v131, v133
    v_max3_u32 v28, v135, v137, v28
    v_max3_u32 v28, v139, v141, v28
    v_max3_u32 v28, v143, v145, v28
    v_cmp_eq_u32 vcc, -1, v28
    s_add_u32 s100, s100, 1
    s_cmp_ge_u32 s100, 262144
    s_cbranch_scc1 Ls3_p_x
    s_cbranch_vccnz Ls3_p
Ls3_p_x:
    s_nop 1
    s_branch Ls3_ok
Lz0_r:
    s_nop 7
Lz0_p:
    global_load_dwordx4 v[62:65], v30, s[56:57] offset:-3072 sc1
    global_load_dwordx4 v[66:69], v30, s[56:57] offset:-2048 sc1
    global_load_dwordx4 v[70:73], v30, s[56:57] offset:-1024 sc1
    global_load_dwordx4 v[74:77], v30, s[56:57] offset:0 sc1
    global_load_dwordx4 v[78:81], v30, s[56:57] offset:1024 sc1
    global_load_dwordx4 v[82:85], v30, s[56:57] offset:2048 sc1
    global_load_dwordx4 v[86:89], v30, s[56:57] offset:3072 sc1
    global_load_dwordx4 v[90:93], v31, s[56:57] offset:-3072 sc1
    global_load_dwordx4 v[94:97], v31, s[56:57] offset:-2048 sc1
    global_load_dwordx4 v[98:101], v31, s[56:57] offset:-1024 sc1
    global_load_dwordx4 v[102:105], v31, s[56:57] offset:0 sc1
    global_load_dwordx4 v[106:109], v31, s[56:57] offset:1024 sc1
    global_load_dwordx4 v[110:113], v31, s[56:57] offset:2048 sc1
    global_load_dwordx4 v[114:117], v31, s[56:57] offset:3072 sc1
    global_load_dwordx4 v[118:121], v30, s[58:59] offset:-3072 sc1
    global_load_dwordx4 v[122:125], v30, s[58:59] offset:-2048 sc1
    s_waitcnt vmcnt(0)
    v_and_b32 v28, v65, v69
    v_bitop3_b32 v28, v73, v77, v28 bitop3:0x80
    v_and_b32 v28, 1, v28
    v_cmp_ne_u32 vcc, 1, v28
    s_add_u32 s100, s100, 1
    s_cmp_ge_u32 s100, 262144
    s_cbranch_scc1 Lz0_p_x
    s_cbranch_vccnz Lz0_p
Lz0_p_x:
    s_nop 1
    s_branch Lz0_ok
Lz1_r:
    s_nop 7
Lz1_p:
    global_load_dwordx4 v[78:81], v30, s[56:57] offset:1024 sc1
    global_load_dwordx4 v[82:85], v30, s[56:57] offset:2048 sc1
    global_load_dwordx4 v[86:89], v30, s[56:57] offset:3072 sc1
    global_load_dwordx4 v[90:93], v31, s[56:57] offset:-3072 sc1
    s_waitcnt vmcnt(0)
    v_and_b32 v28, v81, v85
    v_bitop3_b32 v28, v89, v93, v28 bitop3:0x80
    v_and_b32 v28, 1, v28
    v_cmp_ne_u32 vcc, 1, v28
    s_add_u32 s100, s100, 1
    s_cmp_ge_u32 s100, 262144
    s_cbranch_scc1 Lz1_p_x
    s_cbranch_vccnz Lz1_p
Lz1_p_x:
    s_nop 1
    s_branch Lz1_ok
Lz2_r:
    s_nop 7
Lz2_p:
    global_load_dwordx4 v[94:97], v31, s[56:57] offset:-2048 sc1
    global_load_dwordx4 v[98:101], v31, s[56:57] offset:-1024 sc1
    global_load_dwordx4 v[102:105], v31, s[56:57] offset:0 sc1
    global_load_dwordx4 v[106:109], v31, s[56:57] offset:1024 sc1
    s_waitcnt vmcnt(0)
    v_and_b32 v28, v97, v101
    v_bitop3_b32 v28, v105, v109, v28 bitop3:0x80
    v_and_b32 v28, 1, v28
    v_cmp_ne_u32 vcc, 1, v28
    s_add_u32 s100, s100, 1
    s_cmp_ge_u32 s100, 262144
    s_cbranch_scc1 Lz2_p_x
    s_cbranch_vccnz Lz2_p
Lz2_p_x:
    s_nop 1
    s_branch Lz2_ok
Lz3_r:
    s_nop 7
Lz3_p:
    global_load_dwordx4 v[110:113], v31, s[56:57] offset:2048 sc1
    global_load_dwordx4 v[114:117], v31, s[56:57] offset:3072 sc1
    global_load_dwordx4 v[118:121], v30, s[58:59] offset:-3072 sc1
    global_load_dwordx4 v[122:125], v30, s[58:59] offset:-2048 sc1
    s_waitcnt vmcnt(0)
    v_and_b32 v28, v113, v117
    v_bitop3_b32 v28, v121, v125, v28 bitop3:0x80
    v_and_b32 v28, 1, v28
    v_cmp_ne_u32 vcc, 1, v28
    s_add_u32 s100, s100, 1
    s_cmp_ge_u32 s100, 262144
    s_cbranch_scc1 Lz3_p_x
    s_cbranch_vccnz Lz3_p
Lz3_p_x:
    s_nop 1
    s_branch Lz3_ok
Lz4_r:
    s_nop 7
Lz4_p:
    global_load_dwordx4 v[126:129], v30, s[58:59] offset:-1024 sc1
    global_load_dwordx4 v[130:133], v30, s[58:59] offset:0 sc1
    global_load_dwordx4 v[134:137], v30, s[58:59] offset:1024 sc1
    global_load_dwordx4 v[138:141], v30, s[58:59] offset:2048 sc1
    s_waitcnt vmcnt(0)
    v_and_b32 v28, v129, v133
    v_bitop3_b32 v28, v137, v141, v28 bitop3:0x80
    v_and_b32 v28, 1, v28
    v_cmp_ne_u32 vcc, 1, v28
    s_add_u32 s100, s100, 1
    s_cmp_ge_u32 s100, 262144
    s_cbranch_scc1 Lz4_p_x
    s_cbranch_vccnz Lz4_p
Lz4_p_x:
    s_nop 1
    s_branch Lz4_ok
Lz5_r:
    s_nop 7
Lz5_p:
    global_load_dwordx4 v[62:65], v30, s[58:59] offset:3072 sc1
    global_load_dwordx4 v[66:69], v31, s[58:59] offset:-3072 sc1
    global_load_dwordx4 v[70:73], v31, s[58:59] offset:-2048 sc1
    global_load_dwordx4 v[74:77], v31, s[58:59] offset:-1024 sc1
    s_waitcnt vmcnt(0)
    v_and_b32 v28, v65, v69
    v_bitop3_b32 v28, v73, v77, v28 bitop3:0x80
    v_and_b32 v28, 1, v28
    v_cmp_ne_u32 vcc, 1, v28
    s_add_u32 s100, s100, 1
    s_cmp_ge_u32 s100, 262144
    s_cbranch_scc1 Lz5_p_x
    s_cbranch_vccnz Lz5_p
Lz5_p_x:
    s_nop 1
    s_branch Lz5_ok
Lz6_r:
    s_nop 7
Lz6_p:
    global_load_dwordx4 v[78:81], v31, s[58:59] offset:0 sc1
    global_load_dwordx4 v[82:85], v31, s[58:59] offset:1024 sc1
    global_load_dwordx4 v[86:89], v31, s[58:59] offset:2048 sc1
    global_load_dwordx4 v[90:93], v31, s[58:59] offset:3072 sc1
    s_waitcnt vmcnt(0)
    v_and_b32 v28, v81, v85
    v_bitop3_b32 v28, v89, v93, v28 bitop3:0x80
    v_and_b32 v28, 1, v28
    v_cmp_ne_u32 vcc, 1, v28
    s_add_u32 s100, s100, 1
    s_cmp_ge_u32 s100, 262144
    s_cbranch_scc1 Lz6_p_x
    s_cbranch_vccnz Lz6_p
Lz6_p_x:
    s_nop 1
    s_branch Lz6_ok
Lz7_r:
    s_nop 7
Lz7_p:
    global_load_dwordx4 v[94:97], v30, s[60:61] offset:-3072 sc1
    global_load_dwordx4 v[98:101], v31, s[60:61] offset:-3072 sc1
    global_load_dwordx4 v[102:105], v30, s[62:63] offset:-3072 sc1
    global_load_dwordx4 v[106:109], v31, s[62:63] offset:-3072 sc1
    s_waitcnt vmcnt(0)
    v_and_b32 v28, v97, v101
    v_bitop3_b32 v28, v105, v109, v28 bitop3:0x80
    v_and_b32 v28, 1, v28
    v_cmp_ne_u32 vcc, 1, v28
    s_add_u32 s100, s100, 1
    s_cmp_ge_u32 s100, 262144
    s_cbranch_scc1 Lz7_p_x
    s_cbranch_vccnz Lz7_p
Lz7_p_x:
    s_nop 1
    s_branch Lz7_ok
Lz8_r:
    s_nop 7
Lz8_p:
    global_load_dwordx4 v[110:113], v30, s[52:53] offset:-3072 sc1
    global_load_dwordx4 v[114:117], v31, s[52:53] offset:-3072 sc1
    global_load_dwordx4 v[118:121], v30, s[54:55] offset:-3072 sc1
    global_load_dwordx4 v[122:125], v31, s[54:55] offset:-3072 sc1
    s_waitcnt vmcnt(0)
    v_and_b32 v28, v113, v117
    v_bitop3_b32 v28, v121, v125, v28 bitop3:0x80
    v_and_b32 v28, 1, v28
    v_cmp_ne_u32 vcc, 1, v28
    s_add_u32 s100, s100, 1
    s_cmp_ge_u32 s100, 262144
    s_cbranch_scc1 Lz8_p_x
    s_cbranch_vccnz Lz8_p
Lz8_p_x:
    s_nop 1
    s_branch Lz8_ok
Lz9_r:
    s_nop 7
Lz9_p:
    global_load_dwordx4 v[126:129], v30, s[64:65] offset:-3072 sc1
    global_load_dwordx4 v[130:133], v31, s[64:65] offset:-3072 sc1
    global_load_dwordx4 v[134:137], v30, s[66:67] offset:-3072 sc1
    global_load_dwordx4 v[138:141], v31, s[66:67] offset:-3072 sc1
    s_waitcnt vmcnt(0)
    v_and_b32 v28, v129, v133
    v_bitop3_b32 v28, v137, v141, v28 bitop3:0x80
    v_and_b32 v28, 1, v28
    v_cmp_ne_u32 vcc, 1, v28
    s_add_u32 s100, s100, 1
    s_cmp_ge_u32 s100, 262144
    s_cbranch_scc1 Lz9_p_x
    s_cbranch_vccnz Lz9_p
Lz9_p_x:
    s_nop 1
    s_branch Lz9_ok
Lz10_r:
    s_nop 7
Lz10_p:
    global_load_dwordx4 v[62:65], v30, s[60:61] offset:-2048 sc1
    global_load_dwordx4 v[66:69], v31, s[60:61] offset:-2048 sc1
    global_load_dwordx4 v[70:73], v30, s[62:63] offset:-2048 sc1
    global_load_dwordx4 v[74:77], v31, s[62:63] offset:-2048 sc1
    s_waitcnt vmcnt(0)
    v_and_b32 v28, v65, v69
    v_bitop3_b32 v28, v73, v77, v28 bitop3:0x80
    v_and_b32 v28, 1, v28
    v_cmp_ne_u32 vcc, 1, v28
    s_add_u32 s100, s100, 1
    s_cmp_ge_u32 s100, 262144
    s_cbranch_scc1 Lz10_p_x
    s_cbranch_vccnz Lz10_p
Lz10_p_x:
    s_nop 1
    s_branch Lz10_ok
Lz11_r:
    s_nop 7
Lz11_p:
    global_load_dwordx4 v[78:81], v30, s[52:53] offset:-2048 sc1
    global_load_dwordx4 v[82:85], v31, s[52:53] offset:-2048 sc1
    global_load_dwordx4 v[86:89], v30, s[54:55] offset:-2048 sc1
    global_load_dwordx4 v[90:93], v31, s[54:55] offset:-2048 sc1
    s_waitcnt vmcnt(0)
    v_and_b32 v28, v81, v85
    v_bitop3_b32 v28, v89, v93, v28 bitop3:0x80
    v_and_b32 v28, 1, v28
    v_cmp_ne_u32 vcc, 1, v28
    s_add_u32 s100, s100, 1
    s_cmp_ge_u32 s100, 262144
    s_cbranch_scc1 Lz11_p_x
    s_cbranch_vccnz Lz11_p
Lz11_p_x:
    s_nop 1
    s_branch Lz11_ok
Lz12_r:
    s_nop 7
Lz12_p:
    global_load_dwordx4 v[94:97], v30, s[64:65] offset:-2048 sc1
    global_load_dwordx4 v[98:101], v31, s[64:65] offset:-2048 sc1
    global_load_dwordx4 v[102:105], v30, s[66:67] offset:-2048 sc1
    global_load_dwordx4 v[106:109], v31, s[66:67] offset:-2048 sc1
    s_waitcnt vmcnt(0)
    v_and_b32 v28, v97, v101
    v_bitop3_b32 v28, v105, v109, v28 bitop3:0x80
    v_and_b32 v28, 1, v28
    v_cmp_ne_u32 vcc, 1, v28
    s_add_u32 s100, s100, 1
    s_cmp_ge_u32 s100, 262144
    s_cbranch_scc1 Lz12_p_x
    s_cbranch_vccnz Lz12_p
Lz12_p_x:
    s_nop 1
    s_branch Lz12_ok
Lz13_r:
    s_nop 7
Lz13_p:
    global_load_dwordx4 v[110:113], v30, s[60:61] offset:-1024 sc1
    global_load_dwordx4 v[114:117], v31, s[60:61] offset:-1024 sc1
    global_load_dwordx4 v[118:121], v30, s[62:63] offset:-1024 sc1
    global_load_dwordx4 v[122:125], v31, s[62:63] offset:-1024 sc1
    s_waitcnt vmcnt(0)
    v_and_b32 v28, v113, v117
    v_bitop3_b32 v28, v121, v125, v28 bitop3:0x80
    v_and_b32 v28, 1, v28
    v_cmp_ne_u32 vcc, 1, v28
    s_add_u32 s100, s100, 1
    s_cmp_ge_u32 s100, 262144
    s_cbranch_scc1 Lz13_p_x
    s_cbranch_vccnz Lz13_p
Lz13_p_x:
    s_nop 1
    s_branch Lz13_ok
Lz14_r:
    s_nop 7
Lz14_p:
    global_load_dwordx4 v[126:129], v30, s[52:53] offset:-1024 sc1
    global_load_dwordx4 v[130:133], v31, s[52:53] offset:-1024 sc1
    global_load_dwordx4 v[134:137], v30, s[54:55] offset:-1024 sc1
    global_load_dwordx4 v[138:141], v31, s[54:55] offset:-1024 sc1
    s_waitcnt vmcnt(0)
    v_and_b32 v28, v129, v133
    v_bitop3_b32 v28, v137, v141, v28 bitop3:0x80
    v_and_b32 v28, 1, v28
    v_cmp_ne_u32 vcc, 1, v28
    s_add_u32 s100, s100, 1
    s_cmp_ge_u32 s100, 262144
    s_cbranch_scc1 Lz14_p_x
    s_cbranch_vccnz Lz14_p
Lz14_p_x:
    s_nop 1
    s_branch Lz14_ok
Lz15_r:
    s_nop 7
Lz15_p:
    global_load_dwordx4 v[62:65], v30, s[64:65] offset:-1024 sc1
    global_load_dwordx4 v[66:69], v31, s[64:65] offset:-1024 sc1
    global_load_dwordx4 v[70:73], v30, s[66:67] offset:-1024 sc1
    global_load_dwordx4 v[74:77], v31, s[66:67] offset:-1024 sc1
    s_waitcnt vmcnt(0)
    v_and_b32 v28, v65, v69
    v_bitop3_b32 v28, v73, v77, v28 bitop3:0x80
    v_and_b32 v28, 1, v28
    v_cmp_ne_u32 vcc, 1, v28
    s_add_u32 s100, s100, 1
    s_cmp_ge_u32 s100, 262144
    s_cbranch_scc1 Lz15_p_x
    s_cbranch_vccnz Lz15_p
Lz15_p_x:
    s_nop 1
    s_branch Lz15_ok
Lz16_r:
    s_nop 7
Lz16_p:
    global_load_dwordx4 v[78:81], v30, s[60:61] offset:0 sc1
    global_load_dwordx4 v[82:85], v31, s[60:61] offset:0 sc1
    global_load_dwordx4 v[86:89], v30, s[62:63] offset:0 sc1
    global_load_dwordx4 v[90:93], v31, s[62:63] offset:0 sc1
    s_waitcnt vmcnt(0)
    v_and_b32 v28, v81, v85
    v_bitop3_b32 v28, v89, v93, v28 bitop3:0x80
    v_and_b32 v28, 1, v28
    v_cmp_ne_u32 vcc, 1, v28
    s_add_u32 s100, s100, 1
    s_cmp_ge_u32 s100, 262144
    s_cbranch_scc1 Lz16_p_x
    s_cbranch_vccnz Lz16_p
Lz16_p_x:
    s_nop 1
    s_branch Lz16_ok
Lz17_r:
    s_nop 7
Lz17_p:
    global_load_dwordx4 v[94:97], v30, s[52:53] offset:0 sc1
    global_load_dwordx4 v[98:101], v31, s[52:53] offset:0 sc1
    global_load_dwordx4 v[102:105], v30, s[54:55] offset:0 sc1
    global_load_dwordx4 v[106:109], v31, s[54:55] offset:0 sc1
    s_waitcnt vmcnt(0)
    v_and_b32 v28, v97, v101
    v_bitop3_b32 v28, v105, v109, v28 bitop3:0x80
    v_and_b32 v28, 1, v28
    v_cmp_ne_u32 vcc, 1, v28
    s_add_u32 s100, s100, 1
    s_cmp_ge_u32 s100, 262144
    s_cbranch_scc1 Lz17_p_x
    s_cbranch_vccnz Lz17_p
Lz17_p_x:
    s_nop 1
    s_branch Lz17_ok
Lz18_r:
    s_nop 7
Lz18_p:
    global_load_dwordx4 v[110:113], v30, s[64:65] offset:0 sc1
    global_load_dwordx4 v[114:117], v31, s[64:65] offset:0 sc1
    global_load_dwordx4 v[118:121], v30, s[66:67] offset:0 sc1
    global_load_dwordx4 v[122:125], v31, s[66:67] offset:0 sc1
    s_waitcnt vmcnt(0)
    v_and_b32 v28, v113, v117
    v_bitop3_b32 v28, v121, v125, v28 bitop3:0x80
    v_and_b32 v28, 1, v28
    v_cmp_ne_u32 vcc, 1, v28
    s_add_u32 s100, s100, 1
    s_cmp_ge_u32 s100, 262144
    s_cbranch_scc1 Lz18_p_x
    s_cbranch_vccnz Lz18_p
Lz18_p_x:
    s_nop 1
    s_branch Lz18_ok
Lz19_r:
    s_nop 7
Lz19_p:
    global_load_dwordx4 v[126:129], v30, s[60:61] offset:1024 sc1
    global_load_dwordx4 v[130:133], v31, s[60:61] offset:1024 sc1
    global_load_dwordx4 v[134:137], v30, s[62:63] offset:1024 sc1
    global_load_dwordx4 v[138:141], v31, s[62:63] offset:1024 sc1
    s_waitcnt vmcnt(0)
    v_and_b32 v28, v129, v133
    v_bitop3_b32 v28, v137, v141, v28 bitop3:0x80
    v_and_b32 v28, 1, v28
    v_cmp_ne_u32 vcc, 1, v28
    s_add_u32 s100, s100, 1
    s_cmp_ge_u32 s100, 262144
    s_cbranch_scc1 Lz19_p_x
    s_cbranch_vccnz Lz19_p
Lz19_p_x:
    s_nop 1
    s_branch Lz19_ok
Lz20_r:
    s_nop 7
Lz20_p:
    global_load_dwordx4 v[62:65], v30, s[52:53] offset:1024 sc1
    global_load_dwordx4 v[66:69], v31, s[52:53] offset:1024 sc1
    global_load_dwordx4 v[70:73], v30, s[54:55] offset:1024 sc1
    global_load_dwordx4 v[74:77], v31, s[54:55] offset:1024 sc1
    s_waitcnt vmcnt(0)
    v_and_b32 v28, v65, v69
    v_bitop3_b32 v28, v73, v77, v28 bitop3:0x80
    v_and_b32 v28, 1, v28
    v_cmp_ne_u32 vcc, 1, v28
    s_add_u32 s100, s100, 1
    s_cmp_ge_u32 s100, 262144
    s_cbranch_scc1 Lz20_p_x
    s_cbranch_vccnz Lz20_p
Lz20_p_x:
    s_nop 1
    s_branch Lz20_ok
Lz21_r:
    s_nop 7
Lz21_p:
    global_load_dwordx4 v[78:81], v30, s[64:65] offset:1024 sc1
    global_load_dwordx4 v[82:85], v31, s[64:65] offset:1024 sc1
    global_load_dwordx4 v[86:89], v30, s[66:67] offset:1024 sc1
    global_load_dwordx4 v[90:93], v31, s[66:67] offset:1024 sc1
    s_waitcnt vmcnt(0)
    v_and_b32 v28, v81, v85
    v_bitop3_b32 v28, v89, v93, v28 bitop3:0x80
    v_and_b32 v28, 1, v28
    v_cmp_ne_u32 vcc, 1, v28
    s_add_u32 s100, s100, 1
    s_cmp_ge_u32 s100, 262144
    s_cbranch_scc1 Lz21_p_x
    s_cbranch_vccnz Lz21_p
Lz21_p_x:
    s_nop 1
    s_branch Lz21_ok
Lz22_r:
    s_nop 7
Lz22_p:
    global_load_dwordx4 v[94:97], v30, s[60:61] offset:2048 sc1
    global_load_dwordx4 v[98:101], v31, s[60:61] offset:2048 sc1
    global_load_dwordx4 v[102:105], v30, s[62:63] offset:2048 sc1
    global_load_dwordx4 v[106:109], v31, s[62:63] offset:2048 sc1
    s_waitcnt vmcnt(0)
    v_and_b32 v28, v97, v101
    v_bitop3_b32 v28, v105, v109, v28 bitop3:0x80
    v_and_b32 v28, 1, v28
    v_cmp_ne_u32 vcc, 1, v28
    s_add_u32 s100, s100, 1
    s_cmp_ge_u32 s100, 262144
    s_cbranch_scc1 Lz22_p_x
    s_cbranch_vccnz Lz22_p
Lz22_p_x:
    s_nop 1
    s_branch Lz22_ok
Lz23_r:
    s_nop 7
Lz23_p:
    global_load_dwordx4 v[110:113], v30, s[52:53] offset:2048 sc1
    global_load_dwordx4 v[114:117], v31, s[52:53] offset:2048 sc1
    global_load_dwordx4 v[118:121], v30, s[54:55] offset:2048 sc1
    global_load_dwordx4 v[122:125], v31, s[54:55] offset:2048 sc1
    s_waitcnt vmcnt(0)
    v_and_b32 v28, v113, v117
    v_bitop3_b32 v28, v121, v125, v28 bitop3:0x80
    v_and_b32 v28, 1, v28
    v_cmp_ne_u32 vcc, 1, v28
    s_add_u32 s100, s100, 1
    s_cmp_ge_u32 s100, 262144
    s_cbranch_scc1 Lz23_p_x
    s_cbranch_vccnz Lz23_p
Lz23_p_x:
    s_nop 1
    s_branch Lz23_ok
Lz24_r:
    s_nop 7
Lz24_p:
    global_load_dwordx4 v[126:129], v30, s[64:65] offset:2048 sc1
    global_load_dwordx4 v[130:133], v31, s[64:65] offset:2048 sc1
    global_load_dwordx4 v[134:137], v30, s[66:67] offset:2048 sc1
    global_load_dwordx4 v[138:141], v31, s[66:67] offset:2048 sc1
    s_waitcnt vmcnt(0)
    v_and_b32 v28, v129, v133
    v_bitop3_b32 v28, v137, v141, v28 bitop3:0x80
    v_and_b32 v28, 1, v28
    v_cmp_ne_u32 vcc, 1, v28
    s_add_u32 s100, s100, 1
    s_cmp_ge_u32 s100, 262144
    s_cbranch_scc1 Lz24_p_x
    s_cbranch_vccnz Lz24_p
Lz24_p_x:
    s_nop 1
    s_branch Lz24_ok
Lz25_r:
    s_nop 7
Lz25_p:
    global_load_dwordx4 v[62:65], v30, s[60:61] offset:3072 sc1
    global_load_dwordx4 v[66:69], v31, s[60:61] offset:3072 sc1
    global_load_dwordx4 v[70:73], v30, s[62:63] offset:3072 sc1
    global_load_dwordx4 v[74:77], v31, s[62:63] offset:3072 sc1
    s_waitcnt vmcnt(0)
    v_and_b32 v28, v65, v69
    v_bitop3_b32 v28, v73, v77, v28 bitop3:0x80
    v_and_b32 v28, 1, v28
    v_cmp_ne_u32 vcc, 1, v28
    s_add_u32 s100, s100, 1
    s_cmp_ge_u32 s100, 262144
    s_cbranch_scc1 Lz25_p_x
    s_cbranch_vccnz Lz25_p
Lz25_p_x:
    s_nop 1
    s_branch Lz25_ok
Lz26_r:
    s_nop 7
Lz26_p:
    global_load_dwordx4 v[78:81], v30, s[52:53] offset:3072 sc1
    global_load_dwordx4 v[82:85], v31, s[52:53] offset:3072 sc1
    global_load_dwordx4 v[86:89], v30, s[54:55] offset:3072 sc1
    global_load_dwordx4 v[90:93], v31, s[54:55] offset:3072 sc1
    s_waitcnt vmcnt(0)
    v_and_b32 v28, v81, v85
    v_bitop3_b32 v28, v89, v93, v28 bitop3:0x80
    v_and_b32 v28, 1, v28
    v_cmp_ne_u32 vcc, 1, v28
    s_add_u32 s100, s100, 1
    s_cmp_ge_u32 s100, 262144
    s_cbranch_scc1 Lz26_p_x
    s_cbranch_vccnz Lz26_p
Lz26_p_x:
    s_nop 1
    s_branch Lz26_ok
Lz27_r:
    s_nop 7
Lz27_p:
    global_load_dwordx4 v[94:97], v30, s[64:65] offset:3072 sc1
    global_load_dwordx4 v[98:101], v31, s[64:65] offset:3072 sc1
    global_load_dwordx4 v[102:105], v30, s[66:67] offset:3072 sc1
    global_load_dwordx4 v[106:109], v31, s[66:67] offset:3072 sc1
    s_waitcnt vmcnt(0)
    v_and_b32 v28, v97, v101
    v_bitop3_b32 v28, v105, v109, v28 bitop3:0x80
    v_and_b32 v28, 1, v28
    v_cmp_ne_u32 vcc, 1, v28
    s_add_u32 s100, s100, 1
    s_cmp_ge_u32 s100, 262144
    s_cbranch_scc1 Lz27_p_x
    s_cbranch_vccnz Lz27_p
Lz27_p_x:
    s_nop 1
    s_branch Lz27_ok
Lp0_r:
    s_nop 7
Lp0_p:
    global_load_dwordx4 v[142:145], v6, s[38:39] offset:-4096 sc1
    global_load_dwordx4 v[146:149], v6, s[38:39] offset:-3072 sc1
    global_load_dwordx4 v[150:153], v6, s[38:39] offset:-2048 sc1
    global_load_dwordx4 v[154:157], v6, s[38:39] offset:-1024 sc1
    global_load_dwordx4 v[158:161], v6, s[38:39] offset:0 sc1
    global_load_dwordx4 v[162:165], v6, s[38:39] offset:1024 sc1
    global_load_dwordx4 v[166:169], v6, s[38:39] offset:2048 sc1
    global_load_dwordx4 v[170:173], v6, s[38:39] offset:3072 sc1
    s_waitcnt vmcnt(0)
    v_or_b32 v28, v145, v149
    v_or3_b32 v28, v153, v157, v28
    v_or3_b32 v28, v161, v165, v28
    v_or3_b32 v28, v169, v173, v28
    v_and_b32 v28, 1, v28
    v_cmp_ne_u32 vcc, 0, v28
    s_add_u32 s100, s100, 1
    s_cmp_ge_u32 s100, 262144
    s_cbranch_scc1 Lp0_p_x
    s_cbranch_vccnz Lp0_p
Lp0_p_x:
    s_nop 1
    s_branch Lp0_ok
Lp1_r:
    s_nop 7
Lp1_p:
    global_load_dwordx4 v[174:177], v7, s[38:39] offset:-4096 sc1
    global_load_dwordx4 v[178:181], v7, s[38:39] offset:-3072 sc1
    global_load_dwordx4 v[182:185], v7, s[38:39] offset:-2048 sc1
    global_load_dwordx4 v[186:189], v7, s[38:39] offset:-1024 sc1
    global_load_dwordx4 v[190:193], v7, s[38:39] offset:0 sc1
    global_load_dwordx4 v[194:197], v7, s[38:39] offset:1024 sc1
    global_load_dwordx4 v[198:201], v7, s[38:39] offset:2048 sc1
    global_load_dwordx4 v[202:205], v7, s[38:39] offset:3072 sc1
    s_waitcnt vmcnt(0)
    v_or_b32 v28, v177, v181
    v_or3_b32 v28, v185, v189, v28
    v_or3_b32 v28, v193, v197, v28
    v_or3_b32 v28, v201, v205, v28
    v_and_b32 v28, 1, v28
    v_cmp_ne_u32 vcc, 0, v28
    s_add_u32 s100, s100, 1
    s_cmp_ge_u32 s100, 262144
    s_cbranch_scc1 Lp1_p_x
    s_cbranch_vccnz Lp1_p
Lp1_p_x:
    s_nop 1
    s_branch Lp1_ok
Lp2_r:
    s_nop 7
Lp2_p:
    global_load_dwordx4 v[206:209], v26, s[38:39] offset:-4096 sc1
    global_load_dwordx4 v[210:213], v26, s[38:39] offset:-3072 sc1
    global_load_dwordx4 v[214:217], v26, s[38:39] offset:-2048 sc1
    global_load_dwordx4 v[218:221], v26, s[38:39] offset:-1024 sc1
    global_load_dwordx4 v[222:225], v26, s[38:39] offset:0 sc1
    global_load_dwordx4 v[226:229], v26, s[38:39] offset:1024 sc1
    global_load_dwordx4 v[230:233], v26, s[38:39] offset:2048 sc1
    s_waitcnt vmcnt(0)
    v_or3_b32 v28, v209, v213, v217
    v_or3_b32 v28, v221, v225, v28
    v_or3_b32 v28, v229, v233, v28
    v_and_b32 v28, 1, v28
    v_cmp_ne_u32 vcc, 0, v28
    s_add_u32 s100, s100, 1
    s_cmp_ge_u32 s100, 262144
    s_cbranch_scc1 Lp2_p_x
    s_cbranch_vccnz Lp2_p
Lp2_p_x:
    s_nop 1
    s_branch Lp2_ok
Lp3_r:
    s_nop 7
Lp3_p:
    global_load_dwordx4 v[238:241], v27, s[38:39] offset:-4096 sc1
    global_load_dwordx4 v[242:245], v27, s[38:39] offset:-3072 sc1
    global_load_dwordx4 v[246:249], v27, s[38:39] offset:-2048 sc1
    global_load_dwordx4 v[250:253], v27, s[38:39] offset:-1024 sc1
    s_waitcnt vmcnt(0)
    v_or_b32 v28, v239, v241
    v_or3_b32 v28, v243, v245, v28
    v_or3_b32 v28, v247, v249, v28
    v_or3_b32 v28, v251, v253, v28
    v_and_b32 v28, 1, v28
    v_cmp_ne_u32 vcc, 0, v28
    s_add_u32 s100, s100, 1
    s_cmp_ge_u32 s100, 262144
    s_cbranch_scc1 Lp3_p_x
    s_cbranch_vccnz Lp3_p
Lp3_p_x:
    s_nop 1
    s_branch Lp3_ok
Lcode_end:
    s_endpgm
.section .rodata,"a"
.p2align 6
.amdhsa_kernel adaLN_cond__ssm_conv_h3__mixer_gmlp__prompt_kernel
  .amdhsa_next_free_vgpr 512
  .amdhsa_next_free_sgpr 102
  .amdhsa_accum_offset 256
  .amdhsa_group_segment_fixed_size 0
  .amdhsa_kernarg_size 128
  .amdhsa_user_sgpr_count 2
  .amdhsa_user_sgpr_kernarg_segment_ptr 1
  .amdhsa_system_sgpr_workgroup_id_x 1
  .amdhsa_float_denorm_mode_32 3
.end_amdhsa_kernel
```

```asm
; @launch grid=(256,1,1) block=(256,1,1) lds=163840
.amdgcn_target "amdgcn-amd-amdhsa--gfx950"
.text
.p2align 8
.globl adaLN_cond__ssm_conv_h3__mixer_gmlp__prompt_kernel
.type adaLN_cond__ssm_conv_h3__mixer_gmlp__prompt_kernel,@function
adaLN_cond__ssm_conv_h3__mixer_gmlp__prompt_kernel:
    s_cmp_ge_u32 s2, 256
    s_cbranch_scc1 Lend
    s_load_dwordx16 s[8:23], s[0:1], 0
    s_load_dwordx16 s[24:39], s[0:1], 64
    v_lshrrev_b32 v2, 6, v0
    v_and_b32 v1, 63, v0
    v_readfirstlane_b32 s3, v2
    s_getpc_b64 s[4:5]
Lpf_adaLN_cond__ssm_conv_h3__mixer_gmlp__prompt_kernel_9:
    s_add_u32 s4, s4, adaLN_cond__ssm_conv_h3__mixer_gmlp__prompt_kernel-Lpf_adaLN_cond__ssm_conv_h3__mixer_gmlp__prompt_kernel_9
    s_addc_u32 s5, s5, -1
    s_lshr_b32 s6, s2, 3
    s_and_b32 s6, s6, 31
    v_mul_u32_u24 v254, 32, v0
    v_add_lshl_u32 v254, v254, s6, 7
    v_min_u32 v254, (Lcode_end-adaLN_cond__ssm_conv_h3__mixer_gmlp__prompt_kernel-4), v254
    global_load_dword v254, v254, s[4:5]
    s_mov_b64 s[58:59], s[4:5]
    v_and_b32 v2, 15, v1
    v_lshrrev_b32 v3, 4, v1
    v_lshlrev_b32 v4, 4, v1
    v_lshrrev_b32 v6, 2, v2
    v_and_b32 v5, 3, v2
    v_lshl_add_u32 v5, v6, 3, v5
    s_mov_b32 s100, 0
    s_and_b32 s4, s2, 7
    s_lshr_b32 s5, s2, 3
    s_lshr_b32 s43, s5, 2
    s_lshr_b32 s6, s43, 1
    s_lshl_b32 s6, s6, 3
    s_and_b32 s7, s4, 6
    s_add_u32 s6, s6, s7
    s_and_b32 s7, s43, 1
    s_add_u32 s40, s6, s7
    s_and_b32 s6, s4, 1
    s_lshl_b32 s6, s6, 2
    s_and_b32 s7, s5, 3
    s_add_u32 s41, s6, s7
    s_mul_i32 s4, s4, 20
    s_add_u32 s42, s4, s5
    s_waitcnt lgkmcnt(0)
    s_mov_b64 s[0:1], s[58:59]
    s_cmp_ge_u32 s2, 160
    s_cbranch_scc1 Lspare
Lconv:
    s_and_b32 s4, s42, 15
    s_lshl_b32 s4, s4, 2
    s_add_u32 s4, s4, s3
    s_mul_i32 s4, s4, 40960
    s_lshr_b32 s5, s42, 4
    s_lshl_b32 s6, s5, 7
    s_add_u32 s4, s4, s6
    v_mul_u32_u24 v46, 10240, v3
    v_lshl_add_u32 v46, v2, 3, v46
    v_add_u32 v46, s4, v46
    v_add_u32 v47, 5120, v46
    global_load_dwordx2 v[56:57], v46, s[10:11] offset:0
    global_load_dwordx2 v[58:59], v46, s[10:11] offset:1280
    global_load_dwordx2 v[60:61], v46, s[10:11] offset:2560
    global_load_dwordx2 v[62:63], v46, s[10:11] offset:3840
    global_load_dwordx2 v[64:65], v47, s[10:11] offset:0
    global_load_dwordx2 v[66:67], v47, s[10:11] offset:1280
    global_load_dwordx2 v[68:69], v47, s[10:11] offset:2560
    global_load_dwordx2 v[70:71], v47, s[10:11] offset:3840
    v_max_u32 v48, 3840, v46
    global_load_dwordx2 v[50:51], v48, s[10:11] offset:-3840
    global_load_dwordx2 v[52:53], v48, s[10:11] offset:-2560
    global_load_dwordx2 v[54:55], v48, s[10:11] offset:-1280
    s_lshl_b32 s5, s5, 9
    v_lshl_add_u32 v48, v2, 5, s5
    global_load_dwordx4 v[88:91], v48, s[14:15] offset:0
    global_load_dwordx4 v[92:95], v48, s[14:15] offset:16
    global_load_dwordx2 v[72:73], v46, s[12:13] offset:0 nt
    global_load_dwordx2 v[74:75], v46, s[12:13] offset:1280 nt
    global_load_dwordx2 v[76:77], v46, s[12:13] offset:2560 nt
    global_load_dwordx2 v[78:79], v46, s[12:13] offset:3840 nt
    global_load_dwordx2 v[80:81], v47, s[12:13] offset:0 nt
    global_load_dwordx2 v[82:83], v47, s[12:13] offset:1280 nt
    global_load_dwordx2 v[84:85], v47, s[12:13] offset:2560 nt
    global_load_dwordx2 v[86:87], v47, s[12:13] offset:3840 nt
    s_lshl_b32 s7, s42, 3
    s_load_dwordx2 s[92:93], s[18:19], s7
    v_mov_b32 v156, 0
    v_mov_b32 v157, 0
    v_mov_b32 v158, 0
    v_mov_b32 v159, 0
    s_mul_i32 s5, s3, 8448
    v_and_b32 v28, 48, v4
    v_add_u32 v28, s5, v28
    ds_write_b128 v28, v[156:159] offset:0
    ds_write_b128 v28, v[156:159] offset:4224
    v_min_u32 v28, 448, v4
    s_mul_i32 s4, s3, 9280
    v_add_u32 v28, s4, v28
    ds_write_b128 v28, v[156:159] offset:37888
    ds_write_b128 v28, v[156:159] offset:42528
    v_add_u32 v37, s5, v4
    v_and_b32 v28, 1, v2
    v_lshrrev_b32 v29, 1, v2
    v_mul_u32_u24 v36, 4224, v28
    v_lshl_add_u32 v36, v29, 3, v36
    v_lshl_add_u32 v36, v3, 4, v36
    v_add_u32 v36, s5, v36
    v_mul_u32_u24 v38, 4640, v28
    v_lshlrev_b32 v29, 6, v29
    v_sub_u32 v38, v38, v29
    v_lshl_add_u32 v38, v3, 4, v38
    s_add_u32 s4, s4, 34256
    v_add_u32 v38, s4, v38
    v_lshl_add_u32 v40, v28, 2, v29
    v_lshl_add_u32 v40, v3, 4, v40
    s_mul_i32 s4, s3, 1056
    s_add_u32 s4, s4, 0
    v_add_u32 v40, s4, v40
    v_lshlrev_b32 v28, 2, v0
    v_sub_u32 v39, 34824, v28
    v_add_u32 v41, 0, v28
    v_lshrrev_b32 v28, 5, v0
    v_mul_u32_u24 v43, 114688, v28
    v_and_b32 v28, 31, v0
    v_lshl_add_u32 v43, v28, 4, v43
    s_lshl_b32 s4, s42, 9
    s_add_u32 s4, s4, 1048576
    v_add_u32 v43, s4, v43
    s_waitcnt lgkmcnt(0)
    s_lshl_b32 s20, s92, 16
    s_lshr_b32 s28, s20, 16
    s_and_b32 s21, s92, 0xffff0000
    s_lshr_b32 s29, s21, 16
    s_lshl_b32 s22, s93, 16
    s_lshr_b32 s30, s22, 16
    s_and_b32 s23, s93, 0xffff0000
    s_lshr_b32 s31, s23, 16
    v_and_b32 v211, 7, v1
    v_lshrrev_b32 v212, 3, v1
    s_lshl_b32 s4, s42, 2
    s_add_u32 s4, s4, s3
    s_lshl_b32 s94, s4, 12
    v_add_u32 v28, s94, v4
    s_mul_i32 s5, s3, 8448
    s_add_u32 m0, s5, 4288
    s_nop 0
    global_load_lds_dwordx4 v28, s[16:17] offset:0 nt
    global_load_lds_dwordx4 v28, s[16:17] offset:1024 nt
    global_load_lds_dwordx4 v28, s[16:17] offset:2048 nt
    global_load_lds_dwordx4 v28, s[16:17] offset:3072 nt
    s_lshr_b32 s5, s3, 1
    s_lshl_b32 s5, s5, 5
    s_and_b32 s6, s3, 1
    s_lshl_b32 s6, s6, 2
    s_add_u32 s6, s6, s5
    s_lshl_b32 s5, s40, 6
    s_add_u32 s90, s6, s5
    v_add_lshl_u32 v27, v5, s90, 1
    global_load_ushort v27, v27, s[26:27]
    s_waitcnt vmcnt(25)
    v_lshlrev_b32 v124, 16, v56
    v_and_b32 v125, 0xffff0000, v56
    v_lshlrev_b32 v126, 16, v57
    v_and_b32 v127, 0xffff0000, v57
    s_waitcnt vmcnt(24)
    v_lshlrev_b32 v128, 16, v58
    v_and_b32 v129, 0xffff0000, v58
    v_lshlrev_b32 v130, 16, v59
    v_and_b32 v131, 0xffff0000, v59
    s_waitcnt vmcnt(23)
    v_lshlrev_b32 v132, 16, v60
    v_and_b32 v133, 0xffff0000, v60
    v_lshlrev_b32 v134, 16, v61
    v_and_b32 v135, 0xffff0000, v61
    s_waitcnt vmcnt(22)
    v_lshlrev_b32 v136, 16, v62
    v_and_b32 v137, 0xffff0000, v62
    v_lshlrev_b32 v138, 16, v63
    v_and_b32 v139, 0xffff0000, v63
    s_waitcnt vmcnt(21)
    v_lshlrev_b32 v140, 16, v64
    v_and_b32 v141, 0xffff0000, v64
    v_lshlrev_b32 v142, 16, v65
    v_and_b32 v143, 0xffff0000, v65
    s_waitcnt vmcnt(20)
    v_lshlrev_b32 v144, 16, v66
    v_and_b32 v145, 0xffff0000, v66
    v_lshlrev_b32 v146, 16, v67
    v_and_b32 v147, 0xffff0000, v67
    s_waitcnt vmcnt(19)
    v_lshlrev_b32 v148, 16, v68
    v_and_b32 v149, 0xffff0000, v68
    v_lshlrev_b32 v150, 16, v69
    v_and_b32 v151, 0xffff0000, v69
    s_waitcnt vmcnt(18)
    v_lshlrev_b32 v152, 16, v70
    v_and_b32 v153, 0xffff0000, v70
    v_lshlrev_b32 v154, 16, v71
    v_and_b32 v155, 0xffff0000, v71
    s_lshl_b32 s4, s42, 2
    s_add_u32 s4, s4, s3
    s_mul_i32 s4, s4, 5120
    s_cmp_lt_u32 s42, 128
    s_cselect_b32 s5, -1, 0
    v_add_u32 v209, s4, v4
    v_and_b32 v209, s5, v209
    v_add_u32 v209, 2048, v209
    global_load_dwordx4 v[188:191], v209, s[8:9] offset:-2048 nt
    global_load_dwordx4 v[192:195], v209, s[8:9] offset:-1024 nt
    global_load_dwordx4 v[196:199], v209, s[8:9] offset:0 nt
    global_load_dwordx4 v[200:203], v209, s[8:9] offset:1024 nt
    global_load_dwordx4 v[204:207], v209, s[8:9] offset:2048 nt
    v_cmp_le_u32 vcc, 1280, v46
    s_waitcnt vmcnt(22)
    s_nop 0
    v_cndmask_b32 v50, 0, v50, vcc
    v_cndmask_b32 v51, 0, v51, vcc
    s_waitcnt vmcnt(21)
    v_cndmask_b32 v52, 0, v52, vcc
    v_cndmask_b32 v53, 0, v53, vcc
    s_waitcnt vmcnt(20)
    v_cndmask_b32 v54, 0, v54, vcc
    v_cndmask_b32 v55, 0, v55, vcc
    v_lshlrev_b32 v112, 16, v50
    v_and_b32 v113, 0xffff0000, v50
    v_lshlrev_b32 v114, 16, v51
    v_and_b32 v115, 0xffff0000, v51
    v_lshlrev_b32 v116, 16, v52
    v_and_b32 v117, 0xffff0000, v52
    v_lshlrev_b32 v118, 16, v53
    v_and_b32 v119, 0xffff0000, v53
    v_lshlrev_b32 v120, 16, v54
    v_and_b32 v121, 0xffff0000, v54
    v_lshlrev_b32 v122, 16, v55
    v_and_b32 v123, 0xffff0000, v55
    s_waitcnt vmcnt(19)
    v_lshlrev_b32 v96, 16, v88
    v_and_b32 v100, 0xffff0000, v88
    v_lshlrev_b32 v104, 16, v89
    v_and_b32 v108, 0xffff0000, v89
    v_lshlrev_b32 v97, 16, v90
    v_and_b32 v101, 0xffff0000, v90
    v_lshlrev_b32 v105, 16, v91
    v_and_b32 v109, 0xffff0000, v91
    s_waitcnt vmcnt(18)
    v_lshlrev_b32 v98, 16, v92
    v_and_b32 v102, 0xffff0000, v92
    v_lshlrev_b32 v106, 16, v93
    v_and_b32 v110, 0xffff0000, v93
    v_lshlrev_b32 v99, 16, v94
    v_and_b32 v103, 0xffff0000, v94
    v_lshlrev_b32 v107, 16, v95
    v_and_b32 v111, 0xffff0000, v95
    v_pk_mul_f32 v[156:157], v[124:125], v[96:97] op_sel:[0,0] op_sel_hi:[1,1]
    v_pk_mul_f32 v[158:159], v[126:127], v[98:99] op_sel:[0,0] op_sel_hi:[1,1]
    v_pk_mul_f32 v[160:161], v[128:129], v[96:97] op_sel:[0,0] op_sel_hi:[1,1]
    v_pk_mul_f32 v[162:163], v[130:131], v[98:99] op_sel:[0,0] op_sel_hi:[1,1]
    v_pk_mul_f32 v[164:165], v[132:133], v[96:97] op_sel:[0,0] op_sel_hi:[1,1]
    v_pk_mul_f32 v[166:167], v[134:135], v[98:99] op_sel:[0,0] op_sel_hi:[1,1]
    v_pk_mul_f32 v[168:169], v[136:137], v[96:97] op_sel:[0,0] op_sel_hi:[1,1]
    v_pk_mul_f32 v[170:171], v[138:139], v[98:99] op_sel:[0,0] op_sel_hi:[1,1]
    v_pk_mul_f32 v[172:173], v[140:141], v[96:97] op_sel:[0,0] op_sel_hi:[1,1]
    v_pk_mul_f32 v[174:175], v[142:143], v[98:99] op_sel:[0,0] op_sel_hi:[1,1]
    v_pk_mul_f32 v[176:177], v[144:145], v[96:97] op_sel:[0,0] op_sel_hi:[1,1]
    v_pk_mul_f32 v[178:179], v[146:147], v[98:99] op_sel:[0,0] op_sel_hi:[1,1]
    v_pk_mul_f32 v[180:181], v[148:149], v[96:97] op_sel:[0,0] op_sel_hi:[1,1]
    v_pk_mul_f32 v[182:183], v[150:151], v[98:99] op_sel:[0,0] op_sel_hi:[1,1]
    v_pk_mul_f32 v[184:185], v[152:153], v[96:97] op_sel:[0,0] op_sel_hi:[1,1]
    v_pk_mul_f32 v[186:187], v[154:155], v[98:99] op_sel:[0,0] op_sel_hi:[1,1]
    v_pk_fma_f32 v[156:157], v[120:121], v[100:101], v[156:157] op_sel:[0,0,0] op_sel_hi:[1,1,1]
    v_pk_fma_f32 v[158:159], v[122:123], v[102:103], v[158:159] op_sel:[0,0,0] op_sel_hi:[1,1,1]
    v_pk_fma_f32 v[160:161], v[124:125], v[100:101], v[160:161] op_sel:[0,0,0] op_sel_hi:[1,1,1]
    v_pk_fma_f32 v[162:163], v[126:127], v[102:103], v[162:163] op_sel:[0,0,0] op_sel_hi:[1,1,1]
    v_pk_fma_f32 v[164:165], v[128:129], v[100:101], v[164:165] op_sel:[0,0,0] op_sel_hi:[1,1,1]
    v_pk_fma_f32 v[166:167], v[130:131], v[102:103], v[166:167] op_sel:[0,0,0] op_sel_hi:[1,1,1]
    v_pk_fma_f32 v[168:169], v[132:133], v[100:101], v[168:169] op_sel:[0,0,0] op_sel_hi:[1,1,1]
    v_pk_fma_f32 v[170:171], v[134:135], v[102:103], v[170:171] op_sel:[0,0,0] op_sel_hi:[1,1,1]
    v_pk_fma_f32 v[172:173], v[136:137], v[100:101], v[172:173] op_sel:[0,0,0] op_sel_hi:[1,1,1]
    v_pk_fma_f32 v[174:175], v[138:139], v[102:103], v[174:175] op_sel:[0,0,0] op_sel_hi:[1,1,1]
    v_pk_fma_f32 v[176:177], v[140:141], v[100:101], v[176:177] op_sel:[0,0,0] op_sel_hi:[1,1,1]
    v_pk_fma_f32 v[178:179], v[142:143], v[102:103], v[178:179] op_sel:[0,0,0] op_sel_hi:[1,1,1]
    v_pk_fma_f32 v[180:181], v[144:145], v[100:101], v[180:181] op_sel:[0,0,0] op_sel_hi:[1,1,1]
    v_pk_fma_f32 v[182:183], v[146:147], v[102:103], v[182:183] op_sel:[0,0,0] op_sel_hi:[1,1,1]
    v_pk_fma_f32 v[184:185], v[148:149], v[100:101], v[184:185] op_sel:[0,0,0] op_sel_hi:[1,1,1]
    v_pk_fma_f32 v[186:187], v[150:151], v[102:103], v[186:187] op_sel:[0,0,0] op_sel_hi:[1,1,1]
    v_pk_fma_f32 v[156:157], v[116:117], v[104:105], v[156:157] op_sel:[0,0,0] op_sel_hi:[1,1,1]
    v_pk_fma_f32 v[158:159], v[118:119], v[106:107], v[158:159] op_sel:[0,0,0] op_sel_hi:[1,1,1]
    v_pk_fma_f32 v[160:161], v[120:121], v[104:105], v[160:161] op_sel:[0,0,0] op_sel_hi:[1,1,1]
    v_pk_fma_f32 v[162:163], v[122:123], v[106:107], v[162:163] op_sel:[0,0,0] op_sel_hi:[1,1,1]
    v_pk_fma_f32 v[164:165], v[124:125], v[104:105], v[164:165] op_sel:[0,0,0] op_sel_hi:[1,1,1]
    v_pk_fma_f32 v[166:167], v[126:127], v[106:107], v[166:167] op_sel:[0,0,0] op_sel_hi:[1,1,1]
    v_pk_fma_f32 v[168:169], v[128:129], v[104:105], v[168:169] op_sel:[0,0,0] op_sel_hi:[1,1,1]
    v_pk_fma_f32 v[170:171], v[130:131], v[106:107], v[170:171] op_sel:[0,0,0] op_sel_hi:[1,1,1]
    v_pk_fma_f32 v[172:173], v[132:133], v[104:105], v[172:173] op_sel:[0,0,0] op_sel_hi:[1,1,1]
    v_pk_fma_f32 v[174:175], v[134:135], v[106:107], v[174:175] op_sel:[0,0,0] op_sel_hi:[1,1,1]
    v_pk_fma_f32 v[176:177], v[136:137], v[104:105], v[176:177] op_sel:[0,0,0] op_sel_hi:[1,1,1]
    v_pk_fma_f32 v[178:179], v[138:139], v[106:107], v[178:179] op_sel:[0,0,0] op_sel_hi:[1,1,1]
    v_pk_fma_f32 v[180:181], v[140:141], v[104:105], v[180:181] op_sel:[0,0,0] op_sel_hi:[1,1,1]
    v_pk_fma_f32 v[182:183], v[142:143], v[106:107], v[182:183] op_sel:[0,0,0] op_sel_hi:[1,1,1]
    v_pk_fma_f32 v[184:185], v[144:145], v[104:105], v[184:185] op_sel:[0,0,0] op_sel_hi:[1,1,1]
    v_pk_fma_f32 v[186:187], v[146:147], v[106:107], v[186:187] op_sel:[0,0,0] op_sel_hi:[1,1,1]
    v_pk_fma_f32 v[156:157], v[112:113], v[108:109], v[156:157] op_sel:[0,0,0] op_sel_hi:[1,1,1]
    v_pk_fma_f32 v[158:159], v[114:115], v[110:111], v[158:159] op_sel:[0,0,0] op_sel_hi:[1,1,1]
    v_pk_fma_f32 v[160:161], v[116:117], v[108:109], v[160:161] op_sel:[0,0,0] op_sel_hi:[1,1,1]
    v_pk_fma_f32 v[162:163], v[118:119], v[110:111], v[162:163] op_sel:[0,0,0] op_sel_hi:[1,1,1]
    v_pk_fma_f32 v[164:165], v[120:121], v[108:109], v[164:165] op_sel:[0,0,0] op_sel_hi:[1,1,1]
    v_pk_fma_f32 v[166:167], v[122:123], v[110:111], v[166:167] op_sel:[0,0,0] op_sel_hi:[1,1,1]
    v_pk_fma_f32 v[168:169], v[124:125], v[108:109], v[168:169] op_sel:[0,0,0] op_sel_hi:[1,1,1]
    v_pk_fma_f32 v[170:171], v[126:127], v[110:111], v[170:171] op_sel:[0,0,0] op_sel_hi:[1,1,1]
    v_pk_fma_f32 v[172:173], v[128:129], v[108:109], v[172:173] op_sel:[0,0,0] op_sel_hi:[1,1,1]
    v_pk_fma_f32 v[174:175], v[130:131], v[110:111], v[174:175] op_sel:[0,0,0] op_sel_hi:[1,1,1]
    v_pk_fma_f32 v[176:177], v[132:133], v[108:109], v[176:177] op_sel:[0,0,0] op_sel_hi:[1,1,1]
    v_pk_fma_f32 v[178:179], v[134:135], v[110:111], v[178:179] op_sel:[0,0,0] op_sel_hi:[1,1,1]
    v_pk_fma_f32 v[180:181], v[136:137], v[108:109], v[180:181] op_sel:[0,0,0] op_sel_hi:[1,1,1]
    v_pk_fma_f32 v[182:183], v[138:139], v[110:111], v[182:183] op_sel:[0,0,0] op_sel_hi:[1,1,1]
    v_pk_fma_f32 v[184:185], v[140:141], v[108:109], v[184:185] op_sel:[0,0,0] op_sel_hi:[1,1,1]
    v_pk_fma_f32 v[186:187], v[142:143], v[110:111], v[186:187] op_sel:[0,0,0] op_sel_hi:[1,1,1]
    s_lshl_b32 s4, s3, 6
    s_sub_u32 s4, 104688, s4
    v_mul_u32_u24 v48, 272, v2
    v_add_u32 v48, s4, v48
    v_lshlrev_b32 v47, 4, v3
    v_sub_u32 v48, v48, v47
    s_waitcnt vmcnt(17)
    v_lshlrev_b32 v112, 16, v72
    v_and_b32 v113, 0xffff0000, v72
    v_lshlrev_b32 v114, 16, v73
    v_and_b32 v115, 0xffff0000, v73
    v_pk_mul_f32 v[156:157], v[156:157], v[112:113] op_sel:[0,0] op_sel_hi:[1,1]
    v_pk_mul_f32 v[158:159], v[158:159], v[114:115] op_sel:[0,0] op_sel_hi:[1,1]
    s_waitcnt vmcnt(16)
    v_lshlrev_b32 v116, 16, v74
    v_and_b32 v117, 0xffff0000, v74
    v_lshlrev_b32 v118, 16, v75
    v_and_b32 v119, 0xffff0000, v75
    v_pk_mul_f32 v[160:161], v[160:161], v[116:117] op_sel:[0,0] op_sel_hi:[1,1]
    v_pk_mul_f32 v[162:163], v[162:163], v[118:119] op_sel:[0,0] op_sel_hi:[1,1]
    s_waitcnt vmcnt(15)
    v_lshlrev_b32 v120, 16, v76
    v_and_b32 v121, 0xffff0000, v76
    v_lshlrev_b32 v122, 16, v77
    v_and_b32 v123, 0xffff0000, v77
    v_pk_mul_f32 v[164:165], v[164:165], v[120:121] op_sel:[0,0] op_sel_hi:[1,1]
    v_pk_mul_f32 v[166:167], v[166:167], v[122:123] op_sel:[0,0] op_sel_hi:[1,1]
    s_waitcnt vmcnt(14)
    v_lshlrev_b32 v124, 16, v78
    v_and_b32 v125, 0xffff0000, v78
    v_lshlrev_b32 v126, 16, v79
    v_and_b32 v127, 0xffff0000, v79
    v_pk_mul_f32 v[168:169], v[168:169], v[124:125] op_sel:[0,0] op_sel_hi:[1,1]
    v_pk_mul_f32 v[170:171], v[170:171], v[126:127] op_sel:[0,0] op_sel_hi:[1,1]
    s_waitcnt vmcnt(13)
    v_lshlrev_b32 v128, 16, v80
    v_and_b32 v129, 0xffff0000, v80
    v_lshlrev_b32 v130, 16, v81
    v_and_b32 v131, 0xffff0000, v81
    v_pk_mul_f32 v[172:173], v[172:173], v[128:129] op_sel:[0,0] op_sel_hi:[1,1]
    v_pk_mul_f32 v[174:175], v[174:175], v[130:131] op_sel:[0,0] op_sel_hi:[1,1]
    s_waitcnt vmcnt(12)
    v_lshlrev_b32 v132, 16, v82
    v_and_b32 v133, 0xffff0000, v82
    v_lshlrev_b32 v134, 16, v83
    v_and_b32 v135, 0xffff0000, v83
    v_pk_mul_f32 v[176:177], v[176:177], v[132:133] op_sel:[0,0] op_sel_hi:[1,1]
    v_pk_mul_f32 v[178:179], v[178:179], v[134:135] op_sel:[0,0] op_sel_hi:[1,1]
    s_waitcnt vmcnt(11)
    v_lshlrev_b32 v136, 16, v84
    v_and_b32 v137, 0xffff0000, v84
    v_lshlrev_b32 v138, 16, v85
    v_and_b32 v139, 0xffff0000, v85
    v_pk_mul_f32 v[180:181], v[180:181], v[136:137] op_sel:[0,0] op_sel_hi:[1,1]
    v_pk_mul_f32 v[182:183], v[182:183], v[138:139] op_sel:[0,0] op_sel_hi:[1,1]
    s_waitcnt vmcnt(10)
    v_lshlrev_b32 v140, 16, v86
    v_and_b32 v141, 0xffff0000, v86
    v_lshlrev_b32 v142, 16, v87
    v_and_b32 v143, 0xffff0000, v87
    v_pk_mul_f32 v[184:185], v[184:185], v[140:141] op_sel:[0,0] op_sel_hi:[1,1]
    v_pk_mul_f32 v[186:187], v[186:187], v[142:143] op_sel:[0,0] op_sel_hi:[1,1]
    v_cvt_pk_bf16_f32 v96, v184, v180
    v_cvt_pk_bf16_f32 v97, v176, v172
    v_cvt_pk_bf16_f32 v98, v168, v164
    v_cvt_pk_bf16_f32 v99, v160, v156
    v_and_b32 v99, -2, v99
    ds_write_b128 v48, v[96:99] offset:0
    v_cvt_pk_bf16_f32 v100, v185, v181
    v_cvt_pk_bf16_f32 v101, v177, v173
    v_cvt_pk_bf16_f32 v102, v169, v165
    v_cvt_pk_bf16_f32 v103, v161, v157
    v_and_b32 v103, -2, v103
    ds_write_b128 v48, v[100:103] offset:4352
    v_cvt_pk_bf16_f32 v104, v186, v182
    v_cvt_pk_bf16_f32 v105, v178, v174
    v_cvt_pk_bf16_f32 v106, v170, v166
    v_cvt_pk_bf16_f32 v107, v162, v158
    v_and_b32 v107, -2, v107
    ds_write_b128 v48, v[104:107] offset:8704
    v_cvt_pk_bf16_f32 v108, v187, v183
    v_cvt_pk_bf16_f32 v109, v179, v175
    v_cvt_pk_bf16_f32 v110, v171, v167
    v_cvt_pk_bf16_f32 v111, v163, v159
    v_and_b32 v111, -2, v111
    ds_write_b128 v48, v[108:111] offset:13056
    s_waitcnt lgkmcnt(0)
    s_barrier
    s_mul_i32 s4, s3, 4352
    s_add_u32 s4, s4, 104448
    v_mul_u32_u24 v48, 272, v3
    v_lshl_add_u32 v48, v2, 4, v48
    v_add_u32 v48, s4, v48
    ds_read_b128 v[156:159], v48 offset:0
    ds_read_b128 v[160:163], v48 offset:1088
    ds_read_b128 v[164:167], v48 offset:2176
    ds_read_b128 v[168:171], v48 offset:3264
    s_lshr_b32 s4, s42, 4
    s_lshl_b32 s4, s4, 6
    s_add_u32 s4, s4, s3
    s_lshl_b32 s4, s4, 12
    s_and_b32 s5, s42, 15
    s_lshl_b32 s5, s5, 8
    s_sub_u32 s4, s4, s5
    s_add_u32 s4, s4, 12586752
    v_lshl_add_u32 v46, v3, 14, s4
    v_lshl_add_u32 v46, v2, 4, v46
    s_waitcnt lgkmcnt(3)
    global_store_dwordx4 v46, v[156:159], s[38:39] sc1
    v_add_u32 v46, 65536, v46
    s_waitcnt lgkmcnt(2)
    global_store_dwordx4 v46, v[160:163], s[38:39] sc1
    v_add_u32 v46, 65536, v46
    s_waitcnt lgkmcnt(1)
    global_store_dwordx4 v46, v[164:167], s[38:39] sc1
    v_add_u32 v46, 65536, v46
    s_waitcnt lgkmcnt(0)
    global_store_dwordx4 v46, v[168:171], s[38:39] sc1
    v_and_b32 v220, 7, v1
    v_lshlrev_b32 v220, 2, v220
    v_mov_b32 v221, 1
    s_cmp_lg_u32 s3, 0
    s_cbranch_scc1 Ldb1
    global_load_dword v221, v220, s[36:37] sc1
Ldb1:
    s_waitcnt vmcnt(10)
    ds_read_b128 v[50:53], v37 offset:4288
    ds_read_b32 v49, v37 offset:4284
    ds_read_b128 v[58:61], v37 offset:5312
    ds_read_b32 v57, v37 offset:5308
    ds_read_b128 v[66:69], v37 offset:6336
    ds_read_b32 v65, v37 offset:6332
    ds_read_b128 v[74:77], v37 offset:7360
    ds_read_b32 v73, v37 offset:7356
    s_waitcnt lgkmcnt(6)
    v_alignbit_b32 v80, v50, v49, 16
    v_alignbit_b32 v81, v51, v50, 16
    v_alignbit_b32 v82, v52, v51, 16
    v_alignbit_b32 v83, v53, v52, 16
    ds_write_b128 v37, v[80:83] offset:64
    s_waitcnt lgkmcnt(5)
    v_alignbit_b32 v84, v58, v57, 16
    v_alignbit_b32 v85, v59, v58, 16
    v_alignbit_b32 v86, v60, v59, 16
    v_alignbit_b32 v87, v61, v60, 16
    ds_write_b128 v37, v[84:87] offset:1088
    s_waitcnt lgkmcnt(4)
    v_alignbit_b32 v88, v66, v65, 16
    v_alignbit_b32 v89, v67, v66, 16
    v_alignbit_b32 v90, v68, v67, 16
    v_alignbit_b32 v91, v69, v68, 16
    ds_write_b128 v37, v[88:91] offset:2112
    s_waitcnt lgkmcnt(3)
    v_alignbit_b32 v92, v74, v73, 16
    v_alignbit_b32 v93, v75, v74, 16
    v_alignbit_b32 v94, v76, v75, 16
    v_alignbit_b32 v95, v77, v76, 16
    ds_write_b128 v37, v[92:95] offset:3136
    ds_read_b64 a[0:1], v36 offset:8
    ds_read_b64 a[2:3], v36 offset:16
    ds_read_b64 a[4:5], v36 offset:72
    ds_read_b64 a[6:7], v36 offset:80
    ds_read_b64 a[8:9], v36 offset:136
    ds_read_b64 a[10:11], v36 offset:144
    ds_read_b64 a[12:13], v36 offset:200
    ds_read_b64 a[14:15], v36 offset:208
    ds_read_b64 a[16:17], v36 offset:264
    ds_read_b64 a[18:19], v36 offset:272
    ds_read_b64 a[20:21], v36 offset:328
    ds_read_b64 a[22:23], v36 offset:336
    ds_read_b64 a[24:25], v36 offset:392
    ds_read_b64 a[26:27], v36 offset:400
    ds_read_b64 a[28:29], v36 offset:456
    ds_read_b64 a[30:31], v36 offset:464
    ds_read_b64 a[32:33], v36 offset:520
    ds_read_b64 a[34:35], v36 offset:528
    ds_read_b64 a[36:37], v36 offset:584
    ds_read_b64 a[38:39], v36 offset:592
    ds_read_b64 a[40:41], v36 offset:648
    ds_read_b64 a[42:43], v36 offset:656
    ds_read_b64 a[44:45], v36 offset:712
    ds_read_b64 a[46:47], v36 offset:720
    ds_read_b64 a[48:49], v36 offset:776
    ds_read_b64 a[50:51], v36 offset:784
    ds_read_b64 a[52:53], v36 offset:840
    ds_read_b64 a[54:55], v36 offset:848
    ds_read_b64 a[56:57], v36 offset:904
    ds_read_b64 a[58:59], v36 offset:912
    ds_read_b64 a[60:61], v36 offset:968
    ds_read_b64 a[62:63], v36 offset:976
    ds_read_b64 a[64:65], v36 offset:1032
    ds_read_b64 a[66:67], v36 offset:1040
    ds_read_b64 a[68:69], v36 offset:1096
    ds_read_b64 a[70:71], v36 offset:1104
    ds_read_b64 a[72:73], v36 offset:1160
    ds_read_b64 a[74:75], v36 offset:1168
    ds_read_b64 a[76:77], v36 offset:1224
    ds_read_b64 a[78:79], v36 offset:1232
    ds_read_b64 a[80:81], v36 offset:1288
    ds_read_b64 a[82:83], v36 offset:1296
    ds_read_b64 a[84:85], v36 offset:1352
    ds_read_b64 a[86:87], v36 offset:1360
    ds_read_b64 a[88:89], v36 offset:1416
    ds_read_b64 a[90:91], v36 offset:1424
    ds_read_b64 a[92:93], v36 offset:1480
    ds_read_b64 a[94:95], v36 offset:1488
    s_mul_i32 s5, s3, 5152
    s_add_u32 s5, s5, 122880
    v_add_u32 v209, s5, v4
    v_lshrrev_b32 v210, 5, v1
    v_lshl_add_u32 v210, v210, 4, v209
    s_waitcnt vmcnt(8)
    ds_write_b128 v209, v[188:191] offset:0
    s_waitcnt vmcnt(7)
    ds_write_b128 v209, v[192:195] offset:1024
    s_waitcnt vmcnt(6)
    ds_write_b128 v210, v[196:199] offset:2048
    s_waitcnt vmcnt(5)
    ds_write_b128 v209, v[200:203] offset:3088
    s_waitcnt vmcnt(4)
    ds_write_b128 v209, v[204:207] offset:4112
    s_lshl_b32 s95, s42, 7
    s_add_u32 s95, s95, 77824
    v_max_u32 v44, 1, v2
    v_lshlrev_b32 v44, 7, v44
    v_xor_b32 v44, s95, v44
    s_add_u32 s4, s94, 12582912
    v_add_u32 v28, s4, v4
    s_mul_i32 s93, s3, 9280
    s_waitcnt vmcnt(0)
    v_cmp_eq_u32 vcc, 0, v221
    s_nop 0
    s_cbranch_vccnz Lic_r
Lic_ok:
    s_waitcnt lgkmcnt(0)
    s_barrier
    v_mov_b32 v29, s95
    s_cmp_lg_u32 s3, 0
    s_cbranch_scc1 Lkf_skip
    global_store_dword v29, v29, s[38:39] sc1
Lkf_skip:
    s_cmp_ge_u32 s42, 128
    s_cbranch_scc1 Lc_j2
    v_mul_u32_u24 v209, 2576, v211
    v_lshl_add_u32 v209, v212, 3, v209
    s_mul_i32 s5, s3, 320
    s_add_u32 s5, s5, 122880
    v_add_u32 v209, s5, v209
    ds_read2_b64 v[188:191], v209 offset0:0 offset1:160
    ds_read2_b64 v[192:195], v209 offset0:8 offset1:168
    ds_read2_b64 v[196:199], v209 offset0:16 offset1:176
    ds_read2_b64 v[200:203], v209 offset0:24 offset1:184
    ds_read2_b64 v[204:207], v209 offset0:32 offset1:192
    s_lshr_b32 s4, s42, 2
    s_mul_i32 s4, s4, 114688
    s_and_b32 s5, s42, 3
    s_lshl_b32 s5, s5, 7
    s_add_u32 s4, s4, s5
    s_mul_i32 s5, s3, 20480
    s_add_u32 s4, s4, s5
    s_add_u32 s4, s4, 1052672
    v_lshl_add_u32 v208, v212, 9, s4
    v_lshl_add_u32 v208, v211, 4, v208
    s_mov_b32 s7, 0x3f803f80
    v_mov_b32 v216, 0
    v_mov_b32 v217, 0
    v_mov_b32 v218, 0
    v_mov_b32 v219, 0
    s_waitcnt lgkmcnt(4)
    v_and_b32 v191, -2, v191
    global_store_dwordx4 v208, v[188:191], s[38:39] offset:-4096 sc1
    s_waitcnt lgkmcnt(2)
    v_and_b32 v195, -2, v195
    global_store_dwordx4 v208, v[192:195], s[38:39] offset:0 sc1
    v_add_u32 v208, 8192, v208
    v_and_b32 v199, -2, v199
    global_store_dwordx4 v208, v[196:199], s[38:39] offset:-4096 sc1
    s_waitcnt lgkmcnt(0)
    v_and_b32 v203, -2, v203
    global_store_dwordx4 v208, v[200:203], s[38:39] offset:0 sc1
    v_add_u32 v208, 8192, v208
    v_and_b32 v207, -2, v207
    global_store_dwordx4 v208, v[204:207], s[38:39] offset:-4096 sc1
    v_dot2_f32_bf16 v216, v188, s7, v216
    v_dot2_f32_bf16 v217, v188, v188, v217
    v_dot2_f32_bf16 v218, v190, s7, v218
    v_dot2_f32_bf16 v219, v190, v190, v219
    v_dot2_f32_bf16 v216, v189, s7, v216
    v_dot2_f32_bf16 v217, v189, v189, v217
    v_dot2_f32_bf16 v218, v191, s7, v218
    v_dot2_f32_bf16 v219, v191, v191, v219
    v_dot2_f32_bf16 v216, v192, s7, v216
    v_dot2_f32_bf16 v217, v192, v192, v217
    v_dot2_f32_bf16 v218, v194, s7, v218
    v_dot2_f32_bf16 v219, v194, v194, v219
    v_dot2_f32_bf16 v216, v193, s7, v216
    v_dot2_f32_bf16 v217, v193, v193, v217
    v_dot2_f32_bf16 v218, v195, s7, v218
    v_dot2_f32_bf16 v219, v195, v195, v219
    v_dot2_f32_bf16 v216, v196, s7, v216
    v_dot2_f32_bf16 v217, v196, v196, v217
    v_dot2_f32_bf16 v218, v198, s7, v218
    v_dot2_f32_bf16 v219, v198, v198, v219
    v_dot2_f32_bf16 v216, v197, s7, v216
    v_dot2_f32_bf16 v217, v197, v197, v217
    v_dot2_f32_bf16 v218, v199, s7, v218
    v_dot2_f32_bf16 v219, v199, v199, v219
    v_dot2_f32_bf16 v216, v200, s7, v216
    v_dot2_f32_bf16 v217, v200, v200, v217
    v_dot2_f32_bf16 v218, v202, s7, v218
    v_dot2_f32_bf16 v219, v202, v202, v219
    v_dot2_f32_bf16 v216, v201, s7, v216
    v_dot2_f32_bf16 v217, v201, v201, v217
    v_dot2_f32_bf16 v218, v203, s7, v218
    v_dot2_f32_bf16 v219, v203, v203, v219
    v_dot2_f32_bf16 v216, v204, s7, v216
    v_dot2_f32_bf16 v217, v204, v204, v217
    v_dot2_f32_bf16 v218, v206, s7, v218
    v_dot2_f32_bf16 v219, v206, v206, v219
    v_dot2_f32_bf16 v216, v205, s7, v216
    v_dot2_f32_bf16 v217, v205, v205, v217
    v_dot2_f32_bf16 v218, v207, s7, v218
    v_dot2_f32_bf16 v219, v207, v207, v219
    s_nop 1
    v_permlane32_swap_b32 v216, v218
    v_permlane32_swap_b32 v217, v219
    v_add_f32 v216, v216, v218
    v_add_f32 v217, v217, v219
    s_nop 1
    v_permlane16_swap_b32 v216, v217
    v_add_f32 v216, v216, v217
    v_lshlrev_b32 v209, 4, v211
    v_lshl_add_u32 v209, v3, 2, v209
    v_add_f32_dpp v216, v216, v216 row_ror:8 row_mask:0xf bank_mask:0xf
    s_lshl_b32 s5, s3, 7
    s_add_u32 s5, s5, 143616
    v_add_u32 v209, s5, v209
    ds_write_b32 v209, v216
    s_waitcnt vmcnt(5)
    s_branch Lc_j3
Lc_j2:
    s_waitcnt vmcnt(0)
Lc_j3:
    s_mov_b32 s95, 0
    ds_read_b64 a[96:97], v36 offset:1544
    ds_read_b64 a[98:99], v36 offset:1552
    ds_read_b64 a[100:101], v36 offset:1608
    ds_read_b64 a[102:103], v36 offset:1616
    ds_read_b64 a[104:105], v36 offset:1672
    ds_read_b64 a[106:107], v36 offset:1680
    ds_read_b64 a[108:109], v36 offset:1736
    ds_read_b64 a[110:111], v36 offset:1744
    ds_read_b64 a[112:113], v36 offset:1800
    ds_read_b64 a[114:115], v36 offset:1808
    ds_read_b64 a[116:117], v36 offset:1864
    ds_read_b64 a[118:119], v36 offset:1872
    ds_read_b64 a[120:121], v36 offset:1928
    ds_read_b64 a[122:123], v36 offset:1936
    ds_read_b64 a[124:125], v36 offset:1992
    ds_read_b64 a[126:127], v36 offset:2000
    ds_read_b64 a[128:129], v36 offset:2056
    ds_read_b64 a[130:131], v36 offset:2064
    ds_read_b64 a[132:133], v36 offset:2120
    ds_read_b64 a[134:135], v36 offset:2128
    ds_read_b64 a[136:137], v36 offset:2184
    ds_read_b64 a[138:139], v36 offset:2192
    ds_read_b64 a[140:141], v36 offset:2248
    ds_read_b64 a[142:143], v36 offset:2256
    ds_read_b64 a[144:145], v36 offset:2312
    ds_read_b64 a[146:147], v36 offset:2320
    ds_read_b64 a[148:149], v36 offset:2376
    ds_read_b64 a[150:151], v36 offset:2384
    ds_read_b64 a[152:153], v36 offset:2440
    ds_read_b64 a[154:155], v36 offset:2448
    ds_read_b64 a[156:157], v36 offset:2504
    ds_read_b64 a[158:159], v36 offset:2512
    ds_read_b64 a[160:161], v36 offset:2568
    ds_read_b64 a[162:163], v36 offset:2576
    ds_read_b64 a[164:165], v36 offset:2632
    ds_read_b64 a[166:167], v36 offset:2640
    ds_read_b64 a[168:169], v36 offset:2696
    ds_read_b64 a[170:171], v36 offset:2704
    ds_read_b64 a[172:173], v36 offset:2760
    ds_read_b64 a[174:175], v36 offset:2768
    ds_read_b64 a[176:177], v36 offset:2824
    ds_read_b64 a[178:179], v36 offset:2832
    ds_read_b64 a[180:181], v36 offset:2888
    ds_read_b64 a[182:183], v36 offset:2896
    ds_read_b64 a[184:185], v36 offset:2952
    ds_read_b64 a[186:187], v36 offset:2960
    ds_read_b64 a[188:189], v36 offset:3016
    ds_read_b64 a[190:191], v36 offset:3024
    ds_read_b64 a[192:193], v36 offset:3080
    ds_read_b64 a[194:195], v36 offset:3088
    ds_read_b64 a[196:197], v36 offset:3144
    ds_read_b64 a[198:199], v36 offset:3152
    ds_read_b64 a[200:201], v36 offset:3208
    ds_read_b64 a[202:203], v36 offset:3216
    ds_read_b64 a[204:205], v36 offset:3272
    ds_read_b64 a[206:207], v36 offset:3280
    ds_read_b64 a[208:209], v36 offset:3336
    ds_read_b64 a[210:211], v36 offset:3344
    ds_read_b64 a[212:213], v36 offset:3400
    ds_read_b64 a[214:215], v36 offset:3408
    ds_read_b64 a[216:217], v36 offset:3464
    ds_read_b64 a[218:219], v36 offset:3472
    ds_read_b64 a[220:221], v36 offset:3528
    ds_read_b64 a[222:223], v36 offset:3536
    ds_read_b64 a[224:225], v36 offset:3592
    ds_read_b64 a[226:227], v36 offset:3600
    ds_read_b64 a[228:229], v36 offset:3656
    ds_read_b64 a[230:231], v36 offset:3664
    ds_read_b64 a[232:233], v36 offset:3720
    ds_read_b64 a[234:235], v36 offset:3728
    ds_read_b64 a[236:237], v36 offset:3784
    ds_read_b64 a[238:239], v36 offset:3792
    global_load_dword v45, v44, s[38:39] sc1
    v_min_u32 v99, 49, v1
    v_cmp_lt_u32 vcc, 7, v99
    s_nop 1
    v_cndmask_b32_e64 v100, 0, 7, vcc
    v_add_lshl_u32 v99, v99, v100, 2
    v_mov_b32 v100, 1
    s_cmp_lg_u32 s3, 0
    s_cbranch_scc1 Ldb2
    global_load_dword v100, v99, s[36:37] sc1
Ldb2:
    ds_read_b64 a[240:241], v36 offset:3848
    ds_read_b64 a[242:243], v36 offset:3856
    ds_read_b64 a[244:245], v36 offset:3912
    ds_read_b64 a[246:247], v36 offset:3920
    ds_read_b64 a[248:249], v36 offset:3976
    ds_read_b64 a[250:251], v36 offset:3984
    ds_read_b64 a[252:253], v36 offset:4040
    ds_read_b64 a[254:255], v36 offset:4048
    s_and_b32 s4, s41, 1
    s_lshl_b32 s5, s3, 1
    s_add_u32 s5, s5, s4
    s_cmp_eq_u32 s5, 7
    s_cselect_b32 s5, 0, s5
    s_mul_i32 s96, s41, 7
    s_add_u32 s96, s96, s5
    s_cmp_lt_u32 s96, 54
    s_cselect_b32 s101, 2, 0
    s_min_u32 s96, s96, 53
    s_cmp_eq_u32 s3, 3
    s_cselect_b32 s101, 1, s101
    s_lshr_b32 s97, s101, 1
    s_cselect_b32 s5, -1, 0
    v_and_b32 v7, s5, v4
    s_add_u32 s97, s97, s96
    s_mul_i32 s4, s96, 20480
    s_add_u32 s5, s4, 7344128
    s_add_u32 s8, s38, s5
    s_addc_u32 s9, s39, 0
    s_add_u32 s5, s4, 7352320
    s_add_u32 s10, s38, s5
    s_addc_u32 s11, s39, 0
    s_add_u32 s5, s4, 7360512
    s_add_u32 s12, s38, s5
    s_addc_u32 s13, s39, 0
    s_mul_i32 s4, s97, 20480
    s_add_u32 s5, s4, 7344128
    s_add_u32 s14, s38, s5
    s_addc_u32 s15, s39, 0
    s_add_u32 s5, s4, 7352320
    s_add_u32 s16, s38, s5
    s_addc_u32 s17, s39, 0
    s_add_u32 s5, s4, 7360512
    s_add_u32 s18, s38, s5
    s_addc_u32 s19, s39, 0
    s_and_b32 s4, s41, 3
    s_cmp_eq_u32 s4, 0
    s_cselect_b32 s5, 8, 0
    s_cmp_le_u32 s4, 1
    s_cselect_b32 s6, 16, 8
    s_cmp_eq_u32 s4, 3
    s_cselect_b32 s50, 16, 24
    s_lshl_b32 s44, s4, 3
    s_bitcmp1_b32 s43, 0
    s_cselect_b32 s46, s6, s5
    s_cselect_b32 s48, s5, s6
    s_lshl_b32 s5, s3, 1
    s_add_u32 s44, s44, s5
    s_add_u32 s45, s44, 1
    s_add_u32 s46, s46, s5
    s_add_u32 s47, s46, 1
    s_add_u32 s48, s48, s5
    s_add_u32 s49, s48, 1
    s_add_u32 s50, s50, s5
    s_add_u32 s51, s50, 1
    s_lshl_b32 s5, s40, 18
    s_lshl_b32 s6, s44, 7
    s_add_u32 s6, s6, s5
    s_add_u32 s68, s24, s6
    s_addc_u32 s69, s25, 0
    s_lshl_b32 s6, s45, 7
    s_add_u32 s6, s6, s5
    s_add_u32 s70, s24, s6
    s_addc_u32 s71, s25, 0
    s_lshl_b32 s6, s46, 7
    s_add_u32 s6, s6, s5
    s_add_u32 s72, s24, s6
    s_addc_u32 s73, s25, 0
    s_lshl_b32 s6, s47, 7
    s_add_u32 s6, s6, s5
    s_add_u32 s74, s24, s6
    s_addc_u32 s75, s25, 0
    s_lshl_b32 s6, s48, 7
    s_add_u32 s6, s6, s5
    s_add_u32 s76, s24, s6
    s_addc_u32 s77, s25, 0
    s_lshl_b32 s6, s49, 7
    s_add_u32 s6, s6, s5
    s_add_u32 s78, s24, s6
    s_addc_u32 s79, s25, 0
    s_lshl_b32 s6, s50, 7
    s_add_u32 s6, s6, s5
    s_add_u32 s80, s24, s6
    s_addc_u32 s81, s25, 0
    s_lshl_b32 s6, s51, 7
    s_add_u32 s6, s6, s5
    s_add_u32 s82, s24, s6
    s_addc_u32 s83, s25, 0
    s_lshl_b32 s89, s3, 14
    s_add_u32 s89, s89, 83200
    s_waitcnt vmcnt(0) lgkmcnt(0)
    v_cmp_eq_u32 vcc, 0, v100
    s_nop 0
    s_cbranch_vccnz Lic2_r
Lic2_ok:
    s_barrier
    s_cmp_ge_u32 s42, 128
    s_cbranch_scc1 Lc_j5
    s_cmp_lg_u32 s3, 0
    s_cbranch_scc1 Lc_j5
    v_lshlrev_b32 v209, 3, v2
    v_add_u32 v210, 143616, v209
    ds_read_b64 v[220:221], v210 offset:0
    ds_read_b64 v[222:223], v210 offset:128
    ds_read_b64 v[224:225], v210 offset:256
    ds_read_b64 v[226:227], v210 offset:384
    s_waitcnt lgkmcnt(2)
    v_pk_add_f32 v[220:221], v[220:221], v[222:223] op_sel:[0,0] op_sel_hi:[1,1]
    s_waitcnt lgkmcnt(0)
    v_pk_add_f32 v[224:225], v[224:225], v[226:227] op_sel:[0,0] op_sel_hi:[1,1]
    v_pk_add_f32 v[220:221], v[220:221], v[224:225] op_sel:[0,0] op_sel_hi:[1,1]
    v_mul_f32 v220, 0x3acccccd, v220
    v_mul_f32 v221, 0x3acccccd, v221
    v_fma_f32 v221, -v220, v220, v221
    v_max_f32 v221, 0, v221
    v_add_f32 v221, 0x3727c5ac, v221
    v_rsq_f32 v222, v221
    s_nop 0
    v_mul_f32_e64 v221, -v220, v222
    v_mov_b32 v220, v222
    v_min_u32 v220, -2, v220
    v_min_u32 v221, -2, v221
    s_lshl_b32 s5, s42, 7
    s_add_u32 s5, s5, 32768
    v_add_u32 v209, s5, v209
    global_store_dwordx2 v209, v[220:221], s[38:39] sc1
Lc_j5:
    s_cmp_eq_u32 s95, 1
    s_cbranch_scc1 Lc_k2
    v_cmp_eq_u32 vcc, -1, v45
    s_nop 0
    s_cbranch_vccnz Lkf_r
Lkf_ok:
    s_add_u32 m0, s93, 33804
    s_nop 0
    global_load_lds_dwordx4 v28, s[38:39] offset:0 sc1
    global_load_lds_dwordx4 v28, s[38:39] offset:1024 sc1
    global_load_lds_dwordx4 v28, s[38:39] offset:2048 sc1
    global_load_lds_dwordx4 v28, s[38:39] offset:3072 sc1
    s_add_u32 m0, s93, 38448
    s_nop 0
    global_load_lds_dwordx4 v28, s[38:39] offset:0 sc1
    global_load_lds_dwordx4 v28, s[38:39] offset:1024 sc1
    global_load_lds_dwordx4 v28, s[38:39] offset:2048 sc1
    global_load_lds_dwordx4 v28, s[38:39] offset:3072 sc1
Lc_k2:
    v_bfe_u32 v235, v1, 3, 1
    s_sub_u32 s4, s97, s96
    v_mul_u32_u24 v235, s4, v235
    v_add_lshl_u32 v235, v235, s96, 7
    v_mul_u32_u24 v174, 7168, v3
    v_add_u32 v235, v235, v174
    v_and_b32 v174, 112, v4
    v_add_u32 v235, v235, v174
    v_add_u32 v235, 49152, v235
    v_and_b32 v45, 1, v3
    v_mul_u32_u24 v45, 7168, v45
    v_sub_u32 v45, v235, v45
    v_and_b32 v67, 7, v1
    v_lshl_add_u32 v67, v3, 3, v67
    v_bfe_u32 v69, v1, 3, 1
    v_lshlrev_b32 v66, 9, v69
    v_lshl_add_u32 v66, v67, 4, v66
    s_mul_i32 s4, s3, 20480
    s_mul_i32 s5, s40, 114688
    s_add_u32 s4, s4, s5
    s_add_u32 s4, s4, 1048576
    v_add_u32 v66, s4, v66
    v_lshl_add_u32 v70, v67, 1, v69
    v_min_u32 v72, 9, v1
    v_lshl_add_u32 v72, v72, 11, s4
    v_lshrrev_b32 v67, 5, v1
    v_bfe_u32 v68, v1, 1, 1
    v_lshl_add_u32 v67, v67, 1, v68
    v_mul_u32_u24 v68, 1040, v67
    v_bfe_u32 v67, v1, 3, 1
    v_lshl_add_u32 v68, v67, 3, v68
    v_bfe_u32 v67, v1, 2, 1
    v_lshl_add_u32 v68, v67, 6, v68
    v_bfe_u32 v67, v1, 4, 1
    v_lshl_add_u32 v68, v67, 7, v68
    v_bfe_u32 v67, v1, 0, 1
    v_lshl_add_u32 v68, v67, 5, v68
    s_mul_i32 s5, s3, 20800
    v_add_u32 v68, s5, v68
    v_lshlrev_b32 v30, 3, v1
    s_lshl_b32 s88, s3, 9
    v_lshrrev_b32 v67, 3, v1
    v_lshlrev_b32 v67, 12, v67
    v_bfe_u32 v69, v1, 4, 1
    v_xor_b32 v69, v69, v1
    v_and_b32 v69, 7, v69
    v_xor_b32 v74, 0, v69
    v_lshl_add_u32 v74, v74, 4, v67
    v_add_u32 v78, 131072, v74
    v_xor_b32 v75, 2, v69
    v_lshl_add_u32 v75, v75, 4, v67
    v_add_u32 v75, 31744, v75
    v_add_u32 v79, 131072, v75
    v_xor_b32 v76, 4, v69
    v_lshl_add_u32 v76, v76, 4, v67
    v_add_u32 v76, 63488, v76
    v_add_u32 v80, 131072, v76
    v_xor_b32 v77, 6, v69
    v_lshl_add_u32 v77, v77, 4, v67
    v_add_u32 v77, 95232, v77
    v_add_u32 v81, 131072, v77
    v_lshrrev_b32 v69, 1, v2
    v_xor_b32 v69, v69, v3
    v_lshlrev_b32 v69, 4, v69
    v_lshl_add_u32 v69, v5, 7, v69
    s_xor_b32 s4, s3, 0
    s_lshr_b32 s5, s4, 1
    s_lshl_b32 s5, s5, 12
    s_and_b32 s4, s4, 1
    s_lshl_b32 s4, s4, 9
    s_add_u32 s4, s4, s5
    s_add_u32 s4, s4, s89
    v_add_u32 v82, s4, v69
    v_xor_b32 v83, 64, v82
    s_xor_b32 s4, s3, 1
    s_lshr_b32 s5, s4, 1
    s_lshl_b32 s5, s5, 12
    s_and_b32 s4, s4, 1
    s_lshl_b32 s4, s4, 9
    s_add_u32 s4, s4, s5
    s_add_u32 s4, s4, s89
    v_add_u32 v84, s4, v69
    v_xor_b32 v85, 64, v84
    s_xor_b32 s4, s3, 2
    s_lshr_b32 s5, s4, 1
    s_lshl_b32 s5, s5, 12
    s_and_b32 s4, s4, 1
    s_lshl_b32 s4, s4, 9
    s_add_u32 s4, s4, s5
    s_add_u32 s4, s4, s89
    v_add_u32 v86, s4, v69
    v_xor_b32 v87, 64, v86
    s_xor_b32 s4, s3, 3
    s_lshr_b32 s5, s4, 1
    s_lshl_b32 s5, s5, 12
    s_and_b32 s4, s4, 1
    s_lshl_b32 s4, s4, 9
    s_add_u32 s4, s4, s5
    s_add_u32 s4, s4, s89
    v_add_u32 v88, s4, v69
    s_cmp_eq_u32 s95, 1
    s_cbranch_scc1 Lc_k3
    s_waitcnt vmcnt(0)
Lc_k3:
    ds_read_b128 v[122:125], v38 offset:3584
    ds_read_b128 v[126:129], v38 offset:3648
    s_waitcnt lgkmcnt(1)
    v_mfma_f32_16x16x32_bf16 v[90:93], a[0:3], v[122:125], 0
    ds_read_b128 v[130:133], v38 offset:3712
    v_xor_b32 v89, 64, v88
    v_mfma_f32_16x16x32_bf16 v[94:97], a[32:35], v[122:125], 0
    ds_read_b128 v[134:137], v38 offset:3776
    s_add_u32 s52, s8, 1146880
    s_addc_u32 s53, s9, 0
    v_mfma_f32_16x16x32_bf16 v[98:101], a[64:67], v[122:125], 0
    ds_read_b128 v[138:141], v38 offset:3840
    v_mfma_f32_16x16x32_bf16 v[102:105], a[96:99], v[122:125], 0
    s_add_u32 s54, s10, 1146880
    s_addc_u32 s55, s11, 0
    v_mfma_f32_16x16x32_bf16 v[106:109], a[128:131], v[122:125], 0
    v_mfma_f32_16x16x32_bf16 v[110:113], a[160:163], v[122:125], 0
    s_add_u32 s56, s12, 1146880
    s_addc_u32 s57, s13, 0
    s_waitcnt lgkmcnt(2)
    v_mfma_f32_16x16x32_bf16 v[90:93], a[4:7], v[126:129], v[90:93]
    ds_read_b128 v[142:145], v38 offset:3904
    v_mfma_f32_16x16x32_bf16 v[94:97], a[36:39], v[126:129], v[94:97]
    s_add_u32 s58, s14, 1146880
    s_addc_u32 s59, s15, 0
    v_mfma_f32_16x16x32_bf16 v[98:101], a[68:71], v[126:129], v[98:101]
    v_mfma_f32_16x16x32_bf16 v[102:105], a[100:103], v[126:129], v[102:105]
    s_add_u32 s60, s16, 1146880
    s_addc_u32 s61, s17, 0
    v_mfma_f32_16x16x32_bf16 v[106:109], a[132:135], v[126:129], v[106:109]
    v_mfma_f32_16x16x32_bf16 v[110:113], a[164:167], v[126:129], v[110:113]
    s_add_u32 s62, s18, 1146880
    s_addc_u32 s63, s19, 0
    v_mfma_f32_16x16x32_bf16 v[90:93], a[8:11], v[130:133], v[90:93]
    ds_read_b128 v[146:149], v38 offset:3968
    v_mfma_f32_16x16x32_bf16 v[94:97], a[40:43], v[130:133], v[94:97]
    s_mov_b32 s84, 0xc0135761
    v_mfma_f32_16x16x32_bf16 v[98:101], a[72:75], v[130:133], v[98:101]
    s_mov_b32 s85, 0xbdd2d3e8
    v_mfma_f32_16x16x32_bf16 v[102:105], a[104:107], v[130:133], v[102:105]
    v_lshlrev_b32 v32, 16, v27
    v_mfma_f32_16x16x32_bf16 v[106:109], a[136:139], v[130:133], v[106:109]
    v_lshlrev_b32 v33, 16, v27
    v_mfma_f32_16x16x32_bf16 v[110:113], a[168:171], v[130:133], v[110:113]
    v_lshlrev_b32 v34, 16, v27
    s_waitcnt lgkmcnt(0)
    v_mfma_f32_16x16x32_bf16 v[90:93], a[12:15], v[134:137], v[90:93]
    ds_read_b128 v[150:153], v38 offset:4032
    v_lshlrev_b32 v35, 16, v27
    v_mfma_f32_16x16x32_bf16 v[94:97], a[44:47], v[134:137], v[94:97]
    s_mul_i32 s5, s41, 10
    v_mfma_f32_16x16x32_bf16 v[98:101], a[76:79], v[134:137], v[98:101]
    s_mul_i32 s6, s3, 1040
    v_mfma_f32_16x16x32_bf16 v[102:105], a[108:111], v[134:137], v[102:105]
    v_add_u32 v67, s5, v3
    v_mfma_f32_16x16x32_bf16 v[106:109], a[140:143], v[134:137], v[106:109]
    v_lshrrev_b32 v69, 2, v67
    v_mfma_f32_16x16x32_bf16 v[110:113], a[172:175], v[134:137], v[110:113]
    v_mul_u32_u24 v69, 3136, v69
    v_mfma_f32_16x16x32_bf16 v[90:93], a[16:19], v[138:141], v[90:93]
    ds_read_b128 v[154:157], v38 offset:3072
    v_lshl_add_u32 v69, v67, 8, v69
    v_mfma_f32_16x16x32_bf16 v[94:97], a[48:51], v[138:141], v[94:97]
    v_lshl_add_u32 v69, v2, 4, v69
    v_mfma_f32_16x16x32_bf16 v[98:101], a[80:83], v[138:141], v[98:101]
    v_add_u32 v46, s6, v69
    v_mfma_f32_16x16x32_bf16 v[102:105], a[112:115], v[138:141], v[102:105]
    v_lshrrev_b32 v67, 1, v3
    v_mfma_f32_16x16x32_bf16 v[106:109], a[144:147], v[138:141], v[106:109]
    v_add_u32 v67, s5, v67
    v_mfma_f32_16x16x32_bf16 v[110:113], a[176:179], v[138:141], v[110:113]
    ds_read_b128 v[158:161], v38 offset:3136
    v_lshrrev_b32 v69, 2, v67
    v_mfma_f32_16x16x32_bf16 v[90:93], a[20:23], v[142:145], v[90:93]
    v_mul_u32_u24 v69, 3136, v69
    v_mfma_f32_16x16x32_bf16 v[94:97], a[52:55], v[142:145], v[94:97]
    v_lshl_add_u32 v69, v67, 8, v69
    v_mfma_f32_16x16x32_bf16 v[98:101], a[84:87], v[142:145], v[98:101]
    v_lshl_add_u32 v69, v2, 4, v69
    v_mfma_f32_16x16x32_bf16 v[102:105], a[116:119], v[142:145], v[102:105]
    v_add_u32 v47, s6, v69
    v_mfma_f32_16x16x32_bf16 v[106:109], a[148:151], v[142:145], v[106:109]
    ds_read_b128 v[122:125], v38 offset:3200
    v_and_b32 v67, 1, v3
    v_mfma_f32_16x16x32_bf16 v[110:113], a[180:183], v[142:145], v[110:113]
    v_lshl_add_u32 v47, v67, 3, v47
    v_mfma_f32_16x16x32_bf16 v[90:93], a[24:27], v[146:149], v[90:93]
    v_mov_b32 v166, 0
    v_mfma_f32_16x16x32_bf16 v[94:97], a[56:59], v[146:149], v[94:97]
    v_mov_b32 v167, 0
    v_mfma_f32_16x16x32_bf16 v[98:101], a[88:91], v[146:149], v[98:101]
    v_mov_b32 v168, 0
    v_mfma_f32_16x16x32_bf16 v[102:105], a[120:123], v[146:149], v[102:105]
    ds_read_b128 v[126:129], v38 offset:3264
    v_mov_b32 v169, 0
    v_mfma_f32_16x16x32_bf16 v[106:109], a[152:155], v[146:149], v[106:109]
    v_mfma_f32_16x16x32_bf16 v[110:113], a[184:187], v[146:149], v[110:113]
    s_min_u32 s5, s42, 127
    s_waitcnt lgkmcnt(1)
    v_mfma_f32_16x16x32_bf16 v[90:93], a[28:31], v[150:153], v[90:93]
    s_lshl_b32 s4, s5, 13
    v_mfma_f32_16x16x32_bf16 v[94:97], a[60:63], v[150:153], v[94:97]
    s_add_u32 s4, s4, 15208448
    v_mfma_f32_16x16x32_bf16 v[98:101], a[92:95], v[150:153], v[98:101]
    ds_read_b128 v[130:133], v38 offset:3328
    v_lshl_add_u32 v236, v0, 4, s4
    v_mfma_f32_16x16x32_bf16 v[102:105], a[124:127], v[150:153], v[102:105]
    v_mfma_f32_16x16x32_bf16 v[106:109], a[156:159], v[150:153], v[106:109]
    global_store_dwordx4 v236, v[166:169], s[38:39] offset:-4096 sc1
    v_mfma_f32_16x16x32_bf16 v[110:113], a[188:191], v[150:153], v[110:113]
    global_store_dwordx4 v236, v[166:169], s[38:39] offset:0 sc1
    v_mfma_f32_16x16x32_bf16 v[94:97], a[0:3], v[154:157], v[94:97]
    v_mov_b32 v162, -1
    v_mfma_f32_16x16x32_bf16 v[98:101], a[32:35], v[154:157], v[98:101]
    ds_read_b128 v[134:137], v38 offset:3392
    v_mov_b32 v163, -1
    v_mfma_f32_16x16x32_bf16 v[102:105], a[64:67], v[154:157], v[102:105]
    v_mfma_f32_16x16x32_bf16 v[106:109], a[96:99], v[154:157], v[106:109]
    v_mov_b32 v164, -1
    v_mfma_f32_16x16x32_bf16 v[110:113], a[128:131], v[154:157], v[110:113]
    v_mov_b32 v165, -1
    v_mfma_f32_16x16x32_bf16 v[94:97], a[4:7], v[158:161], v[94:97]
    s_lshr_b32 s4, s5, 2
    v_mfma_f32_16x16x32_bf16 v[98:101], a[36:39], v[158:161], v[98:101]
    ds_read_b128 v[138:141], v38 offset:3456
    s_mul_i32 s4, s4, 114688
    v_mfma_f32_16x16x32_bf16 v[102:105], a[68:71], v[158:161], v[102:105]
    v_mfma_f32_16x16x32_bf16 v[106:109], a[100:103], v[158:161], v[106:109]
    s_and_b32 s5, s5, 3
    v_mfma_f32_16x16x32_bf16 v[110:113], a[132:135], v[158:161], v[110:113]
    s_lshl_b32 s5, s5, 13
    v_mfma_f32_16x16x32_bf16 v[94:97], a[8:11], v[122:125], v[94:97]
    s_add_u32 s4, s4, s5
    v_mfma_f32_16x16x32_bf16 v[98:101], a[40:43], v[122:125], v[98:101]
    ds_read_b128 v[142:145], v38 offset:3520
    s_add_u32 s4, s4, 1134592
    v_mfma_f32_16x16x32_bf16 v[102:105], a[72:75], v[122:125], v[102:105]
    v_mfma_f32_16x16x32_bf16 v[106:109], a[104:107], v[122:125], v[106:109]
    v_lshl_add_u32 v236, v0, 4, s4
    v_mfma_f32_16x16x32_bf16 v[110:113], a[136:139], v[122:125], v[110:113]
    global_store_dwordx4 v236, v[162:165], s[38:39] offset:-4096 sc1
    s_waitcnt lgkmcnt(1)
    v_mfma_f32_16x16x32_bf16 v[94:97], a[12:15], v[126:129], v[94:97]
    global_store_dwordx4 v236, v[162:165], s[38:39] offset:0 sc1
    v_mfma_f32_16x16x32_bf16 v[98:101], a[44:47], v[126:129], v[98:101]
    ds_read_b128 v[146:149], v38 offset:2560
    s_min_u32 s4, s42, 127
    v_mfma_f32_16x16x32_bf16 v[102:105], a[76:79], v[126:129], v[102:105]
    v_mfma_f32_16x16x32_bf16 v[106:109], a[108:111], v[126:129], v[106:109]
    s_lshl_b32 s4, s4, 10
    v_mfma_f32_16x16x32_bf16 v[110:113], a[140:143], v[126:129], v[110:113]
    s_add_u32 s4, s4, 12451840
    v_mfma_f32_16x16x32_bf16 v[94:97], a[16:19], v[130:133], v[94:97]
    ds_read_b128 v[150:153], v38 offset:2624
    v_lshl_add_u32 v236, v0, 2, s4
    v_mfma_f32_16x16x32_bf16 v[98:101], a[48:51], v[130:133], v[98:101]
    global_store_dword v236, v162, s[38:39] sc1
    v_mfma_f32_16x16x32_bf16 v[102:105], a[80:83], v[130:133], v[102:105]
    v_mfma_f32_16x16x32_bf16 v[106:109], a[112:115], v[130:133], v[106:109]
    v_mfma_f32_16x16x32_bf16 v[110:113], a[144:147], v[130:133], v[110:113]
    ds_read_b128 v[154:157], v38 offset:2688
    v_mfma_f32_16x16x32_bf16 v[94:97], a[20:23], v[134:137], v[94:97]
    v_mfma_f32_16x16x32_bf16 v[98:101], a[52:55], v[134:137], v[98:101]
    v_mfma_f32_16x16x32_bf16 v[102:105], a[84:87], v[134:137], v[102:105]
    v_mfma_f32_16x16x32_bf16 v[106:109], a[116:119], v[134:137], v[106:109]
    ds_read_b128 v[158:161], v38 offset:2752
    v_mfma_f32_16x16x32_bf16 v[110:113], a[148:151], v[134:137], v[110:113]
    v_mfma_f32_16x16x32_bf16 v[94:97], a[24:27], v[138:141], v[94:97]
    v_mfma_f32_16x16x32_bf16 v[98:101], a[56:59], v[138:141], v[98:101]
    v_mfma_f32_16x16x32_bf16 v[102:105], a[88:91], v[138:141], v[102:105]
    ds_read_b128 v[122:125], v38 offset:2816
    v_mfma_f32_16x16x32_bf16 v[106:109], a[120:123], v[138:141], v[106:109]
    v_mfma_f32_16x16x32_bf16 v[110:113], a[152:155], v[138:141], v[110:113]
    s_waitcnt lgkmcnt(1)
    v_mfma_f32_16x16x32_bf16 v[94:97], a[28:31], v[142:145], v[94:97]
    v_mfma_f32_16x16x32_bf16 v[98:101], a[60:63], v[142:145], v[98:101]
    ds_read_b128 v[126:129], v38 offset:2880
    v_mfma_f32_16x16x32_bf16 v[102:105], a[92:95], v[142:145], v[102:105]
    v_mfma_f32_16x16x32_bf16 v[106:109], a[124:127], v[142:145], v[106:109]
    v_mfma_f32_16x16x32_bf16 v[110:113], a[156:159], v[142:145], v[110:113]
    v_mfma_f32_16x16x32_bf16 v[98:101], a[0:3], v[146:149], v[98:101]
    ds_read_b128 v[130:133], v38 offset:2944
    v_mfma_f32_16x16x32_bf16 v[102:105], a[32:35], v[146:149], v[102:105]
    v_mfma_f32_16x16x32_bf16 v[106:109], a[64:67], v[146:149], v[106:109]
    v_mfma_f32_16x16x32_bf16 v[110:113], a[96:99], v[146:149], v[110:113]
    v_mfma_f32_16x16x32_bf16 v[98:101], a[4:7], v[150:153], v[98:101]
    ds_read_b128 v[134:137], v38 offset:3008
    v_cvt_pk_bf16_f32 v48, v90, v91
    v_mfma_f32_16x16x32_bf16 v[102:105], a[36:39], v[150:153], v[102:105]
    v_cvt_pk_bf16_f32 v49, v92, v93
    v_mfma_f32_16x16x32_bf16 v[106:109], a[68:71], v[150:153], v[106:109]
    ds_write2_b32 v40, v48, v49 offset0:0 offset1:2
    v_mfma_f32_16x16x32_bf16 v[110:113], a[100:103], v[150:153], v[110:113]
    v_cvt_pk_bf16_f32 v50, v94, v95
    v_mfma_f32_16x16x32_bf16 v[98:101], a[8:11], v[154:157], v[98:101]
    ds_read_b128 v[138:141], v38 offset:2048
    v_cvt_pk_bf16_f32 v51, v96, v97
    v_mfma_f32_16x16x32_bf16 v[102:105], a[40:43], v[154:157], v[102:105]
    ds_write2_b32 v40, v50, v51 offset0:128 offset1:130
    v_mfma_f32_16x16x32_bf16 v[106:109], a[72:75], v[154:157], v[106:109]
    v_add_u32 v40, 4224, v40
    v_mfma_f32_16x16x32_bf16 v[110:113], a[104:107], v[154:157], v[110:113]
    ds_read_b128 v[142:145], v38 offset:2112
    v_mfma_f32_16x16x32_bf16 v[98:101], a[12:15], v[158:161], v[98:101]
    v_lshlrev_b32 v28, 4, v0
    s_waitcnt lgkmcnt(1)
    s_barrier
    v_mfma_f32_16x16x32_bf16 v[102:105], a[44:47], v[158:161], v[102:105]
    v_add_u32 v28, 36864, v28
    global_load_dwordx4 v[214:217], v28, s[38:39] offset:-4096 sc1
    v_mfma_f32_16x16x32_bf16 v[106:109], a[76:79], v[158:161], v[106:109]
    ds_read_b128 v[146:149], v38 offset:2176
    global_load_dwordx4 v[218:221], v28, s[38:39] offset:0 sc1
    v_mfma_f32_16x16x32_bf16 v[110:113], a[108:111], v[158:161], v[110:113]
    v_add_u32 v28, 8192, v28
    ds_read_b32 v52, v41 offset:0
    v_mfma_f32_16x16x32_bf16 v[98:101], a[16:19], v[122:125], v[98:101]
    global_load_dwordx4 v[222:225], v28, s[38:39] offset:-4096 sc1
    ds_read_b32 v53, v41 offset:1056
    v_mfma_f32_16x16x32_bf16 v[102:105], a[48:51], v[122:125], v[102:105]
    ds_read_b128 v[150:153], v38 offset:2240
    global_load_dwordx4 v[226:229], v28, s[38:39] offset:0 sc1
    v_mfma_f32_16x16x32_bf16 v[106:109], a[80:83], v[122:125], v[106:109]
    v_min_u32 v28, 11, v1
    v_lshrrev_b32 v29, 2, v28
    v_mfma_f32_16x16x32_bf16 v[110:113], a[112:115], v[122:125], v[110:113]
    v_mul_u32_u24 v29, 2544, v29
    ds_read_b32 v54, v41 offset:2112
    v_mfma_f32_16x16x32_bf16 v[98:101], a[20:23], v[126:129], v[98:101]
    ds_read_b128 v[154:157], v38 offset:2304
    v_lshl_add_u32 v28, v28, 2, v29
    s_lshl_b32 s4, s42, 4
    v_mfma_f32_16x16x32_bf16 v[102:105], a[52:55], v[126:129], v[102:105]
    ds_read_b32 v55, v41 offset:3168
    ds_read_b32 v56, v39 offset:3072
    s_add_u32 s4, s4, 0
    v_mfma_f32_16x16x32_bf16 v[106:109], a[84:87], v[126:129], v[106:109]
    v_add_u32 v28, s4, v28
    ds_read_b32 v57, v39 offset:12352
    v_mfma_f32_16x16x32_bf16 v[110:113], a[116:119], v[126:129], v[110:113]
    ds_read_b128 v[158:161], v38 offset:2368
    global_load_dword v64, v28, s[38:39] sc1
    v_mfma_f32_16x16x32_bf16 v[98:101], a[24:27], v[130:133], v[98:101]
    v_add_u32 v28, 15360, v28
    global_load_dword v65, v28, s[38:39] sc1
    v_mfma_f32_16x16x32_bf16 v[102:105], a[56:59], v[130:133], v[102:105]
    ds_read_b32 v58, v39 offset:21632
    ds_read_b32 v59, v39 offset:30912
    v_mfma_f32_16x16x32_bf16 v[106:109], a[88:91], v[130:133], v[106:109]
    ds_read_b128 v[122:125], v38 offset:2432
    s_waitcnt lgkmcnt(5)
    v_lshlrev_b32 v90, 16, v52
    v_mfma_f32_16x16x32_bf16 v[110:113], a[120:123], v[130:133], v[110:113]
    v_and_b32 v94, 0xffff0000, v52
    v_lshlrev_b32 v91, 16, v53
    v_mfma_f32_16x16x32_bf16 v[98:101], a[28:31], v[134:137], v[98:101]
    v_and_b32 v95, 0xffff0000, v53
    v_lshlrev_b32 v92, 16, v54
    v_mfma_f32_16x16x32_bf16 v[102:105], a[60:63], v[134:137], v[102:105]
    ds_read_b128 v[126:129], v38 offset:2496
    v_and_b32 v96, 0xffff0000, v54
    v_mfma_f32_16x16x32_bf16 v[106:109], a[92:95], v[134:137], v[106:109]
    v_lshlrev_b32 v93, 16, v55
    v_mfma_f32_16x16x32_bf16 v[110:113], a[124:127], v[134:137], v[110:113]
    v_and_b32 v97, 0xffff0000, v55
    v_mfma_f32_16x16x32_bf16 v[102:105], a[0:3], v[138:141], v[102:105]
    ds_read_b128 v[130:133], v38 offset:1536
    global_load_dword v234, v45, s[38:39] sc1
    v_mfma_f32_16x16x32_bf16 v[106:109], a[32:35], v[138:141], v[106:109]
    v_and_b32 v194, 0xffff0000, v56
    s_waitcnt lgkmcnt(2)
    v_and_b32 v195, 0xffff0000, v57
    v_mfma_f32_16x16x32_bf16 v[110:113], a[64:67], v[138:141], v[110:113]
    ds_read_b128 v[134:137], v38 offset:1600
    v_and_b32 v196, 0xffff0000, v58
    v_mfma_f32_16x16x32_bf16 v[102:105], a[4:7], v[142:145], v[102:105]
    v_mfma_f32_16x16x32_bf16 v[106:109], a[36:39], v[142:145], v[106:109]
    ds_read_b128 v[138:141], v38 offset:1664
    v_and_b32 v197, 0xffff0000, v59
    v_mfma_f32_16x16x32_bf16 v[110:113], a[68:71], v[142:145], v[110:113]
    v_fmac_f32 v90, s20, v194
    v_mfma_f32_16x16x32_bf16 v[102:105], a[8:11], v[146:149], v[102:105]
    ds_read_b128 v[142:145], v38 offset:1728
    v_fmac_f32 v91, s21, v195
    v_mfma_f32_16x16x32_bf16 v[106:109], a[40:43], v[146:149], v[106:109]
    v_fmac_f32 v92, s22, v196
    v_mfma_f32_16x16x32_bf16 v[110:113], a[72:75], v[146:149], v[110:113]
    ds_read_b128 v[146:149], v38 offset:1792
    v_fmac_f32 v93, s23, v197
    v_mfma_f32_16x16x32_bf16 v[102:105], a[12:15], v[150:153], v[102:105]
    v_lshlrev_b32 v194, 16, v56
    v_mfma_f32_16x16x32_bf16 v[106:109], a[44:47], v[150:153], v[106:109]
    v_lshlrev_b32 v195, 16, v57
    v_mfma_f32_16x16x32_bf16 v[110:113], a[76:79], v[150:153], v[110:113]
    ds_read_b128 v[150:153], v38 offset:1856
    v_mfma_f32_16x16x32_bf16 v[102:105], a[16:19], v[154:157], v[102:105]
    v_lshlrev_b32 v196, 16, v58
    v_mfma_f32_16x16x32_bf16 v[106:109], a[48:51], v[154:157], v[106:109]
    v_lshlrev_b32 v197, 16, v59
    v_mfma_f32_16x16x32_bf16 v[110:113], a[80:83], v[154:157], v[110:113]
    ds_read_b128 v[154:157], v38 offset:1920
    v_fmac_f32 v94, s20, v194
    v_mfma_f32_16x16x32_bf16 v[102:105], a[20:23], v[158:161], v[102:105]
    v_fmac_f32 v95, s21, v195
    v_mfma_f32_16x16x32_bf16 v[106:109], a[52:55], v[158:161], v[106:109]
    v_fmac_f32 v96, s22, v196
    v_mfma_f32_16x16x32_bf16 v[110:113], a[84:87], v[158:161], v[110:113]
    ds_read_b128 v[158:161], v38 offset:1984
    v_fmac_f32 v97, s23, v197
    v_mfma_f32_16x16x32_bf16 v[102:105], a[24:27], v[122:125], v[102:105]
    v_mfma_f32_16x16x32_bf16 v[106:109], a[56:59], v[122:125], v[106:109]
    v_mfma_f32_16x16x32_bf16 v[110:113], a[88:91], v[122:125], v[110:113]
    ds_read_b128 v[122:125], v38 offset:1024
    s_waitcnt lgkmcnt(2)
    v_mfma_f32_16x16x32_bf16 v[102:105], a[28:31], v[126:129], v[102:105]
    v_mfma_f32_16x16x32_bf16 v[106:109], a[60:63], v[126:129], v[106:109]
    v_mfma_f32_16x16x32_bf16 v[110:113], a[92:95], v[126:129], v[110:113]
    ds_read_b128 v[126:129], v38 offset:1088
    v_mfma_f32_16x16x32_bf16 v[106:109], a[0:3], v[130:133], v[106:109]
    s_waitcnt vmcnt(6)
    v_max_u32 v236, v215, v217
    s_waitcnt vmcnt(5)
    v_max3_u32 v236, v219, v221, v236
    v_mfma_f32_16x16x32_bf16 v[110:113], a[32:35], v[130:133], v[110:113]
    ds_read_b128 v[130:133], v38 offset:1152
    s_waitcnt vmcnt(4)
    v_max3_u32 v236, v223, v225, v236
    v_mfma_f32_16x16x32_bf16 v[106:109], a[4:7], v[134:137], v[106:109]
    s_waitcnt vmcnt(3)
    v_max3_u32 v236, v227, v229, v236
    s_waitcnt vmcnt(1)
    v_max3_u32 v236, v64, v65, v236
    v_mfma_f32_16x16x32_bf16 v[110:113], a[36:39], v[134:137], v[110:113]
    ds_read_b128 v[134:137], v38 offset:1216
    v_cmp_eq_u32 vcc, -1, v236
    v_mfma_f32_16x16x32_bf16 v[106:109], a[8:11], v[138:141], v[106:109]
    v_cvt_pk_bf16_f32 v48, v98, v99
    s_cbranch_vccnz Lax_r
Lax_ok:
    v_cvt_pk_bf16_f32 v49, v100, v101
    v_mfma_f32_16x16x32_bf16 v[110:113], a[40:43], v[138:141], v[110:113]
    ds_read_b128 v[138:141], v38 offset:1280
    v_add_u32 v42, 0, v43
    v_mfma_f32_16x16x32_bf16 v[106:109], a[12:15], v[142:145], v[106:109]
    ds_write2_b32 v40, v48, v49 offset0:0 offset1:2
    global_load_dwordx4 v[198:201], v42, s[38:39] sc1
    v_mfma_f32_16x16x32_bf16 v[110:113], a[44:47], v[142:145], v[110:113]
    ds_read_b128 v[142:145], v38 offset:1344
    v_cvt_pk_bf16_f32 v50, v102, v103
    v_mfma_f32_16x16x32_bf16 v[106:109], a[16:19], v[146:149], v[106:109]
    v_add_u32 v42, 917504, v43
    v_cvt_pk_bf16_f32 v51, v104, v105
    v_mfma_f32_16x16x32_bf16 v[110:113], a[48:51], v[146:149], v[110:113]
    ds_read_b128 v[146:149], v38 offset:1408
    global_load_dwordx4 v[202:205], v42, s[38:39] sc1
    v_mfma_f32_16x16x32_bf16 v[106:109], a[20:23], v[150:153], v[106:109]
    ds_write2_b32 v40, v50, v51 offset0:128 offset1:130
    v_add_u32 v42, 1835008, v43
    v_mfma_f32_16x16x32_bf16 v[110:113], a[52:55], v[150:153], v[110:113]
    ds_read_b128 v[150:153], v38 offset:1472
    v_add_u32 v40, 4224, v40
    v_mfma_f32_16x16x32_bf16 v[106:109], a[24:27], v[154:157], v[106:109]
    global_load_dwordx4 v[206:209], v42, s[38:39] sc1
    ds_read_b32 v56, v39 offset:2048
    v_mfma_f32_16x16x32_bf16 v[110:113], a[56:59], v[154:157], v[110:113]
    ds_read_b128 v[154:157], v38 offset:3584
    v_add_u32 v42, 2752512, v43
    s_waitcnt lgkmcnt(5)
    v_mfma_f32_16x16x32_bf16 v[106:109], a[28:31], v[158:161], v[106:109]
    ds_read_b32 v57, v39 offset:11328
    global_load_dwordx4 v[210:213], v42, s[38:39] sc1
    v_mfma_f32_16x16x32_bf16 v[110:113], a[60:63], v[158:161], v[110:113]
    ds_read_b128 v[158:161], v38 offset:3648
    ds_read_b32 v58, v39 offset:20608
    v_mfma_f32_16x16x32_bf16 v[110:113], a[0:3], v[122:125], v[110:113]
    ds_read_b128 v[122:125], v38 offset:3712
    v_add_f32 v64, v64, v65
    v_mfma_f32_16x16x32_bf16 v[110:113], a[4:7], v[126:129], v[110:113]
    ds_read_b128 v[126:129], v38 offset:3776
    ds_read_b32 v59, v39 offset:29888
    v_mfma_f32_16x16x32_bf16 v[110:113], a[8:11], v[130:133], v[110:113]
    ds_read_b128 v[130:133], v38 offset:3840
    v_cvt_pk_bf16_f32 v64, v64, v64
    v_lshlrev_b32 v64, 16, v64
    v_mfma_f32_16x16x32_bf16 v[110:113], a[12:15], v[134:137], v[110:113]
    ds_read_b128 v[134:137], v38 offset:3904
    v_mov_b32 v29, 1.0
    s_nop 1
    v_add_f32_dpp v64, v64, v29 quad_perm:[0,1,2,3] row_mask:0xf bank_mask:0x2
    v_cvt_pk_bf16_f32 v64, v64, v64
    v_mfma_f32_16x16x32_bf16 v[110:113], a[16:19], v[138:141], v[110:113]
    ds_read_b128 v[138:141], v38 offset:3968
    s_waitcnt lgkmcnt(6)
    s_barrier
    v_lshlrev_b32 v64, 16, v64
    s_nop 1
    v_mul_f32_dpp v65, v64, v64 row_shl:8 row_mask:0xf bank_mask:0x1
    s_nop 1
    v_mul_f32_dpp v65, v64, v64 row_shl:4 row_mask:0xf bank_mask:0x2
    v_mfma_f32_16x16x32_bf16 v[110:113], a[20:23], v[142:145], v[110:113]
    ds_read_b128 v[142:145], v38 offset:4032
    ds_read_b32 v52, v41 offset:4224
    v_readlane_b32 s32, v65, 0
    v_readlane_b32 s33, v65, 1
    v_readlane_b32 s86, v65, 2
    v_mfma_f32_16x16x32_bf16 v[110:113], a[24:27], v[146:149], v[110:113]
    ds_read_b128 v[146:149], v38 offset:3072
    ds_read_b32 v53, v41 offset:5280
    ds_read_b32 v54, v41 offset:6336
    ds_read_b32 v55, v41 offset:7392
    v_readlane_b32 s87, v65, 3
    v_readlane_b32 s64, v65, 4
    v_readlane_b32 s65, v65, 5
    v_mfma_f32_16x16x32_bf16 v[110:113], a[28:31], v[150:153], v[110:113]
    ds_read_b128 v[150:153], v38 offset:3136
    s_waitcnt lgkmcnt(5)
    v_lshlrev_b32 v98, 16, v52
    v_and_b32 v102, 0xffff0000, v52
    s_waitcnt lgkmcnt(3)
    v_lshlrev_b32 v99, 16, v53
    v_readlane_b32 s66, v65, 6
    v_readlane_b32 s67, v65, 7
    v_mov_b32 v60, s32
    v_mfma_f32_16x16x32_bf16 v[118:121], a[224:227], v[154:157], 0
    v_mov_b32 v61, s33
    v_mov_b32 v62, s86
    v_mov_b32 v63, s87
    v_and_b32 v103, 0xffff0000, v53
    s_waitcnt lgkmcnt(2)
    v_lshlrev_b32 v100, 16, v54
    v_and_b32 v104, 0xffff0000, v54
    v_mfma_f32_16x16x32_bf16 v[114:117], a[192:195], v[154:157], 0
    ds_read_b128 v[154:157], v38 offset:3200
    s_waitcnt lgkmcnt(2)
    v_lshlrev_b32 v101, 16, v55
    v_and_b32 v105, 0xffff0000, v55
    v_and_b32 v194, 0xffff0000, v56
    v_mfma_f32_16x16x32_bf16 v[118:121], a[228:231], v[158:161], v[118:121]
    v_and_b32 v195, 0xffff0000, v57
    v_and_b32 v196, 0xffff0000, v58
    v_and_b32 v197, 0xffff0000, v59
    v_mfma_f32_16x16x32_bf16 v[114:117], a[196:199], v[158:161], v[114:117]
    ds_read_b128 v[158:161], v38 offset:3264
    v_fmac_f32 v98, s20, v194
    v_fmac_f32 v99, s21, v195
    v_fmac_f32 v100, s22, v196
    v_mfma_f32_16x16x32_bf16 v[118:121], a[232:235], v[122:125], v[118:121]
    s_waitcnt vmcnt(4)
    v_cmp_eq_u32 vcc, -1, v234
    v_fmac_f32 v101, s23, v197
    v_lshlrev_b32 v194, 16, v56
    v_lshlrev_b32 v195, 16, v57
    v_mfma_f32_16x16x32_bf16 v[114:117], a[200:203], v[122:125], v[114:117]
    ds_read_b128 v[122:125], v38 offset:3328
    s_barrier
    v_lshlrev_b32 v196, 16, v58
    v_lshlrev_b32 v197, 16, v59
    v_fmac_f32 v102, s20, v194
    v_mfma_f32_16x16x32_bf16 v[118:121], a[236:239], v[126:129], v[118:121]
    v_fmac_f32 v103, s21, v195
    v_fmac_f32 v104, s22, v196
    v_fmac_f32 v105, s23, v197
    v_mfma_f32_16x16x32_bf16 v[114:117], a[204:207], v[126:129], v[114:117]
    ds_read_b128 v[126:129], v38 offset:3392
    s_cbranch_vccnz Lcu_r
Lcu_ok:
    s_add_u32 m0, s89, 0
    v_mfma_f32_16x16x32_bf16 v[118:121], a[240:243], v[130:133], v[118:121]
    v_cvt_pk_bf16_f32 v48, v106, v107
    v_cvt_pk_bf16_f32 v49, v108, v109
    v_mfma_f32_16x16x32_bf16 v[114:117], a[208:211], v[130:133], v[114:117]
    ds_read_b128 v[130:133], v38 offset:3456
    ds_write2_b32 v40, v48, v49 offset0:0 offset1:2
    v_mfma_f32_16x16x32_bf16 v[118:121], a[244:247], v[134:137], v[118:121]
    global_load_lds_dwordx4 v74, s[68:69] offset:0
    v_cvt_pk_bf16_f32 v50, v110, v111
    v_mfma_f32_16x16x32_bf16 v[114:117], a[212:215], v[134:137], v[114:117]
    ds_read_b128 v[134:137], v38 offset:3520
    v_cvt_pk_bf16_f32 v51, v112, v113
    v_mfma_f32_16x16x32_bf16 v[118:121], a[248:251], v[138:141], v[118:121]
    ds_write2_b32 v40, v50, v51 offset0:128 offset1:130
    v_add_u32 v40, 4224, v40
    v_mfma_f32_16x16x32_bf16 v[114:117], a[216:219], v[138:141], v[114:117]
    ds_read_b128 v[138:141], v38 offset:2560
    global_load_lds_dwordx4 v75, s[68:69] offset:1024
    v_mfma_f32_16x16x32_bf16 v[118:121], a[252:255], v[142:145], v[118:121]
    ds_read_b32 v56, v39 offset:1024
    ds_read_b32 v57, v39 offset:10304
    v_mfma_f32_16x16x32_bf16 v[114:117], a[220:223], v[142:145], v[114:117]
    ds_read_b128 v[142:145], v38 offset:2624
    ds_read_b32 v58, v39 offset:19584
    v_mfma_f32_16x16x32_bf16 v[118:121], a[192:195], v[146:149], v[118:121]
    ds_read_b32 v59, v39 offset:28864
    global_load_lds_dwordx4 v76, s[68:69] offset:2048
    v_mfma_f32_16x16x32_bf16 v[114:117], a[160:163], v[146:149], v[114:117]
    ds_read_b128 v[146:149], v38 offset:2688
    s_waitcnt lgkmcnt(7)
    s_barrier
    v_mfma_f32_16x16x32_bf16 v[118:121], a[196:199], v[150:153], v[118:121]
    ds_read_b32 v52, v41 offset:8448
    ds_read_b32 v53, v41 offset:9504
    v_mfma_f32_16x16x32_bf16 v[114:117], a[164:167], v[150:153], v[114:117]
    ds_read_b128 v[150:153], v38 offset:2752
    ds_read_b32 v54, v41 offset:10560
    v_mfma_f32_16x16x32_bf16 v[118:121], a[200:203], v[154:157], v[118:121]
    global_load_lds_dwordx4 v77, s[68:69] offset:3072
    ds_read_b32 v55, v41 offset:11616
    s_add_u32 m0, s89, 4096
    v_mfma_f32_16x16x32_bf16 v[114:117], a[168:171], v[154:157], v[114:117]
    ds_read_b128 v[154:157], v38 offset:2816
    s_waitcnt lgkmcnt(5)
    v_lshlrev_b32 v106, 16, v52
    v_mfma_f32_16x16x32_bf16 v[118:121], a[204:207], v[158:161], v[118:121]
    v_and_b32 v110, 0xffff0000, v52
    s_waitcnt lgkmcnt(4)
    v_lshlrev_b32 v107, 16, v53
    v_mfma_f32_16x16x32_bf16 v[114:117], a[172:175], v[158:161], v[114:117]
    ds_read_b128 v[158:161], v38 offset:2880
    v_and_b32 v111, 0xffff0000, v53
    v_mfma_f32_16x16x32_bf16 v[118:121], a[208:211], v[122:125], v[118:121]
    s_waitcnt lgkmcnt(3)
    v_lshlrev_b32 v108, 16, v54
    v_and_b32 v112, 0xffff0000, v54
    v_mfma_f32_16x16x32_bf16 v[114:117], a[176:179], v[122:125], v[114:117]
    ds_read_b128 v[122:125], v38 offset:2944
    s_waitcnt lgkmcnt(3)
    v_lshlrev_b32 v109, 16, v55
    v_mfma_f32_16x16x32_bf16 v[118:121], a[212:215], v[126:129], v[118:121]
    v_and_b32 v113, 0xffff0000, v55
    global_load_lds_dwordx4 v78, s[68:69] offset:0
    v_mfma_f32_16x16x32_bf16 v[114:117], a[180:183], v[126:129], v[114:117]
    ds_read_b128 v[126:129], v38 offset:3008
    v_and_b32 v194, 0xffff0000, v56
    v_mfma_f32_16x16x32_bf16 v[118:121], a[216:219], v[130:133], v[118:121]
    v_and_b32 v195, 0xffff0000, v57
    v_and_b32 v196, 0xffff0000, v58
    v_mfma_f32_16x16x32_bf16 v[114:117], a[184:187], v[130:133], v[114:117]
    ds_read_b128 v[130:133], v38 offset:2048
    v_and_b32 v197, 0xffff0000, v59
    v_mfma_f32_16x16x32_bf16 v[118:121], a[220:223], v[134:137], v[118:121]
    global_load_lds_dwordx4 v79, s[68:69] offset:1024
    v_fmac_f32 v106, s20, v194
    v_mfma_f32_16x16x32_bf16 v[114:117], a[188:191], v[134:137], v[114:117]
    ds_read_b128 v[134:137], v38 offset:2112
    v_fmac_f32 v107, s21, v195
    v_mfma_f32_16x16x32_bf16 v[118:121], a[160:163], v[138:141], v[118:121]
    v_fmac_f32 v108, s22, v196
    v_fmac_f32 v109, s23, v197
    v_mfma_f32_16x16x32_bf16 v[114:117], a[128:131], v[138:141], v[114:117]
    ds_read_b128 v[138:141], v38 offset:2176
    v_lshlrev_b32 v194, 16, v56
    v_lshlrev_b32 v195, 16, v57
    v_mfma_f32_16x16x32_bf16 v[118:121], a[164:167], v[142:145], v[118:121]
    global_load_lds_dwordx4 v80, s[68:69] offset:2048
    v_lshlrev_b32 v196, 16, v58
    v_lshlrev_b32 v197, 16, v59
    v_fmac_f32 v110, s20, v194
    v_mfma_f32_16x16x32_bf16 v[114:117], a[132:135], v[142:145], v[114:117]
    ds_read_b128 v[142:145], v38 offset:2240
    global_load_lds_dwordx4 v81, s[68:69] offset:3072
    v_fmac_f32 v111, s21, v195
    v_fmac_f32 v112, s22, v196
    v_fmac_f32 v113, s23, v197
    v_mfma_f32_16x16x32_bf16 v[118:121], a[168:171], v[146:149], v[118:121]
    s_waitcnt vmcnt(11)
    v_lshlrev_b32 v162, 16, v198
    global_load_dwordx4 a[248:251], v4, s[12:13] offset:-1024 sc1
    v_mfma_f32_16x16x32_bf16 v[114:117], a[136:139], v[146:149], v[114:117]
    ds_read_b128 v[146:149], v38 offset:2304
    v_and_b32 v163, 0xffff0000, v198
    v_mfma_f32_16x16x32_bf16 v[118:121], a[172:175], v[150:153], v[118:121]
    v_lshlrev_b32 v164, 16, v199
    v_and_b32 v165, 0xffff0000, v199
    v_mfma_f32_16x16x32_bf16 v[114:117], a[140:143], v[150:153], v[114:117]
    ds_read_b128 v[150:153], v38 offset:2368
    v_lshlrev_b32 v166, 16, v200
    s_waitcnt lgkmcnt(2)
    v_mfma_f32_16x16x32_bf16 v[118:121], a[176:179], v[154:157], v[118:121]
    v_and_b32 v167, 0xffff0000, v200
    v_lshlrev_b32 v168, 16, v201
    v_mfma_f32_16x16x32_bf16 v[114:117], a[144:147], v[154:157], v[114:117]
    ds_read_b128 v[154:157], v38 offset:2432
    v_and_b32 v169, 0xffff0000, v201
    v_mfma_f32_16x16x32_bf16 v[118:121], a[180:183], v[158:161], v[118:121]
    v_fma_f32 v170, v162, v214, v215
    v_fma_f32 v171, v163, v214, v215
    v_mfma_f32_16x16x32_bf16 v[114:117], a[148:151], v[158:161], v[114:117]
    ds_read_b128 v[158:161], v38 offset:2496
    v_fma_f32 v172, v164, v214, v215
    v_mfma_f32_16x16x32_bf16 v[118:121], a[184:187], v[122:125], v[118:121]
    v_fma_f32 v173, v165, v214, v215
    v_fma_f32 v174, v166, v216, v217
    v_mfma_f32_16x16x32_bf16 v[114:117], a[152:155], v[122:125], v[114:117]
    ds_read_b128 v[122:125], v38 offset:1536
    v_fma_f32 v175, v167, v216, v217
    v_mfma_f32_16x16x32_bf16 v[118:121], a[188:191], v[126:129], v[118:121]
    v_fma_f32 v176, v168, v216, v217
    global_load_dwordx4 a[252:255], v7, s[18:19] offset:-1024 sc1
    v_mfma_f32_16x16x32_bf16 v[114:117], a[156:159], v[126:129], v[114:117]
    ds_read_b128 v[126:129], v38 offset:1600
    v_fma_f32 v177, v169, v216, v217
    v_mfma_f32_16x16x32_bf16 v[118:121], a[128:131], v[130:133], v[118:121]
    v_fma_f32 v170, v170, s64, v60
    v_fma_f32 v171, v171, s65, v61
    v_mfma_f32_16x16x32_bf16 v[114:117], a[96:99], v[130:133], v[114:117]
    ds_read_b128 v[130:133], v38 offset:1664
    v_fma_f32 v172, v172, s66, v62
    v_mfma_f32_16x16x32_bf16 v[118:121], a[132:135], v[134:137], v[118:121]
    v_fma_f32 v173, v173, s67, v63
    v_fma_f32 v174, v174, s64, v60
    v_mfma_f32_16x16x32_bf16 v[114:117], a[100:103], v[134:137], v[114:117]
    ds_read_b128 v[134:137], v38 offset:1728
    v_fma_f32 v175, v175, s65, v61
    v_mfma_f32_16x16x32_bf16 v[118:121], a[136:139], v[138:141], v[118:121]
    v_fma_f32 v176, v176, s66, v62
    v_fma_f32 v177, v177, s67, v63
    v_mfma_f32_16x16x32_bf16 v[114:117], a[104:107], v[138:141], v[114:117]
    ds_read_b128 v[138:141], v38 offset:1792
    v_fma_f32 v162, v170, v90, v162
    v_mfma_f32_16x16x32_bf16 v[118:121], a[140:143], v[142:145], v[118:121]
    v_fma_f32 v163, v171, v91, v163
    v_fma_f32 v164, v172, v92, v164
    v_mfma_f32_16x16x32_bf16 v[114:117], a[108:111], v[142:145], v[114:117]
    ds_read_b128 v[142:145], v38 offset:1856
    v_fma_f32 v165, v173, v93, v165
    s_waitcnt lgkmcnt(3)
    v_mfma_f32_16x16x32_bf16 v[118:121], a[144:147], v[146:149], v[118:121]
    v_fma_f32 v166, v174, v94, v166
    global_load_dwordx4 a[240:243], v4, s[12:13] offset:-2048 sc1
    v_mfma_f32_16x16x32_bf16 v[114:117], a[112:115], v[146:149], v[114:117]
    ds_read_b128 v[146:149], v38 offset:1920
    v_fma_f32 v167, v175, v95, v167
    v_mfma_f32_16x16x32_bf16 v[118:121], a[148:151], v[150:153], v[118:121]
    v_fma_f32 v168, v176, v96, v168
    v_fma_f32 v169, v177, v97, v169
    v_mfma_f32_16x16x32_bf16 v[114:117], a[116:119], v[150:153], v[114:117]
    ds_read_b128 v[150:153], v38 offset:1984
    v_cvt_pk_bf16_f32 v198, v162, v163
    v_mfma_f32_16x16x32_bf16 v[118:121], a[152:155], v[154:157], v[118:121]
    v_cvt_pk_bf16_f32 v199, v164, v165
    v_cvt_pk_bf16_f32 v200, v166, v167
    v_mfma_f32_16x16x32_bf16 v[114:117], a[120:123], v[154:157], v[114:117]
    ds_read_b128 v[154:157], v38 offset:1024
    v_cvt_pk_bf16_f32 v201, v168, v169
    v_mfma_f32_16x16x32_bf16 v[118:121], a[156:159], v[158:161], v[118:121]
    v_or_b32 v201, 1, v201
    v_add_u32 v44, 0, v43
    v_mfma_f32_16x16x32_bf16 v[114:117], a[124:127], v[158:161], v[114:117]
    ds_read_b128 v[158:161], v38 offset:1088
    global_store_dwordx4 v44, v[198:201], s[38:39] sc1
    v_mfma_f32_16x16x32_bf16 v[118:121], a[96:99], v[122:125], v[118:121]
    s_waitcnt vmcnt(14)
    v_lshlrev_b32 v162, 16, v202
    v_and_b32 v163, 0xffff0000, v202
    v_mfma_f32_16x16x32_bf16 v[114:117], a[64:67], v[122:125], v[114:117]
    ds_read_b128 v[122:125], v38 offset:1152
    v_lshlrev_b32 v164, 16, v203
    v_mfma_f32_16x16x32_bf16 v[118:121], a[100:103], v[126:129], v[118:121]
    v_and_b32 v165, 0xffff0000, v203
    v_lshlrev_b32 v166, 16, v204
    v_mfma_f32_16x16x32_bf16 v[114:117], a[68:71], v[126:129], v[114:117]
    ds_read_b128 v[126:129], v38 offset:1216
    global_load_dwordx4 a[244:247], v7, s[18:19] offset:-2048 sc1
    v_mfma_f32_16x16x32_bf16 v[118:121], a[104:107], v[130:133], v[118:121]
    v_and_b32 v167, 0xffff0000, v204
    v_lshlrev_b32 v168, 16, v205
    v_mfma_f32_16x16x32_bf16 v[114:117], a[72:75], v[130:133], v[114:117]
    ds_read_b128 v[130:133], v38 offset:1280
    v_and_b32 v169, 0xffff0000, v205
    s_waitcnt lgkmcnt(3)
    v_mfma_f32_16x16x32_bf16 v[118:121], a[108:111], v[134:137], v[118:121]
    v_fma_f32 v170, v162, v218, v219
    v_fma_f32 v171, v163, v218, v219
    v_mfma_f32_16x16x32_bf16 v[114:117], a[76:79], v[134:137], v[114:117]
    ds_read_b128 v[134:137], v38 offset:1344
    v_fma_f32 v172, v164, v218, v219
    v_mfma_f32_16x16x32_bf16 v[118:121], a[112:115], v[138:141], v[118:121]
    v_fma_f32 v173, v165, v218, v219
    v_fma_f32 v174, v166, v220, v221
    v_mfma_f32_16x16x32_bf16 v[114:117], a[80:83], v[138:141], v[114:117]
    ds_read_b128 v[138:141], v38 offset:1408
    v_fma_f32 v175, v167, v220, v221
    v_mfma_f32_16x16x32_bf16 v[118:121], a[116:119], v[142:145], v[118:121]
    v_fma_f32 v176, v168, v220, v221
    v_fma_f32 v177, v169, v220, v221
    v_mfma_f32_16x16x32_bf16 v[114:117], a[84:87], v[142:145], v[114:117]
    ds_read_b128 v[142:145], v38 offset:1472
    v_fma_f32 v170, v170, s64, v60
    v_mfma_f32_16x16x32_bf16 v[118:121], a[120:123], v[146:149], v[118:121]
    v_fma_f32 v171, v171, s65, v61
    v_fma_f32 v172, v172, s66, v62
    v_mfma_f32_16x16x32_bf16 v[114:117], a[88:91], v[146:149], v[114:117]
    ds_read_b128 v[146:149], v38 offset:512
    global_load_dwordx4 a[232:235], v4, s[12:13] offset:-3072 sc1
    v_mfma_f32_16x16x32_bf16 v[118:121], a[124:127], v[150:153], v[118:121]
    v_fma_f32 v173, v173, s67, v63
    v_fma_f32 v174, v174, s64, v60
    v_mfma_f32_16x16x32_bf16 v[114:117], a[92:95], v[150:153], v[114:117]
    ds_read_b128 v[150:153], v38 offset:576
    v_fma_f32 v175, v175, s65, v61
    v_mfma_f32_16x16x32_bf16 v[118:121], a[64:67], v[154:157], v[118:121]
    v_fma_f32 v176, v176, s66, v62
    v_fma_f32 v177, v177, s67, v63
    v_mfma_f32_16x16x32_bf16 v[114:117], a[32:35], v[154:157], v[114:117]
    ds_read_b128 v[154:157], v38 offset:640
    v_fma_f32 v162, v170, v98, v162
    v_mfma_f32_16x16x32_bf16 v[118:121], a[68:71], v[158:161], v[118:121]
    v_fma_f32 v163, v171, v99, v163
    v_fma_f32 v164, v172, v100, v164
    v_mfma_f32_16x16x32_bf16 v[114:117], a[36:39], v[158:161], v[114:117]
    ds_read_b128 v[158:161], v38 offset:704
    v_fma_f32 v165, v173, v101, v165
    s_waitcnt lgkmcnt(3)
    v_mfma_f32_16x16x32_bf16 v[118:121], a[72:75], v[122:125], v[118:121]
    v_fma_f32 v166, v174, v102, v166
    v_fma_f32 v167, v175, v103, v167
    v_mfma_f32_16x16x32_bf16 v[114:117], a[40:43], v[122:125], v[114:117]
    ds_read_b128 v[122:125], v38 offset:768
    v_fma_f32 v168, v176, v104, v168
    v_mfma_f32_16x16x32_bf16 v[118:121], a[76:79], v[126:129], v[118:121]
    v_fma_f32 v169, v177, v105, v169
    v_cvt_pk_bf16_f32 v202, v162, v163
    v_mfma_f32_16x16x32_bf16 v[114:117], a[44:47], v[126:129], v[114:117]
    ds_read_b128 v[126:129], v38 offset:832
    v_cvt_pk_bf16_f32 v203, v164, v165
    v_mfma_f32_16x16x32_bf16 v[118:121], a[80:83], v[130:133], v[118:121]
    global_load_dwordx4 a[236:239], v7, s[18:19] offset:-3072 sc1
    v_cvt_pk_bf16_f32 v204, v166, v167
    v_mfma_f32_16x16x32_bf16 v[114:117], a[48:51], v[130:133], v[114:117]
    ds_read_b128 v[130:133], v38 offset:896
    v_cvt_pk_bf16_f32 v205, v168, v169
    v_mfma_f32_16x16x32_bf16 v[118:121], a[84:87], v[134:137], v[118:121]
    v_or_b32 v205, 1, v205
    v_add_u32 v44, 917504, v43
    v_mfma_f32_16x16x32_bf16 v[114:117], a[52:55], v[134:137], v[114:117]
    ds_read_b128 v[134:137], v38 offset:960
    global_store_dwordx4 v44, v[202:205], s[38:39] sc1
    v_mfma_f32_16x16x32_bf16 v[118:121], a[88:91], v[138:141], v[118:121]
    s_waitcnt vmcnt(17)
    v_lshlrev_b32 v162, 16, v206
    v_and_b32 v163, 0xffff0000, v206
    v_mfma_f32_16x16x32_bf16 v[114:117], a[56:59], v[138:141], v[114:117]
    ds_read_b128 v[138:141], v38 offset:0
    v_lshlrev_b32 v164, 16, v207
    v_mfma_f32_16x16x32_bf16 v[118:121], a[92:95], v[142:145], v[118:121]
    v_and_b32 v165, 0xffff0000, v207
    v_lshlrev_b32 v166, 16, v208
    v_mfma_f32_16x16x32_bf16 v[114:117], a[60:63], v[142:145], v[114:117]
    ds_read_b128 v[142:145], v38 offset:64
    v_and_b32 v167, 0xffff0000, v208
    v_mfma_f32_16x16x32_bf16 v[118:121], a[32:35], v[146:149], v[118:121]
    v_lshlrev_b32 v168, 16, v209
    v_and_b32 v169, 0xffff0000, v209
    v_mfma_f32_16x16x32_bf16 v[114:117], a[0:3], v[146:149], v[114:117]
    ds_read_b128 v[146:149], v38 offset:128
    v_fma_f32 v170, v162, v222, v223
    s_waitcnt lgkmcnt(3)
    v_mfma_f32_16x16x32_bf16 v[118:121], a[36:39], v[150:153], v[118:121]
    global_load_dwordx4 a[224:227], v4, s[12:13] offset:-4096 sc1
    v_fma_f32 v171, v163, v222, v223
    v_mfma_f32_16x16x32_bf16 v[114:117], a[4:7], v[150:153], v[114:117]
    ds_read_b128 v[150:153], v38 offset:192
    v_fma_f32 v172, v164, v222, v223
    v_mfma_f32_16x16x32_bf16 v[118:121], a[40:43], v[154:157], v[118:121]
    v_fma_f32 v173, v165, v222, v223
    v_fma_f32 v174, v166, v224, v225
    v_mfma_f32_16x16x32_bf16 v[114:117], a[8:11], v[154:157], v[114:117]
    ds_read_b128 v[154:157], v38 offset:256
    v_fma_f32 v175, v167, v224, v225
    v_mfma_f32_16x16x32_bf16 v[118:121], a[44:47], v[158:161], v[118:121]
    v_fma_f32 v176, v168, v224, v225
    v_fma_f32 v177, v169, v224, v225
    v_mfma_f32_16x16x32_bf16 v[114:117], a[12:15], v[158:161], v[114:117]
    ds_read_b128 v[158:161], v38 offset:320
    v_fma_f32 v170, v170, s64, v60
    v_fma_f32 v171, v171, s65, v61
    v_fma_f32 v172, v172, s66, v62
    v_mfma_f32_16x16x32_bf16 v[118:121], a[48:51], v[122:125], v[118:121]
    v_fma_f32 v173, v173, s67, v63
    v_fma_f32 v174, v174, s64, v60
    v_fma_f32 v175, v175, s65, v61
    v_mfma_f32_16x16x32_bf16 v[114:117], a[16:19], v[122:125], v[114:117]
    ds_read_b128 v[122:125], v38 offset:384
    v_fma_f32 v176, v176, s66, v62
    v_fma_f32 v177, v177, s67, v63
    v_fma_f32 v162, v170, v106, v162
    v_mfma_f32_16x16x32_bf16 v[118:121], a[52:55], v[126:129], v[118:121]
    global_load_dwordx4 a[228:231], v7, s[18:19] offset:-4096 sc1
    v_fma_f32 v163, v171, v107, v163
    v_fma_f32 v164, v172, v108, v164
    v_fma_f32 v165, v173, v109, v165
    v_mfma_f32_16x16x32_bf16 v[114:117], a[20:23], v[126:129], v[114:117]
    ds_read_b128 v[126:129], v38 offset:448
    v_fma_f32 v166, v174, v110, v166
    v_fma_f32 v167, v175, v111, v167
    v_fma_f32 v168, v176, v112, v168
    v_mfma_f32_16x16x32_bf16 v[118:121], a[56:59], v[130:133], v[118:121]
    v_fma_f32 v169, v177, v113, v169
    v_cvt_pk_bf16_f32 v206, v162, v163
    v_cvt_pk_bf16_f32 v207, v164, v165
    v_mfma_f32_16x16x32_bf16 v[114:117], a[24:27], v[130:133], v[114:117]
    v_cvt_pk_bf16_f32 v208, v166, v167
    v_cvt_pk_bf16_f32 v209, v168, v169
    v_or_b32 v209, 1, v209
    v_mfma_f32_16x16x32_bf16 v[118:121], a[60:63], v[134:137], v[118:121]
    v_add_u32 v44, 1835008, v43
    global_store_dwordx4 v44, v[206:209], s[38:39] sc1
    s_waitcnt vmcnt(19)
    v_lshlrev_b32 v178, 16, v210
    v_mfma_f32_16x16x32_bf16 v[114:117], a[28:31], v[134:137], v[114:117]
    global_load_dwordx4 a[216:219], v4, s[10:11] offset:3072 sc1
    v_and_b32 v179, 0xffff0000, v210
    v_lshlrev_b32 v180, 16, v211
    v_and_b32 v181, 0xffff0000, v211
    s_waitcnt lgkmcnt(0)
    v_mfma_f32_16x16x32_bf16 v[118:121], a[0:3], v[138:141], v[118:121]
    v_lshlrev_b32 v182, 16, v212
    v_and_b32 v183, 0xffff0000, v212
    v_lshlrev_b32 v184, 16, v213
    v_mfma_f32_16x16x32_bf16 v[118:121], a[4:7], v[142:145], v[118:121]
    v_and_b32 v185, 0xffff0000, v213
    v_fma_f32 v186, v178, v226, v227
    v_fma_f32 v187, v179, v226, v227
    v_mfma_f32_16x16x32_bf16 v[118:121], a[8:11], v[146:149], v[118:121]
    v_fma_f32 v188, v180, v226, v227
    v_fma_f32 v189, v181, v226, v227
    v_fma_f32 v190, v182, v228, v229
    v_mfma_f32_16x16x32_bf16 v[118:121], a[12:15], v[150:153], v[118:121]
    v_fma_f32 v191, v183, v228, v229
    global_load_dwordx4 a[220:223], v7, s[16:17] offset:3072 sc1
    v_fma_f32 v192, v184, v228, v229
    v_fma_f32 v193, v185, v228, v229
    v_mfma_f32_16x16x32_bf16 v[118:121], a[16:19], v[154:157], v[118:121]
    v_fma_f32 v186, v186, s64, v60
    v_fma_f32 v187, v187, s65, v61
    v_fma_f32 v188, v188, s66, v62
    v_mfma_f32_16x16x32_bf16 v[118:121], a[20:23], v[158:161], v[118:121]
    v_fma_f32 v189, v189, s67, v63
    v_fma_f32 v190, v190, s64, v60
    v_fma_f32 v191, v191, s65, v61
    v_mfma_f32_16x16x32_bf16 v[118:121], a[24:27], v[122:125], v[118:121]
    v_fma_f32 v192, v192, s66, v62
    v_fma_f32 v193, v193, s67, v63
    ds_read_b32 v56, v39 offset:0
    v_mfma_f32_16x16x32_bf16 v[118:121], a[28:31], v[126:129], v[118:121]
    ds_read_b32 v57, v39 offset:9280
    ds_read_b32 v58, v39 offset:18560
    ds_read_b32 v59, v39 offset:27840
    global_load_dwordx4 v[230:233], v235, s[38:39] sc1
    global_load_dwordx4 a[208:211], v4, s[10:11] offset:2048 sc1
    v_cvt_pk_bf16_f32 v48, v114, v115
    v_cvt_pk_bf16_f32 v49, v116, v117
    ds_write2_b32 v40, v48, v49 offset0:0 offset1:2
    v_cvt_pk_bf16_f32 v50, v118, v119
    v_cvt_pk_bf16_f32 v51, v120, v121
    global_load_dwordx4 a[212:215], v7, s[16:17] offset:2048 sc1
    ds_write2_b32 v40, v50, v51 offset0:128 offset1:130
    s_waitcnt lgkmcnt(0)
    s_barrier
    ds_read_b32 v52, v41 offset:12672
    ds_read_b32 v53, v41 offset:13728
    ds_read_b32 v54, v41 offset:14784
    global_load_dwordx4 a[200:203], v4, s[10:11] offset:1024 sc1
    ds_read_b32 v55, v41 offset:15840
    s_waitcnt lgkmcnt(3)
    v_lshlrev_b32 v114, 16, v52
    v_and_b32 v118, 0xffff0000, v52
    s_waitcnt lgkmcnt(2)
    v_lshlrev_b32 v115, 16, v53
    v_and_b32 v119, 0xffff0000, v53
    s_waitcnt lgkmcnt(1)
    v_lshlrev_b32 v116, 16, v54
    global_load_dwordx4 a[204:207], v7, s[16:17] offset:1024 sc1
    v_and_b32 v120, 0xffff0000, v54
    s_waitcnt lgkmcnt(0)
    v_lshlrev_b32 v117, 16, v55
    v_and_b32 v121, 0xffff0000, v55
    v_dot2_f32_bf16 v114, v56, s20, v114
    v_dot2_f32_bf16 v115, v57, s21, v115
    v_dot2_f32_bf16 v116, v58, s22, v116
    v_dot2_f32_bf16 v117, v59, s23, v117
    v_dot2_f32_bf16 v118, v56, s28, v118
    v_dot2_f32_bf16 v119, v57, s29, v119
    v_dot2_f32_bf16 v120, v58, s30, v120
    v_dot2_f32_bf16 v121, v59, s31, v121
    v_pk_fma_f32 v[178:179], v[186:187], v[114:115], v[178:179] op_sel:[0,0,0] op_sel_hi:[1,1,1]
    v_pk_fma_f32 v[180:181], v[188:189], v[116:117], v[180:181] op_sel:[0,0,0] op_sel_hi:[1,1,1]
    v_pk_fma_f32 v[182:183], v[190:191], v[118:119], v[182:183] op_sel:[0,0,0] op_sel_hi:[1,1,1]
    v_pk_fma_f32 v[184:185], v[192:193], v[120:121], v[184:185] op_sel:[0,0,0] op_sel_hi:[1,1,1]
    v_cvt_pk_bf16_f32 v210, v178, v179
    v_cvt_pk_bf16_f32 v211, v180, v181
    v_cvt_pk_bf16_f32 v212, v182, v183
    v_cvt_pk_bf16_f32 v213, v184, v185
    v_or_b32 v213, 1, v213
    v_add_u32 v44, 2752512, v43
    global_store_dwordx4 v44, v[210:213], s[38:39] sc1
    s_waitcnt lgkmcnt(0)
    s_barrier
    s_waitcnt vmcnt(5)
    v_max_u32 v236, v230, v231
    v_max3_u32 v236, v232, v233, v236
    v_cmp_eq_u32 vcc, -1, v236
    s_nop 0
    s_cbranch_vccnz Lcv_r
Lcv_ok:
    v_permlane32_swap_b32 v230, v232
    v_permlane32_swap_b32 v231, v233
    s_lshl_b32 s4, s3, 9
    s_add_u32 s4, s4, 156672
    v_and_b32 v235, 496, v4
    v_add_f32 v230, v230, v232
    v_add_f32 v231, v231, v233
    v_bfe_u32 v232, v1, 3, 1
    v_cmp_gt_u32 vcc, s101, v232
    v_lshrrev_b32 v232, 5, v1
    v_lshl_add_u32 v235, v232, 3, v235
    v_cndmask_b32 v230, 0, v230, vcc
    v_cndmask_b32 v231, 0, v231, vcc
    v_add_u32 v235, s4, v235
    ds_write_b64 v235, v[230:231]
    global_load_dwordx4 a[192:195], v4, s[10:11] offset:0 sc1
    global_load_dwordx4 a[196:199], v7, s[16:17] offset:0 sc1
    global_load_dwordx4 a[184:187], v4, s[10:11] offset:-1024 sc1
    global_load_dwordx4 a[188:191], v7, s[16:17] offset:-1024 sc1
    global_load_dwordx4 a[176:179], v4, s[10:11] offset:-2048 sc1
    global_load_dwordx4 a[180:183], v7, s[16:17] offset:-2048 sc1
    global_load_dwordx4 a[168:171], v4, s[10:11] offset:-3072 sc1
    global_load_dwordx4 a[172:175], v7, s[16:17] offset:-3072 sc1
    global_load_dwordx4 a[160:163], v4, s[10:11] offset:-4096 sc1
    global_load_dwordx4 a[164:167], v7, s[16:17] offset:-4096 sc1
    global_load_dwordx4 a[152:155], v4, s[8:9] offset:3072 sc1
    global_load_dwordx4 a[156:159], v7, s[14:15] offset:3072 sc1
    global_load_dwordx4 a[144:147], v4, s[8:9] offset:2048 sc1
    global_load_dwordx4 a[148:151], v7, s[14:15] offset:2048 sc1
    global_load_dwordx4 a[136:139], v4, s[8:9] offset:1024 sc1
    global_load_dwordx4 a[140:143], v7, s[14:15] offset:1024 sc1
    global_load_dwordx4 a[128:131], v4, s[8:9] offset:0 sc1
    global_load_dwordx4 a[132:135], v7, s[14:15] offset:0 sc1
Ljoin:
    s_bfe_u32 s6, s2, 0x30003
    v_mul_u32_u24 v254, 8, v0
    v_add_lshl_u32 v254, v254, s6, 7
    v_min_u32 v254, (Lmid-Lx_go-4), v254
    v_add_u32 v254, (Lx_go-adaLN_cond__ssm_conv_h3__mixer_gmlp__prompt_kernel), v254
    global_load_dword v254, v254, s[0:1]
    s_cmp_lt_u32 s43, 5
    s_cbranch_scc1 Lx_first
Lx_redo:
    s_branch Lxp_f
Lxp:
    s_sleep 1
Lxp_f:
    global_load_dword v71, v72, s[38:39] offset:508 sc1
    s_waitcnt vmcnt(0)
    v_and_b32 v71, 1, v71
    v_cmp_ne_u32 vcc, 1, v71
    s_add_u32 s100, s100, 1
    s_cmp_ge_u32 s100, 262144
    s_cbranch_scc1 Lxp_x
    s_cbranch_vccnz Lxp
Lxp_x:
Lx_first:
    s_mov_b32 s7, 0x3f803f80
    v_add_u32 v67, 4096, v66
    global_load_dwordx4 v[98:101], v67, s[38:39] offset:-4096 sc1
    global_load_dwordx4 v[102:105], v67, s[38:39] offset:-3072 sc1
    global_load_dwordx4 v[106:109], v67, s[38:39] offset:-2048 sc1
    global_load_dwordx4 v[110:113], v67, s[38:39] offset:-1024 sc1
    global_load_dwordx4 v[114:117], v67, s[38:39] offset:0 sc1
    global_load_dwordx4 v[118:121], v67, s[38:39] offset:1024 sc1
    global_load_dwordx4 v[122:125], v67, s[38:39] offset:2048 sc1
    global_load_dwordx4 v[126:129], v67, s[38:39] offset:3072 sc1
    v_add_u32 v67, 8192, v67
    global_load_dwordx4 v[130:133], v67, s[38:39] offset:-4096 sc1
    global_load_dwordx4 v[134:137], v67, s[38:39] offset:-3072 sc1
    v_mov_b32 v62, 0
    v_mov_b32 v63, 0
    v_mov_b32 v64, 0
    v_mov_b32 v65, 0
    v_mov_b32 v71, -1
    global_load_dwordx4 v[138:141], v67, s[38:39] offset:-2048 sc1
    v_add_u32 v69, 0, v68
    s_waitcnt vmcnt(10)
    ds_write2_b64 v69, v[98:99], v[100:101] offset0:0 offset1:2
    v_dot2_f32_bf16 v62, v98, s7, v62
    v_dot2_f32_bf16 v63, v98, v98, v63
    v_dot2_f32_bf16 v64, v100, s7, v64
    v_dot2_f32_bf16 v65, v100, v100, v65
    v_dot2_f32_bf16 v62, v99, s7, v62
    v_dot2_f32_bf16 v63, v99, v99, v63
    v_dot2_f32_bf16 v64, v101, s7, v64
    v_dot2_f32_bf16 v65, v101, v101, v65
    global_load_dwordx4 v[142:145], v67, s[38:39] offset:-1024 sc1
    s_waitcnt vmcnt(10)
    ds_write2_b64 v69, v[102:103], v[104:105] offset0:32 offset1:34
    v_bitop3_b32 v71, v101, v105, v71 bitop3:0x80
    v_dot2_f32_bf16 v62, v102, s7, v62
    v_dot2_f32_bf16 v63, v102, v102, v63
    v_dot2_f32_bf16 v64, v104, s7, v64
    v_dot2_f32_bf16 v65, v104, v104, v65
    v_dot2_f32_bf16 v62, v103, s7, v62
    v_dot2_f32_bf16 v63, v103, v103, v63
    v_dot2_f32_bf16 v64, v105, s7, v64
    v_dot2_f32_bf16 v65, v105, v105, v65
    global_load_dwordx4 v[146:149], v67, s[38:39] offset:0 sc1
    s_waitcnt vmcnt(10)
    ds_write2_b64 v69, v[106:107], v[108:109] offset0:64 offset1:66
    v_dot2_f32_bf16 v62, v106, s7, v62
    v_dot2_f32_bf16 v63, v106, v106, v63
    v_dot2_f32_bf16 v64, v108, s7, v64
    v_dot2_f32_bf16 v65, v108, v108, v65
    v_dot2_f32_bf16 v62, v107, s7, v62
    v_dot2_f32_bf16 v63, v107, v107, v63
    v_dot2_f32_bf16 v64, v109, s7, v64
    v_dot2_f32_bf16 v65, v109, v109, v65
    global_load_dwordx4 v[150:153], v67, s[38:39] offset:1024 sc1
    s_waitcnt vmcnt(10)
    ds_write2_b64 v69, v[110:111], v[112:113] offset0:96 offset1:98
    v_bitop3_b32 v71, v109, v113, v71 bitop3:0x80
    v_dot2_f32_bf16 v62, v110, s7, v62
    v_dot2_f32_bf16 v63, v110, v110, v63
    v_dot2_f32_bf16 v64, v112, s7, v64
    v_dot2_f32_bf16 v65, v112, v112, v65
    v_dot2_f32_bf16 v62, v111, s7, v62
    v_dot2_f32_bf16 v63, v111, v111, v63
    v_dot2_f32_bf16 v64, v113, s7, v64
    v_dot2_f32_bf16 v65, v113, v113, v65
    global_load_dwordx4 v[154:157], v67, s[38:39] offset:2048 sc1
    v_add_u32 v69, 4160, v68
    s_waitcnt vmcnt(10)
    ds_write2_b64 v69, v[114:115], v[116:117] offset0:0 offset1:2
    v_dot2_f32_bf16 v62, v114, s7, v62
    v_dot2_f32_bf16 v63, v114, v114, v63
    v_dot2_f32_bf16 v64, v116, s7, v64
    v_dot2_f32_bf16 v65, v116, v116, v65
    v_dot2_f32_bf16 v62, v115, s7, v62
    v_dot2_f32_bf16 v63, v115, v115, v63
    v_dot2_f32_bf16 v64, v117, s7, v64
    v_dot2_f32_bf16 v65, v117, v117, v65
    global_load_dwordx4 v[158:161], v67, s[38:39] offset:3072 sc1
    v_add_u32 v67, 8192, v67
    s_waitcnt vmcnt(10)
    ds_write2_b64 v69, v[118:119], v[120:121] offset0:32 offset1:34
    v_bitop3_b32 v71, v117, v121, v71 bitop3:0x80
    v_dot2_f32_bf16 v62, v118, s7, v62
    v_dot2_f32_bf16 v63, v118, v118, v63
    v_dot2_f32_bf16 v64, v120, s7, v64
    v_dot2_f32_bf16 v65, v120, v120, v65
    v_dot2_f32_bf16 v62, v119, s7, v62
    v_dot2_f32_bf16 v63, v119, v119, v63
    v_dot2_f32_bf16 v64, v121, s7, v64
    v_dot2_f32_bf16 v65, v121, v121, v65
    global_load_dwordx4 v[162:165], v67, s[38:39] offset:-4096 sc1
    s_waitcnt vmcnt(10)
    ds_write2_b64 v69, v[122:123], v[124:125] offset0:64 offset1:66
    v_dot2_f32_bf16 v62, v122, s7, v62
    v_dot2_f32_bf16 v63, v122, v122, v63
    v_dot2_f32_bf16 v64, v124, s7, v64
    v_dot2_f32_bf16 v65, v124, v124, v65
    v_dot2_f32_bf16 v62, v123, s7, v62
    v_dot2_f32_bf16 v63, v123, v123, v63
    v_dot2_f32_bf16 v64, v125, s7, v64
    v_dot2_f32_bf16 v65, v125, v125, v65
    global_load_dwordx4 v[166:169], v67, s[38:39] offset:-3072 sc1
    s_waitcnt vmcnt(10)
    ds_write2_b64 v69, v[126:127], v[128:129] offset0:96 offset1:98
    v_bitop3_b32 v71, v125, v129, v71 bitop3:0x80
    v_dot2_f32_bf16 v62, v126, s7, v62
    v_dot2_f32_bf16 v63, v126, v126, v63
    v_dot2_f32_bf16 v64, v128, s7, v64
    v_dot2_f32_bf16 v65, v128, v128, v65
    v_dot2_f32_bf16 v62, v127, s7, v62
    v_dot2_f32_bf16 v63, v127, v127, v63
    v_dot2_f32_bf16 v64, v129, s7, v64
    v_dot2_f32_bf16 v65, v129, v129, v65
    global_load_dwordx4 v[170:173], v67, s[38:39] offset:-2048 sc1
    v_add_u32 v69, 8320, v68
    s_waitcnt vmcnt(10)
    ds_write2_b64 v69, v[130:131], v[132:133] offset0:0 offset1:2
    v_dot2_f32_bf16 v62, v130, s7, v62
    v_dot2_f32_bf16 v63, v130, v130, v63
    v_dot2_f32_bf16 v64, v132, s7, v64
    v_dot2_f32_bf16 v65, v132, v132, v65
    v_dot2_f32_bf16 v62, v131, s7, v62
    v_dot2_f32_bf16 v63, v131, v131, v63
    v_dot2_f32_bf16 v64, v133, s7, v64
    v_dot2_f32_bf16 v65, v133, v133, v65
    global_load_dwordx4 v[174:177], v67, s[38:39] offset:-1024 sc1
    s_waitcnt vmcnt(10)
    ds_write2_b64 v69, v[134:135], v[136:137] offset0:32 offset1:34
    v_bitop3_b32 v71, v133, v137, v71 bitop3:0x80
    v_dot2_f32_bf16 v62, v134, s7, v62
    v_dot2_f32_bf16 v63, v134, v134, v63
    v_dot2_f32_bf16 v64, v136, s7, v64
    v_dot2_f32_bf16 v65, v136, v136, v65
    v_dot2_f32_bf16 v62, v135, s7, v62
    v_dot2_f32_bf16 v63, v135, v135, v63
    v_dot2_f32_bf16 v64, v137, s7, v64
    v_dot2_f32_bf16 v65, v137, v137, v65
    global_load_dwordx4 a[96:99], v4, s[8:9] offset:-4096 sc1
    s_waitcnt vmcnt(10)
    ds_write2_b64 v69, v[138:139], v[140:141] offset0:64 offset1:66
    v_dot2_f32_bf16 v62, v138, s7, v62
    v_dot2_f32_bf16 v63, v138, v138, v63
    v_dot2_f32_bf16 v64, v140, s7, v64
    v_dot2_f32_bf16 v65, v140, v140, v65
    v_dot2_f32_bf16 v62, v139, s7, v62
    v_dot2_f32_bf16 v63, v139, v139, v63
    v_dot2_f32_bf16 v64, v141, s7, v64
    v_dot2_f32_bf16 v65, v141, v141, v65
    global_load_dwordx4 a[100:103], v7, s[14:15] offset:-4096 sc1
    s_waitcnt vmcnt(10)
    ds_write2_b64 v69, v[142:143], v[144:145] offset0:96 offset1:98
    v_bitop3_b32 v71, v141, v145, v71 bitop3:0x80
    v_dot2_f32_bf16 v62, v142, s7, v62
    v_dot2_f32_bf16 v63, v142, v142, v63
    v_dot2_f32_bf16 v64, v144, s7, v64
    v_dot2_f32_bf16 v65, v144, v144, v65
    v_dot2_f32_bf16 v62, v143, s7, v62
    v_dot2_f32_bf16 v63, v143, v143, v63
    v_dot2_f32_bf16 v64, v145, s7, v64
    v_dot2_f32_bf16 v65, v145, v145, v65
    global_load_dwordx4 a[104:107], v4, s[8:9] offset:-3072 sc1
    v_add_u32 v69, 12480, v68
    s_waitcnt vmcnt(10)
    ds_write2_b64 v69, v[146:147], v[148:149] offset0:0 offset1:2
    v_dot2_f32_bf16 v62, v146, s7, v62
    v_dot2_f32_bf16 v63, v146, v146, v63
    v_dot2_f32_bf16 v64, v148, s7, v64
    v_dot2_f32_bf16 v65, v148, v148, v65
    v_dot2_f32_bf16 v62, v147, s7, v62
    v_dot2_f32_bf16 v63, v147, v147, v63
    v_dot2_f32_bf16 v64, v149, s7, v64
    v_dot2_f32_bf16 v65, v149, v149, v65
    global_load_dwordx4 a[108:111], v7, s[14:15] offset:-3072 sc1
    s_waitcnt vmcnt(10)
    ds_write2_b64 v69, v[150:151], v[152:153] offset0:32 offset1:34
    v_bitop3_b32 v71, v149, v153, v71 bitop3:0x80
    v_dot2_f32_bf16 v62, v150, s7, v62
    v_dot2_f32_bf16 v63, v150, v150, v63
    v_dot2_f32_bf16 v64, v152, s7, v64
    v_dot2_f32_bf16 v65, v152, v152, v65
    v_dot2_f32_bf16 v62, v151, s7, v62
    v_dot2_f32_bf16 v63, v151, v151, v63
    v_dot2_f32_bf16 v64, v153, s7, v64
    v_dot2_f32_bf16 v65, v153, v153, v65
    global_load_dwordx4 a[112:115], v4, s[8:9] offset:-2048 sc1
    s_waitcnt vmcnt(10)
    ds_write2_b64 v69, v[154:155], v[156:157] offset0:64 offset1:66
    v_dot2_f32_bf16 v62, v154, s7, v62
    v_dot2_f32_bf16 v63, v154, v154, v63
    v_dot2_f32_bf16 v64, v156, s7, v64
    v_dot2_f32_bf16 v65, v156, v156, v65
    v_dot2_f32_bf16 v62, v155, s7, v62
    v_dot2_f32_bf16 v63, v155, v155, v63
    v_dot2_f32_bf16 v64, v157, s7, v64
    v_dot2_f32_bf16 v65, v157, v157, v65
    global_load_dwordx4 a[116:119], v7, s[14:15] offset:-2048 sc1
    s_waitcnt vmcnt(10)
    ds_write2_b64 v69, v[158:159], v[160:161] offset0:96 offset1:98
    v_bitop3_b32 v71, v157, v161, v71 bitop3:0x80
    v_dot2_f32_bf16 v62, v158, s7, v62
    v_dot2_f32_bf16 v63, v158, v158, v63
    v_dot2_f32_bf16 v64, v160, s7, v64
    v_dot2_f32_bf16 v65, v160, v160, v65
    v_dot2_f32_bf16 v62, v159, s7, v62
    v_dot2_f32_bf16 v63, v159, v159, v63
    v_dot2_f32_bf16 v64, v161, s7, v64
    v_dot2_f32_bf16 v65, v161, v161, v65
    global_load_dwordx4 a[120:123], v4, s[8:9] offset:-1024 sc1
    v_add_u32 v69, 16640, v68
    s_waitcnt vmcnt(10)
    ds_write2_b64 v69, v[162:163], v[164:165] offset0:0 offset1:2
    v_dot2_f32_bf16 v62, v162, s7, v62
    v_dot2_f32_bf16 v63, v162, v162, v63
    v_dot2_f32_bf16 v64, v164, s7, v64
    v_dot2_f32_bf16 v65, v164, v164, v65
    v_dot2_f32_bf16 v62, v163, s7, v62
    v_dot2_f32_bf16 v63, v163, v163, v63
    v_dot2_f32_bf16 v64, v165, s7, v64
    v_dot2_f32_bf16 v65, v165, v165, v65
    global_load_dwordx4 a[124:127], v7, s[14:15] offset:-1024 sc1
    s_waitcnt vmcnt(10)
    ds_write2_b64 v69, v[166:167], v[168:169] offset0:32 offset1:34
    v_bitop3_b32 v71, v165, v169, v71 bitop3:0x80
    v_dot2_f32_bf16 v62, v166, s7, v62
    v_dot2_f32_bf16 v63, v166, v166, v63
    v_dot2_f32_bf16 v64, v168, s7, v64
    v_dot2_f32_bf16 v65, v168, v168, v65
    v_dot2_f32_bf16 v62, v167, s7, v62
    v_dot2_f32_bf16 v63, v167, v167, v63
    v_dot2_f32_bf16 v64, v169, s7, v64
    v_dot2_f32_bf16 v65, v169, v169, v65
    s_waitcnt vmcnt(9)
    ds_write2_b64 v69, v[170:171], v[172:173] offset0:64 offset1:66
    v_dot2_f32_bf16 v62, v170, s7, v62
    v_dot2_f32_bf16 v63, v170, v170, v63
    v_dot2_f32_bf16 v64, v172, s7, v64
    v_dot2_f32_bf16 v65, v172, v172, v65
    v_dot2_f32_bf16 v62, v171, s7, v62
    v_dot2_f32_bf16 v63, v171, v171, v63
    v_dot2_f32_bf16 v64, v173, s7, v64
    v_dot2_f32_bf16 v65, v173, v173, v65
    s_waitcnt vmcnt(8)
    ds_write2_b64 v69, v[174:175], v[176:177] offset0:96 offset1:98
    v_bitop3_b32 v71, v173, v177, v71 bitop3:0x80
    v_dot2_f32_bf16 v62, v174, s7, v62
    v_dot2_f32_bf16 v63, v174, v174, v63
    v_dot2_f32_bf16 v64, v176, s7, v64
    v_dot2_f32_bf16 v65, v176, v176, v65
    v_dot2_f32_bf16 v62, v175, s7, v62
    v_dot2_f32_bf16 v63, v175, v175, v63
    v_dot2_f32_bf16 v64, v177, s7, v64
    v_dot2_f32_bf16 v65, v177, v177, v65
    v_and_b32 v71, 1, v71
    v_cmp_ne_u32 vcc, 1, v71
    s_cmp_ge_u32 s100, 262144
    s_cbranch_scc1 Lx_go
    s_cbranch_vccnz Lx_redo
Lx_go:
    v_add_f32_dpp v90, v62, v62 row_ror:8 row_mask:0xf bank_mask:0x3
    s_nop 1
    v_add_f32_dpp v90, v64, v64 row_ror:8 row_mask:0xf bank_mask:0xc
    v_add_f32_dpp v91, v63, v63 row_ror:8 row_mask:0xf bank_mask:0x3
    s_nop 1
    v_add_f32_dpp v91, v65, v65 row_ror:8 row_mask:0xf bank_mask:0xc
    s_add_u32 s4, s88, 148736
    v_lshl_add_u32 v28, v70, 3, s4
    ds_write_b64 v28, v[90:91]
    s_waitcnt lgkmcnt(0)
    s_barrier
    v_add_u32 v173, 41600, v4
    ds_read_b128 v[48:51], v173 offset:37440
    ds_read_b128 v[52:55], v173 offset:38480
    ds_read_b128 v[56:59], v173 offset:39520
    ds_read_b128 v[60:63], v173 offset:40560
    ds_read_b128 v[64:67], v173 offset:33280
    s_waitcnt lgkmcnt(3)
    v_mfma_f32_16x16x32_bf16 v[178:181], v[48:51], a[248:251], 0
    ds_read_b128 v[68:71], v173 offset:34320
    s_add_u32 m0, s89, 8192
    v_mfma_f32_16x16x32_bf16 v[194:197], v[48:51], a[252:255], 0
    v_mfma_f32_16x16x32_bf16 v[182:185], v[52:55], a[248:251], 0
    ds_read_b128 v[48:51], v173 offset:35360
    v_mfma_f32_16x16x32_bf16 v[198:201], v[52:55], a[252:255], 0
    s_waitcnt lgkmcnt(3)
    v_mfma_f32_16x16x32_bf16 v[186:189], v[56:59], a[248:251], 0
    ds_read_b128 v[52:55], v173 offset:36400
    v_add_u32 v28, 148736, v30
    v_mfma_f32_16x16x32_bf16 v[202:205], v[56:59], a[252:255], 0
    global_load_lds_dwordx4 v74, s[70:71] offset:0
    ds_read_b64 v[90:91], v28 offset:0
    v_mfma_f32_16x16x32_bf16 v[190:193], v[60:63], a[248:251], 0
    ds_read_b128 v[56:59], v173 offset:29120
    v_mfma_f32_16x16x32_bf16 v[206:209], v[60:63], a[252:255], 0
    ds_read_b64 v[92:93], v28 offset:512
    s_waitcnt lgkmcnt(4)
    v_mfma_f32_16x16x32_bf16 v[178:181], v[64:67], a[240:243], v[178:181]
    ds_read_b128 v[60:63], v173 offset:30160
    v_mfma_f32_16x16x32_bf16 v[194:197], v[64:67], a[244:247], v[194:197]
    ds_read_b64 v[94:95], v28 offset:1024
    v_mfma_f32_16x16x32_bf16 v[182:185], v[68:71], a[240:243], v[182:185]
    ds_read_b128 v[64:67], v173 offset:31200
    global_load_lds_dwordx4 v75, s[70:71] offset:1024
    v_mfma_f32_16x16x32_bf16 v[198:201], v[68:71], a[244:247], v[198:201]
    ds_read_b64 v[96:97], v28 offset:1536
    s_waitcnt lgkmcnt(5)
    v_mfma_f32_16x16x32_bf16 v[186:189], v[48:51], a[240:243], v[186:189]
    ds_read_b128 v[68:71], v173 offset:32240
    v_mfma_f32_16x16x32_bf16 v[202:205], v[48:51], a[244:247], v[202:205]
    s_add_u32 s4, s88, 150784
    v_mfma_f32_16x16x32_bf16 v[190:193], v[52:55], a[240:243], v[190:193]
    ds_read_b128 v[48:51], v173 offset:24960
    v_mfma_f32_16x16x32_bf16 v[206:209], v[52:55], a[244:247], v[206:209]
    v_lshl_add_u32 v170, v1, 2, s4
    s_waitcnt lgkmcnt(3)
    v_mfma_f32_16x16x32_bf16 v[178:181], v[56:59], a[232:235], v[178:181]
    ds_read_b128 v[52:55], v173 offset:26000
    global_load_lds_dwordx4 v76, s[70:71] offset:2048
    v_mfma_f32_16x16x32_bf16 v[194:197], v[56:59], a[236:239], v[194:197]
    v_lshl_add_u32 v171, v3, 5, s4
    v_mfma_f32_16x16x32_bf16 v[182:185], v[60:63], a[232:235], v[182:185]
    ds_read_b128 v[56:59], v173 offset:27040
    v_lshl_add_u32 v172, v5, 2, s4
    v_mfma_f32_16x16x32_bf16 v[198:201], v[60:63], a[236:239], v[198:201]
    s_waitcnt lgkmcnt(3)
    v_mfma_f32_16x16x32_bf16 v[186:189], v[64:67], a[232:235], v[186:189]
    ds_read_b128 v[60:63], v173 offset:28080
    v_add_f32 v90, v90, v92
    v_mfma_f32_16x16x32_bf16 v[202:205], v[64:67], a[236:239], v[202:205]
    global_load_lds_dwordx4 v77, s[70:71] offset:3072
    v_mfma_f32_16x16x32_bf16 v[190:193], v[68:71], a[232:235], v[190:193]
    ds_read_b128 v[64:67], v173 offset:20800
    v_add_f32 v91, v91, v93
    v_mfma_f32_16x16x32_bf16 v[206:209], v[68:71], a[236:239], v[206:209]
    s_waitcnt lgkmcnt(3)
    v_mfma_f32_16x16x32_bf16 v[178:181], v[48:51], a[224:227], v[178:181]
    ds_read_b128 v[68:71], v173 offset:21840
    v_add_f32 v94, v94, v96
    v_mfma_f32_16x16x32_bf16 v[194:197], v[48:51], a[228:231], v[194:197]
    v_mfma_f32_16x16x32_bf16 v[182:185], v[52:55], a[224:227], v[182:185]
    ds_read_b128 v[48:51], v173 offset:22880
    v_add_f32 v95, v95, v97
    s_add_u32 m0, s89, 12288
    v_mfma_f32_16x16x32_bf16 v[198:201], v[52:55], a[228:231], v[198:201]
    s_waitcnt lgkmcnt(3)
    v_mfma_f32_16x16x32_bf16 v[186:189], v[56:59], a[224:227], v[186:189]
    ds_read_b128 v[52:55], v173 offset:23920
    v_add_f32 v90, v90, v94
    v_mfma_f32_16x16x32_bf16 v[202:205], v[56:59], a[228:231], v[202:205]
    v_add_f32 v91, v91, v95
    v_mfma_f32_16x16x32_bf16 v[190:193], v[60:63], a[224:227], v[190:193]
    ds_read_b128 v[56:59], v173 offset:16640
    v_mfma_f32_16x16x32_bf16 v[206:209], v[60:63], a[228:231], v[206:209]
    v_mul_f32 v90, 0x3acccccd, v90
    s_waitcnt lgkmcnt(2)
    v_mfma_f32_16x16x32_bf16 v[178:181], v[64:67], a[216:219], v[178:181]
    ds_read_b128 v[60:63], v173 offset:17680
    global_load_lds_dwordx4 v78, s[70:71] offset:0
    v_mfma_f32_16x16x32_bf16 v[194:197], v[64:67], a[220:223], v[194:197]
    v_mul_f32 v91, 0x3acccccd, v91
    v_mfma_f32_16x16x32_bf16 v[182:185], v[68:71], a[216:219], v[182:185]
    ds_read_b128 v[64:67], v173 offset:18720
    v_mfma_f32_16x16x32_bf16 v[198:201], v[68:71], a[220:223], v[198:201]
    v_fma_f32 v91, -v90, v90, v91
    s_waitcnt lgkmcnt(2)
    v_mfma_f32_16x16x32_bf16 v[186:189], v[48:51], a[216:219], v[186:189]
    ds_read_b128 v[68:71], v173 offset:19760
    v_mfma_f32_16x16x32_bf16 v[202:205], v[48:51], a[220:223], v[202:205]
    v_max_f32 v91, 0, v91
    global_load_lds_dwordx4 v79, s[70:71] offset:1024
    v_mfma_f32_16x16x32_bf16 v[190:193], v[52:55], a[216:219], v[190:193]
    ds_read_b128 v[48:51], v173 offset:12480
    v_mfma_f32_16x16x32_bf16 v[206:209], v[52:55], a[220:223], v[206:209]
    v_add_f32 v91, 0x3727c5ac, v91
    s_waitcnt lgkmcnt(2)
    v_mfma_f32_16x16x32_bf16 v[178:181], v[56:59], a[208:211], v[178:181]
    ds_read_b128 v[52:55], v173 offset:13520
    v_mfma_f32_16x16x32_bf16 v[194:197], v[56:59], a[212:215], v[194:197]
    v_rsq_f32 v92, v91
    v_mfma_f32_16x16x32_bf16 v[182:185], v[60:63], a[208:211], v[182:185]
    ds_read_b128 v[56:59], v173 offset:14560
    global_load_lds_dwordx4 v80, s[70:71] offset:2048
    v_mfma_f32_16x16x32_bf16 v[198:201], v[60:63], a[212:215], v[198:201]
    s_waitcnt lgkmcnt(3)
    v_mfma_f32_16x16x32_bf16 v[186:189], v[64:67], a[208:211], v[186:189]
    ds_read_b128 v[60:63], v173 offset:15600
    v_mul_f32_e64 v91, -v90, v92
    v_mfma_f32_16x16x32_bf16 v[202:205], v[64:67], a[212:215], v[202:205]
    v_mfma_f32_16x16x32_bf16 v[190:193], v[68:71], a[208:211], v[190:193]
    ds_read_b128 v[64:67], v173 offset:8320
    v_mov_b32 v90, v92
    v_mfma_f32_16x16x32_bf16 v[206:209], v[68:71], a[212:215], v[206:209]
    s_waitcnt lgkmcnt(3)
    v_mfma_f32_16x16x32_bf16 v[178:181], v[48:51], a[200:203], v[178:181]
    ds_read_b128 v[68:71], v173 offset:9360
    global_load_lds_dwordx4 v81, s[70:71] offset:3072
    v_mfma_f32_16x16x32_bf16 v[194:197], v[48:51], a[204:207], v[194:197]
    ds_write2st64_b32 v170, v90, v91 offset0:0 offset1:1
    v_mfma_f32_16x16x32_bf16 v[182:185], v[52:55], a[200:203], v[182:185]
    ds_read_b128 v[48:51], v173 offset:10400
    ds_read_b128 v[98:101], v171 offset:0
    v_mfma_f32_16x16x32_bf16 v[198:201], v[52:55], a[204:207], v[198:201]
    s_waitcnt lgkmcnt(5)
    v_mfma_f32_16x16x32_bf16 v[186:189], v[56:59], a[200:203], v[186:189]
    ds_read_b128 v[52:55], v173 offset:11440
    ds_read_b128 v[102:105], v171 offset:16
    v_mfma_f32_16x16x32_bf16 v[202:205], v[56:59], a[204:207], v[202:205]
    global_load_dwordx4 a[0:3], v4, s[52:53] offset:-4096 sc1
    v_mfma_f32_16x16x32_bf16 v[190:193], v[60:63], a[200:203], v[190:193]
    ds_read_b128 v[56:59], v173 offset:4160
    ds_read_b128 v[106:109], v171 offset:128
    v_mfma_f32_16x16x32_bf16 v[206:209], v[60:63], a[204:207], v[206:209]
    ds_read_b128 v[110:113], v171 offset:144
    s_waitcnt lgkmcnt(6)
    v_mfma_f32_16x16x32_bf16 v[178:181], v[64:67], a[192:195], v[178:181]
    ds_read_b128 v[60:63], v173 offset:5200
    v_mfma_f32_16x16x32_bf16 v[194:197], v[64:67], a[196:199], v[194:197]
    ds_read_b128 v[114:117], v171 offset:256
    v_mfma_f32_16x16x32_bf16 v[182:185], v[68:71], a[192:195], v[182:185]
    ds_read_b128 v[64:67], v173 offset:6240
    global_load_dwordx4 a[4:7], v7, s[58:59] offset:-4096 sc1
    v_mfma_f32_16x16x32_bf16 v[198:201], v[68:71], a[196:199], v[198:201]
    ds_read_b128 v[118:121], v171 offset:272
    s_waitcnt lgkmcnt(6)
    v_mfma_f32_16x16x32_bf16 v[186:189], v[48:51], a[192:195], v[186:189]
    ds_read_b128 v[68:71], v173 offset:7280
    v_mfma_f32_16x16x32_bf16 v[202:205], v[48:51], a[196:199], v[202:205]
    ds_read_b128 v[122:125], v171 offset:384
    v_mfma_f32_16x16x32_bf16 v[190:193], v[52:55], a[192:195], v[190:193]
    ds_read_b128 v[48:51], v173 offset:0
    v_mfma_f32_16x16x32_bf16 v[206:209], v[52:55], a[196:199], v[206:209]
    ds_read_b128 v[126:129], v171 offset:400
    s_waitcnt lgkmcnt(5)
    v_mfma_f32_16x16x32_bf16 v[178:181], v[56:59], a[184:187], v[178:181]
    ds_read_b128 v[52:55], v173 offset:1040
    global_load_dwordx4 a[8:11], v4, s[52:53] offset:-3072 sc1
    v_mfma_f32_16x16x32_bf16 v[194:197], v[56:59], a[188:191], v[194:197]
    ds_read_b32 v162, v172 offset:0
    v_mfma_f32_16x16x32_bf16 v[182:185], v[60:63], a[184:187], v[182:185]
    ds_read_b128 v[56:59], v173 offset:2080
    v_mfma_f32_16x16x32_bf16 v[198:201], v[60:63], a[188:191], v[198:201]
    ds_read_b32 v163, v172 offset:256
    s_waitcnt lgkmcnt(5)
    v_mfma_f32_16x16x32_bf16 v[186:189], v[64:67], a[184:187], v[186:189]
    ds_read_b128 v[60:63], v173 offset:3120
    ds_read_b32 v164, v172 offset:16
    v_mfma_f32_16x16x32_bf16 v[202:205], v[64:67], a[188:191], v[202:205]
    global_load_dwordx4 a[12:15], v7, s[58:59] offset:-3072 sc1
    v_mfma_f32_16x16x32_bf16 v[190:193], v[68:71], a[184:187], v[190:193]
    ds_read_b128 v[64:67], v4 offset:37440
    ds_read_b32 v165, v172 offset:272
    v_mfma_f32_16x16x32_bf16 v[206:209], v[68:71], a[188:191], v[206:209]
    s_waitcnt lgkmcnt(6)
    v_mfma_f32_16x16x32_bf16 v[178:181], v[48:51], a[176:179], v[178:181]
    ds_read_b128 v[68:71], v4 offset:38480
    ds_read_b32 v166, v172 offset:128
    v_mfma_f32_16x16x32_bf16 v[194:197], v[48:51], a[180:183], v[194:197]
    v_mfma_f32_16x16x32_bf16 v[182:185], v[52:55], a[176:179], v[182:185]
    ds_read_b128 v[48:51], v4 offset:39520
    ds_read_b32 v167, v172 offset:384
    v_mfma_f32_16x16x32_bf16 v[198:201], v[52:55], a[180:183], v[198:201]
    global_load_dwordx4 a[16:19], v4, s[52:53] offset:-2048 sc1
    s_waitcnt lgkmcnt(5)
    v_mfma_f32_16x16x32_bf16 v[186:189], v[56:59], a[176:179], v[186:189]
    ds_read_b128 v[52:55], v4 offset:40560
    ds_read_b32 v168, v172 offset:144
    v_mfma_f32_16x16x32_bf16 v[202:205], v[56:59], a[180:183], v[202:205]
    v_mfma_f32_16x16x32_bf16 v[190:193], v[60:63], a[176:179], v[190:193]
    ds_read_b128 v[56:59], v4 offset:33280
    ds_read_b32 v169, v172 offset:400
    v_mfma_f32_16x16x32_bf16 v[206:209], v[60:63], a[180:183], v[206:209]
    s_waitcnt lgkmcnt(6)
    v_mfma_f32_16x16x32_bf16 v[178:181], v[64:67], a[168:171], v[178:181]
    ds_read_b128 v[60:63], v4 offset:34320
    s_add_u32 s4, s88, 156672
    global_load_dwordx4 a[20:23], v7, s[58:59] offset:-2048 sc1
    v_mfma_f32_16x16x32_bf16 v[194:197], v[64:67], a[172:175], v[194:197]
    v_lshl_add_u32 v28, v2, 2, s4
    v_mfma_f32_16x16x32_bf16 v[182:185], v[68:71], a[168:171], v[182:185]
    ds_read_b128 v[64:67], v4 offset:35360
    v_mfma_f32_16x16x32_bf16 v[198:201], v[68:71], a[172:175], v[198:201]
    ds_read2_b32 v[8:9], v28 offset0:0 offset1:16
    s_waitcnt lgkmcnt(4)
    v_mfma_f32_16x16x32_bf16 v[186:189], v[48:51], a[168:171], v[186:189]
    ds_read_b128 v[68:71], v4 offset:36400
    v_mfma_f32_16x16x32_bf16 v[202:205], v[48:51], a[172:175], v[202:205]
    global_load_dwordx4 a[24:27], v4, s[52:53] offset:-1024 sc1
    ds_read2_b32 v[10:11], v28 offset0:32 offset1:48
    v_mfma_f32_16x16x32_bf16 v[190:193], v[52:55], a[168:171], v[190:193]
    ds_read_b128 v[48:51], v4 offset:29120
    v_mfma_f32_16x16x32_bf16 v[206:209], v[52:55], a[172:175], v[206:209]
    v_lshl_add_u32 v28, v3, 4, s4
    s_waitcnt lgkmcnt(4)
    v_mfma_f32_16x16x32_bf16 v[178:181], v[56:59], a[160:163], v[178:181]
    ds_read_b128 v[52:55], v4 offset:30160
    v_mfma_f32_16x16x32_bf16 v[194:197], v[56:59], a[164:167], v[194:197]
    ds_read_b128 v[12:15], v28 offset:256
    v_mfma_f32_16x16x32_bf16 v[182:185], v[60:63], a[160:163], v[182:185]
    ds_read_b128 v[56:59], v4 offset:31200
    global_load_dwordx4 a[28:31], v7, s[58:59] offset:-1024 sc1
    v_mfma_f32_16x16x32_bf16 v[198:201], v[60:63], a[164:167], v[198:201]
    ds_read_b128 v[16:19], v28 offset:320
    s_waitcnt lgkmcnt(4)
    v_mfma_f32_16x16x32_bf16 v[186:189], v[64:67], a[160:163], v[186:189]
    ds_read_b128 v[60:63], v4 offset:32240
    ds_read_b128 v[20:23], v28 offset:384
    v_mfma_f32_16x16x32_bf16 v[202:205], v[64:67], a[164:167], v[202:205]
    v_mfma_f32_16x16x32_bf16 v[190:193], v[68:71], a[160:163], v[190:193]
    ds_read_b128 v[64:67], v4 offset:24960
    ds_read_b128 v[24:27], v28 offset:448
    v_mfma_f32_16x16x32_bf16 v[206:209], v[68:71], a[164:167], v[206:209]
    s_waitcnt lgkmcnt(6)
    v_mfma_f32_16x16x32_bf16 v[178:181], v[48:51], a[152:155], v[178:181]
    ds_read_b128 v[68:71], v4 offset:26000
    global_load_dwordx4 a[32:35], v4, s[52:53] offset:0 sc1
    v_mfma_f32_16x16x32_bf16 v[194:197], v[48:51], a[156:159], v[194:197]
    v_fma_f32 v130, v114, v8, v9
    v_mfma_f32_16x16x32_bf16 v[182:185], v[52:55], a[152:155], v[182:185]
    ds_read_b128 v[48:51], v4 offset:27040
    v_fma_f32 v131, v115, v8, v9
    v_mfma_f32_16x16x32_bf16 v[198:201], v[52:55], a[156:159], v[198:201]
    s_waitcnt lgkmcnt(4)
    v_mfma_f32_16x16x32_bf16 v[186:189], v[56:59], a[152:155], v[186:189]
    ds_read_b128 v[52:55], v4 offset:28080
    v_fma_f32 v132, v116, v8, v9
    v_mfma_f32_16x16x32_bf16 v[202:205], v[56:59], a[156:159], v[202:205]
    global_load_dwordx4 a[36:39], v7, s[58:59] offset:0 sc1
    v_mfma_f32_16x16x32_bf16 v[190:193], v[60:63], a[152:155], v[190:193]
    ds_read_b128 v[56:59], v4 offset:20800
    v_fma_f32 v133, v117, v8, v9
    v_mfma_f32_16x16x32_bf16 v[206:209], v[60:63], a[156:159], v[206:209]
    s_waitcnt lgkmcnt(3)
    v_mfma_f32_16x16x32_bf16 v[178:181], v[64:67], a[144:147], v[178:181]
    ds_read_b128 v[60:63], v4 offset:21840
    v_fma_f32 v134, v118, v8, v9
    v_mfma_f32_16x16x32_bf16 v[194:197], v[64:67], a[148:151], v[194:197]
    v_fma_f32 v135, v119, v8, v9
    v_mfma_f32_16x16x32_bf16 v[182:185], v[68:71], a[144:147], v[182:185]
    ds_read_b128 v[64:67], v4 offset:22880
    global_load_dwordx4 a[40:43], v4, s[52:53] offset:1024 sc1
    v_mfma_f32_16x16x32_bf16 v[198:201], v[68:71], a[148:151], v[198:201]
    v_fma_f32 v136, v120, v8, v9
    s_waitcnt lgkmcnt(2)
    v_mfma_f32_16x16x32_bf16 v[186:189], v[48:51], a[144:147], v[186:189]
    ds_read_b128 v[68:71], v4 offset:23920
    v_mfma_f32_16x16x32_bf16 v[202:205], v[48:51], a[148:151], v[202:205]
    v_fma_f32 v137, v121, v8, v9
    v_mfma_f32_16x16x32_bf16 v[190:193], v[52:55], a[144:147], v[190:193]
    ds_read_b128 v[48:51], v4 offset:16640
    v_mfma_f32_16x16x32_bf16 v[206:209], v[52:55], a[148:151], v[206:209]
    v_fma_f32 v138, v122, v8, v9
    s_waitcnt lgkmcnt(2)
    v_mfma_f32_16x16x32_bf16 v[178:181], v[56:59], a[136:139], v[178:181]
    ds_read_b128 v[52:55], v4 offset:17680
    global_load_dwordx4 a[44:47], v7, s[58:59] offset:1024 sc1
    v_mfma_f32_16x16x32_bf16 v[194:197], v[56:59], a[140:143], v[194:197]
    v_fma_f32 v139, v123, v8, v9
    v_mfma_f32_16x16x32_bf16 v[182:185], v[60:63], a[136:139], v[182:185]
    ds_read_b128 v[56:59], v4 offset:18720
    v_mfma_f32_16x16x32_bf16 v[198:201], v[60:63], a[140:143], v[198:201]
    v_fma_f32 v140, v124, v8, v9
    s_waitcnt lgkmcnt(2)
    v_mfma_f32_16x16x32_bf16 v[186:189], v[64:67], a[136:139], v[186:189]
    ds_read_b128 v[60:63], v4 offset:19760
    v_mfma_f32_16x16x32_bf16 v[202:205], v[64:67], a[140:143], v[202:205]
    v_fma_f32 v141, v125, v8, v9
    global_load_dwordx4 a[48:51], v4, s[52:53] offset:2048 sc1
    v_mfma_f32_16x16x32_bf16 v[190:193], v[68:71], a[136:139], v[190:193]
    ds_read_b128 v[64:67], v4 offset:0
    v_fma_f32 v142, v126, v8, v9
    v_mfma_f32_16x16x32_bf16 v[206:209], v[68:71], a[140:143], v[206:209]
    s_waitcnt lgkmcnt(3)
    v_mfma_f32_16x16x32_bf16 v[178:181], v[48:51], a[128:131], v[178:181]
    ds_read_b128 v[68:71], v4 offset:1040
    v_fma_f32 v143, v127, v8, v9
    v_mfma_f32_16x16x32_bf16 v[194:197], v[48:51], a[132:135], v[194:197]
    v_mfma_f32_16x16x32_bf16 v[182:185], v[52:55], a[128:131], v[182:185]
    ds_read_b128 v[48:51], v4 offset:2080
    v_fma_f32 v144, v128, v8, v9
    v_mfma_f32_16x16x32_bf16 v[198:201], v[52:55], a[132:135], v[198:201]
    global_load_dwordx4 a[52:55], v7, s[58:59] offset:2048 sc1
    s_waitcnt lgkmcnt(2)
    v_mfma_f32_16x16x32_bf16 v[186:189], v[56:59], a[128:131], v[186:189]
    ds_read_b128 v[52:55], v4 offset:3120
    v_fma_f32 v145, v129, v8, v9
    v_mfma_f32_16x16x32_bf16 v[202:205], v[56:59], a[132:135], v[202:205]
    v_mfma_f32_16x16x32_bf16 v[190:193], v[60:63], a[128:131], v[190:193]
    ds_read_b128 v[56:59], v4 offset:4160
    v_fma_f32 v146, v114, v10, v11
    v_mfma_f32_16x16x32_bf16 v[206:209], v[60:63], a[132:135], v[206:209]
    s_waitcnt lgkmcnt(3)
    s_waitcnt vmcnt(29)
    v_mfma_f32_16x16x32_bf16 v[178:181], v[64:67], a[96:99], v[178:181]
    ds_read_b128 v[60:63], v4 offset:5200
    global_load_dwordx4 a[56:59], v4, s[52:53] offset:3072 sc1
    s_waitcnt vmcnt(29)
    v_mfma_f32_16x16x32_bf16 v[194:197], v[64:67], a[100:103], v[194:197]
    v_fma_f32 v147, v115, v10, v11
    v_mfma_f32_16x16x32_bf16 v[182:185], v[68:71], a[96:99], v[182:185]
    ds_read_b128 v[64:67], v4 offset:6240
    v_fma_f32 v148, v116, v10, v11
    v_mfma_f32_16x16x32_bf16 v[198:201], v[68:71], a[100:103], v[198:201]
    v_fma_f32 v149, v117, v10, v11
    s_waitcnt lgkmcnt(2)
    v_mfma_f32_16x16x32_bf16 v[186:189], v[48:51], a[96:99], v[186:189]
    ds_read_b128 v[68:71], v4 offset:7280
    v_mfma_f32_16x16x32_bf16 v[202:205], v[48:51], a[100:103], v[202:205]
    global_load_dwordx4 a[60:63], v7, s[58:59] offset:3072 sc1
    v_fma_f32 v150, v118, v10, v11
    v_mfma_f32_16x16x32_bf16 v[190:193], v[52:55], a[96:99], v[190:193]
    ds_read_b128 v[48:51], v4 offset:8320
    v_mfma_f32_16x16x32_bf16 v[206:209], v[52:55], a[100:103], v[206:209]
    v_fma_f32 v151, v119, v10, v11
    s_waitcnt lgkmcnt(2)
    s_waitcnt vmcnt(29)
    v_mfma_f32_16x16x32_bf16 v[178:181], v[56:59], a[104:107], v[178:181]
    ds_read_b128 v[52:55], v4 offset:9360
    s_waitcnt vmcnt(28)
    v_mfma_f32_16x16x32_bf16 v[194:197], v[56:59], a[108:111], v[194:197]
    v_fma_f32 v152, v120, v10, v11
    v_mfma_f32_16x16x32_bf16 v[182:185], v[60:63], a[104:107], v[182:185]
    ds_read_b128 v[56:59], v4 offset:10400
    global_load_dwordx4 a[64:67], v4, s[54:55] offset:-4096 sc1
    v_mfma_f32_16x16x32_bf16 v[198:201], v[60:63], a[108:111], v[198:201]
    v_fma_f32 v153, v121, v10, v11
    s_waitcnt lgkmcnt(2)
    v_mfma_f32_16x16x32_bf16 v[186:189], v[64:67], a[104:107], v[186:189]
    ds_read_b128 v[60:63], v4 offset:11440
    v_mfma_f32_16x16x32_bf16 v[202:205], v[64:67], a[108:111], v[202:205]
    v_fma_f32 v154, v122, v10, v11
    v_mfma_f32_16x16x32_bf16 v[190:193], v[68:71], a[104:107], v[190:193]
    ds_read_b128 v[64:67], v4 offset:12480
    v_mfma_f32_16x16x32_bf16 v[206:209], v[68:71], a[108:111], v[206:209]
    v_fma_f32 v155, v123, v10, v11
    s_waitcnt lgkmcnt(2)
    s_waitcnt vmcnt(28)
    v_mfma_f32_16x16x32_bf16 v[178:181], v[48:51], a[112:115], v[178:181]
    ds_read_b128 v[68:71], v4 offset:13520
    global_load_dwordx4 a[68:71], v7, s[60:61] offset:-4096 sc1
    s_waitcnt vmcnt(28)
    v_mfma_f32_16x16x32_bf16 v[194:197], v[48:51], a[116:119], v[194:197]
    v_fma_f32 v156, v124, v10, v11
    v_mfma_f32_16x16x32_bf16 v[182:185], v[52:55], a[112:115], v[182:185]
    ds_read_b128 v[48:51], v4 offset:14560
    v_fma_f32 v157, v125, v10, v11
    v_mfma_f32_16x16x32_bf16 v[198:201], v[52:55], a[116:119], v[198:201]
    s_waitcnt lgkmcnt(3)
    v_mfma_f32_16x16x32_bf16 v[186:189], v[56:59], a[112:115], v[186:189]
    ds_read_b128 v[52:55], v4 offset:15600
    v_fma_f32 v158, v126, v10, v11
    v_mfma_f32_16x16x32_bf16 v[202:205], v[56:59], a[116:119], v[202:205]
    global_load_dwordx4 a[72:75], v4, s[54:55] offset:-3072 sc1
    v_mfma_f32_16x16x32_bf16 v[190:193], v[60:63], a[112:115], v[190:193]
    v_fma_f32 v159, v127, v10, v11
    v_mfma_f32_16x16x32_bf16 v[206:209], v[60:63], a[116:119], v[206:209]
    s_waitcnt lgkmcnt(2)
    s_waitcnt vmcnt(28)
    v_mfma_f32_16x16x32_bf16 v[178:181], v[64:67], a[120:123], v[178:181]
    v_fma_f32 v160, v128, v10, v11
    s_waitcnt vmcnt(27)
    v_mfma_f32_16x16x32_bf16 v[194:197], v[64:67], a[124:127], v[194:197]
    v_mfma_f32_16x16x32_bf16 v[182:185], v[68:71], a[120:123], v[182:185]
    v_fma_f32 v161, v129, v10, v11
    global_load_dwordx4 a[76:79], v7, s[60:61] offset:-3072 sc1
    v_mfma_f32_16x16x32_bf16 v[198:201], v[68:71], a[124:127], v[198:201]
    s_waitcnt lgkmcnt(0)
    v_mfma_f32_16x16x32_bf16 v[186:189], v[48:51], a[120:123], v[186:189]
    v_mfma_f32_16x16x32_bf16 v[202:205], v[48:51], a[124:127], v[202:205]
    v_mfma_f32_16x16x32_bf16 v[190:193], v[52:55], a[120:123], v[190:193]
    v_mfma_f32_16x16x32_bf16 v[206:209], v[52:55], a[124:127], v[206:209]
    s_nop 7
    s_cmp_eq_u32 s101, 2
    s_cbranch_scc1 Lz_keep
    v_mov_b32 v194, 0
    v_mov_b32 v195, 0
    v_mov_b32 v196, 0
    v_mov_b32 v197, 0
    v_mov_b32 v198, 0
    v_mov_b32 v199, 0
    v_mov_b32 v200, 0
    v_mov_b32 v201, 0
    v_mov_b32 v202, 0
    v_mov_b32 v203, 0
    v_mov_b32 v204, 0
    v_mov_b32 v205, 0
    v_mov_b32 v206, 0
    v_mov_b32 v207, 0
    v_mov_b32 v208, 0
    v_mov_b32 v209, 0
    s_cmp_eq_u32 s101, 1
    s_cbranch_scc1 Lz_keep
    v_mov_b32 v178, 0
    v_mov_b32 v179, 0
    v_mov_b32 v180, 0
    v_mov_b32 v181, 0
    v_mov_b32 v182, 0
    v_mov_b32 v183, 0
    v_mov_b32 v184, 0
    v_mov_b32 v185, 0
    v_mov_b32 v186, 0
    v_mov_b32 v187, 0
    v_mov_b32 v188, 0
    v_mov_b32 v189, 0
    v_mov_b32 v190, 0
    v_mov_b32 v191, 0
    v_mov_b32 v192, 0
    v_mov_b32 v193, 0
Lz_keep:
    global_load_dwordx4 a[80:83], v4, s[54:55] offset:-2048 sc1
    v_pk_fma_f32 v[178:179], v[178:179], v[98:99], v[130:131] op_sel:[0,0,0] op_sel_hi:[1,1,1]
    v_pk_fma_f32 v[180:181], v[180:181], v[100:101], v[132:133] op_sel:[0,0,0] op_sel_hi:[1,1,1]
    v_pk_fma_f32 v[182:183], v[182:183], v[102:103], v[134:135] op_sel:[0,0,0] op_sel_hi:[1,1,1]
    v_pk_fma_f32 v[184:185], v[184:185], v[104:105], v[136:137] op_sel:[0,0,0] op_sel_hi:[1,1,1]
    global_load_dwordx4 a[84:87], v7, s[60:61] offset:-2048 sc1
    v_pk_fma_f32 v[186:187], v[186:187], v[106:107], v[138:139] op_sel:[0,0,0] op_sel_hi:[1,1,1]
    v_pk_fma_f32 v[188:189], v[188:189], v[108:109], v[140:141] op_sel:[0,0,0] op_sel_hi:[1,1,1]
    v_pk_fma_f32 v[190:191], v[190:191], v[110:111], v[142:143] op_sel:[0,0,0] op_sel_hi:[1,1,1]
    v_pk_fma_f32 v[192:193], v[192:193], v[112:113], v[144:145] op_sel:[0,0,0] op_sel_hi:[1,1,1]
    global_load_dwordx4 a[88:91], v4, s[54:55] offset:-1024 sc1
    v_pk_fma_f32 v[194:195], v[194:195], v[98:99], v[146:147] op_sel:[0,0,0] op_sel_hi:[1,1,1]
    v_pk_fma_f32 v[196:197], v[196:197], v[100:101], v[148:149] op_sel:[0,0,0] op_sel_hi:[1,1,1]
    v_pk_fma_f32 v[198:199], v[198:199], v[102:103], v[150:151] op_sel:[0,0,0] op_sel_hi:[1,1,1]
    v_pk_fma_f32 v[200:201], v[200:201], v[104:105], v[152:153] op_sel:[0,0,0] op_sel_hi:[1,1,1]
    v_pk_fma_f32 v[202:203], v[202:203], v[106:107], v[154:155] op_sel:[0,0,0] op_sel_hi:[1,1,1]
    global_load_dwordx4 a[92:95], v7, s[60:61] offset:-1024 sc1
    v_pk_fma_f32 v[204:205], v[204:205], v[108:109], v[156:157] op_sel:[0,0,0] op_sel_hi:[1,1,1]
    v_pk_fma_f32 v[206:207], v[206:207], v[110:111], v[158:159] op_sel:[0,0,0] op_sel_hi:[1,1,1]
    v_pk_fma_f32 v[208:209], v[208:209], v[112:113], v[160:161] op_sel:[0,0,0] op_sel_hi:[1,1,1]
    v_pk_mul_f32 v[130:131], v[178:179], v[178:179] op_sel:[0,0] op_sel_hi:[1,1]
    global_load_dwordx4 a[96:99], v4, s[54:55] offset:0 sc1
    v_pk_mul_f32 v[132:133], v[180:181], v[180:181] op_sel:[0,0] op_sel_hi:[1,1]
    v_pk_mul_f32 v[134:135], v[182:183], v[182:183] op_sel:[0,0] op_sel_hi:[1,1]
    v_pk_mul_f32 v[136:137], v[184:185], v[184:185] op_sel:[0,0] op_sel_hi:[1,1]
    v_pk_mul_f32 v[138:139], v[186:187], v[186:187] op_sel:[0,0] op_sel_hi:[1,1]
    global_load_dwordx4 a[100:103], v7, s[60:61] offset:0 sc1
    v_pk_mul_f32 v[140:141], v[188:189], v[188:189] op_sel:[0,0] op_sel_hi:[1,1]
    v_pk_mul_f32 v[142:143], v[190:191], v[190:191] op_sel:[0,0] op_sel_hi:[1,1]
    v_pk_mul_f32 v[144:145], v[192:193], v[192:193] op_sel:[0,0] op_sel_hi:[1,1]
    v_pk_mul_f32 v[146:147], v[194:195], v[194:195] op_sel:[0,0] op_sel_hi:[1,1]
    v_pk_mul_f32 v[148:149], v[196:197], v[196:197] op_sel:[0,0] op_sel_hi:[1,1]
    global_load_dwordx4 a[104:107], v4, s[54:55] offset:1024 sc1
    v_pk_mul_f32 v[150:151], v[198:199], v[198:199] op_sel:[0,0] op_sel_hi:[1,1]
    v_pk_mul_f32 v[152:153], v[200:201], v[200:201] op_sel:[0,0] op_sel_hi:[1,1]
    v_pk_mul_f32 v[154:155], v[202:203], v[202:203] op_sel:[0,0] op_sel_hi:[1,1]
    v_pk_mul_f32 v[156:157], v[204:205], v[204:205] op_sel:[0,0] op_sel_hi:[1,1]
    global_load_dwordx4 a[108:111], v7, s[60:61] offset:1024 sc1
    v_pk_mul_f32 v[158:159], v[206:207], v[206:207] op_sel:[0,0] op_sel_hi:[1,1]
    v_pk_mul_f32 v[160:161], v[208:209], v[208:209] op_sel:[0,0] op_sel_hi:[1,1]
    v_pk_fma_f32 v[130:131], v[130:131], s[84:85], s[84:85] op_sel:[0,1,0] op_sel_hi:[1,1,0]
    v_pk_fma_f32 v[132:133], v[132:133], s[84:85], s[84:85] op_sel:[0,1,0] op_sel_hi:[1,1,0]
    global_load_dwordx4 a[112:115], v4, s[54:55] offset:2048 sc1
    v_pk_fma_f32 v[134:135], v[134:135], s[84:85], s[84:85] op_sel:[0,1,0] op_sel_hi:[1,1,0]
    v_pk_fma_f32 v[136:137], v[136:137], s[84:85], s[84:85] op_sel:[0,1,0] op_sel_hi:[1,1,0]
    v_pk_fma_f32 v[138:139], v[138:139], s[84:85], s[84:85] op_sel:[0,1,0] op_sel_hi:[1,1,0]
    v_pk_fma_f32 v[140:141], v[140:141], s[84:85], s[84:85] op_sel:[0,1,0] op_sel_hi:[1,1,0]
    v_pk_fma_f32 v[142:143], v[142:143], s[84:85], s[84:85] op_sel:[0,1,0] op_sel_hi:[1,1,0]
    global_load_dwordx4 a[116:119], v7, s[60:61] offset:2048 sc1
    v_pk_fma_f32 v[144:145], v[144:145], s[84:85], s[84:85] op_sel:[0,1,0] op_sel_hi:[1,1,0]
    v_pk_fma_f32 v[146:147], v[146:147], s[84:85], s[84:85] op_sel:[0,1,0] op_sel_hi:[1,1,0]
    v_pk_fma_f32 v[148:149], v[148:149], s[84:85], s[84:85] op_sel:[0,1,0] op_sel_hi:[1,1,0]
    v_pk_fma_f32 v[150:151], v[150:151], s[84:85], s[84:85] op_sel:[0,1,0] op_sel_hi:[1,1,0]
    global_load_dwordx4 a[120:123], v4, s[54:55] offset:3072 sc1
    v_pk_fma_f32 v[152:153], v[152:153], s[84:85], s[84:85] op_sel:[0,1,0] op_sel_hi:[1,1,0]
    v_pk_fma_f32 v[154:155], v[154:155], s[84:85], s[84:85] op_sel:[0,1,0] op_sel_hi:[1,1,0]
    v_pk_fma_f32 v[156:157], v[156:157], s[84:85], s[84:85] op_sel:[0,1,0] op_sel_hi:[1,1,0]
    v_pk_fma_f32 v[158:159], v[158:159], s[84:85], s[84:85] op_sel:[0,1,0] op_sel_hi:[1,1,0]
    global_load_dwordx4 a[124:127], v7, s[60:61] offset:3072 sc1
    v_pk_fma_f32 v[160:161], v[160:161], s[84:85], s[84:85] op_sel:[0,1,0] op_sel_hi:[1,1,0]
    v_pk_mul_f32 v[130:131], v[130:131], v[178:179] op_sel:[0,0] op_sel_hi:[1,1]
    v_pk_mul_f32 v[132:133], v[132:133], v[180:181] op_sel:[0,0] op_sel_hi:[1,1]
    v_pk_mul_f32 v[134:135], v[134:135], v[182:183] op_sel:[0,0] op_sel_hi:[1,1]
    v_pk_mul_f32 v[136:137], v[136:137], v[184:185] op_sel:[0,0] op_sel_hi:[1,1]
    global_load_dwordx4 a[128:131], v4, s[56:57] offset:-4096 sc1
    v_pk_mul_f32 v[138:139], v[138:139], v[186:187] op_sel:[0,0] op_sel_hi:[1,1]
    v_pk_mul_f32 v[140:141], v[140:141], v[188:189] op_sel:[0,0] op_sel_hi:[1,1]
    v_pk_mul_f32 v[142:143], v[142:143], v[190:191] op_sel:[0,0] op_sel_hi:[1,1]
    v_pk_mul_f32 v[144:145], v[144:145], v[192:193] op_sel:[0,0] op_sel_hi:[1,1]
    global_load_dwordx4 a[132:135], v7, s[62:63] offset:-4096 sc1
    v_pk_mul_f32 v[146:147], v[146:147], v[194:195] op_sel:[0,0] op_sel_hi:[1,1]
    v_pk_mul_f32 v[148:149], v[148:149], v[196:197] op_sel:[0,0] op_sel_hi:[1,1]
    v_pk_mul_f32 v[150:151], v[150:151], v[198:199] op_sel:[0,0] op_sel_hi:[1,1]
    v_pk_mul_f32 v[152:153], v[152:153], v[200:201] op_sel:[0,0] op_sel_hi:[1,1]
    global_load_dwordx4 a[136:139], v4, s[56:57] offset:-3072 sc1
    v_pk_mul_f32 v[154:155], v[154:155], v[202:203] op_sel:[0,0] op_sel_hi:[1,1]
    v_pk_mul_f32 v[156:157], v[156:157], v[204:205] op_sel:[0,0] op_sel_hi:[1,1]
    v_pk_mul_f32 v[158:159], v[158:159], v[206:207] op_sel:[0,0] op_sel_hi:[1,1]
    v_pk_mul_f32 v[160:161], v[160:161], v[208:209] op_sel:[0,0] op_sel_hi:[1,1]
    v_exp_f32 v130, v130
    global_load_dwordx4 a[140:143], v7, s[62:63] offset:-3072 sc1
    v_exp_f32 v131, v131
    v_exp_f32 v132, v132
    v_exp_f32 v133, v133
    v_exp_f32 v134, v134
    global_load_dwordx4 a[144:147], v4, s[56:57] offset:-2048 sc1
    v_exp_f32 v135, v135
    v_exp_f32 v136, v136
    v_exp_f32 v137, v137
    v_exp_f32 v138, v138
    global_load_dwordx4 a[148:151], v7, s[62:63] offset:-2048 sc1
    v_exp_f32 v139, v139
    v_exp_f32 v140, v140
    v_exp_f32 v141, v141
    v_exp_f32 v142, v142
    v_exp_f32 v143, v143
    global_load_dwordx4 a[152:155], v4, s[56:57] offset:-1024 sc1
    v_exp_f32 v144, v144
    v_exp_f32 v145, v145
    v_exp_f32 v146, v146
    v_exp_f32 v147, v147
    global_load_dwordx4 a[156:159], v7, s[62:63] offset:-1024 sc1
    v_exp_f32 v148, v148
    v_exp_f32 v149, v149
    v_exp_f32 v150, v150
    v_exp_f32 v151, v151
    ds_read_b128 a[224:227], v82 offset:0
    v_exp_f32 v152, v152
    v_exp_f32 v153, v153
    v_exp_f32 v154, v154
    v_exp_f32 v155, v155
    v_exp_f32 v156, v156
    ds_read_b128 a[228:231], v84 offset:0
    v_exp_f32 v157, v157
    v_exp_f32 v158, v158
    v_exp_f32 v159, v159
    v_exp_f32 v160, v160
    ds_read_b128 a[232:235], v86 offset:0
    v_exp_f32 v161, v161
    v_pk_add_f32 v[130:131], v[130:131], 1.0 op_sel:[0,0] op_sel_hi:[1,0]
    v_pk_add_f32 v[132:133], v[132:133], 1.0 op_sel:[0,0] op_sel_hi:[1,0]
    v_pk_add_f32 v[134:135], v[134:135], 1.0 op_sel:[0,0] op_sel_hi:[1,0]
    ds_read_b128 a[236:239], v88 offset:0
    v_pk_add_f32 v[136:137], v[136:137], 1.0 op_sel:[0,0] op_sel_hi:[1,0]
    v_pk_add_f32 v[138:139], v[138:139], 1.0 op_sel:[0,0] op_sel_hi:[1,0]
    v_pk_add_f32 v[140:141], v[140:141], 1.0 op_sel:[0,0] op_sel_hi:[1,0]
    v_pk_add_f32 v[142:143], v[142:143], 1.0 op_sel:[0,0] op_sel_hi:[1,0]
    v_pk_add_f32 v[144:145], v[144:145], 1.0 op_sel:[0,0] op_sel_hi:[1,0]
    ds_read_b128 a[240:243], v83 offset:0
    v_pk_add_f32 v[146:147], v[146:147], 1.0 op_sel:[0,0] op_sel_hi:[1,0]
    v_pk_add_f32 v[148:149], v[148:149], 1.0 op_sel:[0,0] op_sel_hi:[1,0]
    v_pk_add_f32 v[150:151], v[150:151], 1.0 op_sel:[0,0] op_sel_hi:[1,0]
    v_pk_add_f32 v[152:153], v[152:153], 1.0 op_sel:[0,0] op_sel_hi:[1,0]
    ds_read_b128 a[244:247], v85 offset:0
    v_pk_add_f32 v[154:155], v[154:155], 1.0 op_sel:[0,0] op_sel_hi:[1,0]
    v_pk_add_f32 v[156:157], v[156:157], 1.0 op_sel:[0,0] op_sel_hi:[1,0]
    v_pk_add_f32 v[158:159], v[158:159], 1.0 op_sel:[0,0] op_sel_hi:[1,0]
    v_pk_add_f32 v[160:161], v[160:161], 1.0 op_sel:[0,0] op_sel_hi:[1,0]
    v_rcp_f32 v130, v130
    ds_read_b128 a[248:251], v87 offset:0
    v_rcp_f32 v131, v131
    v_rcp_f32 v132, v132
    v_rcp_f32 v133, v133
    v_rcp_f32 v134, v134
    ds_read_b128 a[252:255], v89 offset:0
    v_rcp_f32 v135, v135
    v_rcp_f32 v136, v136
    v_rcp_f32 v137, v137
    v_rcp_f32 v138, v138
    s_waitcnt lgkmcnt(0)
    s_add_u32 m0, s89, 0
    s_nop 0
    global_load_lds_dwordx4 v74, s[72:73] offset:0
    v_rcp_f32 v139, v139
    v_rcp_f32 v140, v140
    v_rcp_f32 v141, v141
    v_rcp_f32 v142, v142
    v_rcp_f32 v143, v143
    global_load_lds_dwordx4 v75, s[72:73] offset:1024
    v_rcp_f32 v144, v144
    v_rcp_f32 v145, v145
    v_rcp_f32 v146, v146
    v_rcp_f32 v147, v147
    global_load_lds_dwordx4 v76, s[72:73] offset:2048
    v_rcp_f32 v148, v148
    v_rcp_f32 v149, v149
    v_rcp_f32 v150, v150
    v_rcp_f32 v151, v151
    global_load_lds_dwordx4 v77, s[72:73] offset:3072
    v_rcp_f32 v152, v152
    v_rcp_f32 v153, v153
    v_rcp_f32 v154, v154
    v_rcp_f32 v155, v155
    v_rcp_f32 v156, v156
    s_add_u32 m0, s89, 4096
    s_nop 0
    global_load_lds_dwordx4 v78, s[72:73] offset:0
    v_rcp_f32 v157, v157
    v_rcp_f32 v158, v158
    v_rcp_f32 v159, v159
    v_rcp_f32 v160, v160
    global_load_lds_dwordx4 v79, s[72:73] offset:1024
    v_rcp_f32 v161, v161
    v_pk_mul_f32 v[178:179], v[178:179], v[130:131] op_sel:[0,0] op_sel_hi:[1,1]
    v_pk_mul_f32 v[180:181], v[180:181], v[132:133] op_sel:[0,0] op_sel_hi:[1,1]
    v_pk_mul_f32 v[182:183], v[182:183], v[134:135] op_sel:[0,0] op_sel_hi:[1,1]
    global_load_lds_dwordx4 v80, s[72:73] offset:2048
    v_pk_mul_f32 v[184:185], v[184:185], v[136:137] op_sel:[0,0] op_sel_hi:[1,1]
    v_pk_mul_f32 v[186:187], v[186:187], v[138:139] op_sel:[0,0] op_sel_hi:[1,1]
    v_pk_mul_f32 v[188:189], v[188:189], v[140:141] op_sel:[0,0] op_sel_hi:[1,1]
    v_pk_mul_f32 v[190:191], v[190:191], v[142:143] op_sel:[0,0] op_sel_hi:[1,1]
    v_pk_mul_f32 v[192:193], v[192:193], v[144:145] op_sel:[0,0] op_sel_hi:[1,1]
    global_load_lds_dwordx4 v81, s[72:73] offset:3072
    v_pk_mul_f32 v[194:195], v[194:195], v[146:147] op_sel:[0,0] op_sel_hi:[1,1]
    v_pk_mul_f32 v[196:197], v[196:197], v[148:149] op_sel:[0,0] op_sel_hi:[1,1]
    v_pk_mul_f32 v[198:199], v[198:199], v[150:151] op_sel:[0,0] op_sel_hi:[1,1]
    v_pk_mul_f32 v[200:201], v[200:201], v[152:153] op_sel:[0,0] op_sel_hi:[1,1]
    s_waitcnt vmcnt(48)
    ds_read_b128 a[192:195], v82 offset:8192
    v_pk_mul_f32 v[202:203], v[202:203], v[154:155] op_sel:[0,0] op_sel_hi:[1,1]
    v_pk_mul_f32 v[204:205], v[204:205], v[156:157] op_sel:[0,0] op_sel_hi:[1,1]
    v_pk_mul_f32 v[206:207], v[206:207], v[158:159] op_sel:[0,0] op_sel_hi:[1,1]
    v_pk_mul_f32 v[208:209], v[208:209], v[160:161] op_sel:[0,0] op_sel_hi:[1,1]
    ds_read_b128 a[196:199], v84 offset:8192
    v_pk_add_f32 v[130:131], v[178:179], v[194:195] op_sel:[0,0] op_sel_hi:[1,1]
    v_pk_mul_f32 v[146:147], v[178:179], v[178:179] op_sel:[0,0] op_sel_hi:[1,1]
    v_pk_add_f32 v[132:133], v[180:181], v[196:197] op_sel:[0,0] op_sel_hi:[1,1]
    v_pk_mul_f32 v[148:149], v[180:181], v[180:181] op_sel:[0,0] op_sel_hi:[1,1]
    v_pk_add_f32 v[134:135], v[182:183], v[198:199] op_sel:[0,0] op_sel_hi:[1,1]
    ds_read_b128 a[200:203], v86 offset:8192
    v_pk_mul_f32 v[150:151], v[182:183], v[182:183] op_sel:[0,0] op_sel_hi:[1,1]
    v_pk_add_f32 v[136:137], v[184:185], v[200:201] op_sel:[0,0] op_sel_hi:[1,1]
    v_pk_mul_f32 v[152:153], v[184:185], v[184:185] op_sel:[0,0] op_sel_hi:[1,1]
    v_pk_add_f32 v[138:139], v[186:187], v[202:203] op_sel:[0,0] op_sel_hi:[1,1]
    ds_read_b128 a[204:207], v88 offset:8192
    v_pk_mul_f32 v[154:155], v[186:187], v[186:187] op_sel:[0,0] op_sel_hi:[1,1]
    v_pk_add_f32 v[140:141], v[188:189], v[204:205] op_sel:[0,0] op_sel_hi:[1,1]
    v_pk_mul_f32 v[156:157], v[188:189], v[188:189] op_sel:[0,0] op_sel_hi:[1,1]
    v_pk_add_f32 v[142:143], v[190:191], v[206:207] op_sel:[0,0] op_sel_hi:[1,1]
    ds_read_b128 a[208:211], v83 offset:8192
    v_pk_mul_f32 v[158:159], v[190:191], v[190:191] op_sel:[0,0] op_sel_hi:[1,1]
    v_pk_add_f32 v[144:145], v[192:193], v[208:209] op_sel:[0,0] op_sel_hi:[1,1]
    v_pk_mul_f32 v[160:161], v[192:193], v[192:193] op_sel:[0,0] op_sel_hi:[1,1]
    v_pk_fma_f32 v[146:147], v[194:195], v[194:195], v[146:147] op_sel:[0,0,0] op_sel_hi:[1,1,1]
    v_pk_fma_f32 v[148:149], v[196:197], v[196:197], v[148:149] op_sel:[0,0,0] op_sel_hi:[1,1,1]
    ds_read_b128 a[212:215], v85 offset:8192
    v_pk_fma_f32 v[150:151], v[198:199], v[198:199], v[150:151] op_sel:[0,0,0] op_sel_hi:[1,1,1]
    v_pk_fma_f32 v[152:153], v[200:201], v[200:201], v[152:153] op_sel:[0,0,0] op_sel_hi:[1,1,1]
    v_pk_fma_f32 v[154:155], v[202:203], v[202:203], v[154:155] op_sel:[0,0,0] op_sel_hi:[1,1,1]
    v_pk_fma_f32 v[156:157], v[204:205], v[204:205], v[156:157] op_sel:[0,0,0] op_sel_hi:[1,1,1]
    ds_read_b128 a[216:219], v87 offset:8192
    v_pk_fma_f32 v[158:159], v[206:207], v[206:207], v[158:159] op_sel:[0,0,0] op_sel_hi:[1,1,1]
    v_pk_fma_f32 v[160:161], v[208:209], v[208:209], v[160:161] op_sel:[0,0,0] op_sel_hi:[1,1,1]
    v_add_f32_dpp v98, v130, v130 row_ror:8 row_mask:0xf bank_mask:0x3
    v_add_f32_dpp v99, v131, v131 row_ror:8 row_mask:0xf bank_mask:0x3
    ds_read_b128 a[220:223], v89 offset:8192
    v_add_f32_dpp v100, v132, v132 row_ror:8 row_mask:0xf bank_mask:0x3
    v_add_f32_dpp v101, v133, v133 row_ror:8 row_mask:0xf bank_mask:0x3
    v_add_f32_dpp v102, v134, v134 row_ror:8 row_mask:0xf bank_mask:0x3
    v_add_f32_dpp v103, v135, v135 row_ror:8 row_mask:0xf bank_mask:0x3
    v_add_f32_dpp v104, v136, v136 row_ror:8 row_mask:0xf bank_mask:0x3
    s_waitcnt lgkmcnt(0)
    s_add_u32 m0, s89, 8192
    s_nop 0
    global_load_lds_dwordx4 v74, s[74:75] offset:0
    v_add_f32_dpp v105, v137, v137 row_ror:8 row_mask:0xf bank_mask:0x3
    v_add_f32_dpp v106, v138, v138 row_ror:8 row_mask:0xf bank_mask:0x3
    v_add_f32_dpp v107, v139, v139 row_ror:8 row_mask:0xf bank_mask:0x3
    v_add_f32_dpp v108, v140, v140 row_ror:8 row_mask:0xf bank_mask:0x3
    global_load_lds_dwordx4 v75, s[74:75] offset:1024
    v_add_f32_dpp v109, v141, v141 row_ror:8 row_mask:0xf bank_mask:0x3
    v_add_f32_dpp v110, v142, v142 row_ror:8 row_mask:0xf bank_mask:0x3
    v_add_f32_dpp v111, v143, v143 row_ror:8 row_mask:0xf bank_mask:0x3
    v_add_f32_dpp v112, v144, v144 row_ror:8 row_mask:0xf bank_mask:0x3
    global_load_lds_dwordx4 v76, s[74:75] offset:2048
    v_add_f32_dpp v113, v145, v145 row_ror:8 row_mask:0xf bank_mask:0x3
    v_add_f32_dpp v98, v146, v146 row_ror:8 row_mask:0xf bank_mask:0xc
    v_add_f32_dpp v99, v147, v147 row_ror:8 row_mask:0xf bank_mask:0xc
    v_add_f32_dpp v100, v148, v148 row_ror:8 row_mask:0xf bank_mask:0xc
    v_add_f32_dpp v101, v149, v149 row_ror:8 row_mask:0xf bank_mask:0xc
    global_load_lds_dwordx4 v77, s[74:75] offset:3072
    v_add_f32_dpp v102, v150, v150 row_ror:8 row_mask:0xf bank_mask:0xc
    v_add_f32_dpp v103, v151, v151 row_ror:8 row_mask:0xf bank_mask:0xc
    v_add_f32_dpp v104, v152, v152 row_ror:8 row_mask:0xf bank_mask:0xc
    v_add_f32_dpp v105, v153, v153 row_ror:8 row_mask:0xf bank_mask:0xc
    s_add_u32 m0, s89, 12288
    s_nop 0
    global_load_lds_dwordx4 v78, s[74:75] offset:0
    v_add_f32_dpp v106, v154, v154 row_ror:8 row_mask:0xf bank_mask:0xc
    v_add_f32_dpp v107, v155, v155 row_ror:8 row_mask:0xf bank_mask:0xc
    v_add_f32_dpp v108, v156, v156 row_ror:8 row_mask:0xf bank_mask:0xc
    v_add_f32_dpp v109, v157, v157 row_ror:8 row_mask:0xf bank_mask:0xc
    global_load_lds_dwordx4 v79, s[74:75] offset:1024
    v_add_f32_dpp v110, v158, v158 row_ror:8 row_mask:0xf bank_mask:0xc
    v_add_f32_dpp v111, v159, v159 row_ror:8 row_mask:0xf bank_mask:0xc
    v_add_f32_dpp v112, v160, v160 row_ror:8 row_mask:0xf bank_mask:0xc
    v_add_f32_dpp v113, v161, v161 row_ror:8 row_mask:0xf bank_mask:0xc
    v_add_f32_dpp v130, v98, v98 row_half_mirror row_mask:0xf bank_mask:0x5
    global_load_lds_dwordx4 v80, s[74:75] offset:2048
    v_add_f32_dpp v131, v99, v99 row_half_mirror row_mask:0xf bank_mask:0x5
    v_add_f32_dpp v132, v100, v100 row_half_mirror row_mask:0xf bank_mask:0x5
    v_add_f32_dpp v133, v101, v101 row_half_mirror row_mask:0xf bank_mask:0x5
    v_add_f32_dpp v134, v102, v102 row_half_mirror row_mask:0xf bank_mask:0x5
    global_load_lds_dwordx4 v81, s[74:75] offset:3072
    v_add_f32_dpp v135, v103, v103 row_half_mirror row_mask:0xf bank_mask:0x5
    v_add_f32_dpp v136, v104, v104 row_half_mirror row_mask:0xf bank_mask:0x5
    v_add_f32_dpp v137, v105, v105 row_half_mirror row_mask:0xf bank_mask:0x5
    v_add_f32_dpp v130, v106, v106 row_half_mirror row_mask:0xf bank_mask:0xa
    v_add_f32_dpp v131, v107, v107 row_half_mirror row_mask:0xf bank_mask:0xa
    v_add_f32_dpp v132, v108, v108 row_half_mirror row_mask:0xf bank_mask:0xa
    v_add_f32_dpp v133, v109, v109 row_half_mirror row_mask:0xf bank_mask:0xa
    v_add_f32_dpp v134, v110, v110 row_half_mirror row_mask:0xf bank_mask:0xa
    v_add_f32_dpp v135, v111, v111 row_half_mirror row_mask:0xf bank_mask:0xa
    v_add_f32_dpp v136, v112, v112 row_half_mirror row_mask:0xf bank_mask:0xa
    v_add_f32_dpp v137, v113, v113 row_half_mirror row_mask:0xf bank_mask:0xa
    v_add_f32_dpp v130, v130, v130 quad_perm:[1,0,3,2] row_mask:0xf bank_mask:0xf
    v_add_f32_dpp v131, v131, v131 quad_perm:[1,0,3,2] row_mask:0xf bank_mask:0xf
    v_add_f32_dpp v132, v132, v132 quad_perm:[1,0,3,2] row_mask:0xf bank_mask:0xf
    v_add_f32_dpp v133, v133, v133 quad_perm:[1,0,3,2] row_mask:0xf bank_mask:0xf
    v_add_f32_dpp v134, v134, v134 quad_perm:[1,0,3,2] row_mask:0xf bank_mask:0xf
    v_add_f32_dpp v135, v135, v135 quad_perm:[1,0,3,2] row_mask:0xf bank_mask:0xf
    v_add_f32_dpp v136, v136, v136 quad_perm:[1,0,3,2] row_mask:0xf bank_mask:0xf
    v_add_f32_dpp v137, v137, v137 quad_perm:[1,0,3,2] row_mask:0xf bank_mask:0xf
    v_add_f32_dpp v130, v130, v130 quad_perm:[2,3,0,1] row_mask:0xf bank_mask:0xf
    v_add_f32_dpp v131, v131, v131 quad_perm:[2,3,0,1] row_mask:0xf bank_mask:0xf
    v_add_f32_dpp v132, v132, v132 quad_perm:[2,3,0,1] row_mask:0xf bank_mask:0xf
    v_add_f32_dpp v133, v133, v133 quad_perm:[2,3,0,1] row_mask:0xf bank_mask:0xf
    v_add_f32_dpp v134, v134, v134 quad_perm:[2,3,0,1] row_mask:0xf bank_mask:0xf
    v_add_f32_dpp v135, v135, v135 quad_perm:[2,3,0,1] row_mask:0xf bank_mask:0xf
    v_add_f32_dpp v136, v136, v136 quad_perm:[2,3,0,1] row_mask:0xf bank_mask:0xf
    v_add_f32_dpp v137, v137, v137 quad_perm:[2,3,0,1] row_mask:0xf bank_mask:0xf
    v_lshrrev_b32 v28, 2, v2
    v_lshl_add_u32 v28, v28, 7, v171
    ds_write_b128 v28, v[130:133]
    ds_write_b128 v28, v[134:137] offset:16
    s_waitcnt lgkmcnt(0)
    s_barrier
    v_lshlrev_b32 v28, 2, v1
    v_add_u32 v28, 150784, v28
    ds_read2st64_b32 v[90:91], v28 offset0:0 offset1:1
    ds_read2st64_b32 v[92:93], v28 offset0:2 offset1:3
    ds_read2st64_b32 v[94:95], v28 offset0:4 offset1:5
    ds_read2st64_b32 v[96:97], v28 offset0:6 offset1:7
    s_lshl_b32 s4, s40, 12
    s_add_u32 s4, s4, 12451840
    v_add_u32 v174, s4, v30
    s_lshl_b32 s4, s41, 9
    v_add_u32 v28, s4, v174
    v_subrev_u32 v170, 2048, v170
    v_subrev_u32 v171, 2048, v171
    s_waitcnt lgkmcnt(2)
    v_pk_add_f32 v[90:91], v[90:91], v[92:93] op_sel:[0,0] op_sel_hi:[1,1]
    s_waitcnt lgkmcnt(0)
    v_pk_add_f32 v[94:95], v[94:95], v[96:97] op_sel:[0,0] op_sel_hi:[1,1]
    v_pk_add_f32 v[90:91], v[90:91], v[94:95] op_sel:[0,0] op_sel_hi:[1,1]
    v_min_u32 v90, -2, v90
    v_min_u32 v91, -2, v91
    s_lshl_b32 s4, s3, 4
    s_lshl_b64 exec, 0xffff, s4
    global_store_dwordx2 v28, v[90:91], s[38:39] sc1
    s_mov_b64 exec, -1
    ds_read_b128 v[48:51], v4 offset:0
    ds_read_b128 v[52:55], v4 offset:1040
    ds_read_b128 v[56:59], v4 offset:2080
    ds_read_b128 v[60:63], v4 offset:3120
    ds_read_b128 v[64:67], v4 offset:4160
    s_waitcnt lgkmcnt(3)
    s_waitcnt vmcnt(56)
    v_mfma_f32_16x16x32_bf16 v[210:213], a[0:3], v[48:51], 0
    ds_read_b128 v[68:71], v4 offset:5200
    s_waitcnt vmcnt(55)
    v_mfma_f32_16x16x32_bf16 v[226:229], a[4:7], v[48:51], 0
    v_mfma_f32_16x16x32_bf16 v[214:217], a[0:3], v[52:55], 0
    ds_read_b128 v[48:51], v4 offset:6240
    s_waitcnt vmcnt(9)
    ds_read_b128 a[160:163], v82 offset:0
    v_mfma_f32_16x16x32_bf16 v[230:233], a[4:7], v[52:55], 0
    v_min_u32 v175, 26, v1
    s_waitcnt lgkmcnt(4)
    v_mfma_f32_16x16x32_bf16 v[218:221], a[0:3], v[56:59], 0
    ds_read_b128 v[52:55], v4 offset:7280
    v_lshlrev_b32 v175, 7, v175
    v_mfma_f32_16x16x32_bf16 v[234:237], a[4:7], v[56:59], 0
    ds_read_b128 a[164:167], v84 offset:0
    v_mfma_f32_16x16x32_bf16 v[222:225], a[0:3], v[60:63], 0
    ds_read_b128 v[56:59], v4 offset:8320
    v_add_u32 v175, 98304, v175
    v_mfma_f32_16x16x32_bf16 v[238:241], a[4:7], v[60:63], 0
    ds_read_b128 a[168:171], v86 offset:0
    s_waitcnt lgkmcnt(5)
    v_mfma_f32_16x16x32_bf16 v[210:213], a[8:11], v[64:67], v[210:213]
    ds_read_b128 v[60:63], v4 offset:9360
    ds_read_b128 a[172:175], v88 offset:0
    v_mfma_f32_16x16x32_bf16 v[226:229], a[12:15], v[64:67], v[226:229]
    global_load_dword v250, v175, s[38:39] sc1
    v_mfma_f32_16x16x32_bf16 v[214:217], a[8:11], v[68:71], v[214:217]
    ds_read_b128 v[64:67], v4 offset:10400
    ds_read_b128 a[176:179], v83 offset:0
    s_mul_i32 s7, s41, 320
    v_mfma_f32_16x16x32_bf16 v[230:233], a[12:15], v[68:71], v[230:233]
    ds_read_b128 a[180:183], v85 offset:0
    s_waitcnt lgkmcnt(6)
    v_mfma_f32_16x16x32_bf16 v[218:221], a[8:11], v[48:51], v[218:221]
    ds_read_b128 v[68:71], v4 offset:11440
    s_add_u32 s7, s7, 12800
    v_mfma_f32_16x16x32_bf16 v[234:237], a[12:15], v[48:51], v[234:237]
    ds_read_b128 a[184:187], v87 offset:0
    v_mfma_f32_16x16x32_bf16 v[222:225], a[8:11], v[52:55], v[222:225]
    ds_read_b128 v[48:51], v4 offset:12480
    v_min_u32 v175, 304, v4
    v_mfma_f32_16x16x32_bf16 v[238:241], a[12:15], v[52:55], v[238:241]
    ds_read_b128 a[188:191], v89 offset:0
    s_waitcnt lgkmcnt(6)
    v_mfma_f32_16x16x32_bf16 v[210:213], a[16:19], v[56:59], v[210:213]
    ds_read_b128 v[52:55], v4 offset:13520
    s_waitcnt lgkmcnt(1)
    s_add_u32 m0, s89, 0
    v_mfma_f32_16x16x32_bf16 v[226:229], a[20:23], v[56:59], v[226:229]
    v_add_u32 v175, s7, v175
    v_mfma_f32_16x16x32_bf16 v[214:217], a[16:19], v[60:63], v[214:217]
    ds_read_b128 v[56:59], v4 offset:14560
    global_load_dwordx4 v[242:245], v175, s[38:39] sc1
    v_mfma_f32_16x16x32_bf16 v[230:233], a[20:23], v[60:63], v[230:233]
    global_load_lds_dwordx4 v74, s[76:77] offset:0
    v_mfma_f32_16x16x32_bf16 v[218:221], a[16:19], v[64:67], v[218:221]
    ds_read_b128 v[60:63], v4 offset:15600
    v_add_u32 v175, 15360, v175
    v_mfma_f32_16x16x32_bf16 v[234:237], a[20:23], v[64:67], v[234:237]
    global_load_lds_dwordx4 v75, s[76:77] offset:1024
    v_mfma_f32_16x16x32_bf16 v[222:225], a[16:19], v[68:71], v[222:225]
    ds_read_b128 v[64:67], v4 offset:16640
    global_load_lds_dwordx4 v76, s[76:77] offset:2048
    v_mfma_f32_16x16x32_bf16 v[238:241], a[20:23], v[68:71], v[238:241]
    global_load_dwordx4 v[246:249], v175, s[38:39] sc1
    s_waitcnt lgkmcnt(2)
    v_mfma_f32_16x16x32_bf16 v[210:213], a[24:27], v[48:51], v[210:213]
    ds_read_b128 v[68:71], v4 offset:17680
    global_load_lds_dwordx4 v77, s[76:77] offset:3072
    v_mfma_f32_16x16x32_bf16 v[226:229], a[28:31], v[48:51], v[226:229]
    ds_read_b128 v[36:39], v46 offset:0
    v_mfma_f32_16x16x32_bf16 v[214:217], a[24:27], v[52:55], v[214:217]
    ds_read_b128 v[48:51], v4 offset:18720
    s_add_u32 m0, s89, 4096
    ds_read_b128 v[40:43], v46 offset:4160
    v_mfma_f32_16x16x32_bf16 v[230:233], a[28:31], v[52:55], v[230:233]
    global_load_lds_dwordx4 v78, s[76:77] offset:0
    s_waitcnt lgkmcnt(4)
    v_mfma_f32_16x16x32_bf16 v[218:221], a[24:27], v[56:59], v[218:221]
    ds_read_b128 v[52:55], v4 offset:19760
    ds_read_b64 v[44:45], v47 offset:8320
    v_mfma_f32_16x16x32_bf16 v[234:237], a[28:31], v[56:59], v[234:237]
    global_load_lds_dwordx4 v79, s[76:77] offset:1024
    v_mfma_f32_16x16x32_bf16 v[222:225], a[24:27], v[60:63], v[222:225]
    ds_read_b128 v[56:59], v4 offset:20800
    global_load_lds_dwordx4 v80, s[76:77] offset:2048
    v_mfma_f32_16x16x32_bf16 v[238:241], a[28:31], v[60:63], v[238:241]
    s_waitcnt vmcnt(8)
    v_max3_u32 v28, v242, v243, v244
    s_waitcnt lgkmcnt(4)
    v_mfma_f32_16x16x32_bf16 v[210:213], a[32:35], v[64:67], v[210:213]
    ds_read_b128 v[60:63], v4 offset:21840
    global_load_lds_dwordx4 v81, s[76:77] offset:3072
    v_mfma_f32_16x16x32_bf16 v[226:229], a[36:39], v[64:67], v[226:229]
    s_waitcnt vmcnt(5)
    v_max3_u32 v28, v245, v246, v28
    v_mfma_f32_16x16x32_bf16 v[214:217], a[32:35], v[68:71], v[214:217]
    ds_read_b128 v[64:67], v4 offset:22880
    ds_read_b128 a[0:3], v82 offset:8192
    v_mfma_f32_16x16x32_bf16 v[230:233], a[36:39], v[68:71], v[230:233]
    v_max3_u32 v28, v247, v248, v28
    s_waitcnt lgkmcnt(3)
    v_mfma_f32_16x16x32_bf16 v[218:221], a[32:35], v[48:51], v[218:221]
    ds_read_b128 v[68:71], v4 offset:23920
    v_max3_u32 v28, v249, v250, v28
    v_mfma_f32_16x16x32_bf16 v[234:237], a[36:39], v[48:51], v[234:237]
    ds_read_b128 a[4:7], v84 offset:8192
    v_mfma_f32_16x16x32_bf16 v[222:225], a[32:35], v[52:55], v[222:225]
    ds_read_b128 v[48:51], v4 offset:24960
    ds_read_b128 a[8:11], v86 offset:8192
    v_mfma_f32_16x16x32_bf16 v[238:241], a[36:39], v[52:55], v[238:241]
    v_cmp_eq_u32 vcc, -1, v28
    s_waitcnt lgkmcnt(5)
    v_mfma_f32_16x16x32_bf16 v[210:213], a[40:43], v[56:59], v[210:213]
    ds_read_b128 v[52:55], v4 offset:26000
    ds_read_b128 a[12:15], v88 offset:8192
    v_mfma_f32_16x16x32_bf16 v[226:229], a[44:47], v[56:59], v[226:229]
    s_cbranch_vccnz Lgb_r
Lgb_ok:
    v_mfma_f32_16x16x32_bf16 v[214:217], a[40:43], v[60:63], v[214:217]
    ds_read_b128 v[56:59], v4 offset:27040
    ds_read_b128 a[16:19], v83 offset:8192
    v_mfma_f32_16x16x32_bf16 v[230:233], a[44:47], v[60:63], v[230:233]
    ds_read_b128 a[20:23], v85 offset:8192
    v_add_f32 v242, v242, v246
    s_waitcnt lgkmcnt(5)
    v_mfma_f32_16x16x32_bf16 v[218:221], a[40:43], v[64:67], v[218:221]
    ds_read_b128 v[60:63], v4 offset:28080
    v_mfma_f32_16x16x32_bf16 v[234:237], a[44:47], v[64:67], v[234:237]
    ds_read_b128 a[24:27], v87 offset:8192
    v_add_f32 v243, v243, v247
    v_mfma_f32_16x16x32_bf16 v[222:225], a[40:43], v[68:71], v[222:225]
    ds_read_b128 v[64:67], v4 offset:29120
    ds_read_b128 a[28:31], v89 offset:8192
    v_mfma_f32_16x16x32_bf16 v[238:241], a[44:47], v[68:71], v[238:241]
    v_add_f32 v244, v244, v248
    s_waitcnt lgkmcnt(6)
    v_mfma_f32_16x16x32_bf16 v[210:213], a[48:51], v[48:51], v[210:213]
    ds_read_b128 v[68:71], v4 offset:30160
    s_waitcnt lgkmcnt(1)
    s_add_u32 m0, s89, 8192
    v_mfma_f32_16x16x32_bf16 v[226:229], a[52:55], v[48:51], v[226:229]
    v_add_f32 v245, v245, v249
    v_mfma_f32_16x16x32_bf16 v[214:217], a[48:51], v[52:55], v[214:217]
    ds_read_b128 v[48:51], v4 offset:31200
    v_mfma_f32_16x16x32_bf16 v[230:233], a[52:55], v[52:55], v[230:233]
    global_load_lds_dwordx4 v74, s[78:79] offset:0
    v_cvt_pk_bf16_f32 v242, v242, v242
    v_mfma_f32_16x16x32_bf16 v[218:221], a[48:51], v[56:59], v[218:221]
    ds_read_b128 v[52:55], v4 offset:32240
    v_mfma_f32_16x16x32_bf16 v[234:237], a[52:55], v[56:59], v[234:237]
    global_load_lds_dwordx4 v75, s[78:79] offset:1024
    v_lshlrev_b32 v242, 16, v242
    v_mfma_f32_16x16x32_bf16 v[222:225], a[48:51], v[60:63], v[222:225]
    ds_read_b128 v[56:59], v4 offset:33280
    global_load_lds_dwordx4 v76, s[78:79] offset:2048
    v_mfma_f32_16x16x32_bf16 v[238:241], a[52:55], v[60:63], v[238:241]
    v_cvt_pk_bf16_f32 v243, v243, v243
    s_waitcnt lgkmcnt(2)
    v_mfma_f32_16x16x32_bf16 v[210:213], a[56:59], v[64:67], v[210:213]
    ds_read_b128 v[60:63], v4 offset:34320
    global_load_lds_dwordx4 v77, s[78:79] offset:3072
    v_mfma_f32_16x16x32_bf16 v[226:229], a[60:63], v[64:67], v[226:229]
    v_lshlrev_b32 v243, 16, v243
    v_mfma_f32_16x16x32_bf16 v[214:217], a[56:59], v[68:71], v[214:217]
    ds_read_b128 v[64:67], v4 offset:35360
    s_add_u32 m0, s89, 12288
    v_mfma_f32_16x16x32_bf16 v[230:233], a[60:63], v[68:71], v[230:233]
    global_load_lds_dwordx4 v78, s[78:79] offset:0
    v_cvt_pk_bf16_f32 v244, v244, v244
    s_waitcnt lgkmcnt(2)
    v_mfma_f32_16x16x32_bf16 v[218:221], a[56:59], v[48:51], v[218:221]
    ds_read_b128 v[68:71], v4 offset:36400
    v_mfma_f32_16x16x32_bf16 v[234:237], a[60:63], v[48:51], v[234:237]
    global_load_lds_dwordx4 v79, s[78:79] offset:1024
    v_lshlrev_b32 v244, 16, v244
    v_mfma_f32_16x16x32_bf16 v[222:225], a[56:59], v[52:55], v[222:225]
    ds_read_b128 v[48:51], v4 offset:37440
    global_load_lds_dwordx4 v80, s[78:79] offset:2048
    v_mfma_f32_16x16x32_bf16 v[238:241], a[60:63], v[52:55], v[238:241]
    v_cvt_pk_bf16_f32 v245, v245, v245
    s_waitcnt lgkmcnt(2)
    v_mfma_f32_16x16x32_bf16 v[210:213], a[64:67], v[56:59], v[210:213]
    ds_read_b128 v[52:55], v4 offset:38480
    global_load_lds_dwordx4 v81, s[78:79] offset:3072
    v_mfma_f32_16x16x32_bf16 v[226:229], a[68:71], v[56:59], v[226:229]
    v_lshlrev_b32 v245, 16, v245
    v_mfma_f32_16x16x32_bf16 v[214:217], a[64:67], v[60:63], v[214:217]
    ds_read_b128 v[56:59], v4 offset:39520
    s_waitcnt vmcnt(8)
    ds_read_b128 a[32:35], v82 offset:0
    v_mfma_f32_16x16x32_bf16 v[230:233], a[68:71], v[60:63], v[230:233]
    v_min_u32 v175, 304, v4
    s_waitcnt lgkmcnt(3)
    v_mfma_f32_16x16x32_bf16 v[218:221], a[64:67], v[64:67], v[218:221]
    ds_read_b128 v[60:63], v4 offset:40560
    v_mfma_f32_16x16x32_bf16 v[234:237], a[68:71], v[64:67], v[234:237]
    ds_read_b128 a[36:39], v84 offset:0
    v_add_u32 v175, 162816, v175
    v_mfma_f32_16x16x32_bf16 v[222:225], a[64:67], v[68:71], v[222:225]
    ds_read_b128 v[64:67], v173 offset:0
    ds_read_b128 a[40:43], v86 offset:0
    v_mfma_f32_16x16x32_bf16 v[238:241], a[68:71], v[68:71], v[238:241]
    s_waitcnt lgkmcnt(6)
    v_mfma_f32_16x16x32_bf16 v[210:213], a[72:75], v[48:51], v[210:213]
    ds_read_b128 v[68:71], v173 offset:1040
    ds_read_b128 a[44:47], v88 offset:0
    v_mfma_f32_16x16x32_bf16 v[226:229], a[76:79], v[48:51], v[226:229]
    ds_write_b128 v175, v[242:245]
    v_mfma_f32_16x16x32_bf16 v[214:217], a[72:75], v[52:55], v[214:217]
    ds_read_b128 v[48:51], v173 offset:2080
    ds_read_b128 a[48:51], v83 offset:0
    v_mfma_f32_16x16x32_bf16 v[230:233], a[76:79], v[52:55], v[230:233]
    ds_read_b128 a[52:55], v85 offset:0
    s_waitcnt lgkmcnt(7)
    v_mfma_f32_16x16x32_bf16 v[218:221], a[72:75], v[56:59], v[218:221]
    ds_read_b128 v[52:55], v173 offset:3120
    v_mfma_f32_16x16x32_bf16 v[234:237], a[76:79], v[56:59], v[234:237]
    ds_read_b128 a[56:59], v87 offset:0
    v_mfma_f32_16x16x32_bf16 v[222:225], a[72:75], v[60:63], v[222:225]
    ds_read_b128 v[56:59], v173 offset:4160
    global_load_dwordx2 v[130:131], v174, s[38:39] offset:0 sc1
    v_mfma_f32_16x16x32_bf16 v[238:241], a[76:79], v[60:63], v[238:241]
    global_load_dwordx2 v[132:133], v174, s[38:39] offset:512 sc1
    ds_read_b128 a[60:63], v89 offset:0
    s_waitcnt lgkmcnt(5)
    v_mfma_f32_16x16x32_bf16 v[210:213], a[80:83], v[64:67], v[210:213]
    ds_read_b128 v[60:63], v173 offset:5200
    global_load_dwordx2 v[134:135], v174, s[38:39] offset:1024 sc1
    v_mfma_f32_16x16x32_bf16 v[226:229], a[84:87], v[64:67], v[226:229]
    global_load_dwordx2 v[136:137], v174, s[38:39] offset:1536 sc1
    s_waitcnt lgkmcnt(1)
    s_add_u32 m0, s89, 0
    v_mfma_f32_16x16x32_bf16 v[214:217], a[80:83], v[68:71], v[214:217]
    ds_read_b128 v[64:67], v173 offset:6240
    global_load_dwordx2 v[138:139], v174, s[38:39] offset:2048 sc1
    v_mfma_f32_16x16x32_bf16 v[230:233], a[84:87], v[68:71], v[230:233]
    global_load_dwordx2 v[140:141], v174, s[38:39] offset:2560 sc1
    global_load_dwordx2 v[142:143], v174, s[38:39] offset:3072 sc1
    v_mfma_f32_16x16x32_bf16 v[218:221], a[80:83], v[48:51], v[218:221]
    ds_read_b128 v[68:71], v173 offset:7280
    global_load_lds_dwordx4 v74, s[80:81] offset:0
    v_mfma_f32_16x16x32_bf16 v[234:237], a[84:87], v[48:51], v[234:237]
    global_load_dwordx2 v[144:145], v174, s[38:39] offset:3584 sc1
    s_bfe_u32 s6, s2, 0x30003
    global_load_lds_dwordx4 v75, s[80:81] offset:1024
    v_mfma_f32_16x16x32_bf16 v[222:225], a[80:83], v[52:55], v[222:225]
    ds_read_b128 v[48:51], v173 offset:8320
    v_mul_u32_u24 v254, 8, v0
    v_mfma_f32_16x16x32_bf16 v[238:241], a[84:87], v[52:55], v[238:241]
    v_add_lshl_u32 v254, v254, s6, 7
    global_load_lds_dwordx4 v76, s[80:81] offset:2048
    s_waitcnt lgkmcnt(2)
    v_mfma_f32_16x16x32_bf16 v[210:213], a[88:91], v[56:59], v[210:213]
    ds_read_b128 v[52:55], v173 offset:9360
    v_min_u32 v254, (Lend-Lmid-4), v254
    v_mfma_f32_16x16x32_bf16 v[226:229], a[92:95], v[56:59], v[226:229]
    v_add_u32 v254, (Lmid-adaLN_cond__ssm_conv_h3__mixer_gmlp__prompt_kernel), v254
    global_load_lds_dwordx4 v77, s[80:81] offset:3072
    v_mfma_f32_16x16x32_bf16 v[214:217], a[88:91], v[60:63], v[214:217]
    ds_read_b128 v[56:59], v173 offset:10400
    global_load_dword v254, v254, s[0:1]
    s_add_u32 m0, s89, 4096
    v_mfma_f32_16x16x32_bf16 v[230:233], a[92:95], v[60:63], v[230:233]
    global_load_lds_dwordx4 v78, s[80:81] offset:0
    s_waitcnt lgkmcnt(2)
    v_mfma_f32_16x16x32_bf16 v[218:221], a[88:91], v[64:67], v[218:221]
    ds_read_b128 v[60:63], v173 offset:11440
    v_mfma_f32_16x16x32_bf16 v[234:237], a[92:95], v[64:67], v[234:237]
    global_load_lds_dwordx4 v79, s[80:81] offset:1024
    v_mfma_f32_16x16x32_bf16 v[222:225], a[88:91], v[68:71], v[222:225]
    ds_read_b128 v[64:67], v173 offset:12480
    global_load_lds_dwordx4 v80, s[80:81] offset:2048
    v_mfma_f32_16x16x32_bf16 v[238:241], a[92:95], v[68:71], v[238:241]
    s_waitcnt lgkmcnt(3)
    v_mfma_f32_16x16x32_bf16 v[210:213], a[96:99], v[48:51], v[210:213]
    ds_read_b128 v[68:71], v173 offset:13520
    global_load_lds_dwordx4 v81, s[80:81] offset:3072
    v_mfma_f32_16x16x32_bf16 v[226:229], a[100:103], v[48:51], v[226:229]
    v_mfma_f32_16x16x32_bf16 v[214:217], a[96:99], v[52:55], v[214:217]
    ds_read_b128 v[48:51], v173 offset:14560
    s_waitcnt vmcnt(17)
    ds_read_b128 a[64:67], v82 offset:8192
    v_mfma_f32_16x16x32_bf16 v[230:233], a[100:103], v[52:55], v[230:233]
    s_waitcnt lgkmcnt(4)
    v_mfma_f32_16x16x32_bf16 v[218:221], a[96:99], v[56:59], v[218:221]
    ds_read_b128 v[52:55], v173 offset:15600
    v_mfma_f32_16x16x32_bf16 v[234:237], a[100:103], v[56:59], v[234:237]
    ds_read_b128 a[68:71], v84 offset:8192
    v_mfma_f32_16x16x32_bf16 v[222:225], a[96:99], v[60:63], v[222:225]
    ds_read_b128 v[56:59], v173 offset:16640
    ds_read_b128 a[72:75], v86 offset:8192
    v_mfma_f32_16x16x32_bf16 v[238:241], a[100:103], v[60:63], v[238:241]
    s_waitcnt lgkmcnt(6)
    v_mfma_f32_16x16x32_bf16 v[210:213], a[104:107], v[64:67], v[210:213]
    ds_read_b128 v[60:63], v173 offset:17680
    ds_read_b128 a[76:79], v88 offset:8192
    v_mfma_f32_16x16x32_bf16 v[226:229], a[108:111], v[64:67], v[226:229]
    v_mfma_f32_16x16x32_bf16 v[214:217], a[104:107], v[68:71], v[214:217]
    ds_read_b128 v[64:67], v173 offset:18720
    ds_read_b128 a[80:83], v83 offset:8192
    v_mfma_f32_16x16x32_bf16 v[230:233], a[108:111], v[68:71], v[230:233]
    ds_read_b128 a[84:87], v85 offset:8192
    s_waitcnt lgkmcnt(6)
    s_waitcnt vmcnt(15)
    v_max_u32 v28, v131, v133
    s_waitcnt vmcnt(13)
    v_max3_u32 v28, v135, v137, v28
    s_waitcnt vmcnt(11)
    v_max3_u32 v28, v139, v141, v28
    s_waitcnt vmcnt(8)
    v_max3_u32 v28, v143, v145, v28
    v_cmp_eq_u32 vcc, -1, v28
    s_nop 0
    s_cbranch_vccnz Ls3_r
Ls3_ok:
    v_pk_add_f32 v[130:131], v[130:131], v[132:133] op_sel:[0,0] op_sel_hi:[1,1]
    v_pk_add_f32 v[134:135], v[134:135], v[136:137] op_sel:[0,0] op_sel_hi:[1,1]
    v_pk_add_f32 v[138:139], v[138:139], v[140:141] op_sel:[0,0] op_sel_hi:[1,1]
    v_pk_add_f32 v[142:143], v[142:143], v[144:145] op_sel:[0,0] op_sel_hi:[1,1]
    v_pk_add_f32 v[130:131], v[130:131], v[134:135] op_sel:[0,0] op_sel_hi:[1,1]
    v_pk_add_f32 v[138:139], v[138:139], v[142:143] op_sel:[0,0] op_sel_hi:[1,1]
    v_pk_add_f32 v[130:131], v[130:131], v[138:139] op_sel:[0,0] op_sel_hi:[1,1]
    v_mul_f32 v130, 0x3a97b426, v130
    v_mul_f32 v131, 0x3a97b426, v131
    v_fma_f32 v131, -v130, v130, v131
    v_max_f32 v131, 0, v131
    v_add_f32 v131, 0x3727c5ac, v131
    v_rsq_f32 v132, v131
    s_nop 0
    v_mul_f32_e64 v131, -v130, v132
    v_mov_b32 v130, v132
    ds_write2st64_b32 v170, v130, v131 offset0:0 offset1:1
    ds_read_b128 v[98:101], v171 offset:0
    ds_read_b128 v[102:105], v171 offset:16
    ds_read_b128 v[106:109], v171 offset:128
    ds_read_b128 v[110:113], v171 offset:144
    ds_read_b128 v[114:117], v171 offset:256
    ds_read_b128 v[118:121], v171 offset:272
    ds_read_b128 v[122:125], v171 offset:384
    ds_read_b128 v[126:129], v171 offset:400
    s_lshl_b32 s4, s41, 6
    s_lshl_b32 s5, s40, 1
    s_add_u32 s4, s4, s5
    s_mul_i32 s4, s4, 7168
    s_lshl_b32 s5, s3, 11
    s_add_u32 s4, s4, s5
    s_add_u32 s4, s4, 12582912
    v_add_u32 v28, s4, v4
    v_add_u32 v29, 7168, v28
    s_waitcnt lgkmcnt(3)
    v_pk_fma_f32 v[178:179], v[178:179], v[98:99], v[114:115] op_sel:[0,0,0] op_sel_hi:[1,1,1]
    v_pk_fma_f32 v[180:181], v[180:181], v[100:101], v[116:117] op_sel:[0,0,0] op_sel_hi:[1,1,1]
    s_waitcnt lgkmcnt(2)
    v_pk_fma_f32 v[182:183], v[182:183], v[102:103], v[118:119] op_sel:[0,0,0] op_sel_hi:[1,1,1]
    v_pk_fma_f32 v[184:185], v[184:185], v[104:105], v[120:121] op_sel:[0,0,0] op_sel_hi:[1,1,1]
    v_cvt_pk_bf16_f32 v130, v178, v179
    v_cvt_pk_bf16_f32 v131, v180, v181
    v_cvt_pk_bf16_f32 v132, v182, v183
    v_cvt_pk_bf16_f32 v133, v184, v185
    v_or_b32 v133, 1, v133
    global_store_dwordx4 v28, v[130:133], s[38:39] offset:0 sc1
    s_waitcnt lgkmcnt(0)
    v_pk_fma_f32 v[186:187], v[186:187], v[106:107], v[122:123] op_sel:[0,0,0] op_sel_hi:[1,1,1]
    v_pk_fma_f32 v[188:189], v[188:189], v[108:109], v[124:125] op_sel:[0,0,0] op_sel_hi:[1,1,1]
    v_pk_fma_f32 v[190:191], v[190:191], v[110:111], v[126:127] op_sel:[0,0,0] op_sel_hi:[1,1,1]
    v_pk_fma_f32 v[192:193], v[192:193], v[112:113], v[128:129] op_sel:[0,0,0] op_sel_hi:[1,1,1]
    v_cvt_pk_bf16_f32 v134, v186, v187
    v_cvt_pk_bf16_f32 v135, v188, v189
    v_cvt_pk_bf16_f32 v136, v190, v191
    v_cvt_pk_bf16_f32 v137, v192, v193
    v_or_b32 v137, 1, v137
    global_store_dwordx4 v29, v[134:137], s[38:39] offset:0 sc1
    v_pk_fma_f32 v[194:195], v[194:195], v[98:99], v[114:115] op_sel:[0,0,0] op_sel_hi:[1,1,1]
    v_pk_fma_f32 v[196:197], v[196:197], v[100:101], v[116:117] op_sel:[0,0,0] op_sel_hi:[1,1,1]
    v_pk_fma_f32 v[198:199], v[198:199], v[102:103], v[118:119] op_sel:[0,0,0] op_sel_hi:[1,1,1]
    v_pk_fma_f32 v[200:201], v[200:201], v[104:105], v[120:121] op_sel:[0,0,0] op_sel_hi:[1,1,1]
    v_cvt_pk_bf16_f32 v138, v194, v195
    v_cvt_pk_bf16_f32 v139, v196, v197
    v_cvt_pk_bf16_f32 v140, v198, v199
    v_cvt_pk_bf16_f32 v141, v200, v201
    v_or_b32 v141, 1, v141
    s_cmp_eq_u32 s3, 3
    s_cbranch_scc1 Lzs_0
    global_store_dwordx4 v28, v[138:141], s[38:39] offset:1024 sc1
Lzs_0:
    v_pk_fma_f32 v[202:203], v[202:203], v[106:107], v[122:123] op_sel:[0,0,0] op_sel_hi:[1,1,1]
    v_pk_fma_f32 v[204:205], v[204:205], v[108:109], v[124:125] op_sel:[0,0,0] op_sel_hi:[1,1,1]
    v_pk_fma_f32 v[206:207], v[206:207], v[110:111], v[126:127] op_sel:[0,0,0] op_sel_hi:[1,1,1]
    v_pk_fma_f32 v[208:209], v[208:209], v[112:113], v[128:129] op_sel:[0,0,0] op_sel_hi:[1,1,1]
    v_cvt_pk_bf16_f32 v142, v202, v203
    v_cvt_pk_bf16_f32 v143, v204, v205
    v_cvt_pk_bf16_f32 v144, v206, v207
    v_cvt_pk_bf16_f32 v145, v208, v209
    v_or_b32 v145, 1, v145
    s_cmp_eq_u32 s3, 3
    s_cbranch_scc1 Lzs_1
    global_store_dwordx4 v29, v[142:145], s[38:39] offset:1024 sc1
Lzs_1:
    v_mfma_f32_16x16x32_bf16 v[218:221], a[104:107], v[48:51], v[218:221]
    ds_read_b128 v[68:71], v173 offset:19760
    v_mfma_f32_16x16x32_bf16 v[234:237], a[108:111], v[48:51], v[234:237]
    ds_read_b128 a[88:91], v87 offset:8192
    s_mul_i32 s91, s41, 458752
    v_mfma_f32_16x16x32_bf16 v[222:225], a[104:107], v[52:55], v[222:225]
    ds_read_b128 v[48:51], v173 offset:20800
    ds_read_b128 a[92:95], v89 offset:8192
    s_add_u32 s91, s91, 12582912
    v_mfma_f32_16x16x32_bf16 v[238:241], a[108:111], v[52:55], v[238:241]
    v_mfma_f32_16x16x32_bf16 v[210:213], a[112:115], v[56:59], v[210:213]
    ds_read_b128 v[52:55], v173 offset:21840
    s_waitcnt lgkmcnt(1)
    s_add_u32 m0, s89, 8192
    v_mfma_f32_16x16x32_bf16 v[226:229], a[116:119], v[56:59], v[226:229]
    s_mul_i32 s6, s44, 14336
    v_mfma_f32_16x16x32_bf16 v[214:217], a[112:115], v[60:63], v[214:217]
    ds_read_b128 v[56:59], v173 offset:22880
    s_add_u32 s6, s6, s91
    v_mfma_f32_16x16x32_bf16 v[230:233], a[116:119], v[60:63], v[230:233]
    global_load_lds_dwordx4 v74, s[82:83] offset:0
    v_mfma_f32_16x16x32_bf16 v[218:221], a[112:115], v[64:67], v[218:221]
    ds_read_b128 v[60:63], v173 offset:23920
    s_add_u32 s52, s38, s6
    s_addc_u32 s53, s39, 0
    v_mfma_f32_16x16x32_bf16 v[234:237], a[116:119], v[64:67], v[234:237]
    global_load_lds_dwordx4 v75, s[82:83] offset:1024
    v_mfma_f32_16x16x32_bf16 v[222:225], a[112:115], v[68:71], v[222:225]
    ds_read_b128 v[64:67], v173 offset:24960
    global_load_lds_dwordx4 v76, s[82:83] offset:2048
    v_mfma_f32_16x16x32_bf16 v[238:241], a[116:119], v[68:71], v[238:241]
    s_waitcnt lgkmcnt(3)
    v_mfma_f32_16x16x32_bf16 v[210:213], a[120:123], v[48:51], v[210:213]
    ds_read_b128 v[68:71], v173 offset:26000
    global_load_lds_dwordx4 v77, s[82:83] offset:3072
    v_mfma_f32_16x16x32_bf16 v[226:229], a[124:127], v[48:51], v[226:229]
    s_add_u32 s54, s52, 14336
    s_addc_u32 s55, s53, 0
    v_mfma_f32_16x16x32_bf16 v[214:217], a[120:123], v[52:55], v[214:217]
    ds_read_b128 v[48:51], v173 offset:27040
    s_add_u32 m0, s89, 12288
    v_mfma_f32_16x16x32_bf16 v[230:233], a[124:127], v[52:55], v[230:233]
    global_load_lds_dwordx4 v78, s[82:83] offset:0
    s_waitcnt lgkmcnt(2)
    v_mfma_f32_16x16x32_bf16 v[218:221], a[120:123], v[56:59], v[218:221]
    ds_read_b128 v[52:55], v173 offset:28080
    s_mul_i32 s6, s46, 14336
    v_mfma_f32_16x16x32_bf16 v[234:237], a[124:127], v[56:59], v[234:237]
    global_load_lds_dwordx4 v79, s[82:83] offset:1024
    v_mfma_f32_16x16x32_bf16 v[222:225], a[120:123], v[60:63], v[222:225]
    ds_read_b128 v[56:59], v173 offset:29120
    s_add_u32 s6, s6, s91
    global_load_lds_dwordx4 v80, s[82:83] offset:2048
    v_mfma_f32_16x16x32_bf16 v[238:241], a[124:127], v[60:63], v[238:241]
    s_waitcnt lgkmcnt(3)
    v_mfma_f32_16x16x32_bf16 v[210:213], a[128:131], v[64:67], v[210:213]
    ds_read_b128 v[60:63], v173 offset:30160
    global_load_lds_dwordx4 v81, s[82:83] offset:3072
    v_mfma_f32_16x16x32_bf16 v[226:229], a[132:135], v[64:67], v[226:229]
    s_add_u32 s56, s38, s6
    s_addc_u32 s57, s39, 0
    v_mfma_f32_16x16x32_bf16 v[214:217], a[128:131], v[68:71], v[214:217]
    ds_read_b128 v[64:67], v173 offset:31200
    s_waitcnt vmcnt(10)
    ds_read_b128 a[96:99], v82 offset:0
    v_mfma_f32_16x16x32_bf16 v[230:233], a[132:135], v[68:71], v[230:233]
    s_waitcnt lgkmcnt(4)
    v_mfma_f32_16x16x32_bf16 v[218:221], a[128:131], v[48:51], v[218:221]
    ds_read_b128 v[68:71], v173 offset:32240
    s_add_u32 s58, s56, 14336
    s_addc_u32 s59, s57, 0
    v_mfma_f32_16x16x32_bf16 v[234:237], a[132:135], v[48:51], v[234:237]
    v_mfma_f32_16x16x32_bf16 v[222:225], a[128:131], v[52:55], v[222:225]
    ds_read_b128 v[48:51], v173 offset:33280
    ds_read_b128 a[100:103], v84 offset:0
    v_mfma_f32_16x16x32_bf16 v[238:241], a[132:135], v[52:55], v[238:241]
    s_mul_i32 s6, s48, 14336
    s_waitcnt lgkmcnt(4)
    v_mfma_f32_16x16x32_bf16 v[210:213], a[136:139], v[56:59], v[210:213]
    ds_read_b128 v[52:55], v173 offset:34320
    v_mfma_f32_16x16x32_bf16 v[226:229], a[140:143], v[56:59], v[226:229]
    ds_read_b128 a[104:107], v86 offset:0
    s_add_u32 s6, s6, s91
    v_mfma_f32_16x16x32_bf16 v[214:217], a[136:139], v[60:63], v[214:217]
    ds_read_b128 v[56:59], v173 offset:35360
    v_mfma_f32_16x16x32_bf16 v[230:233], a[140:143], v[60:63], v[230:233]
    ds_read_b128 a[108:111], v88 offset:0
    s_waitcnt lgkmcnt(5)
    v_mfma_f32_16x16x32_bf16 v[218:221], a[136:139], v[64:67], v[218:221]
    ds_read_b128 v[60:63], v173 offset:36400
    s_add_u32 s60, s38, s6
    s_addc_u32 s61, s39, 0
    v_mfma_f32_16x16x32_bf16 v[234:237], a[140:143], v[64:67], v[234:237]
    ds_read_b128 a[112:115], v83 offset:0
    v_mfma_f32_16x16x32_bf16 v[222:225], a[136:139], v[68:71], v[222:225]
    ds_read_b128 v[64:67], v173 offset:37440
    v_mfma_f32_16x16x32_bf16 v[238:241], a[140:143], v[68:71], v[238:241]
    s_add_u32 s62, s60, 14336
    s_addc_u32 s63, s61, 0
    s_waitcnt lgkmcnt(4)
    v_mfma_f32_16x16x32_bf16 v[210:213], a[144:147], v[48:51], v[210:213]
    ds_read_b128 v[68:71], v173 offset:38480
    ds_read_b128 a[116:119], v85 offset:0
    v_mfma_f32_16x16x32_bf16 v[226:229], a[148:151], v[48:51], v[226:229]
    v_mfma_f32_16x16x32_bf16 v[214:217], a[144:147], v[52:55], v[214:217]
    ds_read_b128 v[48:51], v173 offset:39520
    ds_read_b128 a[120:123], v87 offset:0
    v_mfma_f32_16x16x32_bf16 v[230:233], a[148:151], v[52:55], v[230:233]
    s_mul_i32 s6, s50, 14336
    s_waitcnt lgkmcnt(4)
    v_mfma_f32_16x16x32_bf16 v[218:221], a[144:147], v[56:59], v[218:221]
    ds_read_b128 v[52:55], v173 offset:40560
    ds_read_b128 a[124:127], v89 offset:0
    v_mfma_f32_16x16x32_bf16 v[234:237], a[148:151], v[56:59], v[234:237]
    s_add_u32 s6, s6, s91
    v_mfma_f32_16x16x32_bf16 v[222:225], a[144:147], v[60:63], v[222:225]
    v_mfma_f32_16x16x32_bf16 v[238:241], a[148:151], v[60:63], v[238:241]
    s_add_u32 s64, s38, s6
    s_addc_u32 s65, s39, 0
    s_waitcnt lgkmcnt(2)
    v_mfma_f32_16x16x32_bf16 v[210:213], a[152:155], v[64:67], v[210:213]
    v_mfma_f32_16x16x32_bf16 v[226:229], a[156:159], v[64:67], v[226:229]
    v_mfma_f32_16x16x32_bf16 v[214:217], a[152:155], v[68:71], v[214:217]
    v_mfma_f32_16x16x32_bf16 v[230:233], a[156:159], v[68:71], v[230:233]
    s_add_u32 s66, s64, 14336
    s_addc_u32 s67, s65, 0
    s_waitcnt lgkmcnt(0)
    v_mfma_f32_16x16x32_bf16 v[218:221], a[152:155], v[48:51], v[218:221]
    v_mfma_f32_16x16x32_bf16 v[234:237], a[156:159], v[48:51], v[234:237]
    v_mfma_f32_16x16x32_bf16 v[222:225], a[152:155], v[52:55], v[222:225]
    v_mfma_f32_16x16x32_bf16 v[238:241], a[156:159], v[52:55], v[238:241]
    s_waitcnt vmcnt(0)
    ds_read_b128 a[128:131], v82 offset:8192
    ds_read_b128 a[132:135], v84 offset:8192
    ds_read_b128 a[136:139], v86 offset:8192
    ds_read_b128 a[140:143], v88 offset:8192
    ds_read_b128 a[144:147], v83 offset:8192
    ds_read_b128 a[148:151], v85 offset:8192
    ds_read_b128 a[152:155], v87 offset:8192
    ds_read_b128 a[156:159], v89 offset:8192
    s_waitcnt lgkmcnt(0)
    s_barrier
    s_mul_i32 s5, s41, 138240
    s_add_u32 s5, s5, 10485760
    s_add_u32 s92, s38, s5
    s_addc_u32 s93, s39, 0
    s_mul_i32 s95, s3, 34816
    s_min_u32 s95, s95, 103424
    s_add_u32 s92, s92, s95
    s_addc_u32 s93, s93, 0
    s_add_u32 m0, s95, 0
    s_nop 0
    global_load_lds_dwordx4 v4, s[92:93] offset:0 sc1
    s_lshl_b32 s4, s3, 10
    s_add_u32 s4, s4, 138240
    v_add_u32 v170, s4, v30
    s_lshl_b32 s4, s3, 12
    s_add_u32 s4, s4, 138240
    v_add_u32 v171, s4, v30
    v_add_u32 v30, 3072, v4
    v_add_u32 v31, 10240, v4
    v_min_u32 v29, 27, v1
    v_lshlrev_b32 v29, 10, v29
    v_pk_fma_f32 v[178:179], v[162:163], v[12:13], v[16:17] op_sel:[1,0,0] op_sel_hi:[1,1,1]
    v_pk_fma_f32 v[180:181], v[162:163], v[14:15], v[18:19] op_sel:[1,0,0] op_sel_hi:[1,1,1]
    v_pk_fma_f32 v[182:183], v[164:165], v[12:13], v[16:17] op_sel:[1,0,0] op_sel_hi:[1,1,1]
    v_pk_fma_f32 v[184:185], v[164:165], v[14:15], v[18:19] op_sel:[1,0,0] op_sel_hi:[1,1,1]
    v_pk_fma_f32 v[186:187], v[166:167], v[12:13], v[16:17] op_sel:[1,0,0] op_sel_hi:[1,1,1]
    v_pk_fma_f32 v[188:189], v[166:167], v[14:15], v[18:19] op_sel:[1,0,0] op_sel_hi:[1,1,1]
    v_pk_fma_f32 v[190:191], v[168:169], v[12:13], v[16:17] op_sel:[1,0,0] op_sel_hi:[1,1,1]
    v_pk_fma_f32 v[192:193], v[168:169], v[14:15], v[18:19] op_sel:[1,0,0] op_sel_hi:[1,1,1]
    v_pk_fma_f32 v[210:211], v[162:163], v[210:211], v[178:179] op_sel:[0,0,0] op_sel_hi:[0,1,1]
    global_load_lds_dwordx4 v4, s[92:93] offset:1024 sc1
    v_pk_fma_f32 v[212:213], v[162:163], v[212:213], v[180:181] op_sel:[0,0,0] op_sel_hi:[0,1,1]
    v_pk_fma_f32 v[214:215], v[164:165], v[214:215], v[182:183] op_sel:[0,0,0] op_sel_hi:[0,1,1]
    v_pk_fma_f32 v[216:217], v[164:165], v[216:217], v[184:185] op_sel:[0,0,0] op_sel_hi:[0,1,1]
    v_pk_fma_f32 v[218:219], v[166:167], v[218:219], v[186:187] op_sel:[0,0,0] op_sel_hi:[0,1,1]
    v_pk_fma_f32 v[220:221], v[166:167], v[220:221], v[188:189] op_sel:[0,0,0] op_sel_hi:[0,1,1]
    v_pk_fma_f32 v[222:223], v[168:169], v[222:223], v[190:191] op_sel:[0,0,0] op_sel_hi:[0,1,1]
    v_pk_fma_f32 v[224:225], v[168:169], v[224:225], v[192:193] op_sel:[0,0,0] op_sel_hi:[0,1,1]
    v_pk_fma_f32 v[178:179], v[162:163], v[20:21], v[24:25] op_sel:[1,0,0] op_sel_hi:[1,1,1]
    v_pk_fma_f32 v[180:181], v[162:163], v[22:23], v[26:27] op_sel:[1,0,0] op_sel_hi:[1,1,1]
    v_pk_fma_f32 v[182:183], v[164:165], v[20:21], v[24:25] op_sel:[1,0,0] op_sel_hi:[1,1,1]
    v_pk_fma_f32 v[184:185], v[164:165], v[22:23], v[26:27] op_sel:[1,0,0] op_sel_hi:[1,1,1]
    v_pk_fma_f32 v[186:187], v[166:167], v[20:21], v[24:25] op_sel:[1,0,0] op_sel_hi:[1,1,1]
    v_pk_fma_f32 v[188:189], v[166:167], v[22:23], v[26:27] op_sel:[1,0,0] op_sel_hi:[1,1,1]
    v_pk_fma_f32 v[190:191], v[168:169], v[20:21], v[24:25] op_sel:[1,0,0] op_sel_hi:[1,1,1]
    v_pk_fma_f32 v[192:193], v[168:169], v[22:23], v[26:27] op_sel:[1,0,0] op_sel_hi:[1,1,1]
    v_pk_fma_f32 v[226:227], v[162:163], v[226:227], v[178:179] op_sel:[0,0,0] op_sel_hi:[0,1,1]
    v_pk_fma_f32 v[228:229], v[162:163], v[228:229], v[180:181] op_sel:[0,0,0] op_sel_hi:[0,1,1]
    v_pk_fma_f32 v[230:231], v[164:165], v[230:231], v[182:183] op_sel:[0,0,0] op_sel_hi:[0,1,1]
    v_pk_fma_f32 v[232:233], v[164:165], v[232:233], v[184:185] op_sel:[0,0,0] op_sel_hi:[0,1,1]
    global_load_lds_dwordx4 v4, s[92:93] offset:2048 sc1
    v_pk_fma_f32 v[234:235], v[166:167], v[234:235], v[186:187] op_sel:[0,0,0] op_sel_hi:[0,1,1]
    v_pk_fma_f32 v[236:237], v[166:167], v[236:237], v[188:189] op_sel:[0,0,0] op_sel_hi:[0,1,1]
    v_pk_fma_f32 v[238:239], v[168:169], v[238:239], v[190:191] op_sel:[0,0,0] op_sel_hi:[0,1,1]
    v_pk_fma_f32 v[240:241], v[168:169], v[240:241], v[192:193] op_sel:[0,0,0] op_sel_hi:[0,1,1]
    v_pk_mul_f32 v[178:179], v[210:211], v[210:211] op_sel:[0,0] op_sel_hi:[1,1]
    v_pk_mul_f32 v[180:181], v[212:213], v[212:213] op_sel:[0,0] op_sel_hi:[1,1]
    v_pk_mul_f32 v[182:183], v[214:215], v[214:215] op_sel:[0,0] op_sel_hi:[1,1]
    v_pk_mul_f32 v[184:185], v[216:217], v[216:217] op_sel:[0,0] op_sel_hi:[1,1]
    v_pk_mul_f32 v[186:187], v[218:219], v[218:219] op_sel:[0,0] op_sel_hi:[1,1]
    v_pk_mul_f32 v[188:189], v[220:221], v[220:221] op_sel:[0,0] op_sel_hi:[1,1]
    v_pk_mul_f32 v[190:191], v[222:223], v[222:223] op_sel:[0,0] op_sel_hi:[1,1]
    v_pk_mul_f32 v[192:193], v[224:225], v[224:225] op_sel:[0,0] op_sel_hi:[1,1]
    v_pk_mul_f32 v[194:195], v[226:227], v[226:227] op_sel:[0,0] op_sel_hi:[1,1]
    v_pk_mul_f32 v[196:197], v[228:229], v[228:229] op_sel:[0,0] op_sel_hi:[1,1]
    v_pk_mul_f32 v[198:199], v[230:231], v[230:231] op_sel:[0,0] op_sel_hi:[1,1]
    v_pk_mul_f32 v[200:201], v[232:233], v[232:233] op_sel:[0,0] op_sel_hi:[1,1]
    v_pk_mul_f32 v[202:203], v[234:235], v[234:235] op_sel:[0,0] op_sel_hi:[1,1]
    v_pk_mul_f32 v[204:205], v[236:237], v[236:237] op_sel:[0,0] op_sel_hi:[1,1]
    v_pk_mul_f32 v[206:207], v[238:239], v[238:239] op_sel:[0,0] op_sel_hi:[1,1]
    global_load_lds_dwordx4 v4, s[92:93] offset:3072 sc1
    v_pk_mul_f32 v[208:209], v[240:241], v[240:241] op_sel:[0,0] op_sel_hi:[1,1]
    v_pk_fma_f32 v[178:179], v[178:179], s[84:85], s[84:85] op_sel:[0,1,0] op_sel_hi:[1,1,0]
    v_pk_fma_f32 v[180:181], v[180:181], s[84:85], s[84:85] op_sel:[0,1,0] op_sel_hi:[1,1,0]
    v_pk_fma_f32 v[182:183], v[182:183], s[84:85], s[84:85] op_sel:[0,1,0] op_sel_hi:[1,1,0]
    v_pk_fma_f32 v[184:185], v[184:185], s[84:85], s[84:85] op_sel:[0,1,0] op_sel_hi:[1,1,0]
    v_pk_fma_f32 v[186:187], v[186:187], s[84:85], s[84:85] op_sel:[0,1,0] op_sel_hi:[1,1,0]
    v_pk_fma_f32 v[188:189], v[188:189], s[84:85], s[84:85] op_sel:[0,1,0] op_sel_hi:[1,1,0]
    v_pk_fma_f32 v[190:191], v[190:191], s[84:85], s[84:85] op_sel:[0,1,0] op_sel_hi:[1,1,0]
    v_pk_fma_f32 v[192:193], v[192:193], s[84:85], s[84:85] op_sel:[0,1,0] op_sel_hi:[1,1,0]
    v_pk_fma_f32 v[194:195], v[194:195], s[84:85], s[84:85] op_sel:[0,1,0] op_sel_hi:[1,1,0]
    v_pk_fma_f32 v[196:197], v[196:197], s[84:85], s[84:85] op_sel:[0,1,0] op_sel_hi:[1,1,0]
    v_pk_fma_f32 v[198:199], v[198:199], s[84:85], s[84:85] op_sel:[0,1,0] op_sel_hi:[1,1,0]
    v_pk_fma_f32 v[200:201], v[200:201], s[84:85], s[84:85] op_sel:[0,1,0] op_sel_hi:[1,1,0]
    v_pk_fma_f32 v[202:203], v[202:203], s[84:85], s[84:85] op_sel:[0,1,0] op_sel_hi:[1,1,0]
    v_pk_fma_f32 v[204:205], v[204:205], s[84:85], s[84:85] op_sel:[0,1,0] op_sel_hi:[1,1,0]
    v_pk_fma_f32 v[206:207], v[206:207], s[84:85], s[84:85] op_sel:[0,1,0] op_sel_hi:[1,1,0]
    v_pk_fma_f32 v[208:209], v[208:209], s[84:85], s[84:85] op_sel:[0,1,0] op_sel_hi:[1,1,0]
    v_pk_mul_f32 v[178:179], v[178:179], v[210:211] op_sel:[0,0] op_sel_hi:[1,1]
    v_pk_mul_f32 v[180:181], v[180:181], v[212:213] op_sel:[0,0] op_sel_hi:[1,1]
    s_add_u32 m0, s95, 4096
    s_add_u32 s92, s92, 4096
    s_addc_u32 s93, s93, 0
    global_load_lds_dwordx4 v4, s[92:93] offset:0 sc1
    v_pk_mul_f32 v[182:183], v[182:183], v[214:215] op_sel:[0,0] op_sel_hi:[1,1]
    v_pk_mul_f32 v[184:185], v[184:185], v[216:217] op_sel:[0,0] op_sel_hi:[1,1]
    v_pk_mul_f32 v[186:187], v[186:187], v[218:219] op_sel:[0,0] op_sel_hi:[1,1]
    v_pk_mul_f32 v[188:189], v[188:189], v[220:221] op_sel:[0,0] op_sel_hi:[1,1]
    v_pk_mul_f32 v[190:191], v[190:191], v[222:223] op_sel:[0,0] op_sel_hi:[1,1]
    v_pk_mul_f32 v[192:193], v[192:193], v[224:225] op_sel:[0,0] op_sel_hi:[1,1]
    v_pk_mul_f32 v[194:195], v[194:195], v[226:227] op_sel:[0,0] op_sel_hi:[1,1]
    v_pk_mul_f32 v[196:197], v[196:197], v[228:229] op_sel:[0,0] op_sel_hi:[1,1]
    v_pk_mul_f32 v[198:199], v[198:199], v[230:231] op_sel:[0,0] op_sel_hi:[1,1]
    v_pk_mul_f32 v[200:201], v[200:201], v[232:233] op_sel:[0,0] op_sel_hi:[1,1]
    v_pk_mul_f32 v[202:203], v[202:203], v[234:235] op_sel:[0,0] op_sel_hi:[1,1]
    v_pk_mul_f32 v[204:205], v[204:205], v[236:237] op_sel:[0,0] op_sel_hi:[1,1]
    v_pk_mul_f32 v[206:207], v[206:207], v[238:239] op_sel:[0,0] op_sel_hi:[1,1]
    v_pk_mul_f32 v[208:209], v[208:209], v[240:241] op_sel:[0,0] op_sel_hi:[1,1]
    v_exp_f32 v178, v178
    v_exp_f32 v179, v179
    v_exp_f32 v180, v180
    v_exp_f32 v181, v181
    v_exp_f32 v182, v182
    global_load_lds_dwordx4 v4, s[92:93] offset:1024 sc1
    v_exp_f32 v183, v183
    v_exp_f32 v184, v184
    v_exp_f32 v185, v185
    v_exp_f32 v186, v186
    v_exp_f32 v187, v187
    v_exp_f32 v188, v188
    v_exp_f32 v189, v189
    v_exp_f32 v190, v190
    v_exp_f32 v191, v191
    v_exp_f32 v192, v192
    v_exp_f32 v193, v193
    v_exp_f32 v194, v194
    global_load_dwordx4 v[62:65], v30, s[56:57] offset:-3072 sc1
    v_exp_f32 v195, v195
    v_exp_f32 v196, v196
    v_exp_f32 v197, v197
    v_exp_f32 v198, v198
    v_exp_f32 v199, v199
    v_exp_f32 v200, v200
    global_load_dwordx4 v[66:69], v30, s[56:57] offset:-2048 sc1
    v_exp_f32 v201, v201
    v_exp_f32 v202, v202
    v_exp_f32 v203, v203
    v_exp_f32 v204, v204
    v_exp_f32 v205, v205
    v_exp_f32 v206, v206
    global_load_dwordx4 v[70:73], v30, s[56:57] offset:-1024 sc1
    v_exp_f32 v207, v207
    v_exp_f32 v208, v208
    v_exp_f32 v209, v209
    v_pk_add_f32 v[178:179], v[178:179], 1.0 op_sel:[0,0] op_sel_hi:[1,0]
    v_pk_add_f32 v[180:181], v[180:181], 1.0 op_sel:[0,0] op_sel_hi:[1,0]
    v_pk_add_f32 v[182:183], v[182:183], 1.0 op_sel:[0,0] op_sel_hi:[1,0]
    v_pk_add_f32 v[184:185], v[184:185], 1.0 op_sel:[0,0] op_sel_hi:[1,0]
    global_load_dwordx4 v[74:77], v30, s[56:57] offset:0 sc1
    v_pk_add_f32 v[186:187], v[186:187], 1.0 op_sel:[0,0] op_sel_hi:[1,0]
    v_pk_add_f32 v[188:189], v[188:189], 1.0 op_sel:[0,0] op_sel_hi:[1,0]
    v_pk_add_f32 v[190:191], v[190:191], 1.0 op_sel:[0,0] op_sel_hi:[1,0]
    v_pk_add_f32 v[192:193], v[192:193], 1.0 op_sel:[0,0] op_sel_hi:[1,0]
    v_pk_add_f32 v[194:195], v[194:195], 1.0 op_sel:[0,0] op_sel_hi:[1,0]
    v_pk_add_f32 v[196:197], v[196:197], 1.0 op_sel:[0,0] op_sel_hi:[1,0]
    global_load_dwordx4 v[78:81], v30, s[56:57] offset:1024 sc1
    v_pk_add_f32 v[198:199], v[198:199], 1.0 op_sel:[0,0] op_sel_hi:[1,0]
    v_pk_add_f32 v[200:201], v[200:201], 1.0 op_sel:[0,0] op_sel_hi:[1,0]
    v_pk_add_f32 v[202:203], v[202:203], 1.0 op_sel:[0,0] op_sel_hi:[1,0]
    v_pk_add_f32 v[204:205], v[204:205], 1.0 op_sel:[0,0] op_sel_hi:[1,0]
    v_pk_add_f32 v[206:207], v[206:207], 1.0 op_sel:[0,0] op_sel_hi:[1,0]
    v_pk_add_f32 v[208:209], v[208:209], 1.0 op_sel:[0,0] op_sel_hi:[1,0]
    v_rcp_f32 v178, v178
    global_load_dwordx4 v[82:85], v30, s[56:57] offset:2048 sc1
    v_rcp_f32 v179, v179
    v_rcp_f32 v180, v180
    v_rcp_f32 v181, v181
    v_rcp_f32 v182, v182
    v_rcp_f32 v183, v183
    v_rcp_f32 v184, v184
    global_load_dwordx4 v[86:89], v30, s[56:57] offset:3072 sc1
    v_rcp_f32 v185, v185
    v_rcp_f32 v186, v186
    v_rcp_f32 v187, v187
    v_rcp_f32 v188, v188
    v_rcp_f32 v189, v189
    v_rcp_f32 v190, v190
    v_rcp_f32 v191, v191
    global_load_dwordx4 v[90:93], v31, s[56:57] offset:-3072 sc1
    v_rcp_f32 v192, v192
    v_rcp_f32 v193, v193
    v_rcp_f32 v194, v194
    v_rcp_f32 v195, v195
    v_rcp_f32 v196, v196
    v_rcp_f32 v197, v197
    global_load_dwordx4 v[94:97], v31, s[56:57] offset:-2048 sc1
    v_rcp_f32 v198, v198
    v_rcp_f32 v199, v199
    v_rcp_f32 v200, v200
    v_rcp_f32 v201, v201
    v_rcp_f32 v202, v202
    v_rcp_f32 v203, v203
    global_load_dwordx4 v[98:101], v31, s[56:57] offset:-1024 sc1
    v_rcp_f32 v204, v204
    v_rcp_f32 v205, v205
    v_rcp_f32 v206, v206
    v_rcp_f32 v207, v207
    v_rcp_f32 v208, v208
    v_rcp_f32 v209, v209
    v_pk_mul_f32 v[210:211], v[210:211], v[178:179] op_sel:[0,0] op_sel_hi:[1,1]
    global_load_dwordx4 v[102:105], v31, s[56:57] offset:0 sc1
    v_pk_mul_f32 v[212:213], v[212:213], v[180:181] op_sel:[0,0] op_sel_hi:[1,1]
    v_pk_mul_f32 v[214:215], v[214:215], v[182:183] op_sel:[0,0] op_sel_hi:[1,1]
    v_pk_mul_f32 v[216:217], v[216:217], v[184:185] op_sel:[0,0] op_sel_hi:[1,1]
    v_pk_mul_f32 v[218:219], v[218:219], v[186:187] op_sel:[0,0] op_sel_hi:[1,1]
    v_pk_mul_f32 v[220:221], v[220:221], v[188:189] op_sel:[0,0] op_sel_hi:[1,1]
    v_pk_mul_f32 v[222:223], v[222:223], v[190:191] op_sel:[0,0] op_sel_hi:[1,1]
    global_load_dwordx4 v[106:109], v31, s[56:57] offset:1024 sc1
    v_pk_mul_f32 v[224:225], v[224:225], v[192:193] op_sel:[0,0] op_sel_hi:[1,1]
    v_pk_mul_f32 v[226:227], v[226:227], v[194:195] op_sel:[0,0] op_sel_hi:[1,1]
    v_pk_mul_f32 v[228:229], v[228:229], v[196:197] op_sel:[0,0] op_sel_hi:[1,1]
    v_pk_mul_f32 v[230:231], v[230:231], v[198:199] op_sel:[0,0] op_sel_hi:[1,1]
    v_pk_mul_f32 v[232:233], v[232:233], v[200:201] op_sel:[0,0] op_sel_hi:[1,1]
    v_pk_mul_f32 v[234:235], v[234:235], v[202:203] op_sel:[0,0] op_sel_hi:[1,1]
    v_pk_mul_f32 v[236:237], v[236:237], v[204:205] op_sel:[0,0] op_sel_hi:[1,1]
    global_load_dwordx4 v[110:113], v31, s[56:57] offset:2048 sc1
    v_pk_mul_f32 v[238:239], v[238:239], v[206:207] op_sel:[0,0] op_sel_hi:[1,1]
    v_pk_mul_f32 v[240:241], v[240:241], v[208:209] op_sel:[0,0] op_sel_hi:[1,1]
    v_cvt_pk_bf16_f32 v178, v210, v211
    v_cvt_pk_bf16_f32 v179, v212, v213
    v_cvt_pk_bf16_f32 v180, v214, v215
    v_cvt_pk_bf16_f32 v181, v216, v217
    global_load_dwordx4 v[114:117], v31, s[56:57] offset:3072 sc1
    v_cvt_pk_bf16_f32 v182, v218, v219
    v_cvt_pk_bf16_f32 v183, v220, v221
    v_cvt_pk_bf16_f32 v184, v222, v223
    v_cvt_pk_bf16_f32 v185, v224, v225
    v_cvt_pk_bf16_f32 v186, v226, v227
    v_cvt_pk_bf16_f32 v187, v228, v229
    v_cvt_pk_bf16_f32 v188, v230, v231
    global_load_dwordx4 v[118:121], v30, s[58:59] offset:-3072 sc1
    v_cvt_pk_bf16_f32 v189, v232, v233
    v_cvt_pk_bf16_f32 v190, v234, v235
    v_cvt_pk_bf16_f32 v191, v236, v237
    v_cvt_pk_bf16_f32 v192, v238, v239
    v_cvt_pk_bf16_f32 v193, v240, v241
    ds_write_b64 v170, v[178:179] offset:0
    global_load_dwordx4 v[122:125], v30, s[58:59] offset:-2048 sc1
    ds_write_b64 v170, v[180:181] offset:4096
    ds_write_b64 v170, v[182:183] offset:8192
    ds_write_b64 v170, v[184:185] offset:12288
    ds_write_b64 v170, v[186:187] offset:512
    ds_write_b64 v170, v[188:189] offset:4608
    ds_write_b64 v170, v[190:191] offset:8704
    ds_write_b64 v170, v[192:193] offset:12800
    s_waitcnt lgkmcnt(0)
    s_barrier
    ds_read_b64 v[48:49], v171 offset:0
    ds_read_b64 v[50:51], v171 offset:512
    ds_read_b64 v[52:53], v171 offset:1024
    ds_read_b64 v[54:55], v171 offset:1536
    ds_read_b64 v[56:57], v171 offset:2048
    ds_read_b64 v[58:59], v171 offset:2560
    ds_read_b64 v[60:61], v171 offset:3072
Lmid:
    s_waitcnt vmcnt(14)
    v_and_b32 v28, v65, v69
    s_waitcnt vmcnt(12)
    v_bitop3_b32 v28, v73, v77, v28 bitop3:0x80
    v_and_b32 v28, 1, v28
    v_cmp_ne_u32 vcc, 1, v28
    s_nop 0
    s_cbranch_vccnz Lz0_r
Lz0_ok:
    v_mfma_f32_16x16x32_bf16 v[142:145], v[62:65], a[160:163], v[32:35]
    global_load_dwordx4 v[126:129], v30, s[58:59] offset:-1024 sc1
    v_mfma_f32_16x16x32_bf16 v[146:149], v[62:65], a[164:167], 0
    v_mfma_f32_16x16x32_bf16 v[150:153], v[62:65], a[168:171], 0
    v_mfma_f32_16x16x32_bf16 v[154:157], v[62:65], a[172:175], 0
    v_mfma_f32_16x16x32_bf16 v[158:161], v[66:69], a[160:163], v[32:35]
    global_load_dwordx4 v[130:133], v30, s[58:59] offset:0 sc1
    v_mfma_f32_16x16x32_bf16 v[162:165], v[66:69], a[164:167], 0
    v_mfma_f32_16x16x32_bf16 v[166:169], v[66:69], a[168:171], 0
    v_mfma_f32_16x16x32_bf16 v[170:173], v[66:69], a[172:175], 0
    v_mfma_f32_16x16x32_bf16 v[174:177], v[70:73], a[160:163], v[32:35]
    global_load_dwordx4 v[134:137], v30, s[58:59] offset:1024 sc1
    v_mfma_f32_16x16x32_bf16 v[178:181], v[70:73], a[164:167], 0
    v_mfma_f32_16x16x32_bf16 v[182:185], v[70:73], a[168:171], 0
    s_waitcnt vmcnt(13)
    v_and_b32 v28, v81, v85
    v_mfma_f32_16x16x32_bf16 v[186:189], v[70:73], a[172:175], 0
    s_waitcnt vmcnt(11)
    v_bitop3_b32 v28, v89, v93, v28 bitop3:0x80
    v_mfma_f32_16x16x32_bf16 v[190:193], v[74:77], a[160:163], v[32:35]
    v_and_b32 v28, 1, v28
    global_load_dwordx4 v[138:141], v30, s[58:59] offset:2048 sc1
    v_mfma_f32_16x16x32_bf16 v[194:197], v[74:77], a[164:167], 0
    v_cmp_ne_u32 vcc, 1, v28
    v_mfma_f32_16x16x32_bf16 v[198:201], v[74:77], a[168:171], 0
    v_mfma_f32_16x16x32_bf16 v[202:205], v[74:77], a[172:175], 0
    s_cbranch_vccnz Lz1_r
Lz1_ok:
    v_mfma_f32_16x16x32_bf16 v[206:209], v[78:81], a[160:163], v[32:35]
    global_load_dwordx4 v[62:65], v30, s[58:59] offset:3072 sc1
    s_xor_b32 s4, s3, 1
    s_mul_i32 s4, s4, 3072
    v_mfma_f32_16x16x32_bf16 v[210:213], v[78:81], a[164:167], 0
    s_add_u32 s4, s4, 138240
    v_add_u32 v20, s4, v4
    s_xor_b32 s4, s3, 2
    v_mfma_f32_16x16x32_bf16 v[214:217], v[78:81], a[168:171], 0
    s_mul_i32 s4, s4, 3072
    s_add_u32 s4, s4, 139264
    v_add_u32 v21, s4, v4
    v_mfma_f32_16x16x32_bf16 v[218:221], v[78:81], a[172:175], 0
    s_xor_b32 s4, s3, 3
    s_mul_i32 s4, s4, 3072
    v_mfma_f32_16x16x32_bf16 v[222:225], v[82:85], a[160:163], v[32:35]
    global_load_dwordx4 v[66:69], v31, s[58:59] offset:-3072 sc1
    s_add_u32 s4, s4, 140288
    v_add_u32 v22, s4, v4
    v_mfma_f32_16x16x32_bf16 v[226:229], v[82:85], a[164:167], 0
    s_mul_i32 s4, s3, 3072
    s_add_u32 s4, s4, 138240
    v_add_u32 v23, s4, v4
    v_mfma_f32_16x16x32_bf16 v[230:233], v[82:85], a[168:171], 0
    s_mul_i32 s4, s40, 114688
    s_add_u32 s4, s4, 1052672
    v_mfma_f32_16x16x32_bf16 v[234:237], v[82:85], a[172:175], 0
    s_lshl_b32 s5, s3, 13
    s_add_u32 s5, s5, s4
    v_mfma_f32_16x16x32_bf16 v[238:241], v[86:89], a[160:163], v[32:35]
    global_load_dwordx4 v[70:73], v31, s[58:59] offset:-2048 sc1
    v_add_u32 v6, s5, v4
    v_mfma_f32_16x16x32_bf16 v[242:245], v[86:89], a[164:167], 0
    v_add_u32 v7, 32768, v6
    v_add_u32 v26, 65536, v6
    s_lshl_b32 s5, s3, 12
    v_mfma_f32_16x16x32_bf16 v[246:249], v[86:89], a[168:171], 0
    s_waitcnt vmcnt(13)
    v_and_b32 v28, v97, v101
    s_add_u32 s5, s5, s4
    s_add_u32 s5, s5, 98304
    v_mfma_f32_16x16x32_bf16 v[250:253], v[86:89], a[172:175], 0
    s_waitcnt vmcnt(11)
    v_bitop3_b32 v28, v105, v109, v28 bitop3:0x80
    v_add_u32 v27, s5, v4
    s_lshl_b32 s4, s41, 10
    v_mfma_f32_16x16x32_bf16 v[142:145], v[90:93], a[176:179], v[142:145]
    s_add_u32 s8, s38, s4
    s_addc_u32 s9, s39, 0
    v_and_b32 v28, 1, v28
    v_mfma_f32_16x16x32_bf16 v[146:149], v[90:93], a[180:183], v[146:149]
    global_load_dwordx4 v[74:77], v31, s[58:59] offset:-1024 sc1
    s_lshr_b32 s4, s41, 1
    s_lshl_b32 s4, s4, 10
    s_and_b32 s5, s41, 1
    v_mfma_f32_16x16x32_bf16 v[150:153], v[90:93], a[184:187], v[150:153]
    v_cmp_ne_u32 vcc, 1, v28
    s_lshl_b32 s5, s5, 3
    s_add_u32 s4, s4, s5
    s_add_u32 s10, s38, s4
    s_addc_u32 s11, s39, 0
    v_mfma_f32_16x16x32_bf16 v[154:157], v[90:93], a[188:191], v[154:157]
    s_waitcnt lgkmcnt(0)
    s_barrier
    s_cbranch_vccnz Lz2_r
Lz2_ok:
    v_mfma_f32_16x16x32_bf16 v[158:161], v[94:97], a[176:179], v[158:161]
    global_load_dwordx4 v[78:81], v31, s[58:59] offset:0 sc1
    v_mfma_f32_16x16x32_bf16 v[162:165], v[94:97], a[180:183], v[162:165]
    v_mfma_f32_16x16x32_bf16 v[166:169], v[94:97], a[184:187], v[166:169]
    v_mfma_f32_16x16x32_bf16 v[170:173], v[94:97], a[188:191], v[170:173]
    v_mfma_f32_16x16x32_bf16 v[174:177], v[98:101], a[176:179], v[174:177]
    global_load_dwordx4 v[82:85], v31, s[58:59] offset:1024 sc1
    v_mfma_f32_16x16x32_bf16 v[178:181], v[98:101], a[180:183], v[178:181]
    v_mfma_f32_16x16x32_bf16 v[182:185], v[98:101], a[184:187], v[182:185]
    v_mfma_f32_16x16x32_bf16 v[186:189], v[98:101], a[188:191], v[186:189]
    v_mfma_f32_16x16x32_bf16 v[190:193], v[102:105], a[176:179], v[190:193]
    global_load_dwordx4 v[86:89], v31, s[58:59] offset:2048 sc1
    v_mfma_f32_16x16x32_bf16 v[194:197], v[102:105], a[180:183], v[194:197]
    v_mfma_f32_16x16x32_bf16 v[198:201], v[102:105], a[184:187], v[198:201]
    s_waitcnt vmcnt(13)
    v_and_b32 v28, v113, v117
    v_mfma_f32_16x16x32_bf16 v[202:205], v[102:105], a[188:191], v[202:205]
    s_waitcnt vmcnt(11)
    v_bitop3_b32 v28, v121, v125, v28 bitop3:0x80
    v_mfma_f32_16x16x32_bf16 v[206:209], v[106:109], a[176:179], v[206:209]
    v_and_b32 v28, 1, v28
    global_load_dwordx4 v[90:93], v31, s[58:59] offset:3072 sc1
    v_mfma_f32_16x16x32_bf16 v[210:213], v[106:109], a[180:183], v[210:213]
    v_cmp_ne_u32 vcc, 1, v28
    v_mfma_f32_16x16x32_bf16 v[214:217], v[106:109], a[184:187], v[214:217]
    v_mfma_f32_16x16x32_bf16 v[218:221], v[106:109], a[188:191], v[218:221]
    s_cbranch_vccnz Lz3_r
Lz3_ok:
    v_mfma_f32_16x16x32_bf16 v[222:225], v[110:113], a[176:179], v[222:225]
    global_load_dwordx4 v[94:97], v30, s[60:61] offset:-3072 sc1
    v_mfma_f32_16x16x32_bf16 v[226:229], v[110:113], a[180:183], v[226:229]
    v_mfma_f32_16x16x32_bf16 v[230:233], v[110:113], a[184:187], v[230:233]
    v_mfma_f32_16x16x32_bf16 v[234:237], v[110:113], a[188:191], v[234:237]
    v_mfma_f32_16x16x32_bf16 v[238:241], v[114:117], a[176:179], v[238:241]
    global_load_dwordx4 v[98:101], v31, s[60:61] offset:-3072 sc1
    v_mfma_f32_16x16x32_bf16 v[242:245], v[114:117], a[180:183], v[242:245]
    v_mfma_f32_16x16x32_bf16 v[246:249], v[114:117], a[184:187], v[246:249]
    v_mfma_f32_16x16x32_bf16 v[250:253], v[114:117], a[188:191], v[250:253]
    v_mfma_f32_16x16x32_bf16 v[142:145], v[118:121], a[0:3], v[142:145]
    global_load_dwordx4 v[102:105], v30, s[62:63] offset:-3072 sc1
    v_mfma_f32_16x16x32_bf16 v[146:149], v[118:121], a[4:7], v[146:149]
    v_mfma_f32_16x16x32_bf16 v[150:153], v[118:121], a[8:11], v[150:153]
    s_waitcnt vmcnt(13)
    v_and_b32 v28, v129, v133
    v_mfma_f32_16x16x32_bf16 v[154:157], v[118:121], a[12:15], v[154:157]
    s_waitcnt vmcnt(11)
    v_bitop3_b32 v28, v137, v141, v28 bitop3:0x80
    v_mfma_f32_16x16x32_bf16 v[158:161], v[122:125], a[0:3], v[158:161]
    v_and_b32 v28, 1, v28
    global_load_dwordx4 v[106:109], v31, s[62:63] offset:-3072 sc1
    v_mfma_f32_16x16x32_bf16 v[162:165], v[122:125], a[4:7], v[162:165]
    v_cmp_ne_u32 vcc, 1, v28
    v_mfma_f32_16x16x32_bf16 v[166:169], v[122:125], a[8:11], v[166:169]
    v_mfma_f32_16x16x32_bf16 v[170:173], v[122:125], a[12:15], v[170:173]
    s_cbranch_vccnz Lz4_r
Lz4_ok:
    v_mfma_f32_16x16x32_bf16 v[174:177], v[126:129], a[0:3], v[174:177]
    global_load_dwordx4 v[110:113], v30, s[52:53] offset:-3072 sc1
    v_mfma_f32_16x16x32_bf16 v[178:181], v[126:129], a[4:7], v[178:181]
    v_mfma_f32_16x16x32_bf16 v[182:185], v[126:129], a[8:11], v[182:185]
    v_mfma_f32_16x16x32_bf16 v[186:189], v[126:129], a[12:15], v[186:189]
    v_mfma_f32_16x16x32_bf16 v[190:193], v[130:133], a[0:3], v[190:193]
    global_load_dwordx4 v[114:117], v31, s[52:53] offset:-3072 sc1
    v_mfma_f32_16x16x32_bf16 v[194:197], v[130:133], a[4:7], v[194:197]
    v_mfma_f32_16x16x32_bf16 v[198:201], v[130:133], a[8:11], v[198:201]
    v_mfma_f32_16x16x32_bf16 v[202:205], v[130:133], a[12:15], v[202:205]
    v_mfma_f32_16x16x32_bf16 v[206:209], v[134:137], a[0:3], v[206:209]
    global_load_dwordx4 v[118:121], v30, s[54:55] offset:-3072 sc1
    v_mfma_f32_16x16x32_bf16 v[210:213], v[134:137], a[4:7], v[210:213]
    v_mfma_f32_16x16x32_bf16 v[214:217], v[134:137], a[8:11], v[214:217]
    s_waitcnt vmcnt(13)
    v_and_b32 v28, v65, v69
    v_mfma_f32_16x16x32_bf16 v[218:221], v[134:137], a[12:15], v[218:221]
    s_waitcnt vmcnt(11)
    v_bitop3_b32 v28, v73, v77, v28 bitop3:0x80
    v_mfma_f32_16x16x32_bf16 v[222:225], v[138:141], a[0:3], v[222:225]
    v_and_b32 v28, 1, v28
    global_load_dwordx4 v[122:125], v31, s[54:55] offset:-3072 sc1
    v_mfma_f32_16x16x32_bf16 v[226:229], v[138:141], a[4:7], v[226:229]
    v_cmp_ne_u32 vcc, 1, v28
    v_mfma_f32_16x16x32_bf16 v[230:233], v[138:141], a[8:11], v[230:233]
    v_mfma_f32_16x16x32_bf16 v[234:237], v[138:141], a[12:15], v[234:237]
    s_cbranch_vccnz Lz5_r
Lz5_ok:
    v_mfma_f32_16x16x32_bf16 v[238:241], v[62:65], a[0:3], v[238:241]
    global_load_dwordx4 v[126:129], v30, s[64:65] offset:-3072 sc1
    v_mfma_f32_16x16x32_bf16 v[242:245], v[62:65], a[4:7], v[242:245]
    v_mfma_f32_16x16x32_bf16 v[246:249], v[62:65], a[8:11], v[246:249]
    v_mfma_f32_16x16x32_bf16 v[250:253], v[62:65], a[12:15], v[250:253]
    v_mfma_f32_16x16x32_bf16 v[142:145], v[66:69], a[16:19], v[142:145]
    global_load_dwordx4 v[130:133], v31, s[64:65] offset:-3072 sc1
    v_mfma_f32_16x16x32_bf16 v[146:149], v[66:69], a[20:23], v[146:149]
    v_mfma_f32_16x16x32_bf16 v[150:153], v[66:69], a[24:27], v[150:153]
    v_mfma_f32_16x16x32_bf16 v[154:157], v[66:69], a[28:31], v[154:157]
    v_mfma_f32_16x16x32_bf16 v[158:161], v[70:73], a[16:19], v[158:161]
    global_load_dwordx4 v[134:137], v30, s[66:67] offset:-3072 sc1
    v_mfma_f32_16x16x32_bf16 v[162:165], v[70:73], a[20:23], v[162:165]
    v_mfma_f32_16x16x32_bf16 v[166:169], v[70:73], a[24:27], v[166:169]
    s_waitcnt vmcnt(13)
    v_and_b32 v28, v81, v85
    v_mfma_f32_16x16x32_bf16 v[170:173], v[70:73], a[28:31], v[170:173]
    s_waitcnt vmcnt(11)
    v_bitop3_b32 v28, v89, v93, v28 bitop3:0x80
    v_mfma_f32_16x16x32_bf16 v[174:177], v[74:77], a[16:19], v[174:177]
    v_and_b32 v28, 1, v28
    global_load_dwordx4 v[138:141], v31, s[66:67] offset:-3072 sc1
    v_mfma_f32_16x16x32_bf16 v[178:181], v[74:77], a[20:23], v[178:181]
    v_cmp_ne_u32 vcc, 1, v28
    v_mfma_f32_16x16x32_bf16 v[182:185], v[74:77], a[24:27], v[182:185]
    v_mfma_f32_16x16x32_bf16 v[186:189], v[74:77], a[28:31], v[186:189]
    s_cbranch_vccnz Lz6_r
Lz6_ok:
    v_mfma_f32_16x16x32_bf16 v[190:193], v[78:81], a[16:19], v[190:193]
    global_load_dwordx4 v[62:65], v30, s[60:61] offset:-2048 sc1
    v_mfma_f32_16x16x32_bf16 v[194:197], v[78:81], a[20:23], v[194:197]
    v_mfma_f32_16x16x32_bf16 v[198:201], v[78:81], a[24:27], v[198:201]
    v_mfma_f32_16x16x32_bf16 v[202:205], v[78:81], a[28:31], v[202:205]
    v_mfma_f32_16x16x32_bf16 v[206:209], v[82:85], a[16:19], v[206:209]
    global_load_dwordx4 v[66:69], v31, s[60:61] offset:-2048 sc1
    v_mfma_f32_16x16x32_bf16 v[210:213], v[82:85], a[20:23], v[210:213]
    v_mfma_f32_16x16x32_bf16 v[214:217], v[82:85], a[24:27], v[214:217]
    v_mfma_f32_16x16x32_bf16 v[218:221], v[82:85], a[28:31], v[218:221]
    v_mfma_f32_16x16x32_bf16 v[222:225], v[86:89], a[16:19], v[222:225]
    global_load_dwordx4 v[70:73], v30, s[62:63] offset:-2048 sc1
    v_mfma_f32_16x16x32_bf16 v[226:229], v[86:89], a[20:23], v[226:229]
    v_mfma_f32_16x16x32_bf16 v[230:233], v[86:89], a[24:27], v[230:233]
    s_waitcnt vmcnt(13)
    v_and_b32 v28, v97, v101
    v_mfma_f32_16x16x32_bf16 v[234:237], v[86:89], a[28:31], v[234:237]
    s_waitcnt vmcnt(11)
    v_bitop3_b32 v28, v105, v109, v28 bitop3:0x80
    v_mfma_f32_16x16x32_bf16 v[238:241], v[90:93], a[16:19], v[238:241]
    v_and_b32 v28, 1, v28
    global_load_dwordx4 v[74:77], v31, s[62:63] offset:-2048 sc1
    v_mfma_f32_16x16x32_bf16 v[242:245], v[90:93], a[20:23], v[242:245]
    v_cmp_ne_u32 vcc, 1, v28
    v_mfma_f32_16x16x32_bf16 v[246:249], v[90:93], a[24:27], v[246:249]
    v_mfma_f32_16x16x32_bf16 v[250:253], v[90:93], a[28:31], v[250:253]
    s_cbranch_vccnz Lz7_r
Lz7_ok:
    v_mfma_f32_16x16x32_bf16 v[154:157], v[94:97], a[44:47], v[154:157]
    global_load_dwordx4 v[78:81], v30, s[52:53] offset:-2048 sc1
    v_mfma_f32_16x16x32_bf16 v[154:157], v[98:101], a[60:63], v[154:157]
    v_mfma_f32_16x16x32_bf16 v[154:157], v[102:105], a[76:79], v[154:157]
    v_mfma_f32_16x16x32_bf16 v[154:157], v[106:109], a[92:95], v[154:157]
    v_mfma_f32_16x16x32_bf16 v[150:153], v[94:97], a[40:43], v[150:153]
    global_load_dwordx4 v[82:85], v31, s[52:53] offset:-2048 sc1
    v_mfma_f32_16x16x32_bf16 v[150:153], v[98:101], a[56:59], v[150:153]
    v_mfma_f32_16x16x32_bf16 v[150:153], v[102:105], a[72:75], v[150:153]
    v_mfma_f32_16x16x32_bf16 v[150:153], v[106:109], a[88:91], v[150:153]
    v_mfma_f32_16x16x32_bf16 v[146:149], v[94:97], a[36:39], v[146:149]
    global_load_dwordx4 v[86:89], v30, s[54:55] offset:-2048 sc1
    v_mfma_f32_16x16x32_bf16 v[146:149], v[98:101], a[52:55], v[146:149]
    v_mfma_f32_16x16x32_bf16 v[146:149], v[102:105], a[68:71], v[146:149]
    s_waitcnt vmcnt(13)
    v_and_b32 v28, v113, v117
    v_mfma_f32_16x16x32_bf16 v[146:149], v[106:109], a[84:87], v[146:149]
    s_waitcnt vmcnt(11)
    v_bitop3_b32 v28, v121, v125, v28 bitop3:0x80
    v_mfma_f32_16x16x32_bf16 v[142:145], v[94:97], a[32:35], v[142:145]
    v_and_b32 v28, 1, v28
    global_load_dwordx4 v[90:93], v31, s[54:55] offset:-2048 sc1
    v_mfma_f32_16x16x32_bf16 v[142:145], v[98:101], a[48:51], v[142:145]
    v_cmp_ne_u32 vcc, 1, v28
    v_mfma_f32_16x16x32_bf16 v[142:145], v[102:105], a[64:67], v[142:145]
    v_mfma_f32_16x16x32_bf16 v[142:145], v[106:109], a[80:83], v[142:145]
    s_cbranch_vccnz Lz8_r
Lz8_ok:
    v_mfma_f32_16x16x32_bf16 v[154:157], v[110:113], a[236:239], v[154:157]
    global_load_dwordx4 v[94:97], v30, s[64:65] offset:-2048 sc1
    v_mfma_f32_16x16x32_bf16 v[154:157], v[114:117], a[252:255], v[154:157]
    v_mfma_f32_16x16x32_bf16 v[154:157], v[118:121], a[204:207], v[154:157]
    v_mfma_f32_16x16x32_bf16 v[154:157], v[122:125], a[220:223], v[154:157]
    v_mfma_f32_16x16x32_bf16 v[150:153], v[110:113], a[232:235], v[150:153]
    global_load_dwordx4 v[98:101], v31, s[64:65] offset:-2048 sc1
    v_mfma_f32_16x16x32_bf16 v[150:153], v[114:117], a[248:251], v[150:153]
    v_mfma_f32_16x16x32_bf16 v[150:153], v[118:121], a[200:203], v[150:153]
    v_mfma_f32_16x16x32_bf16 v[150:153], v[122:125], a[216:219], v[150:153]
    v_mfma_f32_16x16x32_bf16 v[146:149], v[110:113], a[228:231], v[146:149]
    global_load_dwordx4 v[102:105], v30, s[66:67] offset:-2048 sc1
    v_mfma_f32_16x16x32_bf16 v[146:149], v[114:117], a[244:247], v[146:149]
    v_mfma_f32_16x16x32_bf16 v[146:149], v[118:121], a[196:199], v[146:149]
    s_waitcnt vmcnt(13)
    v_and_b32 v28, v129, v133
    v_mfma_f32_16x16x32_bf16 v[146:149], v[122:125], a[212:215], v[146:149]
    s_waitcnt vmcnt(11)
    v_bitop3_b32 v28, v137, v141, v28 bitop3:0x80
    v_mfma_f32_16x16x32_bf16 v[142:145], v[110:113], a[224:227], v[142:145]
    v_and_b32 v28, 1, v28
    global_load_dwordx4 v[106:109], v31, s[66:67] offset:-2048 sc1
    v_mfma_f32_16x16x32_bf16 v[142:145], v[114:117], a[240:243], v[142:145]
    v_cmp_ne_u32 vcc, 1, v28
    v_mfma_f32_16x16x32_bf16 v[142:145], v[118:121], a[192:195], v[142:145]
    v_mfma_f32_16x16x32_bf16 v[142:145], v[122:125], a[208:211], v[142:145]
    s_cbranch_vccnz Lz9_r
Lz9_ok:
    v_mfma_f32_16x16x32_bf16 v[154:157], v[126:129], a[108:111], v[154:157]
    global_load_dwordx4 v[110:113], v30, s[60:61] offset:-1024 sc1
    v_mfma_f32_16x16x32_bf16 v[154:157], v[130:133], a[124:127], v[154:157]
    v_mfma_f32_16x16x32_bf16 v[154:157], v[134:137], a[140:143], v[154:157]
    v_mfma_f32_16x16x32_bf16 v[154:157], v[138:141], a[156:159], v[154:157]
    v_mfma_f32_16x16x32_bf16 v[150:153], v[126:129], a[104:107], v[150:153]
    global_load_dwordx4 v[114:117], v31, s[60:61] offset:-1024 sc1
    v_mfma_f32_16x16x32_bf16 v[150:153], v[130:133], a[120:123], v[150:153]
    v_mfma_f32_16x16x32_bf16 v[150:153], v[134:137], a[136:139], v[150:153]
    v_mfma_f32_16x16x32_bf16 v[150:153], v[138:141], a[152:155], v[150:153]
    v_mfma_f32_16x16x32_bf16 v[146:149], v[126:129], a[100:103], v[146:149]
    global_load_dwordx4 v[118:121], v30, s[62:63] offset:-1024 sc1
    v_mfma_f32_16x16x32_bf16 v[146:149], v[130:133], a[116:119], v[146:149]
    v_mfma_f32_16x16x32_bf16 v[146:149], v[134:137], a[132:135], v[146:149]
    s_waitcnt vmcnt(13)
    v_and_b32 v28, v65, v69
    v_mfma_f32_16x16x32_bf16 v[146:149], v[138:141], a[148:151], v[146:149]
    s_waitcnt vmcnt(11)
    v_bitop3_b32 v28, v73, v77, v28 bitop3:0x80
    v_mfma_f32_16x16x32_bf16 v[142:145], v[126:129], a[96:99], v[142:145]
    v_and_b32 v28, 1, v28
    global_load_dwordx4 v[122:125], v31, s[62:63] offset:-1024 sc1
    v_mfma_f32_16x16x32_bf16 v[142:145], v[130:133], a[112:115], v[142:145]
    v_cmp_ne_u32 vcc, 1, v28
    v_mfma_f32_16x16x32_bf16 v[142:145], v[134:137], a[128:131], v[142:145]
    v_mfma_f32_16x16x32_bf16 v[142:145], v[138:141], a[144:147], v[142:145]
    s_cbranch_vccnz Lz10_r
Lz10_ok:
    v_mfma_f32_16x16x32_bf16 v[170:173], v[62:65], a[44:47], v[170:173]
    global_load_dwordx4 v[126:129], v30, s[52:53] offset:-1024 sc1
    v_mfma_f32_16x16x32_bf16 v[170:173], v[66:69], a[60:63], v[170:173]
    v_mfma_f32_16x16x32_bf16 v[170:173], v[70:73], a[76:79], v[170:173]
    v_mfma_f32_16x16x32_bf16 v[170:173], v[74:77], a[92:95], v[170:173]
    ds_write_b128 v20, v[146:149] offset:0
    v_mfma_f32_16x16x32_bf16 v[166:169], v[62:65], a[40:43], v[166:169]
    global_load_dwordx4 v[130:133], v31, s[52:53] offset:-1024 sc1
    v_mfma_f32_16x16x32_bf16 v[166:169], v[66:69], a[56:59], v[166:169]
    v_mfma_f32_16x16x32_bf16 v[166:169], v[70:73], a[72:75], v[166:169]
    ds_write_b128 v21, v[150:153] offset:0
    v_mfma_f32_16x16x32_bf16 v[166:169], v[74:77], a[88:91], v[166:169]
    v_mfma_f32_16x16x32_bf16 v[162:165], v[62:65], a[36:39], v[162:165]
    global_load_dwordx4 v[134:137], v30, s[54:55] offset:-1024 sc1
    v_mfma_f32_16x16x32_bf16 v[162:165], v[66:69], a[52:55], v[162:165]
    ds_write_b128 v22, v[154:157] offset:0
    v_mfma_f32_16x16x32_bf16 v[162:165], v[70:73], a[68:71], v[162:165]
    s_waitcnt vmcnt(13)
    v_and_b32 v28, v81, v85
    v_mfma_f32_16x16x32_bf16 v[162:165], v[74:77], a[84:87], v[162:165]
    s_waitcnt vmcnt(11)
    v_bitop3_b32 v28, v89, v93, v28 bitop3:0x80
    v_mfma_f32_16x16x32_bf16 v[158:161], v[62:65], a[32:35], v[158:161]
    v_and_b32 v28, 1, v28
    global_load_dwordx4 v[138:141], v31, s[54:55] offset:-1024 sc1
    v_mfma_f32_16x16x32_bf16 v[158:161], v[66:69], a[48:51], v[158:161]
    s_waitcnt lgkmcnt(0)
    s_barrier
    v_cmp_ne_u32 vcc, 1, v28
    v_mfma_f32_16x16x32_bf16 v[158:161], v[70:73], a[64:67], v[158:161]
    v_mfma_f32_16x16x32_bf16 v[158:161], v[74:77], a[80:83], v[158:161]
    s_cbranch_vccnz Lz11_r
Lz11_ok:
    v_mfma_f32_16x16x32_bf16 v[170:173], v[78:81], a[236:239], v[170:173]
    global_load_dwordx4 v[62:65], v30, s[64:65] offset:-1024 sc1
    ds_read_b128 v[146:149], v23 offset:0
    v_mfma_f32_16x16x32_bf16 v[170:173], v[82:85], a[252:255], v[170:173]
    ds_read_b128 v[150:153], v23 offset:1024
    v_mfma_f32_16x16x32_bf16 v[170:173], v[86:89], a[204:207], v[170:173]
    ds_read_b128 v[154:157], v23 offset:2048
    v_mfma_f32_16x16x32_bf16 v[170:173], v[90:93], a[220:223], v[170:173]
    v_lshlrev_b32 v12, 16, v48
    v_mfma_f32_16x16x32_bf16 v[166:169], v[78:81], a[232:235], v[166:169]
    global_load_dwordx4 v[66:69], v31, s[64:65] offset:-1024 sc1
    v_and_b32 v13, 0xffff0000, v48
    v_mfma_f32_16x16x32_bf16 v[166:169], v[82:85], a[248:251], v[166:169]
    v_mfma_f32_16x16x32_bf16 v[166:169], v[86:89], a[200:203], v[166:169]
    v_lshlrev_b32 v14, 16, v49
    v_mfma_f32_16x16x32_bf16 v[166:169], v[90:93], a[216:219], v[166:169]
    v_and_b32 v15, 0xffff0000, v49
    v_mfma_f32_16x16x32_bf16 v[162:165], v[78:81], a[228:231], v[162:165]
    global_load_dwordx4 v[70:73], v30, s[66:67] offset:-1024 sc1
    s_waitcnt lgkmcnt(0)
    v_add_f32 v142, v142, v146
    v_mfma_f32_16x16x32_bf16 v[162:165], v[82:85], a[244:247], v[162:165]
    v_add_f32 v143, v143, v147
    v_mfma_f32_16x16x32_bf16 v[162:165], v[86:89], a[196:199], v[162:165]
    s_waitcnt vmcnt(13)
    v_and_b32 v28, v97, v101
    v_mfma_f32_16x16x32_bf16 v[162:165], v[90:93], a[212:215], v[162:165]
    s_waitcnt vmcnt(11)
    v_bitop3_b32 v28, v105, v109, v28 bitop3:0x80
    v_add_f32 v144, v144, v148
    v_mfma_f32_16x16x32_bf16 v[158:161], v[78:81], a[224:227], v[158:161]
    v_and_b32 v28, 1, v28
    global_load_dwordx4 v[74:77], v31, s[66:67] offset:-1024 sc1
    v_mfma_f32_16x16x32_bf16 v[158:161], v[82:85], a[240:243], v[158:161]
    v_add_f32 v145, v145, v149
    v_cmp_ne_u32 vcc, 1, v28
    v_mfma_f32_16x16x32_bf16 v[158:161], v[86:89], a[192:195], v[158:161]
    v_add_f32 v142, v142, v150
    v_add_f32 v143, v143, v151
    v_mfma_f32_16x16x32_bf16 v[158:161], v[90:93], a[208:211], v[158:161]
    s_cbranch_vccnz Lz12_r
Lz12_ok:
    v_mfma_f32_16x16x32_bf16 v[170:173], v[94:97], a[108:111], v[170:173]
    global_load_dwordx4 v[78:81], v30, s[60:61] offset:0 sc1
    v_add_f32 v144, v144, v152
    v_mfma_f32_16x16x32_bf16 v[170:173], v[98:101], a[124:127], v[170:173]
    v_add_f32 v145, v145, v153
    v_mfma_f32_16x16x32_bf16 v[170:173], v[102:105], a[140:143], v[170:173]
    v_add_f32 v142, v142, v154
    v_mfma_f32_16x16x32_bf16 v[170:173], v[106:109], a[156:159], v[170:173]
    v_mfma_f32_16x16x32_bf16 v[166:169], v[94:97], a[104:107], v[166:169]
    global_load_dwordx4 v[82:85], v31, s[60:61] offset:0 sc1
    v_add_f32 v143, v143, v155
    v_mfma_f32_16x16x32_bf16 v[166:169], v[98:101], a[120:123], v[166:169]
    v_add_f32 v144, v144, v156
    v_mfma_f32_16x16x32_bf16 v[166:169], v[102:105], a[136:139], v[166:169]
    v_add_f32 v145, v145, v157
    v_mfma_f32_16x16x32_bf16 v[166:169], v[106:109], a[152:155], v[166:169]
    v_mfma_f32_16x16x32_bf16 v[162:165], v[94:97], a[100:103], v[162:165]
    global_load_dwordx4 v[86:89], v30, s[62:63] offset:0 sc1
    v_mul_f32 v142, v142, v12
    v_mfma_f32_16x16x32_bf16 v[162:165], v[98:101], a[116:119], v[162:165]
    v_mul_f32 v143, v143, v13
    v_mfma_f32_16x16x32_bf16 v[162:165], v[102:105], a[132:135], v[162:165]
    s_waitcnt vmcnt(13)
    v_and_b32 v28, v113, v117
    v_mul_f32 v144, v144, v14
    v_mfma_f32_16x16x32_bf16 v[162:165], v[106:109], a[148:151], v[162:165]
    s_waitcnt vmcnt(11)
    v_bitop3_b32 v28, v121, v125, v28 bitop3:0x80
    v_mfma_f32_16x16x32_bf16 v[158:161], v[94:97], a[96:99], v[158:161]
    v_and_b32 v28, 1, v28
    global_load_dwordx4 v[90:93], v31, s[62:63] offset:0 sc1
    v_mfma_f32_16x16x32_bf16 v[158:161], v[98:101], a[112:115], v[158:161]
    v_mul_f32 v145, v145, v15
    v_cmp_ne_u32 vcc, 1, v28
    v_mfma_f32_16x16x32_bf16 v[158:161], v[102:105], a[128:131], v[158:161]
    v_cvt_pk_bf16_f32 v48, v142, v143
    v_cvt_pk_bf16_f32 v49, v144, v145
    v_mfma_f32_16x16x32_bf16 v[158:161], v[106:109], a[144:147], v[158:161]
    s_cbranch_vccnz Lz13_r
Lz13_ok:
    v_mfma_f32_16x16x32_bf16 v[186:189], v[110:113], a[44:47], v[186:189]
    global_load_dwordx4 v[94:97], v30, s[52:53] offset:0 sc1
    v_mfma_f32_16x16x32_bf16 v[186:189], v[114:117], a[60:63], v[186:189]
    v_mfma_f32_16x16x32_bf16 v[186:189], v[118:121], a[76:79], v[186:189]
    v_mfma_f32_16x16x32_bf16 v[186:189], v[122:125], a[92:95], v[186:189]
    ds_write_b128 v20, v[162:165] offset:12288
    v_mfma_f32_16x16x32_bf16 v[182:185], v[110:113], a[40:43], v[182:185]
    global_load_dwordx4 v[98:101], v31, s[52:53] offset:0 sc1
    v_mfma_f32_16x16x32_bf16 v[182:185], v[114:117], a[56:59], v[182:185]
    v_mfma_f32_16x16x32_bf16 v[182:185], v[118:121], a[72:75], v[182:185]
    ds_write_b128 v21, v[166:169] offset:12288
    v_mfma_f32_16x16x32_bf16 v[182:185], v[122:125], a[88:91], v[182:185]
    v_mfma_f32_16x16x32_bf16 v[178:181], v[110:113], a[36:39], v[178:181]
    global_load_dwordx4 v[102:105], v30, s[54:55] offset:0 sc1
    v_mfma_f32_16x16x32_bf16 v[178:181], v[114:117], a[52:55], v[178:181]
    ds_write_b128 v22, v[170:173] offset:12288
    v_mfma_f32_16x16x32_bf16 v[178:181], v[118:121], a[68:71], v[178:181]
    s_waitcnt vmcnt(13)
    v_and_b32 v28, v129, v133
    v_mfma_f32_16x16x32_bf16 v[178:181], v[122:125], a[84:87], v[178:181]
    s_waitcnt vmcnt(11)
    v_bitop3_b32 v28, v137, v141, v28 bitop3:0x80
    v_mfma_f32_16x16x32_bf16 v[174:177], v[110:113], a[32:35], v[174:177]
    v_and_b32 v28, 1, v28
    global_load_dwordx4 v[106:109], v31, s[54:55] offset:0 sc1
    v_mfma_f32_16x16x32_bf16 v[174:177], v[114:117], a[48:51], v[174:177]
    s_waitcnt lgkmcnt(0)
    s_barrier
    v_cmp_ne_u32 vcc, 1, v28
    v_mfma_f32_16x16x32_bf16 v[174:177], v[118:121], a[64:67], v[174:177]
    v_mfma_f32_16x16x32_bf16 v[174:177], v[122:125], a[80:83], v[174:177]
    s_cbranch_vccnz Lz14_r
Lz14_ok:
    v_mfma_f32_16x16x32_bf16 v[186:189], v[126:129], a[236:239], v[186:189]
    global_load_dwordx4 v[110:113], v30, s[64:65] offset:0 sc1
    ds_read_b128 v[162:165], v23 offset:12288
    v_mfma_f32_16x16x32_bf16 v[186:189], v[130:133], a[252:255], v[186:189]
    ds_read_b128 v[166:169], v23 offset:13312
    v_mfma_f32_16x16x32_bf16 v[186:189], v[134:137], a[204:207], v[186:189]
    ds_read_b128 v[170:173], v23 offset:14336
    global_load_dwordx4 v[114:117], v31, s[64:65] offset:0 sc1
    v_mfma_f32_16x16x32_bf16 v[186:189], v[138:141], a[220:223], v[186:189]
    v_lshlrev_b32 v12, 16, v50
    v_mfma_f32_16x16x32_bf16 v[182:185], v[126:129], a[232:235], v[182:185]
    v_and_b32 v13, 0xffff0000, v50
    v_mfma_f32_16x16x32_bf16 v[182:185], v[130:133], a[248:251], v[182:185]
    global_load_dwordx4 v[118:121], v30, s[66:67] offset:0 sc1
    v_mfma_f32_16x16x32_bf16 v[182:185], v[134:137], a[200:203], v[182:185]
    v_lshlrev_b32 v14, 16, v51
    v_mfma_f32_16x16x32_bf16 v[182:185], v[138:141], a[216:219], v[182:185]
    v_and_b32 v15, 0xffff0000, v51
    v_mfma_f32_16x16x32_bf16 v[178:181], v[126:129], a[228:231], v[178:181]
    global_load_dwordx4 v[122:125], v31, s[66:67] offset:0 sc1
    s_waitcnt lgkmcnt(0)
    v_add_f32 v158, v158, v162
    v_mfma_f32_16x16x32_bf16 v[178:181], v[130:133], a[244:247], v[178:181]
    v_add_f32 v159, v159, v163
    v_mfma_f32_16x16x32_bf16 v[178:181], v[134:137], a[196:199], v[178:181]
    s_waitcnt vmcnt(14)
    v_and_b32 v28, v65, v69
    global_load_lds_dwordx4 v4, s[92:93] offset:2048 sc1
    v_mfma_f32_16x16x32_bf16 v[178:181], v[138:141], a[212:215], v[178:181]
    s_waitcnt vmcnt(13)
    v_bitop3_b32 v28, v73, v77, v28 bitop3:0x80
    v_add_f32 v160, v160, v164
    v_mfma_f32_16x16x32_bf16 v[174:177], v[126:129], a[224:227], v[174:177]
    v_and_b32 v28, 1, v28
    v_add_f32 v161, v161, v165
    v_mfma_f32_16x16x32_bf16 v[174:177], v[130:133], a[240:243], v[174:177]
    v_cmp_ne_u32 vcc, 1, v28
    global_load_lds_dwordx4 v4, s[92:93] offset:3072 sc1
    v_mfma_f32_16x16x32_bf16 v[174:177], v[134:137], a[192:195], v[174:177]
    v_add_f32 v158, v158, v166
    v_add_f32 v159, v159, v167
    v_mfma_f32_16x16x32_bf16 v[174:177], v[138:141], a[208:211], v[174:177]
    s_cbranch_vccnz Lz15_r
Lz15_ok:
    v_mfma_f32_16x16x32_bf16 v[186:189], v[62:65], a[108:111], v[186:189]
    global_load_dwordx4 v[126:129], v30, s[60:61] offset:1024 sc1
    v_add_f32 v160, v160, v168
    v_mfma_f32_16x16x32_bf16 v[186:189], v[66:69], a[124:127], v[186:189]
    v_add_f32 v161, v161, v169
    global_load_dwordx4 v[130:133], v31, s[60:61] offset:1024 sc1
    v_mfma_f32_16x16x32_bf16 v[186:189], v[70:73], a[140:143], v[186:189]
    v_add_f32 v158, v158, v170
    v_mfma_f32_16x16x32_bf16 v[186:189], v[74:77], a[156:159], v[186:189]
    global_load_dwordx4 v[134:137], v30, s[62:63] offset:1024 sc1
    v_add_f32 v159, v159, v171
    v_mfma_f32_16x16x32_bf16 v[182:185], v[62:65], a[104:107], v[182:185]
    v_add_f32 v160, v160, v172
    v_mfma_f32_16x16x32_bf16 v[182:185], v[66:69], a[120:123], v[182:185]
    global_load_dwordx4 v[138:141], v31, s[62:63] offset:1024 sc1
    v_mfma_f32_16x16x32_bf16 v[182:185], v[70:73], a[136:139], v[182:185]
    v_add_f32 v161, v161, v173
    v_mfma_f32_16x16x32_bf16 v[182:185], v[74:77], a[152:155], v[182:185]
    s_add_u32 m0, s95, 8192
    v_mul_f32 v158, v158, v12
    v_mfma_f32_16x16x32_bf16 v[178:181], v[62:65], a[100:103], v[178:181]
    v_mul_f32 v159, v159, v13
    s_add_u32 s92, s92, 4096
    s_addc_u32 s93, s93, 0
    v_mfma_f32_16x16x32_bf16 v[178:181], v[66:69], a[116:119], v[178:181]
    v_mul_f32 v160, v160, v14
    v_mfma_f32_16x16x32_bf16 v[178:181], v[70:73], a[132:135], v[178:181]
    s_waitcnt vmcnt(16)
    v_and_b32 v28, v81, v85
    v_mfma_f32_16x16x32_bf16 v[178:181], v[74:77], a[148:151], v[178:181]
    s_waitcnt vmcnt(14)
    v_bitop3_b32 v28, v89, v93, v28 bitop3:0x80
    v_mul_f32 v161, v161, v15
    v_mfma_f32_16x16x32_bf16 v[174:177], v[62:65], a[96:99], v[174:177]
    v_and_b32 v28, 1, v28
    v_cvt_pk_bf16_f32 v50, v158, v159
    v_mfma_f32_16x16x32_bf16 v[174:177], v[66:69], a[112:115], v[174:177]
    global_load_lds_dwordx4 v4, s[92:93] offset:0 sc1
    v_cmp_ne_u32 vcc, 1, v28
    v_mfma_f32_16x16x32_bf16 v[174:177], v[70:73], a[128:131], v[174:177]
    v_cvt_pk_bf16_f32 v51, v160, v161
    global_load_lds_dwordx4 v4, s[92:93] offset:1024 sc1
    v_mfma_f32_16x16x32_bf16 v[174:177], v[74:77], a[144:147], v[174:177]
    v_and_b32 v51, -2, v51
    s_cbranch_vccnz Lz16_r
Lz16_ok:
    v_mfma_f32_16x16x32_bf16 v[202:205], v[78:81], a[44:47], v[202:205]
    global_load_dwordx4 v[62:65], v30, s[52:53] offset:1024 sc1
    v_mfma_f32_16x16x32_bf16 v[202:205], v[82:85], a[60:63], v[202:205]
    v_mfma_f32_16x16x32_bf16 v[202:205], v[86:89], a[76:79], v[202:205]
    global_load_dwordx4 v[66:69], v31, s[52:53] offset:1024 sc1
    v_mfma_f32_16x16x32_bf16 v[202:205], v[90:93], a[92:95], v[202:205]
    ds_write_b128 v20, v[178:181] offset:0
    v_mfma_f32_16x16x32_bf16 v[198:201], v[78:81], a[40:43], v[198:201]
    v_mfma_f32_16x16x32_bf16 v[198:201], v[82:85], a[56:59], v[198:201]
    global_load_dwordx4 v[70:73], v30, s[54:55] offset:1024 sc1
    v_mfma_f32_16x16x32_bf16 v[198:201], v[86:89], a[72:75], v[198:201]
    ds_write_b128 v21, v[182:185] offset:0
    v_mfma_f32_16x16x32_bf16 v[198:201], v[90:93], a[88:91], v[198:201]
    v_mfma_f32_16x16x32_bf16 v[194:197], v[78:81], a[36:39], v[194:197]
    global_load_dwordx4 v[74:77], v31, s[54:55] offset:1024 sc1
    v_mfma_f32_16x16x32_bf16 v[194:197], v[82:85], a[52:55], v[194:197]
    ds_write_b128 v22, v[186:189] offset:0
    v_mfma_f32_16x16x32_bf16 v[194:197], v[86:89], a[68:71], v[194:197]
    s_waitcnt vmcnt(18)
    v_and_b32 v28, v97, v101
    global_load_lds_dwordx4 v4, s[92:93] offset:2048 sc1
    v_mfma_f32_16x16x32_bf16 v[194:197], v[90:93], a[84:87], v[194:197]
    s_waitcnt vmcnt(17)
    v_bitop3_b32 v28, v105, v109, v28 bitop3:0x80
    v_mfma_f32_16x16x32_bf16 v[190:193], v[78:81], a[32:35], v[190:193]
    v_and_b32 v28, 1, v28
    s_waitcnt lgkmcnt(0)
    s_barrier
    v_mfma_f32_16x16x32_bf16 v[190:193], v[82:85], a[48:51], v[190:193]
    v_cmp_ne_u32 vcc, 1, v28
    global_load_lds_dwordx4 v4, s[92:93] offset:3072 sc1
    v_mfma_f32_16x16x32_bf16 v[190:193], v[86:89], a[64:67], v[190:193]
    v_mfma_f32_16x16x32_bf16 v[190:193], v[90:93], a[80:83], v[190:193]
    s_cbranch_vccnz Lz17_r
Lz17_ok:
    v_mfma_f32_16x16x32_bf16 v[202:205], v[94:97], a[236:239], v[202:205]
    global_load_dwordx4 v[78:81], v30, s[64:65] offset:1024 sc1
    ds_read_b128 v[178:181], v23 offset:0
    v_mfma_f32_16x16x32_bf16 v[202:205], v[98:101], a[252:255], v[202:205]
    ds_read_b128 v[182:185], v23 offset:1024
    global_load_dwordx4 v[82:85], v31, s[64:65] offset:1024 sc1
    v_mfma_f32_16x16x32_bf16 v[202:205], v[102:105], a[204:207], v[202:205]
    ds_read_b128 v[186:189], v23 offset:2048
    v_mfma_f32_16x16x32_bf16 v[202:205], v[106:109], a[220:223], v[202:205]
    global_load_dwordx4 v[86:89], v30, s[66:67] offset:1024 sc1
    v_lshlrev_b32 v12, 16, v52
    v_mfma_f32_16x16x32_bf16 v[198:201], v[94:97], a[232:235], v[198:201]
    v_and_b32 v13, 0xffff0000, v52
    v_mfma_f32_16x16x32_bf16 v[198:201], v[98:101], a[248:251], v[198:201]
    global_load_dwordx4 v[90:93], v31, s[66:67] offset:1024 sc1
    v_mfma_f32_16x16x32_bf16 v[198:201], v[102:105], a[200:203], v[198:201]
    v_lshlrev_b32 v14, 16, v53
    v_mfma_f32_16x16x32_bf16 v[198:201], v[106:109], a[216:219], v[198:201]
    s_add_u32 m0, s95, 12288
    v_and_b32 v15, 0xffff0000, v53
    v_mfma_f32_16x16x32_bf16 v[194:197], v[94:97], a[228:231], v[194:197]
    s_waitcnt lgkmcnt(0)
    v_add_f32 v174, v174, v178
    s_add_u32 s92, s92, 4096
    s_addc_u32 s93, s93, 0
    v_mfma_f32_16x16x32_bf16 v[194:197], v[98:101], a[244:247], v[194:197]
    v_add_f32 v175, v175, v179
    v_mfma_f32_16x16x32_bf16 v[194:197], v[102:105], a[196:199], v[194:197]
    s_waitcnt vmcnt(20)
    v_and_b32 v28, v113, v117
    v_mfma_f32_16x16x32_bf16 v[194:197], v[106:109], a[212:215], v[194:197]
    s_waitcnt vmcnt(18)
    v_bitop3_b32 v28, v121, v125, v28 bitop3:0x80
    v_add_f32 v176, v176, v180
    v_mfma_f32_16x16x32_bf16 v[190:193], v[94:97], a[224:227], v[190:193]
    v_and_b32 v28, 1, v28
    v_add_f32 v177, v177, v181
    v_mfma_f32_16x16x32_bf16 v[190:193], v[98:101], a[240:243], v[190:193]
    global_load_lds_dwordx4 v4, s[92:93] offset:0 sc1
    v_cmp_ne_u32 vcc, 1, v28
    v_mfma_f32_16x16x32_bf16 v[190:193], v[102:105], a[192:195], v[190:193]
    v_add_f32 v174, v174, v182
    global_load_lds_dwordx4 v4, s[92:93] offset:1024 sc1
    v_mfma_f32_16x16x32_bf16 v[190:193], v[106:109], a[208:211], v[190:193]
    v_add_f32 v175, v175, v183
    s_cbranch_vccnz Lz18_r
Lz18_ok:
    v_mfma_f32_16x16x32_bf16 v[202:205], v[110:113], a[108:111], v[202:205]
    global_load_dwordx4 v[94:97], v30, s[60:61] offset:2048 sc1
    v_add_f32 v176, v176, v184
    v_mfma_f32_16x16x32_bf16 v[202:205], v[114:117], a[124:127], v[202:205]
    v_add_f32 v177, v177, v185
    v_mfma_f32_16x16x32_bf16 v[202:205], v[118:121], a[140:143], v[202:205]
    global_load_dwordx4 v[98:101], v31, s[60:61] offset:2048 sc1
    v_add_f32 v174, v174, v186
    v_mfma_f32_16x16x32_bf16 v[202:205], v[122:125], a[156:159], v[202:205]
    v_mfma_f32_16x16x32_bf16 v[198:201], v[110:113], a[104:107], v[198:201]
    v_add_f32 v175, v175, v187
    v_mfma_f32_16x16x32_bf16 v[198:201], v[114:117], a[120:123], v[198:201]
    global_load_dwordx4 v[102:105], v30, s[62:63] offset:2048 sc1
    v_add_f32 v176, v176, v188
    v_mfma_f32_16x16x32_bf16 v[198:201], v[118:121], a[136:139], v[198:201]
    v_add_f32 v177, v177, v189
    v_mfma_f32_16x16x32_bf16 v[198:201], v[122:125], a[152:155], v[198:201]
    v_mfma_f32_16x16x32_bf16 v[194:197], v[110:113], a[100:103], v[194:197]
    global_load_dwordx4 v[106:109], v31, s[62:63] offset:2048 sc1
    v_mul_f32 v174, v174, v12
    v_mfma_f32_16x16x32_bf16 v[194:197], v[114:117], a[116:119], v[194:197]
    v_mul_f32 v175, v175, v13
    v_mfma_f32_16x16x32_bf16 v[194:197], v[118:121], a[132:135], v[194:197]
    s_waitcnt vmcnt(20)
    v_and_b32 v28, v129, v133
    global_load_lds_dwordx4 v4, s[92:93] offset:2048 sc1
    v_mfma_f32_16x16x32_bf16 v[194:197], v[122:125], a[148:151], v[194:197]
    s_waitcnt vmcnt(19)
    v_bitop3_b32 v28, v137, v141, v28 bitop3:0x80
    v_mul_f32 v176, v176, v14
    v_mfma_f32_16x16x32_bf16 v[190:193], v[110:113], a[96:99], v[190:193]
    v_and_b32 v28, 1, v28
    v_mul_f32 v177, v177, v15
    v_mfma_f32_16x16x32_bf16 v[190:193], v[114:117], a[112:115], v[190:193]
    v_cmp_ne_u32 vcc, 1, v28
    global_load_lds_dwordx4 v4, s[92:93] offset:3072 sc1
    v_mfma_f32_16x16x32_bf16 v[190:193], v[118:121], a[128:131], v[190:193]
    v_cvt_pk_bf16_f32 v52, v174, v175
    v_cvt_pk_bf16_f32 v53, v176, v177
    v_mfma_f32_16x16x32_bf16 v[190:193], v[122:125], a[144:147], v[190:193]
    s_cbranch_vccnz Lz19_r
Lz19_ok:
    v_mfma_f32_16x16x32_bf16 v[218:221], v[126:129], a[44:47], v[218:221]
    global_load_dwordx4 v[110:113], v30, s[52:53] offset:2048 sc1
    v_mfma_f32_16x16x32_bf16 v[218:221], v[130:133], a[60:63], v[218:221]
    global_load_dwordx4 v[114:117], v31, s[52:53] offset:2048 sc1
    v_mfma_f32_16x16x32_bf16 v[218:221], v[134:137], a[76:79], v[218:221]
    v_mfma_f32_16x16x32_bf16 v[218:221], v[138:141], a[92:95], v[218:221]
    ds_write_b128 v20, v[194:197] offset:12288
    v_mfma_f32_16x16x32_bf16 v[214:217], v[126:129], a[40:43], v[214:217]
    global_load_dwordx4 v[118:121], v30, s[54:55] offset:2048 sc1
    v_mfma_f32_16x16x32_bf16 v[214:217], v[130:133], a[56:59], v[214:217]
    global_load_dwordx4 v[122:125], v31, s[54:55] offset:2048 sc1
    v_mfma_f32_16x16x32_bf16 v[214:217], v[134:137], a[72:75], v[214:217]
    ds_write_b128 v21, v[198:201] offset:12288
    v_mfma_f32_16x16x32_bf16 v[214:217], v[138:141], a[88:91], v[214:217]
    s_add_u32 m0, s95, 16384
    v_mfma_f32_16x16x32_bf16 v[210:213], v[126:129], a[36:39], v[210:213]
    s_add_u32 s92, s92, 4096
    s_addc_u32 s93, s93, 0
    v_mfma_f32_16x16x32_bf16 v[210:213], v[130:133], a[52:55], v[210:213]
    ds_write_b128 v22, v[202:205] offset:12288
    v_mfma_f32_16x16x32_bf16 v[210:213], v[134:137], a[68:71], v[210:213]
    s_waitcnt vmcnt(20)
    v_and_b32 v28, v65, v69
    v_mfma_f32_16x16x32_bf16 v[210:213], v[138:141], a[84:87], v[210:213]
    s_waitcnt vmcnt(18)
    v_bitop3_b32 v28, v73, v77, v28 bitop3:0x80
    v_mfma_f32_16x16x32_bf16 v[206:209], v[126:129], a[32:35], v[206:209]
    v_and_b32 v28, 1, v28
    global_load_lds_dwordx4 v4, s[92:93] offset:0 sc1
    v_mfma_f32_16x16x32_bf16 v[206:209], v[130:133], a[48:51], v[206:209]
    s_waitcnt lgkmcnt(0)
    s_barrier
    v_cmp_ne_u32 vcc, 1, v28
    v_mfma_f32_16x16x32_bf16 v[206:209], v[134:137], a[64:67], v[206:209]
    global_load_lds_dwordx4 v4, s[92:93] offset:1024 sc1
    v_mfma_f32_16x16x32_bf16 v[206:209], v[138:141], a[80:83], v[206:209]
    s_cbranch_vccnz Lz20_r
Lz20_ok:
    v_mfma_f32_16x16x32_bf16 v[218:221], v[62:65], a[236:239], v[218:221]
    global_load_dwordx4 v[126:129], v30, s[64:65] offset:2048 sc1
    ds_read_b128 v[194:197], v23 offset:12288
    v_mfma_f32_16x16x32_bf16 v[218:221], v[66:69], a[252:255], v[218:221]
    ds_read_b128 v[198:201], v23 offset:13312
    v_mfma_f32_16x16x32_bf16 v[218:221], v[70:73], a[204:207], v[218:221]
    ds_read_b128 v[202:205], v23 offset:14336
    global_load_dwordx4 v[130:133], v31, s[64:65] offset:2048 sc1
    v_mfma_f32_16x16x32_bf16 v[218:221], v[74:77], a[220:223], v[218:221]
    v_lshlrev_b32 v12, 16, v54
    v_mfma_f32_16x16x32_bf16 v[214:217], v[62:65], a[232:235], v[214:217]
    v_and_b32 v13, 0xffff0000, v54
    v_mfma_f32_16x16x32_bf16 v[214:217], v[66:69], a[248:251], v[214:217]
    global_load_dwordx4 v[134:137], v30, s[66:67] offset:2048 sc1
    v_mfma_f32_16x16x32_bf16 v[214:217], v[70:73], a[200:203], v[214:217]
    v_lshlrev_b32 v14, 16, v55
    v_mfma_f32_16x16x32_bf16 v[214:217], v[74:77], a[216:219], v[214:217]
    v_and_b32 v15, 0xffff0000, v55
    v_mfma_f32_16x16x32_bf16 v[210:213], v[62:65], a[228:231], v[210:213]
    global_load_dwordx4 v[138:141], v31, s[66:67] offset:2048 sc1
    s_waitcnt lgkmcnt(0)
    v_add_f32 v190, v190, v194
    v_mfma_f32_16x16x32_bf16 v[210:213], v[66:69], a[244:247], v[210:213]
    v_add_f32 v191, v191, v195
    v_mfma_f32_16x16x32_bf16 v[210:213], v[70:73], a[196:199], v[210:213]
    s_waitcnt vmcnt(20)
    v_and_b32 v28, v81, v85
    global_load_lds_dwordx4 v4, s[92:93] offset:2048 sc1
    v_mfma_f32_16x16x32_bf16 v[210:213], v[74:77], a[212:215], v[210:213]
    s_waitcnt vmcnt(19)
    v_bitop3_b32 v28, v89, v93, v28 bitop3:0x80
    v_add_f32 v192, v192, v196
    v_mfma_f32_16x16x32_bf16 v[206:209], v[62:65], a[224:227], v[206:209]
    v_and_b32 v28, 1, v28
    v_add_f32 v193, v193, v197
    v_mfma_f32_16x16x32_bf16 v[206:209], v[66:69], a[240:243], v[206:209]
    v_cmp_ne_u32 vcc, 1, v28
    global_load_lds_dwordx4 v4, s[92:93] offset:3072 sc1
    v_mfma_f32_16x16x32_bf16 v[206:209], v[70:73], a[192:195], v[206:209]
    v_add_f32 v190, v190, v198
    v_add_f32 v191, v191, v199
    v_mfma_f32_16x16x32_bf16 v[206:209], v[74:77], a[208:211], v[206:209]
    s_cbranch_vccnz Lz21_r
Lz21_ok:
    v_mfma_f32_16x16x32_bf16 v[218:221], v[78:81], a[108:111], v[218:221]
    global_load_dwordx4 v[62:65], v30, s[60:61] offset:3072 sc1
    v_add_f32 v192, v192, v200
    v_mfma_f32_16x16x32_bf16 v[218:221], v[82:85], a[124:127], v[218:221]
    v_add_f32 v193, v193, v201
    global_load_dwordx4 v[66:69], v31, s[60:61] offset:3072 sc1
    v_mfma_f32_16x16x32_bf16 v[218:221], v[86:89], a[140:143], v[218:221]
    v_add_f32 v190, v190, v202
    v_mfma_f32_16x16x32_bf16 v[218:221], v[90:93], a[156:159], v[218:221]
    global_load_dwordx4 v[70:73], v30, s[62:63] offset:3072 sc1
    v_add_f32 v191, v191, v203
    v_mfma_f32_16x16x32_bf16 v[214:217], v[78:81], a[104:107], v[214:217]
    v_add_f32 v192, v192, v204
    v_mfma_f32_16x16x32_bf16 v[214:217], v[82:85], a[120:123], v[214:217]
    global_load_dwordx4 v[74:77], v31, s[62:63] offset:3072 sc1
    v_mfma_f32_16x16x32_bf16 v[214:217], v[86:89], a[136:139], v[214:217]
    v_add_f32 v193, v193, v205
    v_mfma_f32_16x16x32_bf16 v[214:217], v[90:93], a[152:155], v[214:217]
    s_add_u32 m0, s95, 20480
    v_mul_f32 v190, v190, v12
    v_mfma_f32_16x16x32_bf16 v[210:213], v[78:81], a[100:103], v[210:213]
    v_mul_f32 v191, v191, v13
    s_add_u32 s92, s92, 4096
    s_addc_u32 s93, s93, 0
    v_mfma_f32_16x16x32_bf16 v[210:213], v[82:85], a[116:119], v[210:213]
    v_mul_f32 v192, v192, v14
    v_mfma_f32_16x16x32_bf16 v[210:213], v[86:89], a[132:135], v[210:213]
    s_waitcnt vmcnt(20)
    v_and_b32 v28, v97, v101
    v_mfma_f32_16x16x32_bf16 v[210:213], v[90:93], a[148:151], v[210:213]
    s_waitcnt vmcnt(18)
    v_bitop3_b32 v28, v105, v109, v28 bitop3:0x80
    v_mul_f32 v193, v193, v15
    v_mfma_f32_16x16x32_bf16 v[206:209], v[78:81], a[96:99], v[206:209]
    v_and_b32 v28, 1, v28
    v_cvt_pk_bf16_f32 v54, v190, v191
    v_mfma_f32_16x16x32_bf16 v[206:209], v[82:85], a[112:115], v[206:209]
    global_load_lds_dwordx4 v4, s[92:93] offset:0 sc1
    v_cmp_ne_u32 vcc, 1, v28
    v_mfma_f32_16x16x32_bf16 v[206:209], v[86:89], a[128:131], v[206:209]
    v_cvt_pk_bf16_f32 v55, v192, v193
    global_load_lds_dwordx4 v4, s[92:93] offset:1024 sc1
    v_mfma_f32_16x16x32_bf16 v[206:209], v[90:93], a[144:147], v[206:209]
    v_and_b32 v55, -2, v55
    s_cbranch_vccnz Lz22_r
Lz22_ok:
    v_mfma_f32_16x16x32_bf16 v[234:237], v[94:97], a[44:47], v[234:237]
    global_load_dwordx4 v[78:81], v30, s[52:53] offset:3072 sc1
    v_mfma_f32_16x16x32_bf16 v[234:237], v[98:101], a[60:63], v[234:237]
    v_mfma_f32_16x16x32_bf16 v[234:237], v[102:105], a[76:79], v[234:237]
    global_load_dwordx4 v[82:85], v31, s[52:53] offset:3072 sc1
    v_mfma_f32_16x16x32_bf16 v[234:237], v[106:109], a[92:95], v[234:237]
    ds_write_b128 v20, v[210:213] offset:0
    v_mfma_f32_16x16x32_bf16 v[230:233], v[94:97], a[40:43], v[230:233]
    global_load_dwordx4 v[86:89], v30, s[54:55] offset:3072 sc1
    v_mfma_f32_16x16x32_bf16 v[230:233], v[98:101], a[56:59], v[230:233]
    v_mfma_f32_16x16x32_bf16 v[230:233], v[102:105], a[72:75], v[230:233]
    global_load_dwordx4 v[90:93], v31, s[54:55] offset:3072 sc1
    v_mfma_f32_16x16x32_bf16 v[230:233], v[106:109], a[88:91], v[230:233]
    ds_write_b128 v21, v[214:217] offset:0
    v_mfma_f32_16x16x32_bf16 v[226:229], v[94:97], a[36:39], v[226:229]
    global_store_dwordx4 v6, v[48:51], s[8:9] offset:-4096 sc1
    v_mfma_f32_16x16x32_bf16 v[226:229], v[98:101], a[52:55], v[226:229]
    ds_write_b128 v22, v[218:221] offset:0
    v_mfma_f32_16x16x32_bf16 v[226:229], v[102:105], a[68:71], v[226:229]
    s_waitcnt vmcnt(21)
    v_and_b32 v28, v113, v117
    global_store_dwordx4 v7, v[52:55], s[8:9] offset:-4096 sc1
    v_mfma_f32_16x16x32_bf16 v[226:229], v[106:109], a[84:87], v[226:229]
    s_waitcnt vmcnt(20)
    v_bitop3_b32 v28, v121, v125, v28 bitop3:0x80
    v_mfma_f32_16x16x32_bf16 v[222:225], v[94:97], a[32:35], v[222:225]
    v_and_b32 v28, 1, v28
    global_load_lds_dwordx4 v4, s[92:93] offset:2048 sc1
    v_mfma_f32_16x16x32_bf16 v[222:225], v[98:101], a[48:51], v[222:225]
    s_waitcnt lgkmcnt(0)
    s_barrier
    v_cmp_ne_u32 vcc, 1, v28
    v_mfma_f32_16x16x32_bf16 v[222:225], v[102:105], a[64:67], v[222:225]
    global_load_lds_dwordx4 v4, s[92:93] offset:3072 sc1
    v_mfma_f32_16x16x32_bf16 v[222:225], v[106:109], a[80:83], v[222:225]
    s_cbranch_vccnz Lz23_r
Lz23_ok:
    v_mfma_f32_16x16x32_bf16 v[234:237], v[110:113], a[236:239], v[234:237]
    global_load_dwordx4 v[94:97], v30, s[64:65] offset:3072 sc1
    ds_read_b128 v[210:213], v23 offset:0
    v_mfma_f32_16x16x32_bf16 v[234:237], v[114:117], a[252:255], v[234:237]
    ds_read_b128 v[214:217], v23 offset:1024
    global_load_dwordx4 v[98:101], v31, s[64:65] offset:3072 sc1
    v_mfma_f32_16x16x32_bf16 v[234:237], v[118:121], a[204:207], v[234:237]
    ds_read_b128 v[218:221], v23 offset:2048
    v_mfma_f32_16x16x32_bf16 v[234:237], v[122:125], a[220:223], v[234:237]
    global_load_dwordx4 v[102:105], v30, s[66:67] offset:3072 sc1
    v_lshlrev_b32 v12, 16, v56
    v_mfma_f32_16x16x32_bf16 v[230:233], v[110:113], a[232:235], v[230:233]
    v_and_b32 v13, 0xffff0000, v56
    v_mfma_f32_16x16x32_bf16 v[230:233], v[114:117], a[248:251], v[230:233]
    global_load_dwordx4 v[106:109], v31, s[66:67] offset:3072 sc1
    v_mfma_f32_16x16x32_bf16 v[230:233], v[118:121], a[200:203], v[230:233]
    v_lshlrev_b32 v14, 16, v57
    v_mfma_f32_16x16x32_bf16 v[230:233], v[122:125], a[216:219], v[230:233]
    s_add_u32 m0, s95, 24576
    v_and_b32 v15, 0xffff0000, v57
    v_mfma_f32_16x16x32_bf16 v[226:229], v[110:113], a[228:231], v[226:229]
    s_waitcnt lgkmcnt(0)
    v_add_f32 v206, v206, v210
    s_add_u32 s92, s92, 4096
    s_addc_u32 s93, s93, 0
    v_mfma_f32_16x16x32_bf16 v[226:229], v[114:117], a[244:247], v[226:229]
    v_add_f32 v207, v207, v211
    v_mfma_f32_16x16x32_bf16 v[226:229], v[118:121], a[196:199], v[226:229]
    s_waitcnt vmcnt(22)
    v_and_b32 v28, v129, v133
    v_mfma_f32_16x16x32_bf16 v[226:229], v[122:125], a[212:215], v[226:229]
    s_waitcnt vmcnt(20)
    v_bitop3_b32 v28, v137, v141, v28 bitop3:0x80
    v_add_f32 v208, v208, v212
    v_mfma_f32_16x16x32_bf16 v[222:225], v[110:113], a[224:227], v[222:225]
    v_and_b32 v28, 1, v28
    v_add_f32 v209, v209, v213
    v_mfma_f32_16x16x32_bf16 v[222:225], v[114:117], a[240:243], v[222:225]
    global_load_lds_dwordx4 v4, s[92:93] offset:0 sc1
    v_cmp_ne_u32 vcc, 1, v28
    v_mfma_f32_16x16x32_bf16 v[222:225], v[118:121], a[192:195], v[222:225]
    v_add_f32 v206, v206, v214
    global_load_lds_dwordx4 v4, s[92:93] offset:1024 sc1
    v_mfma_f32_16x16x32_bf16 v[222:225], v[122:125], a[208:211], v[222:225]
    v_add_f32 v207, v207, v215
    s_cbranch_vccnz Lz24_r
Lz24_ok:
    v_mfma_f32_16x16x32_bf16 v[234:237], v[126:129], a[108:111], v[234:237]
    global_load_lds_dwordx4 v4, s[92:93] offset:2048 sc1
    v_add_f32 v208, v208, v216
    v_mfma_f32_16x16x32_bf16 v[234:237], v[130:133], a[124:127], v[234:237]
    v_add_f32 v209, v209, v217
    v_mfma_f32_16x16x32_bf16 v[234:237], v[134:137], a[140:143], v[234:237]
    v_add_f32 v206, v206, v218
    v_mfma_f32_16x16x32_bf16 v[234:237], v[138:141], a[156:159], v[234:237]
    v_mfma_f32_16x16x32_bf16 v[230:233], v[126:129], a[104:107], v[230:233]
    v_add_f32 v207, v207, v219
    v_mfma_f32_16x16x32_bf16 v[230:233], v[130:133], a[120:123], v[230:233]
    v_add_f32 v208, v208, v220
    v_mfma_f32_16x16x32_bf16 v[230:233], v[134:137], a[136:139], v[230:233]
    v_add_f32 v209, v209, v221
    v_mfma_f32_16x16x32_bf16 v[230:233], v[138:141], a[152:155], v[230:233]
    v_mfma_f32_16x16x32_bf16 v[226:229], v[126:129], a[100:103], v[226:229]
    global_load_lds_dwordx4 v4, s[92:93] offset:3072 sc1
    v_mul_f32 v206, v206, v12
    v_mfma_f32_16x16x32_bf16 v[226:229], v[130:133], a[116:119], v[226:229]
    v_mul_f32 v207, v207, v13
    v_mfma_f32_16x16x32_bf16 v[226:229], v[134:137], a[132:135], v[226:229]
    s_waitcnt vmcnt(20)
    v_and_b32 v28, v65, v69
    v_mul_f32 v208, v208, v14
    v_mfma_f32_16x16x32_bf16 v[226:229], v[138:141], a[148:151], v[226:229]
    s_waitcnt vmcnt(18)
    v_bitop3_b32 v28, v73, v77, v28 bitop3:0x80
    v_mfma_f32_16x16x32_bf16 v[222:225], v[126:129], a[96:99], v[222:225]
    v_and_b32 v28, 1, v28
    v_mul_f32 v209, v209, v15
    v_mfma_f32_16x16x32_bf16 v[222:225], v[130:133], a[112:115], v[222:225]
    v_cmp_ne_u32 vcc, 1, v28
    v_cvt_pk_bf16_f32 v56, v206, v207
    v_mfma_f32_16x16x32_bf16 v[222:225], v[134:137], a[128:131], v[222:225]
    v_cvt_pk_bf16_f32 v57, v208, v209
    v_mfma_f32_16x16x32_bf16 v[222:225], v[138:141], a[144:147], v[222:225]
    s_cbranch_vccnz Lz25_r
Lz25_ok:
    v_mfma_f32_16x16x32_bf16 v[250:253], v[62:65], a[44:47], v[250:253]
    s_add_u32 m0, s95, 28672
    v_mfma_f32_16x16x32_bf16 v[250:253], v[66:69], a[60:63], v[250:253]
    v_mfma_f32_16x16x32_bf16 v[250:253], v[70:73], a[76:79], v[250:253]
    v_mfma_f32_16x16x32_bf16 v[250:253], v[74:77], a[92:95], v[250:253]
    ds_write_b128 v20, v[226:229] offset:12288
    v_mfma_f32_16x16x32_bf16 v[246:249], v[62:65], a[40:43], v[246:249]
    s_add_u32 s92, s92, 4096
    s_addc_u32 s93, s93, 0
    v_mfma_f32_16x16x32_bf16 v[246:249], v[66:69], a[56:59], v[246:249]
    v_mfma_f32_16x16x32_bf16 v[246:249], v[70:73], a[72:75], v[246:249]
    ds_write_b128 v21, v[230:233] offset:12288
    v_mfma_f32_16x16x32_bf16 v[246:249], v[74:77], a[88:91], v[246:249]
    v_mfma_f32_16x16x32_bf16 v[242:245], v[62:65], a[36:39], v[242:245]
    v_mfma_f32_16x16x32_bf16 v[242:245], v[66:69], a[52:55], v[242:245]
    ds_write_b128 v22, v[234:237] offset:12288
    v_mfma_f32_16x16x32_bf16 v[242:245], v[70:73], a[68:71], v[242:245]
    s_waitcnt vmcnt(14)
    v_and_b32 v28, v81, v85
    global_load_lds_dwordx4 v4, s[92:93] offset:0 sc1
    v_mfma_f32_16x16x32_bf16 v[242:245], v[74:77], a[84:87], v[242:245]
    s_waitcnt vmcnt(13)
    v_bitop3_b32 v28, v89, v93, v28 bitop3:0x80
    v_mfma_f32_16x16x32_bf16 v[238:241], v[62:65], a[32:35], v[238:241]
    v_and_b32 v28, 1, v28
    s_waitcnt lgkmcnt(0)
    s_barrier
    v_mfma_f32_16x16x32_bf16 v[238:241], v[66:69], a[48:51], v[238:241]
    global_load_lds_dwordx4 v4, s[92:93] offset:1024 sc1
    v_cmp_ne_u32 vcc, 1, v28
    v_mfma_f32_16x16x32_bf16 v[238:241], v[70:73], a[64:67], v[238:241]
    v_mfma_f32_16x16x32_bf16 v[238:241], v[74:77], a[80:83], v[238:241]
    s_cbranch_vccnz Lz26_r
Lz26_ok:
    v_mfma_f32_16x16x32_bf16 v[250:253], v[78:81], a[236:239], v[250:253]
    global_load_lds_dwordx4 v4, s[92:93] offset:2048 sc1
    ds_read_b128 v[226:229], v23 offset:12288
    v_mfma_f32_16x16x32_bf16 v[250:253], v[82:85], a[252:255], v[250:253]
    ds_read_b128 v[230:233], v23 offset:13312
    v_mfma_f32_16x16x32_bf16 v[250:253], v[86:89], a[204:207], v[250:253]
    ds_read_b128 v[234:237], v23 offset:14336
    v_mfma_f32_16x16x32_bf16 v[250:253], v[90:93], a[220:223], v[250:253]
    v_lshlrev_b32 v12, 16, v58
    v_mfma_f32_16x16x32_bf16 v[246:249], v[78:81], a[232:235], v[246:249]
    v_and_b32 v13, 0xffff0000, v58
    v_mfma_f32_16x16x32_bf16 v[246:249], v[82:85], a[248:251], v[246:249]
    v_mfma_f32_16x16x32_bf16 v[246:249], v[86:89], a[200:203], v[246:249]
    v_lshlrev_b32 v14, 16, v59
    v_mfma_f32_16x16x32_bf16 v[246:249], v[90:93], a[216:219], v[246:249]
    v_and_b32 v15, 0xffff0000, v59
    v_mfma_f32_16x16x32_bf16 v[242:245], v[78:81], a[228:231], v[242:245]
    global_load_lds_dwordx4 v4, s[92:93] offset:3072 sc1
    s_waitcnt lgkmcnt(0)
    v_add_f32 v222, v222, v226
    v_mfma_f32_16x16x32_bf16 v[242:245], v[82:85], a[244:247], v[242:245]
    v_add_f32 v223, v223, v227
    v_mfma_f32_16x16x32_bf16 v[242:245], v[86:89], a[196:199], v[242:245]
    s_waitcnt vmcnt(10)
    v_and_b32 v28, v97, v101
    v_mfma_f32_16x16x32_bf16 v[242:245], v[90:93], a[212:215], v[242:245]
    s_waitcnt vmcnt(8)
    v_bitop3_b32 v28, v105, v109, v28 bitop3:0x80
    v_add_f32 v224, v224, v228
    v_mfma_f32_16x16x32_bf16 v[238:241], v[78:81], a[224:227], v[238:241]
    v_and_b32 v28, 1, v28
    v_add_f32 v225, v225, v229
    v_mfma_f32_16x16x32_bf16 v[238:241], v[82:85], a[240:243], v[238:241]
    v_cmp_ne_u32 vcc, 1, v28
    v_add_f32 v222, v222, v230
    v_mfma_f32_16x16x32_bf16 v[238:241], v[86:89], a[192:195], v[238:241]
    v_add_f32 v223, v223, v231
    v_mfma_f32_16x16x32_bf16 v[238:241], v[90:93], a[208:211], v[238:241]
    s_cbranch_vccnz Lz27_r
Lz27_ok:
    v_mfma_f32_16x16x32_bf16 v[250:253], v[94:97], a[108:111], v[250:253]
    s_add_u32 m0, s95, 32768
    v_add_f32 v224, v224, v232
    v_mfma_f32_16x16x32_bf16 v[250:253], v[98:101], a[124:127], v[250:253]
    v_add_f32 v225, v225, v233
    v_mfma_f32_16x16x32_bf16 v[250:253], v[102:105], a[140:143], v[250:253]
    v_add_f32 v222, v222, v234
    v_mfma_f32_16x16x32_bf16 v[250:253], v[106:109], a[156:159], v[250:253]
    s_add_u32 s92, s92, 4096
    s_addc_u32 s93, s93, 0
    v_add_f32 v223, v223, v235
    v_mfma_f32_16x16x32_bf16 v[246:249], v[94:97], a[104:107], v[246:249]
    v_add_f32 v224, v224, v236
    v_mfma_f32_16x16x32_bf16 v[246:249], v[98:101], a[120:123], v[246:249]
    v_mfma_f32_16x16x32_bf16 v[246:249], v[102:105], a[136:139], v[246:249]
    v_add_f32 v225, v225, v237
    v_mfma_f32_16x16x32_bf16 v[246:249], v[106:109], a[152:155], v[246:249]
    v_mul_f32 v222, v222, v12
    v_mfma_f32_16x16x32_bf16 v[242:245], v[94:97], a[100:103], v[242:245]
    v_mul_f32 v223, v223, v13
    v_mfma_f32_16x16x32_bf16 v[242:245], v[98:101], a[116:119], v[242:245]
    global_load_lds_dwordx4 v4, s[92:93] offset:0 sc1
    v_mul_f32 v224, v224, v14
    v_mfma_f32_16x16x32_bf16 v[242:245], v[102:105], a[132:135], v[242:245]
    v_mfma_f32_16x16x32_bf16 v[242:245], v[106:109], a[148:151], v[242:245]
    v_mul_f32 v225, v225, v15
    v_mfma_f32_16x16x32_bf16 v[238:241], v[94:97], a[96:99], v[238:241]
    v_cvt_pk_bf16_f32 v58, v222, v223
    global_load_lds_dwordx4 v4, s[92:93] offset:1024 sc1
    v_mfma_f32_16x16x32_bf16 v[238:241], v[98:101], a[112:115], v[238:241]
    v_cvt_pk_bf16_f32 v59, v224, v225
    v_mfma_f32_16x16x32_bf16 v[238:241], v[102:105], a[128:131], v[238:241]
    v_and_b32 v59, -2, v59
    v_mfma_f32_16x16x32_bf16 v[238:241], v[106:109], a[144:147], v[238:241]
    global_load_dwordx4 v[142:145], v6, s[38:39] offset:-4096 sc1
    ds_write_b128 v20, v[242:245] offset:0
    ds_write_b128 v21, v[246:249] offset:0
    global_load_dwordx4 v[146:149], v6, s[38:39] offset:-3072 sc1
    ds_write_b128 v22, v[250:253] offset:0
    s_waitcnt lgkmcnt(0)
    s_barrier
    global_load_dwordx4 v[150:153], v6, s[38:39] offset:-2048 sc1
    ds_read_b128 v[242:245], v23 offset:0
    ds_read_b128 v[246:249], v23 offset:1024
    global_load_dwordx4 v[154:157], v6, s[38:39] offset:-1024 sc1
    ds_read_b128 v[250:253], v23 offset:2048
    v_lshlrev_b32 v12, 16, v60
    v_and_b32 v13, 0xffff0000, v60
    global_load_dwordx4 v[158:161], v6, s[38:39] offset:0 sc1
    v_lshlrev_b32 v14, 16, v61
    v_and_b32 v15, 0xffff0000, v61
    global_load_dwordx4 v[162:165], v6, s[38:39] offset:1024 sc1
    s_waitcnt lgkmcnt(2)
    v_pk_add_f32 v[238:239], v[238:239], v[242:243] op_sel:[0,0] op_sel_hi:[1,1]
    v_pk_add_f32 v[240:241], v[240:241], v[244:245] op_sel:[0,0] op_sel_hi:[1,1]
    s_waitcnt lgkmcnt(1)
    v_pk_add_f32 v[238:239], v[238:239], v[246:247] op_sel:[0,0] op_sel_hi:[1,1]
    global_load_dwordx4 v[166:169], v6, s[38:39] offset:2048 sc1
    v_pk_add_f32 v[240:241], v[240:241], v[248:249] op_sel:[0,0] op_sel_hi:[1,1]
    s_waitcnt lgkmcnt(0)
    v_pk_add_f32 v[238:239], v[238:239], v[250:251] op_sel:[0,0] op_sel_hi:[1,1]
    global_load_dwordx4 v[170:173], v6, s[38:39] offset:3072 sc1
    v_pk_add_f32 v[240:241], v[240:241], v[252:253] op_sel:[0,0] op_sel_hi:[1,1]
    v_pk_mul_f32 v[238:239], v[238:239], v[12:13] op_sel:[0,0] op_sel_hi:[1,1]
    v_pk_mul_f32 v[240:241], v[240:241], v[14:15] op_sel:[0,0] op_sel_hi:[1,1]
    v_cvt_pk_bf16_f32 v60, v238, v239
    v_cvt_pk_bf16_f32 v61, v240, v241
    v_and_b32 v61, -2, v61
    global_store_dwordx4 v26, v[56:59], s[8:9] offset:-4096 sc1
    global_store_dwordx2 v27, v[60:61], s[10:11] offset:-4096 sc1
    v_add_u32 v30, 61440, v4
    v_add_u32 v31, 122880, v4
    global_load_dwordx4 v[174:177], v7, s[38:39] offset:-4096 sc1
    global_load_dwordx4 v[178:181], v7, s[38:39] offset:-3072 sc1
    global_load_dwordx4 v[182:185], v7, s[38:39] offset:-2048 sc1
    global_load_dwordx4 v[186:189], v7, s[38:39] offset:-1024 sc1
    global_load_dwordx4 v[190:193], v7, s[38:39] offset:0 sc1
    global_load_dwordx4 v[194:197], v7, s[38:39] offset:1024 sc1
    global_load_dwordx4 v[198:201], v7, s[38:39] offset:2048 sc1
    global_load_dwordx4 v[202:205], v7, s[38:39] offset:3072 sc1
    s_waitcnt vmcnt(18)
    s_barrier
    ds_read_b128 a[0:3], v4 offset:0
    ds_read_b128 a[4:7], v4 offset:20480
    ds_read_b128 a[8:11], v4 offset:35840
    ds_read_b128 a[12:15], v4 offset:56320
    ds_read_b128 a[16:19], v30 offset:10240
    ds_read_b128 a[20:23], v30 offset:30720
    ds_read_b128 a[24:27], v30 offset:46080
    ds_read_b128 a[28:31], v31 offset:5120
    ds_read_b128 a[32:35], v4 offset:1024
    ds_read_b128 a[36:39], v4 offset:21504
    s_waitcnt vmcnt(16)
    v_or_b32 v28, v145, v149
    s_waitcnt vmcnt(14)
    v_or3_b32 v28, v153, v157, v28
    s_waitcnt vmcnt(12)
    v_or3_b32 v28, v161, v165, v28
    s_waitcnt vmcnt(10)
    v_or3_b32 v28, v169, v173, v28
    v_and_b32 v28, 1, v28
    v_cmp_ne_u32 vcc, 0, v28
    s_nop 0
    s_cbranch_vccnz Lp0_r
Lp0_ok:
    s_waitcnt lgkmcnt(9)
    v_mfma_f32_16x16x32_bf16 v[62:65], a[0:3], v[142:145], 0
    ds_read_b128 a[40:43], v4 offset:36864
    s_waitcnt lgkmcnt(9)
    v_mfma_f32_16x16x32_bf16 v[62:65], a[4:7], v[146:149], v[62:65]
    ds_read_b128 a[0:3], v4 offset:57344
    s_waitcnt lgkmcnt(6)
    v_mfma_f32_16x16x32_bf16 v[62:65], a[8:11], v[150:153], v[62:65]
    ds_read_b128 a[4:7], v30 offset:11264
    v_mfma_f32_16x16x32_bf16 v[62:65], a[12:15], v[154:157], v[62:65]
    ds_read_b128 a[8:11], v30 offset:31744
    v_mfma_f32_16x16x32_bf16 v[62:65], a[16:19], v[158:161], v[62:65]
    ds_read_b128 a[12:15], v30 offset:47104
    v_mfma_f32_16x16x32_bf16 v[62:65], a[20:23], v[162:165], v[62:65]
    ds_read_b128 a[16:19], v31 offset:6144
    s_waitcnt lgkmcnt(5)
    v_mfma_f32_16x16x32_bf16 v[62:65], a[24:27], v[166:169], v[62:65]
    ds_read_b128 a[20:23], v4 offset:2048
    v_mfma_f32_16x16x32_bf16 v[62:65], a[28:31], v[170:173], v[62:65]
    ds_read_b128 a[24:27], v4 offset:22528
    v_mfma_f32_16x16x32_bf16 v[66:69], a[32:35], v[142:145], 0
    ds_read_b128 a[28:31], v4 offset:37888
    v_mfma_f32_16x16x32_bf16 v[66:69], a[36:39], v[146:149], v[66:69]
    ds_read_b128 a[32:35], v4 offset:58368
    v_mfma_f32_16x16x32_bf16 v[66:69], a[40:43], v[150:153], v[66:69]
    ds_read_b128 a[36:39], v30 offset:12288
    s_waitcnt lgkmcnt(5)
    v_mfma_f32_16x16x32_bf16 v[66:69], a[0:3], v[154:157], v[66:69]
    ds_read_b128 a[40:43], v30 offset:32768
    v_mfma_f32_16x16x32_bf16 v[66:69], a[4:7], v[158:161], v[66:69]
    ds_read_b128 a[0:3], v30 offset:48128
    v_mfma_f32_16x16x32_bf16 v[66:69], a[8:11], v[162:165], v[66:69]
    ds_read_b128 a[4:7], v31 offset:7168
    v_mfma_f32_16x16x32_bf16 v[66:69], a[12:15], v[166:169], v[66:69]
    ds_read_b128 a[8:11], v4 offset:3072
    v_mfma_f32_16x16x32_bf16 v[66:69], a[16:19], v[170:173], v[66:69]
    ds_read_b128 a[12:15], v4 offset:23552
    s_waitcnt lgkmcnt(5)
    v_mfma_f32_16x16x32_bf16 v[70:73], a[20:23], v[142:145], 0
    ds_read_b128 a[16:19], v4 offset:38912
    v_mfma_f32_16x16x32_bf16 v[70:73], a[24:27], v[146:149], v[70:73]
    ds_read_b128 a[20:23], v4 offset:59392
    v_mfma_f32_16x16x32_bf16 v[70:73], a[28:31], v[150:153], v[70:73]
    ds_read_b128 a[24:27], v30 offset:13312
    v_mfma_f32_16x16x32_bf16 v[70:73], a[32:35], v[154:157], v[70:73]
    ds_read_b128 a[28:31], v30 offset:33792
    v_mfma_f32_16x16x32_bf16 v[70:73], a[36:39], v[158:161], v[70:73]
    ds_read_b128 a[32:35], v30 offset:49152
    s_waitcnt lgkmcnt(5)
    v_mfma_f32_16x16x32_bf16 v[70:73], a[40:43], v[162:165], v[70:73]
    ds_read_b128 a[36:39], v31 offset:8192
    v_mfma_f32_16x16x32_bf16 v[70:73], a[0:3], v[166:169], v[70:73]
    ds_read_b128 a[40:43], v4 offset:4096
    v_mfma_f32_16x16x32_bf16 v[70:73], a[4:7], v[170:173], v[70:73]
    ds_read_b128 a[0:3], v4 offset:24576
    v_mfma_f32_16x16x32_bf16 v[74:77], a[8:11], v[142:145], 0
    ds_read_b128 a[4:7], v4 offset:39936
    v_mfma_f32_16x16x32_bf16 v[74:77], a[12:15], v[146:149], v[74:77]
    ds_read_b128 a[8:11], v4 offset:60416
    s_waitcnt lgkmcnt(5)
    v_mfma_f32_16x16x32_bf16 v[74:77], a[16:19], v[150:153], v[74:77]
    ds_read_b128 a[12:15], v30 offset:14336
    v_mfma_f32_16x16x32_bf16 v[74:77], a[20:23], v[154:157], v[74:77]
    ds_read_b128 a[16:19], v30 offset:34816
    v_mfma_f32_16x16x32_bf16 v[74:77], a[24:27], v[158:161], v[74:77]
    ds_read_b128 a[20:23], v30 offset:50176
    v_mfma_f32_16x16x32_bf16 v[74:77], a[28:31], v[162:165], v[74:77]
    ds_read_b128 a[24:27], v31 offset:9216
    v_mfma_f32_16x16x32_bf16 v[74:77], a[32:35], v[166:169], v[74:77]
    ds_read_b128 a[28:31], v4 offset:5120
    s_waitcnt lgkmcnt(5)
    v_mfma_f32_16x16x32_bf16 v[74:77], a[36:39], v[170:173], v[74:77]
    ds_read_b128 a[32:35], v4 offset:25600
    v_mfma_f32_16x16x32_bf16 v[78:81], a[40:43], v[142:145], 0
    ds_read_b128 a[36:39], v4 offset:40960
    v_mfma_f32_16x16x32_bf16 v[78:81], a[0:3], v[146:149], v[78:81]
    ds_read_b128 a[40:43], v30 offset:0
    v_mfma_f32_16x16x32_bf16 v[78:81], a[4:7], v[150:153], v[78:81]
    ds_read_b128 a[0:3], v30 offset:15360
    v_mfma_f32_16x16x32_bf16 v[78:81], a[8:11], v[154:157], v[78:81]
    ds_read_b128 a[4:7], v30 offset:35840
    s_waitcnt lgkmcnt(5)
    v_mfma_f32_16x16x32_bf16 v[78:81], a[12:15], v[158:161], v[78:81]
    ds_read_b128 a[8:11], v30 offset:51200
    v_mfma_f32_16x16x32_bf16 v[78:81], a[16:19], v[162:165], v[78:81]
    ds_read_b128 a[12:15], v31 offset:10240
    v_mfma_f32_16x16x32_bf16 v[78:81], a[20:23], v[166:169], v[78:81]
    ds_read_b128 a[16:19], v4 offset:6144
    v_mfma_f32_16x16x32_bf16 v[78:81], a[24:27], v[170:173], v[78:81]
    ds_read_b128 a[20:23], v4 offset:26624
    s_waitcnt vmcnt(6)
    v_or_b32 v28, v177, v181
    s_waitcnt vmcnt(4)
    v_or3_b32 v28, v185, v189, v28
    s_waitcnt vmcnt(2)
    v_or3_b32 v28, v193, v197, v28
    s_waitcnt vmcnt(0)
    v_or3_b32 v28, v201, v205, v28
    v_and_b32 v28, 1, v28
    v_cmp_ne_u32 vcc, 0, v28
    s_nop 0
    s_cbranch_vccnz Lp1_r
Lp1_ok:
    v_mfma_f32_16x16x32_bf16 v[62:65], a[28:31], v[174:177], v[62:65]
    ds_read_b128 a[24:27], v4 offset:41984
    s_waitcnt lgkmcnt(3)
    v_mfma_f32_16x16x32_bf16 v[62:65], a[32:35], v[178:181], v[62:65]
    ds_read_b128 a[28:31], v30 offset:1024
    v_mfma_f32_16x16x32_bf16 v[62:65], a[36:39], v[182:185], v[62:65]
    ds_read_b128 a[32:35], v30 offset:16384
    v_mfma_f32_16x16x32_bf16 v[62:65], a[40:43], v[186:189], v[62:65]
    ds_read_b128 a[36:39], v30 offset:36864
    v_mfma_f32_16x16x32_bf16 v[62:65], a[0:3], v[190:193], v[62:65]
    ds_read_b128 a[40:43], v30 offset:52224
    v_mfma_f32_16x16x32_bf16 v[62:65], a[4:7], v[194:197], v[62:65]
    ds_read_b128 a[0:3], v31 offset:11264
    v_mfma_f32_16x16x32_bf16 v[62:65], a[8:11], v[198:201], v[62:65]
    ds_read_b128 a[4:7], v4 offset:7168
    v_mfma_f32_16x16x32_bf16 v[62:65], a[12:15], v[202:205], v[62:65]
    ds_read_b128 a[8:11], v4 offset:27648
    s_waitcnt lgkmcnt(5)
    v_mfma_f32_16x16x32_bf16 v[66:69], a[16:19], v[174:177], v[66:69]
    ds_read_b128 a[12:15], v4 offset:43008
    v_mfma_f32_16x16x32_bf16 v[66:69], a[20:23], v[178:181], v[66:69]
    ds_read_b128 a[16:19], v30 offset:2048
    v_mfma_f32_16x16x32_bf16 v[66:69], a[24:27], v[182:185], v[66:69]
    ds_read_b128 a[20:23], v30 offset:17408
    global_load_dwordx4 v[206:209], v26, s[38:39] offset:-4096 sc1
    v_mfma_f32_16x16x32_bf16 v[66:69], a[28:31], v[186:189], v[66:69]
    ds_read_b128 a[24:27], v30 offset:37888
    v_mfma_f32_16x16x32_bf16 v[66:69], a[32:35], v[190:193], v[66:69]
    ds_read_b128 a[28:31], v30 offset:53248
    global_load_dwordx4 v[210:213], v26, s[38:39] offset:-3072 sc1
    s_waitcnt lgkmcnt(5)
    v_mfma_f32_16x16x32_bf16 v[66:69], a[36:39], v[194:197], v[66:69]
    ds_read_b128 a[32:35], v31 offset:12288
    v_mfma_f32_16x16x32_bf16 v[66:69], a[40:43], v[198:201], v[66:69]
    ds_read_b128 a[36:39], v4 offset:8192
    v_mfma_f32_16x16x32_bf16 v[66:69], a[0:3], v[202:205], v[66:69]
    ds_read_b128 a[40:43], v4 offset:28672
    global_load_dwordx4 v[214:217], v26, s[38:39] offset:-2048 sc1
    v_mfma_f32_16x16x32_bf16 v[70:73], a[4:7], v[174:177], v[70:73]
    ds_read_b128 a[0:3], v4 offset:44032
    v_mfma_f32_16x16x32_bf16 v[70:73], a[8:11], v[178:181], v[70:73]
    ds_read_b128 a[4:7], v30 offset:3072
    s_waitcnt lgkmcnt(5)
    v_mfma_f32_16x16x32_bf16 v[70:73], a[12:15], v[182:185], v[70:73]
    ds_read_b128 a[8:11], v30 offset:18432
    global_load_dwordx4 v[218:221], v26, s[38:39] offset:-1024 sc1
    v_mfma_f32_16x16x32_bf16 v[70:73], a[16:19], v[186:189], v[70:73]
    ds_read_b128 a[12:15], v30 offset:38912
    v_mfma_f32_16x16x32_bf16 v[70:73], a[20:23], v[190:193], v[70:73]
    ds_read_b128 a[16:19], v30 offset:54272
    global_load_dwordx4 v[222:225], v26, s[38:39] offset:0 sc1
    v_mfma_f32_16x16x32_bf16 v[70:73], a[24:27], v[194:197], v[70:73]
    ds_read_b128 a[20:23], v31 offset:13312
    v_mfma_f32_16x16x32_bf16 v[70:73], a[28:31], v[198:201], v[70:73]
    ds_read_b128 a[24:27], v4 offset:9216
    s_waitcnt lgkmcnt(5)
    v_mfma_f32_16x16x32_bf16 v[70:73], a[32:35], v[202:205], v[70:73]
    ds_read_b128 a[28:31], v4 offset:29696
    global_load_dwordx4 v[226:229], v26, s[38:39] offset:1024 sc1
    v_mfma_f32_16x16x32_bf16 v[74:77], a[36:39], v[174:177], v[74:77]
    ds_read_b128 a[32:35], v4 offset:45056
    v_mfma_f32_16x16x32_bf16 v[74:77], a[40:43], v[178:181], v[74:77]
    ds_read_b128 a[36:39], v30 offset:4096
    v_mfma_f32_16x16x32_bf16 v[74:77], a[0:3], v[182:185], v[74:77]
    ds_read_b128 a[40:43], v30 offset:19456
    global_load_dwordx4 v[230:233], v26, s[38:39] offset:2048 sc1
    v_mfma_f32_16x16x32_bf16 v[74:77], a[4:7], v[186:189], v[74:77]
    ds_read_b128 a[0:3], v30 offset:39936
    s_waitcnt lgkmcnt(5)
    v_mfma_f32_16x16x32_bf16 v[74:77], a[8:11], v[190:193], v[74:77]
    ds_read_b128 a[4:7], v30 offset:55296
    v_mfma_f32_16x16x32_bf16 v[74:77], a[12:15], v[194:197], v[74:77]
    ds_read_b128 a[8:11], v31 offset:14336
    global_load_dwordx4 v[238:241], v27, s[38:39] offset:-4096 sc1
    v_mfma_f32_16x16x32_bf16 v[74:77], a[16:19], v[198:201], v[74:77]
    ds_read_b128 a[12:15], v4 offset:10240
    v_mfma_f32_16x16x32_bf16 v[74:77], a[20:23], v[202:205], v[74:77]
    ds_read_b128 a[16:19], v4 offset:30720
    global_load_dwordx4 v[242:245], v27, s[38:39] offset:-3072 sc1
    v_mfma_f32_16x16x32_bf16 v[78:81], a[24:27], v[174:177], v[78:81]
    ds_read_b128 a[20:23], v4 offset:46080
    s_waitcnt lgkmcnt(5)
    v_mfma_f32_16x16x32_bf16 v[78:81], a[28:31], v[178:181], v[78:81]
    ds_read_b128 a[24:27], v30 offset:5120
    v_mfma_f32_16x16x32_bf16 v[78:81], a[32:35], v[182:185], v[78:81]
    ds_read_b128 a[28:31], v30 offset:20480
    global_load_dwordx4 v[246:249], v27, s[38:39] offset:-2048 sc1
    v_mfma_f32_16x16x32_bf16 v[78:81], a[36:39], v[186:189], v[78:81]
    ds_read_b128 a[32:35], v30 offset:40960
    v_mfma_f32_16x16x32_bf16 v[78:81], a[40:43], v[190:193], v[78:81]
    ds_read_b128 a[36:39], v30 offset:56320
    v_mfma_f32_16x16x32_bf16 v[78:81], a[0:3], v[194:197], v[78:81]
    ds_read_b128 a[40:43], v4 offset:11264
    global_load_dwordx4 v[250:253], v27, s[38:39] offset:-1024 sc1
    s_waitcnt lgkmcnt(5)
    v_mfma_f32_16x16x32_bf16 v[78:81], a[4:7], v[198:201], v[78:81]
    ds_read_b128 a[0:3], v4 offset:31744
    v_mfma_f32_16x16x32_bf16 v[78:81], a[8:11], v[202:205], v[78:81]
    ds_read_b128 a[4:7], v4 offset:47104
    v_lshlrev_b32 v29, 5, v3
    v_add_u32 v29, 162816, v29
    ds_read_b128 v[106:109], v29 offset:0
    ds_read_b128 v[110:113], v29 offset:16
    ds_read_b128 v[114:117], v29 offset:128
    ds_read_b128 v[118:121], v29 offset:144
    v_lshlrev_b32 v29, 4, v3
    v_add_u32 v29, 162816, v29
    ds_read_b128 v[122:125], v29 offset:256
    v_lshlrev_b32 v126, 16, v36
    v_and_b32 v127, 0xffff0000, v36
    v_lshlrev_b32 v128, 16, v37
    v_and_b32 v129, 0xffff0000, v37
    v_lshlrev_b32 v130, 16, v38
    v_and_b32 v131, 0xffff0000, v38
    v_lshlrev_b32 v132, 16, v39
    v_and_b32 v133, 0xffff0000, v39
    v_lshlrev_b32 v134, 16, v40
    v_and_b32 v135, 0xffff0000, v40
    v_lshlrev_b32 v136, 16, v41
    v_and_b32 v137, 0xffff0000, v41
    v_lshlrev_b32 v138, 16, v42
    v_and_b32 v139, 0xffff0000, v42
    v_lshlrev_b32 v140, 16, v43
    v_and_b32 v141, 0xffff0000, v43
    v_lshlrev_b32 v12, 16, v44
    v_and_b32 v13, 0xffff0000, v44
    v_lshlrev_b32 v14, 16, v45
    v_and_b32 v15, 0xffff0000, v45
    v_add_u32 v46, s90, v5
    v_mul_u32_u24 v46, 1280, v46
    s_mul_i32 s4, s41, 160
    v_add_u32 v46, s4, v46
    v_lshl_add_u32 v47, v3, 4, v46
    v_lshl_add_u32 v46, v3, 3, v46
    s_waitcnt vmcnt(8)
    v_or3_b32 v28, v209, v213, v217
    s_waitcnt vmcnt(6)
    v_or3_b32 v28, v221, v225, v28
    s_waitcnt vmcnt(4)
    v_or3_b32 v28, v229, v233, v28
    v_and_b32 v28, 1, v28
    v_cmp_ne_u32 vcc, 0, v28
    s_nop 0
    s_cbranch_vccnz Lp2_r
Lp2_ok:
    v_mfma_f32_16x16x32_bf16 v[62:65], a[12:15], v[206:209], v[62:65]
    ds_read_b128 a[8:11], v30 offset:6144
    v_mfma_f32_16x16x32_bf16 v[62:65], a[16:19], v[210:213], v[62:65]
    ds_read_b128 a[12:15], v30 offset:21504
    v_mfma_f32_16x16x32_bf16 v[62:65], a[20:23], v[214:217], v[62:65]
    ds_read_b128 a[16:19], v30 offset:41984
    s_waitcnt lgkmcnt(3)
    v_mfma_f32_16x16x32_bf16 v[62:65], a[24:27], v[218:221], v[62:65]
    ds_read_b128 a[20:23], v30 offset:57344
    v_mfma_f32_16x16x32_bf16 v[62:65], a[28:31], v[222:225], v[62:65]
    ds_read_b128 a[24:27], v4 offset:12288
    v_mfma_f32_16x16x32_bf16 v[62:65], a[32:35], v[226:229], v[62:65]
    ds_read_b128 a[28:31], v4 offset:32768
    v_mfma_f32_16x16x32_bf16 v[62:65], a[36:39], v[230:233], v[62:65]
    ds_read_b128 a[32:35], v4 offset:48128
    v_mfma_f32_16x16x32_bf16 v[66:69], a[40:43], v[206:209], v[66:69]
    ds_read_b128 a[36:39], v30 offset:7168
    v_mfma_f32_16x16x32_bf16 v[66:69], a[0:3], v[210:213], v[66:69]
    ds_read_b128 a[40:43], v30 offset:22528
    v_mfma_f32_16x16x32_bf16 v[66:69], a[4:7], v[214:217], v[66:69]
    ds_read_b128 a[0:3], v30 offset:43008
    s_waitcnt lgkmcnt(5)
    v_mfma_f32_16x16x32_bf16 v[66:69], a[8:11], v[218:221], v[66:69]
    ds_read_b128 a[4:7], v30 offset:58368
    v_mfma_f32_16x16x32_bf16 v[66:69], a[12:15], v[222:225], v[66:69]
    ds_read_b128 a[8:11], v4 offset:13312
    v_mfma_f32_16x16x32_bf16 v[66:69], a[16:19], v[226:229], v[66:69]
    ds_read_b128 a[12:15], v4 offset:33792
    v_mfma_f32_16x16x32_bf16 v[66:69], a[20:23], v[230:233], v[66:69]
    ds_read_b128 a[16:19], v4 offset:49152
    v_mfma_f32_16x16x32_bf16 v[70:73], a[24:27], v[206:209], v[70:73]
    ds_read_b128 a[20:23], v30 offset:8192
    s_waitcnt lgkmcnt(5)
    v_mfma_f32_16x16x32_bf16 v[70:73], a[28:31], v[210:213], v[70:73]
    ds_read_b128 a[24:27], v30 offset:23552
    v_mfma_f32_16x16x32_bf16 v[70:73], a[32:35], v[214:217], v[70:73]
    ds_read_b128 a[28:31], v30 offset:44032
    v_mfma_f32_16x16x32_bf16 v[70:73], a[36:39], v[218:221], v[70:73]
    ds_read_b128 a[32:35], v30 offset:59392
    v_mfma_f32_16x16x32_bf16 v[70:73], a[40:43], v[222:225], v[70:73]
    ds_read_b128 a[36:39], v4 offset:14336
    v_mfma_f32_16x16x32_bf16 v[70:73], a[0:3], v[226:229], v[70:73]
    ds_read_b128 a[40:43], v4 offset:34816
    s_waitcnt lgkmcnt(5)
    v_mfma_f32_16x16x32_bf16 v[70:73], a[4:7], v[230:233], v[70:73]
    ds_read_b128 a[0:3], v4 offset:50176
    v_mfma_f32_16x16x32_bf16 v[74:77], a[8:11], v[206:209], v[74:77]
    ds_read_b128 a[4:7], v30 offset:9216
    v_mfma_f32_16x16x32_bf16 v[74:77], a[12:15], v[210:213], v[74:77]
    ds_read_b128 a[8:11], v30 offset:24576
    v_mfma_f32_16x16x32_bf16 v[74:77], a[16:19], v[214:217], v[74:77]
    ds_read_b128 a[12:15], v30 offset:45056
    v_mfma_f32_16x16x32_bf16 v[74:77], a[20:23], v[218:221], v[74:77]
    ds_read_b128 a[16:19], v30 offset:60416
    s_waitcnt lgkmcnt(5)
    v_mfma_f32_16x16x32_bf16 v[74:77], a[24:27], v[222:225], v[74:77]
    ds_read_b128 a[20:23], v4 offset:15360
    v_mfma_f32_16x16x32_bf16 v[74:77], a[28:31], v[226:229], v[74:77]
    ds_read_b128 a[24:27], v4 offset:51200
    v_mfma_f32_16x16x32_bf16 v[74:77], a[32:35], v[230:233], v[74:77]
    ds_read_b128 a[28:31], v30 offset:25600
    v_mfma_f32_16x16x32_bf16 v[78:81], a[36:39], v[206:209], v[78:81]
    ds_read_b128 a[32:35], v31 offset:0
    v_mfma_f32_16x16x32_bf16 v[78:81], a[40:43], v[210:213], v[78:81]
    ds_read_b128 a[36:39], v4 offset:16384
    s_waitcnt lgkmcnt(5)
    v_mfma_f32_16x16x32_bf16 v[78:81], a[0:3], v[214:217], v[78:81]
    ds_read_b128 a[40:43], v4 offset:52224
    v_mfma_f32_16x16x32_bf16 v[78:81], a[4:7], v[218:221], v[78:81]
    ds_read_b128 a[0:3], v30 offset:26624
    v_mfma_f32_16x16x32_bf16 v[78:81], a[8:11], v[222:225], v[78:81]
    ds_read_b128 a[4:7], v31 offset:1024
    v_mfma_f32_16x16x32_bf16 v[78:81], a[12:15], v[226:229], v[78:81]
    ds_read_b128 a[8:11], v4 offset:17408
    v_mfma_f32_16x16x32_bf16 v[78:81], a[16:19], v[230:233], v[78:81]
    ds_read_b128 a[12:15], v4 offset:53248
    s_waitcnt vmcnt(3)
    v_or_b32 v28, v239, v241
    s_waitcnt vmcnt(2)
    v_or3_b32 v28, v243, v245, v28
    s_waitcnt vmcnt(1)
    v_or3_b32 v28, v247, v249, v28
    s_waitcnt vmcnt(0)
    v_or3_b32 v28, v251, v253, v28
    v_and_b32 v28, 1, v28
    v_cmp_ne_u32 vcc, 0, v28
    s_nop 0
    s_cbranch_vccnz Lp3_r
Lp3_ok:
    s_waitcnt lgkmcnt(3)
    v_mfma_f32_16x16x32_bf16 v[62:65], a[20:23], v[238:241], v[62:65]
    ds_read_b128 a[16:19], v30 offset:27648
    v_mfma_f32_16x16x32_bf16 v[62:65], a[24:27], v[242:245], v[62:65]
    ds_read_b128 a[20:23], v31 offset:2048
    v_mfma_f32_16x16x32_bf16 v[62:65], a[28:31], v[246:249], v[62:65]
    ds_read_b128 a[24:27], v4 offset:18432
    v_mfma_f32_16x16x32_bf16 v[62:65], a[32:35], v[250:253], v[62:65]
    ds_read_b128 a[28:31], v4 offset:54272
    v_mfma_f32_16x16x32_bf16 v[66:69], a[36:39], v[238:241], v[66:69]
    ds_read_b128 a[32:35], v30 offset:28672
    v_mfma_f32_16x16x32_bf16 v[66:69], a[40:43], v[242:245], v[66:69]
    ds_read_b128 a[36:39], v31 offset:3072
    v_mfma_f32_16x16x32_bf16 v[66:69], a[0:3], v[246:249], v[66:69]
    ds_read_b128 a[40:43], v4 offset:19456
    s_waitcnt lgkmcnt(5)
    v_mfma_f32_16x16x32_bf16 v[66:69], a[4:7], v[250:253], v[66:69]
    ds_read_b128 a[0:3], v4 offset:55296
    v_mfma_f32_16x16x32_bf16 v[70:73], a[8:11], v[238:241], v[70:73]
    ds_read_b128 a[4:7], v30 offset:29696
    v_mfma_f32_16x16x32_bf16 v[70:73], a[12:15], v[242:245], v[70:73]
    ds_read_b128 a[8:11], v31 offset:4096
    v_mfma_f32_16x16x32_bf16 v[70:73], a[16:19], v[246:249], v[70:73]
    v_mfma_f32_16x16x32_bf16 v[70:73], a[20:23], v[250:253], v[70:73]
    s_waitcnt lgkmcnt(3)
    v_mfma_f32_16x16x32_bf16 v[74:77], a[24:27], v[238:241], v[74:77]
    v_mfma_f32_16x16x32_bf16 v[74:77], a[28:31], v[242:245], v[74:77]
    v_mfma_f32_16x16x32_bf16 v[74:77], a[32:35], v[246:249], v[74:77]
    v_mfma_f32_16x16x32_bf16 v[74:77], a[36:39], v[250:253], v[74:77]
    v_mfma_f32_16x16x32_bf16 v[78:81], a[40:43], v[238:241], v[78:81]
    s_waitcnt lgkmcnt(0)
    v_mfma_f32_16x16x32_bf16 v[78:81], a[0:3], v[242:245], v[78:81]
    v_mfma_f32_16x16x32_bf16 v[78:81], a[4:7], v[246:249], v[78:81]
    v_mfma_f32_16x16x32_bf16 v[78:81], a[8:11], v[250:253], v[78:81]
    v_fmac_f32 v126, v62, v106
    v_fmac_f32 v127, v66, v107
    v_fmac_f32 v128, v63, v108
    v_fmac_f32 v129, v67, v109
    v_fmac_f32 v130, v64, v110
    v_fmac_f32 v131, v68, v111
    v_fmac_f32 v132, v65, v112
    v_fmac_f32 v133, v69, v113
    v_cvt_pk_bf16_f32 v142, v126, v127
    v_cvt_pk_bf16_f32 v143, v128, v129
    v_cvt_pk_bf16_f32 v144, v130, v131
    v_cvt_pk_bf16_f32 v145, v132, v133
    global_store_dwordx4 v47, v[142:145], s[34:35] offset:0
    v_fmac_f32 v134, v70, v114
    v_fmac_f32 v135, v74, v115
    v_fmac_f32 v136, v71, v116
    v_fmac_f32 v137, v75, v117
    v_fmac_f32 v138, v72, v118
    v_fmac_f32 v139, v76, v119
    v_fmac_f32 v140, v73, v120
    v_fmac_f32 v141, v77, v121
    v_cvt_pk_bf16_f32 v146, v134, v135
    v_cvt_pk_bf16_f32 v147, v136, v137
    v_cvt_pk_bf16_f32 v148, v138, v139
    v_cvt_pk_bf16_f32 v149, v140, v141
    global_store_dwordx4 v47, v[146:149], s[34:35] offset:64
    v_fmac_f32 v12, v78, v122
    v_fmac_f32 v13, v79, v123
    v_fmac_f32 v14, v80, v124
    v_fmac_f32 v15, v81, v125
    v_cvt_pk_bf16_f32 v150, v12, v13
    v_cvt_pk_bf16_f32 v151, v14, v15
    global_store_dwordx2 v46, v[150:151], s[34:35] offset:128
Lflush:
Lend:
    s_endpgm
Lspare:
    s_sub_u32 s42, s2, 160
    s_cmp_lt_u32 s42, 54
    s_cbranch_scc0 Lsp_b
    s_cmp_ge_u32 s42, 8
    s_cbranch_scc1 Lsp_a2
    s_mov_b32 s48, s42
    v_mov_b32 v8, -1
    v_mov_b32 v9, -1
    v_mov_b32 v10, -1
    v_mov_b32 v11, -1
    s_mul_i32 s4, s48, 9216
    s_mul_i32 s5, s3, 2304
    s_add_u32 s4, s4, s5
    s_add_u32 s4, s4, 32768
    v_add_u32 v6, s4, v4
    global_store_dwordx4 v6, v[8:11], s[38:39] offset:0 sc1
    global_store_dwordx4 v6, v[8:11], s[38:39] offset:1024 sc1
    global_store_dwordx4 v6, v[8:11], s[38:39] offset:1280 sc1
    s_lshl_b32 s4, s48, 2
    v_mov_b32 v6, s4
    s_waitcnt vmcnt(0)
    s_barrier
    s_cmp_lg_u32 s3, 0
    s_cbranch_scc1 Linit_skip
    global_store_dword v6, v8, s[36:37] sc1
Linit_skip:
    s_branch Lsp_a2
Lsp_b:
    s_sub_u32 s48, s42, 54
    s_add_u32 s49, s48, 42
    s_add_u32 s50, s48, 84
    s_cmp_ge_u32 s50, 120
    s_cselect_b32 s50, s49, s50
    s_cmp_eq_u32 s3, 1
    s_cselect_b32 s51, s49, s48
    s_cmp_eq_u32 s3, 2
    s_cselect_b32 s51, s50, s51
    s_lshr_b32 s4, s51, 1
    s_and_b32 s5, s51, 1
    s_cmp_lt_u32 s4, 50
    s_cselect_b32 s6, -20, 0
    s_cmp_lt_u32 s4, 20
    s_cselect_b32 s6, 30, s6
    s_add_u32 s4, s4, s6
    s_mul_i32 s6, s5, 15360
    s_lshl_b32 s7, s4, 8
    s_add_u32 s51, s6, s7
    v_lshl_add_u32 v164, v1, 2, s51
    v_mov_b32 v165, -1
    global_store_dword v164, v165, s[38:39] offset:0 sc1
    s_lshr_b32 s4, s48, 1
    s_and_b32 s5, s48, 1
    s_cmp_lt_u32 s4, 50
    s_cselect_b32 s6, -20, 0
    s_cmp_lt_u32 s4, 20
    s_cselect_b32 s6, 30, s6
    s_add_u32 s4, s4, s6
    s_mul_i32 s6, s5, 15360
    s_lshl_b32 s7, s4, 8
    s_add_u32 s44, s6, s7
    s_lshl_b32 s5, s5, 2
    s_add_u32 s5, s5, s3
    s_mul_i32 s5, s5, 80
    s_lshl_b32 s4, s4, 7
    s_mul_i32 s6, s5, 7680
    s_add_u32 s4, s4, s6
    v_min_u32 v28, 39, v1
    s_lshl_b32 s5, s5, 1
    v_lshl_add_u32 v28, v28, 2, s5
    global_load_dword v80, v28, s[30:31]
    v_lshrrev_b32 v29, 3, v1
    v_mul_u32_u24 v28, 15232, v29
    v_add3_u32 v28, v28, v4, s4
    global_load_dwordx4 v[40:43], v28, s[32:33] nt
    v_add_u32 v28, 7680, v28
    global_load_dwordx4 v[44:47], v28, s[32:33] nt
    v_add_u32 v28, 115200, v28
    global_load_dwordx4 v[48:51], v28, s[32:33] nt
    v_add_u32 v28, 7680, v28
    global_load_dwordx4 v[52:55], v28, s[32:33] nt
    v_add_u32 v28, 115200, v28
    global_load_dwordx4 v[56:59], v28, s[32:33] nt
    v_add_u32 v28, 7680, v28
    global_load_dwordx4 v[60:63], v28, s[32:33] nt
    v_add_u32 v28, 115200, v28
    global_load_dwordx4 v[64:67], v28, s[32:33] nt
    v_add_u32 v28, 7680, v28
    global_load_dwordx4 v[68:71], v28, s[32:33] nt
    v_add_u32 v28, 115200, v28
    global_load_dwordx4 v[72:75], v28, s[32:33] nt
    v_add_u32 v28, 7680, v28
    global_load_dwordx4 v[76:79], v28, s[32:33] nt
    s_lshl_b32 s4, s48, 2
    s_add_u32 s4, s4, 60
    v_mov_b32 v164, s4
    s_waitcnt vmcnt(10)
    s_barrier
    s_cmp_lg_u32 s3, 0
    s_cbranch_scc1 Lsb_skip
    global_store_dword v164, v165, s[36:37] sc1
    s_branch Lsb_skip2
Lsb_skip:
    global_load_dword v165, v164, s[30:31]
Lsb_skip2:
    s_lshr_b32 s4, s49, 1
    s_and_b32 s5, s49, 1
    s_cmp_lt_u32 s4, 50
    s_cselect_b32 s6, -20, 0
    s_cmp_lt_u32 s4, 20
    s_cselect_b32 s6, 30, s6
    s_add_u32 s4, s4, s6
    s_mul_i32 s6, s5, 15360
    s_lshl_b32 s7, s4, 8
    s_add_u32 s45, s6, s7
    s_lshl_b32 s5, s5, 2
    s_add_u32 s5, s5, s3
    s_mul_i32 s5, s5, 80
    s_lshl_b32 s4, s4, 7
    s_mul_i32 s6, s5, 7680
    s_add_u32 s4, s4, s6
    v_min_u32 v96, 39, v1
    s_lshl_b32 s5, s5, 1
    v_lshl_add_u32 v96, v96, 2, s5
    global_load_dword v148, v96, s[30:31]
    v_lshrrev_b32 v97, 3, v1
    v_mul_u32_u24 v96, 15232, v97
    v_add3_u32 v96, v96, v4, s4
    global_load_dwordx4 v[108:111], v96, s[32:33] nt
    v_add_u32 v96, 7680, v96
    global_load_dwordx4 v[112:115], v96, s[32:33] nt
    v_add_u32 v96, 115200, v96
    global_load_dwordx4 v[116:119], v96, s[32:33] nt
    v_add_u32 v96, 7680, v96
    global_load_dwordx4 v[120:123], v96, s[32:33] nt
    v_add_u32 v96, 115200, v96
    global_load_dwordx4 v[124:127], v96, s[32:33] nt
    v_add_u32 v96, 7680, v96
    global_load_dwordx4 v[128:131], v96, s[32:33] nt
    v_add_u32 v96, 115200, v96
    global_load_dwordx4 v[132:135], v96, s[32:33] nt
    v_add_u32 v96, 7680, v96
    global_load_dwordx4 v[136:139], v96, s[32:33] nt
    v_add_u32 v96, 115200, v96
    global_load_dwordx4 v[140:143], v96, s[32:33] nt
    v_add_u32 v96, 7680, v96
    v_lshlrev_b32 v82, 16, v80
    v_and_b32 v83, 0xffff0000, v80
    v_lshlrev_b32 v29, 2, v29
    v_mul_f32 v84, 0xbfb8aa3b, v82
    v_mul_f32 v85, 0xbfb8aa3b, v83
    v_exp_f32 v84, v84
    v_exp_f32 v85, v85
    v_add_f32 v84, 1.0, v84
    v_add_f32 v85, 1.0, v85
    v_rcp_f32 v84, v84
    v_rcp_f32 v85, v85
    v_mul_f32 v82, v82, v84
    v_mul_f32 v83, v83, v85
    v_cvt_pk_bf16_f32 v80, v82, v83
    ds_bpermute_b32 v88, v29, v80 offset:0
    ds_bpermute_b32 v89, v29, v80 offset:32
    ds_bpermute_b32 v90, v29, v80 offset:64
    ds_bpermute_b32 v91, v29, v80 offset:96
    ds_bpermute_b32 v92, v29, v80 offset:128
    s_waitcnt lgkmcnt(4)
    v_lshlrev_b32 v30, 16, v88
    v_and_b32 v31, 0xffff0000, v88
    s_waitcnt lgkmcnt(3)
    v_lshlrev_b32 v32, 16, v89
    v_and_b32 v33, 0xffff0000, v89
    s_waitcnt lgkmcnt(2)
    v_lshlrev_b32 v34, 16, v90
    v_and_b32 v35, 0xffff0000, v90
    s_waitcnt lgkmcnt(1)
    v_lshlrev_b32 v36, 16, v91
    v_and_b32 v37, 0xffff0000, v91
    s_waitcnt lgkmcnt(0)
    v_lshlrev_b32 v38, 16, v92
    v_and_b32 v39, 0xffff0000, v92
    s_waitcnt vmcnt(20)
    v_lshlrev_b32 v80, 16, v40
    v_and_b32 v81, 0xffff0000, v40
    v_lshlrev_b32 v82, 16, v41
    v_and_b32 v83, 0xffff0000, v41
    v_lshlrev_b32 v84, 16, v42
    v_and_b32 v85, 0xffff0000, v42
    v_lshlrev_b32 v86, 16, v43
    v_and_b32 v87, 0xffff0000, v43
    v_pk_mul_f32 v[88:89], v[30:31], v[80:81] op_sel:[0,0] op_sel_hi:[0,1]
    v_pk_mul_f32 v[90:91], v[30:31], v[82:83] op_sel:[0,0] op_sel_hi:[0,1]
    v_pk_mul_f32 v[92:93], v[30:31], v[84:85] op_sel:[0,0] op_sel_hi:[0,1]
    v_pk_mul_f32 v[94:95], v[30:31], v[86:87] op_sel:[0,0] op_sel_hi:[0,1]
    s_waitcnt vmcnt(19)
    v_lshlrev_b32 v80, 16, v44
    v_and_b32 v81, 0xffff0000, v44
    v_lshlrev_b32 v82, 16, v45
    v_and_b32 v83, 0xffff0000, v45
    v_lshlrev_b32 v84, 16, v46
    v_and_b32 v85, 0xffff0000, v46
    v_lshlrev_b32 v86, 16, v47
    v_and_b32 v87, 0xffff0000, v47
    v_pk_fma_f32 v[88:89], v[30:31], v[80:81], v[88:89] op_sel:[1,0,0] op_sel_hi:[1,1,1]
    v_pk_fma_f32 v[90:91], v[30:31], v[82:83], v[90:91] op_sel:[1,0,0] op_sel_hi:[1,1,1]
    v_pk_fma_f32 v[92:93], v[30:31], v[84:85], v[92:93] op_sel:[1,0,0] op_sel_hi:[1,1,1]
    v_pk_fma_f32 v[94:95], v[30:31], v[86:87], v[94:95] op_sel:[1,0,0] op_sel_hi:[1,1,1]
    s_waitcnt vmcnt(18)
    v_lshlrev_b32 v80, 16, v48
    v_and_b32 v81, 0xffff0000, v48
    v_lshlrev_b32 v82, 16, v49
    v_and_b32 v83, 0xffff0000, v49
    v_lshlrev_b32 v84, 16, v50
    v_and_b32 v85, 0xffff0000, v50
    v_lshlrev_b32 v86, 16, v51
    v_and_b32 v87, 0xffff0000, v51
    v_pk_fma_f32 v[88:89], v[32:33], v[80:81], v[88:89] op_sel:[0,0,0] op_sel_hi:[0,1,1]
    v_pk_fma_f32 v[90:91], v[32:33], v[82:83], v[90:91] op_sel:[0,0,0] op_sel_hi:[0,1,1]
    v_pk_fma_f32 v[92:93], v[32:33], v[84:85], v[92:93] op_sel:[0,0,0] op_sel_hi:[0,1,1]
    v_pk_fma_f32 v[94:95], v[32:33], v[86:87], v[94:95] op_sel:[0,0,0] op_sel_hi:[0,1,1]
    s_waitcnt vmcnt(17)
    v_lshlrev_b32 v80, 16, v52
    v_and_b32 v81, 0xffff0000, v52
    v_lshlrev_b32 v82, 16, v53
    v_and_b32 v83, 0xffff0000, v53
    v_lshlrev_b32 v84, 16, v54
    v_and_b32 v85, 0xffff0000, v54
    v_lshlrev_b32 v86, 16, v55
    v_and_b32 v87, 0xffff0000, v55
    v_pk_fma_f32 v[88:89], v[32:33], v[80:81], v[88:89] op_sel:[1,0,0] op_sel_hi:[1,1,1]
    v_pk_fma_f32 v[90:91], v[32:33], v[82:83], v[90:91] op_sel:[1,0,0] op_sel_hi:[1,1,1]
    v_pk_fma_f32 v[92:93], v[32:33], v[84:85], v[92:93] op_sel:[1,0,0] op_sel_hi:[1,1,1]
    v_pk_fma_f32 v[94:95], v[32:33], v[86:87], v[94:95] op_sel:[1,0,0] op_sel_hi:[1,1,1]
    s_waitcnt vmcnt(16)
    v_lshlrev_b32 v80, 16, v56
    v_and_b32 v81, 0xffff0000, v56
    v_lshlrev_b32 v82, 16, v57
    v_and_b32 v83, 0xffff0000, v57
    v_lshlrev_b32 v84, 16, v58
    v_and_b32 v85, 0xffff0000, v58
    v_lshlrev_b32 v86, 16, v59
    v_and_b32 v87, 0xffff0000, v59
    v_pk_fma_f32 v[88:89], v[34:35], v[80:81], v[88:89] op_sel:[0,0,0] op_sel_hi:[0,1,1]
    v_pk_fma_f32 v[90:91], v[34:35], v[82:83], v[90:91] op_sel:[0,0,0] op_sel_hi:[0,1,1]
    v_pk_fma_f32 v[92:93], v[34:35], v[84:85], v[92:93] op_sel:[0,0,0] op_sel_hi:[0,1,1]
    v_pk_fma_f32 v[94:95], v[34:35], v[86:87], v[94:95] op_sel:[0,0,0] op_sel_hi:[0,1,1]
    s_waitcnt vmcnt(15)
    v_lshlrev_b32 v80, 16, v60
    v_and_b32 v81, 0xffff0000, v60
    v_lshlrev_b32 v82, 16, v61
    v_and_b32 v83, 0xffff0000, v61
    v_lshlrev_b32 v84, 16, v62
    v_and_b32 v85, 0xffff0000, v62
    v_lshlrev_b32 v86, 16, v63
    v_and_b32 v87, 0xffff0000, v63
    v_pk_fma_f32 v[88:89], v[34:35], v[80:81], v[88:89] op_sel:[1,0,0] op_sel_hi:[1,1,1]
    v_pk_fma_f32 v[90:91], v[34:35], v[82:83], v[90:91] op_sel:[1,0,0] op_sel_hi:[1,1,1]
    v_pk_fma_f32 v[92:93], v[34:35], v[84:85], v[92:93] op_sel:[1,0,0] op_sel_hi:[1,1,1]
    v_pk_fma_f32 v[94:95], v[34:35], v[86:87], v[94:95] op_sel:[1,0,0] op_sel_hi:[1,1,1]
    s_waitcnt vmcnt(14)
    v_lshlrev_b32 v80, 16, v64
    v_and_b32 v81, 0xffff0000, v64
    v_lshlrev_b32 v82, 16, v65
    v_and_b32 v83, 0xffff0000, v65
    v_lshlrev_b32 v84, 16, v66
    v_and_b32 v85, 0xffff0000, v66
    v_lshlrev_b32 v86, 16, v67
    v_and_b32 v87, 0xffff0000, v67
    v_pk_fma_f32 v[88:89], v[36:37], v[80:81], v[88:89] op_sel:[0,0,0] op_sel_hi:[0,1,1]
    v_pk_fma_f32 v[90:91], v[36:37], v[82:83], v[90:91] op_sel:[0,0,0] op_sel_hi:[0,1,1]
    v_pk_fma_f32 v[92:93], v[36:37], v[84:85], v[92:93] op_sel:[0,0,0] op_sel_hi:[0,1,1]
    v_pk_fma_f32 v[94:95], v[36:37], v[86:87], v[94:95] op_sel:[0,0,0] op_sel_hi:[0,1,1]
    s_waitcnt vmcnt(13)
    v_lshlrev_b32 v80, 16, v68
    v_and_b32 v81, 0xffff0000, v68
    v_lshlrev_b32 v82, 16, v69
    v_and_b32 v83, 0xffff0000, v69
    v_lshlrev_b32 v84, 16, v70
    v_and_b32 v85, 0xffff0000, v70
    v_lshlrev_b32 v86, 16, v71
    v_and_b32 v87, 0xffff0000, v71
    v_pk_fma_f32 v[88:89], v[36:37], v[80:81], v[88:89] op_sel:[1,0,0] op_sel_hi:[1,1,1]
    v_pk_fma_f32 v[90:91], v[36:37], v[82:83], v[90:91] op_sel:[1,0,0] op_sel_hi:[1,1,1]
    v_pk_fma_f32 v[92:93], v[36:37], v[84:85], v[92:93] op_sel:[1,0,0] op_sel_hi:[1,1,1]
    v_pk_fma_f32 v[94:95], v[36:37], v[86:87], v[94:95] op_sel:[1,0,0] op_sel_hi:[1,1,1]
    s_waitcnt vmcnt(12)
    v_lshlrev_b32 v80, 16, v72
    v_and_b32 v81, 0xffff0000, v72
    v_lshlrev_b32 v82, 16, v73
    v_and_b32 v83, 0xffff0000, v73
    v_lshlrev_b32 v84, 16, v74
    v_and_b32 v85, 0xffff0000, v74
    v_lshlrev_b32 v86, 16, v75
    v_and_b32 v87, 0xffff0000, v75
    v_pk_fma_f32 v[88:89], v[38:39], v[80:81], v[88:89] op_sel:[0,0,0] op_sel_hi:[0,1,1]
    v_pk_fma_f32 v[90:91], v[38:39], v[82:83], v[90:91] op_sel:[0,0,0] op_sel_hi:[0,1,1]
    v_pk_fma_f32 v[92:93], v[38:39], v[84:85], v[92:93] op_sel:[0,0,0] op_sel_hi:[0,1,1]
    v_pk_fma_f32 v[94:95], v[38:39], v[86:87], v[94:95] op_sel:[0,0,0] op_sel_hi:[0,1,1]
    s_waitcnt vmcnt(11)
    v_lshlrev_b32 v80, 16, v76
    v_and_b32 v81, 0xffff0000, v76
    v_lshlrev_b32 v82, 16, v77
    v_and_b32 v83, 0xffff0000, v77
    v_lshlrev_b32 v84, 16, v78
    v_and_b32 v85, 0xffff0000, v78
    v_lshlrev_b32 v86, 16, v79
    v_and_b32 v87, 0xffff0000, v79
    v_pk_fma_f32 v[88:89], v[38:39], v[80:81], v[88:89] op_sel:[1,0,0] op_sel_hi:[1,1,1]
    v_pk_fma_f32 v[90:91], v[38:39], v[82:83], v[90:91] op_sel:[1,0,0] op_sel_hi:[1,1,1]
    v_pk_fma_f32 v[92:93], v[38:39], v[84:85], v[92:93] op_sel:[1,0,0] op_sel_hi:[1,1,1]
    v_pk_fma_f32 v[94:95], v[38:39], v[86:87], v[94:95] op_sel:[1,0,0] op_sel_hi:[1,1,1]
    s_nop 0
    v_permlane32_swap_b32 v88, v92
    v_permlane32_swap_b32 v89, v93
    v_permlane32_swap_b32 v90, v94
    v_permlane32_swap_b32 v91, v95
    v_add_f32 v88, v88, v92
    v_add_f32 v89, v89, v93
    v_add_f32 v90, v90, v94
    v_add_f32 v91, v91, v95
    s_nop 0
    v_permlane16_swap_b32 v88, v90
    v_permlane16_swap_b32 v89, v91
    v_add_f32 v88, v88, v90
    v_add_f32 v89, v89, v91
    v_and_b32 v81, 7, v1
    v_lshrrev_b32 v82, 3, v1
    v_add_f32_dpp v80, v88, v88 row_ror:8 row_mask:0xf bank_mask:0x3
    s_nop 1
    v_add_f32_dpp v80, v89, v89 row_ror:8 row_mask:0xf bank_mask:0xc
    v_lshl_add_u32 v81, v81, 3, v82
    s_lshl_b32 s7, s3, 8
    s_add_u32 s7, s7, 122880
    v_lshl_add_u32 v81, v81, 2, s7
    ds_write_b32 v81, v80
    s_waitcnt lgkmcnt(0)
    s_barrier
    v_lshlrev_b32 v81, 2, v1
    v_add_u32 v82, 122880, v81
    ds_read_b32 v88, v82 offset:0
    ds_read_b32 v89, v82 offset:256
    ds_read_b32 v90, v82 offset:512
    ds_read_b32 v91, v82 offset:768
    v_add_u32 v81, s44, v81
    s_waitcnt lgkmcnt(2)
    v_add_f32 v88, v88, v89
    s_waitcnt lgkmcnt(0)
    v_add_f32 v90, v90, v91
    v_add_f32 v88, v88, v90
    v_min_u32 v88, -2, v88
    s_cmp_lg_u32 s3, 0
    s_cbranch_scc1 Lmod_skip_s1
    global_store_dword v81, v88, s[38:39] offset:0 sc1
Lmod_skip_s1:
    global_load_dwordx4 v[144:147], v96, s[32:33] nt
    s_cmp_ge_u32 s48, 27
    s_cbranch_scc1 Lsb_n3
    s_mul_i32 s4, s48, 40960
    s_mul_i32 s5, s3, 10240
    s_add_u32 s4, s4, s5
    v_lshl_add_u32 v164, v1, 4, s4
    s_add_u32 m0, s5, 0
    s_nop 0
    global_load_lds_dwordx4 v164, s[28:29] offset:0 nt
    global_load_lds_dwordx4 v164, s[28:29] offset:1024 nt
    global_load_lds_dwordx4 v164, s[28:29] offset:2048 nt
    global_load_lds_dwordx4 v164, s[28:29] offset:3072 nt
    s_add_u32 m0, s5, 4096
    v_add_u32 v164, 4096, v164
    global_load_lds_dwordx4 v164, s[28:29] offset:0 nt
    global_load_lds_dwordx4 v164, s[28:29] offset:1024 nt
    global_load_lds_dwordx4 v164, s[28:29] offset:2048 nt
    global_load_lds_dwordx4 v164, s[28:29] offset:3072 nt
    s_add_u32 m0, s5, 8192
    v_add_u32 v164, 4096, v164
    global_load_lds_dwordx4 v164, s[28:29] offset:0 nt
    global_load_lds_dwordx4 v164, s[28:29] offset:1024 nt
    s_waitcnt vmcnt(10)
    s_branch Lsb_n4
Lsb_n3:
    s_add_u32 s50, s48, 78
    s_lshr_b32 s4, s50, 1
    s_and_b32 s5, s50, 1
    s_cmp_lt_u32 s4, 50
    s_cselect_b32 s6, -20, 0
    s_cmp_lt_u32 s4, 20
    s_cselect_b32 s6, 30, s6
    s_add_u32 s4, s4, s6
    s_mul_i32 s6, s5, 15360
    s_lshl_b32 s7, s4, 8
    s_add_u32 s44, s6, s7
    s_lshl_b32 s5, s5, 2
    s_add_u32 s5, s5, s3
    s_mul_i32 s5, s5, 80
    s_lshl_b32 s4, s4, 7
    s_mul_i32 s6, s5, 7680
    s_add_u32 s4, s4, s6
    v_min_u32 v28, 39, v1
    s_lshl_b32 s5, s5, 1
    v_lshl_add_u32 v28, v28, 2, s5
    global_load_dword v80, v28, s[30:31]
    v_lshrrev_b32 v29, 3, v1
    v_mul_u32_u24 v28, 15232, v29
    v_add3_u32 v28, v28, v4, s4
    global_load_dwordx4 v[40:43], v28, s[32:33] nt
    v_add_u32 v28, 7680, v28
    global_load_dwordx4 v[44:47], v28, s[32:33] nt
    v_add_u32 v28, 115200, v28
    global_load_dwordx4 v[48:51], v28, s[32:33] nt
    v_add_u32 v28, 7680, v28
    global_load_dwordx4 v[52:55], v28, s[32:33] nt
    v_add_u32 v28, 115200, v28
    global_load_dwordx4 v[56:59], v28, s[32:33] nt
    v_add_u32 v28, 7680, v28
    global_load_dwordx4 v[60:63], v28, s[32:33] nt
    v_add_u32 v28, 115200, v28
    global_load_dwordx4 v[64:67], v28, s[32:33] nt
    v_add_u32 v28, 7680, v28
    global_load_dwordx4 v[68:71], v28, s[32:33] nt
    v_add_u32 v28, 115200, v28
    global_load_dwordx4 v[72:75], v28, s[32:33] nt
    v_add_u32 v28, 7680, v28
    global_load_dwordx4 v[76:79], v28, s[32:33] nt
    s_waitcnt vmcnt(11)
Lsb_n4:
    v_lshlrev_b32 v150, 16, v148
    v_and_b32 v151, 0xffff0000, v148
    v_lshlrev_b32 v97, 2, v97
    v_mul_f32 v152, 0xbfb8aa3b, v150
    v_mul_f32 v153, 0xbfb8aa3b, v151
    v_exp_f32 v152, v152
    v_exp_f32 v153, v153
    v_add_f32 v152, 1.0, v152
    v_add_f32 v153, 1.0, v153
    v_rcp_f32 v152, v152
    v_rcp_f32 v153, v153
    v_mul_f32 v150, v150, v152
    v_mul_f32 v151, v151, v153
    v_cvt_pk_bf16_f32 v148, v150, v151
    ds_bpermute_b32 v156, v97, v148 offset:0
    ds_bpermute_b32 v157, v97, v148 offset:32
    ds_bpermute_b32 v158, v97, v148 offset:64
    ds_bpermute_b32 v159, v97, v148 offset:96
    ds_bpermute_b32 v160, v97, v148 offset:128
    s_waitcnt lgkmcnt(4)
    v_lshlrev_b32 v98, 16, v156
    v_and_b32 v99, 0xffff0000, v156
    s_waitcnt lgkmcnt(3)
    v_lshlrev_b32 v100, 16, v157
    v_and_b32 v101, 0xffff0000, v157
    s_waitcnt lgkmcnt(2)
    v_lshlrev_b32 v102, 16, v158
    v_and_b32 v103, 0xffff0000, v158
    s_waitcnt lgkmcnt(1)
    v_lshlrev_b32 v104, 16, v159
    v_and_b32 v105, 0xffff0000, v159
    s_waitcnt lgkmcnt(0)
    v_lshlrev_b32 v106, 16, v160
    v_and_b32 v107, 0xffff0000, v160
    v_lshlrev_b32 v148, 16, v108
    v_and_b32 v149, 0xffff0000, v108
    v_lshlrev_b32 v150, 16, v109
    v_and_b32 v151, 0xffff0000, v109
    v_lshlrev_b32 v152, 16, v110
    v_and_b32 v153, 0xffff0000, v110
    v_lshlrev_b32 v154, 16, v111
    v_and_b32 v155, 0xffff0000, v111
    v_pk_mul_f32 v[156:157], v[98:99], v[148:149] op_sel:[0,0] op_sel_hi:[0,1]
    v_pk_mul_f32 v[158:159], v[98:99], v[150:151] op_sel:[0,0] op_sel_hi:[0,1]
    v_pk_mul_f32 v[160:161], v[98:99], v[152:153] op_sel:[0,0] op_sel_hi:[0,1]
    v_pk_mul_f32 v[162:163], v[98:99], v[154:155] op_sel:[0,0] op_sel_hi:[0,1]
    v_lshlrev_b32 v148, 16, v112
    v_and_b32 v149, 0xffff0000, v112
    v_lshlrev_b32 v150, 16, v113
    v_and_b32 v151, 0xffff0000, v113
    v_lshlrev_b32 v152, 16, v114
    v_and_b32 v153, 0xffff0000, v114
    v_lshlrev_b32 v154, 16, v115
    v_and_b32 v155, 0xffff0000, v115
    v_pk_fma_f32 v[156:157], v[98:99], v[148:149], v[156:157] op_sel:[1,0,0] op_sel_hi:[1,1,1]
    v_pk_fma_f32 v[158:159], v[98:99], v[150:151], v[158:159] op_sel:[1,0,0] op_sel_hi:[1,1,1]
    v_pk_fma_f32 v[160:161], v[98:99], v[152:153], v[160:161] op_sel:[1,0,0] op_sel_hi:[1,1,1]
    v_pk_fma_f32 v[162:163], v[98:99], v[154:155], v[162:163] op_sel:[1,0,0] op_sel_hi:[1,1,1]
    v_lshlrev_b32 v148, 16, v116
    v_and_b32 v149, 0xffff0000, v116
    v_lshlrev_b32 v150, 16, v117
    v_and_b32 v151, 0xffff0000, v117
    v_lshlrev_b32 v152, 16, v118
    v_and_b32 v153, 0xffff0000, v118
    v_lshlrev_b32 v154, 16, v119
    v_and_b32 v155, 0xffff0000, v119
    v_pk_fma_f32 v[156:157], v[100:101], v[148:149], v[156:157] op_sel:[0,0,0] op_sel_hi:[0,1,1]
    v_pk_fma_f32 v[158:159], v[100:101], v[150:151], v[158:159] op_sel:[0,0,0] op_sel_hi:[0,1,1]
    v_pk_fma_f32 v[160:161], v[100:101], v[152:153], v[160:161] op_sel:[0,0,0] op_sel_hi:[0,1,1]
    v_pk_fma_f32 v[162:163], v[100:101], v[154:155], v[162:163] op_sel:[0,0,0] op_sel_hi:[0,1,1]
    v_lshlrev_b32 v148, 16, v120
    v_and_b32 v149, 0xffff0000, v120
    v_lshlrev_b32 v150, 16, v121
    v_and_b32 v151, 0xffff0000, v121
    v_lshlrev_b32 v152, 16, v122
    v_and_b32 v153, 0xffff0000, v122
    v_lshlrev_b32 v154, 16, v123
    v_and_b32 v155, 0xffff0000, v123
    v_pk_fma_f32 v[156:157], v[100:101], v[148:149], v[156:157] op_sel:[1,0,0] op_sel_hi:[1,1,1]
    v_pk_fma_f32 v[158:159], v[100:101], v[150:151], v[158:159] op_sel:[1,0,0] op_sel_hi:[1,1,1]
    v_pk_fma_f32 v[160:161], v[100:101], v[152:153], v[160:161] op_sel:[1,0,0] op_sel_hi:[1,1,1]
    v_pk_fma_f32 v[162:163], v[100:101], v[154:155], v[162:163] op_sel:[1,0,0] op_sel_hi:[1,1,1]
    v_lshlrev_b32 v148, 16, v124
    v_and_b32 v149, 0xffff0000, v124
    v_lshlrev_b32 v150, 16, v125
    v_and_b32 v151, 0xffff0000, v125
    v_lshlrev_b32 v152, 16, v126
    v_and_b32 v153, 0xffff0000, v126
    v_lshlrev_b32 v154, 16, v127
    v_and_b32 v155, 0xffff0000, v127
    v_pk_fma_f32 v[156:157], v[102:103], v[148:149], v[156:157] op_sel:[0,0,0] op_sel_hi:[0,1,1]
    v_pk_fma_f32 v[158:159], v[102:103], v[150:151], v[158:159] op_sel:[0,0,0] op_sel_hi:[0,1,1]
    v_pk_fma_f32 v[160:161], v[102:103], v[152:153], v[160:161] op_sel:[0,0,0] op_sel_hi:[0,1,1]
    v_pk_fma_f32 v[162:163], v[102:103], v[154:155], v[162:163] op_sel:[0,0,0] op_sel_hi:[0,1,1]
    v_lshlrev_b32 v148, 16, v128
    v_and_b32 v149, 0xffff0000, v128
    v_lshlrev_b32 v150, 16, v129
    v_and_b32 v151, 0xffff0000, v129
    v_lshlrev_b32 v152, 16, v130
    v_and_b32 v153, 0xffff0000, v130
    v_lshlrev_b32 v154, 16, v131
    v_and_b32 v155, 0xffff0000, v131
    v_pk_fma_f32 v[156:157], v[102:103], v[148:149], v[156:157] op_sel:[1,0,0] op_sel_hi:[1,1,1]
    v_pk_fma_f32 v[158:159], v[102:103], v[150:151], v[158:159] op_sel:[1,0,0] op_sel_hi:[1,1,1]
    v_pk_fma_f32 v[160:161], v[102:103], v[152:153], v[160:161] op_sel:[1,0,0] op_sel_hi:[1,1,1]
    v_pk_fma_f32 v[162:163], v[102:103], v[154:155], v[162:163] op_sel:[1,0,0] op_sel_hi:[1,1,1]
    v_lshlrev_b32 v148, 16, v132
    v_and_b32 v149, 0xffff0000, v132
    v_lshlrev_b32 v150, 16, v133
    v_and_b32 v151, 0xffff0000, v133
    v_lshlrev_b32 v152, 16, v134
    v_and_b32 v153, 0xffff0000, v134
    v_lshlrev_b32 v154, 16, v135
    v_and_b32 v155, 0xffff0000, v135
    v_pk_fma_f32 v[156:157], v[104:105], v[148:149], v[156:157] op_sel:[0,0,0] op_sel_hi:[0,1,1]
    v_pk_fma_f32 v[158:159], v[104:105], v[150:151], v[158:159] op_sel:[0,0,0] op_sel_hi:[0,1,1]
    v_pk_fma_f32 v[160:161], v[104:105], v[152:153], v[160:161] op_sel:[0,0,0] op_sel_hi:[0,1,1]
    v_pk_fma_f32 v[162:163], v[104:105], v[154:155], v[162:163] op_sel:[0,0,0] op_sel_hi:[0,1,1]
    v_lshlrev_b32 v148, 16, v136
    v_and_b32 v149, 0xffff0000, v136
    v_lshlrev_b32 v150, 16, v137
    v_and_b32 v151, 0xffff0000, v137
    v_lshlrev_b32 v152, 16, v138
    v_and_b32 v153, 0xffff0000, v138
    v_lshlrev_b32 v154, 16, v139
    v_and_b32 v155, 0xffff0000, v139
    v_pk_fma_f32 v[156:157], v[104:105], v[148:149], v[156:157] op_sel:[1,0,0] op_sel_hi:[1,1,1]
    v_pk_fma_f32 v[158:159], v[104:105], v[150:151], v[158:159] op_sel:[1,0,0] op_sel_hi:[1,1,1]
    v_pk_fma_f32 v[160:161], v[104:105], v[152:153], v[160:161] op_sel:[1,0,0] op_sel_hi:[1,1,1]
    v_pk_fma_f32 v[162:163], v[104:105], v[154:155], v[162:163] op_sel:[1,0,0] op_sel_hi:[1,1,1]
    v_lshlrev_b32 v148, 16, v140
    v_and_b32 v149, 0xffff0000, v140
    v_lshlrev_b32 v150, 16, v141
    v_and_b32 v151, 0xffff0000, v141
    v_lshlrev_b32 v152, 16, v142
    v_and_b32 v153, 0xffff0000, v142
    v_lshlrev_b32 v154, 16, v143
    v_and_b32 v155, 0xffff0000, v143
    v_pk_fma_f32 v[156:157], v[106:107], v[148:149], v[156:157] op_sel:[0,0,0] op_sel_hi:[0,1,1]
    v_pk_fma_f32 v[158:159], v[106:107], v[150:151], v[158:159] op_sel:[0,0,0] op_sel_hi:[0,1,1]
    v_pk_fma_f32 v[160:161], v[106:107], v[152:153], v[160:161] op_sel:[0,0,0] op_sel_hi:[0,1,1]
    v_pk_fma_f32 v[162:163], v[106:107], v[154:155], v[162:163] op_sel:[0,0,0] op_sel_hi:[0,1,1]
    v_lshlrev_b32 v148, 16, v144
    v_and_b32 v149, 0xffff0000, v144
    v_lshlrev_b32 v150, 16, v145
    v_and_b32 v151, 0xffff0000, v145
    v_lshlrev_b32 v152, 16, v146
    v_and_b32 v153, 0xffff0000, v146
    v_lshlrev_b32 v154, 16, v147
    v_and_b32 v155, 0xffff0000, v147
    v_pk_fma_f32 v[156:157], v[106:107], v[148:149], v[156:157] op_sel:[1,0,0] op_sel_hi:[1,1,1]
    v_pk_fma_f32 v[158:159], v[106:107], v[150:151], v[158:159] op_sel:[1,0,0] op_sel_hi:[1,1,1]
    v_pk_fma_f32 v[160:161], v[106:107], v[152:153], v[160:161] op_sel:[1,0,0] op_sel_hi:[1,1,1]
    v_pk_fma_f32 v[162:163], v[106:107], v[154:155], v[162:163] op_sel:[1,0,0] op_sel_hi:[1,1,1]
    s_nop 0
    v_permlane32_swap_b32 v156, v160
    v_permlane32_swap_b32 v157, v161
    v_permlane32_swap_b32 v158, v162
    v_permlane32_swap_b32 v159, v163
    v_add_f32 v156, v156, v160
    v_add_f32 v157, v157, v161
    v_add_f32 v158, v158, v162
    v_add_f32 v159, v159, v163
    s_nop 0
    v_permlane16_swap_b32 v156, v158
    v_permlane16_swap_b32 v157, v159
    v_add_f32 v156, v156, v158
    v_add_f32 v157, v157, v159
    v_and_b32 v149, 7, v1
    v_lshrrev_b32 v150, 3, v1
    v_add_f32_dpp v148, v156, v156 row_ror:8 row_mask:0xf bank_mask:0x3
    s_nop 1
    v_add_f32_dpp v148, v157, v157 row_ror:8 row_mask:0xf bank_mask:0xc
    v_lshl_add_u32 v149, v149, 3, v150
    s_lshl_b32 s7, s3, 8
    s_add_u32 s7, s7, 123904
    v_lshl_add_u32 v149, v149, 2, s7
    ds_write_b32 v149, v148
    s_waitcnt lgkmcnt(0)
    s_barrier
    v_lshlrev_b32 v149, 2, v1
    v_add_u32 v150, 123904, v149
    ds_read_b32 v156, v150 offset:0
    ds_read_b32 v157, v150 offset:256
    ds_read_b32 v158, v150 offset:512
    ds_read_b32 v159, v150 offset:768
    v_add_u32 v149, s45, v149
    s_waitcnt lgkmcnt(2)
    v_add_f32 v156, v156, v157
    s_waitcnt lgkmcnt(0)
    v_add_f32 v158, v158, v159
    v_add_f32 v156, v156, v158
    v_min_u32 v156, -2, v156
    s_cmp_lg_u32 s3, 0
    s_cbranch_scc1 Lmod_skip_s2
    global_store_dword v149, v156, s[38:39] offset:0 sc1
Lmod_skip_s2:
    s_cmp_lg_u32 s3, 0
    s_cbranch_scc1 Lbic_x
    v_min_u32 v164, 49, v1
    v_cmp_lt_u32 vcc, 7, v164
    s_nop 1
    v_cndmask_b32_e64 v165, 0, 7, vcc
    v_add_lshl_u32 v164, v164, v165, 2
    s_branch Lbic_f
Lbic:
    s_sleep 4
Lbic_f:
    global_load_dword v165, v164, s[36:37] sc1
    s_waitcnt vmcnt(0)
    v_cmp_eq_u32 vcc, 0, v165
    s_add_u32 s100, s100, 1
    s_cmp_ge_u32 s100, 262144
    s_cbranch_scc1 Lbic_x
    s_cbranch_vccnz Lbic
Lbic_x:
    s_waitcnt vmcnt(0)
    s_cmp_ge_u32 s48, 27
    s_cbranch_scc1 Lsp_b3
    s_barrier
    v_and_b32 v33, 15, v1
    v_lshrrev_b32 v34, 4, v1
    v_mul_u32_u24 v34, 10240, v34
    s_mul_i32 s5, s3, 320
    s_add_u32 s5, s5, 0
    v_add_u32 v34, s5, v34
    v_lshl_add_u32 v31, v33, 2, v34
    v_lshl_add_u32 v32, v33, 1, v34
    s_mul_i32 s5, s3, 276480
    s_mul_i32 s6, s48, 5120
    s_add_u32 s5, s5, s6
    s_add_u32 s5, s5, 10487808
    v_lshl_add_u32 v30, v1, 4, s5
    s_mov_b32 s6, 0x5040100
    s_mov_b32 s7, 0x7060302
    ds_read_b32 v36, v31 offset:0
    ds_read_b32 v37, v31 offset:2560
    ds_read_b32 v38, v31 offset:5120
    ds_read_b32 v39, v31 offset:7680
    ds_read_b32 v40, v31 offset:1280
    ds_read_b32 v41, v31 offset:3840
    ds_read_b32 v42, v31 offset:6400
    ds_read_b32 v43, v31 offset:8960
    ds_read_b32 v44, v31 offset:64
    ds_read_b32 v45, v31 offset:2624
    ds_read_b32 v46, v31 offset:5184
    ds_read_b32 v47, v31 offset:7744
    ds_read_b32 v48, v31 offset:1344
    ds_read_b32 v49, v31 offset:3904
    ds_read_b32 v50, v31 offset:6464
    ds_read_b32 v51, v31 offset:9024
    ds_read_u16 v52, v32 offset:128
    ds_read_u16 v53, v32 offset:2688
    ds_read_u16 v54, v32 offset:5248
    ds_read_u16 v55, v32 offset:7808
    ds_read_u16 v56, v32 offset:1408
    ds_read_u16 v57, v32 offset:3968
    ds_read_u16 v58, v32 offset:6528
    ds_read_u16 v59, v32 offset:9088
    s_waitcnt lgkmcnt(15)
    v_perm_b32 v60, v37, v36, s6
    v_perm_b32 v61, v39, v38, s6
    v_perm_b32 v62, v41, v40, s6
    v_perm_b32 v63, v43, v42, s6
    v_perm_b32 v64, v37, v36, s7
    v_perm_b32 v65, v39, v38, s7
    v_perm_b32 v66, v41, v40, s7
    v_perm_b32 v67, v43, v42, s7
    s_waitcnt lgkmcnt(11)
    v_perm_b32 v68, v45, v44, s6
    v_perm_b32 v69, v47, v46, s6
    s_waitcnt lgkmcnt(9)
    v_perm_b32 v70, v49, v48, s6
    s_waitcnt lgkmcnt(8)
    v_perm_b32 v71, v51, v50, s6
    v_perm_b32 v72, v45, v44, s7
    v_perm_b32 v73, v47, v46, s7
    v_perm_b32 v74, v49, v48, s7
    v_perm_b32 v75, v51, v50, s7
    s_waitcnt lgkmcnt(3)
    v_perm_b32 v76, v53, v52, s6
    v_perm_b32 v77, v55, v54, s6
    s_waitcnt lgkmcnt(1)
    v_perm_b32 v78, v57, v56, s6
    s_waitcnt lgkmcnt(0)
    v_perm_b32 v79, v59, v58, s6
    global_store_dwordx4 v30, v[60:63], s[38:39] offset:-2048 sc1
    global_store_dwordx4 v30, v[64:67], s[38:39] offset:-1024 sc1
    global_store_dwordx4 v30, v[68:71], s[38:39] offset:0 sc1
    global_store_dwordx4 v30, v[72:75], s[38:39] offset:1024 sc1
    global_store_dwordx4 v30, v[76:79], s[38:39] offset:2048 sc1
    v_add_u32 v30, 138240, v30
    ds_read_b32 v80, v31 offset:160
    ds_read_b32 v81, v31 offset:2720
    ds_read_b32 v82, v31 offset:5280
    ds_read_b32 v83, v31 offset:7840
    ds_read_b32 v84, v31 offset:1440
    ds_read_b32 v85, v31 offset:4000
    ds_read_b32 v86, v31 offset:6560
    ds_read_b32 v87, v31 offset:9120
    ds_read_b32 v88, v31 offset:224
    ds_read_b32 v89, v31 offset:2784
    ds_read_b32 v90, v31 offset:5344
    ds_read_b32 v91, v31 offset:7904
    ds_read_b32 v92, v31 offset:1504
    ds_read_b32 v93, v31 offset:4064
    ds_read_b32 v94, v31 offset:6624
    ds_read_b32 v95, v31 offset:9184
    ds_read_u16 v96, v32 offset:288
    ds_read_u16 v97, v32 offset:2848
    ds_read_u16 v98, v32 offset:5408
    ds_read_u16 v99, v32 offset:7968
    ds_read_u16 v100, v32 offset:1568
    ds_read_u16 v101, v32 offset:4128
    ds_read_u16 v102, v32 offset:6688
    ds_read_u16 v103, v32 offset:9248
    s_waitcnt lgkmcnt(15)
    v_perm_b32 v104, v81, v80, s6
    v_perm_b32 v105, v83, v82, s6
    v_perm_b32 v106, v85, v84, s6
    v_perm_b32 v107, v87, v86, s6
    v_perm_b32 v108, v81, v80, s7
    v_perm_b32 v109, v83, v82, s7
    v_perm_b32 v110, v85, v84, s7
    v_perm_b32 v111, v87, v86, s7
    s_waitcnt lgkmcnt(11)
    v_perm_b32 v112, v89, v88, s6
    v_perm_b32 v113, v91, v90, s6
    s_waitcnt lgkmcnt(9)
    v_perm_b32 v114, v93, v92, s6
    s_waitcnt lgkmcnt(8)
    v_perm_b32 v115, v95, v94, s6
    v_perm_b32 v116, v89, v88, s7
    v_perm_b32 v117, v91, v90, s7
    v_perm_b32 v118, v93, v92, s7
    v_perm_b32 v119, v95, v94, s7
    s_waitcnt lgkmcnt(3)
    v_perm_b32 v120, v97, v96, s6
    v_perm_b32 v121, v99, v98, s6
    s_waitcnt lgkmcnt(1)
    v_perm_b32 v122, v101, v100, s6
    s_waitcnt lgkmcnt(0)
    v_perm_b32 v123, v103, v102, s6
    global_store_dwordx4 v30, v[104:107], s[38:39] offset:-2048 sc1
    global_store_dwordx4 v30, v[108:111], s[38:39] offset:-1024 sc1
    global_store_dwordx4 v30, v[112:115], s[38:39] offset:0 sc1
    global_store_dwordx4 v30, v[116:119], s[38:39] offset:1024 sc1
    global_store_dwordx4 v30, v[120:123], s[38:39] offset:2048 sc1
    s_lshl_b32 s4, s48, 7
    s_add_u32 s51, s4, 98304
    s_branch Lsp_d
Lsp_a2:
    s_and_b32 s4, s42, 1
    s_lshl_b32 s4, s4, 1
    s_and_b32 s5, s3, 1
    s_add_u32 s44, s4, s5
    s_and_b32 s4, s42, -2
    s_lshr_b32 s5, s3, 1
    s_add_u32 s45, s4, s5
    s_and_b32 s4, s42, 1
    s_lshl_b32 s4, s4, 2
    s_add_u32 s4, s4, s3
    s_mul_i32 s4, s4, 276480
    s_lshr_b32 s5, s42, 1
    s_lshl_b32 s5, s5, 7
    s_add_u32 s4, s4, s5
    v_lshrrev_b32 v28, 3, v1
    v_mul_u32_u24 v28, 3328, v28
    v_add3_u32 v28, v28, v4, s4
    s_mul_i32 s5, s3, 10240
    s_add_u32 m0, s5, 0
    s_nop 0
    global_load_lds_dwordx4 v28, s[22:23] nt
    v_add_u32 v28, 27648, v28
    s_add_u32 m0, s5, 1024
    s_nop 0
    global_load_lds_dwordx4 v28, s[22:23] nt
    v_add_u32 v28, 27648, v28
    s_add_u32 m0, s5, 2048
    s_nop 0
    global_load_lds_dwordx4 v28, s[22:23] nt
    v_add_u32 v28, 27648, v28
    s_add_u32 m0, s5, 3072
    s_nop 0
    global_load_lds_dwordx4 v28, s[22:23] nt
    v_add_u32 v28, 27648, v28
    s_add_u32 m0, s5, 4096
    s_nop 0
    global_load_lds_dwordx4 v28, s[22:23] nt
    v_add_u32 v28, 27648, v28
    s_add_u32 m0, s5, 5120
    s_nop 0
    global_load_lds_dwordx4 v28, s[22:23] nt
    v_add_u32 v28, 27648, v28
    s_add_u32 m0, s5, 6144
    s_nop 0
    global_load_lds_dwordx4 v28, s[22:23] nt
    v_add_u32 v28, 27648, v28
    s_add_u32 m0, s5, 7168
    s_nop 0
    global_load_lds_dwordx4 v28, s[22:23] nt
    v_add_u32 v28, 27648, v28
    s_add_u32 m0, s5, 8192
    s_nop 0
    global_load_lds_dwordx4 v28, s[22:23] nt
    v_add_u32 v28, 27648, v28
    s_add_u32 m0, s5, 9216
    s_nop 0
    global_load_lds_dwordx4 v28, s[22:23] nt
    v_add_u32 v28, 27648, v28
    v_min_u32 v72, 624, v4
    s_mul_i32 s5, s44, 640
    s_add_u32 s5, s5, 7680
    v_add_u32 v73, s5, v72
    s_mul_i32 s5, s3, 1280
    s_add_u32 s5, s5, 124928
    v_add_u32 v72, s5, v72
    v_lshl_add_u32 v74, v3, 5, s5
    s_cmp_ge_u32 s45, 27
    s_cselect_b32 s6, -54, 56
    s_lshl_b32 s7, s45, 1
    s_add_u32 s46, s6, s7
    s_mul_i32 s4, s46, 20480
    s_mul_i32 s5, s44, 5120
    s_add_u32 s4, s4, s5
    s_add_u32 s4, s4, 7342080
    v_add_u32 v75, s4, v4
    v_add_u32 v76, 20480, v75
    s_and_b32 s4, s3, 1
    s_mul_i32 s4, s4, 20480
    s_lshr_b32 s5, s3, 1
    s_lshl_b32 s5, s5, 6
    s_add_u32 s4, s4, s5
    v_lshl_add_u32 v28, v3, 10, s4
    v_lshl_add_u32 v28, v2, 2, v28
    s_cmp_lt_u32 s42, 8
    s_cselect_b32 s48, 21, 0
    s_add_u32 s48, s48, s42
    s_add_u32 s48, s48, 76
    s_sub_u32 s4, s42, 5
    s_cmp_ge_u32 s4, 21
    s_cbranch_scc1 Lwp_n1
    s_lshr_b32 s4, s48, 1
    s_and_b32 s5, s48, 1
    s_cmp_lt_u32 s4, 50
    s_cselect_b32 s6, -20, 0
    s_cmp_lt_u32 s4, 20
    s_cselect_b32 s6, 30, s6
    s_add_u32 s4, s4, s6
    s_mul_i32 s6, s5, 15360
    s_lshl_b32 s7, s4, 8
    s_add_u32 s47, s6, s7
    s_lshl_b32 s5, s5, 2
    s_add_u32 s5, s5, s3
    s_mul_i32 s5, s5, 80
    s_lshl_b32 s4, s4, 7
    s_mul_i32 s6, s5, 7680
    s_add_u32 s4, s4, s6
    v_min_u32 v78, 39, v1
    s_lshl_b32 s5, s5, 1
    v_lshl_add_u32 v78, v78, 2, s5
    global_load_dword v132, v78, s[30:31]
    v_lshrrev_b32 v79, 3, v1
    v_mul_u32_u24 v78, 15232, v79
    v_add3_u32 v78, v78, v4, s4
    global_load_dwordx4 v[92:95], v78, s[32:33] nt
    v_add_u32 v78, 7680, v78
    global_load_dwordx4 v[96:99], v78, s[32:33] nt
    v_add_u32 v78, 115200, v78
    global_load_dwordx4 v[100:103], v78, s[32:33] nt
    v_add_u32 v78, 7680, v78
    global_load_dwordx4 v[104:107], v78, s[32:33] nt
    v_add_u32 v78, 115200, v78
    global_load_dwordx4 v[108:111], v78, s[32:33] nt
    v_add_u32 v78, 7680, v78
    global_load_dwordx4 v[112:115], v78, s[32:33] nt
    v_add_u32 v78, 115200, v78
    global_load_dwordx4 v[116:119], v78, s[32:33] nt
    v_add_u32 v78, 7680, v78
    global_load_dwordx4 v[120:123], v78, s[32:33] nt
    v_add_u32 v78, 115200, v78
    global_load_dwordx4 v[124:127], v78, s[32:33] nt
    v_add_u32 v78, 7680, v78
    global_load_dwordx4 v[128:131], v78, s[32:33] nt
    s_waitcnt vmcnt(11)
    s_branch Lwp_n2
Lwp_n1:
    s_waitcnt vmcnt(0)
Lwp_n2:
    s_barrier
    ds_read_b32 v32, v28 offset:0
    ds_read_b32 v33, v28 offset:128
    ds_read_b32 v34, v28 offset:256
    ds_read_b32 v35, v28 offset:384
    ds_read_b32 v36, v28 offset:512
    ds_read_b32 v37, v28 offset:640
    ds_read_b32 v38, v28 offset:768
    ds_read_b32 v39, v28 offset:896
    ds_read_b32 v40, v28 offset:4096
    ds_read_b32 v41, v28 offset:4224
    ds_read_b32 v42, v28 offset:4352
    ds_read_b32 v43, v28 offset:4480
    ds_read_b32 v44, v28 offset:4608
    ds_read_b32 v45, v28 offset:4736
    ds_read_b32 v46, v28 offset:4864
    ds_read_b32 v47, v28 offset:4992
    ds_read_b32 v48, v28 offset:8192
    ds_read_b32 v49, v28 offset:8320
    ds_read_b32 v50, v28 offset:8448
    ds_read_b32 v51, v28 offset:8576
    ds_read_b32 v52, v28 offset:8704
    ds_read_b32 v53, v28 offset:8832
    ds_read_b32 v54, v28 offset:8960
    ds_read_b32 v55, v28 offset:9088
    ds_read_b32 v56, v28 offset:12288
    ds_read_b32 v57, v28 offset:12416
    ds_read_b32 v58, v28 offset:12544
    ds_read_b32 v59, v28 offset:12672
    ds_read_b32 v60, v28 offset:12800
    ds_read_b32 v61, v28 offset:12928
    ds_read_b32 v62, v28 offset:13056
    ds_read_b32 v63, v28 offset:13184
    ds_read_b32 v64, v28 offset:16384
    ds_read_b32 v65, v28 offset:16512
    ds_read_b32 v66, v28 offset:16640
    ds_read_b32 v67, v28 offset:16768
    ds_read_b32 v68, v28 offset:16896
    ds_read_b32 v69, v28 offset:17024
    ds_read_b32 v70, v28 offset:17152
    ds_read_b32 v71, v28 offset:17280
    s_waitcnt lgkmcnt(15)
    v_lshlrev_b32 v152, 16, v32
    v_and_b32 v153, 0xffff0000, v32
    v_lshlrev_b32 v154, 16, v33
    v_and_b32 v155, 0xffff0000, v33
    v_lshlrev_b32 v156, 16, v34
    v_and_b32 v157, 0xffff0000, v34
    v_lshlrev_b32 v158, 16, v35
    v_and_b32 v159, 0xffff0000, v35
    v_lshlrev_b32 v160, 16, v36
    v_and_b32 v161, 0xffff0000, v36
    v_lshlrev_b32 v162, 16, v37
    v_and_b32 v163, 0xffff0000, v37
    v_lshlrev_b32 v164, 16, v38
    v_and_b32 v165, 0xffff0000, v38
    v_lshlrev_b32 v166, 16, v39
    v_and_b32 v167, 0xffff0000, v39
    v_lshlrev_b32 v168, 16, v40
    v_and_b32 v169, 0xffff0000, v40
    v_lshlrev_b32 v170, 16, v41
    v_and_b32 v171, 0xffff0000, v41
    v_lshlrev_b32 v172, 16, v42
    v_and_b32 v173, 0xffff0000, v42
    v_lshlrev_b32 v174, 16, v43
    v_and_b32 v175, 0xffff0000, v43
    v_lshlrev_b32 v176, 16, v44
    v_and_b32 v177, 0xffff0000, v44
    v_lshlrev_b32 v178, 16, v45
    v_and_b32 v179, 0xffff0000, v45
    v_lshlrev_b32 v180, 16, v46
    v_and_b32 v181, 0xffff0000, v46
    v_lshlrev_b32 v182, 16, v47
    v_and_b32 v183, 0xffff0000, v47
    v_lshlrev_b32 v184, 16, v48
    v_and_b32 v185, 0xffff0000, v48
    v_lshlrev_b32 v186, 16, v49
    v_and_b32 v187, 0xffff0000, v49
    v_lshlrev_b32 v188, 16, v50
    v_and_b32 v189, 0xffff0000, v50
    v_lshlrev_b32 v190, 16, v51
    v_and_b32 v191, 0xffff0000, v51
    v_lshlrev_b32 v192, 16, v52
    v_and_b32 v193, 0xffff0000, v52
    v_lshlrev_b32 v194, 16, v53
    v_and_b32 v195, 0xffff0000, v53
    v_lshlrev_b32 v196, 16, v54
    v_and_b32 v197, 0xffff0000, v54
    v_lshlrev_b32 v198, 16, v55
    v_and_b32 v199, 0xffff0000, v55
    v_lshlrev_b32 v200, 16, v56
    v_and_b32 v201, 0xffff0000, v56
    s_waitcnt lgkmcnt(0)
    v_lshlrev_b32 v202, 16, v57
    v_and_b32 v203, 0xffff0000, v57
    v_lshlrev_b32 v204, 16, v58
    v_and_b32 v205, 0xffff0000, v58
    v_lshlrev_b32 v206, 16, v59
    v_and_b32 v207, 0xffff0000, v59
    v_lshlrev_b32 v208, 16, v60
    v_and_b32 v209, 0xffff0000, v60
    v_lshlrev_b32 v210, 16, v61
    v_and_b32 v211, 0xffff0000, v61
    v_lshlrev_b32 v212, 16, v62
    v_and_b32 v213, 0xffff0000, v62
    v_lshlrev_b32 v214, 16, v63
    v_and_b32 v215, 0xffff0000, v63
    v_lshlrev_b32 v216, 16, v64
    v_and_b32 v217, 0xffff0000, v64
    v_lshlrev_b32 v218, 16, v65
    v_and_b32 v219, 0xffff0000, v65
    v_lshlrev_b32 v220, 16, v66
    v_and_b32 v221, 0xffff0000, v66
    v_lshlrev_b32 v222, 16, v67
    v_and_b32 v223, 0xffff0000, v67
    v_lshlrev_b32 v224, 16, v68
    v_and_b32 v225, 0xffff0000, v68
    v_lshlrev_b32 v226, 16, v69
    v_and_b32 v227, 0xffff0000, v69
    v_lshlrev_b32 v228, 16, v70
    v_and_b32 v229, 0xffff0000, v70
    v_lshlrev_b32 v230, 16, v71
    v_and_b32 v231, 0xffff0000, v71
    s_cmp_lg_u32 s3, 0
    s_cbranch_scc1 Lwic_x
    v_min_u32 v32, 49, v1
    v_cmp_lt_u32 vcc, 7, v32
    s_nop 1
    v_cndmask_b32_e64 v33, 0, 7, vcc
    v_add_lshl_u32 v32, v32, v33, 2
    s_branch Lwic_f
Lwic:
    s_sleep 4
Lwic_f:
    global_load_dword v33, v32, s[36:37] sc1
    s_waitcnt vmcnt(0)
    v_cmp_eq_u32 vcc, 0, v33
    s_add_u32 s100, s100, 1
    s_cmp_ge_u32 s100, 262144
    s_cbranch_scc1 Lwic_x
    s_cbranch_vccnz Lwic
Lwic_x:
    s_waitcnt vmcnt(0)
    s_barrier
    s_sub_u32 s4, s42, 5
    s_cmp_ge_u32 s4, 21
    s_cbranch_scc1 Lwp_n3
    v_lshlrev_b32 v134, 16, v132
    v_and_b32 v135, 0xffff0000, v132
    v_lshlrev_b32 v79, 2, v79
    v_mul_f32 v136, 0xbfb8aa3b, v134
    v_mul_f32 v137, 0xbfb8aa3b, v135
    v_exp_f32 v136, v136
    v_exp_f32 v137, v137
    v_add_f32 v136, 1.0, v136
    v_add_f32 v137, 1.0, v137
    v_rcp_f32 v136, v136
    v_rcp_f32 v137, v137
    v_mul_f32 v134, v134, v136
    v_mul_f32 v135, v135, v137
    v_cvt_pk_bf16_f32 v132, v134, v135
    ds_bpermute_b32 v140, v79, v132 offset:0
    ds_bpermute_b32 v141, v79, v132 offset:32
    ds_bpermute_b32 v142, v79, v132 offset:64
    ds_bpermute_b32 v143, v79, v132 offset:96
    ds_bpermute_b32 v144, v79, v132 offset:128
    s_waitcnt lgkmcnt(4)
    v_lshlrev_b32 v80, 16, v140
    v_and_b32 v81, 0xffff0000, v140
    s_waitcnt lgkmcnt(3)
    v_lshlrev_b32 v82, 16, v141
    v_and_b32 v83, 0xffff0000, v141
    s_waitcnt lgkmcnt(2)
    v_lshlrev_b32 v84, 16, v142
    v_and_b32 v85, 0xffff0000, v142
    s_waitcnt lgkmcnt(1)
    v_lshlrev_b32 v86, 16, v143
    v_and_b32 v87, 0xffff0000, v143
    s_waitcnt lgkmcnt(0)
    v_lshlrev_b32 v88, 16, v144
    v_and_b32 v89, 0xffff0000, v144
    v_lshlrev_b32 v132, 16, v92
    v_and_b32 v133, 0xffff0000, v92
    v_lshlrev_b32 v134, 16, v93
    v_and_b32 v135, 0xffff0000, v93
    v_lshlrev_b32 v136, 16, v94
    v_and_b32 v137, 0xffff0000, v94
    v_lshlrev_b32 v138, 16, v95
    v_and_b32 v139, 0xffff0000, v95
    v_pk_mul_f32 v[140:141], v[80:81], v[132:133] op_sel:[0,0] op_sel_hi:[0,1]
    v_pk_mul_f32 v[142:143], v[80:81], v[134:135] op_sel:[0,0] op_sel_hi:[0,1]
    v_pk_mul_f32 v[144:145], v[80:81], v[136:137] op_sel:[0,0] op_sel_hi:[0,1]
    v_pk_mul_f32 v[146:147], v[80:81], v[138:139] op_sel:[0,0] op_sel_hi:[0,1]
    v_lshlrev_b32 v132, 16, v96
    v_and_b32 v133, 0xffff0000, v96
    v_lshlrev_b32 v134, 16, v97
    v_and_b32 v135, 0xffff0000, v97
    v_lshlrev_b32 v136, 16, v98
    v_and_b32 v137, 0xffff0000, v98
    v_lshlrev_b32 v138, 16, v99
    v_and_b32 v139, 0xffff0000, v99
    v_pk_fma_f32 v[140:141], v[80:81], v[132:133], v[140:141] op_sel:[1,0,0] op_sel_hi:[1,1,1]
    v_pk_fma_f32 v[142:143], v[80:81], v[134:135], v[142:143] op_sel:[1,0,0] op_sel_hi:[1,1,1]
    v_pk_fma_f32 v[144:145], v[80:81], v[136:137], v[144:145] op_sel:[1,0,0] op_sel_hi:[1,1,1]
    v_pk_fma_f32 v[146:147], v[80:81], v[138:139], v[146:147] op_sel:[1,0,0] op_sel_hi:[1,1,1]
    v_lshlrev_b32 v132, 16, v100
    v_and_b32 v133, 0xffff0000, v100
    v_lshlrev_b32 v134, 16, v101
    v_and_b32 v135, 0xffff0000, v101
    v_lshlrev_b32 v136, 16, v102
    v_and_b32 v137, 0xffff0000, v102
    v_lshlrev_b32 v138, 16, v103
    v_and_b32 v139, 0xffff0000, v103
    v_pk_fma_f32 v[140:141], v[82:83], v[132:133], v[140:141] op_sel:[0,0,0] op_sel_hi:[0,1,1]
    v_pk_fma_f32 v[142:143], v[82:83], v[134:135], v[142:143] op_sel:[0,0,0] op_sel_hi:[0,1,1]
    v_pk_fma_f32 v[144:145], v[82:83], v[136:137], v[144:145] op_sel:[0,0,0] op_sel_hi:[0,1,1]
    v_pk_fma_f32 v[146:147], v[82:83], v[138:139], v[146:147] op_sel:[0,0,0] op_sel_hi:[0,1,1]
    v_lshlrev_b32 v132, 16, v104
    v_and_b32 v133, 0xffff0000, v104
    v_lshlrev_b32 v134, 16, v105
    v_and_b32 v135, 0xffff0000, v105
    v_lshlrev_b32 v136, 16, v106
    v_and_b32 v137, 0xffff0000, v106
    v_lshlrev_b32 v138, 16, v107
    v_and_b32 v139, 0xffff0000, v107
    v_pk_fma_f32 v[140:141], v[82:83], v[132:133], v[140:141] op_sel:[1,0,0] op_sel_hi:[1,1,1]
    v_pk_fma_f32 v[142:143], v[82:83], v[134:135], v[142:143] op_sel:[1,0,0] op_sel_hi:[1,1,1]
    v_pk_fma_f32 v[144:145], v[82:83], v[136:137], v[144:145] op_sel:[1,0,0] op_sel_hi:[1,1,1]
    v_pk_fma_f32 v[146:147], v[82:83], v[138:139], v[146:147] op_sel:[1,0,0] op_sel_hi:[1,1,1]
    v_lshlrev_b32 v132, 16, v108
    v_and_b32 v133, 0xffff0000, v108
    v_lshlrev_b32 v134, 16, v109
    v_and_b32 v135, 0xffff0000, v109
    v_lshlrev_b32 v136, 16, v110
    v_and_b32 v137, 0xffff0000, v110
    v_lshlrev_b32 v138, 16, v111
    v_and_b32 v139, 0xffff0000, v111
    v_pk_fma_f32 v[140:141], v[84:85], v[132:133], v[140:141] op_sel:[0,0,0] op_sel_hi:[0,1,1]
    v_pk_fma_f32 v[142:143], v[84:85], v[134:135], v[142:143] op_sel:[0,0,0] op_sel_hi:[0,1,1]
    v_pk_fma_f32 v[144:145], v[84:85], v[136:137], v[144:145] op_sel:[0,0,0] op_sel_hi:[0,1,1]
    v_pk_fma_f32 v[146:147], v[84:85], v[138:139], v[146:147] op_sel:[0,0,0] op_sel_hi:[0,1,1]
    v_lshlrev_b32 v132, 16, v112
    v_and_b32 v133, 0xffff0000, v112
    v_lshlrev_b32 v134, 16, v113
    v_and_b32 v135, 0xffff0000, v113
    v_lshlrev_b32 v136, 16, v114
    v_and_b32 v137, 0xffff0000, v114
    v_lshlrev_b32 v138, 16, v115
    v_and_b32 v139, 0xffff0000, v115
    v_pk_fma_f32 v[140:141], v[84:85], v[132:133], v[140:141] op_sel:[1,0,0] op_sel_hi:[1,1,1]
    v_pk_fma_f32 v[142:143], v[84:85], v[134:135], v[142:143] op_sel:[1,0,0] op_sel_hi:[1,1,1]
    v_pk_fma_f32 v[144:145], v[84:85], v[136:137], v[144:145] op_sel:[1,0,0] op_sel_hi:[1,1,1]
    v_pk_fma_f32 v[146:147], v[84:85], v[138:139], v[146:147] op_sel:[1,0,0] op_sel_hi:[1,1,1]
    v_lshlrev_b32 v132, 16, v116
    v_and_b32 v133, 0xffff0000, v116
    v_lshlrev_b32 v134, 16, v117
    v_and_b32 v135, 0xffff0000, v117
    v_lshlrev_b32 v136, 16, v118
    v_and_b32 v137, 0xffff0000, v118
    v_lshlrev_b32 v138, 16, v119
    v_and_b32 v139, 0xffff0000, v119
    v_pk_fma_f32 v[140:141], v[86:87], v[132:133], v[140:141] op_sel:[0,0,0] op_sel_hi:[0,1,1]
    v_pk_fma_f32 v[142:143], v[86:87], v[134:135], v[142:143] op_sel:[0,0,0] op_sel_hi:[0,1,1]
    v_pk_fma_f32 v[144:145], v[86:87], v[136:137], v[144:145] op_sel:[0,0,0] op_sel_hi:[0,1,1]
    v_pk_fma_f32 v[146:147], v[86:87], v[138:139], v[146:147] op_sel:[0,0,0] op_sel_hi:[0,1,1]
    v_lshlrev_b32 v132, 16, v120
    v_and_b32 v133, 0xffff0000, v120
    v_lshlrev_b32 v134, 16, v121
    v_and_b32 v135, 0xffff0000, v121
    v_lshlrev_b32 v136, 16, v122
    v_and_b32 v137, 0xffff0000, v122
    v_lshlrev_b32 v138, 16, v123
    v_and_b32 v139, 0xffff0000, v123
    v_pk_fma_f32 v[140:141], v[86:87], v[132:133], v[140:141] op_sel:[1,0,0] op_sel_hi:[1,1,1]
    v_pk_fma_f32 v[142:143], v[86:87], v[134:135], v[142:143] op_sel:[1,0,0] op_sel_hi:[1,1,1]
    v_pk_fma_f32 v[144:145], v[86:87], v[136:137], v[144:145] op_sel:[1,0,0] op_sel_hi:[1,1,1]
    v_pk_fma_f32 v[146:147], v[86:87], v[138:139], v[146:147] op_sel:[1,0,0] op_sel_hi:[1,1,1]
    v_lshlrev_b32 v132, 16, v124
    v_and_b32 v133, 0xffff0000, v124
    v_lshlrev_b32 v134, 16, v125
    v_and_b32 v135, 0xffff0000, v125
    v_lshlrev_b32 v136, 16, v126
    v_and_b32 v137, 0xffff0000, v126
    v_lshlrev_b32 v138, 16, v127
    v_and_b32 v139, 0xffff0000, v127
    v_pk_fma_f32 v[140:141], v[88:89], v[132:133], v[140:141] op_sel:[0,0,0] op_sel_hi:[0,1,1]
    v_pk_fma_f32 v[142:143], v[88:89], v[134:135], v[142:143] op_sel:[0,0,0] op_sel_hi:[0,1,1]
    v_pk_fma_f32 v[144:145], v[88:89], v[136:137], v[144:145] op_sel:[0,0,0] op_sel_hi:[0,1,1]
    v_pk_fma_f32 v[146:147], v[88:89], v[138:139], v[146:147] op_sel:[0,0,0] op_sel_hi:[0,1,1]
    v_lshlrev_b32 v132, 16, v128
    v_and_b32 v133, 0xffff0000, v128
    v_lshlrev_b32 v134, 16, v129
    v_and_b32 v135, 0xffff0000, v129
    v_lshlrev_b32 v136, 16, v130
    v_and_b32 v137, 0xffff0000, v130
    v_lshlrev_b32 v138, 16, v131
    v_and_b32 v139, 0xffff0000, v131
    v_pk_fma_f32 v[140:141], v[88:89], v[132:133], v[140:141] op_sel:[1,0,0] op_sel_hi:[1,1,1]
    v_pk_fma_f32 v[142:143], v[88:89], v[134:135], v[142:143] op_sel:[1,0,0] op_sel_hi:[1,1,1]
    v_pk_fma_f32 v[144:145], v[88:89], v[136:137], v[144:145] op_sel:[1,0,0] op_sel_hi:[1,1,1]
    v_pk_fma_f32 v[146:147], v[88:89], v[138:139], v[146:147] op_sel:[1,0,0] op_sel_hi:[1,1,1]
    s_nop 0
    v_permlane32_swap_b32 v140, v144
    v_permlane32_swap_b32 v141, v145
    v_permlane32_swap_b32 v142, v146
    v_permlane32_swap_b32 v143, v147
    v_add_f32 v140, v140, v144
    v_add_f32 v141, v141, v145
    v_add_f32 v142, v142, v146
    v_add_f32 v143, v143, v147
    s_nop 0
    v_permlane16_swap_b32 v140, v142
    v_permlane16_swap_b32 v141, v143
    v_add_f32 v140, v140, v142
    v_add_f32 v141, v141, v143
    v_and_b32 v133, 7, v1
    v_lshrrev_b32 v134, 3, v1
    v_add_f32_dpp v132, v140, v140 row_ror:8 row_mask:0xf bank_mask:0x3
    s_nop 1
    v_add_f32_dpp v132, v141, v141 row_ror:8 row_mask:0xf bank_mask:0xc
    v_lshl_add_u32 v133, v133, 3, v134
    s_lshl_b32 s7, s3, 8
    s_add_u32 s7, s7, 122880
    v_lshl_add_u32 v133, v133, 2, s7
    ds_write_b32 v133, v132
    s_waitcnt lgkmcnt(0)
    s_barrier
    v_lshlrev_b32 v133, 2, v1
    v_add_u32 v134, 122880, v133
    ds_read_b32 v140, v134 offset:0
    ds_read_b32 v141, v134 offset:256
    ds_read_b32 v142, v134 offset:512
    ds_read_b32 v143, v134 offset:768
    v_add_u32 v133, s47, v133
    s_waitcnt lgkmcnt(2)
    v_add_f32 v140, v140, v141
    s_waitcnt lgkmcnt(0)
    v_add_f32 v142, v142, v143
    v_add_f32 v140, v140, v142
    v_min_u32 v140, -2, v140
    s_cmp_lg_u32 s3, 0
    s_cbranch_scc1 Lmod_skip_w
    global_store_dword v133, v140, s[38:39] offset:0 sc1
Lmod_skip_w:
Lwp_n3:
    s_branch Lwm_f
Lwm:
    s_sleep 4
Lwm_f:
    v_add_u32 v77, 0, v73
    global_load_dwordx4 v[80:83], v77, s[38:39] sc1
    global_load_dwordx4 v[84:87], v77, s[38:39] offset:2560 sc1
    v_add_u32 v77, 15360, v73
    global_load_dwordx4 v[88:91], v77, s[38:39] sc1
    global_load_dwordx4 v[92:95], v77, s[38:39] offset:2560 sc1
    s_waitcnt vmcnt(0)
    v_max_u32 v77, v80, v81
    v_max3_u32 v77, v82, v83, v77
    v_max3_u32 v77, v84, v85, v77
    v_max3_u32 v77, v86, v87, v77
    v_max3_u32 v77, v88, v89, v77
    v_max3_u32 v77, v90, v91, v77
    v_max3_u32 v77, v92, v93, v77
    v_max3_u32 v77, v94, v95, v77
    v_cmp_eq_u32 vcc, -1, v77
    s_add_u32 s100, s100, 1
    s_cmp_ge_u32 s100, 262144
    s_cbranch_scc1 Lwm_x
    s_cbranch_vccnz Lwm
Lwm_x:
    v_pk_add_f32 v[80:81], v[80:81], v[88:89] op_sel:[0,0] op_sel_hi:[1,1]
    v_pk_add_f32 v[82:83], v[82:83], v[90:91] op_sel:[0,0] op_sel_hi:[1,1]
    v_pk_add_f32 v[84:85], v[84:85], v[92:93] op_sel:[0,0] op_sel_hi:[1,1]
    v_pk_add_f32 v[86:87], v[86:87], v[94:95] op_sel:[0,0] op_sel_hi:[1,1]
    v_cvt_pk_bf16_f32 v80, v80, v80
    v_lshlrev_b32 v80, 16, v80
    v_cvt_pk_bf16_f32 v81, v81, v81
    v_lshlrev_b32 v81, 16, v81
    v_cvt_pk_bf16_f32 v82, v82, v82
    v_lshlrev_b32 v82, 16, v82
    v_cvt_pk_bf16_f32 v83, v83, v83
    v_lshlrev_b32 v83, 16, v83
    v_cvt_pk_bf16_f32 v84, v84, v84
    v_lshlrev_b32 v84, 16, v84
    v_cvt_pk_bf16_f32 v85, v85, v85
    v_lshlrev_b32 v85, 16, v85
    v_cvt_pk_bf16_f32 v86, v86, v86
    v_lshlrev_b32 v86, 16, v86
    v_cvt_pk_bf16_f32 v87, v87, v87
    v_lshlrev_b32 v87, 16, v87
    v_add_f32 v84, 1.0, v84
    v_add_f32 v85, 1.0, v85
    v_add_f32 v86, 1.0, v86
    v_add_f32 v87, 1.0, v87
    v_cvt_pk_bf16_f32 v84, v84, v84
    v_lshlrev_b32 v84, 16, v84
    v_cvt_pk_bf16_f32 v85, v85, v85
    v_lshlrev_b32 v85, 16, v85
    v_cvt_pk_bf16_f32 v86, v86, v86
    v_lshlrev_b32 v86, 16, v86
    v_cvt_pk_bf16_f32 v87, v87, v87
    v_lshlrev_b32 v87, 16, v87
    ds_write_b128 v72, v[84:87]
    ds_write_b128 v72, v[80:83] offset:640
    ds_read_b128 v[32:35], v74 offset:0
    ds_read_b128 v[36:39], v74 offset:16
    ds_read_b128 v[40:43], v74 offset:128
    ds_read_b128 v[44:47], v74 offset:144
    ds_read_b128 v[48:51], v74 offset:256
    ds_read_b128 v[52:55], v74 offset:272
    ds_read_b128 v[56:59], v74 offset:384
    ds_read_b128 v[60:63], v74 offset:400
    ds_read_b128 v[64:67], v74 offset:512
    ds_read_b128 v[68:71], v74 offset:528
    s_waitcnt lgkmcnt(9)
    v_pk_mul_f32 v[96:97], v[32:33], v[152:153] op_sel:[0,0] op_sel_hi:[0,1]
    v_pk_mul_f32 v[98:99], v[32:33], v[154:155] op_sel:[1,0] op_sel_hi:[1,1]
    v_pk_mul_f32 v[100:101], v[34:35], v[156:157] op_sel:[0,0] op_sel_hi:[0,1]
    v_pk_mul_f32 v[102:103], v[34:35], v[158:159] op_sel:[1,0] op_sel_hi:[1,1]
    s_waitcnt lgkmcnt(8)
    v_pk_mul_f32 v[104:105], v[36:37], v[160:161] op_sel:[0,0] op_sel_hi:[0,1]
    v_pk_mul_f32 v[106:107], v[36:37], v[162:163] op_sel:[1,0] op_sel_hi:[1,1]
    v_pk_mul_f32 v[108:109], v[38:39], v[164:165] op_sel:[0,0] op_sel_hi:[0,1]
    v_pk_mul_f32 v[110:111], v[38:39], v[166:167] op_sel:[1,0] op_sel_hi:[1,1]
    v_cvt_pk_bf16_f32 v112, v96, v98
    v_cvt_pk_bf16_f32 v113, v100, v102
    v_cvt_pk_bf16_f32 v114, v104, v106
    v_cvt_pk_bf16_f32 v115, v108, v110
    v_cvt_pk_bf16_f32 v116, v97, v99
    v_cvt_pk_bf16_f32 v117, v101, v103
    v_cvt_pk_bf16_f32 v118, v105, v107
    v_cvt_pk_bf16_f32 v119, v109, v111
    global_store_dwordx4 v75, v[112:115], s[38:39] offset:-2048 sc1
    global_store_dwordx4 v76, v[116:119], s[38:39] offset:-2048 sc1
    s_waitcnt lgkmcnt(1)
    v_pk_mul_f32 v[96:97], v[40:41], v[168:169] op_sel:[0,0] op_sel_hi:[0,1]
    v_pk_mul_f32 v[98:99], v[40:41], v[170:171] op_sel:[1,0] op_sel_hi:[1,1]
    v_pk_mul_f32 v[100:101], v[42:43], v[172:173] op_sel:[0,0] op_sel_hi:[0,1]
    v_pk_mul_f32 v[102:103], v[42:43], v[174:175] op_sel:[1,0] op_sel_hi:[1,1]
    v_pk_mul_f32 v[104:105], v[44:45], v[176:177] op_sel:[0,0] op_sel_hi:[0,1]
    v_pk_mul_f32 v[106:107], v[44:45], v[178:179] op_sel:[1,0] op_sel_hi:[1,1]
    v_pk_mul_f32 v[108:109], v[46:47], v[180:181] op_sel:[0,0] op_sel_hi:[0,1]
    v_pk_mul_f32 v[110:111], v[46:47], v[182:183] op_sel:[1,0] op_sel_hi:[1,1]
    v_cvt_pk_bf16_f32 v120, v96, v98
    v_cvt_pk_bf16_f32 v121, v100, v102
    v_cvt_pk_bf16_f32 v122, v104, v106
    v_cvt_pk_bf16_f32 v123, v108, v110
    v_cvt_pk_bf16_f32 v124, v97, v99
    v_cvt_pk_bf16_f32 v125, v101, v103
    v_cvt_pk_bf16_f32 v126, v105, v107
    v_cvt_pk_bf16_f32 v127, v109, v111
    global_store_dwordx4 v75, v[120:123], s[38:39] offset:-1024 sc1
    global_store_dwordx4 v76, v[124:127], s[38:39] offset:-1024 sc1
    v_pk_mul_f32 v[96:97], v[48:49], v[184:185] op_sel:[0,0] op_sel_hi:[0,1]
    v_pk_mul_f32 v[98:99], v[48:49], v[186:187] op_sel:[1,0] op_sel_hi:[1,1]
    v_pk_mul_f32 v[100:101], v[50:51], v[188:189] op_sel:[0,0] op_sel_hi:[0,1]
    v_pk_mul_f32 v[102:103], v[50:51], v[190:191] op_sel:[1,0] op_sel_hi:[1,1]
    v_pk_mul_f32 v[104:105], v[52:53], v[192:193] op_sel:[0,0] op_sel_hi:[0,1]
    v_pk_mul_f32 v[106:107], v[52:53], v[194:195] op_sel:[1,0] op_sel_hi:[1,1]
    v_pk_mul_f32 v[108:109], v[54:55], v[196:197] op_sel:[0,0] op_sel_hi:[0,1]
    v_pk_mul_f32 v[110:111], v[54:55], v[198:199] op_sel:[1,0] op_sel_hi:[1,1]
    v_cvt_pk_bf16_f32 v128, v96, v98
    v_cvt_pk_bf16_f32 v129, v100, v102
    v_cvt_pk_bf16_f32 v130, v104, v106
    v_cvt_pk_bf16_f32 v131, v108, v110
    v_cvt_pk_bf16_f32 v132, v97, v99
    v_cvt_pk_bf16_f32 v133, v101, v103
    v_cvt_pk_bf16_f32 v134, v105, v107
    v_cvt_pk_bf16_f32 v135, v109, v111
    global_store_dwordx4 v75, v[128:131], s[38:39] offset:0 sc1
    global_store_dwordx4 v76, v[132:135], s[38:39] offset:0 sc1
    v_pk_mul_f32 v[96:97], v[56:57], v[200:201] op_sel:[0,0] op_sel_hi:[0,1]
    v_pk_mul_f32 v[98:99], v[56:57], v[202:203] op_sel:[1,0] op_sel_hi:[1,1]
    v_pk_mul_f32 v[100:101], v[58:59], v[204:205] op_sel:[0,0] op_sel_hi:[0,1]
    v_pk_mul_f32 v[102:103], v[58:59], v[206:207] op_sel:[1,0] op_sel_hi:[1,1]
    v_pk_mul_f32 v[104:105], v[60:61], v[208:209] op_sel:[0,0] op_sel_hi:[0,1]
    v_pk_mul_f32 v[106:107], v[60:61], v[210:211] op_sel:[1,0] op_sel_hi:[1,1]
    v_pk_mul_f32 v[108:109], v[62:63], v[212:213] op_sel:[0,0] op_sel_hi:[0,1]
    v_pk_mul_f32 v[110:111], v[62:63], v[214:215] op_sel:[1,0] op_sel_hi:[1,1]
    v_cvt_pk_bf16_f32 v136, v96, v98
    v_cvt_pk_bf16_f32 v137, v100, v102
    v_cvt_pk_bf16_f32 v138, v104, v106
    v_cvt_pk_bf16_f32 v139, v108, v110
    v_cvt_pk_bf16_f32 v140, v97, v99
    v_cvt_pk_bf16_f32 v141, v101, v103
    v_cvt_pk_bf16_f32 v142, v105, v107
    v_cvt_pk_bf16_f32 v143, v109, v111
    global_store_dwordx4 v75, v[136:139], s[38:39] offset:1024 sc1
    global_store_dwordx4 v76, v[140:143], s[38:39] offset:1024 sc1
    v_pk_mul_f32 v[96:97], v[64:65], v[216:217] op_sel:[0,0] op_sel_hi:[0,1]
    v_pk_mul_f32 v[98:99], v[64:65], v[218:219] op_sel:[1,0] op_sel_hi:[1,1]
    v_pk_mul_f32 v[100:101], v[66:67], v[220:221] op_sel:[0,0] op_sel_hi:[0,1]
    v_pk_mul_f32 v[102:103], v[66:67], v[222:223] op_sel:[1,0] op_sel_hi:[1,1]
    s_waitcnt lgkmcnt(0)
    v_pk_mul_f32 v[104:105], v[68:69], v[224:225] op_sel:[0,0] op_sel_hi:[0,1]
    v_pk_mul_f32 v[106:107], v[68:69], v[226:227] op_sel:[1,0] op_sel_hi:[1,1]
    v_pk_mul_f32 v[108:109], v[70:71], v[228:229] op_sel:[0,0] op_sel_hi:[0,1]
    v_pk_mul_f32 v[110:111], v[70:71], v[230:231] op_sel:[1,0] op_sel_hi:[1,1]
    v_cvt_pk_bf16_f32 v144, v96, v98
    v_cvt_pk_bf16_f32 v145, v100, v102
    v_cvt_pk_bf16_f32 v146, v104, v106
    v_cvt_pk_bf16_f32 v147, v108, v110
    v_cvt_pk_bf16_f32 v148, v97, v99
    v_cvt_pk_bf16_f32 v149, v101, v103
    v_cvt_pk_bf16_f32 v150, v105, v107
    v_cvt_pk_bf16_f32 v151, v109, v111
    global_store_dwordx4 v75, v[144:147], s[38:39] offset:2048 sc1
    global_store_dwordx4 v76, v[148:151], s[38:39] offset:2048 sc1
    ds_read_b128 v[32:35], v74 offset:640
    ds_read_b128 v[36:39], v74 offset:656
    ds_read_b128 v[40:43], v74 offset:768
    ds_read_b128 v[44:47], v74 offset:784
    ds_read_b128 v[48:51], v74 offset:896
    ds_read_b128 v[52:55], v74 offset:912
    ds_read_b128 v[56:59], v74 offset:1024
    ds_read_b128 v[60:63], v74 offset:1040
    ds_read_b128 v[64:67], v74 offset:1152
    ds_read_b128 v[68:71], v74 offset:1168
    s_mov_b32 s7, 0x3f803f80
    v_mov_b32 v88, 0
    v_mov_b32 v89, 0
    v_mov_b32 v90, 0
    v_mov_b32 v91, 0
    v_mov_b32 v92, 0
    v_mov_b32 v93, 0
    v_mov_b32 v94, 0
    v_mov_b32 v95, 0
    v_dot2_f32_bf16 v88, v112, s7, v88
    v_dot2_f32_bf16 v89, v116, s7, v89
    v_dot2_f32_bf16 v88, v113, s7, v88
    v_dot2_f32_bf16 v89, v117, s7, v89
    v_dot2_f32_bf16 v88, v114, s7, v88
    v_dot2_f32_bf16 v89, v118, s7, v89
    v_dot2_f32_bf16 v88, v115, s7, v88
    v_dot2_f32_bf16 v89, v119, s7, v89
    v_dot2_f32_bf16 v88, v120, s7, v88
    v_dot2_f32_bf16 v89, v124, s7, v89
    v_dot2_f32_bf16 v88, v121, s7, v88
    v_dot2_f32_bf16 v89, v125, s7, v89
    v_dot2_f32_bf16 v88, v122, s7, v88
    v_dot2_f32_bf16 v89, v126, s7, v89
    v_dot2_f32_bf16 v88, v123, s7, v88
    v_dot2_f32_bf16 v89, v127, s7, v89
    v_dot2_f32_bf16 v88, v128, s7, v88
    v_dot2_f32_bf16 v89, v132, s7, v89
    v_dot2_f32_bf16 v88, v129, s7, v88
    v_dot2_f32_bf16 v89, v133, s7, v89
    v_dot2_f32_bf16 v88, v130, s7, v88
    v_dot2_f32_bf16 v89, v134, s7, v89
    v_dot2_f32_bf16 v88, v131, s7, v88
    v_dot2_f32_bf16 v89, v135, s7, v89
    v_dot2_f32_bf16 v88, v136, s7, v88
    v_dot2_f32_bf16 v89, v140, s7, v89
    v_dot2_f32_bf16 v88, v137, s7, v88
    v_dot2_f32_bf16 v89, v141, s7, v89
    v_dot2_f32_bf16 v88, v138, s7, v88
    v_dot2_f32_bf16 v89, v142, s7, v89
    v_dot2_f32_bf16 v88, v139, s7, v88
    v_dot2_f32_bf16 v89, v143, s7, v89
    v_dot2_f32_bf16 v88, v144, s7, v88
    v_dot2_f32_bf16 v89, v148, s7, v89
    v_dot2_f32_bf16 v88, v145, s7, v88
    v_dot2_f32_bf16 v89, v149, s7, v89
    v_dot2_f32_bf16 v88, v146, s7, v88
    v_dot2_f32_bf16 v89, v150, s7, v89
    v_dot2_f32_bf16 v88, v147, s7, v88
    v_dot2_f32_bf16 v89, v151, s7, v89
    s_waitcnt lgkmcnt(0)
    v_pk_fma_f32 v[90:91], v[32:33], v[152:153], v[90:91] op_sel:[0,0,0] op_sel_hi:[0,1,1]
    v_pk_fma_f32 v[92:93], v[32:33], v[154:155], v[92:93] op_sel:[1,0,0] op_sel_hi:[1,1,1]
    v_pk_fma_f32 v[94:95], v[34:35], v[156:157], v[94:95] op_sel:[0,0,0] op_sel_hi:[0,1,1]
    v_pk_fma_f32 v[90:91], v[34:35], v[158:159], v[90:91] op_sel:[1,0,0] op_sel_hi:[1,1,1]
    v_pk_fma_f32 v[92:93], v[36:37], v[160:161], v[92:93] op_sel:[0,0,0] op_sel_hi:[0,1,1]
    v_pk_fma_f32 v[94:95], v[36:37], v[162:163], v[94:95] op_sel:[1,0,0] op_sel_hi:[1,1,1]
    v_pk_fma_f32 v[90:91], v[38:39], v[164:165], v[90:91] op_sel:[0,0,0] op_sel_hi:[0,1,1]
    v_pk_fma_f32 v[92:93], v[38:39], v[166:167], v[92:93] op_sel:[1,0,0] op_sel_hi:[1,1,1]
    v_pk_fma_f32 v[94:95], v[40:41], v[168:169], v[94:95] op_sel:[0,0,0] op_sel_hi:[0,1,1]
    v_pk_fma_f32 v[90:91], v[40:41], v[170:171], v[90:91] op_sel:[1,0,0] op_sel_hi:[1,1,1]
    v_pk_fma_f32 v[92:93], v[42:43], v[172:173], v[92:93] op_sel:[0,0,0] op_sel_hi:[0,1,1]
    v_pk_fma_f32 v[94:95], v[42:43], v[174:175], v[94:95] op_sel:[1,0,0] op_sel_hi:[1,1,1]
    v_pk_fma_f32 v[90:91], v[44:45], v[176:177], v[90:91] op_sel:[0,0,0] op_sel_hi:[0,1,1]
    v_pk_fma_f32 v[92:93], v[44:45], v[178:179], v[92:93] op_sel:[1,0,0] op_sel_hi:[1,1,1]
    v_pk_fma_f32 v[94:95], v[46:47], v[180:181], v[94:95] op_sel:[0,0,0] op_sel_hi:[0,1,1]
    v_pk_fma_f32 v[90:91], v[46:47], v[182:183], v[90:91] op_sel:[1,0,0] op_sel_hi:[1,1,1]
    v_pk_fma_f32 v[92:93], v[48:49], v[184:185], v[92:93] op_sel:[0,0,0] op_sel_hi:[0,1,1]
    v_pk_fma_f32 v[94:95], v[48:49], v[186:187], v[94:95] op_sel:[1,0,0] op_sel_hi:[1,1,1]
    v_pk_fma_f32 v[90:91], v[50:51], v[188:189], v[90:91] op_sel:[0,0,0] op_sel_hi:[0,1,1]
    v_pk_fma_f32 v[92:93], v[50:51], v[190:191], v[92:93] op_sel:[1,0,0] op_sel_hi:[1,1,1]
    v_pk_fma_f32 v[94:95], v[52:53], v[192:193], v[94:95] op_sel:[0,0,0] op_sel_hi:[0,1,1]
    v_pk_fma_f32 v[90:91], v[52:53], v[194:195], v[90:91] op_sel:[1,0,0] op_sel_hi:[1,1,1]
    v_pk_fma_f32 v[92:93], v[54:55], v[196:197], v[92:93] op_sel:[0,0,0] op_sel_hi:[0,1,1]
    v_pk_fma_f32 v[94:95], v[54:55], v[198:199], v[94:95] op_sel:[1,0,0] op_sel_hi:[1,1,1]
    v_pk_fma_f32 v[90:91], v[56:57], v[200:201], v[90:91] op_sel:[0,0,0] op_sel_hi:[0,1,1]
    v_pk_fma_f32 v[92:93], v[56:57], v[202:203], v[92:93] op_sel:[1,0,0] op_sel_hi:[1,1,1]
    v_pk_fma_f32 v[94:95], v[58:59], v[204:205], v[94:95] op_sel:[0,0,0] op_sel_hi:[0,1,1]
    v_pk_fma_f32 v[90:91], v[58:59], v[206:207], v[90:91] op_sel:[1,0,0] op_sel_hi:[1,1,1]
    v_pk_fma_f32 v[92:93], v[60:61], v[208:209], v[92:93] op_sel:[0,0,0] op_sel_hi:[0,1,1]
    v_pk_fma_f32 v[94:95], v[60:61], v[210:211], v[94:95] op_sel:[1,0,0] op_sel_hi:[1,1,1]
    v_pk_fma_f32 v[90:91], v[62:63], v[212:213], v[90:91] op_sel:[0,0,0] op_sel_hi:[0,1,1]
    v_pk_fma_f32 v[92:93], v[62:63], v[214:215], v[92:93] op_sel:[1,0,0] op_sel_hi:[1,1,1]
    v_pk_fma_f32 v[94:95], v[64:65], v[216:217], v[94:95] op_sel:[0,0,0] op_sel_hi:[0,1,1]
    v_pk_fma_f32 v[90:91], v[64:65], v[218:219], v[90:91] op_sel:[1,0,0] op_sel_hi:[1,1,1]
    v_pk_fma_f32 v[92:93], v[66:67], v[220:221], v[92:93] op_sel:[0,0,0] op_sel_hi:[0,1,1]
    v_pk_fma_f32 v[94:95], v[66:67], v[222:223], v[94:95] op_sel:[1,0,0] op_sel_hi:[1,1,1]
    v_pk_fma_f32 v[90:91], v[68:69], v[224:225], v[90:91] op_sel:[0,0,0] op_sel_hi:[0,1,1]
    v_pk_fma_f32 v[92:93], v[68:69], v[226:227], v[92:93] op_sel:[1,0,0] op_sel_hi:[1,1,1]
    v_pk_fma_f32 v[94:95], v[70:71], v[228:229], v[94:95] op_sel:[0,0,0] op_sel_hi:[0,1,1]
    v_pk_fma_f32 v[90:91], v[70:71], v[230:231], v[90:91] op_sel:[1,0,0] op_sel_hi:[1,1,1]
    v_pk_add_f32 v[90:91], v[90:91], v[92:93] op_sel:[0,0] op_sel_hi:[1,1]
    v_pk_add_f32 v[90:91], v[90:91], v[94:95] op_sel:[0,0] op_sel_hi:[1,1]
    v_permlane32_swap_b32 v88, v89
    s_nop 0
    v_permlane32_swap_b32 v90, v91
    v_add_f32 v88, v88, v89
    v_add_f32 v90, v90, v91
    s_nop 1
    v_permlane16_swap_b32 v88, v90
    v_add_f32 v88, v88, v90
    v_lshlrev_b32 v74, 2, v0
    v_add_u32 v74, 131072, v74
    ds_write_b32 v74, v88
    v_xor_b32 v74, 256, v74
    s_waitcnt vmcnt(0) lgkmcnt(0)
    s_barrier
    ds_read_b32 v89, v74
    s_lshl_b32 s6, s46, 7
    s_lshr_b32 s5, s44, 1
    s_mul_i32 s5, s5, 14336
    s_add_u32 s6, s6, s5
    s_add_u32 s6, s6, 49152
    v_lshl_add_u32 v74, v1, 2, s6
    s_waitcnt lgkmcnt(0)
    v_add_f32 v88, v88, v89
    v_min_u32 v88, -2, v88
    s_bitcmp1_b32 s3, 0
    s_cbranch_scc1 Lwp_skip
    global_store_dword v74, v88, s[38:39] sc1
Lwp_skip:
    s_branch Lsp_c
Lsp_b3:
    v_lshlrev_b32 v82, 16, v80
    v_and_b32 v83, 0xffff0000, v80
    v_lshlrev_b32 v29, 2, v29
    v_mul_f32 v84, 0xbfb8aa3b, v82
    v_mul_f32 v85, 0xbfb8aa3b, v83
    v_exp_f32 v84, v84
    v_exp_f32 v85, v85
    v_add_f32 v84, 1.0, v84
    v_add_f32 v85, 1.0, v85
    v_rcp_f32 v84, v84
    v_rcp_f32 v85, v85
    v_mul_f32 v82, v82, v84
    v_mul_f32 v83, v83, v85
    v_cvt_pk_bf16_f32 v80, v82, v83
    ds_bpermute_b32 v88, v29, v80 offset:0
    ds_bpermute_b32 v89, v29, v80 offset:32
    ds_bpermute_b32 v90, v29, v80 offset:64
    ds_bpermute_b32 v91, v29, v80 offset:96
    ds_bpermute_b32 v92, v29, v80 offset:128
    s_waitcnt lgkmcnt(4)
    v_lshlrev_b32 v30, 16, v88
    v_and_b32 v31, 0xffff0000, v88
    s_waitcnt lgkmcnt(3)
    v_lshlrev_b32 v32, 16, v89
    v_and_b32 v33, 0xffff0000, v89
    s_waitcnt lgkmcnt(2)
    v_lshlrev_b32 v34, 16, v90
    v_and_b32 v35, 0xffff0000, v90
    s_waitcnt lgkmcnt(1)
    v_lshlrev_b32 v36, 16, v91
    v_and_b32 v37, 0xffff0000, v91
    s_waitcnt lgkmcnt(0)
    v_lshlrev_b32 v38, 16, v92
    v_and_b32 v39, 0xffff0000, v92
    v_lshlrev_b32 v80, 16, v40
    v_and_b32 v81, 0xffff0000, v40
    v_lshlrev_b32 v82, 16, v41
    v_and_b32 v83, 0xffff0000, v41
    v_lshlrev_b32 v84, 16, v42
    v_and_b32 v85, 0xffff0000, v42
    v_lshlrev_b32 v86, 16, v43
    v_and_b32 v87, 0xffff0000, v43
    v_pk_mul_f32 v[88:89], v[30:31], v[80:81] op_sel:[0,0] op_sel_hi:[0,1]
    v_pk_mul_f32 v[90:91], v[30:31], v[82:83] op_sel:[0,0] op_sel_hi:[0,1]
    v_pk_mul_f32 v[92:93], v[30:31], v[84:85] op_sel:[0,0] op_sel_hi:[0,1]
    v_pk_mul_f32 v[94:95], v[30:31], v[86:87] op_sel:[0,0] op_sel_hi:[0,1]
    v_lshlrev_b32 v80, 16, v44
    v_and_b32 v81, 0xffff0000, v44
    v_lshlrev_b32 v82, 16, v45
    v_and_b32 v83, 0xffff0000, v45
    v_lshlrev_b32 v84, 16, v46
    v_and_b32 v85, 0xffff0000, v46
    v_lshlrev_b32 v86, 16, v47
    v_and_b32 v87, 0xffff0000, v47
    v_pk_fma_f32 v[88:89], v[30:31], v[80:81], v[88:89] op_sel:[1,0,0] op_sel_hi:[1,1,1]
    v_pk_fma_f32 v[90:91], v[30:31], v[82:83], v[90:91] op_sel:[1,0,0] op_sel_hi:[1,1,1]
    v_pk_fma_f32 v[92:93], v[30:31], v[84:85], v[92:93] op_sel:[1,0,0] op_sel_hi:[1,1,1]
    v_pk_fma_f32 v[94:95], v[30:31], v[86:87], v[94:95] op_sel:[1,0,0] op_sel_hi:[1,1,1]
    v_lshlrev_b32 v80, 16, v48
    v_and_b32 v81, 0xffff0000, v48
    v_lshlrev_b32 v82, 16, v49
    v_and_b32 v83, 0xffff0000, v49
    v_lshlrev_b32 v84, 16, v50
    v_and_b32 v85, 0xffff0000, v50
    v_lshlrev_b32 v86, 16, v51
    v_and_b32 v87, 0xffff0000, v51
    v_pk_fma_f32 v[88:89], v[32:33], v[80:81], v[88:89] op_sel:[0,0,0] op_sel_hi:[0,1,1]
    v_pk_fma_f32 v[90:91], v[32:33], v[82:83], v[90:91] op_sel:[0,0,0] op_sel_hi:[0,1,1]
    v_pk_fma_f32 v[92:93], v[32:33], v[84:85], v[92:93] op_sel:[0,0,0] op_sel_hi:[0,1,1]
    v_pk_fma_f32 v[94:95], v[32:33], v[86:87], v[94:95] op_sel:[0,0,0] op_sel_hi:[0,1,1]
    v_lshlrev_b32 v80, 16, v52
    v_and_b32 v81, 0xffff0000, v52
    v_lshlrev_b32 v82, 16, v53
    v_and_b32 v83, 0xffff0000, v53
    v_lshlrev_b32 v84, 16, v54
    v_and_b32 v85, 0xffff0000, v54
    v_lshlrev_b32 v86, 16, v55
    v_and_b32 v87, 0xffff0000, v55
    v_pk_fma_f32 v[88:89], v[32:33], v[80:81], v[88:89] op_sel:[1,0,0] op_sel_hi:[1,1,1]
    v_pk_fma_f32 v[90:91], v[32:33], v[82:83], v[90:91] op_sel:[1,0,0] op_sel_hi:[1,1,1]
    v_pk_fma_f32 v[92:93], v[32:33], v[84:85], v[92:93] op_sel:[1,0,0] op_sel_hi:[1,1,1]
    v_pk_fma_f32 v[94:95], v[32:33], v[86:87], v[94:95] op_sel:[1,0,0] op_sel_hi:[1,1,1]
    v_lshlrev_b32 v80, 16, v56
    v_and_b32 v81, 0xffff0000, v56
    v_lshlrev_b32 v82, 16, v57
    v_and_b32 v83, 0xffff0000, v57
    v_lshlrev_b32 v84, 16, v58
    v_and_b32 v85, 0xffff0000, v58
    v_lshlrev_b32 v86, 16, v59
    v_and_b32 v87, 0xffff0000, v59
    v_pk_fma_f32 v[88:89], v[34:35], v[80:81], v[88:89] op_sel:[0,0,0] op_sel_hi:[0,1,1]
    v_pk_fma_f32 v[90:91], v[34:35], v[82:83], v[90:91] op_sel:[0,0,0] op_sel_hi:[0,1,1]
    v_pk_fma_f32 v[92:93], v[34:35], v[84:85], v[92:93] op_sel:[0,0,0] op_sel_hi:[0,1,1]
    v_pk_fma_f32 v[94:95], v[34:35], v[86:87], v[94:95] op_sel:[0,0,0] op_sel_hi:[0,1,1]
    v_lshlrev_b32 v80, 16, v60
    v_and_b32 v81, 0xffff0000, v60
    v_lshlrev_b32 v82, 16, v61
    v_and_b32 v83, 0xffff0000, v61
    v_lshlrev_b32 v84, 16, v62
    v_and_b32 v85, 0xffff0000, v62
    v_lshlrev_b32 v86, 16, v63
    v_and_b32 v87, 0xffff0000, v63
    v_pk_fma_f32 v[88:89], v[34:35], v[80:81], v[88:89] op_sel:[1,0,0] op_sel_hi:[1,1,1]
    v_pk_fma_f32 v[90:91], v[34:35], v[82:83], v[90:91] op_sel:[1,0,0] op_sel_hi:[1,1,1]
    v_pk_fma_f32 v[92:93], v[34:35], v[84:85], v[92:93] op_sel:[1,0,0] op_sel_hi:[1,1,1]
    v_pk_fma_f32 v[94:95], v[34:35], v[86:87], v[94:95] op_sel:[1,0,0] op_sel_hi:[1,1,1]
    v_lshlrev_b32 v80, 16, v64
    v_and_b32 v81, 0xffff0000, v64
    v_lshlrev_b32 v82, 16, v65
    v_and_b32 v83, 0xffff0000, v65
    v_lshlrev_b32 v84, 16, v66
    v_and_b32 v85, 0xffff0000, v66
    v_lshlrev_b32 v86, 16, v67
    v_and_b32 v87, 0xffff0000, v67
    v_pk_fma_f32 v[88:89], v[36:37], v[80:81], v[88:89] op_sel:[0,0,0] op_sel_hi:[0,1,1]
    v_pk_fma_f32 v[90:91], v[36:37], v[82:83], v[90:91] op_sel:[0,0,0] op_sel_hi:[0,1,1]
    v_pk_fma_f32 v[92:93], v[36:37], v[84:85], v[92:93] op_sel:[0,0,0] op_sel_hi:[0,1,1]
    v_pk_fma_f32 v[94:95], v[36:37], v[86:87], v[94:95] op_sel:[0,0,0] op_sel_hi:[0,1,1]
    v_lshlrev_b32 v80, 16, v68
    v_and_b32 v81, 0xffff0000, v68
    v_lshlrev_b32 v82, 16, v69
    v_and_b32 v83, 0xffff0000, v69
    v_lshlrev_b32 v84, 16, v70
    v_and_b32 v85, 0xffff0000, v70
    v_lshlrev_b32 v86, 16, v71
    v_and_b32 v87, 0xffff0000, v71
    v_pk_fma_f32 v[88:89], v[36:37], v[80:81], v[88:89] op_sel:[1,0,0] op_sel_hi:[1,1,1]
    v_pk_fma_f32 v[90:91], v[36:37], v[82:83], v[90:91] op_sel:[1,0,0] op_sel_hi:[1,1,1]
    v_pk_fma_f32 v[92:93], v[36:37], v[84:85], v[92:93] op_sel:[1,0,0] op_sel_hi:[1,1,1]
    v_pk_fma_f32 v[94:95], v[36:37], v[86:87], v[94:95] op_sel:[1,0,0] op_sel_hi:[1,1,1]
    v_lshlrev_b32 v80, 16, v72
    v_and_b32 v81, 0xffff0000, v72
    v_lshlrev_b32 v82, 16, v73
    v_and_b32 v83, 0xffff0000, v73
    v_lshlrev_b32 v84, 16, v74
    v_and_b32 v85, 0xffff0000, v74
    v_lshlrev_b32 v86, 16, v75
    v_and_b32 v87, 0xffff0000, v75
    v_pk_fma_f32 v[88:89], v[38:39], v[80:81], v[88:89] op_sel:[0,0,0] op_sel_hi:[0,1,1]
    v_pk_fma_f32 v[90:91], v[38:39], v[82:83], v[90:91] op_sel:[0,0,0] op_sel_hi:[0,1,1]
    v_pk_fma_f32 v[92:93], v[38:39], v[84:85], v[92:93] op_sel:[0,0,0] op_sel_hi:[0,1,1]
    v_pk_fma_f32 v[94:95], v[38:39], v[86:87], v[94:95] op_sel:[0,0,0] op_sel_hi:[0,1,1]
    v_lshlrev_b32 v80, 16, v76
    v_and_b32 v81, 0xffff0000, v76
    v_lshlrev_b32 v82, 16, v77
    v_and_b32 v83, 0xffff0000, v77
    v_lshlrev_b32 v84, 16, v78
    v_and_b32 v85, 0xffff0000, v78
    v_lshlrev_b32 v86, 16, v79
    v_and_b32 v87, 0xffff0000, v79
    v_pk_fma_f32 v[88:89], v[38:39], v[80:81], v[88:89] op_sel:[1,0,0] op_sel_hi:[1,1,1]
    v_pk_fma_f32 v[90:91], v[38:39], v[82:83], v[90:91] op_sel:[1,0,0] op_sel_hi:[1,1,1]
    v_pk_fma_f32 v[92:93], v[38:39], v[84:85], v[92:93] op_sel:[1,0,0] op_sel_hi:[1,1,1]
    v_pk_fma_f32 v[94:95], v[38:39], v[86:87], v[94:95] op_sel:[1,0,0] op_sel_hi:[1,1,1]
    s_nop 0
    v_permlane32_swap_b32 v88, v92
    v_permlane32_swap_b32 v89, v93
    v_permlane32_swap_b32 v90, v94
    v_permlane32_swap_b32 v91, v95
    v_add_f32 v88, v88, v92
    v_add_f32 v89, v89, v93
    v_add_f32 v90, v90, v94
    v_add_f32 v91, v91, v95
    s_nop 0
    v_permlane16_swap_b32 v88, v90
    v_permlane16_swap_b32 v89, v91
    v_add_f32 v88, v88, v90
    v_add_f32 v89, v89, v91
    v_and_b32 v81, 7, v1
    v_lshrrev_b32 v82, 3, v1
    v_add_f32_dpp v80, v88, v88 row_ror:8 row_mask:0xf bank_mask:0x3
    s_nop 1
    v_add_f32_dpp v80, v89, v89 row_ror:8 row_mask:0xf bank_mask:0xc
    v_lshl_add_u32 v81, v81, 3, v82
    s_lshl_b32 s7, s3, 8
    s_add_u32 s7, s7, 124928
    v_lshl_add_u32 v81, v81, 2, s7
    ds_write_b32 v81, v80
    s_waitcnt lgkmcnt(0)
    s_barrier
    v_lshlrev_b32 v81, 2, v1
    v_add_u32 v82, 124928, v81
    ds_read_b32 v88, v82 offset:0
    ds_read_b32 v89, v82 offset:256
    ds_read_b32 v90, v82 offset:512
    ds_read_b32 v91, v82 offset:768
    v_add_u32 v81, s44, v81
    s_waitcnt lgkmcnt(2)
    v_add_f32 v88, v88, v89
    s_waitcnt lgkmcnt(0)
    v_add_f32 v90, v90, v91
    v_add_f32 v88, v88, v90
    v_min_u32 v88, -2, v88
    s_cmp_lg_u32 s3, 0
    s_cbranch_scc1 Lmod_skip_s3
    global_store_dword v81, v88, s[38:39] offset:0 sc1
Lmod_skip_s3:
Lsp_c:
    s_mov_b32 s51, 102400
Lsp_d:
    s_mov_b32 s93, s51
    s_waitcnt lgkmcnt(0)
    s_barrier
    s_lshr_b32 s5, s3, 1
    s_lshl_b32 s5, s5, 5
    s_and_b32 s6, s3, 1
    s_lshl_b32 s6, s6, 2
    s_add_u32 s6, s6, s5
    s_lshl_b32 s5, s40, 6
    s_add_u32 s90, s6, s5
    v_add_lshl_u32 v27, v5, s90, 1
    global_load_ushort v27, v27, s[26:27]
    s_and_b32 s4, s41, 3
    s_cmp_eq_u32 s4, 0
    s_cselect_b32 s5, 8, 0
    s_cmp_le_u32 s4, 1
    s_cselect_b32 s6, 16, 8
    s_cmp_eq_u32 s4, 3
    s_cselect_b32 s50, 16, 24
    s_lshl_b32 s44, s4, 3
    s_bitcmp1_b32 s43, 0
    s_cselect_b32 s46, s6, s5
    s_cselect_b32 s48, s5, s6
    s_lshl_b32 s5, s3, 1
    s_add_u32 s44, s44, s5
    s_add_u32 s45, s44, 1
    s_add_u32 s46, s46, s5
    s_add_u32 s47, s46, 1
    s_add_u32 s48, s48, s5
    s_add_u32 s49, s48, 1
    s_add_u32 s50, s50, s5
    s_add_u32 s51, s50, 1
    s_lshl_b32 s5, s40, 18
    s_lshl_b32 s6, s44, 7
    s_add_u32 s6, s6, s5
    s_add_u32 s68, s24, s6
    s_addc_u32 s69, s25, 0
    s_lshl_b32 s6, s45, 7
    s_add_u32 s6, s6, s5
    s_add_u32 s70, s24, s6
    s_addc_u32 s71, s25, 0
    s_lshl_b32 s6, s46, 7
    s_add_u32 s6, s6, s5
    s_add_u32 s72, s24, s6
    s_addc_u32 s73, s25, 0
    s_lshl_b32 s6, s47, 7
    s_add_u32 s6, s6, s5
    s_add_u32 s74, s24, s6
    s_addc_u32 s75, s25, 0
    s_lshl_b32 s6, s48, 7
    s_add_u32 s6, s6, s5
    s_add_u32 s76, s24, s6
    s_addc_u32 s77, s25, 0
    s_lshl_b32 s6, s49, 7
    s_add_u32 s6, s6, s5
    s_add_u32 s78, s24, s6
    s_addc_u32 s79, s25, 0
    s_lshl_b32 s6, s50, 7
    s_add_u32 s6, s6, s5
    s_add_u32 s80, s24, s6
    s_addc_u32 s81, s25, 0
    s_lshl_b32 s6, s51, 7
    s_add_u32 s6, s6, s5
    s_add_u32 s82, s24, s6
    s_addc_u32 s83, s25, 0
    s_lshl_b32 s89, s3, 14
    s_add_u32 s89, s89, 83200
    s_and_b32 s4, s41, 1
    s_lshl_b32 s5, s3, 1
    s_add_u32 s5, s5, s4
    s_cmp_eq_u32 s5, 7
    s_cselect_b32 s5, 0, s5
    s_mul_i32 s96, s41, 7
    s_add_u32 s96, s96, s5
    s_cmp_lt_u32 s96, 54
    s_cselect_b32 s101, 2, 0
    s_min_u32 s96, s96, 53
    s_cmp_eq_u32 s3, 3
    s_cselect_b32 s101, 1, s101
    s_lshr_b32 s97, s101, 1
    s_cselect_b32 s5, -1, 0
    v_and_b32 v7, s5, v4
    s_add_u32 s97, s97, s96
    s_mul_i32 s4, s96, 20480
    s_add_u32 s5, s4, 7344128
    s_add_u32 s8, s38, s5
    s_addc_u32 s9, s39, 0
    s_add_u32 s5, s4, 7352320
    s_add_u32 s10, s38, s5
    s_addc_u32 s11, s39, 0
    s_add_u32 s5, s4, 7360512
    s_add_u32 s12, s38, s5
    s_addc_u32 s13, s39, 0
    s_mul_i32 s4, s97, 20480
    s_add_u32 s5, s4, 7344128
    s_add_u32 s14, s38, s5
    s_addc_u32 s15, s39, 0
    s_add_u32 s5, s4, 7352320
    s_add_u32 s16, s38, s5
    s_addc_u32 s17, s39, 0
    s_add_u32 s5, s4, 7360512
    s_add_u32 s18, s38, s5
    s_addc_u32 s19, s39, 0
    v_bfe_u32 v106, v1, 3, 1
    s_sub_u32 s4, s97, s96
    v_mul_u32_u24 v106, s4, v106
    v_add_lshl_u32 v106, v106, s96, 7
    v_mul_u32_u24 v101, 7168, v3
    v_add_u32 v106, v106, v101
    v_and_b32 v101, 112, v4
    v_add_u32 v106, v106, v101
    v_add_u32 v106, 49152, v106
    v_and_b32 v100, 1, v3
    v_mul_u32_u24 v100, 7168, v100
    v_sub_u32 v100, v106, v100
    s_branch Lsp_f
Lsp:
    s_sleep 16
Lsp_f:
    global_load_dword v112, v100, s[38:39] sc1
    s_waitcnt vmcnt(0)
    v_cmp_eq_u32 vcc, -1, v112
    s_add_u32 s100, s100, 1
    s_cmp_ge_u32 s100, 262144
    s_cbranch_scc1 Lsp_x
    s_cbranch_vccnz Lsp
Lsp_x:
    s_barrier
    s_cmp_eq_u32 s93, 102400
    s_cbranch_scc1 Lsd_none
    v_mov_b32 v103, s93
    s_cmp_lg_u32 s3, 0
    s_cbranch_scc1 Lsd_skip
    global_store_dword v103, v103, s[38:39] sc1
Lsd_skip:
Lsd_none:
    global_load_dwordx4 a[248:251], v4, s[12:13] offset:-1024 sc1
    v_and_b32 v67, 7, v1
    v_lshl_add_u32 v67, v3, 3, v67
    v_bfe_u32 v69, v1, 3, 1
    global_load_dwordx4 a[252:255], v7, s[18:19] offset:-1024 sc1
    v_lshlrev_b32 v66, 9, v69
    v_lshl_add_u32 v66, v67, 4, v66
    s_mul_i32 s4, s3, 20480
    s_mul_i32 s5, s40, 114688
    global_load_dwordx4 a[240:243], v4, s[12:13] offset:-2048 sc1
    s_add_u32 s4, s4, s5
    s_add_u32 s4, s4, 1048576
    v_add_u32 v66, s4, v66
    v_lshl_add_u32 v70, v67, 1, v69
    global_load_dwordx4 a[244:247], v7, s[18:19] offset:-2048 sc1
    v_min_u32 v72, 9, v1
    v_lshl_add_u32 v72, v72, 11, s4
    v_lshrrev_b32 v67, 5, v1
    v_bfe_u32 v68, v1, 1, 1
    global_load_dwordx4 a[232:235], v4, s[12:13] offset:-3072 sc1
    v_lshl_add_u32 v67, v67, 1, v68
    v_mul_u32_u24 v68, 1040, v67
    v_bfe_u32 v67, v1, 3, 1
    v_lshl_add_u32 v68, v67, 3, v68
    global_load_dwordx4 a[236:239], v7, s[18:19] offset:-3072 sc1
    v_bfe_u32 v67, v1, 2, 1
    v_lshl_add_u32 v68, v67, 6, v68
    v_bfe_u32 v67, v1, 4, 1
    v_lshl_add_u32 v68, v67, 7, v68
    global_load_dwordx4 a[224:227], v4, s[12:13] offset:-4096 sc1
    v_bfe_u32 v67, v1, 0, 1
    v_lshl_add_u32 v68, v67, 5, v68
    s_mul_i32 s5, s3, 20800
    v_add_u32 v68, s5, v68
    global_load_dwordx4 a[228:231], v7, s[18:19] offset:-4096 sc1
    v_lshlrev_b32 v30, 3, v1
    s_lshl_b32 s88, s3, 9
    v_lshrrev_b32 v67, 3, v1
    v_lshlrev_b32 v67, 12, v67
    global_load_dwordx4 a[216:219], v4, s[10:11] offset:3072 sc1
    v_bfe_u32 v69, v1, 4, 1
    v_xor_b32 v69, v69, v1
    v_and_b32 v69, 7, v69
    global_load_dwordx4 a[220:223], v7, s[16:17] offset:3072 sc1
    v_xor_b32 v74, 0, v69
    v_lshl_add_u32 v74, v74, 4, v67
    v_add_u32 v78, 131072, v74
    v_xor_b32 v75, 2, v69
    global_load_dwordx4 a[208:211], v4, s[10:11] offset:2048 sc1
    v_lshl_add_u32 v75, v75, 4, v67
    v_add_u32 v75, 31744, v75
    v_add_u32 v79, 131072, v75
    v_xor_b32 v76, 4, v69
    global_load_dwordx4 a[212:215], v7, s[16:17] offset:2048 sc1
    v_lshl_add_u32 v76, v76, 4, v67
    v_add_u32 v76, 63488, v76
    v_add_u32 v80, 131072, v76
    v_xor_b32 v77, 6, v69
    global_load_dwordx4 a[200:203], v4, s[10:11] offset:1024 sc1
    v_lshl_add_u32 v77, v77, 4, v67
    v_add_u32 v77, 95232, v77
    v_add_u32 v81, 131072, v77
    v_lshrrev_b32 v69, 1, v2
    global_load_dwordx4 a[204:207], v7, s[16:17] offset:1024 sc1
    v_xor_b32 v69, v69, v3
    v_lshlrev_b32 v69, 4, v69
    v_lshl_add_u32 v69, v5, 7, v69
    s_xor_b32 s4, s3, 0
    global_load_dwordx4 a[192:195], v4, s[10:11] offset:0 sc1
    s_lshr_b32 s5, s4, 1
    s_lshl_b32 s5, s5, 12
    s_and_b32 s4, s4, 1
    s_lshl_b32 s4, s4, 9
    global_load_dwordx4 a[196:199], v7, s[16:17] offset:0 sc1
    s_add_u32 s4, s4, s5
    s_add_u32 s4, s4, s89
    v_add_u32 v82, s4, v69
    v_xor_b32 v83, 64, v82
    global_load_dwordx4 a[184:187], v4, s[10:11] offset:-1024 sc1
    s_xor_b32 s4, s3, 1
    s_lshr_b32 s5, s4, 1
    s_lshl_b32 s5, s5, 12
    global_load_dwordx4 a[188:191], v7, s[16:17] offset:-1024 sc1
    s_and_b32 s4, s4, 1
    s_lshl_b32 s4, s4, 9
    s_add_u32 s4, s4, s5
    s_add_u32 s4, s4, s89
    global_load_dwordx4 a[176:179], v4, s[10:11] offset:-2048 sc1
    v_add_u32 v84, s4, v69
    v_xor_b32 v85, 64, v84
    s_xor_b32 s4, s3, 2
    s_lshr_b32 s5, s4, 1
    global_load_dwordx4 a[180:183], v7, s[16:17] offset:-2048 sc1
    s_lshl_b32 s5, s5, 12
    s_and_b32 s4, s4, 1
    s_lshl_b32 s4, s4, 9
    s_add_u32 s4, s4, s5
    global_load_dwordx4 a[168:171], v4, s[10:11] offset:-3072 sc1
    s_add_u32 s4, s4, s89
    v_add_u32 v86, s4, v69
    v_xor_b32 v87, 64, v86
    s_xor_b32 s4, s3, 3
    global_load_dwordx4 a[172:175], v7, s[16:17] offset:-3072 sc1
    s_lshr_b32 s5, s4, 1
    s_lshl_b32 s5, s5, 12
    s_and_b32 s4, s4, 1
    s_lshl_b32 s4, s4, 9
    global_load_dwordx4 a[160:163], v4, s[10:11] offset:-4096 sc1
    s_add_u32 s4, s4, s5
    s_add_u32 s4, s4, s89
    v_add_u32 v88, s4, v69
    v_xor_b32 v89, 64, v88
    global_load_dwordx4 a[164:167], v7, s[16:17] offset:-4096 sc1
    s_add_u32 s52, s8, 1146880
    s_addc_u32 s53, s9, 0
    s_add_u32 s54, s10, 1146880
    s_addc_u32 s55, s11, 0
    global_load_dwordx4 a[152:155], v4, s[8:9] offset:3072 sc1
    s_add_u32 s56, s12, 1146880
    s_addc_u32 s57, s13, 0
    s_add_u32 s58, s14, 1146880
    global_load_dwordx4 a[156:159], v7, s[14:15] offset:3072 sc1
    s_addc_u32 s59, s15, 0
    s_add_u32 s60, s16, 1146880
    s_addc_u32 s61, s17, 0
    s_add_u32 s62, s18, 1146880
    global_load_dwordx4 a[144:147], v4, s[8:9] offset:2048 sc1
    s_addc_u32 s63, s19, 0
    s_mov_b32 s84, 0xc0135761
    s_mov_b32 s85, 0xbdd2d3e8
    v_lshlrev_b32 v32, 16, v27
    global_load_dwordx4 a[148:151], v7, s[14:15] offset:2048 sc1
    v_lshlrev_b32 v33, 16, v27
    v_lshlrev_b32 v34, 16, v27
    v_lshlrev_b32 v35, 16, v27
    s_mul_i32 s5, s41, 10
    global_load_dwordx4 a[136:139], v4, s[8:9] offset:1024 sc1
    s_mul_i32 s6, s3, 1040
    v_add_u32 v67, s5, v3
    v_lshrrev_b32 v69, 2, v67
    v_mul_u32_u24 v69, 3136, v69
    global_load_dwordx4 a[140:143], v7, s[14:15] offset:1024 sc1
    v_lshl_add_u32 v69, v67, 8, v69
    v_lshl_add_u32 v69, v2, 4, v69
    v_add_u32 v46, s6, v69
    v_lshrrev_b32 v67, 1, v3
    global_load_dwordx4 a[128:131], v4, s[8:9] offset:0 sc1
    v_add_u32 v67, s5, v67
    v_lshrrev_b32 v69, 2, v67
    v_mul_u32_u24 v69, 3136, v69
    v_lshl_add_u32 v69, v67, 8, v69
    global_load_dwordx4 a[132:135], v7, s[14:15] offset:0 sc1
    v_lshl_add_u32 v69, v2, 4, v69
    v_add_u32 v47, s6, v69
    v_and_b32 v67, 1, v3
    v_lshl_add_u32 v47, v67, 3, v47
    s_add_u32 m0, s89, 0
    s_nop 0
    global_load_lds_dwordx4 v74, s[68:69] offset:0
    global_load_lds_dwordx4 v75, s[68:69] offset:1024
    global_load_lds_dwordx4 v76, s[68:69] offset:2048
    global_load_lds_dwordx4 v77, s[68:69] offset:3072
    s_add_u32 m0, s89, 4096
    s_nop 0
    global_load_lds_dwordx4 v78, s[68:69] offset:0
    global_load_lds_dwordx4 v79, s[68:69] offset:1024
    global_load_lds_dwordx4 v80, s[68:69] offset:2048
    global_load_lds_dwordx4 v81, s[68:69] offset:3072
    s_lshl_b32 s4, s40, 9
    s_add_u32 s4, s4, 32772
    v_lshl_add_u32 v102, v1, 3, s4
    s_branch Lsu_f
Lsu:
    s_sleep 16
Lsu_f:
    global_load_dwordx4 v[112:115], v106, s[38:39] sc1
    global_load_dword v116, v102, s[38:39] sc1
    s_waitcnt vmcnt(0)
    v_max3_u32 v101, v112, v113, v114
    v_max3_u32 v101, v115, v116, v101
    v_cmp_eq_u32 vcc, -1, v101
    s_add_u32 s100, s100, 1
    s_cmp_ge_u32 s100, 262144
    s_cbranch_scc1 Lsu_x
    s_cbranch_vccnz Lsu
Lsu_x:
    v_permlane32_swap_b32 v112, v114
    v_permlane32_swap_b32 v113, v115
    s_lshl_b32 s4, s3, 9
    s_add_u32 s4, s4, 156672
    v_and_b32 v106, 496, v4
    v_add_f32 v112, v112, v114
    v_add_f32 v113, v113, v115
    v_bfe_u32 v114, v1, 3, 1
    v_cmp_gt_u32 vcc, s101, v114
    v_lshrrev_b32 v114, 5, v1
    v_lshl_add_u32 v106, v114, 3, v106
    v_cndmask_b32 v112, 0, v112, vcc
    v_cndmask_b32 v113, 0, v113, vcc
    v_add_u32 v106, s4, v106
    ds_write_b64 v106, v[112:113]
    s_barrier
    s_branch Ljoin
Lic_r:
    s_branch Lic_p_f
Lic_p:
    s_sleep 4
Lic_p_f:
    global_load_dword v221, v220, s[36:37] sc1
    s_waitcnt vmcnt(0)
    v_cmp_eq_u32 vcc, 0, v221
    s_add_u32 s100, s100, 1
    s_cmp_ge_u32 s100, 262144
    s_cbranch_scc1 Lic_p_x
    s_cbranch_vccnz Lic_p
Lic_p_x:
    s_branch Lic_ok
Lic2_r:
    s_branch Lic2_p_f
Lic2_p:
    s_sleep 4
Lic2_p_f:
    global_load_dword v100, v99, s[36:37] sc1
    s_waitcnt vmcnt(0)
    v_cmp_eq_u32 vcc, 0, v100
    s_add_u32 s100, s100, 1
    s_cmp_ge_u32 s100, 262144
    s_cbranch_scc1 Lic2_p_x
    s_cbranch_vccnz Lic2_p
Lic2_p_x:
    s_branch Lic2_ok
Lkf_r:
    s_nop 7
Lkf_p:
    global_load_dword v45, v44, s[38:39] sc1
    s_waitcnt vmcnt(0)
    v_cmp_eq_u32 vcc, -1, v45
    s_add_u32 s100, s100, 1
    s_cmp_ge_u32 s100, 262144
    s_cbranch_scc1 Lkf_p_x
    s_cbranch_vccnz Lkf_p
Lkf_p_x:
    s_nop 1
    s_branch Lkf_ok
Lcu_r:
    s_nop 7
Lcu_p:
    global_load_dword v234, v45, s[38:39] sc1
    s_waitcnt vmcnt(0)
    v_cmp_eq_u32 vcc, -1, v234
    s_add_u32 s100, s100, 1
    s_cmp_ge_u32 s100, 262144
    s_cbranch_scc1 Lcu_p_x
    s_cbranch_vccnz Lcu_p
Lcu_p_x:
    s_nop 1
    s_branch Lcu_ok
Lax_r:
    s_nop 7
Lax_p:
    v_lshlrev_b32 v28, 4, v0
    v_add_u32 v28, 36864, v28
    global_load_dwordx4 v[214:217], v28, s[38:39] offset:-4096 sc1
    global_load_dwordx4 v[218:221], v28, s[38:39] offset:0 sc1
    v_add_u32 v28, 8192, v28
    global_load_dwordx4 v[222:225], v28, s[38:39] offset:-4096 sc1
    global_load_dwordx4 v[226:229], v28, s[38:39] offset:0 sc1
    v_min_u32 v28, 11, v1
    v_lshrrev_b32 v29, 2, v28
    v_mul_u32_u24 v29, 2544, v29
    v_lshl_add_u32 v28, v28, 2, v29
    s_lshl_b32 s4, s42, 4
    s_add_u32 s4, s4, 0
    v_add_u32 v28, s4, v28
    global_load_dword v64, v28, s[38:39] sc1
    v_add_u32 v28, 15360, v28
    global_load_dword v65, v28, s[38:39] sc1
    s_waitcnt vmcnt(0)
    v_max_u32 v236, v215, v217
    v_max3_u32 v236, v219, v221, v236
    v_max3_u32 v236, v223, v225, v236
    v_max3_u32 v236, v227, v229, v236
    v_max3_u32 v236, v64, v65, v236
    v_cmp_eq_u32 vcc, -1, v236
    s_add_u32 s100, s100, 1
    s_cmp_ge_u32 s100, 262144
    s_cbranch_scc1 Lax_p_x
    s_cbranch_vccnz Lax_p
Lax_p_x:
    s_nop 1
    s_branch Lax_ok
Lcv_r:
    s_nop 7
Lcv_p:
    global_load_dwordx4 v[230:233], v235, s[38:39] sc1
    s_waitcnt vmcnt(0)
    v_max_u32 v236, v230, v231
    v_max3_u32 v236, v232, v233, v236
    v_cmp_eq_u32 vcc, -1, v236
    s_add_u32 s100, s100, 1
    s_cmp_ge_u32 s100, 262144
    s_cbranch_scc1 Lcv_p_x
    s_cbranch_vccnz Lcv_p
Lcv_p_x:
    s_nop 1
    s_branch Lcv_ok
Lgb_r:
    s_nop 7
Lgb_p:
    v_min_u32 v175, 26, v1
    v_lshlrev_b32 v175, 7, v175
    v_add_u32 v175, 98304, v175
    global_load_dword v250, v175, s[38:39] sc1
    s_mul_i32 s7, s41, 320
    s_add_u32 s7, s7, 12800
    v_min_u32 v175, 304, v4
    v_add_u32 v175, s7, v175
    global_load_dwordx4 v[242:245], v175, s[38:39] sc1
    v_add_u32 v175, 15360, v175
    global_load_dwordx4 v[246:249], v175, s[38:39] sc1
    s_waitcnt vmcnt(0)
    v_max3_u32 v28, v242, v243, v244
    v_max3_u32 v28, v245, v246, v28
    v_max3_u32 v28, v247, v248, v28
    v_max3_u32 v28, v249, v250, v28
    v_cmp_eq_u32 vcc, -1, v28
    s_add_u32 s100, s100, 1
    s_cmp_ge_u32 s100, 262144
    s_cbranch_scc1 Lgb_p_x
    s_cbranch_vccnz Lgb_p
Lgb_p_x:
    s_nop 1
    s_branch Lgb_ok
Ls3_r:
    s_nop 7
Ls3_p:
    global_load_dwordx2 v[130:131], v174, s[38:39] offset:0 sc1
    global_load_dwordx2 v[132:133], v174, s[38:39] offset:512 sc1
    global_load_dwordx2 v[134:135], v174, s[38:39] offset:1024 sc1
    global_load_dwordx2 v[136:137], v174, s[38:39] offset:1536 sc1
    global_load_dwordx2 v[138:139], v174, s[38:39] offset:2048 sc1
    global_load_dwordx2 v[140:141], v174, s[38:39] offset:2560 sc1
    global_load_dwordx2 v[142:143], v174, s[38:39] offset:3072 sc1
    global_load_dwordx2 v[144:145], v174, s[38:39] offset:3584 sc1
    s_waitcnt vmcnt(0)
    v_max_u32 v28, v131, v133
    v_max3_u32 v28, v135, v137, v28
    v_max3_u32 v28, v139, v141, v28
    v_max3_u32 v28, v143, v145, v28
    v_cmp_eq_u32 vcc, -1, v28
    s_add_u32 s100, s100, 1
    s_cmp_ge_u32 s100, 262144
    s_cbranch_scc1 Ls3_p_x
    s_cbranch_vccnz Ls3_p
Ls3_p_x:
    s_nop 1
    s_branch Ls3_ok
Lz0_r:
    s_nop 7
Lz0_p:
    global_load_dwordx4 v[62:65], v30, s[56:57] offset:-3072 sc1
    global_load_dwordx4 v[66:69], v30, s[56:57] offset:-2048 sc1
    global_load_dwordx4 v[70:73], v30, s[56:57] offset:-1024 sc1
    global_load_dwordx4 v[74:77], v30, s[56:57] offset:0 sc1
    global_load_dwordx4 v[78:81], v30, s[56:57] offset:1024 sc1
    global_load_dwordx4 v[82:85], v30, s[56:57] offset:2048 sc1
    global_load_dwordx4 v[86:89], v30, s[56:57] offset:3072 sc1
    global_load_dwordx4 v[90:93], v31, s[56:57] offset:-3072 sc1
    global_load_dwordx4 v[94:97], v31, s[56:57] offset:-2048 sc1
    global_load_dwordx4 v[98:101], v31, s[56:57] offset:-1024 sc1
    global_load_dwordx4 v[102:105], v31, s[56:57] offset:0 sc1
    global_load_dwordx4 v[106:109], v31, s[56:57] offset:1024 sc1
    global_load_dwordx4 v[110:113], v31, s[56:57] offset:2048 sc1
    global_load_dwordx4 v[114:117], v31, s[56:57] offset:3072 sc1
    global_load_dwordx4 v[118:121], v30, s[58:59] offset:-3072 sc1
    global_load_dwordx4 v[122:125], v30, s[58:59] offset:-2048 sc1
    s_waitcnt vmcnt(0)
    v_and_b32 v28, v65, v69
    v_bitop3_b32 v28, v73, v77, v28 bitop3:0x80
    v_and_b32 v28, 1, v28
    v_cmp_ne_u32 vcc, 1, v28
    s_add_u32 s100, s100, 1
    s_cmp_ge_u32 s100, 262144
    s_cbranch_scc1 Lz0_p_x
    s_cbranch_vccnz Lz0_p
Lz0_p_x:
    s_nop 1
    s_branch Lz0_ok
Lz1_r:
    s_nop 7
Lz1_p:
    global_load_dwordx4 v[78:81], v30, s[56:57] offset:1024 sc1
    global_load_dwordx4 v[82:85], v30, s[56:57] offset:2048 sc1
    global_load_dwordx4 v[86:89], v30, s[56:57] offset:3072 sc1
    global_load_dwordx4 v[90:93], v31, s[56:57] offset:-3072 sc1
    s_waitcnt vmcnt(0)
    v_and_b32 v28, v81, v85
    v_bitop3_b32 v28, v89, v93, v28 bitop3:0x80
    v_and_b32 v28, 1, v28
    v_cmp_ne_u32 vcc, 1, v28
    s_add_u32 s100, s100, 1
    s_cmp_ge_u32 s100, 262144
    s_cbranch_scc1 Lz1_p_x
    s_cbranch_vccnz Lz1_p
Lz1_p_x:
    s_nop 1
    s_branch Lz1_ok
Lz2_r:
    s_nop 7
Lz2_p:
    global_load_dwordx4 v[94:97], v31, s[56:57] offset:-2048 sc1
    global_load_dwordx4 v[98:101], v31, s[56:57] offset:-1024 sc1
    global_load_dwordx4 v[102:105], v31, s[56:57] offset:0 sc1
    global_load_dwordx4 v[106:109], v31, s[56:57] offset:1024 sc1
    s_waitcnt vmcnt(0)
    v_and_b32 v28, v97, v101
    v_bitop3_b32 v28, v105, v109, v28 bitop3:0x80
    v_and_b32 v28, 1, v28
    v_cmp_ne_u32 vcc, 1, v28
    s_add_u32 s100, s100, 1
    s_cmp_ge_u32 s100, 262144
    s_cbranch_scc1 Lz2_p_x
    s_cbranch_vccnz Lz2_p
Lz2_p_x:
    s_nop 1
    s_branch Lz2_ok
Lz3_r:
    s_nop 7
Lz3_p:
    global_load_dwordx4 v[110:113], v31, s[56:57] offset:2048 sc1
    global_load_dwordx4 v[114:117], v31, s[56:57] offset:3072 sc1
    global_load_dwordx4 v[118:121], v30, s[58:59] offset:-3072 sc1
    global_load_dwordx4 v[122:125], v30, s[58:59] offset:-2048 sc1
    s_waitcnt vmcnt(0)
    v_and_b32 v28, v113, v117
    v_bitop3_b32 v28, v121, v125, v28 bitop3:0x80
    v_and_b32 v28, 1, v28
    v_cmp_ne_u32 vcc, 1, v28
    s_add_u32 s100, s100, 1
    s_cmp_ge_u32 s100, 262144
    s_cbranch_scc1 Lz3_p_x
    s_cbranch_vccnz Lz3_p
Lz3_p_x:
    s_nop 1
    s_branch Lz3_ok
Lz4_r:
    s_nop 7
Lz4_p:
    global_load_dwordx4 v[126:129], v30, s[58:59] offset:-1024 sc1
    global_load_dwordx4 v[130:133], v30, s[58:59] offset:0 sc1
    global_load_dwordx4 v[134:137], v30, s[58:59] offset:1024 sc1
    global_load_dwordx4 v[138:141], v30, s[58:59] offset:2048 sc1
    s_waitcnt vmcnt(0)
    v_and_b32 v28, v129, v133
    v_bitop3_b32 v28, v137, v141, v28 bitop3:0x80
    v_and_b32 v28, 1, v28
    v_cmp_ne_u32 vcc, 1, v28
    s_add_u32 s100, s100, 1
    s_cmp_ge_u32 s100, 262144
    s_cbranch_scc1 Lz4_p_x
    s_cbranch_vccnz Lz4_p
Lz4_p_x:
    s_nop 1
    s_branch Lz4_ok
Lz5_r:
    s_nop 7
Lz5_p:
    global_load_dwordx4 v[62:65], v30, s[58:59] offset:3072 sc1
    global_load_dwordx4 v[66:69], v31, s[58:59] offset:-3072 sc1
    global_load_dwordx4 v[70:73], v31, s[58:59] offset:-2048 sc1
    global_load_dwordx4 v[74:77], v31, s[58:59] offset:-1024 sc1
    s_waitcnt vmcnt(0)
    v_and_b32 v28, v65, v69
    v_bitop3_b32 v28, v73, v77, v28 bitop3:0x80
    v_and_b32 v28, 1, v28
    v_cmp_ne_u32 vcc, 1, v28
    s_add_u32 s100, s100, 1
    s_cmp_ge_u32 s100, 262144
    s_cbranch_scc1 Lz5_p_x
    s_cbranch_vccnz Lz5_p
Lz5_p_x:
    s_nop 1
    s_branch Lz5_ok
Lz6_r:
    s_nop 7
Lz6_p:
    global_load_dwordx4 v[78:81], v31, s[58:59] offset:0 sc1
    global_load_dwordx4 v[82:85], v31, s[58:59] offset:1024 sc1
    global_load_dwordx4 v[86:89], v31, s[58:59] offset:2048 sc1
    global_load_dwordx4 v[90:93], v31, s[58:59] offset:3072 sc1
    s_waitcnt vmcnt(0)
    v_and_b32 v28, v81, v85
    v_bitop3_b32 v28, v89, v93, v28 bitop3:0x80
    v_and_b32 v28, 1, v28
    v_cmp_ne_u32 vcc, 1, v28
    s_add_u32 s100, s100, 1
    s_cmp_ge_u32 s100, 262144
    s_cbranch_scc1 Lz6_p_x
    s_cbranch_vccnz Lz6_p
Lz6_p_x:
    s_nop 1
    s_branch Lz6_ok
Lz7_r:
    s_nop 7
Lz7_p:
    global_load_dwordx4 v[94:97], v30, s[60:61] offset:-3072 sc1
    global_load_dwordx4 v[98:101], v31, s[60:61] offset:-3072 sc1
    global_load_dwordx4 v[102:105], v30, s[62:63] offset:-3072 sc1
    global_load_dwordx4 v[106:109], v31, s[62:63] offset:-3072 sc1
    s_waitcnt vmcnt(0)
    v_and_b32 v28, v97, v101
    v_bitop3_b32 v28, v105, v109, v28 bitop3:0x80
    v_and_b32 v28, 1, v28
    v_cmp_ne_u32 vcc, 1, v28
    s_add_u32 s100, s100, 1
    s_cmp_ge_u32 s100, 262144
    s_cbranch_scc1 Lz7_p_x
    s_cbranch_vccnz Lz7_p
Lz7_p_x:
    s_nop 1
    s_branch Lz7_ok
Lz8_r:
    s_nop 7
Lz8_p:
    global_load_dwordx4 v[110:113], v30, s[52:53] offset:-3072 sc1
    global_load_dwordx4 v[114:117], v31, s[52:53] offset:-3072 sc1
    global_load_dwordx4 v[118:121], v30, s[54:55] offset:-3072 sc1
    global_load_dwordx4 v[122:125], v31, s[54:55] offset:-3072 sc1
    s_waitcnt vmcnt(0)
    v_and_b32 v28, v113, v117
    v_bitop3_b32 v28, v121, v125, v28 bitop3:0x80
    v_and_b32 v28, 1, v28
    v_cmp_ne_u32 vcc, 1, v28
    s_add_u32 s100, s100, 1
    s_cmp_ge_u32 s100, 262144
    s_cbranch_scc1 Lz8_p_x
    s_cbranch_vccnz Lz8_p
Lz8_p_x:
    s_nop 1
    s_branch Lz8_ok
Lz9_r:
    s_nop 7
Lz9_p:
    global_load_dwordx4 v[126:129], v30, s[64:65] offset:-3072 sc1
    global_load_dwordx4 v[130:133], v31, s[64:65] offset:-3072 sc1
    global_load_dwordx4 v[134:137], v30, s[66:67] offset:-3072 sc1
    global_load_dwordx4 v[138:141], v31, s[66:67] offset:-3072 sc1
    s_waitcnt vmcnt(0)
    v_and_b32 v28, v129, v133
    v_bitop3_b32 v28, v137, v141, v28 bitop3:0x80
    v_and_b32 v28, 1, v28
    v_cmp_ne_u32 vcc, 1, v28
    s_add_u32 s100, s100, 1
    s_cmp_ge_u32 s100, 262144
    s_cbranch_scc1 Lz9_p_x
    s_cbranch_vccnz Lz9_p
Lz9_p_x:
    s_nop 1
    s_branch Lz9_ok
Lz10_r:
    s_nop 7
Lz10_p:
    global_load_dwordx4 v[62:65], v30, s[60:61] offset:-2048 sc1
    global_load_dwordx4 v[66:69], v31, s[60:61] offset:-2048 sc1
    global_load_dwordx4 v[70:73], v30, s[62:63] offset:-2048 sc1
    global_load_dwordx4 v[74:77], v31, s[62:63] offset:-2048 sc1
    s_waitcnt vmcnt(0)
    v_and_b32 v28, v65, v69
    v_bitop3_b32 v28, v73, v77, v28 bitop3:0x80
    v_and_b32 v28, 1, v28
    v_cmp_ne_u32 vcc, 1, v28
    s_add_u32 s100, s100, 1
    s_cmp_ge_u32 s100, 262144
    s_cbranch_scc1 Lz10_p_x
    s_cbranch_vccnz Lz10_p
Lz10_p_x:
    s_nop 1
    s_branch Lz10_ok
Lz11_r:
    s_nop 7
Lz11_p:
    global_load_dwordx4 v[78:81], v30, s[52:53] offset:-2048 sc1
    global_load_dwordx4 v[82:85], v31, s[52:53] offset:-2048 sc1
    global_load_dwordx4 v[86:89], v30, s[54:55] offset:-2048 sc1
    global_load_dwordx4 v[90:93], v31, s[54:55] offset:-2048 sc1
    s_waitcnt vmcnt(0)
    v_and_b32 v28, v81, v85
    v_bitop3_b32 v28, v89, v93, v28 bitop3:0x80
    v_and_b32 v28, 1, v28
    v_cmp_ne_u32 vcc, 1, v28
    s_add_u32 s100, s100, 1
    s_cmp_ge_u32 s100, 262144
    s_cbranch_scc1 Lz11_p_x
    s_cbranch_vccnz Lz11_p
Lz11_p_x:
    s_nop 1
    s_branch Lz11_ok
Lz12_r:
    s_nop 7
Lz12_p:
    global_load_dwordx4 v[94:97], v30, s[64:65] offset:-2048 sc1
    global_load_dwordx4 v[98:101], v31, s[64:65] offset:-2048 sc1
    global_load_dwordx4 v[102:105], v30, s[66:67] offset:-2048 sc1
    global_load_dwordx4 v[106:109], v31, s[66:67] offset:-2048 sc1
    s_waitcnt vmcnt(0)
    v_and_b32 v28, v97, v101
    v_bitop3_b32 v28, v105, v109, v28 bitop3:0x80
    v_and_b32 v28, 1, v28
    v_cmp_ne_u32 vcc, 1, v28
    s_add_u32 s100, s100, 1
    s_cmp_ge_u32 s100, 262144
    s_cbranch_scc1 Lz12_p_x
    s_cbranch_vccnz Lz12_p
Lz12_p_x:
    s_nop 1
    s_branch Lz12_ok
Lz13_r:
    s_nop 7
Lz13_p:
    global_load_dwordx4 v[110:113], v30, s[60:61] offset:-1024 sc1
    global_load_dwordx4 v[114:117], v31, s[60:61] offset:-1024 sc1
    global_load_dwordx4 v[118:121], v30, s[62:63] offset:-1024 sc1
    global_load_dwordx4 v[122:125], v31, s[62:63] offset:-1024 sc1
    s_waitcnt vmcnt(0)
    v_and_b32 v28, v113, v117
    v_bitop3_b32 v28, v121, v125, v28 bitop3:0x80
    v_and_b32 v28, 1, v28
    v_cmp_ne_u32 vcc, 1, v28
    s_add_u32 s100, s100, 1
    s_cmp_ge_u32 s100, 262144
    s_cbranch_scc1 Lz13_p_x
    s_cbranch_vccnz Lz13_p
Lz13_p_x:
    s_nop 1
    s_branch Lz13_ok
Lz14_r:
    s_nop 7
Lz14_p:
    global_load_dwordx4 v[126:129], v30, s[52:53] offset:-1024 sc1
    global_load_dwordx4 v[130:133], v31, s[52:53] offset:-1024 sc1
    global_load_dwordx4 v[134:137], v30, s[54:55] offset:-1024 sc1
    global_load_dwordx4 v[138:141], v31, s[54:55] offset:-1024 sc1
    s_waitcnt vmcnt(0)
    v_and_b32 v28, v129, v133
    v_bitop3_b32 v28, v137, v141, v28 bitop3:0x80
    v_and_b32 v28, 1, v28
    v_cmp_ne_u32 vcc, 1, v28
    s_add_u32 s100, s100, 1
    s_cmp_ge_u32 s100, 262144
    s_cbranch_scc1 Lz14_p_x
    s_cbranch_vccnz Lz14_p
Lz14_p_x:
    s_nop 1
    s_branch Lz14_ok
Lz15_r:
    s_nop 7
Lz15_p:
    global_load_dwordx4 v[62:65], v30, s[64:65] offset:-1024 sc1
    global_load_dwordx4 v[66:69], v31, s[64:65] offset:-1024 sc1
    global_load_dwordx4 v[70:73], v30, s[66:67] offset:-1024 sc1
    global_load_dwordx4 v[74:77], v31, s[66:67] offset:-1024 sc1
    s_waitcnt vmcnt(0)
    v_and_b32 v28, v65, v69
    v_bitop3_b32 v28, v73, v77, v28 bitop3:0x80
    v_and_b32 v28, 1, v28
    v_cmp_ne_u32 vcc, 1, v28
    s_add_u32 s100, s100, 1
    s_cmp_ge_u32 s100, 262144
    s_cbranch_scc1 Lz15_p_x
    s_cbranch_vccnz Lz15_p
Lz15_p_x:
    s_nop 1
    s_branch Lz15_ok
Lz16_r:
    s_nop 7
Lz16_p:
    global_load_dwordx4 v[78:81], v30, s[60:61] offset:0 sc1
    global_load_dwordx4 v[82:85], v31, s[60:61] offset:0 sc1
    global_load_dwordx4 v[86:89], v30, s[62:63] offset:0 sc1
    global_load_dwordx4 v[90:93], v31, s[62:63] offset:0 sc1
    s_waitcnt vmcnt(0)
    v_and_b32 v28, v81, v85
    v_bitop3_b32 v28, v89, v93, v28 bitop3:0x80
    v_and_b32 v28, 1, v28
    v_cmp_ne_u32 vcc, 1, v28
    s_add_u32 s100, s100, 1
    s_cmp_ge_u32 s100, 262144
    s_cbranch_scc1 Lz16_p_x
    s_cbranch_vccnz Lz16_p
Lz16_p_x:
    s_nop 1
    s_branch Lz16_ok
Lz17_r:
    s_nop 7
Lz17_p:
    global_load_dwordx4 v[94:97], v30, s[52:53] offset:0 sc1
    global_load_dwordx4 v[98:101], v31, s[52:53] offset:0 sc1
    global_load_dwordx4 v[102:105], v30, s[54:55] offset:0 sc1
    global_load_dwordx4 v[106:109], v31, s[54:55] offset:0 sc1
    s_waitcnt vmcnt(0)
    v_and_b32 v28, v97, v101
    v_bitop3_b32 v28, v105, v109, v28 bitop3:0x80
    v_and_b32 v28, 1, v28
    v_cmp_ne_u32 vcc, 1, v28
    s_add_u32 s100, s100, 1
    s_cmp_ge_u32 s100, 262144
    s_cbranch_scc1 Lz17_p_x
    s_cbranch_vccnz Lz17_p
Lz17_p_x:
    s_nop 1
    s_branch Lz17_ok
Lz18_r:
    s_nop 7
Lz18_p:
    global_load_dwordx4 v[110:113], v30, s[64:65] offset:0 sc1
    global_load_dwordx4 v[114:117], v31, s[64:65] offset:0 sc1
    global_load_dwordx4 v[118:121], v30, s[66:67] offset:0 sc1
    global_load_dwordx4 v[122:125], v31, s[66:67] offset:0 sc1
    s_waitcnt vmcnt(0)
    v_and_b32 v28, v113, v117
    v_bitop3_b32 v28, v121, v125, v28 bitop3:0x80
    v_and_b32 v28, 1, v28
    v_cmp_ne_u32 vcc, 1, v28
    s_add_u32 s100, s100, 1
    s_cmp_ge_u32 s100, 262144
    s_cbranch_scc1 Lz18_p_x
    s_cbranch_vccnz Lz18_p
Lz18_p_x:
    s_nop 1
    s_branch Lz18_ok
Lz19_r:
    s_nop 7
Lz19_p:
    global_load_dwordx4 v[126:129], v30, s[60:61] offset:1024 sc1
    global_load_dwordx4 v[130:133], v31, s[60:61] offset:1024 sc1
    global_load_dwordx4 v[134:137], v30, s[62:63] offset:1024 sc1
    global_load_dwordx4 v[138:141], v31, s[62:63] offset:1024 sc1
    s_waitcnt vmcnt(0)
    v_and_b32 v28, v129, v133
    v_bitop3_b32 v28, v137, v141, v28 bitop3:0x80
    v_and_b32 v28, 1, v28
    v_cmp_ne_u32 vcc, 1, v28
    s_add_u32 s100, s100, 1
    s_cmp_ge_u32 s100, 262144
    s_cbranch_scc1 Lz19_p_x
    s_cbranch_vccnz Lz19_p
Lz19_p_x:
    s_nop 1
    s_branch Lz19_ok
Lz20_r:
    s_nop 7
Lz20_p:
    global_load_dwordx4 v[62:65], v30, s[52:53] offset:1024 sc1
    global_load_dwordx4 v[66:69], v31, s[52:53] offset:1024 sc1
    global_load_dwordx4 v[70:73], v30, s[54:55] offset:1024 sc1
    global_load_dwordx4 v[74:77], v31, s[54:55] offset:1024 sc1
    s_waitcnt vmcnt(0)
    v_and_b32 v28, v65, v69
    v_bitop3_b32 v28, v73, v77, v28 bitop3:0x80
    v_and_b32 v28, 1, v28
    v_cmp_ne_u32 vcc, 1, v28
    s_add_u32 s100, s100, 1
    s_cmp_ge_u32 s100, 262144
    s_cbranch_scc1 Lz20_p_x
    s_cbranch_vccnz Lz20_p
Lz20_p_x:
    s_nop 1
    s_branch Lz20_ok
Lz21_r:
    s_nop 7
Lz21_p:
    global_load_dwordx4 v[78:81], v30, s[64:65] offset:1024 sc1
    global_load_dwordx4 v[82:85], v31, s[64:65] offset:1024 sc1
    global_load_dwordx4 v[86:89], v30, s[66:67] offset:1024 sc1
    global_load_dwordx4 v[90:93], v31, s[66:67] offset:1024 sc1
    s_waitcnt vmcnt(0)
    v_and_b32 v28, v81, v85
    v_bitop3_b32 v28, v89, v93, v28 bitop3:0x80
    v_and_b32 v28, 1, v28
    v_cmp_ne_u32 vcc, 1, v28
    s_add_u32 s100, s100, 1
    s_cmp_ge_u32 s100, 262144
    s_cbranch_scc1 Lz21_p_x
    s_cbranch_vccnz Lz21_p
Lz21_p_x:
    s_nop 1
    s_branch Lz21_ok
Lz22_r:
    s_nop 7
Lz22_p:
    global_load_dwordx4 v[94:97], v30, s[60:61] offset:2048 sc1
    global_load_dwordx4 v[98:101], v31, s[60:61] offset:2048 sc1
    global_load_dwordx4 v[102:105], v30, s[62:63] offset:2048 sc1
    global_load_dwordx4 v[106:109], v31, s[62:63] offset:2048 sc1
    s_waitcnt vmcnt(0)
    v_and_b32 v28, v97, v101
    v_bitop3_b32 v28, v105, v109, v28 bitop3:0x80
    v_and_b32 v28, 1, v28
    v_cmp_ne_u32 vcc, 1, v28
    s_add_u32 s100, s100, 1
    s_cmp_ge_u32 s100, 262144
    s_cbranch_scc1 Lz22_p_x
    s_cbranch_vccnz Lz22_p
Lz22_p_x:
    s_nop 1
    s_branch Lz22_ok
Lz23_r:
    s_nop 7
Lz23_p:
    global_load_dwordx4 v[110:113], v30, s[52:53] offset:2048 sc1
    global_load_dwordx4 v[114:117], v31, s[52:53] offset:2048 sc1
    global_load_dwordx4 v[118:121], v30, s[54:55] offset:2048 sc1
    global_load_dwordx4 v[122:125], v31, s[54:55] offset:2048 sc1
    s_waitcnt vmcnt(0)
    v_and_b32 v28, v113, v117
    v_bitop3_b32 v28, v121, v125, v28 bitop3:0x80
    v_and_b32 v28, 1, v28
    v_cmp_ne_u32 vcc, 1, v28
    s_add_u32 s100, s100, 1
    s_cmp_ge_u32 s100, 262144
    s_cbranch_scc1 Lz23_p_x
    s_cbranch_vccnz Lz23_p
Lz23_p_x:
    s_nop 1
    s_branch Lz23_ok
Lz24_r:
    s_nop 7
Lz24_p:
    global_load_dwordx4 v[126:129], v30, s[64:65] offset:2048 sc1
    global_load_dwordx4 v[130:133], v31, s[64:65] offset:2048 sc1
    global_load_dwordx4 v[134:137], v30, s[66:67] offset:2048 sc1
    global_load_dwordx4 v[138:141], v31, s[66:67] offset:2048 sc1
    s_waitcnt vmcnt(0)
    v_and_b32 v28, v129, v133
    v_bitop3_b32 v28, v137, v141, v28 bitop3:0x80
    v_and_b32 v28, 1, v28
    v_cmp_ne_u32 vcc, 1, v28
    s_add_u32 s100, s100, 1
    s_cmp_ge_u32 s100, 262144
    s_cbranch_scc1 Lz24_p_x
    s_cbranch_vccnz Lz24_p
Lz24_p_x:
    s_nop 1
    s_branch Lz24_ok
Lz25_r:
    s_nop 7
Lz25_p:
    global_load_dwordx4 v[62:65], v30, s[60:61] offset:3072 sc1
    global_load_dwordx4 v[66:69], v31, s[60:61] offset:3072 sc1
    global_load_dwordx4 v[70:73], v30, s[62:63] offset:3072 sc1
    global_load_dwordx4 v[74:77], v31, s[62:63] offset:3072 sc1
    s_waitcnt vmcnt(0)
    v_and_b32 v28, v65, v69
    v_bitop3_b32 v28, v73, v77, v28 bitop3:0x80
    v_and_b32 v28, 1, v28
    v_cmp_ne_u32 vcc, 1, v28
    s_add_u32 s100, s100, 1
    s_cmp_ge_u32 s100, 262144
    s_cbranch_scc1 Lz25_p_x
    s_cbranch_vccnz Lz25_p
Lz25_p_x:
    s_nop 1
    s_branch Lz25_ok
Lz26_r:
    s_nop 7
Lz26_p:
    global_load_dwordx4 v[78:81], v30, s[52:53] offset:3072 sc1
    global_load_dwordx4 v[82:85], v31, s[52:53] offset:3072 sc1
    global_load_dwordx4 v[86:89], v30, s[54:55] offset:3072 sc1
    global_load_dwordx4 v[90:93], v31, s[54:55] offset:3072 sc1
    s_waitcnt vmcnt(0)
    v_and_b32 v28, v81, v85
    v_bitop3_b32 v28, v89, v93, v28 bitop3:0x80
    v_and_b32 v28, 1, v28
    v_cmp_ne_u32 vcc, 1, v28
    s_add_u32 s100, s100, 1
    s_cmp_ge_u32 s100, 262144
    s_cbranch_scc1 Lz26_p_x
    s_cbranch_vccnz Lz26_p
Lz26_p_x:
    s_nop 1
    s_branch Lz26_ok
Lz27_r:
    s_nop 7
Lz27_p:
    global_load_dwordx4 v[94:97], v30, s[64:65] offset:3072 sc1
    global_load_dwordx4 v[98:101], v31, s[64:65] offset:3072 sc1
    global_load_dwordx4 v[102:105], v30, s[66:67] offset:3072 sc1
    global_load_dwordx4 v[106:109], v31, s[66:67] offset:3072 sc1
    s_waitcnt vmcnt(0)
    v_and_b32 v28, v97, v101
    v_bitop3_b32 v28, v105, v109, v28 bitop3:0x80
    v_and_b32 v28, 1, v28
    v_cmp_ne_u32 vcc, 1, v28
    s_add_u32 s100, s100, 1
    s_cmp_ge_u32 s100, 262144
    s_cbranch_scc1 Lz27_p_x
    s_cbranch_vccnz Lz27_p
Lz27_p_x:
    s_nop 1
    s_branch Lz27_ok
Lp0_r:
    s_nop 7
Lp0_p:
    global_load_dwordx4 v[142:145], v6, s[38:39] offset:-4096 sc1
    global_load_dwordx4 v[146:149], v6, s[38:39] offset:-3072 sc1
    global_load_dwordx4 v[150:153], v6, s[38:39] offset:-2048 sc1
    global_load_dwordx4 v[154:157], v6, s[38:39] offset:-1024 sc1
    global_load_dwordx4 v[158:161], v6, s[38:39] offset:0 sc1
    global_load_dwordx4 v[162:165], v6, s[38:39] offset:1024 sc1
    global_load_dwordx4 v[166:169], v6, s[38:39] offset:2048 sc1
    global_load_dwordx4 v[170:173], v6, s[38:39] offset:3072 sc1
    s_waitcnt vmcnt(0)
    v_or_b32 v28, v145, v149
    v_or3_b32 v28, v153, v157, v28
    v_or3_b32 v28, v161, v165, v28
    v_or3_b32 v28, v169, v173, v28
    v_and_b32 v28, 1, v28
    v_cmp_ne_u32 vcc, 0, v28
    s_add_u32 s100, s100, 1
    s_cmp_ge_u32 s100, 262144
    s_cbranch_scc1 Lp0_p_x
    s_cbranch_vccnz Lp0_p
Lp0_p_x:
    s_nop 1
    s_branch Lp0_ok
Lp1_r:
    s_nop 7
Lp1_p:
    global_load_dwordx4 v[174:177], v7, s[38:39] offset:-4096 sc1
    global_load_dwordx4 v[178:181], v7, s[38:39] offset:-3072 sc1
    global_load_dwordx4 v[182:185], v7, s[38:39] offset:-2048 sc1
    global_load_dwordx4 v[186:189], v7, s[38:39] offset:-1024 sc1
    global_load_dwordx4 v[190:193], v7, s[38:39] offset:0 sc1
    global_load_dwordx4 v[194:197], v7, s[38:39] offset:1024 sc1
    global_load_dwordx4 v[198:201], v7, s[38:39] offset:2048 sc1
    global_load_dwordx4 v[202:205], v7, s[38:39] offset:3072 sc1
    s_waitcnt vmcnt(0)
    v_or_b32 v28, v177, v181
    v_or3_b32 v28, v185, v189, v28
    v_or3_b32 v28, v193, v197, v28
    v_or3_b32 v28, v201, v205, v28
    v_and_b32 v28, 1, v28
    v_cmp_ne_u32 vcc, 0, v28
    s_add_u32 s100, s100, 1
    s_cmp_ge_u32 s100, 262144
    s_cbranch_scc1 Lp1_p_x
    s_cbranch_vccnz Lp1_p
Lp1_p_x:
    s_nop 1
    s_branch Lp1_ok
Lp2_r:
    s_nop 7
Lp2_p:
    global_load_dwordx4 v[206:209], v26, s[38:39] offset:-4096 sc1
    global_load_dwordx4 v[210:213], v26, s[38:39] offset:-3072 sc1
    global_load_dwordx4 v[214:217], v26, s[38:39] offset:-2048 sc1
    global_load_dwordx4 v[218:221], v26, s[38:39] offset:-1024 sc1
    global_load_dwordx4 v[222:225], v26, s[38:39] offset:0 sc1
    global_load_dwordx4 v[226:229], v26, s[38:39] offset:1024 sc1
    global_load_dwordx4 v[230:233], v26, s[38:39] offset:2048 sc1
    s_waitcnt vmcnt(0)
    v_or3_b32 v28, v209, v213, v217
    v_or3_b32 v28, v221, v225, v28
    v_or3_b32 v28, v229, v233, v28
    v_and_b32 v28, 1, v28
    v_cmp_ne_u32 vcc, 0, v28
    s_add_u32 s100, s100, 1
    s_cmp_ge_u32 s100, 262144
    s_cbranch_scc1 Lp2_p_x
    s_cbranch_vccnz Lp2_p
Lp2_p_x:
    s_nop 1
    s_branch Lp2_ok
Lp3_r:
    s_nop 7
Lp3_p:
    global_load_dwordx4 v[238:241], v27, s[38:39] offset:-4096 sc1
    global_load_dwordx4 v[242:245], v27, s[38:39] offset:-3072 sc1
    global_load_dwordx4 v[246:249], v27, s[38:39] offset:-2048 sc1
    global_load_dwordx4 v[250:253], v27, s[38:39] offset:-1024 sc1
    s_waitcnt vmcnt(0)
    v_or_b32 v28, v239, v241
    v_or3_b32 v28, v243, v245, v28
    v_or3_b32 v28, v247, v249, v28
    v_or3_b32 v28, v251, v253, v28
    v_and_b32 v28, 1, v28
    v_cmp_ne_u32 vcc, 0, v28
    s_add_u32 s100, s100, 1
    s_cmp_ge_u32 s100, 262144
    s_cbranch_scc1 Lp3_p_x
    s_cbranch_vccnz Lp3_p
Lp3_p_x:
    s_nop 1
    s_branch Lp3_ok
Lcode_end:
    s_endpgm
.section .rodata,"a"
.p2align 6
.amdhsa_kernel adaLN_cond__ssm_conv_h3__mixer_gmlp__prompt_kernel
  .amdhsa_next_free_vgpr 512
  .amdhsa_next_free_sgpr 102
  .amdhsa_accum_offset 256
  .amdhsa_group_segment_fixed_size 0
  .amdhsa_kernarg_size 128
  .amdhsa_user_sgpr_count 2
  .amdhsa_user_sgpr_kernarg_segment_ptr 1
  .amdhsa_system_sgpr_workgroup_id_x 1
  .amdhsa_float_denorm_mode_32 3
.end_amdhsa_kernel
```
